```python
import torch

def _softmax(x, axis=-1):
    return torch.softmax(x, dim=axis)
def _gelu(x):
    return torch.nn.functional.gelu(x, approximate="tanh")
def _silu(x):
    return torch.nn.functional.silu(x)
def _sigmoid(x):
    return torch.sigmoid(x)
def _layernorm(x, axis=-1, eps=1e-5):
    m = x.mean(dim=axis, keepdim=True)
    v = x.var(dim=axis, keepdim=True, unbiased=False)
    return (x - m) / torch.sqrt(v + eps)
def _scatter_add(tgt, idx, src, axis=0):
    return tgt.clone().index_add_(axis, idx, src)
def _segment_sum(src, seg, n):
    out = torch.zeros((n,) + src.shape[1:], dtype=src.dtype)
    return out.index_add_(0, seg, src)
def _pad(x, pw):
    flat = tuple(v for pair in reversed(pw) for v in pair)
    return torch.nn.functional.pad(x, flat)

kernel_name = 'standalone__deep_cross_pnn__recsys'

def setup_inputs():

    _w = (lambda a: (lambda t: t.to(torch.bfloat16) if t.is_floating_point() else t)(torch.as_tensor(a)))
    B, F, D, V = 16384, 100, 128, min(1000, 100000)
    H = 4 * D
    return {
        "idx": _w((lambda lo, hi, *s: torch.randint(lo, hi, s))(0, V, B, F).to(torch.int64)),
        "table": _w((lambda *s: torch.randn(*s, dtype=torch.bfloat16) * 1.6)(V, D) * (D ** -0.5)),
        "w_p": _w((lambda *s: torch.randn(*s, dtype=torch.bfloat16) * 0.05)(F * F) * ((F * F) ** -0.5)),
        "w1": _w((lambda *s: torch.randn(*s, dtype=torch.bfloat16) * 1.6)(F * D, H) * ((F * D) ** -0.5)),
        "b1": _w((lambda *s: torch.randn(*s, dtype=torch.bfloat16) * 12.8)(H) * 0.01),
        "w2": _w((lambda *s: torch.randn(*s, dtype=torch.bfloat16) * 0.05)(H) * (H ** -0.5)),
        "b2": _w((lambda *s: torch.randn(*s, dtype=torch.bfloat16) * 1.6)(1) * 0.01),
    }

def reference(idx, table, w_p, w1, b1, w2, b2):
    emb = table[idx]
    B = emb.shape[0]; F = emb.shape[1]; D = emb.shape[2]
    ip = torch.einsum('bid,bjd->bij', emb, emb)
    ip = ip.reshape(B, F * F)
    logit_p = ip @ w_p
    z = emb.reshape(B, F * D)
    h = _gelu(z @ w1 + b1)
    logit_d = h @ w2 + b2
    return logit_p + logit_d
```

```asm
; @launch grid=(256,1,1) block=(512,1,1) lds=163840
.amdgcn_target "amdgcn-amd-amdhsa--gfx950"
.text
.globl standalone__deep_cross_pnn__recsys_kernel
.p2align 8
.type standalone__deep_cross_pnn__recsys_kernel,@function
standalone__deep_cross_pnn__recsys_kernel:

    s_cmp_ge_u32 s2, 256
    s_cbranch_scc1 standalone__deep_cross_pnn__recsys_kernel_end
    s_load_dwordx8 s[4:11], s[0:1], 0
    s_load_dwordx2 s[12:13], s[0:1], 72
    s_load_dwordx2 s[52:53], s[0:1], 64
    v_lshrrev_b32 v1, 6, v0
    v_and_b32 v255, 63, v0
    s_bfe_u32 s36, s2, 0x10003
    v_readfirstlane_b32 s3, v1
    s_lshr_b32 s37, s2, 4
    s_lshl_b32 s37, s37, 3
    s_and_b32 s38, s2, 7
    s_or_b32 s37, s37, s38
    v_lshlrev_b32 v254, 4, v255
    v_mov_b32 v252, 163712
    v_mov_b32 v253, 1
    v_mov_b32 v40, 0
    v_cmp_gt_u32 vcc, 8, v0
    v_lshl_add_u32 v41, v0, 2, v252
    s_and_saveexec_b64 s[46:47], vcc
    ds_write_b32 v41, v40
    s_mov_b64 exec, s[46:47]
    v_mul_u32_u24 v6, 57, v255
    v_lshrrev_b32 v6, 9, v6
    v_mul_u32_u24 v5, 9, v6
    v_sub_u32 v5, v255, v5
    v_cmp_gt_u32 s[40:41], 8, v5
    v_lshlrev_b32 v5, 4, v5
    v_lshl_add_u32 v83, v6, 8, v5
    s_and_b32 s56, s3, 3
    s_mul_i32 s42, s56, 1792
    s_mul_i32 s43, s56, 1008
    s_lshl_b32 s38, s36, 7
    s_add_u32 s42, s42, s38
    s_bitset0_b32 s41, 31
    s_waitcnt lgkmcnt(0)

    s_mov_b32 s16, s4
    s_and_b32 s17, s5, 0xffff
    s_mov_b32 s18, 6553600
    s_mov_b32 s19, 0x00020000
    s_mov_b32 s20, s6
    s_and_b32 s21, s7, 0xffff
    s_mov_b32 s22, 256000
    s_mov_b32 s23, 0x00020000
    s_mov_b32 s24, s8
    s_and_b32 s25, s9, 0xffff
    s_mov_b32 s26, 20000
    s_mov_b32 s27, 0x00020000
    s_mov_b32 s28, s10
    s_and_b32 s29, s11, 0xffff
    s_mov_b32 s30, 13107200
    s_mov_b32 s31, 0x00020000
    s_mov_b32 s32, s12
    s_and_b32 s33, s13, 0xffff
    s_mov_b32 s34, 268435456
    s_mov_b32 s35, 0x00020000
    s_mov_b32 s12, s12
    s_and_b32 s13, s13, 0xffff
    s_mov_b32 s14, 268435456
    s_mov_b32 s15, 0x00020000
    s_mov_b32 s52, s52
    s_and_b32 s53, s53, 0xffff
    s_mov_b32 s54, 256
    s_mov_b32 s55, 0x00020000
    s_mov_b32 s50, s36

    s_cmp_ge_u32 s3, 4
    s_cbranch_scc1 standalone__deep_cross_pnn__recsys_kernel_aux

    s_setprio 3
    s_lshl_b32 s38, s3, 10
    s_add_u32 m0, s38, 144144
    v_and_b32 v5, 15, v255

    buffer_load_dwordx4 v254, s[24:27], s38 offen lds
    s_add_u32 m0, m0, 4096
    s_add_u32 s38, s38, 4096
    buffer_load_dwordx4 v254, s[24:27], s38 offen lds
    s_add_u32 m0, m0, 4096
    s_add_u32 s38, s38, 4096
    buffer_load_dwordx4 v254, s[24:27], s38 offen lds
    s_add_u32 m0, m0, 4096
    s_add_u32 s38, s38, 4096
    buffer_load_dwordx4 v254, s[24:27], s38 offen lds
    s_add_u32 m0, m0, 4096
    s_add_u32 s38, s38, 4096
    s_cmp_eq_u32 s3, 3
    s_cselect_b32 s45, 1024, 0
    s_sub_u32 m0, m0, s45
    s_sub_u32 s38, s38, s45
    buffer_load_dwordx4 v254, s[24:27], s38 offen lds

    v_lshrrev_b32 v6, 4, v255
    v_and_b32 v8, 3, v255
    v_bfe_u32 v7, v255, 2, 2
    v_mul_u32_u24 v245, 24, v5
    s_movk_i32 s45, 400
    v_lshlrev_b32 v246, 2, v7
    v_mad_u32_u24 v246, v8, s45, v246
    s_lshl_b32 s72, s37, 7
    s_lshl_b32 s73, s3, 5
    s_add_u32 s72, s72, s73
    s_mul_i32 s74, s72, 400
    s_add_u32 s58, s74, 12800
    s_mov_b32 s18, s58
    v_mul_u32_u24 v184, 12, v5
    s_movk_i32 s45, 200
    v_mad_u32_u24 v185, v6, s45, v184
    v_lshlrev_b32 v186, 1, v7
    v_mad_u32_u24 v186, v6, s45, v186
    v_mov_b32 v90, 0
    s_movk_i32 s45, 19200

    buffer_load_dwordx3 v[188:190], v185, s[24:27], s45 offen
    buffer_load_short_d16_hi v90, v186, s[24:27], s45 offen offset:192
    buffer_load_dwordx4 v[192:195], v245, s[16:19], s74 offen
    buffer_load_dwordx2 v[196:197], v245, s[16:19], s74 offen offset:16
    buffer_load_dword v198, v246, s[16:19], s74 offen offset:384
    buffer_load_dwordx4 v[218:221], v245, s[16:19], s74 offen offset:400
    buffer_load_dwordx2 v[222:223], v245, s[16:19], s74 offen offset:416
    buffer_load_dwordx4 v[224:227], v245, s[16:19], s74 offen offset:800
    buffer_load_dwordx2 v[228:229], v245, s[16:19], s74 offen offset:816
    buffer_load_dwordx4 v[230:233], v245, s[16:19], s74 offen offset:1200
    buffer_load_dwordx2 v[234:235], v245, s[16:19], s74 offen offset:1216
    buffer_load_dwordx4 v[212:215], v245, s[16:19], s74 offen offset:1600
    buffer_load_dwordx2 v[216:217], v245, s[16:19], s74 offen offset:1616
    buffer_load_dword v236, v246, s[16:19], s74 offen offset:1984

    v_add_u32 v184, 144144, v184
    s_movk_i32 s45, 4800
    v_mad_u32_u24 v184, v6, s45, v184
    v_mul_u32_u24 v186, 1200, v5
    v_add_u32 v186, 144144, v186
    v_mad_u32_u24 v185, v6, 48, v186
    v_lshl_add_u32 v186, v6, 1, v186
    v_and_b32 v244, 48, v255
    s_movk_i32 s57, 144
    v_cmp_eq_u32 s[60:61], 0, v8
    v_cmp_eq_u32 s[62:63], 1, v8
    v_cmp_eq_u32 s[66:67], 2, v8
    v_cmp_eq_u32 s[68:69], 3, v8
    s_mov_b32 s70, 0x00010001
    s_mov_b32 s71, 0x00010001

    v_mov_b32 v0, 0
    v_mov_b32 v1, 0
    v_mov_b32 v2, 0
    v_mov_b32 v3, 0
    v_mov_b32 v4, 0
    v_mov_b32 v5, 0
    v_mov_b32 v6, 0
    v_mov_b32 v7, 0
    v_mov_b32 v8, 0
    v_mov_b32 v9, 0
    v_mov_b32 v10, 0
    v_mov_b32 v11, 0
    v_mov_b32 v12, 0
    v_mov_b32 v13, 0
    v_mov_b32 v14, 0
    v_mov_b32 v15, 0
    v_mov_b32 v16, 0
    v_mov_b32 v17, 0
    v_mov_b32 v18, 0
    v_mov_b32 v19, 0
    v_mov_b32 v20, 0
    v_mov_b32 v21, 0
    v_mov_b32 v22, 0
    v_mov_b32 v23, 0
    v_mov_b32 v24, 0
    v_mov_b32 v25, 0
    v_mov_b32 v26, 0
    v_mov_b32 v27, 0
    v_mov_b32 v28, 0
    v_mov_b32 v29, 0
    v_mov_b32 v30, 0
    v_mov_b32 v31, 0
    v_mov_b32 v32, 0
    v_mov_b32 v33, 0
    v_mov_b32 v34, 0
    v_mov_b32 v35, 0
    v_mov_b32 v36, 0
    v_mov_b32 v37, 0
    v_mov_b32 v38, 0
    v_mov_b32 v39, 0
    v_mov_b32 v40, 0
    v_mov_b32 v41, 0
    v_mov_b32 v42, 0
    v_mov_b32 v43, 0
    v_mov_b32 v44, 0
    v_mov_b32 v45, 0
    v_mov_b32 v46, 0
    v_mov_b32 v47, 0
    v_mov_b32 v48, 0
    v_mov_b32 v49, 0
    v_mov_b32 v50, 0
    v_mov_b32 v51, 0
    v_mov_b32 v52, 0
    v_mov_b32 v53, 0
    v_mov_b32 v54, 0
    v_mov_b32 v55, 0
    v_mov_b32 v56, 0
    v_mov_b32 v57, 0
    v_mov_b32 v58, 0
    v_mov_b32 v59, 0
    v_mov_b32 v60, 0
    v_mov_b32 v61, 0
    v_mov_b32 v62, 0
    v_mov_b32 v63, 0
    v_mov_b32 v64, 0
    v_mov_b32 v65, 0
    v_mov_b32 v66, 0
    v_mov_b32 v67, 0
    v_mov_b32 v68, 0
    v_mov_b32 v69, 0
    v_mov_b32 v70, 0
    v_mov_b32 v71, 0
    v_mov_b32 v72, 0
    v_mov_b32 v73, 0
    v_mov_b32 v74, 0
    v_mov_b32 v75, 0
    v_mov_b32 v76, 0
    v_mov_b32 v77, 0
    v_mov_b32 v78, 0
    v_mov_b32 v79, 0
    v_mov_b32 v80, 0
    v_mov_b32 v81, 0
    v_mov_b32 v82, 0
    v_mov_b32 v83, 0
    v_mov_b32 v84, 0
    v_mov_b32 v85, 0
    v_mov_b32 v86, 0
    v_mov_b32 v87, 0
    v_mov_b32 v88, 0
    v_mov_b32 v89, 0
    s_waitcnt vmcnt(14)
    s_barrier
    ds_read_b64 v[96:97], v185 offset:200
    ds_read_b64 v[98:99], v185 offset:208
    ds_read_b64 v[100:101], v185 offset:224
    ds_read_b64 v[102:103], v185 offset:232
    ds_read_b64 v[104:105], v185 offset:400
    ds_read_b64 v[106:107], v185 offset:408
    ds_read_b64 v[108:109], v185 offset:424
    ds_read_b64 v[110:111], v185 offset:432
    ds_read_b64 v[112:113], v185 offset:600
    ds_read_b64 v[114:115], v185 offset:608
    ds_read_b64 v[116:117], v185 offset:616
    ds_read_b64 v[118:119], v185 offset:624
    ds_read_b64 v[120:121], v185 offset:632
    ds_read_b64 v[122:123], v185 offset:640
    ds_read_b64 v[124:125], v185 offset:800
    ds_read_b64 v[126:127], v185 offset:808
    ds_read_b64 v[128:129], v185 offset:816
    ds_read_b64 v[130:131], v185 offset:824
    ds_read_b64 v[132:133], v185 offset:832
    ds_read_b64 v[134:135], v185 offset:840
    ds_read_b64 v[136:137], v185 offset:1000
    ds_read_b64 v[138:139], v185 offset:1008
    ds_read_b64 v[140:141], v185 offset:1016
    ds_read_b64 v[142:143], v185 offset:1024
    ds_read_b64 v[144:145], v185 offset:1032
    ds_read_b64 v[146:147], v185 offset:1040
    ds_read_u16_d16_hi v84, v186 offset:192
    ds_read_u16_d16_hi v85, v186 offset:392
    ds_read_u16_d16_hi v86, v186 offset:592
    ds_read_u16_d16_hi v87, v186 offset:792
    ds_read_u16_d16_hi v88, v186 offset:992
    ds_read_u16_d16_hi v89, v186 offset:1192
    ds_read_u16_d16_hi v4, v184 offset:2
    ds_read_u16_d16_hi v5, v184 offset:1202
    ds_read_u16_d16_hi v6, v184 offset:2402
    ds_read_u16_d16_hi v7, v184 offset:3602
    ds_read_u16_d16_hi v8, v184 offset:4
    ds_read_u16_d16_hi v9, v184 offset:1204
    ds_read_u16_d16_hi v10, v184 offset:2404
    ds_read_u16_d16_hi v11, v184 offset:3604
    ds_read_u16_d16_hi v12, v184 offset:6
    ds_read_u16_d16_hi v13, v184 offset:1206
    ds_read_u16_d16_hi v14, v184 offset:2406
    ds_read_u16_d16_hi v15, v184 offset:3606
    ds_read_u16_d16_hi v16, v184 offset:8
    ds_read_u16_d16_hi v17, v184 offset:1208
    ds_read_u16_d16_hi v18, v184 offset:2408
    ds_read_u16_d16_hi v19, v184 offset:3608
    ds_read_u16_d16_hi v20, v184 offset:10
    ds_read_u16_d16_hi v21, v184 offset:1210
    ds_read_u16_d16_hi v22, v184 offset:2410
    ds_read_u16_d16_hi v23, v184 offset:3610
    ds_read_u16_d16_hi v28, v184 offset:204
    ds_read_u16_d16_hi v29, v184 offset:1404
    ds_read_u16_d16_hi v30, v184 offset:2604
    ds_read_u16_d16_hi v31, v184 offset:3804
    ds_read_u16_d16_hi v32, v184 offset:206
    ds_read_u16_d16_hi v33, v184 offset:1406
    ds_read_u16_d16_hi v34, v184 offset:2606
    ds_read_u16_d16_hi v35, v184 offset:3806
    ds_read_u16_d16_hi v36, v184 offset:208
    ds_read_u16_d16_hi v37, v184 offset:1408
    ds_read_u16_d16_hi v38, v184 offset:2608
    ds_read_u16_d16_hi v39, v184 offset:3808
    ds_read_u16_d16_hi v40, v184 offset:210
    ds_read_u16_d16_hi v41, v184 offset:1410
    ds_read_u16_d16_hi v42, v184 offset:2610
    ds_read_u16_d16_hi v43, v184 offset:3810
    ds_read_u16_d16_hi v48, v184 offset:406
    ds_read_u16_d16_hi v49, v184 offset:1606
    ds_read_u16_d16_hi v50, v184 offset:2806
    ds_read_u16_d16_hi v51, v184 offset:4006
    ds_read_u16_d16_hi v52, v184 offset:408
    ds_read_u16_d16_hi v53, v184 offset:1608
    ds_read_u16_d16_hi v54, v184 offset:2808
    ds_read_u16_d16_hi v55, v184 offset:4008
    ds_read_u16_d16_hi v56, v184 offset:410
    ds_read_u16_d16_hi v57, v184 offset:1610
    ds_read_u16_d16_hi v58, v184 offset:2810
    ds_read_u16_d16_hi v59, v184 offset:4010
    ds_read_u16_d16_hi v64, v184 offset:608
    ds_read_u16_d16_hi v65, v184 offset:1808
    ds_read_u16_d16_hi v66, v184 offset:3008
    ds_read_u16_d16_hi v67, v184 offset:4208
    ds_read_u16_d16_hi v68, v184 offset:610
    ds_read_u16_d16_hi v69, v184 offset:1810
    ds_read_u16_d16_hi v70, v184 offset:3010
    ds_read_u16_d16_hi v71, v184 offset:4210
    ds_read_u16_d16_hi v76, v184 offset:810
    ds_read_u16_d16_hi v77, v184 offset:2010
    ds_read_u16_d16_hi v78, v184 offset:3210
    ds_read_u16_d16_hi v79, v184 offset:4410
    ds_read_u16_d16_hi v0, v184 offset:0
    ds_read_u16_d16_hi v1, v184 offset:1200
    ds_read_u16_d16_hi v2, v184 offset:2400
    ds_read_u16_d16_hi v3, v184 offset:3600
    ds_read_u16_d16_hi v24, v184 offset:202
    ds_read_u16_d16_hi v25, v184 offset:1402
    ds_read_u16_d16_hi v26, v184 offset:2602
    ds_read_u16_d16_hi v27, v184 offset:3802
    ds_read_u16_d16_hi v44, v184 offset:404
    ds_read_u16_d16_hi v45, v184 offset:1604
    ds_read_u16_d16_hi v46, v184 offset:2804
    ds_read_u16_d16_hi v47, v184 offset:4004
    ds_read_u16_d16_hi v60, v184 offset:606
    ds_read_u16_d16_hi v61, v184 offset:1806
    ds_read_u16_d16_hi v62, v184 offset:3006
    ds_read_u16_d16_hi v63, v184 offset:4206
    ds_read_u16_d16_hi v72, v184 offset:808
    ds_read_u16_d16_hi v73, v184 offset:2008
    ds_read_u16_d16_hi v74, v184 offset:3208
    ds_read_u16_d16_hi v75, v184 offset:4408
    ds_read_u16_d16_hi v80, v184 offset:1010
    ds_read_u16_d16_hi v81, v184 offset:2210
    ds_read_u16_d16_hi v82, v184 offset:3410
    ds_read_u16_d16_hi v83, v184 offset:4610
    s_waitcnt vmcnt(9) lgkmcnt(15)
    v_lshlrev_b32 v200, 16, v96
    v_add_f32 v4, v4, v200
    v_lshlrev_b32 v201, 16, v99
    v_add_f32 v5, v5, v201
    v_lshlrev_b32 v200, 16, v100
    v_add_f32 v6, v6, v200
    v_lshlrev_b32 v201, 16, v103
    v_add_f32 v7, v7, v201
    v_lshlrev_b32 v200, 16, v104
    v_add_f32 v8, v8, v200
    v_lshlrev_b32 v201, 16, v107
    v_add_f32 v9, v9, v201
    v_lshlrev_b32 v200, 16, v108
    v_add_f32 v10, v10, v200
    v_lshlrev_b32 v201, 16, v111
    v_add_f32 v11, v11, v201
    v_lshlrev_b32 v200, 16, v112
    v_add_f32 v12, v12, v200
    v_lshlrev_b32 v201, 16, v115
    v_add_f32 v13, v13, v201
    v_lshlrev_b32 v200, 16, v118
    v_add_f32 v14, v14, v200
    v_lshlrev_b32 v201, 16, v121
    v_add_f32 v15, v15, v201
    v_lshlrev_b32 v200, 16, v124
    v_add_f32 v16, v16, v200
    v_lshlrev_b32 v201, 16, v127
    v_add_f32 v17, v17, v201
    v_lshlrev_b32 v200, 16, v130
    v_add_f32 v18, v18, v200
    v_lshlrev_b32 v201, 16, v133
    v_add_f32 v19, v19, v201
    v_lshlrev_b32 v200, 16, v136
    v_add_f32 v20, v20, v200
    v_lshlrev_b32 v201, 16, v139
    v_add_f32 v21, v21, v201
    v_lshlrev_b32 v200, 16, v142
    v_add_f32 v22, v22, v200
    v_lshlrev_b32 v201, 16, v145
    v_add_f32 v23, v23, v201
    v_and_b32 v200, 0xffff0000, v104
    v_add_f32 v28, v28, v200
    v_and_b32 v201, 0xffff0000, v107
    v_add_f32 v29, v29, v201
    v_and_b32 v200, 0xffff0000, v108
    v_add_f32 v30, v30, v200
    v_and_b32 v201, 0xffff0000, v111
    v_add_f32 v31, v31, v201
    v_and_b32 v200, 0xffff0000, v112
    v_add_f32 v32, v32, v200
    v_and_b32 v201, 0xffff0000, v115
    v_add_f32 v33, v33, v201
    v_and_b32 v200, 0xffff0000, v118
    v_add_f32 v34, v34, v200
    v_and_b32 v201, 0xffff0000, v121
    v_add_f32 v35, v35, v201
    v_and_b32 v200, 0xffff0000, v124
    v_add_f32 v36, v36, v200
    v_and_b32 v201, 0xffff0000, v127
    v_add_f32 v37, v37, v201
    v_and_b32 v200, 0xffff0000, v130
    v_add_f32 v38, v38, v200
    v_and_b32 v201, 0xffff0000, v133
    v_add_f32 v39, v39, v201
    v_and_b32 v200, 0xffff0000, v136
    v_add_f32 v40, v40, v200
    v_and_b32 v201, 0xffff0000, v139
    v_add_f32 v41, v41, v201
    v_and_b32 v200, 0xffff0000, v142
    v_add_f32 v42, v42, v200
    v_and_b32 v201, 0xffff0000, v145
    v_add_f32 v43, v43, v201
    v_lshlrev_b32 v200, 16, v113
    v_add_f32 v48, v48, v200
    v_lshlrev_b32 v201, 16, v116
    v_add_f32 v49, v49, v201
    v_lshlrev_b32 v200, 16, v119
    v_add_f32 v50, v50, v200
    v_lshlrev_b32 v201, 16, v122
    v_add_f32 v51, v51, v201
    v_lshlrev_b32 v200, 16, v125
    v_add_f32 v52, v52, v200
    v_lshlrev_b32 v201, 16, v128
    v_add_f32 v53, v53, v201
    v_lshlrev_b32 v200, 16, v131
    v_add_f32 v54, v54, v200
    v_lshlrev_b32 v201, 16, v134
    v_add_f32 v55, v55, v201
    v_lshlrev_b32 v200, 16, v137
    v_add_f32 v56, v56, v200
    v_lshlrev_b32 v201, 16, v140
    v_add_f32 v57, v57, v201
    v_lshlrev_b32 v200, 16, v143
    v_add_f32 v58, v58, v200
    v_lshlrev_b32 v201, 16, v146
    v_add_f32 v59, v59, v201
    v_and_b32 v200, 0xffff0000, v125
    v_add_f32 v64, v64, v200
    v_and_b32 v201, 0xffff0000, v128
    v_add_f32 v65, v65, v201
    v_and_b32 v200, 0xffff0000, v131
    v_add_f32 v66, v66, v200
    v_and_b32 v201, 0xffff0000, v134
    v_add_f32 v67, v67, v201
    v_and_b32 v200, 0xffff0000, v137
    v_add_f32 v68, v68, v200
    v_and_b32 v201, 0xffff0000, v140
    v_add_f32 v69, v69, v201
    v_and_b32 v200, 0xffff0000, v143
    v_add_f32 v70, v70, v200
    v_and_b32 v201, 0xffff0000, v146
    v_add_f32 v71, v71, v201
    v_lshlrev_b32 v200, 16, v138
    v_add_f32 v76, v76, v200
    v_lshlrev_b32 v201, 16, v141
    v_add_f32 v77, v77, v201
    v_lshlrev_b32 v200, 16, v144
    v_add_f32 v78, v78, v200
    v_lshlrev_b32 v201, 16, v147
    v_add_f32 v79, v79, v201
    v_lshlrev_b32 v200, 16, v188
    v_add_f32 v84, v84, v200
    v_and_b32 v201, 0xffff0000, v188
    v_add_f32 v85, v85, v201
    v_lshlrev_b32 v200, 16, v189
    v_add_f32 v86, v86, v200
    v_and_b32 v201, 0xffff0000, v189
    v_add_f32 v87, v87, v201
    v_lshlrev_b32 v200, 16, v190
    v_add_f32 v88, v88, v200
    v_and_b32 v201, 0xffff0000, v190
    v_add_f32 v89, v89, v201
    v_mad_u32_u24 v192, v192, s57, v244
    v_mad_u32_u24 v193, v193, s57, v244
    v_mad_u32_u24 v194, v194, s57, v244
    v_mad_u32_u24 v195, v195, s57, v244
    v_mad_u32_u24 v196, v196, s57, v244
    v_mad_u32_u24 v197, v197, s57, v244
    v_mad_u32_u24 v198, v198, s57, v244
    v_cndmask_b32 v93, 0, v90, s[68:69]
    v_cndmask_b32 v92, 0, v90, s[66:67]
    v_cndmask_b32 v91, 0, v90, s[62:63]
    v_cndmask_b32 v90, 0, v90, s[60:61]
    s_waitcnt lgkmcnt(0)
    s_barrier
    s_setprio 0
    ds_read_b128 v[96:99], v192 offset:0
    ds_read_b128 v[100:103], v192 offset:64
    ds_read_b128 v[104:107], v193 offset:0
    ds_read_b128 v[108:111], v193 offset:64
    ds_read_b128 v[112:115], v194 offset:0
    ds_read_b128 v[116:119], v194 offset:64
    ds_read_b128 v[128:131], v195 offset:0
    ds_read_b128 v[132:135], v195 offset:64
    ds_read_b128 v[144:147], v196 offset:0
    ds_read_b128 v[148:151], v196 offset:64
    ds_read_b128 v[160:163], v197 offset:0
    ds_read_b128 v[164:167], v197 offset:64
    ds_read_b128 v[176:179], v198 offset:0
    ds_read_b128 v[180:183], v198 offset:64
    s_waitcnt vmcnt(7) lgkmcnt(0)
standalone__deep_cross_pnn__recsys_kernel_loop:
    v_mfma_f32_16x16x32_bf16 v[184:187], v[96:99], v[96:99], 0
    v_fmac_f32 v240, v188, v64
    v_fmac_f32 v240, v189, v65
    v_mfma_f32_16x16x32_bf16 v[184:187], v[100:103], v[100:103], v[184:187]
    v_fmac_f32 v240, v190, v66
    v_fmac_f32 v240, v191, v67
    v_mfma_f32_16x16x32_bf16 v[188:191], v[96:99], v[104:107], 0
    v_fmac_f32 v240, v192, v68
    v_fmac_f32 v240, v193, v69
    v_fmac_f32 v240, v194, v70
    v_fmac_f32 v240, v195, v71
    v_mad_u32_u24 v220, v220, s57, v244
    v_mfma_f32_16x16x32_bf16 v[188:191], v[100:103], v[108:111], v[188:191]
    ds_read_b128 v[120:123], v220 offset:0
    ds_read_b128 v[124:127], v220 offset:64
    v_mfma_f32_16x16x32_bf16 v[192:195], v[96:99], v[112:115], 0
    v_fmac_f32 v240, v196, v72
    v_fmac_f32 v240, v197, v73
    v_mfma_f32_16x16x32_bf16 v[192:195], v[100:103], v[116:119], v[192:195]
    v_fmac_f32 v240, v198, v74
    v_fmac_f32 v240, v199, v75
    v_mfma_f32_16x16x32_bf16 v[196:199], v[176:179], v[96:99], 0
    v_fmac_f32 v240, v200, v76
    v_fmac_f32 v240, v201, v77
    v_mfma_f32_16x16x32_bf16 v[196:199], v[180:183], v[100:103], v[196:199]
    v_fmac_f32 v240, v202, v78
    v_fmac_f32 v240, v203, v79
    v_mad_u32_u24 v221, v221, s57, v244
    v_mfma_f32_16x16x32_bf16 v[200:203], v[96:99], v[128:131], 0
    ds_read_b128 v[136:139], v221 offset:0
    ds_read_b128 v[140:143], v221 offset:64
    v_mfma_f32_16x16x32_bf16 v[200:203], v[100:103], v[132:135], v[200:203]
    v_fmac_f32 v240, v204, v80
    v_fmac_f32 v240, v205, v81
    v_fmac_f32 v240, v206, v82
    v_fmac_f32 v240, v207, v83
    v_mfma_f32_16x16x32_bf16 v[204:207], v[96:99], v[144:147], 0
    v_mad_u32_u24 v218, v218, s57, v244
    v_mul_f32 v237, v184, v0
    v_mfma_f32_16x16x32_bf16 v[204:207], v[100:103], v[148:151], v[204:207]
    v_fmac_f32 v237, v185, v1
    v_fmac_f32 v237, v186, v2
    v_mfma_f32_16x16x32_bf16 v[208:211], v[96:99], v[160:163], 0
    v_fmac_f32 v237, v187, v3
    v_fmac_f32 v237, v188, v4
    v_mfma_f32_16x16x32_bf16 v[208:211], v[100:103], v[164:167], v[208:211]
    ds_read_b128 v[96:99], v218 offset:0
    ds_read_b128 v[100:103], v218 offset:64
    v_mfma_f32_16x16x32_bf16 v[184:187], v[104:107], v[104:107], 0
    v_fmac_f32 v237, v189, v5
    v_fmac_f32 v237, v190, v6
    v_mfma_f32_16x16x32_bf16 v[184:187], v[108:111], v[108:111], v[184:187]
    v_fmac_f32 v237, v191, v7
    v_fmac_f32 v237, v192, v8
    v_mfma_f32_16x16x32_bf16 v[188:191], v[104:107], v[112:115], 0
    v_fmac_f32 v237, v193, v9
    v_fmac_f32 v237, v194, v10
    v_mfma_f32_16x16x32_bf16 v[188:191], v[108:111], v[116:119], v[188:191]
    v_fmac_f32 v237, v195, v11
    v_mad_u32_u24 v222, v222, s57, v244
    v_mfma_f32_16x16x32_bf16 v[192:195], v[176:179], v[104:107], 0
    v_fmac_f32 v237, v196, v84
    v_fmac_f32 v237, v200, v12
    v_mfma_f32_16x16x32_bf16 v[192:195], v[180:183], v[108:111], v[192:195]
    ds_read_b128 v[152:155], v222 offset:0
    ds_read_b128 v[156:159], v222 offset:64
    v_mfma_f32_16x16x32_bf16 v[196:199], v[104:107], v[128:131], 0
    v_fmac_f32 v237, v201, v13
    v_fmac_f32 v237, v202, v14
    v_mfma_f32_16x16x32_bf16 v[196:199], v[108:111], v[132:135], v[196:199]
    v_fmac_f32 v237, v203, v15
    v_fmac_f32 v237, v204, v16
    v_mfma_f32_16x16x32_bf16 v[200:203], v[104:107], v[144:147], 0
    v_fmac_f32 v237, v205, v17
    v_fmac_f32 v237, v206, v18
    v_mfma_f32_16x16x32_bf16 v[200:203], v[108:111], v[148:151], v[200:203]
    v_fmac_f32 v237, v207, v19
    v_mad_u32_u24 v219, v219, s57, v244
    v_mfma_f32_16x16x32_bf16 v[204:207], v[104:107], v[160:163], 0
    v_fmac_f32 v237, v208, v20
    v_fmac_f32 v237, v209, v21
    v_fmac_f32 v237, v210, v22
    v_fmac_f32 v237, v211, v23
    v_mfma_f32_16x16x32_bf16 v[204:207], v[108:111], v[164:167], v[204:207]
    ds_read_b128 v[104:107], v219 offset:0
    ds_read_b128 v[108:111], v219 offset:64
    v_mfma_f32_16x16x32_bf16 v[208:211], v[112:115], v[112:115], 0
    v_fmac_f32 v237, v184, v24
    v_fmac_f32 v237, v185, v25
    v_mfma_f32_16x16x32_bf16 v[208:211], v[116:119], v[116:119], v[208:211]
    v_fmac_f32 v237, v186, v26
    v_fmac_f32 v237, v187, v27
    v_mfma_f32_16x16x32_bf16 v[184:187], v[176:179], v[112:115], 0
    v_fmac_f32 v237, v188, v28
    v_fmac_f32 v237, v189, v29
    v_mfma_f32_16x16x32_bf16 v[184:187], v[180:183], v[116:119], v[184:187]
    v_fmac_f32 v237, v190, v30
    v_fmac_f32 v237, v191, v31
    v_mfma_f32_16x16x32_bf16 v[188:191], v[112:115], v[128:131], 0
    v_permlane32_swap_b32 v239, v240
    v_mad_u32_u24 v223, v223, s57, v244
    v_fmac_f32 v237, v192, v85
    v_mfma_f32_16x16x32_bf16 v[188:191], v[116:119], v[132:135], v[188:191]
    ds_read_b128 v[168:171], v223 offset:0
    ds_read_b128 v[172:175], v223 offset:64
    v_mfma_f32_16x16x32_bf16 v[192:195], v[112:115], v[144:147], 0
    v_add_f32 v242, v239, v240
    v_fmac_f32 v237, v196, v32
    v_fmac_f32 v237, v197, v33
    v_fmac_f32 v237, v198, v34
    v_fmac_f32 v237, v199, v35
    v_mfma_f32_16x16x32_bf16 v[192:195], v[116:119], v[148:151], v[192:195]
    buffer_load_dwordx4 v[218:221], v245, s[16:19], s74 offen offset:2000
    buffer_load_dwordx2 v[222:223], v245, s[16:19], s74 offen offset:2016
    v_mfma_f32_16x16x32_bf16 v[196:199], v[176:179], v[128:131], 0
    v_permlane16_swap_b32 v241, v242
    v_mfma_f32_16x16x32_bf16 v[196:199], v[180:183], v[132:135], v[196:199]
    v_fmac_f32 v237, v200, v36
    v_fmac_f32 v237, v201, v37
    v_fmac_f32 v237, v202, v38
    v_fmac_f32 v237, v203, v39
    v_mfma_f32_16x16x32_bf16 v[200:203], v[112:115], v[160:163], 0
    v_add_f32 v241, v241, v242
    v_fmac_f32 v237, v204, v40
    v_mfma_f32_16x16x32_bf16 v[200:203], v[116:119], v[164:167], v[200:203]
    v_fmac_f32 v237, v205, v41
    v_fmac_f32 v237, v206, v42
    v_fmac_f32 v237, v207, v43
    v_mfma_f32_16x16x32_bf16 v[204:207], v[128:131], v[128:131], 0
    v_add_f32_dpp v241, v241, v241 row_ror:8 row_mask:0xf bank_mask:0xf
    v_fmac_f32 v237, v208, v44
    v_mfma_f32_16x16x32_bf16 v[204:207], v[132:135], v[132:135], v[204:207]
    v_fmac_f32 v237, v209, v45
    v_fmac_f32 v237, v210, v46
    v_fmac_f32 v237, v211, v47
    v_mfma_f32_16x16x32_bf16 v[208:211], v[176:179], v[144:147], 0
    v_add_f32_dpp v241, v241, v241 row_ror:4 row_mask:0xf bank_mask:0xf
    v_fmac_f32 v237, v184, v86
    v_mfma_f32_16x16x32_bf16 v[208:211], v[180:183], v[148:151], v[208:211]
    v_fmac_f32 v237, v188, v48
    v_fmac_f32 v237, v189, v49
    v_mfma_f32_16x16x32_bf16 v[184:187], v[128:131], v[144:147], 0
    v_add_f32_dpp v241, v241, v241 row_ror:2 row_mask:0xf bank_mask:0xf
    v_fmac_f32 v237, v190, v50
    v_mfma_f32_16x16x32_bf16 v[184:187], v[132:135], v[148:151], v[184:187]
    v_fmac_f32 v237, v191, v51
    v_fmac_f32 v237, v192, v52
    v_mfma_f32_16x16x32_bf16 v[188:191], v[128:131], v[160:163], 0
    v_add_f32_dpp v241, v241, v241 row_ror:1 row_mask:0xf bank_mask:0xf
    v_fmac_f32 v237, v193, v53
    v_mfma_f32_16x16x32_bf16 v[188:191], v[132:135], v[164:167], v[188:191]
    v_fmac_f32 v237, v194, v54
    v_fmac_f32 v237, v195, v55
    v_mfma_f32_16x16x32_bf16 v[192:195], v[176:179], v[160:163], 0
    v_cndmask_b32 v243, v243, v241, s[70:71]
    v_fmac_f32 v237, v196, v87
    v_mfma_f32_16x16x32_bf16 v[192:195], v[180:183], v[164:167], v[192:195]
    s_lshl_b64 s[70:71], s[70:71], 1
    v_fmac_f32 v237, v200, v56
    v_mfma_f32_16x16x32_bf16 v[196:199], v[144:147], v[144:147], 0
    v_fmac_f32 v237, v201, v57
    v_fmac_f32 v237, v202, v58
    v_mfma_f32_16x16x32_bf16 v[196:199], v[148:151], v[148:151], v[196:199]
    v_fmac_f32 v237, v203, v59
    v_fmac_f32 v237, v204, v60
    v_mfma_f32_16x16x32_bf16 v[200:203], v[144:147], v[160:163], 0
    v_fmac_f32 v237, v205, v61
    v_fmac_f32 v237, v206, v62
    v_mfma_f32_16x16x32_bf16 v[200:203], v[148:151], v[164:167], v[200:203]
    v_fmac_f32 v237, v207, v63
    v_fmac_f32 v237, v208, v88
    v_mfma_f32_16x16x32_bf16 v[204:207], v[160:163], v[160:163], 0
    v_fmac_f32 v237, v184, v64
    v_fmac_f32 v237, v185, v65
    v_mfma_f32_16x16x32_bf16 v[204:207], v[164:167], v[164:167], v[204:207]
    v_fmac_f32 v237, v186, v66
    s_waitcnt vmcnt(7) lgkmcnt(0)
    v_mfma_f32_16x16x32_bf16 v[208:211], v[96:99], v[96:99], 0
    v_fmac_f32 v237, v187, v67
    v_mad_u32_u24 v226, v226, s57, v244
    v_mfma_f32_16x16x32_bf16 v[208:211], v[100:103], v[100:103], v[208:211]
    v_fmac_f32 v237, v188, v68
    v_fmac_f32 v237, v189, v69
    v_mfma_f32_16x16x32_bf16 v[184:187], v[96:99], v[104:107], 0
    v_fmac_f32 v237, v190, v70
    v_fmac_f32 v237, v191, v71
    v_mfma_f32_16x16x32_bf16 v[184:187], v[100:103], v[108:111], v[184:187]
    ds_read_b128 v[112:115], v226 offset:0
    ds_read_b128 v[116:119], v226 offset:64
    v_mfma_f32_16x16x32_bf16 v[188:191], v[96:99], v[120:123], 0
    v_fmac_f32 v237, v192, v89
    v_mad_u32_u24 v227, v227, s57, v244
    v_mfma_f32_16x16x32_bf16 v[188:191], v[100:103], v[124:127], v[188:191]
    v_fmac_f32 v237, v196, v72
    v_fmac_f32 v237, v197, v73
    v_mfma_f32_16x16x32_bf16 v[192:195], v[176:179], v[96:99], 0
    v_fmac_f32 v237, v198, v74
    v_fmac_f32 v237, v199, v75
    v_mfma_f32_16x16x32_bf16 v[192:195], v[180:183], v[100:103], v[192:195]
    v_fmac_f32 v237, v200, v76
    v_fmac_f32 v237, v201, v77
    v_mfma_f32_16x16x32_bf16 v[196:199], v[96:99], v[136:139], 0
    ds_read_b128 v[128:131], v227 offset:0
    ds_read_b128 v[132:135], v227 offset:64
    v_mfma_f32_16x16x32_bf16 v[196:199], v[100:103], v[140:143], v[196:199]
    v_fmac_f32 v237, v202, v78
    v_fmac_f32 v237, v203, v79
    v_mfma_f32_16x16x32_bf16 v[200:203], v[96:99], v[152:155], 0
    v_fmac_f32 v237, v204, v80
    v_fmac_f32 v237, v205, v81
    v_mfma_f32_16x16x32_bf16 v[200:203], v[100:103], v[156:159], v[200:203]
    v_fmac_f32 v237, v206, v82
    v_fmac_f32 v237, v207, v83
    v_mfma_f32_16x16x32_bf16 v[204:207], v[96:99], v[168:171], 0
    v_mad_u32_u24 v224, v224, s57, v244
    v_mul_f32 v238, v208, v0
    v_fmac_f32 v238, v209, v1
    v_fmac_f32 v238, v210, v2
    v_fmac_f32 v238, v211, v3
    v_mfma_f32_16x16x32_bf16 v[204:207], v[100:103], v[172:175], v[204:207]
    ds_read_b128 v[96:99], v224 offset:0
    ds_read_b128 v[100:103], v224 offset:64
    v_mfma_f32_16x16x32_bf16 v[208:211], v[104:107], v[104:107], 0
    v_fmac_f32 v238, v184, v4
    v_fmac_f32 v238, v185, v5
    v_mfma_f32_16x16x32_bf16 v[208:211], v[108:111], v[108:111], v[208:211]
    v_fmac_f32 v238, v186, v6
    v_fmac_f32 v238, v187, v7
    v_mfma_f32_16x16x32_bf16 v[184:187], v[104:107], v[120:123], 0
    v_fmac_f32 v238, v188, v8
    v_fmac_f32 v238, v189, v9
    v_mfma_f32_16x16x32_bf16 v[184:187], v[108:111], v[124:127], v[184:187]
    v_fmac_f32 v238, v190, v10
    v_fmac_f32 v238, v191, v11
    v_mfma_f32_16x16x32_bf16 v[188:191], v[176:179], v[104:107], 0
    v_mad_u32_u24 v228, v228, s57, v244
    v_fmac_f32 v238, v193, v84
    v_mfma_f32_16x16x32_bf16 v[188:191], v[180:183], v[108:111], v[188:191]
    ds_read_b128 v[144:147], v228 offset:0
    ds_read_b128 v[148:151], v228 offset:64
    v_mfma_f32_16x16x32_bf16 v[192:195], v[104:107], v[136:139], 0
    v_fmac_f32 v238, v196, v12
    v_fmac_f32 v238, v197, v13
    v_mfma_f32_16x16x32_bf16 v[192:195], v[108:111], v[140:143], v[192:195]
    v_fmac_f32 v238, v198, v14
    v_fmac_f32 v238, v199, v15
    v_mfma_f32_16x16x32_bf16 v[196:199], v[104:107], v[152:155], 0
    v_fmac_f32 v238, v200, v16
    v_fmac_f32 v238, v201, v17
    v_mfma_f32_16x16x32_bf16 v[196:199], v[108:111], v[156:159], v[196:199]
    v_fmac_f32 v238, v202, v18
    v_fmac_f32 v238, v203, v19
    v_mfma_f32_16x16x32_bf16 v[200:203], v[104:107], v[168:171], 0
    v_mad_u32_u24 v225, v225, s57, v244
    v_fmac_f32 v238, v204, v20
    v_fmac_f32 v238, v205, v21
    v_fmac_f32 v238, v206, v22
    v_fmac_f32 v238, v207, v23
    v_mfma_f32_16x16x32_bf16 v[200:203], v[108:111], v[172:175], v[200:203]
    ds_read_b128 v[104:107], v225 offset:0
    ds_read_b128 v[108:111], v225 offset:64
    v_mfma_f32_16x16x32_bf16 v[204:207], v[120:123], v[120:123], 0
    v_fmac_f32 v238, v208, v24
    v_fmac_f32 v238, v209, v25
    v_mfma_f32_16x16x32_bf16 v[204:207], v[124:127], v[124:127], v[204:207]
    v_fmac_f32 v238, v210, v26
    v_fmac_f32 v238, v211, v27
    v_fmac_f32 v238, v184, v28
    v_fmac_f32 v238, v185, v29
    v_fmac_f32 v238, v186, v30
    v_fmac_f32 v238, v187, v31
    v_mfma_f32_16x16x32_bf16 v[184:187], v[176:179], v[120:123], 0
    v_fmac_f32 v238, v189, v85
    v_mad_u32_u24 v229, v229, s57, v244
    v_mfma_f32_16x16x32_bf16 v[184:187], v[180:183], v[124:127], v[184:187]
    v_fmac_f32 v238, v192, v32
    v_fmac_f32 v238, v193, v33
    v_mfma_f32_16x16x32_bf16 v[188:191], v[120:123], v[136:139], 0
    v_fmac_f32 v238, v194, v34
    v_fmac_f32 v238, v195, v35
    v_mfma_f32_16x16x32_bf16 v[188:191], v[124:127], v[140:143], v[188:191]
    ds_read_b128 v[160:163], v229 offset:0
    ds_read_b128 v[164:167], v229 offset:64
    v_mfma_f32_16x16x32_bf16 v[192:195], v[120:123], v[152:155], 0
    v_fmac_f32 v238, v196, v36
    v_fmac_f32 v238, v197, v37
    v_fmac_f32 v238, v198, v38
    v_fmac_f32 v238, v199, v39
    v_mfma_f32_16x16x32_bf16 v[192:195], v[124:127], v[156:159], v[192:195]
    buffer_load_dwordx4 v[224:227], v245, s[16:19], s74 offen offset:2400
    buffer_load_dwordx2 v[228:229], v245, s[16:19], s74 offen offset:2416
    v_mfma_f32_16x16x32_bf16 v[196:199], v[176:179], v[136:139], 0
    v_fmac_f32 v238, v200, v40
    v_fmac_f32 v238, v201, v41
    v_mfma_f32_16x16x32_bf16 v[196:199], v[180:183], v[140:143], v[196:199]
    v_fmac_f32 v238, v202, v42
    v_fmac_f32 v238, v203, v43
    v_mfma_f32_16x16x32_bf16 v[200:203], v[120:123], v[168:171], 0
    v_fmac_f32 v238, v204, v44
    v_fmac_f32 v238, v205, v45
    v_mfma_f32_16x16x32_bf16 v[200:203], v[124:127], v[172:175], v[200:203]
    v_fmac_f32 v238, v206, v46
    v_fmac_f32 v238, v207, v47
    v_mfma_f32_16x16x32_bf16 v[204:207], v[136:139], v[136:139], 0
    v_fmac_f32 v238, v185, v86
    v_fmac_f32 v238, v188, v48
    v_mfma_f32_16x16x32_bf16 v[204:207], v[140:143], v[140:143], v[204:207]
    v_fmac_f32 v238, v189, v49
    v_fmac_f32 v238, v190, v50
    v_mfma_f32_16x16x32_bf16 v[208:211], v[176:179], v[176:179], 0
    v_fmac_f32 v238, v191, v51
    v_fmac_f32 v238, v192, v52
    v_mfma_f32_16x16x32_bf16 v[208:211], v[180:183], v[180:183], v[208:211]
    v_fmac_f32 v238, v193, v53
    v_fmac_f32 v238, v194, v54
    v_mfma_f32_16x16x32_bf16 v[184:187], v[176:179], v[152:155], 0
    v_fmac_f32 v238, v195, v55
    v_fmac_f32 v238, v197, v87
    v_mfma_f32_16x16x32_bf16 v[184:187], v[180:183], v[156:159], v[184:187]
    v_fmac_f32 v238, v200, v56
    v_fmac_f32 v238, v201, v57
    v_mfma_f32_16x16x32_bf16 v[188:191], v[136:139], v[152:155], 0
    v_fmac_f32 v238, v202, v58
    v_fmac_f32 v238, v203, v59
    v_mfma_f32_16x16x32_bf16 v[188:191], v[140:143], v[156:159], v[188:191]
    v_fmac_f32 v238, v204, v60
    v_fmac_f32 v238, v205, v61
    v_mfma_f32_16x16x32_bf16 v[192:195], v[136:139], v[168:171], 0
    v_fmac_f32 v238, v206, v62
    v_fmac_f32 v238, v207, v63
    v_mfma_f32_16x16x32_bf16 v[192:195], v[140:143], v[172:175], v[192:195]
    v_fmac_f32 v237, v208, v90
    v_fmac_f32 v238, v209, v91
    v_mfma_f32_16x16x32_bf16 v[196:199], v[176:179], v[168:171], 0
    v_mul_f32 v239, v210, v92
    v_mul_f32 v240, v211, v93
    v_mfma_f32_16x16x32_bf16 v[196:199], v[180:183], v[172:175], v[196:199]
    v_fmac_f32 v238, v185, v88
    v_fmac_f32 v238, v188, v64
    v_mfma_f32_16x16x32_bf16 v[200:203], v[152:155], v[152:155], 0
    v_fmac_f32 v238, v189, v65
    v_fmac_f32 v238, v190, v66
    v_mfma_f32_16x16x32_bf16 v[200:203], v[156:159], v[156:159], v[200:203]
    v_fmac_f32 v238, v191, v67
    v_fmac_f32 v238, v192, v68
    v_mfma_f32_16x16x32_bf16 v[204:207], v[152:155], v[168:171], 0
    v_fmac_f32 v238, v193, v69
    v_fmac_f32 v238, v194, v70
    v_mfma_f32_16x16x32_bf16 v[204:207], v[156:159], v[172:175], v[204:207]
    v_fmac_f32 v238, v195, v71
    v_fmac_f32 v238, v197, v89
    v_mfma_f32_16x16x32_bf16 v[208:211], v[168:171], v[168:171], 0
    v_fmac_f32 v238, v200, v72
    v_fmac_f32 v238, v201, v73
    v_mfma_f32_16x16x32_bf16 v[208:211], v[172:175], v[172:175], v[208:211]
    v_fmac_f32 v238, v202, v74
    s_waitcnt vmcnt(7) lgkmcnt(0)
    v_mfma_f32_16x16x32_bf16 v[184:187], v[96:99], v[96:99], 0
    v_mad_u32_u24 v232, v232, s57, v244
    v_mad_u32_u24 v233, v233, s57, v244
    v_mfma_f32_16x16x32_bf16 v[184:187], v[100:103], v[100:103], v[184:187]
    v_fmac_f32 v238, v203, v75
    v_fmac_f32 v238, v204, v76
    v_mfma_f32_16x16x32_bf16 v[188:191], v[96:99], v[104:107], 0
    v_fmac_f32 v238, v205, v77
    v_fmac_f32 v238, v206, v78
    v_mfma_f32_16x16x32_bf16 v[188:191], v[100:103], v[108:111], v[188:191]
    ds_read_b128 v[120:123], v232 offset:0
    ds_read_b128 v[124:127], v232 offset:64
    v_mfma_f32_16x16x32_bf16 v[192:195], v[96:99], v[112:115], 0
    v_fmac_f32 v238, v207, v79
    v_fmac_f32 v238, v208, v80
    v_mfma_f32_16x16x32_bf16 v[192:195], v[100:103], v[116:119], v[192:195]
    v_fmac_f32 v238, v209, v81
    v_fmac_f32 v238, v210, v82
    v_mfma_f32_16x16x32_bf16 v[196:199], v[176:179], v[96:99], 0
    v_fmac_f32 v238, v211, v83
    v_mad_u32_u24 v230, v230, s57, v244
    v_mfma_f32_16x16x32_bf16 v[196:199], v[180:183], v[100:103], v[196:199]
    v_fmac_f32 v239, v184, v0
    v_fmac_f32 v239, v185, v1
    v_mfma_f32_16x16x32_bf16 v[200:203], v[96:99], v[128:131], 0
    ds_read_b128 v[136:139], v233 offset:0
    ds_read_b128 v[140:143], v233 offset:64
    v_mfma_f32_16x16x32_bf16 v[200:203], v[100:103], v[132:135], v[200:203]
    v_fmac_f32 v239, v186, v2
    v_fmac_f32 v239, v187, v3
    v_mfma_f32_16x16x32_bf16 v[204:207], v[96:99], v[144:147], 0
    v_fmac_f32 v239, v188, v4
    v_fmac_f32 v239, v189, v5
    v_mfma_f32_16x16x32_bf16 v[204:207], v[100:103], v[148:151], v[204:207]
    v_fmac_f32 v239, v190, v6
    v_fmac_f32 v239, v191, v7
    v_mfma_f32_16x16x32_bf16 v[208:211], v[96:99], v[160:163], 0
    v_fmac_f32 v239, v192, v8
    v_fmac_f32 v239, v193, v9
    v_mfma_f32_16x16x32_bf16 v[208:211], v[100:103], v[164:167], v[208:211]
    ds_read_b128 v[96:99], v230 offset:0
    ds_read_b128 v[100:103], v230 offset:64
    v_mfma_f32_16x16x32_bf16 v[184:187], v[104:107], v[104:107], 0
    v_fmac_f32 v239, v194, v10
    v_fmac_f32 v239, v195, v11
    v_mfma_f32_16x16x32_bf16 v[184:187], v[108:111], v[108:111], v[184:187]
    v_mad_u32_u24 v234, v234, s57, v244
    v_fmac_f32 v239, v198, v84
    v_mfma_f32_16x16x32_bf16 v[188:191], v[104:107], v[112:115], 0
    v_fmac_f32 v239, v200, v12
    v_fmac_f32 v239, v201, v13
    v_mfma_f32_16x16x32_bf16 v[188:191], v[108:111], v[116:119], v[188:191]
    v_fmac_f32 v239, v202, v14
    v_fmac_f32 v239, v203, v15
    v_mfma_f32_16x16x32_bf16 v[192:195], v[176:179], v[104:107], 0
    v_fmac_f32 v239, v204, v16
    v_fmac_f32 v239, v205, v17
    v_mfma_f32_16x16x32_bf16 v[192:195], v[180:183], v[108:111], v[192:195]
    ds_read_b128 v[152:155], v234 offset:0
    ds_read_b128 v[156:159], v234 offset:64
    v_mfma_f32_16x16x32_bf16 v[196:199], v[104:107], v[128:131], 0
    v_fmac_f32 v239, v206, v18
    v_fmac_f32 v239, v207, v19
    v_mfma_f32_16x16x32_bf16 v[196:199], v[108:111], v[132:135], v[196:199]
    v_mad_u32_u24 v231, v231, s57, v244
    v_fmac_f32 v239, v208, v20
    v_mfma_f32_16x16x32_bf16 v[200:203], v[104:107], v[144:147], 0
    v_fmac_f32 v239, v209, v21
    v_fmac_f32 v239, v210, v22
    v_mfma_f32_16x16x32_bf16 v[200:203], v[108:111], v[148:151], v[200:203]
    v_fmac_f32 v239, v211, v23
    v_fmac_f32 v239, v184, v24
    v_mfma_f32_16x16x32_bf16 v[204:207], v[104:107], v[160:163], 0
    v_fmac_f32 v239, v185, v25
    v_fmac_f32 v239, v186, v26
    v_mfma_f32_16x16x32_bf16 v[204:207], v[108:111], v[164:167], v[204:207]
    ds_read_b128 v[104:107], v231 offset:0
    ds_read_b128 v[108:111], v231 offset:64
    v_mfma_f32_16x16x32_bf16 v[208:211], v[112:115], v[112:115], 0
    v_fmac_f32 v239, v187, v27
    v_fmac_f32 v239, v188, v28
    v_mfma_f32_16x16x32_bf16 v[208:211], v[116:119], v[116:119], v[208:211]
    v_fmac_f32 v239, v189, v29
    v_fmac_f32 v239, v190, v30
    v_mfma_f32_16x16x32_bf16 v[184:187], v[176:179], v[112:115], 0
    v_fmac_f32 v239, v191, v31
    v_mad_u32_u24 v235, v235, s57, v244
    v_mfma_f32_16x16x32_bf16 v[184:187], v[180:183], v[116:119], v[184:187]
    v_fmac_f32 v239, v194, v85
    v_fmac_f32 v239, v196, v32
    v_mfma_f32_16x16x32_bf16 v[188:191], v[112:115], v[128:131], 0
    v_fmac_f32 v239, v197, v33
    v_fmac_f32 v239, v198, v34
    v_mfma_f32_16x16x32_bf16 v[188:191], v[116:119], v[132:135], v[188:191]
    ds_read_b128 v[168:171], v235 offset:0
    ds_read_b128 v[172:175], v235 offset:64
    v_mfma_f32_16x16x32_bf16 v[192:195], v[112:115], v[144:147], 0
    v_fmac_f32 v239, v199, v35
    v_fmac_f32 v239, v200, v36
    v_mfma_f32_16x16x32_bf16 v[192:195], v[116:119], v[148:151], v[192:195]
    buffer_load_dwordx4 v[230:233], v245, s[16:19], s74 offen offset:2800
    buffer_load_dwordx2 v[234:235], v245, s[16:19], s74 offen offset:2816
    v_mfma_f32_16x16x32_bf16 v[196:199], v[176:179], v[128:131], 0
    v_fmac_f32 v239, v201, v37
    v_fmac_f32 v239, v202, v38
    v_mfma_f32_16x16x32_bf16 v[196:199], v[180:183], v[132:135], v[196:199]
    v_fmac_f32 v239, v203, v39
    v_fmac_f32 v239, v204, v40
    v_mfma_f32_16x16x32_bf16 v[200:203], v[112:115], v[160:163], 0
    v_fmac_f32 v239, v205, v41
    v_fmac_f32 v239, v206, v42
    v_mfma_f32_16x16x32_bf16 v[200:203], v[116:119], v[164:167], v[200:203]
    v_fmac_f32 v239, v207, v43
    v_fmac_f32 v239, v208, v44
    v_mfma_f32_16x16x32_bf16 v[204:207], v[128:131], v[128:131], 0
    v_fmac_f32 v239, v209, v45
    v_fmac_f32 v239, v210, v46
    v_mfma_f32_16x16x32_bf16 v[204:207], v[132:135], v[132:135], v[204:207]
    v_fmac_f32 v239, v211, v47
    v_fmac_f32 v239, v186, v86
    v_mfma_f32_16x16x32_bf16 v[184:187], v[176:179], v[144:147], 0
    v_fmac_f32 v239, v188, v48
    v_fmac_f32 v239, v189, v49
    v_mfma_f32_16x16x32_bf16 v[184:187], v[180:183], v[148:151], v[184:187]
    v_fmac_f32 v239, v190, v50
    v_fmac_f32 v239, v191, v51
    v_mfma_f32_16x16x32_bf16 v[188:191], v[128:131], v[144:147], 0
    v_fmac_f32 v239, v192, v52
    v_fmac_f32 v239, v193, v53
    v_mfma_f32_16x16x32_bf16 v[188:191], v[132:135], v[148:151], v[188:191]
    v_fmac_f32 v239, v194, v54
    v_fmac_f32 v239, v195, v55
    v_mfma_f32_16x16x32_bf16 v[192:195], v[128:131], v[160:163], 0
    v_fmac_f32 v239, v198, v87
    v_fmac_f32 v239, v200, v56
    v_mfma_f32_16x16x32_bf16 v[192:195], v[132:135], v[164:167], v[192:195]
    v_fmac_f32 v239, v201, v57
    v_fmac_f32 v239, v202, v58
    v_mfma_f32_16x16x32_bf16 v[196:199], v[176:179], v[160:163], 0
    v_fmac_f32 v239, v203, v59
    v_fmac_f32 v239, v204, v60
    v_mfma_f32_16x16x32_bf16 v[196:199], v[180:183], v[164:167], v[196:199]
    v_fmac_f32 v239, v205, v61
    v_fmac_f32 v239, v206, v62
    v_mfma_f32_16x16x32_bf16 v[200:203], v[144:147], v[144:147], 0
    v_fmac_f32 v239, v207, v63
    v_fmac_f32 v239, v186, v88
    v_mfma_f32_16x16x32_bf16 v[200:203], v[148:151], v[148:151], v[200:203]
    v_fmac_f32 v239, v188, v64
    v_fmac_f32 v239, v189, v65
    v_mfma_f32_16x16x32_bf16 v[204:207], v[144:147], v[160:163], 0
    v_fmac_f32 v239, v190, v66
    v_fmac_f32 v239, v191, v67
    v_mfma_f32_16x16x32_bf16 v[204:207], v[148:151], v[164:167], v[204:207]
    v_fmac_f32 v239, v192, v68
    v_fmac_f32 v239, v193, v69
    v_mfma_f32_16x16x32_bf16 v[208:211], v[160:163], v[160:163], 0
    v_fmac_f32 v239, v194, v70
    v_fmac_f32 v239, v195, v71
    v_mfma_f32_16x16x32_bf16 v[208:211], v[164:167], v[164:167], v[208:211]
    v_fmac_f32 v239, v198, v89
    s_waitcnt vmcnt(6) lgkmcnt(0)
    v_mfma_f32_16x16x32_bf16 v[184:187], v[96:99], v[96:99], 0
    v_mad_u32_u24 v214, v214, s57, v244
    v_mad_u32_u24 v215, v215, s57, v244
    v_mfma_f32_16x16x32_bf16 v[184:187], v[100:103], v[100:103], v[184:187]
    v_fmac_f32 v239, v200, v72
    v_fmac_f32 v239, v201, v73
    v_mfma_f32_16x16x32_bf16 v[188:191], v[96:99], v[104:107], 0
    v_fmac_f32 v239, v202, v74
    v_fmac_f32 v239, v203, v75
    v_mfma_f32_16x16x32_bf16 v[188:191], v[100:103], v[108:111], v[188:191]
    ds_read_b128 v[112:115], v214 offset:0
    ds_read_b128 v[116:119], v214 offset:64
    v_mfma_f32_16x16x32_bf16 v[192:195], v[176:179], v[120:123], 0
    v_fmac_f32 v239, v204, v76
    v_fmac_f32 v239, v205, v77
    v_mfma_f32_16x16x32_bf16 v[192:195], v[180:183], v[124:127], v[192:195]
    v_fmac_f32 v239, v206, v78
    v_fmac_f32 v239, v207, v79
    v_mfma_f32_16x16x32_bf16 v[196:199], v[96:99], v[120:123], 0
    v_fmac_f32 v239, v208, v80
    v_fmac_f32 v239, v209, v81
    v_mfma_f32_16x16x32_bf16 v[196:199], v[100:103], v[124:127], v[196:199]
    v_fmac_f32 v239, v210, v82
    v_fmac_f32 v239, v211, v83
    v_mfma_f32_16x16x32_bf16 v[200:203], v[176:179], v[96:99], 0
    ds_read_b128 v[128:131], v215 offset:0
    ds_read_b128 v[132:135], v215 offset:64
    v_mfma_f32_16x16x32_bf16 v[200:203], v[180:183], v[100:103], v[200:203]
    v_fmac_f32 v240, v184, v0
    v_fmac_f32 v240, v185, v1
    v_mfma_f32_16x16x32_bf16 v[204:207], v[96:99], v[136:139], 0
    v_fmac_f32 v240, v186, v2
    v_fmac_f32 v240, v187, v3
    v_mfma_f32_16x16x32_bf16 v[204:207], v[100:103], v[140:143], v[204:207]
    v_fmac_f32 v240, v188, v4
    v_fmac_f32 v240, v189, v5
    v_mfma_f32_16x16x32_bf16 v[208:211], v[176:179], v[136:139], 0
    v_fmac_f32 v240, v190, v6
    v_fmac_f32 v240, v191, v7
    v_mfma_f32_16x16x32_bf16 v[208:211], v[180:183], v[140:143], v[208:211]
    v_mad_u32_u24 v212, v212, s57, v244
    v_fmac_f32 v240, v195, v86
    v_mfma_f32_16x16x32_bf16 v[184:187], v[96:99], v[152:155], 0
    v_mad_u32_u24 v216, v216, s57, v244
    v_fmac_f32 v240, v196, v8
    v_mfma_f32_16x16x32_bf16 v[184:187], v[100:103], v[156:159], v[184:187]
    v_fmac_f32 v240, v197, v9
    v_fmac_f32 v240, v198, v10
    v_mfma_f32_16x16x32_bf16 v[188:191], v[96:99], v[168:171], 0
    v_fmac_f32 v240, v199, v11
    v_fmac_f32 v240, v203, v84
    v_mfma_f32_16x16x32_bf16 v[188:191], v[100:103], v[172:175], v[188:191]
    ds_read_b128 v[96:99], v212 offset:0
    ds_read_b128 v[100:103], v212 offset:64
    v_mfma_f32_16x16x32_bf16 v[192:195], v[104:107], v[104:107], 0
    v_fmac_f32 v240, v204, v12
    v_fmac_f32 v240, v205, v13
    v_mfma_f32_16x16x32_bf16 v[192:195], v[108:111], v[108:111], v[192:195]
    ds_read_b128 v[144:147], v216 offset:0
    ds_read_b128 v[148:151], v216 offset:64
    v_mfma_f32_16x16x32_bf16 v[196:199], v[104:107], v[120:123], 0
    v_fmac_f32 v240, v206, v14
    v_fmac_f32 v240, v207, v15
    v_mfma_f32_16x16x32_bf16 v[196:199], v[108:111], v[124:127], v[196:199]
    v_fmac_f32 v240, v211, v87
    v_fmac_f32 v240, v184, v16
    v_mfma_f32_16x16x32_bf16 v[200:203], v[176:179], v[152:155], 0
    v_fmac_f32 v240, v185, v17
    v_fmac_f32 v240, v186, v18
    v_mfma_f32_16x16x32_bf16 v[200:203], v[180:183], v[156:159], v[200:203]
    v_fmac_f32 v240, v187, v19
    v_fmac_f32 v240, v188, v20
    v_mfma_f32_16x16x32_bf16 v[204:207], v[176:179], v[104:107], 0
    v_fmac_f32 v240, v189, v21
    v_fmac_f32 v240, v190, v22
    v_mfma_f32_16x16x32_bf16 v[204:207], v[180:183], v[108:111], v[204:207]
    v_fmac_f32 v240, v191, v23
    v_mad_u32_u24 v217, v217, s57, v244
    v_mfma_f32_16x16x32_bf16 v[208:211], v[104:107], v[136:139], 0
    v_mad_u32_u24 v236, v236, s57, v244
    v_mad_u32_u24 v213, v213, s57, v244
    v_mfma_f32_16x16x32_bf16 v[208:211], v[108:111], v[140:143], v[208:211]
    v_fmac_f32 v240, v192, v24
    v_fmac_f32 v240, v193, v25
    v_mfma_f32_16x16x32_bf16 v[184:187], v[104:107], v[152:155], 0
    v_fmac_f32 v240, v194, v26
    v_fmac_f32 v240, v195, v27
    v_mfma_f32_16x16x32_bf16 v[184:187], v[108:111], v[156:159], v[184:187]
    v_fmac_f32 v240, v196, v28
    v_fmac_f32 v240, v197, v29
    v_mfma_f32_16x16x32_bf16 v[188:191], v[176:179], v[168:171], 0
    v_fmac_f32 v240, v198, v30
    v_fmac_f32 v240, v199, v31
    v_mfma_f32_16x16x32_bf16 v[188:191], v[180:183], v[172:175], v[188:191]
    ds_read_b128 v[160:163], v217 offset:0
    ds_read_b128 v[164:167], v217 offset:64
    v_mfma_f32_16x16x32_bf16 v[192:195], v[104:107], v[168:171], 0
    ds_read_b128 v[176:179], v236 offset:0
    ds_read_b128 v[180:183], v236 offset:64
    v_mfma_f32_16x16x32_bf16 v[192:195], v[108:111], v[172:175], v[192:195]
    ds_read_b128 v[104:107], v213 offset:0
    ds_read_b128 v[108:111], v213 offset:64
    v_mfma_f32_16x16x32_bf16 v[196:199], v[120:123], v[120:123], 0
    v_fmac_f32 v240, v203, v88
    v_fmac_f32 v240, v207, v85
    v_mfma_f32_16x16x32_bf16 v[196:199], v[124:127], v[124:127], v[196:199]
    buffer_load_dwordx4 v[212:215], v245, s[16:19], s74 offen offset:3200
    buffer_load_dwordx2 v[216:217], v245, s[16:19], s74 offen offset:3216
    buffer_load_dword v236, v246, s[16:19], s74 offen offset:3584
    v_mfma_f32_16x16x32_bf16 v[200:203], v[120:123], v[136:139], 0
    v_fmac_f32 v240, v208, v32
    v_fmac_f32 v240, v209, v33
    v_mfma_f32_16x16x32_bf16 v[200:203], v[124:127], v[140:143], v[200:203]
    v_fmac_f32 v240, v210, v34
    v_fmac_f32 v240, v211, v35
    v_mfma_f32_16x16x32_bf16 v[204:207], v[120:123], v[152:155], 0
    v_fmac_f32 v240, v184, v36
    v_fmac_f32 v240, v185, v37
    v_mfma_f32_16x16x32_bf16 v[204:207], v[124:127], v[156:159], v[204:207]
    v_fmac_f32 v240, v186, v38
    v_fmac_f32 v240, v187, v39
    v_mfma_f32_16x16x32_bf16 v[208:211], v[120:123], v[168:171], 0
    v_fmac_f32 v240, v191, v89
    v_fmac_f32 v240, v192, v40
    v_mfma_f32_16x16x32_bf16 v[208:211], v[124:127], v[172:175], v[208:211]
    v_fmac_f32 v240, v193, v41
    v_fmac_f32 v240, v194, v42
    v_mfma_f32_16x16x32_bf16 v[184:187], v[136:139], v[136:139], 0
    v_fmac_f32 v240, v195, v43
    v_permlane32_swap_b32 v237, v238
    v_mfma_f32_16x16x32_bf16 v[184:187], v[140:143], v[140:143], v[184:187]
    s_add_u32 s74, s74, 1600
    v_fmac_f32 v240, v196, v44
    v_mfma_f32_16x16x32_bf16 v[188:191], v[136:139], v[152:155], 0
    v_fmac_f32 v240, v197, v45
    v_fmac_f32 v240, v198, v46
    v_mfma_f32_16x16x32_bf16 v[188:191], v[140:143], v[156:159], v[188:191]
    v_fmac_f32 v240, v199, v47
    v_add_f32 v241, v237, v238
    v_mfma_f32_16x16x32_bf16 v[192:195], v[136:139], v[168:171], 0
    s_cmp_lt_u32 s74, s58
    v_fmac_f32 v240, v200, v48
    v_mfma_f32_16x16x32_bf16 v[192:195], v[140:143], v[172:175], v[192:195]
    v_fmac_f32 v240, v201, v49
    v_fmac_f32 v240, v202, v50
    v_mfma_f32_16x16x32_bf16 v[196:199], v[152:155], v[152:155], 0
    v_fmac_f32 v240, v203, v51
    v_fmac_f32 v240, v204, v52
    v_mfma_f32_16x16x32_bf16 v[196:199], v[156:159], v[156:159], v[196:199]
    v_fmac_f32 v240, v205, v53
    v_fmac_f32 v240, v206, v54
    v_mfma_f32_16x16x32_bf16 v[200:203], v[152:155], v[168:171], 0
    v_fmac_f32 v240, v207, v55
    v_fmac_f32 v240, v208, v56
    v_mfma_f32_16x16x32_bf16 v[200:203], v[156:159], v[172:175], v[200:203]
    v_fmac_f32 v240, v209, v57
    v_fmac_f32 v240, v210, v58
    v_mfma_f32_16x16x32_bf16 v[204:207], v[168:171], v[168:171], 0
    v_fmac_f32 v240, v211, v59
    v_fmac_f32 v240, v184, v60
    v_mfma_f32_16x16x32_bf16 v[204:207], v[172:175], v[172:175], v[204:207]
    v_fmac_f32 v240, v185, v61
    v_fmac_f32 v240, v186, v62
    v_fmac_f32 v240, v187, v63
    s_waitcnt vmcnt(7) lgkmcnt(0)
    s_cbranch_scc1 standalone__deep_cross_pnn__recsys_kernel_loop
    s_nop 7
    v_fmac_f32 v240, v188, v64
    v_fmac_f32 v240, v189, v65
    v_fmac_f32 v240, v190, v66
    v_fmac_f32 v240, v191, v67
    v_fmac_f32 v240, v192, v68
    v_fmac_f32 v240, v193, v69
    v_fmac_f32 v240, v194, v70
    v_fmac_f32 v240, v195, v71
    v_fmac_f32 v240, v196, v72
    v_fmac_f32 v240, v197, v73
    v_fmac_f32 v240, v198, v74
    v_fmac_f32 v240, v199, v75
    v_fmac_f32 v240, v200, v76
    v_fmac_f32 v240, v201, v77
    v_fmac_f32 v240, v202, v78
    v_fmac_f32 v240, v203, v79
    v_fmac_f32 v240, v204, v80
    v_fmac_f32 v240, v205, v81
    v_fmac_f32 v240, v206, v82
    v_fmac_f32 v240, v207, v83
    s_nop 1
    v_permlane32_swap_b32 v239, v240
    s_nop 1
    v_add_f32 v242, v239, v240
    s_nop 1
    v_permlane16_swap_b32 v241, v242
    s_nop 1
    v_add_f32 v241, v241, v242
    s_nop 1
    v_add_f32_dpp v241, v241, v241 row_ror:8 row_mask:0xf bank_mask:0xf
    s_nop 1
    v_add_f32_dpp v241, v241, v241 row_ror:4 row_mask:0xf bank_mask:0xf
    s_nop 1
    v_add_f32_dpp v241, v241, v241 row_ror:2 row_mask:0xf bank_mask:0xf
    s_nop 1
    v_add_f32_dpp v241, v241, v241 row_ror:1 row_mask:0xf bank_mask:0xf
    s_nop 1
    v_cndmask_b32 v243, v243, v241, s[70:71]

    v_and_b32 v40, 15, v255
    v_add_u32 v40, -1, v40
    v_cmp_gt_u32 vcc, 8, v40
    s_lshl_b32 s74, s72, 2
    s_lshl_b32 s76, s36, 16
    s_add_u32 s74, s74, s76
    s_add_u32 s74, s74, 29360128
    v_lshlrev_b32 v40, 4, v40
    v_lshrrev_b32 v41, 5, v255
    v_lshl_add_u32 v40, v41, 2, v40
    v_bfe_u32 v41, v255, 4, 1
    v_lshl_add_u32 v112, v41, 3, v40
    s_mov_b64 s[46:47], vcc
    v_mov_b32 v113, v243
    s_mov_b32 s64, 0x40000000
    s_waitcnt vmcnt(0)

    s_branch standalone__deep_cross_pnn__recsys_kernel_k2
standalone__deep_cross_pnn__recsys_kernel_aux:

    s_setprio 0
    v_mov_b32 v8, v255
    v_mov_b32 v9, v254
    v_mov_b32 v10, v253
    v_mov_b32 v11, v252
    s_mov_b32 s51, s2
    s_mov_b32 s64, 0
    s_mov_b32 s65, 0

    v_mov_b32 v35, v83
    s_lshr_b32 s72, s2, 3
    s_mul_i32 s72, s72, 36
    s_lshr_b32 s72, s72, 5
    s_lshl_b32 s75, s36, 7
    s_add_u32 s75, s75, 254464
    s_mov_b32 s76, 143136
    s_lshl_b32 s6, s2, 15
    s_lshl_b32 s7, s56, 13
    s_add_u32 s6, s6, s7
    s_add_u32 s6, s6, 20971520
    s_add_u32 s7, s6, 4096
    s_lshl_b32 s8, s36, 7
    s_add_u32 s8, s8, s37
    s_lshl_b32 s8, s8, 9
    s_add_u32 s8, s8, 29360128

standalone__deep_cross_pnn__recsys_kernel_unit:

    s_bfe_u32 s36, s51, 0x10003

    s_lshr_b32 s38, s51, 4
    s_and_b32 s39, s51, 7
    s_sub_u32 s57, 2, s36
    s_lshl_b32 s57, s39, s57
    s_lshl_b32 s37, s36, 5
    s_add_u32 s57, s57, s37
    s_add_u32 s57, s57, s56
    s_mul_i32 s37, s38, 48
    s_add_u32 s37, s37, s57
    s_lshl_b32 s38, s38, 1
    s_lshr_b32 s39, s39, 2
    s_add_u32 s38, s38, s39
    s_add_u32 s38, s38, 768
    s_and_b32 s57, s57, 7
    s_cmp_eq_u32 s57, 2
    s_cselect_b32 s38, s38, 1000
    s_lshl_b32 s39, s36, 1
    s_and_b32 s39, s39, s56
    s_cselect_b32 s57, s38, s37

    s_lshr_b32 s37, s51, 4
    s_lshl_b32 s37, s37, 3
    s_and_b32 s38, s51, 7
    s_or_b32 s37, s37, s38
    s_and_b32 s58, s56, 1
    s_lshl_b32 s59, s37, 1
    s_add_u32 s58, s58, s59
    s_lshr_b32 s59, s56, 1
    s_lshl_b32 s60, s36, 1
    s_add_u32 s59, s59, s60
    s_mul_i32 s60, s58, 25600
    s_mul_i32 s61, s59, 96
    s_add_u32 s60, s60, s61
    s_movk_i32 s61, 400
    v_lshrrev_b32 v1, 3, v8
    v_and_b32 v2, 7, v8
    v_mul_u32_u24 v0, s61, v1
    v_cmp_gt_u32 s[48:49], 7, v2
    v_lshl_add_u32 v0, v2, 4, v0
    v_and_b32 v5, 15, v8
    v_and_b32 v6, 48, v8
    v_lshl_add_u32 v7, v5, 8, v6
    s_lshr_b32 s44, s37, 1
    s_lshl_b32 s44, s44, 12
    s_lshl_b32 s38, s36, 1
    s_and_b32 s39, s37, 1
    s_add_u32 s38, s38, s39
    s_lshl_b32 s38, s38, 6
    s_add_u32 s44, s44, s38
    s_lshl_b32 s47, s36, 7
    s_add_u32 s47, s47, s37
    s_lshl_b32 s47, s47, 10
    s_add_u32 s47, s47, 15204352
    s_lshl_b32 s38, s56, 4
    s_lshl_b64 s[4:5], 0xffff, s38

    s_cmp_lg_u32 s64, 0
    s_cbranch_scc1 standalone__deep_cross_pnn__recsys_kernel_nd1
    s_mov_b64 exec, s[40:41]

    s_mul_i32 s73, s72, 4032
    s_mul_i32 s74, s72, 7168
    s_add_u32 s73, s73, s43
    s_add_u32 s74, s74, s42
    s_min_u32 m0, s73, s76
    s_min_u32 s74, s74, s75
    s_add_u32 s72, s72, 1

    buffer_load_dwordx4 v35, s[20:23], s74 offen lds
    s_cmp_eq_u32 s72, 36
    s_cselect_b32 s72, 0, s72

    s_mul_i32 s73, s72, 4032
    s_mul_i32 s74, s72, 7168
    s_add_u32 s73, s73, s43
    s_add_u32 s74, s74, s42
    s_min_u32 m0, s73, s76
    s_min_u32 s74, s74, s75
    s_add_u32 s72, s72, 1

    buffer_load_dwordx4 v35, s[20:23], s74 offen lds
    s_cmp_eq_u32 s72, 36
    s_cselect_b32 s72, 0, s72

    s_mul_i32 s73, s72, 4032
    s_mul_i32 s74, s72, 7168
    s_add_u32 s73, s73, s43
    s_add_u32 s74, s74, s42
    s_min_u32 m0, s73, s76
    s_min_u32 s74, s74, s75
    s_add_u32 s72, s72, 1

    buffer_load_dwordx4 v35, s[20:23], s74 offen lds
    s_cmp_eq_u32 s72, 36
    s_cselect_b32 s72, 0, s72

    s_mul_i32 s73, s72, 4032
    s_mul_i32 s74, s72, 7168
    s_add_u32 s73, s73, s43
    s_add_u32 s74, s74, s42
    s_min_u32 m0, s73, s76
    s_min_u32 s74, s74, s75
    s_add_u32 s72, s72, 1

    buffer_load_dwordx4 v35, s[20:23], s74 offen lds
    s_cmp_eq_u32 s72, 36
    s_cselect_b32 s72, 0, s72

    s_mul_i32 s73, s72, 4032
    s_mul_i32 s74, s72, 7168
    s_add_u32 s73, s73, s43
    s_add_u32 s74, s74, s42
    s_min_u32 m0, s73, s76
    s_min_u32 s74, s74, s75
    s_add_u32 s72, s72, 1

    buffer_load_dwordx4 v35, s[20:23], s74 offen lds
    s_cmp_eq_u32 s72, 36
    s_cselect_b32 s72, 0, s72

    s_mul_i32 s73, s72, 4032
    s_mul_i32 s74, s72, 7168
    s_add_u32 s73, s73, s43
    s_add_u32 s74, s74, s42
    s_min_u32 m0, s73, s76
    s_min_u32 s74, s74, s75
    s_add_u32 s72, s72, 1

    buffer_load_dwordx4 v35, s[20:23], s74 offen lds
    s_cmp_eq_u32 s72, 36
    s_cselect_b32 s72, 0, s72

    s_mul_i32 s73, s72, 4032
    s_mul_i32 s74, s72, 7168
    s_add_u32 s73, s73, s43
    s_add_u32 s74, s74, s42
    s_min_u32 m0, s73, s76
    s_min_u32 s74, s74, s75
    s_add_u32 s72, s72, 1

    buffer_load_dwordx4 v35, s[20:23], s74 offen lds
    s_cmp_eq_u32 s72, 36
    s_cselect_b32 s72, 0, s72

    s_mul_i32 s73, s72, 4032
    s_mul_i32 s74, s72, 7168
    s_add_u32 s73, s73, s43
    s_add_u32 s74, s74, s42
    s_min_u32 m0, s73, s76
    s_min_u32 s74, s74, s75
    s_add_u32 s72, s72, 1

    buffer_load_dwordx4 v35, s[20:23], s74 offen lds
    s_cmp_eq_u32 s72, 36
    s_cselect_b32 s72, 0, s72

    s_mul_i32 s73, s72, 4032
    s_mul_i32 s74, s72, 7168
    s_add_u32 s73, s73, s43
    s_add_u32 s74, s74, s42
    s_min_u32 m0, s73, s76
    s_min_u32 s74, s74, s75
    s_add_u32 s72, s72, 1
    s_barrier

    buffer_load_dwordx4 v35, s[20:23], s74 offen lds
    s_cmp_eq_u32 s72, 36
    s_cselect_b32 s72, 0, s72

    s_mul_i32 s73, s72, 4032
    s_mul_i32 s74, s72, 7168
    s_add_u32 s73, s73, s43
    s_add_u32 s74, s74, s42
    s_min_u32 m0, s73, s76
    s_min_u32 s74, s74, s75
    s_add_u32 s72, s72, 1

    buffer_load_dwordx4 v35, s[20:23], s74 offen lds
    s_cmp_eq_u32 s72, 36
    s_cselect_b32 s72, 0, s72

    s_mul_i32 s73, s72, 4032
    s_mul_i32 s74, s72, 7168
    s_add_u32 s73, s73, s43
    s_add_u32 s74, s74, s42
    s_min_u32 m0, s73, s76
    s_min_u32 s74, s74, s75
    s_add_u32 s72, s72, 1

    buffer_load_dwordx4 v35, s[20:23], s74 offen lds
    s_cmp_eq_u32 s72, 36
    s_cselect_b32 s72, 0, s72

    s_mul_i32 s73, s72, 4032
    s_mul_i32 s74, s72, 7168
    s_add_u32 s73, s73, s43
    s_add_u32 s74, s74, s42
    s_min_u32 m0, s73, s76
    s_min_u32 s74, s74, s75
    s_add_u32 s72, s72, 1

    buffer_load_dwordx4 v35, s[20:23], s74 offen lds
    s_cmp_eq_u32 s72, 36
    s_cselect_b32 s72, 0, s72

    s_mov_b64 exec, -1
standalone__deep_cross_pnn__recsys_kernel_nd1:

    s_lshr_b32 s78, s57, 5
    s_bfe_u32 s79, s57, 0x20003
    s_bfe_u32 s80, s57, 0x20001
    s_and_b32 s81, s57, 1
    s_lshl_b32 s77, s78, 2
    s_lshl_b32 s83, s81, 1
    s_add_u32 s77, s77, s83
    s_lshl_b32 s77, s77, 7
    s_lshl_b32 s83, s79, 5
    s_add_u32 s77, s77, s83
    s_lshl_b32 s83, s80, 3
    s_add_u32 s77, s77, s83
    s_lshl_b32 s77, s77, 10
    s_lshl_b32 s82, s78, 12
    s_lshl_b32 s83, s79, 10
    s_add_u32 s82, s82, s83
    s_lshl_b32 s83, s80, 8
    s_add_u32 s82, s82, s83
    s_lshl_b32 s83, s81, 7
    s_add_u32 s82, s82, s83
    s_mov_b32 s84, 205312
    v_lshrrev_b32 v3, 2, v8
    v_and_b32 v4, 3, v8
    v_mul_lo_u32 v14, v3, s84
    v_lshl_add_u32 v14, v4, 4, v14
    s_cmp_ge_u32 s57, 800
    s_cselect_b32 s83, 0x40000000, 0
    v_or_b32 v14, s83, v14
    s_lshl_b32 s61, s56, 12
    s_add_u32 s61, s61, 144256
    v_and_b32 v3, 3, v3
    v_lshlrev_b32 v36, 6, v8
    v_lshl_add_u32 v36, v3, 4, v36
    v_add_u32 v36, s61, v36
    v_xor_b32 v37, 16, v36
    v_xor_b32 v38, 32, v36
    v_xor_b32 v39, 48, v36
    v_and_b32 v3, 48, v8
    v_xor_b32 v15, v3, v9
    v_add_u32 v15, s61, v15
    s_mov_b32 s84, 0x05040100
    s_mov_b32 s85, 0x07060302

    s_cmp_lg_u32 s64, 0
    s_cbranch_scc1 standalone__deep_cross_pnn__recsys_kernel_nd2
    s_mov_b64 exec, s[40:41]

    s_mul_i32 s73, s72, 4032
    s_mul_i32 s74, s72, 7168
    s_add_u32 s73, s73, s43
    s_add_u32 s74, s74, s42
    s_min_u32 m0, s73, s76
    s_min_u32 s74, s74, s75
    s_add_u32 s72, s72, 1

    buffer_load_dwordx4 v35, s[20:23], s74 offen lds
    s_cmp_eq_u32 s72, 36
    s_cselect_b32 s72, 0, s72

    s_mul_i32 s73, s72, 4032
    s_mul_i32 s74, s72, 7168
    s_add_u32 s73, s73, s43
    s_add_u32 s74, s74, s42
    s_min_u32 m0, s73, s76
    s_min_u32 s74, s74, s75
    s_add_u32 s72, s72, 1

    buffer_load_dwordx4 v35, s[20:23], s74 offen lds
    s_cmp_eq_u32 s72, 36
    s_cselect_b32 s72, 0, s72

    s_mul_i32 s73, s72, 4032
    s_mul_i32 s74, s72, 7168
    s_add_u32 s73, s73, s43
    s_add_u32 s74, s74, s42
    s_min_u32 m0, s73, s76
    s_min_u32 s74, s74, s75
    s_add_u32 s72, s72, 1

    buffer_load_dwordx4 v35, s[20:23], s74 offen lds
    s_cmp_eq_u32 s72, 36
    s_cselect_b32 s72, 0, s72

    s_mul_i32 s73, s72, 4032
    s_mul_i32 s74, s72, 7168
    s_add_u32 s73, s73, s43
    s_add_u32 s74, s74, s42
    s_min_u32 m0, s73, s76
    s_min_u32 s74, s74, s75
    s_add_u32 s72, s72, 1

    buffer_load_dwordx4 v35, s[20:23], s74 offen lds
    s_cmp_eq_u32 s72, 36
    s_cselect_b32 s72, 0, s72

    s_mul_i32 s73, s72, 4032
    s_mul_i32 s74, s72, 7168
    s_add_u32 s73, s73, s43
    s_add_u32 s74, s74, s42
    s_min_u32 m0, s73, s76
    s_min_u32 s74, s74, s75
    s_add_u32 s72, s72, 1

    buffer_load_dwordx4 v35, s[20:23], s74 offen lds
    s_cmp_eq_u32 s72, 36
    s_cselect_b32 s72, 0, s72

    s_mul_i32 s73, s72, 4032
    s_mul_i32 s74, s72, 7168
    s_add_u32 s73, s73, s43
    s_add_u32 s74, s74, s42
    s_min_u32 m0, s73, s76
    s_min_u32 s74, s74, s75
    s_add_u32 s72, s72, 1

    buffer_load_dwordx4 v35, s[20:23], s74 offen lds
    s_cmp_eq_u32 s72, 36
    s_cselect_b32 s72, 0, s72

    s_mul_i32 s73, s72, 4032
    s_mul_i32 s74, s72, 7168
    s_add_u32 s73, s73, s43
    s_add_u32 s74, s74, s42
    s_min_u32 m0, s73, s76
    s_min_u32 s74, s74, s75
    s_add_u32 s72, s72, 1

    buffer_load_dwordx4 v35, s[20:23], s74 offen lds
    s_cmp_eq_u32 s72, 36
    s_cselect_b32 s72, 0, s72

    s_mul_i32 s73, s72, 4032
    s_mul_i32 s74, s72, 7168
    s_add_u32 s73, s73, s43
    s_add_u32 s74, s74, s42
    s_min_u32 m0, s73, s76
    s_min_u32 s74, s74, s75
    s_add_u32 s72, s72, 1

    buffer_load_dwordx4 v35, s[20:23], s74 offen lds
    s_cmp_eq_u32 s72, 36
    s_cselect_b32 s72, 0, s72

    s_mul_i32 s73, s72, 4032
    s_mul_i32 s74, s72, 7168
    s_add_u32 s73, s73, s43
    s_add_u32 s74, s74, s42
    s_min_u32 m0, s73, s76
    s_min_u32 s74, s74, s75
    s_add_u32 s72, s72, 1

    buffer_load_dwordx4 v35, s[20:23], s74 offen lds
    s_cmp_eq_u32 s72, 36
    s_cselect_b32 s72, 0, s72

    s_mul_i32 s73, s72, 4032
    s_mul_i32 s74, s72, 7168
    s_add_u32 s73, s73, s43
    s_add_u32 s74, s74, s42
    s_min_u32 m0, s73, s76
    s_min_u32 s74, s74, s75
    s_add_u32 s72, s72, 1

    buffer_load_dwordx4 v35, s[20:23], s74 offen lds
    s_cmp_eq_u32 s72, 36
    s_cselect_b32 s72, 0, s72

    s_mul_i32 s73, s72, 4032
    s_mul_i32 s74, s72, 7168
    s_add_u32 s73, s73, s43
    s_add_u32 s74, s74, s42
    s_min_u32 m0, s73, s76
    s_min_u32 s74, s74, s75
    s_add_u32 s72, s72, 1

    buffer_load_dwordx4 v35, s[20:23], s74 offen lds
    s_cmp_eq_u32 s72, 36
    s_cselect_b32 s72, 0, s72

    s_mul_i32 s73, s72, 4032
    s_mul_i32 s74, s72, 7168
    s_add_u32 s73, s73, s43
    s_add_u32 s74, s74, s42
    s_min_u32 m0, s73, s76
    s_min_u32 s74, s74, s75
    s_add_u32 s72, s72, 1

    buffer_load_dwordx4 v35, s[20:23], s74 offen lds
    s_cmp_eq_u32 s72, 36
    s_cselect_b32 s72, 0, s72

    s_mul_i32 s73, s72, 4032
    s_mul_i32 s74, s72, 7168
    s_add_u32 s73, s73, s43
    s_add_u32 s74, s74, s42
    s_min_u32 m0, s73, s76
    s_min_u32 s74, s74, s75
    s_add_u32 s72, s72, 1

    buffer_load_dwordx4 v35, s[20:23], s74 offen lds
    s_cmp_eq_u32 s72, 36
    s_cselect_b32 s72, 0, s72

    s_mul_i32 s73, s72, 4032
    s_mul_i32 s74, s72, 7168
    s_add_u32 s73, s73, s43
    s_add_u32 s74, s74, s42
    s_min_u32 m0, s73, s76
    s_min_u32 s74, s74, s75
    s_add_u32 s72, s72, 1

    buffer_load_dwordx4 v35, s[20:23], s74 offen lds
    s_cmp_eq_u32 s72, 36
    s_cselect_b32 s72, 0, s72

    s_mul_i32 s73, s72, 4032
    s_mul_i32 s74, s72, 7168
    s_add_u32 s73, s73, s43
    s_add_u32 s74, s74, s42
    s_min_u32 m0, s73, s76
    s_min_u32 s74, s74, s75
    s_add_u32 s72, s72, 1

    buffer_load_dwordx4 v35, s[20:23], s74 offen lds
    s_cmp_eq_u32 s72, 36
    s_cselect_b32 s72, 0, s72

    s_mul_i32 s73, s72, 4032
    s_mul_i32 s74, s72, 7168
    s_add_u32 s73, s73, s43
    s_add_u32 s74, s74, s42
    s_min_u32 m0, s73, s76
    s_min_u32 s74, s74, s75
    s_add_u32 s72, s72, 1

    buffer_load_dwordx4 v35, s[20:23], s74 offen lds
    s_cmp_eq_u32 s72, 36
    s_cselect_b32 s72, 0, s72

    s_mul_i32 s73, s72, 4032
    s_mul_i32 s74, s72, 7168
    s_add_u32 s73, s73, s43
    s_add_u32 s74, s74, s42
    s_min_u32 m0, s73, s76
    s_min_u32 s74, s74, s75
    s_add_u32 s72, s72, 1

    buffer_load_dwordx4 v35, s[20:23], s74 offen lds
    s_cmp_eq_u32 s72, 36
    s_cselect_b32 s72, 0, s72

    s_mul_i32 s73, s72, 4032
    s_mul_i32 s74, s72, 7168
    s_add_u32 s73, s73, s43
    s_add_u32 s74, s74, s42
    s_min_u32 m0, s73, s76
    s_min_u32 s74, s74, s75
    s_add_u32 s72, s72, 1

    buffer_load_dwordx4 v35, s[20:23], s74 offen lds
    s_cmp_eq_u32 s72, 36
    s_cselect_b32 s72, 0, s72

    s_mul_i32 s73, s72, 4032
    s_mul_i32 s74, s72, 7168
    s_add_u32 s73, s73, s43
    s_add_u32 s74, s74, s42
    s_min_u32 m0, s73, s76
    s_min_u32 s74, s74, s75
    s_add_u32 s72, s72, 1

    buffer_load_dwordx4 v35, s[20:23], s74 offen lds
    s_cmp_eq_u32 s72, 36
    s_cselect_b32 s72, 0, s72

    s_mul_i32 s73, s72, 4032
    s_mul_i32 s74, s72, 7168
    s_add_u32 s73, s73, s43
    s_add_u32 s74, s74, s42
    s_min_u32 m0, s73, s76
    s_min_u32 s74, s74, s75
    s_add_u32 s72, s72, 1

    buffer_load_dwordx4 v35, s[20:23], s74 offen lds
    s_cmp_eq_u32 s72, 36
    s_cselect_b32 s72, 0, s72

    s_mul_i32 s73, s72, 4032
    s_mul_i32 s74, s72, 7168
    s_add_u32 s73, s73, s43
    s_add_u32 s74, s74, s42
    s_min_u32 m0, s73, s76
    s_min_u32 s74, s74, s75
    s_add_u32 s72, s72, 1

    buffer_load_dwordx4 v35, s[20:23], s74 offen lds
    s_cmp_eq_u32 s72, 36
    s_cselect_b32 s72, 0, s72

    s_mul_i32 s73, s72, 4032
    s_mul_i32 s74, s72, 7168
    s_add_u32 s73, s73, s43
    s_add_u32 s74, s74, s42
    s_min_u32 m0, s73, s76
    s_min_u32 s74, s74, s75
    s_add_u32 s72, s72, 1

    buffer_load_dwordx4 v35, s[20:23], s74 offen lds
    s_cmp_eq_u32 s72, 36
    s_cselect_b32 s72, 0, s72

    s_mul_i32 s73, s72, 4032
    s_mul_i32 s74, s72, 7168
    s_add_u32 s73, s73, s43
    s_add_u32 s74, s74, s42
    s_min_u32 m0, s73, s76
    s_min_u32 s74, s74, s75
    s_add_u32 s72, s72, 1

    buffer_load_dwordx4 v35, s[20:23], s74 offen lds
    s_cmp_eq_u32 s72, 36
    s_cselect_b32 s72, 0, s72

    s_mul_i32 s73, s72, 4032
    s_mul_i32 s74, s72, 7168
    s_add_u32 s73, s73, s43
    s_add_u32 s74, s74, s42
    s_min_u32 m0, s73, s76
    s_min_u32 s74, s74, s75
    s_add_u32 s72, s72, 1

    buffer_load_dwordx4 v35, s[20:23], s74 offen lds
    s_cmp_eq_u32 s72, 36
    s_cselect_b32 s72, 0, s72

    s_mov_b64 exec, -1
standalone__deep_cross_pnn__recsys_kernel_nd2:

    s_cmp_lg_u32 s64, 0
    s_cbranch_scc1 standalone__deep_cross_pnn__recsys_kernel_nsig
    s_waitcnt vmcnt(0)
    s_barrier

standalone__deep_cross_pnn__recsys_kernel_nsig:
    s_mov_b64 exec, s[48:49]
    buffer_load_dwordx4 v[224:227], v0, s[16:19], s60 offen
    s_add_u32 s60, s60, 3200
    buffer_load_dwordx4 v[228:231], v0, s[16:19], s60 offen
    s_add_u32 s60, s60, 3200
    buffer_load_dwordx4 v[232:235], v0, s[16:19], s60 offen
    s_add_u32 s60, s60, 3200
    buffer_load_dwordx4 v[236:239], v0, s[16:19], s60 offen
    s_add_u32 s60, s60, 3200
    buffer_load_dwordx4 v[240:243], v0, s[16:19], s60 offen
    s_add_u32 s60, s60, 3200
    buffer_load_dwordx4 v[244:247], v0, s[16:19], s60 offen
    s_add_u32 s60, s60, 3200
    buffer_load_dwordx4 v[248:251], v0, s[16:19], s60 offen
    s_add_u32 s60, s60, 3200
    buffer_load_dwordx4 v[252:255], v0, s[16:19], s60 offen
    s_add_u32 s60, s60, 3200
    s_mov_b64 exec, -1
    s_setprio 1

    s_lshl_b32 s61, s56, 12
    s_add_u32 s61, s61, 144256
    v_lshlrev_b32 v86, 2, v8
    v_add_u32 v86, s61, v86
    v_and_b32 v85, 0xffffff80, v86
    v_and_b32 v123, 32, v8
    s_add_u32 s61, s61, 256
    v_mul_u32_u24 v31, 56, v8
    v_add_u32 v31, s61, v31
    v_mul_u32_u24 v34, 56, v1
    v_lshl_add_u32 v34, v2, 3, v34
    v_add_u32 v34, s61, v34
    v_add_u32 v2, s59, v2
    v_subrev_u32 v3, 5, v2
    v_min_u32 v2, v2, v3
    v_mov_b32 v13, 0
    v_mul_u32_u24 v2, 0x10001, v2
    v_lshlrev_b32 v2, 12, v2
    v_add_u32 v32, 67108864, v2
    v_add_u32 v33, 201328640, v2
    v_mov_b32 v71, 0xf00
    s_lshr_b32 s62, s58, 7
    s_mul_i32 s62, s62, 25
    s_mul_i32 s63, s59, 6
    s_add_u32 s62, s62, s63
    s_lshl_b32 s62, s62, 3
    s_bfe_u32 s63, s58, 0x30004
    s_add_u32 s62, s62, s63
    s_lshl_b32 s62, s62, 13
    s_bfe_u32 s63, s58, 0x30001
    s_lshl_b32 s63, s63, 10
    s_add_u32 s62, s62, s63
    s_and_b32 s63, s58, 1
    s_lshl_b32 s63, s63, 9
    s_add_u32 s62, s62, s63
    s_add_u32 s62, s62, 16777216
    v_and_b32 v30, 31, v8
    v_lshrrev_b32 v3, 5, v8
    v_lshlrev_b32 v30, 4, v30
    v_lshl_add_u32 v30, v3, 3, v30
    s_cmp_eq_u32 s59, 3
    s_cselect_b32 s63, 0xf00, 0
    s_movk_i32 s66, 0x7c
    s_mov_b32 s67, 0x001f001f
    s_mov_b32 s75, 0x06040200
    v_mov_b32 v54, 0x08040201
    v_mov_b32 v55, 0x80402010
    v_mov_b32 v108, -1
    v_mov_b32 v109, -1
    v_mov_b32 v110, -1
    v_mov_b32 v111, -1
    s_mov_b64 exec, s[48:49]

    s_waitcnt vmcnt(7)
    v_lshl_or_b32 v224, v225, 16, v224
    v_lshl_or_b32 v225, v227, 16, v226
    v_add_u32 v224, v32, v224
    v_add_u32 v225, v33, v225
    ds_write_b64 v34, v[224:225] offset:0

    s_waitcnt vmcnt(6)
    v_lshl_or_b32 v228, v229, 16, v228
    v_lshl_or_b32 v229, v231, 16, v230
    v_add_u32 v228, v32, v228
    v_add_u32 v229, v33, v229
    ds_write_b64 v34, v[228:229] offset:448

    s_waitcnt vmcnt(5)
    v_lshl_or_b32 v232, v233, 16, v232
    v_lshl_or_b32 v233, v235, 16, v234
    v_add_u32 v232, v32, v232
    v_add_u32 v233, v33, v233
    ds_write_b64 v34, v[232:233] offset:896

    s_waitcnt vmcnt(4)
    v_lshl_or_b32 v236, v237, 16, v236
    v_lshl_or_b32 v237, v239, 16, v238
    v_add_u32 v236, v32, v236
    v_add_u32 v237, v33, v237
    ds_write_b64 v34, v[236:237] offset:1344

    s_waitcnt vmcnt(3)
    v_lshl_or_b32 v240, v241, 16, v240
    v_lshl_or_b32 v241, v243, 16, v242
    v_add_u32 v240, v32, v240
    v_add_u32 v241, v33, v241
    ds_write_b64 v34, v[240:241] offset:1792

    s_waitcnt vmcnt(2)
    v_lshl_or_b32 v244, v245, 16, v244
    v_lshl_or_b32 v245, v247, 16, v246
    v_add_u32 v244, v32, v244
    v_add_u32 v245, v33, v245
    ds_write_b64 v34, v[244:245] offset:2240

    s_waitcnt vmcnt(1)
    v_lshl_or_b32 v248, v249, 16, v248
    v_lshl_or_b32 v249, v251, 16, v250
    v_add_u32 v248, v32, v248
    v_add_u32 v249, v33, v249
    ds_write_b64 v34, v[248:249] offset:2688

    s_waitcnt vmcnt(0)
    v_lshl_or_b32 v252, v253, 16, v252
    v_lshl_or_b32 v253, v255, 16, v254
    v_add_u32 v252, v32, v252
    v_add_u32 v253, v33, v253
    ds_write_b64 v34, v[252:253] offset:3136

    s_mov_b64 exec, -1
    ds_read_b64 v[40:41], v31 offset:0
    ds_read_b64 v[42:43], v31 offset:8
    ds_read_b64 v[44:45], v31 offset:16
    ds_read_b64 v[46:47], v31 offset:24
    ds_read_b64 v[48:49], v31 offset:32
    ds_read_b64 v[50:51], v31 offset:40
    ds_read_b64 v[52:53], v31 offset:48

    s_waitcnt lgkmcnt(6)
    v_and_b32 v72, s67, v40
    v_and_b32 v73, s67, v41
    v_lshl_or_b32 v72, v73, 10, v72
    v_lshlrev_b32_sdwa v73, 5, v72 dst_sel:DWORD dst_unused:UNUSED_PAD src0_sel:DWORD src1_sel:WORD_1
    v_or_b32_sdwa v64, v73, v72 dst_sel:DWORD dst_unused:UNUSED_PAD src0_sel:DWORD src1_sel:WORD_0
    v_perm_b32 v72, v41, v40, s75
    v_lshrrev_b32 v73, 3, v72
    v_and_b32 v72, 0x07070707, v72
    v_and_b32 v0, 0x03030303, v73
    v_perm_b32 v16, v55, v54, v72
    v_add_u32 v23, v54, v16

    s_waitcnt lgkmcnt(5)
    v_and_b32 v72, s67, v42
    v_and_b32 v73, s67, v43
    v_lshl_or_b32 v72, v73, 10, v72
    v_lshlrev_b32_sdwa v73, 5, v72 dst_sel:DWORD dst_unused:UNUSED_PAD src0_sel:DWORD src1_sel:WORD_1
    v_or_b32_sdwa v65, v73, v72 dst_sel:DWORD dst_unused:UNUSED_PAD src0_sel:DWORD src1_sel:WORD_0
    v_perm_b32 v72, v43, v42, s75
    v_lshrrev_b32 v73, 3, v72
    v_and_b32 v72, 0x07070707, v72
    v_and_b32 v1, 0x03030303, v73
    v_perm_b32 v17, v55, v54, v72
    v_add_u32 v24, v54, v17

    s_waitcnt lgkmcnt(4)
    v_and_b32 v72, s67, v44
    v_and_b32 v73, s67, v45
    v_lshl_or_b32 v72, v73, 10, v72
    v_lshlrev_b32_sdwa v73, 5, v72 dst_sel:DWORD dst_unused:UNUSED_PAD src0_sel:DWORD src1_sel:WORD_1
    v_or_b32_sdwa v66, v73, v72 dst_sel:DWORD dst_unused:UNUSED_PAD src0_sel:DWORD src1_sel:WORD_0
    v_perm_b32 v72, v45, v44, s75
    v_lshrrev_b32 v73, 3, v72
    v_and_b32 v72, 0x07070707, v72
    v_and_b32 v2, 0x03030303, v73
    v_perm_b32 v18, v55, v54, v72
    v_add_u32 v25, v54, v18

    s_waitcnt lgkmcnt(3)
    v_and_b32 v72, s67, v46
    v_and_b32 v73, s67, v47
    v_lshl_or_b32 v72, v73, 10, v72
    v_lshlrev_b32_sdwa v73, 5, v72 dst_sel:DWORD dst_unused:UNUSED_PAD src0_sel:DWORD src1_sel:WORD_1
    v_or_b32_sdwa v67, v73, v72 dst_sel:DWORD dst_unused:UNUSED_PAD src0_sel:DWORD src1_sel:WORD_0
    v_perm_b32 v72, v47, v46, s75
    v_lshrrev_b32 v73, 3, v72
    v_and_b32 v72, 0x07070707, v72
    v_and_b32 v3, 0x03030303, v73
    v_perm_b32 v19, v55, v54, v72
    v_add_u32 v26, v54, v19

    s_waitcnt lgkmcnt(2)
    v_and_b32 v72, s67, v48
    v_and_b32 v73, s67, v49
    v_lshl_or_b32 v72, v73, 10, v72
    v_lshlrev_b32_sdwa v73, 5, v72 dst_sel:DWORD dst_unused:UNUSED_PAD src0_sel:DWORD src1_sel:WORD_1
    v_or_b32_sdwa v68, v73, v72 dst_sel:DWORD dst_unused:UNUSED_PAD src0_sel:DWORD src1_sel:WORD_0
    v_perm_b32 v72, v49, v48, s75
    v_lshrrev_b32 v73, 3, v72
    v_and_b32 v72, 0x07070707, v72
    v_and_b32 v4, 0x03030303, v73
    v_perm_b32 v20, v55, v54, v72
    v_add_u32 v27, v54, v20

    s_waitcnt lgkmcnt(1)
    v_and_b32 v72, s67, v50
    v_and_b32 v73, s67, v51
    v_lshl_or_b32 v72, v73, 10, v72
    v_lshlrev_b32_sdwa v73, 5, v72 dst_sel:DWORD dst_unused:UNUSED_PAD src0_sel:DWORD src1_sel:WORD_1
    v_or_b32_sdwa v69, v73, v72 dst_sel:DWORD dst_unused:UNUSED_PAD src0_sel:DWORD src1_sel:WORD_0
    v_perm_b32 v72, v51, v50, s75
    v_lshrrev_b32 v73, 3, v72
    v_and_b32 v72, 0x07070707, v72
    v_and_b32 v5, 0x03030303, v73
    v_perm_b32 v21, v55, v54, v72
    v_add_u32 v28, v54, v21

    s_waitcnt lgkmcnt(0)
    v_and_b32 v72, s67, v52
    v_and_b32 v73, s67, v53
    v_lshl_or_b32 v72, v73, 10, v72
    v_lshlrev_b32_sdwa v73, 5, v72 dst_sel:DWORD dst_unused:UNUSED_PAD src0_sel:DWORD src1_sel:WORD_1
    v_or_b32_sdwa v70, v73, v72 dst_sel:DWORD dst_unused:UNUSED_PAD src0_sel:DWORD src1_sel:WORD_0
    v_perm_b32 v72, v53, v52, s75
    v_lshrrev_b32 v73, 3, v72
    v_and_b32 v72, 0x07070707, v72
    v_and_b32 v6, 0x03030303, v73
    v_perm_b32 v22, v55, v54, v72
    v_add_u32 v29, v54, v22

    ds_write_b32 v86, v13
    v_lshrrev_b32 v71, 4, v71
    v_or_b32 v71, 0xf00, v71
    v_lshlrev_b32 v74, 22, v64
    v_lshrrev_b32 v75, 10, v64
    v_lshl_or_b32 v75, v65, 10, v75

    v_ffbl_b32 v84, v71
    v_mul_u32_u24 v72, 5, v84
    v_lshrrev_b64 v[72:73], v72, v[74:75]
    v_and_or_b32 v72, v72, s66, v85
    ds_add_rtn_u32 v87, v72, v10
    ds_wrxchg_rtn_b32 v116, v86, v13
    v_and_b32 v117, 15, v71
    v_bcnt_u32_b32 v118, v117, 0
    v_cmp_eq_u32 vcc, 4, v118

    s_mov_b64 exec, s[4:5]
    buffer_load_dwordx4 v[104:107], v7, s[20:23], s44 offen
    s_mov_b64 exec, -1

    v_cndmask_b32 v119, v71, v117, vcc
    s_waitcnt lgkmcnt(0)
    v_cmp_gt_u32 s[68:69], 2, v116
    v_cmp_gt_u32 s[70:71], 2, v87

    s_nop 0
    v_lshrrev_b64 v[76:77], v123, s[68:69]
    v_perm_b32 v121, v76, v76, v1
    v_perm_b32 v122, v76, v76, v0
    v_and_b32 v121, v121, v17
    v_and_b32 v122, v122, v16
    v_msad_u8 v120, v24, v121, 0
    v_lshlrev_b32 v120, 4, v120
    v_msad_u8 v120, v23, v122, v120
    v_lshlrev_b32 v120, 4, v120

    v_and_b32 v120, v120, v119
    v_cmp_eq_u32 vcc, 0, v120
    v_ffbl_b32 v118, v120
    s_or_b64 vcc, vcc, s[70:71]
    v_cndmask_b32 v118, v118, v84, vcc
    v_lshlrev_b32 v72, v118, v10
    v_lshl_add_u32 v73, v118, 1, v31
    v_xor_b32 v71, v71, v72

    v_subrev_u32 v73, 8, v73
    ds_read_u16 v80, v73 offset:0

    v_ffbl_b32 v84, v71
    v_mul_u32_u24 v72, 5, v84
    v_lshrrev_b64 v[72:73], v72, v[74:75]
    v_and_or_b32 v72, v72, s66, v85
    ds_add_rtn_u32 v87, v72, v10
    ds_wrxchg_rtn_b32 v116, v86, v13
    v_and_b32 v117, 15, v71
    v_bcnt_u32_b32 v118, v117, 0
    v_cmp_eq_u32 vcc, 3, v118

    s_lshl_b32 s45, s2, 8
    s_add_u32 s45, s45, 14680064
    buffer_store_dword v13, v13, s[12:15], s45 offen sc1
    buffer_load_dwordx4 v[128:131], v9, s[28:31], s77 offen offset:0
    buffer_load_dwordx4 v[132:135], v9, s[28:31], s77 offen offset:1024

    v_cndmask_b32 v119, v71, v117, vcc
    s_waitcnt lgkmcnt(0)
    v_cmp_gt_u32 s[68:69], 2, v116
    v_cmp_gt_u32 s[70:71], 2, v87

    s_nop 0
    v_lshrrev_b64 v[76:77], v123, s[68:69]
    v_perm_b32 v121, v76, v76, v1
    v_perm_b32 v122, v76, v76, v0
    v_and_b32 v121, v121, v17
    v_and_b32 v122, v122, v16
    v_msad_u8 v120, v24, v121, 0
    v_lshlrev_b32 v120, 4, v120
    v_msad_u8 v120, v23, v122, v120
    v_lshlrev_b32 v120, 4, v120

    v_and_b32 v120, v120, v119
    v_cmp_eq_u32 vcc, 0, v120
    v_ffbl_b32 v118, v120
    s_or_b64 vcc, vcc, s[70:71]
    v_cndmask_b32 v118, v118, v84, vcc
    v_lshlrev_b32 v72, v118, v10
    v_lshl_add_u32 v73, v118, 1, v31
    v_xor_b32 v71, v71, v72

    v_subrev_u32 v73, 8, v73
    ds_read_u16 v81, v73 offset:0

    v_ffbl_b32 v84, v71
    v_mul_u32_u24 v72, 5, v84
    v_lshrrev_b64 v[72:73], v72, v[74:75]
    v_and_or_b32 v72, v72, s66, v85
    ds_add_rtn_u32 v87, v72, v10
    ds_wrxchg_rtn_b32 v116, v86, v13
    v_and_b32 v117, 15, v71
    v_bcnt_u32_b32 v118, v117, 0
    v_cmp_eq_u32 vcc, 2, v118

    buffer_load_dwordx4 v[136:139], v9, s[28:31], s77 offen offset:2048
    buffer_load_dwordx4 v[140:143], v9, s[28:31], s77 offen offset:3072
    s_add_u32 s77, s77, 4096

    v_cndmask_b32 v119, v71, v117, vcc
    s_waitcnt lgkmcnt(0)
    v_cmp_gt_u32 s[68:69], 2, v116
    v_cmp_gt_u32 s[70:71], 2, v87

    s_nop 0
    v_lshrrev_b64 v[76:77], v123, s[68:69]
    v_perm_b32 v121, v76, v76, v1
    v_perm_b32 v122, v76, v76, v0
    v_and_b32 v121, v121, v17
    v_and_b32 v122, v122, v16
    v_msad_u8 v120, v24, v121, 0
    v_lshlrev_b32 v120, 4, v120
    v_msad_u8 v120, v23, v122, v120
    v_lshlrev_b32 v120, 4, v120

    v_and_b32 v120, v120, v119
    v_cmp_eq_u32 vcc, 0, v120
    v_ffbl_b32 v118, v120
    s_or_b64 vcc, vcc, s[70:71]
    v_cndmask_b32 v118, v118, v84, vcc
    v_lshlrev_b32 v72, v118, v10
    v_lshl_add_u32 v73, v118, 1, v31
    v_xor_b32 v71, v71, v72

    v_subrev_u32 v73, 8, v73
    ds_read_u16 v82, v73 offset:0
    s_setprio 0

    v_ffbl_b32 v84, v71
    v_mul_u32_u24 v72, 5, v84
    v_lshrrev_b64 v[72:73], v72, v[74:75]
    v_and_or_b32 v72, v72, s66, v85
    ds_add_rtn_u32 v87, v72, v10
    ds_wrxchg_rtn_b32 v116, v86, v13
    v_and_b32 v117, 15, v71
    v_bcnt_u32_b32 v118, v117, 0
    v_cmp_eq_u32 vcc, 1, v118

    buffer_load_dwordx4 v[144:147], v9, s[28:31], s77 offen offset:0
    buffer_load_dwordx4 v[148:151], v9, s[28:31], s77 offen offset:1024

    v_cndmask_b32 v119, v71, v117, vcc
    s_waitcnt lgkmcnt(0)
    v_cmp_gt_u32 s[68:69], 2, v116
    v_cmp_gt_u32 s[70:71], 2, v87

    s_nop 0
    v_lshrrev_b64 v[76:77], v123, s[68:69]
    v_perm_b32 v121, v76, v76, v1
    v_perm_b32 v122, v76, v76, v0
    v_and_b32 v121, v121, v17
    v_and_b32 v122, v122, v16
    v_msad_u8 v120, v24, v121, 0
    v_lshlrev_b32 v120, 4, v120
    v_msad_u8 v120, v23, v122, v120
    v_lshlrev_b32 v120, 4, v120

    v_and_b32 v120, v120, v119
    v_cmp_eq_u32 vcc, 0, v120
    v_ffbl_b32 v118, v120
    s_or_b64 vcc, vcc, s[70:71]
    v_cndmask_b32 v118, v118, v84, vcc
    v_lshlrev_b32 v72, v118, v10
    v_lshl_add_u32 v73, v118, 1, v31
    v_xor_b32 v71, v71, v72

    v_subrev_u32 v73, 8, v73
    ds_read_u16 v83, v73 offset:0
    v_lshrrev_b32 v71, 4, v71
    v_or_b32 v71, 0xf00, v71
    v_lshlrev_b32 v74, 22, v65
    v_lshl_or_b32 v74, v64, 2, v74
    v_lshrrev_b32 v75, 10, v65
    v_lshl_or_b32 v75, v66, 10, v75
    s_setprio 1

    v_ffbl_b32 v84, v71
    v_mul_u32_u24 v72, 5, v84
    v_lshrrev_b64 v[72:73], v72, v[74:75]
    v_and_or_b32 v72, v72, s66, v85
    ds_add_rtn_u32 v87, v72, v10
    ds_wrxchg_rtn_b32 v116, v86, v13
    v_and_b32 v117, 15, v71
    v_bcnt_u32_b32 v118, v117, 0
    v_cmp_eq_u32 vcc, 4, v118

    buffer_load_dwordx4 v[152:155], v9, s[28:31], s77 offen offset:2048
    buffer_load_dwordx4 v[156:159], v9, s[28:31], s77 offen offset:3072
    s_add_u32 s77, s77, 126976

    v_cndmask_b32 v119, v71, v117, vcc
    s_waitcnt lgkmcnt(0)
    v_cmp_gt_u32 s[68:69], 2, v116
    v_cmp_gt_u32 s[70:71], 2, v87

    v_lshl_or_b32 v78, v81, 16, v80
    v_lshl_or_b32 v79, v83, 16, v82
    buffer_store_dwordx2 v[78:79], v30, s[32:35], s62 offen sc1
    s_add_u32 s62, s62, 65536
    v_lshrrev_b64 v[76:77], v123, s[68:69]
    v_perm_b32 v121, v76, v76, v2
    v_perm_b32 v122, v76, v76, v1
    v_perm_b32 v77, v76, v76, v0
    v_and_b32 v121, v121, v18
    v_and_b32 v122, v122, v17
    v_and_b32 v77, v77, v16
    v_msad_u8 v120, v25, v121, 0
    v_lshlrev_b32 v120, 4, v120
    v_msad_u8 v120, v24, v122, v120
    v_lshlrev_b32 v120, 4, v120
    v_msad_u8 v120, v23, v77, v120

    v_and_b32 v120, v120, v119
    v_cmp_eq_u32 vcc, 0, v120
    v_ffbl_b32 v118, v120
    s_or_b64 vcc, vcc, s[70:71]
    v_cndmask_b32 v118, v118, v84, vcc
    v_lshlrev_b32 v72, v118, v10
    v_lshl_add_u32 v73, v118, 1, v31
    v_xor_b32 v71, v71, v72

    ds_read_u16 v80, v73 offset:0

    v_ffbl_b32 v84, v71
    v_mul_u32_u24 v72, 5, v84
    v_lshrrev_b64 v[72:73], v72, v[74:75]
    v_and_or_b32 v72, v72, s66, v85
    ds_add_rtn_u32 v87, v72, v10
    ds_wrxchg_rtn_b32 v116, v86, v13
    v_and_b32 v117, 15, v71
    v_bcnt_u32_b32 v118, v117, 0
    v_cmp_eq_u32 vcc, 3, v118

    s_waitcnt vmcnt(10)
    s_mov_b64 exec, s[4:5]
    buffer_store_dwordx4 v[104:107], v9, s[32:35], s47 offen sc1
    s_mov_b64 exec, -1
    buffer_load_dwordx4 v[160:163], v9, s[28:31], s77 offen offset:0
    buffer_load_dwordx4 v[164:167], v9, s[28:31], s77 offen offset:1024

    v_cndmask_b32 v119, v71, v117, vcc
    s_waitcnt lgkmcnt(0)
    v_cmp_gt_u32 s[68:69], 2, v116
    v_cmp_gt_u32 s[70:71], 2, v87

    s_nop 0
    v_lshrrev_b64 v[76:77], v123, s[68:69]
    v_perm_b32 v121, v76, v76, v2
    v_perm_b32 v122, v76, v76, v1
    v_perm_b32 v77, v76, v76, v0
    v_and_b32 v121, v121, v18
    v_and_b32 v122, v122, v17
    v_and_b32 v77, v77, v16
    v_msad_u8 v120, v25, v121, 0
    v_lshlrev_b32 v120, 4, v120
    v_msad_u8 v120, v24, v122, v120
    v_lshlrev_b32 v120, 4, v120
    v_msad_u8 v120, v23, v77, v120

    v_and_b32 v120, v120, v119
    v_cmp_eq_u32 vcc, 0, v120
    v_ffbl_b32 v118, v120
    s_or_b64 vcc, vcc, s[70:71]
    v_cndmask_b32 v118, v118, v84, vcc
    v_lshlrev_b32 v72, v118, v10
    v_lshl_add_u32 v73, v118, 1, v31
    v_xor_b32 v71, v71, v72

    ds_read_u16 v81, v73 offset:0

    v_ffbl_b32 v84, v71
    v_mul_u32_u24 v72, 5, v84
    v_lshrrev_b64 v[72:73], v72, v[74:75]
    v_and_or_b32 v72, v72, s66, v85
    ds_add_rtn_u32 v87, v72, v10
    ds_wrxchg_rtn_b32 v116, v86, v13
    v_and_b32 v117, 15, v71
    v_bcnt_u32_b32 v118, v117, 0
    v_cmp_eq_u32 vcc, 2, v118

    buffer_load_dwordx4 v[168:171], v9, s[28:31], s77 offen offset:2048
    buffer_load_dwordx4 v[172:175], v9, s[28:31], s77 offen offset:3072
    s_add_u32 s77, s77, 4096

    v_cndmask_b32 v119, v71, v117, vcc
    s_waitcnt lgkmcnt(0)
    v_cmp_gt_u32 s[68:69], 2, v116
    v_cmp_gt_u32 s[70:71], 2, v87

    s_nop 0
    v_lshrrev_b64 v[76:77], v123, s[68:69]
    v_perm_b32 v121, v76, v76, v2
    v_perm_b32 v122, v76, v76, v1
    v_perm_b32 v77, v76, v76, v0
    v_and_b32 v121, v121, v18
    v_and_b32 v122, v122, v17
    v_and_b32 v77, v77, v16
    v_msad_u8 v120, v25, v121, 0
    v_lshlrev_b32 v120, 4, v120
    v_msad_u8 v120, v24, v122, v120
    v_lshlrev_b32 v120, 4, v120
    v_msad_u8 v120, v23, v77, v120

    v_and_b32 v120, v120, v119
    v_cmp_eq_u32 vcc, 0, v120
    v_ffbl_b32 v118, v120
    s_or_b64 vcc, vcc, s[70:71]
    v_cndmask_b32 v118, v118, v84, vcc
    v_lshlrev_b32 v72, v118, v10
    v_lshl_add_u32 v73, v118, 1, v31
    v_xor_b32 v71, v71, v72

    ds_read_u16 v82, v73 offset:0
    s_setprio 0

    v_ffbl_b32 v84, v71
    v_mul_u32_u24 v72, 5, v84
    v_lshrrev_b64 v[72:73], v72, v[74:75]
    v_and_or_b32 v72, v72, s66, v85
    ds_add_rtn_u32 v87, v72, v10
    ds_wrxchg_rtn_b32 v116, v86, v13
    v_and_b32 v117, 15, v71
    v_bcnt_u32_b32 v118, v117, 0
    v_cmp_eq_u32 vcc, 1, v118

    buffer_load_dwordx4 v[176:179], v9, s[28:31], s77 offen offset:0
    buffer_load_dwordx4 v[180:183], v9, s[28:31], s77 offen offset:1024

    v_cndmask_b32 v119, v71, v117, vcc
    s_waitcnt lgkmcnt(0)
    v_cmp_gt_u32 s[68:69], 2, v116
    v_cmp_gt_u32 s[70:71], 2, v87

    s_nop 0
    v_lshrrev_b64 v[76:77], v123, s[68:69]
    v_perm_b32 v121, v76, v76, v2
    v_perm_b32 v122, v76, v76, v1
    v_perm_b32 v77, v76, v76, v0
    v_and_b32 v121, v121, v18
    v_and_b32 v122, v122, v17
    v_and_b32 v77, v77, v16
    v_msad_u8 v120, v25, v121, 0
    v_lshlrev_b32 v120, 4, v120
    v_msad_u8 v120, v24, v122, v120
    v_lshlrev_b32 v120, 4, v120
    v_msad_u8 v120, v23, v77, v120

    v_and_b32 v120, v120, v119
    v_cmp_eq_u32 vcc, 0, v120
    v_ffbl_b32 v118, v120
    s_or_b64 vcc, vcc, s[70:71]
    v_cndmask_b32 v118, v118, v84, vcc
    v_lshlrev_b32 v72, v118, v10
    v_lshl_add_u32 v73, v118, 1, v31
    v_xor_b32 v71, v71, v72

    ds_read_u16 v83, v73 offset:0
    v_lshrrev_b32 v71, 4, v71
    v_or_b32 v71, 0xf00, v71
    v_lshlrev_b32 v74, 22, v66
    v_lshl_or_b32 v74, v65, 2, v74
    v_lshrrev_b32 v75, 10, v66
    v_lshl_or_b32 v75, v67, 10, v75
    s_setprio 1

    v_ffbl_b32 v84, v71
    v_mul_u32_u24 v72, 5, v84
    v_lshrrev_b64 v[72:73], v72, v[74:75]
    v_and_or_b32 v72, v72, s66, v85
    ds_add_rtn_u32 v87, v72, v10
    ds_wrxchg_rtn_b32 v116, v86, v13
    v_and_b32 v117, 15, v71
    v_bcnt_u32_b32 v118, v117, 0
    v_cmp_eq_u32 vcc, 4, v118

    buffer_load_dwordx4 v[184:187], v9, s[28:31], s77 offen offset:2048
    buffer_load_dwordx4 v[188:191], v9, s[28:31], s77 offen offset:3072

    v_cndmask_b32 v119, v71, v117, vcc
    s_waitcnt lgkmcnt(0)
    v_cmp_gt_u32 s[68:69], 2, v116
    v_cmp_gt_u32 s[70:71], 2, v87

    v_lshl_or_b32 v78, v81, 16, v80
    v_lshl_or_b32 v79, v83, 16, v82
    buffer_store_dwordx2 v[78:79], v30, s[32:35], s62 offen sc1
    s_add_u32 s62, s62, 65536
    v_lshrrev_b64 v[76:77], v123, s[68:69]
    v_perm_b32 v121, v76, v76, v3
    v_perm_b32 v122, v76, v76, v2
    v_perm_b32 v77, v76, v76, v1
    v_and_b32 v121, v121, v19
    v_and_b32 v122, v122, v18
    v_and_b32 v77, v77, v17
    v_msad_u8 v120, v26, v121, 0
    v_lshlrev_b32 v120, 4, v120
    v_msad_u8 v120, v25, v122, v120
    v_lshlrev_b32 v120, 4, v120
    v_msad_u8 v120, v24, v77, v120

    v_and_b32 v120, v120, v119
    v_cmp_eq_u32 vcc, 0, v120
    v_ffbl_b32 v118, v120
    s_or_b64 vcc, vcc, s[70:71]
    v_cndmask_b32 v118, v118, v84, vcc
    v_lshlrev_b32 v72, v118, v10
    v_lshl_add_u32 v73, v118, 1, v31
    v_xor_b32 v71, v71, v72

    ds_read_u16 v80, v73 offset:8

    v_ffbl_b32 v84, v71
    v_mul_u32_u24 v72, 5, v84
    v_lshrrev_b64 v[72:73], v72, v[74:75]
    v_and_or_b32 v72, v72, s66, v85
    ds_add_rtn_u32 v87, v72, v10
    ds_wrxchg_rtn_b32 v116, v86, v13
    v_and_b32 v117, 15, v71
    v_bcnt_u32_b32 v118, v117, 0
    v_cmp_eq_u32 vcc, 3, v118

    buffer_store_dwordx4 v[108:111], v9, s[12:15], s6 offen offset:0 sc1
    buffer_store_dwordx4 v[108:111], v9, s[12:15], s6 offen offset:1024 sc1

    v_cndmask_b32 v119, v71, v117, vcc
    s_waitcnt lgkmcnt(0)
    v_cmp_gt_u32 s[68:69], 2, v116
    v_cmp_gt_u32 s[70:71], 2, v87

    s_nop 0
    v_lshrrev_b64 v[76:77], v123, s[68:69]
    v_perm_b32 v121, v76, v76, v3
    v_perm_b32 v122, v76, v76, v2
    v_perm_b32 v77, v76, v76, v1
    v_and_b32 v121, v121, v19
    v_and_b32 v122, v122, v18
    v_and_b32 v77, v77, v17
    v_msad_u8 v120, v26, v121, 0
    v_lshlrev_b32 v120, 4, v120
    v_msad_u8 v120, v25, v122, v120
    v_lshlrev_b32 v120, 4, v120
    v_msad_u8 v120, v24, v77, v120

    v_and_b32 v120, v120, v119
    v_cmp_eq_u32 vcc, 0, v120
    v_ffbl_b32 v118, v120
    s_or_b64 vcc, vcc, s[70:71]
    v_cndmask_b32 v118, v118, v84, vcc
    v_lshlrev_b32 v72, v118, v10
    v_lshl_add_u32 v73, v118, 1, v31
    v_xor_b32 v71, v71, v72

    ds_read_u16 v81, v73 offset:8

    v_ffbl_b32 v84, v71
    v_mul_u32_u24 v72, 5, v84
    v_lshrrev_b64 v[72:73], v72, v[74:75]
    v_and_or_b32 v72, v72, s66, v85
    ds_add_rtn_u32 v87, v72, v10
    ds_wrxchg_rtn_b32 v116, v86, v13
    v_and_b32 v117, 15, v71
    v_bcnt_u32_b32 v118, v117, 0
    v_cmp_eq_u32 vcc, 2, v118

    buffer_store_dwordx4 v[108:111], v9, s[12:15], s6 offen offset:2048 sc1
    buffer_store_dwordx4 v[108:111], v9, s[12:15], s6 offen offset:3072 sc1

    v_cndmask_b32 v119, v71, v117, vcc
    s_waitcnt lgkmcnt(0)
    v_cmp_gt_u32 s[68:69], 2, v116
    v_cmp_gt_u32 s[70:71], 2, v87

    s_nop 0
    v_lshrrev_b64 v[76:77], v123, s[68:69]
    v_perm_b32 v121, v76, v76, v3
    v_perm_b32 v122, v76, v76, v2
    v_perm_b32 v77, v76, v76, v1
    v_and_b32 v121, v121, v19
    v_and_b32 v122, v122, v18
    v_and_b32 v77, v77, v17
    v_msad_u8 v120, v26, v121, 0
    v_lshlrev_b32 v120, 4, v120
    v_msad_u8 v120, v25, v122, v120
    v_lshlrev_b32 v120, 4, v120
    v_msad_u8 v120, v24, v77, v120

    v_and_b32 v120, v120, v119
    v_cmp_eq_u32 vcc, 0, v120
    v_ffbl_b32 v118, v120
    s_or_b64 vcc, vcc, s[70:71]
    v_cndmask_b32 v118, v118, v84, vcc
    v_lshlrev_b32 v72, v118, v10
    v_lshl_add_u32 v73, v118, 1, v31
    v_xor_b32 v71, v71, v72

    ds_read_u16 v82, v73 offset:8
    s_setprio 0

    v_ffbl_b32 v84, v71
    v_mul_u32_u24 v72, 5, v84
    v_lshrrev_b64 v[72:73], v72, v[74:75]
    v_and_or_b32 v72, v72, s66, v85
    ds_add_rtn_u32 v87, v72, v10
    ds_wrxchg_rtn_b32 v116, v86, v13
    v_and_b32 v117, 15, v71
    v_bcnt_u32_b32 v118, v117, 0
    v_cmp_eq_u32 vcc, 1, v118

    buffer_store_dwordx4 v[108:111], v9, s[12:15], s7 offen offset:0 sc1
    buffer_store_dwordx4 v[108:111], v9, s[12:15], s7 offen offset:1024 sc1

    v_cndmask_b32 v119, v71, v117, vcc
    s_waitcnt lgkmcnt(0)
    v_cmp_gt_u32 s[68:69], 2, v116
    v_cmp_gt_u32 s[70:71], 2, v87

    s_nop 0
    v_lshrrev_b64 v[76:77], v123, s[68:69]
    v_perm_b32 v121, v76, v76, v3
    v_perm_b32 v122, v76, v76, v2
    v_perm_b32 v77, v76, v76, v1
    v_and_b32 v121, v121, v19
    v_and_b32 v122, v122, v18
    v_and_b32 v77, v77, v17
    v_msad_u8 v120, v26, v121, 0
    v_lshlrev_b32 v120, 4, v120
    v_msad_u8 v120, v25, v122, v120
    v_lshlrev_b32 v120, 4, v120
    v_msad_u8 v120, v24, v77, v120

    v_and_b32 v120, v120, v119
    v_cmp_eq_u32 vcc, 0, v120
    v_ffbl_b32 v118, v120
    s_or_b64 vcc, vcc, s[70:71]
    v_cndmask_b32 v118, v118, v84, vcc
    v_lshlrev_b32 v72, v118, v10
    v_lshl_add_u32 v73, v118, 1, v31
    v_xor_b32 v71, v71, v72

    ds_read_u16 v83, v73 offset:8
    v_lshrrev_b32 v71, 4, v71
    v_or_b32 v71, 0xf00, v71
    v_lshlrev_b32 v74, 22, v67
    v_lshl_or_b32 v74, v66, 2, v74
    v_lshrrev_b32 v75, 10, v67
    v_lshl_or_b32 v75, v68, 10, v75
    s_setprio 1

    v_ffbl_b32 v84, v71
    v_mul_u32_u24 v72, 5, v84
    v_lshrrev_b64 v[72:73], v72, v[74:75]
    v_and_or_b32 v72, v72, s66, v85
    ds_add_rtn_u32 v87, v72, v10
    ds_wrxchg_rtn_b32 v116, v86, v13
    v_and_b32 v117, 15, v71
    v_bcnt_u32_b32 v118, v117, 0
    v_cmp_eq_u32 vcc, 4, v118

    buffer_store_dwordx4 v[108:111], v9, s[12:15], s7 offen offset:2048 sc1
    buffer_store_dwordx4 v[108:111], v9, s[12:15], s7 offen offset:3072 sc1

    v_cndmask_b32 v119, v71, v117, vcc
    s_waitcnt lgkmcnt(0)
    v_cmp_gt_u32 s[68:69], 2, v116
    v_cmp_gt_u32 s[70:71], 2, v87

    v_lshl_or_b32 v78, v81, 16, v80
    v_lshl_or_b32 v79, v83, 16, v82
    buffer_store_dwordx2 v[78:79], v30, s[32:35], s62 offen sc1
    s_add_u32 s62, s62, 65536
    v_lshrrev_b64 v[76:77], v123, s[68:69]
    v_perm_b32 v121, v76, v76, v4
    v_perm_b32 v122, v76, v76, v3
    v_perm_b32 v77, v76, v76, v2
    v_and_b32 v121, v121, v20
    v_and_b32 v122, v122, v19
    v_and_b32 v77, v77, v18
    v_msad_u8 v120, v27, v121, 0
    v_lshlrev_b32 v120, 4, v120
    v_msad_u8 v120, v26, v122, v120
    v_lshlrev_b32 v120, 4, v120
    v_msad_u8 v120, v25, v77, v120

    v_and_b32 v120, v120, v119
    v_cmp_eq_u32 vcc, 0, v120
    v_ffbl_b32 v118, v120
    s_or_b64 vcc, vcc, s[70:71]
    v_cndmask_b32 v118, v118, v84, vcc
    v_lshlrev_b32 v72, v118, v10
    v_lshl_add_u32 v73, v118, 1, v31
    v_xor_b32 v71, v71, v72

    ds_read_u16 v80, v73 offset:16

    v_ffbl_b32 v84, v71
    v_mul_u32_u24 v72, 5, v84
    v_lshrrev_b64 v[72:73], v72, v[74:75]
    v_and_or_b32 v72, v72, s66, v85
    ds_add_rtn_u32 v87, v72, v10
    ds_wrxchg_rtn_b32 v116, v86, v13
    v_and_b32 v117, 15, v71
    v_bcnt_u32_b32 v118, v117, 0
    v_cmp_eq_u32 vcc, 3, v118

    buffer_store_dwordx2 v[108:109], v30, s[12:15], s8 offen sc1

    v_cndmask_b32 v119, v71, v117, vcc
    s_waitcnt lgkmcnt(0)
    v_cmp_gt_u32 s[68:69], 2, v116
    v_cmp_gt_u32 s[70:71], 2, v87

    s_nop 0
    v_lshrrev_b64 v[76:77], v123, s[68:69]
    v_perm_b32 v121, v76, v76, v4
    v_perm_b32 v122, v76, v76, v3
    v_perm_b32 v77, v76, v76, v2
    v_and_b32 v121, v121, v20
    v_and_b32 v122, v122, v19
    v_and_b32 v77, v77, v18
    v_msad_u8 v120, v27, v121, 0
    v_lshlrev_b32 v120, 4, v120
    v_msad_u8 v120, v26, v122, v120
    v_lshlrev_b32 v120, 4, v120
    v_msad_u8 v120, v25, v77, v120

    v_and_b32 v120, v120, v119
    v_cmp_eq_u32 vcc, 0, v120
    v_ffbl_b32 v118, v120
    s_or_b64 vcc, vcc, s[70:71]
    v_cndmask_b32 v118, v118, v84, vcc
    v_lshlrev_b32 v72, v118, v10
    v_lshl_add_u32 v73, v118, 1, v31
    v_xor_b32 v71, v71, v72

    ds_read_u16 v81, v73 offset:16

    s_cmp_ge_u32 s57, 800
    s_cbranch_scc1 standalone__deep_cross_pnn__recsys_kernel_norl
    s_waitcnt vmcnt(0)

    v_perm_b32 v88, v132, v128, s84
    v_perm_b32 v89, v140, v136, s84
    v_perm_b32 v90, v148, v144, s84
    v_perm_b32 v91, v156, v152, s84
    v_perm_b32 v92, v132, v128, s85
    v_perm_b32 v93, v140, v136, s85
    v_perm_b32 v94, v148, v144, s85
    v_perm_b32 v95, v156, v152, s85
    v_perm_b32 v96, v133, v129, s84
    v_perm_b32 v97, v141, v137, s84
    v_perm_b32 v98, v149, v145, s84
    v_perm_b32 v99, v157, v153, s84
    v_perm_b32 v100, v133, v129, s85
    v_perm_b32 v101, v141, v137, s85
    v_perm_b32 v102, v149, v145, s85
    v_perm_b32 v103, v157, v153, s85
    ds_write_b128 v36, v[88:91]
    ds_write_b128 v37, v[92:95]
    ds_write_b128 v38, v[96:99]
    ds_write_b128 v39, v[100:103]
    ds_read_b128 v[192:195], v15 offset:0
    ds_read_b128 v[196:199], v15 offset:1024
    ds_read_b128 v[200:203], v15 offset:2048
    ds_read_b128 v[204:207], v15 offset:3072
    s_waitcnt lgkmcnt(4)
    v_perm_b32 v88, v164, v160, s84
    v_perm_b32 v89, v172, v168, s84
    v_perm_b32 v90, v180, v176, s84
    v_perm_b32 v91, v188, v184, s84
    v_perm_b32 v92, v164, v160, s85
    v_perm_b32 v93, v172, v168, s85
    v_perm_b32 v94, v180, v176, s85
    v_perm_b32 v95, v188, v184, s85
    v_perm_b32 v96, v165, v161, s84
    v_perm_b32 v97, v173, v169, s84
    v_perm_b32 v98, v181, v177, s84
    v_perm_b32 v99, v189, v185, s84
    v_perm_b32 v100, v165, v161, s85
    v_perm_b32 v101, v173, v169, s85
    v_perm_b32 v102, v181, v177, s85
    v_perm_b32 v103, v189, v185, s85
    ds_write_b128 v36, v[88:91]
    ds_write_b128 v37, v[92:95]
    ds_write_b128 v38, v[96:99]
    ds_write_b128 v39, v[100:103]
    ds_read_b128 v[208:211], v15 offset:0
    ds_read_b128 v[212:215], v15 offset:1024
    ds_read_b128 v[216:219], v15 offset:2048
    ds_read_b128 v[220:223], v15 offset:3072
    s_waitcnt lgkmcnt(4)
    v_perm_b32 v88, v134, v130, s84
    v_perm_b32 v89, v142, v138, s84
    v_perm_b32 v90, v150, v146, s84
    v_perm_b32 v91, v158, v154, s84
    v_perm_b32 v92, v134, v130, s85
    v_perm_b32 v93, v142, v138, s85
    v_perm_b32 v94, v150, v146, s85
    v_perm_b32 v95, v158, v154, s85
    v_perm_b32 v96, v135, v131, s84
    v_perm_b32 v97, v143, v139, s84
    v_perm_b32 v98, v151, v147, s84
    v_perm_b32 v99, v159, v155, s84
    v_perm_b32 v100, v135, v131, s85
    v_perm_b32 v101, v143, v139, s85
    v_perm_b32 v102, v151, v147, s85
    v_perm_b32 v103, v159, v155, s85
    ds_write_b128 v36, v[88:91]
    ds_write_b128 v37, v[92:95]
    ds_write_b128 v38, v[96:99]
    ds_write_b128 v39, v[100:103]
    ds_read_b128 v[224:227], v15 offset:0
    ds_read_b128 v[228:231], v15 offset:1024
    ds_read_b128 v[232:235], v15 offset:2048
    ds_read_b128 v[236:239], v15 offset:3072
    s_waitcnt lgkmcnt(4)
    v_perm_b32 v88, v166, v162, s84
    v_perm_b32 v89, v174, v170, s84
    v_perm_b32 v90, v182, v178, s84
    v_perm_b32 v91, v190, v186, s84
    v_perm_b32 v92, v166, v162, s85
    v_perm_b32 v93, v174, v170, s85
    v_perm_b32 v94, v182, v178, s85
    v_perm_b32 v95, v190, v186, s85
    v_perm_b32 v96, v167, v163, s84
    v_perm_b32 v97, v175, v171, s84
    v_perm_b32 v98, v183, v179, s84
    v_perm_b32 v99, v191, v187, s84
    v_perm_b32 v100, v167, v163, s85
    v_perm_b32 v101, v175, v171, s85
    v_perm_b32 v102, v183, v179, s85
    v_perm_b32 v103, v191, v187, s85
    ds_write_b128 v36, v[88:91]
    ds_write_b128 v37, v[92:95]
    ds_write_b128 v38, v[96:99]
    ds_write_b128 v39, v[100:103]
    ds_read_b128 v[240:243], v15 offset:0
    ds_read_b128 v[244:247], v15 offset:1024
    ds_read_b128 v[248:251], v15 offset:2048
    ds_read_b128 v[252:255], v15 offset:3072
    ds_write_b64 v31, v[40:41] offset:0
    ds_write_b64 v31, v[42:43] offset:8
    ds_write_b64 v31, v[44:45] offset:16
    ds_write_b64 v31, v[46:47] offset:24
    ds_write_b64 v31, v[48:49] offset:32
    ds_write_b64 v31, v[50:51] offset:40
    ds_write_b64 v31, v[52:53] offset:48
    s_waitcnt lgkmcnt(7)
standalone__deep_cross_pnn__recsys_kernel_norl:
standalone__deep_cross_pnn__recsys_kernel_rld:
    ds_write_b32 v86, v13

    v_ffbl_b32 v84, v71
    v_mul_u32_u24 v72, 5, v84
    v_lshrrev_b64 v[72:73], v72, v[74:75]
    v_and_or_b32 v72, v72, s66, v85
    ds_add_rtn_u32 v87, v72, v10
    ds_wrxchg_rtn_b32 v116, v86, v13
    v_and_b32 v117, 15, v71
    v_bcnt_u32_b32 v118, v117, 0
    v_cmp_eq_u32 vcc, 2, v118

    s_add_u32 s83, s82, 0
    buffer_store_dwordx4 v[192:195], v14, s[32:35], s83 offen sc1
    s_add_u32 s83, s82, 64
    buffer_store_dwordx4 v[208:211], v14, s[32:35], s83 offen sc1

    v_cndmask_b32 v119, v71, v117, vcc
    s_waitcnt lgkmcnt(0)
    v_cmp_gt_u32 s[68:69], 2, v116
    v_cmp_gt_u32 s[70:71], 2, v87

    s_nop 0
    v_lshrrev_b64 v[76:77], v123, s[68:69]
    v_perm_b32 v121, v76, v76, v4
    v_perm_b32 v122, v76, v76, v3
    v_perm_b32 v77, v76, v76, v2
    v_and_b32 v121, v121, v20
    v_and_b32 v122, v122, v19
    v_and_b32 v77, v77, v18
    v_msad_u8 v120, v27, v121, 0
    v_lshlrev_b32 v120, 4, v120
    v_msad_u8 v120, v26, v122, v120
    v_lshlrev_b32 v120, 4, v120
    v_msad_u8 v120, v25, v77, v120

    v_and_b32 v120, v120, v119
    v_cmp_eq_u32 vcc, 0, v120
    v_ffbl_b32 v118, v120
    s_or_b64 vcc, vcc, s[70:71]
    v_cndmask_b32 v118, v118, v84, vcc
    v_lshlrev_b32 v72, v118, v10
    v_lshl_add_u32 v73, v118, 1, v31
    v_xor_b32 v71, v71, v72

    ds_read_u16 v82, v73 offset:16
    s_setprio 0

    v_ffbl_b32 v84, v71
    v_mul_u32_u24 v72, 5, v84
    v_lshrrev_b64 v[72:73], v72, v[74:75]
    v_and_or_b32 v72, v72, s66, v85
    ds_add_rtn_u32 v87, v72, v10
    ds_wrxchg_rtn_b32 v116, v86, v13
    v_and_b32 v117, 15, v71
    v_bcnt_u32_b32 v118, v117, 0
    v_cmp_eq_u32 vcc, 1, v118

    s_add_u32 s83, s82, 3284992
    buffer_store_dwordx4 v[196:199], v14, s[32:35], s83 offen sc1
    s_add_u32 s83, s82, 3285056
    buffer_store_dwordx4 v[212:215], v14, s[32:35], s83 offen sc1

    v_cndmask_b32 v119, v71, v117, vcc
    s_waitcnt lgkmcnt(0)
    v_cmp_gt_u32 s[68:69], 2, v116
    v_cmp_gt_u32 s[70:71], 2, v87

    s_nop 0
    v_lshrrev_b64 v[76:77], v123, s[68:69]
    v_perm_b32 v121, v76, v76, v4
    v_perm_b32 v122, v76, v76, v3
    v_perm_b32 v77, v76, v76, v2
    v_and_b32 v121, v121, v20
    v_and_b32 v122, v122, v19
    v_and_b32 v77, v77, v18
    v_msad_u8 v120, v27, v121, 0
    v_lshlrev_b32 v120, 4, v120
    v_msad_u8 v120, v26, v122, v120
    v_lshlrev_b32 v120, 4, v120
    v_msad_u8 v120, v25, v77, v120

    v_and_b32 v120, v120, v119
    v_cmp_eq_u32 vcc, 0, v120
    v_ffbl_b32 v118, v120
    s_or_b64 vcc, vcc, s[70:71]
    v_cndmask_b32 v118, v118, v84, vcc
    v_lshlrev_b32 v72, v118, v10
    v_lshl_add_u32 v73, v118, 1, v31
    v_xor_b32 v71, v71, v72

    ds_read_u16 v83, v73 offset:16
    v_lshrrev_b32 v71, 4, v71
    v_or_b32 v71, 0xf00, v71
    v_lshlrev_b32 v74, 22, v68
    v_lshl_or_b32 v74, v67, 2, v74
    v_lshrrev_b32 v75, 10, v68
    v_lshl_or_b32 v75, v69, 10, v75
    s_setprio 1

    v_ffbl_b32 v84, v71
    v_mul_u32_u24 v72, 5, v84
    v_lshrrev_b64 v[72:73], v72, v[74:75]
    v_and_or_b32 v72, v72, s66, v85
    ds_add_rtn_u32 v87, v72, v10
    ds_wrxchg_rtn_b32 v116, v86, v13
    v_and_b32 v117, 15, v71
    v_bcnt_u32_b32 v118, v117, 0
    v_cmp_eq_u32 vcc, 4, v118

    s_add_u32 s83, s82, 6569984
    buffer_store_dwordx4 v[200:203], v14, s[32:35], s83 offen sc1
    s_add_u32 s83, s82, 6570048
    buffer_store_dwordx4 v[216:219], v14, s[32:35], s83 offen sc1

    v_cndmask_b32 v119, v71, v117, vcc
    s_waitcnt lgkmcnt(0)
    v_cmp_gt_u32 s[68:69], 2, v116
    v_cmp_gt_u32 s[70:71], 2, v87

    v_lshl_or_b32 v78, v81, 16, v80
    v_lshl_or_b32 v79, v83, 16, v82
    buffer_store_dwordx2 v[78:79], v30, s[32:35], s62 offen sc1
    s_add_u32 s62, s62, 65536
    v_lshrrev_b64 v[76:77], v123, s[68:69]
    v_perm_b32 v121, v76, v76, v5
    v_perm_b32 v122, v76, v76, v4
    v_perm_b32 v77, v76, v76, v3
    v_and_b32 v121, v121, v21
    v_and_b32 v122, v122, v20
    v_and_b32 v77, v77, v19
    v_msad_u8 v120, v28, v121, 0
    v_lshlrev_b32 v120, 4, v120
    v_msad_u8 v120, v27, v122, v120
    v_lshlrev_b32 v120, 4, v120
    v_msad_u8 v120, v26, v77, v120

    v_and_b32 v120, v120, v119
    v_cmp_eq_u32 vcc, 0, v120
    v_ffbl_b32 v118, v120
    s_or_b64 vcc, vcc, s[70:71]
    v_cndmask_b32 v118, v118, v84, vcc
    v_lshlrev_b32 v72, v118, v10
    v_lshl_add_u32 v73, v118, 1, v31
    v_xor_b32 v71, v71, v72

    ds_read_u16 v80, v73 offset:24

    v_ffbl_b32 v84, v71
    v_mul_u32_u24 v72, 5, v84
    v_lshrrev_b64 v[72:73], v72, v[74:75]
    v_and_or_b32 v72, v72, s66, v85
    ds_add_rtn_u32 v87, v72, v10
    ds_wrxchg_rtn_b32 v116, v86, v13
    v_and_b32 v117, 15, v71
    v_bcnt_u32_b32 v118, v117, 0
    v_cmp_eq_u32 vcc, 3, v118

    s_add_u32 s83, s82, 9854976
    buffer_store_dwordx4 v[204:207], v14, s[32:35], s83 offen sc1
    s_add_u32 s83, s82, 9855040
    buffer_store_dwordx4 v[220:223], v14, s[32:35], s83 offen sc1

    v_cndmask_b32 v119, v71, v117, vcc
    s_waitcnt lgkmcnt(0)
    v_cmp_gt_u32 s[68:69], 2, v116
    v_cmp_gt_u32 s[70:71], 2, v87

    s_nop 0
    v_lshrrev_b64 v[76:77], v123, s[68:69]
    v_perm_b32 v121, v76, v76, v5
    v_perm_b32 v122, v76, v76, v4
    v_perm_b32 v77, v76, v76, v3
    v_and_b32 v121, v121, v21
    v_and_b32 v122, v122, v20
    v_and_b32 v77, v77, v19
    v_msad_u8 v120, v28, v121, 0
    v_lshlrev_b32 v120, 4, v120
    v_msad_u8 v120, v27, v122, v120
    v_lshlrev_b32 v120, 4, v120
    v_msad_u8 v120, v26, v77, v120

    v_and_b32 v120, v120, v119
    v_cmp_eq_u32 vcc, 0, v120
    v_ffbl_b32 v118, v120
    s_or_b64 vcc, vcc, s[70:71]
    v_cndmask_b32 v118, v118, v84, vcc
    v_lshlrev_b32 v72, v118, v10
    v_lshl_add_u32 v73, v118, 1, v31
    v_xor_b32 v71, v71, v72

    ds_read_u16 v81, v73 offset:24

    v_ffbl_b32 v84, v71
    v_mul_u32_u24 v72, 5, v84
    v_lshrrev_b64 v[72:73], v72, v[74:75]
    v_and_or_b32 v72, v72, s66, v85
    ds_add_rtn_u32 v87, v72, v10
    ds_wrxchg_rtn_b32 v116, v86, v13
    v_and_b32 v117, 15, v71
    v_bcnt_u32_b32 v118, v117, 0
    v_cmp_eq_u32 vcc, 2, v118

    s_add_u32 s83, s82, 102656
    buffer_store_dwordx4 v[224:227], v14, s[32:35], s83 offen sc1
    s_add_u32 s83, s82, 102720
    buffer_store_dwordx4 v[240:243], v14, s[32:35], s83 offen sc1

    v_cndmask_b32 v119, v71, v117, vcc
    s_waitcnt lgkmcnt(0)
    v_cmp_gt_u32 s[68:69], 2, v116
    v_cmp_gt_u32 s[70:71], 2, v87

    s_nop 0
    v_lshrrev_b64 v[76:77], v123, s[68:69]
    v_perm_b32 v121, v76, v76, v5
    v_perm_b32 v122, v76, v76, v4
    v_perm_b32 v77, v76, v76, v3
    v_and_b32 v121, v121, v21
    v_and_b32 v122, v122, v20
    v_and_b32 v77, v77, v19
    v_msad_u8 v120, v28, v121, 0
    v_lshlrev_b32 v120, 4, v120
    v_msad_u8 v120, v27, v122, v120
    v_lshlrev_b32 v120, 4, v120
    v_msad_u8 v120, v26, v77, v120

    v_and_b32 v120, v120, v119
    v_cmp_eq_u32 vcc, 0, v120
    v_ffbl_b32 v118, v120
    s_or_b64 vcc, vcc, s[70:71]
    v_cndmask_b32 v118, v118, v84, vcc
    v_lshlrev_b32 v72, v118, v10
    v_lshl_add_u32 v73, v118, 1, v31
    v_xor_b32 v71, v71, v72

    ds_read_u16 v82, v73 offset:24
    s_setprio 0

    v_ffbl_b32 v84, v71
    v_mul_u32_u24 v72, 5, v84
    v_lshrrev_b64 v[72:73], v72, v[74:75]
    v_and_or_b32 v72, v72, s66, v85
    ds_add_rtn_u32 v87, v72, v10
    ds_wrxchg_rtn_b32 v116, v86, v13
    v_and_b32 v117, 15, v71
    v_bcnt_u32_b32 v118, v117, 0
    v_cmp_eq_u32 vcc, 1, v118

    s_add_u32 s83, s82, 3387648
    buffer_store_dwordx4 v[228:231], v14, s[32:35], s83 offen sc1
    s_add_u32 s83, s82, 3387712
    buffer_store_dwordx4 v[244:247], v14, s[32:35], s83 offen sc1

    v_cndmask_b32 v119, v71, v117, vcc
    s_waitcnt lgkmcnt(0)
    v_cmp_gt_u32 s[68:69], 2, v116
    v_cmp_gt_u32 s[70:71], 2, v87

    s_nop 0
    v_lshrrev_b64 v[76:77], v123, s[68:69]
    v_perm_b32 v121, v76, v76, v5
    v_perm_b32 v122, v76, v76, v4
    v_perm_b32 v77, v76, v76, v3
    v_and_b32 v121, v121, v21
    v_and_b32 v122, v122, v20
    v_and_b32 v77, v77, v19
    v_msad_u8 v120, v28, v121, 0
    v_lshlrev_b32 v120, 4, v120
    v_msad_u8 v120, v27, v122, v120
    v_lshlrev_b32 v120, 4, v120
    v_msad_u8 v120, v26, v77, v120

    v_and_b32 v120, v120, v119
    v_cmp_eq_u32 vcc, 0, v120
    v_ffbl_b32 v118, v120
    s_or_b64 vcc, vcc, s[70:71]
    v_cndmask_b32 v118, v118, v84, vcc
    v_lshlrev_b32 v72, v118, v10
    v_lshl_add_u32 v73, v118, 1, v31
    v_xor_b32 v71, v71, v72

    ds_read_u16 v83, v73 offset:24
    v_lshrrev_b32 v71, 4, v71
    v_or_b32 v71, s63, v71
    v_lshlrev_b32 v74, 22, v69
    v_lshl_or_b32 v74, v68, 2, v74
    v_lshrrev_b32 v75, 10, v69
    v_lshl_or_b32 v75, v70, 10, v75
    s_setprio 1

    v_ffbl_b32 v84, v71
    v_mul_u32_u24 v72, 5, v84
    v_lshrrev_b64 v[72:73], v72, v[74:75]
    v_and_or_b32 v72, v72, s66, v85
    ds_add_rtn_u32 v87, v72, v10
    ds_wrxchg_rtn_b32 v116, v86, v13
    v_and_b32 v117, 15, v71
    v_bcnt_u32_b32 v118, v117, 0
    v_cmp_eq_u32 vcc, 4, v118

    s_add_u32 s83, s82, 6672640
    buffer_store_dwordx4 v[232:235], v14, s[32:35], s83 offen sc1
    s_add_u32 s83, s82, 6672704
    buffer_store_dwordx4 v[248:251], v14, s[32:35], s83 offen sc1

    v_cndmask_b32 v119, v71, v117, vcc
    s_waitcnt lgkmcnt(0)
    v_cmp_gt_u32 s[68:69], 2, v116
    v_cmp_gt_u32 s[70:71], 2, v87

    v_lshl_or_b32 v78, v81, 16, v80
    v_lshl_or_b32 v79, v83, 16, v82
    buffer_store_dwordx2 v[78:79], v30, s[32:35], s62 offen sc1
    s_add_u32 s62, s62, 65536
    v_lshrrev_b64 v[76:77], v123, s[68:69]
    v_perm_b32 v121, v76, v76, v6
    v_perm_b32 v122, v76, v76, v5
    v_perm_b32 v77, v76, v76, v4
    v_and_b32 v121, v121, v22
    v_and_b32 v122, v122, v21
    v_and_b32 v77, v77, v20
    v_msad_u8 v120, v29, v121, 0
    v_lshlrev_b32 v120, 4, v120
    v_msad_u8 v120, v28, v122, v120
    v_lshlrev_b32 v120, 4, v120
    v_msad_u8 v120, v27, v77, v120

    v_and_b32 v120, v120, v119
    v_cmp_eq_u32 vcc, 0, v120
    v_ffbl_b32 v118, v120
    s_or_b64 vcc, vcc, s[70:71]
    v_cndmask_b32 v118, v118, v84, vcc
    v_lshlrev_b32 v72, v118, v10
    v_lshl_add_u32 v73, v118, 1, v31
    v_xor_b32 v71, v71, v72

    ds_read_u16 v80, v73 offset:32

    v_ffbl_b32 v84, v71
    v_mul_u32_u24 v72, 5, v84
    v_lshrrev_b64 v[72:73], v72, v[74:75]
    v_and_or_b32 v72, v72, s66, v85
    ds_add_rtn_u32 v87, v72, v10
    ds_wrxchg_rtn_b32 v116, v86, v13
    v_and_b32 v117, 15, v71
    v_bcnt_u32_b32 v118, v117, 0
    v_cmp_eq_u32 vcc, 3, v118

    s_add_u32 s83, s82, 9957632
    buffer_store_dwordx4 v[236:239], v14, s[32:35], s83 offen sc1
    s_add_u32 s83, s82, 9957696
    buffer_store_dwordx4 v[252:255], v14, s[32:35], s83 offen sc1

    v_cndmask_b32 v119, v71, v117, vcc
    s_waitcnt lgkmcnt(0)
    v_cmp_gt_u32 s[68:69], 2, v116
    v_cmp_gt_u32 s[70:71], 2, v87

    s_nop 0
    v_lshrrev_b64 v[76:77], v123, s[68:69]
    v_perm_b32 v121, v76, v76, v6
    v_perm_b32 v122, v76, v76, v5
    v_perm_b32 v77, v76, v76, v4
    v_and_b32 v121, v121, v22
    v_and_b32 v122, v122, v21
    v_and_b32 v77, v77, v20
    v_msad_u8 v120, v29, v121, 0
    v_lshlrev_b32 v120, 4, v120
    v_msad_u8 v120, v28, v122, v120
    v_lshlrev_b32 v120, 4, v120
    v_msad_u8 v120, v27, v77, v120

    v_and_b32 v120, v120, v119
    v_cmp_eq_u32 vcc, 0, v120
    v_ffbl_b32 v118, v120
    s_or_b64 vcc, vcc, s[70:71]
    v_cndmask_b32 v118, v118, v84, vcc
    v_lshlrev_b32 v72, v118, v10
    v_lshl_add_u32 v73, v118, 1, v31
    v_xor_b32 v71, v71, v72

    ds_read_u16 v81, v73 offset:32

    v_ffbl_b32 v84, v71
    v_mul_u32_u24 v72, 5, v84
    v_lshrrev_b64 v[72:73], v72, v[74:75]
    v_and_or_b32 v72, v72, s66, v85
    ds_add_rtn_u32 v87, v72, v10
    ds_wrxchg_rtn_b32 v116, v86, v13
    v_and_b32 v117, 15, v71
    v_bcnt_u32_b32 v118, v117, 0
    v_cmp_eq_u32 vcc, 2, v118

    s_nop 1

    v_cndmask_b32 v119, v71, v117, vcc
    s_waitcnt lgkmcnt(0)
    v_cmp_gt_u32 s[68:69], 2, v116
    v_cmp_gt_u32 s[70:71], 2, v87

    s_nop 0
    v_lshrrev_b64 v[76:77], v123, s[68:69]
    v_perm_b32 v121, v76, v76, v6
    v_perm_b32 v122, v76, v76, v5
    v_perm_b32 v77, v76, v76, v4
    v_and_b32 v121, v121, v22
    v_and_b32 v122, v122, v21
    v_and_b32 v77, v77, v20
    v_msad_u8 v120, v29, v121, 0
    v_lshlrev_b32 v120, 4, v120
    v_msad_u8 v120, v28, v122, v120
    v_lshlrev_b32 v120, 4, v120
    v_msad_u8 v120, v27, v77, v120

    v_and_b32 v120, v120, v119
    v_cmp_eq_u32 vcc, 0, v120
    v_ffbl_b32 v118, v120
    s_or_b64 vcc, vcc, s[70:71]
    v_cndmask_b32 v118, v118, v84, vcc
    v_lshlrev_b32 v72, v118, v10
    v_lshl_add_u32 v73, v118, 1, v31
    v_xor_b32 v71, v71, v72

    ds_read_u16 v82, v73 offset:32
    s_setprio 0

    v_ffbl_b32 v84, v71
    v_mul_u32_u24 v72, 5, v84
    v_lshrrev_b64 v[72:73], v72, v[74:75]
    v_and_or_b32 v72, v72, s66, v85
    ds_add_rtn_u32 v87, v72, v10
    ds_wrxchg_rtn_b32 v116, v86, v13
    v_and_b32 v117, 15, v71
    v_bcnt_u32_b32 v118, v117, 0
    v_cmp_eq_u32 vcc, 1, v118

    s_nop 1

    v_cndmask_b32 v119, v71, v117, vcc
    s_waitcnt lgkmcnt(0)
    v_cmp_gt_u32 s[68:69], 2, v116
    v_cmp_gt_u32 s[70:71], 2, v87

    s_nop 0
    v_lshrrev_b64 v[76:77], v123, s[68:69]
    v_perm_b32 v121, v76, v76, v6
    v_perm_b32 v122, v76, v76, v5
    v_perm_b32 v77, v76, v76, v4
    v_and_b32 v121, v121, v22
    v_and_b32 v122, v122, v21
    v_and_b32 v77, v77, v20
    v_msad_u8 v120, v29, v121, 0
    v_lshlrev_b32 v120, 4, v120
    v_msad_u8 v120, v28, v122, v120
    v_lshlrev_b32 v120, 4, v120
    v_msad_u8 v120, v27, v77, v120

    v_and_b32 v120, v120, v119
    v_cmp_eq_u32 vcc, 0, v120
    v_ffbl_b32 v118, v120
    s_or_b64 vcc, vcc, s[70:71]
    v_cndmask_b32 v118, v118, v84, vcc
    v_lshlrev_b32 v72, v118, v10
    v_lshl_add_u32 v73, v118, 1, v31
    v_xor_b32 v71, v71, v72

    ds_read_u16 v83, v73 offset:32
    s_cmp_lg_u32 s59, 3
    s_cbranch_scc1 standalone__deep_cross_pnn__recsys_kernel_sdone
    v_lshrrev_b32 v71, 4, v71
    v_lshlrev_b32 v74, 22, v70
    v_lshl_or_b32 v74, v69, 2, v74
    v_lshrrev_b32 v75, 10, v70
    s_setprio 1

    v_ffbl_b32 v84, v71
    v_mul_u32_u24 v72, 5, v84
    v_lshrrev_b64 v[72:73], v72, v[74:75]
    v_and_or_b32 v72, v72, s66, v85
    ds_add_rtn_u32 v87, v72, v10
    ds_wrxchg_rtn_b32 v116, v86, v13
    v_and_b32 v117, 15, v71
    v_bcnt_u32_b32 v118, v117, 0
    v_cmp_eq_u32 vcc, 4, v118

    s_nop 1

    v_cndmask_b32 v119, v71, v117, vcc
    s_waitcnt lgkmcnt(0)
    v_cmp_gt_u32 s[68:69], 2, v116
    v_cmp_gt_u32 s[70:71], 2, v87

    v_lshl_or_b32 v78, v81, 16, v80
    v_lshl_or_b32 v79, v83, 16, v82
    buffer_store_dwordx2 v[78:79], v30, s[32:35], s62 offen sc1
    s_add_u32 s62, s62, 65536
    v_lshrrev_b64 v[76:77], v123, s[68:69]
    v_perm_b32 v121, v76, v76, v6
    v_perm_b32 v122, v76, v76, v5
    v_and_b32 v121, v121, v22
    v_and_b32 v122, v122, v21
    v_msad_u8 v120, v29, v121, 0
    v_lshlrev_b32 v120, 4, v120
    v_msad_u8 v120, v28, v122, v120

    v_and_b32 v120, v120, v119
    v_cmp_eq_u32 vcc, 0, v120
    v_ffbl_b32 v118, v120
    s_or_b64 vcc, vcc, s[70:71]
    v_cndmask_b32 v118, v118, v84, vcc
    v_lshlrev_b32 v72, v118, v10
    v_lshl_add_u32 v73, v118, 1, v31
    v_xor_b32 v71, v71, v72

    ds_read_u16 v80, v73 offset:40

    v_ffbl_b32 v84, v71
    v_mul_u32_u24 v72, 5, v84
    v_lshrrev_b64 v[72:73], v72, v[74:75]
    v_and_or_b32 v72, v72, s66, v85
    ds_add_rtn_u32 v87, v72, v10
    ds_wrxchg_rtn_b32 v116, v86, v13
    v_and_b32 v117, 15, v71
    v_bcnt_u32_b32 v118, v117, 0
    v_cmp_eq_u32 vcc, 3, v118

    s_nop 1

    v_cndmask_b32 v119, v71, v117, vcc
    s_waitcnt lgkmcnt(0)
    v_cmp_gt_u32 s[68:69], 2, v116
    v_cmp_gt_u32 s[70:71], 2, v87

    s_nop 0
    v_lshrrev_b64 v[76:77], v123, s[68:69]
    v_perm_b32 v121, v76, v76, v6
    v_perm_b32 v122, v76, v76, v5
    v_and_b32 v121, v121, v22
    v_and_b32 v122, v122, v21
    v_msad_u8 v120, v29, v121, 0
    v_lshlrev_b32 v120, 4, v120
    v_msad_u8 v120, v28, v122, v120

    v_and_b32 v120, v120, v119
    v_cmp_eq_u32 vcc, 0, v120
    v_ffbl_b32 v118, v120
    s_or_b64 vcc, vcc, s[70:71]
    v_cndmask_b32 v118, v118, v84, vcc
    v_lshlrev_b32 v72, v118, v10
    v_lshl_add_u32 v73, v118, 1, v31
    v_xor_b32 v71, v71, v72

    ds_read_u16 v81, v73 offset:40

    v_ffbl_b32 v84, v71
    v_mul_u32_u24 v72, 5, v84
    v_lshrrev_b64 v[72:73], v72, v[74:75]
    v_and_or_b32 v72, v72, s66, v85
    ds_add_rtn_u32 v87, v72, v10
    ds_wrxchg_rtn_b32 v116, v86, v13
    v_and_b32 v117, 15, v71
    v_bcnt_u32_b32 v118, v117, 0
    v_cmp_eq_u32 vcc, 2, v118

    s_nop 1

    v_cndmask_b32 v119, v71, v117, vcc
    s_waitcnt lgkmcnt(0)
    v_cmp_gt_u32 s[68:69], 2, v116
    v_cmp_gt_u32 s[70:71], 2, v87

    s_nop 0
    v_lshrrev_b64 v[76:77], v123, s[68:69]
    v_perm_b32 v121, v76, v76, v6
    v_perm_b32 v122, v76, v76, v5
    v_and_b32 v121, v121, v22
    v_and_b32 v122, v122, v21
    v_msad_u8 v120, v29, v121, 0
    v_lshlrev_b32 v120, 4, v120
    v_msad_u8 v120, v28, v122, v120

    v_and_b32 v120, v120, v119
    v_cmp_eq_u32 vcc, 0, v120
    v_ffbl_b32 v118, v120
    s_or_b64 vcc, vcc, s[70:71]
    v_cndmask_b32 v118, v118, v84, vcc
    v_lshlrev_b32 v72, v118, v10
    v_lshl_add_u32 v73, v118, 1, v31
    v_xor_b32 v71, v71, v72

    ds_read_u16 v82, v73 offset:40

    v_ffbl_b32 v84, v71
    v_mul_u32_u24 v72, 5, v84
    v_lshrrev_b64 v[72:73], v72, v[74:75]
    v_and_or_b32 v72, v72, s66, v85
    ds_add_rtn_u32 v87, v72, v10
    ds_wrxchg_rtn_b32 v116, v86, v13
    v_and_b32 v117, 15, v71
    v_bcnt_u32_b32 v118, v117, 0
    v_cmp_eq_u32 vcc, 1, v118

    s_nop 1

    v_cndmask_b32 v119, v71, v117, vcc
    s_waitcnt lgkmcnt(0)
    v_cmp_gt_u32 s[68:69], 2, v116
    v_cmp_gt_u32 s[70:71], 2, v87

    s_nop 0
    v_lshrrev_b64 v[76:77], v123, s[68:69]
    v_perm_b32 v121, v76, v76, v6
    v_perm_b32 v122, v76, v76, v5
    v_and_b32 v121, v121, v22
    v_and_b32 v122, v122, v21
    v_msad_u8 v120, v29, v121, 0
    v_lshlrev_b32 v120, 4, v120
    v_msad_u8 v120, v28, v122, v120

    v_and_b32 v120, v120, v119
    v_cmp_eq_u32 vcc, 0, v120
    v_ffbl_b32 v118, v120
    s_or_b64 vcc, vcc, s[70:71]
    v_cndmask_b32 v118, v118, v84, vcc
    v_lshlrev_b32 v72, v118, v10
    v_lshl_add_u32 v73, v118, 1, v31
    v_xor_b32 v71, v71, v72

    ds_read_u16 v83, v73 offset:40
standalone__deep_cross_pnn__recsys_kernel_sdone:
    s_waitcnt lgkmcnt(0)
    v_lshl_or_b32 v78, v81, 16, v80
    v_lshl_or_b32 v79, v83, 16, v82
    buffer_store_dwordx2 v[78:79], v30, s[32:35], s62 offen sc1
    s_add_u32 s62, s62, 65536
standalone__deep_cross_pnn__recsys_kernel_udone:
    s_setprio 0

    s_waitcnt vmcnt(0)

    s_mov_b64 exec, 1
    ds_add_rtn_u32 v12, v11, v10 offset:20
    v_mov_b32 v0, s51
    s_waitcnt lgkmcnt(0)
    v_readfirstlane_b32 s45, v12
    s_and_b32 s45, s45, 3
    s_cmp_eq_u32 s45, 3
    s_cbranch_scc0 standalone__deep_cross_pnn__recsys_kernel_wdec
    s_mov_b64 exec, 0xffff
    s_lshr_b32 s38, s51, 5
    s_lshl_b32 s39, 1, s51

    s_cmp_eq_u32 s64, 0
    s_cselect_b32 s45, 7, 15
    v_and_b32 v1, s45, v8
    v_cmp_eq_u32 vcc, s38, v1
    v_mov_b32 v2, s39
    v_lshlrev_b32 v0, 2, v8
    v_cndmask_b32 v2, 0, v2, vcc
    v_mov_b32 v1, v2
    buffer_atomic_or v1, v0, s[52:55], 0 offen sc0
    s_lshl_b32 s45, s2, 8
    s_add_u32 s45, s45, 14680064
    s_waitcnt vmcnt(0)
    v_or_b32 v1, v1, v2
    v_cmp_ne_u32 vcc, -1, v1
    s_and_b32 s39, vcc_lo, 0xff
    s_cbranch_scc1 standalone__deep_cross_pnn__recsys_kernel_poll
    s_cmp_eq_u32 vcc_lo, 0
    s_cselect_b32 s39, 3, 2
    s_mov_b64 exec, -1
    v_lshlrev_b32 v0, 8, v8
    v_mov_b32 v1, s39
    s_mov_b32 s38, 14680064

    buffer_store_dword v1, v0, s[12:15], s38 offen sc1
    s_add_u32 s38, s38, 16384
    buffer_store_dword v1, v0, s[12:15], s38 offen sc1
    s_add_u32 s38, s38, 16384
    buffer_store_dword v1, v0, s[12:15], s38 offen sc1
    s_add_u32 s38, s38, 16384
    buffer_store_dword v1, v0, s[12:15], s38 offen sc1
    s_branch standalone__deep_cross_pnn__recsys_kernel_go
standalone__deep_cross_pnn__recsys_kernel_poll:

    buffer_load_dword v1, v13, s[12:15], s45 offen sc1
    s_add_u32 s65, s65, 1
    s_waitcnt vmcnt(0)
    v_readfirstlane_b32 s39, v1
    s_cmp_lg_u32 s39, 0
    s_cbranch_scc1 standalone__deep_cross_pnn__recsys_kernel_go
    s_cmp_lt_u32 s65, 200
    s_cbranch_scc1 standalone__deep_cross_pnn__recsys_kernel_poll
    buffer_load_dword v1, v0, s[52:55], 0 offen sc1
    s_waitcnt vmcnt(0)
    v_cmp_ne_u32 vcc, -1, v1
    s_mov_b32 s39, 2
    s_and_b32 vcc_lo, vcc_lo, 0xff
    s_cbranch_scc0 standalone__deep_cross_pnn__recsys_kernel_go
    s_ff1_i32_b64 s38, vcc
    s_nop 3
    v_readlane_b32 s39, v1, s38
    s_ff0_i32_b32 s39, s39
    s_lshl_b32 s38, s38, 5
    s_add_u32 s38, s38, s39
    s_andn2_b32 s39, s64, 255
    s_add_u32 s39, s39, 256
    s_or_b32 s38, s38, s39
    s_branch standalone__deep_cross_pnn__recsys_kernel_dec

standalone__deep_cross_pnn__recsys_kernel_go:

    s_lshl_b32 s38, s39, 30

standalone__deep_cross_pnn__recsys_kernel_dec:

    v_mov_b32 v1, s38
    s_mov_b64 exec, 1
    ds_write_b32 v11, v1 offset:24

standalone__deep_cross_pnn__recsys_kernel_wdec:

    s_mov_b64 exec, -1
    ds_read_b32 v12, v11 offset:24
    s_waitcnt lgkmcnt(0)
    v_readfirstlane_b32 s45, v12
    s_cmp_lg_u32 s45, s64
    s_cbranch_scc1 standalone__deep_cross_pnn__recsys_kernel_gotd
    s_sleep 2
    s_branch standalone__deep_cross_pnn__recsys_kernel_wdec

standalone__deep_cross_pnn__recsys_kernel_gotd:

    s_mov_b32 s64, s45
    s_and_b32 s51, s45, 255
    s_mov_b32 s65, 0x10000
    s_bitcmp0_b32 s45, 31
    s_cbranch_scc1 standalone__deep_cross_pnn__recsys_kernel_unit
    s_xor_b32 s44, s50, 1
    s_lshl_b32 s44, s44, 3
    s_add_u32 s44, s44, s56
    s_lshl_b32 s44, s44, 14
    s_add_u32 s44, s44, 15204352
    s_add_u32 s47, s44, 65536

    buffer_load_dwordx4 v[32:35], v9, s[12:15], s44 offen offset:0 sc1
    buffer_load_dwordx4 v[36:39], v9, s[12:15], s44 offen offset:1024 sc1
    buffer_load_dwordx4 v[40:43], v9, s[12:15], s44 offen offset:2048 sc1
    buffer_load_dwordx4 v[44:47], v9, s[12:15], s44 offen offset:3072 sc1
    s_add_u32 s44, s44, 4096
    buffer_load_dwordx4 v[48:51], v9, s[12:15], s44 offen offset:0 sc1
    buffer_load_dwordx4 v[52:55], v9, s[12:15], s44 offen offset:1024 sc1
    buffer_load_dwordx4 v[56:59], v9, s[12:15], s44 offen offset:2048 sc1
    buffer_load_dwordx4 v[60:63], v9, s[12:15], s44 offen offset:3072 sc1
    s_add_u32 s44, s44, 4096
    s_waitcnt vmcnt(7)
    buffer_load_dwordx4 v[88:91], v9, s[12:15], s44 offen offset:0 sc1
    s_waitcnt vmcnt(7)
    buffer_load_dwordx4 v[92:95], v9, s[12:15], s44 offen offset:1024 sc1
    s_waitcnt vmcnt(7)
    buffer_load_dwordx4 v[96:99], v9, s[12:15], s44 offen offset:2048 sc1
    s_waitcnt vmcnt(7)
    buffer_load_dwordx4 v[100:103], v9, s[12:15], s44 offen offset:3072 sc1
    s_add_u32 s44, s44, 4096
    s_waitcnt vmcnt(7)
    buffer_load_dwordx4 v[104:107], v9, s[12:15], s44 offen offset:0 sc1
    s_waitcnt vmcnt(7)
    buffer_load_dwordx4 v[108:111], v9, s[12:15], s44 offen offset:1024 sc1
    s_waitcnt vmcnt(7)
    buffer_load_dwordx4 v[112:115], v9, s[12:15], s44 offen offset:2048 sc1
    s_waitcnt vmcnt(7)
    buffer_load_dwordx4 v[124:127], v9, s[12:15], s44 offen offset:3072 sc1
    s_add_u32 s44, s44, 4096
    s_waitcnt vmcnt(7)
    buffer_load_dwordx4 v[136:139], v9, s[12:15], s47 offen offset:0 sc1
    s_waitcnt vmcnt(7)
    buffer_load_dwordx4 v[140:143], v9, s[12:15], s47 offen offset:1024 sc1
    s_waitcnt vmcnt(7)
    buffer_load_dwordx4 v[152:155], v9, s[12:15], s47 offen offset:2048 sc1
    s_waitcnt vmcnt(7)
    buffer_load_dwordx4 v[156:159], v9, s[12:15], s47 offen offset:3072 sc1
    s_add_u32 s47, s47, 4096
    s_waitcnt vmcnt(7)
    buffer_load_dwordx4 v[168:171], v9, s[12:15], s47 offen offset:0 sc1
    s_waitcnt vmcnt(7)
    buffer_load_dwordx4 v[172:175], v9, s[12:15], s47 offen offset:1024 sc1
    s_waitcnt vmcnt(7)
    buffer_load_dwordx4 v[184:187], v9, s[12:15], s47 offen offset:2048 sc1
    s_waitcnt vmcnt(7)
    buffer_load_dwordx4 v[188:191], v9, s[12:15], s47 offen offset:3072 sc1
    s_add_u32 s47, s47, 4096
    s_waitcnt vmcnt(7)
    buffer_load_dwordx4 v[200:203], v9, s[12:15], s47 offen offset:0 sc1
    s_waitcnt vmcnt(7)
    buffer_load_dwordx4 v[204:207], v9, s[12:15], s47 offen offset:1024 sc1
    s_waitcnt vmcnt(7)
    buffer_load_dwordx4 v[216:219], v9, s[12:15], s47 offen offset:2048 sc1
    s_waitcnt vmcnt(7)
    buffer_load_dwordx4 v[220:223], v9, s[12:15], s47 offen offset:3072 sc1
    s_add_u32 s47, s47, 4096
    s_waitcnt vmcnt(7)
    buffer_load_dwordx4 v[232:235], v9, s[12:15], s47 offen offset:0 sc1
    s_waitcnt vmcnt(7)
    buffer_load_dwordx4 v[236:239], v9, s[12:15], s47 offen offset:1024 sc1
    s_waitcnt vmcnt(7)
    buffer_load_dwordx4 v[248:251], v9, s[12:15], s47 offen offset:2048 sc1
    s_waitcnt vmcnt(7)
    buffer_load_dwordx4 v[252:255], v9, s[12:15], s47 offen offset:3072 sc1
    s_add_u32 s47, s47, 4096
standalone__deep_cross_pnn__recsys_kernel_k2:

    s_setprio 0
    s_load_dwordx4 s[8:11], s[0:1], 32
    v_mbcnt_lo_u32_b32 v0, -1, 0
    v_mbcnt_hi_u32_b32 v0, -1, v0
    s_mul_i32 s35, s3, 18432
    v_and_b32 v1, 15, v0
    v_lshrrev_b32 v2, 4, v0
    v_mul_u32_u24 v71, 144, v1
    v_lshl_add_u32 v71, v2, 4, v71
    v_add_u32 v71, s35, v71

    ds_read_b128 v[128:131], v71 offset:0
    ds_read_b128 v[132:135], v71 offset:64
    ds_read_b128 v[144:147], v71 offset:2304
    ds_read_b128 v[148:151], v71 offset:2368
    ds_read_b128 v[160:163], v71 offset:4608
    ds_read_b128 v[164:167], v71 offset:4672
    ds_read_b128 v[176:179], v71 offset:6912
    ds_read_b128 v[180:183], v71 offset:6976
    ds_read_b128 v[192:195], v71 offset:9216
    ds_read_b128 v[196:199], v71 offset:9280
    ds_read_b128 v[208:211], v71 offset:11520
    ds_read_b128 v[212:215], v71 offset:11584
    ds_read_b128 v[224:227], v71 offset:13824
    ds_read_b128 v[228:231], v71 offset:13888
    ds_read_b128 v[240:243], v71 offset:16128
    ds_read_b128 v[244:247], v71 offset:16192

    s_lshr_b32 s33, s2, 1
    s_and_b32 s34, s2, 1
    s_mov_b32 s32, 0x8000
    v_lshlrev_b32 v69, 4, v0
    s_mul_i32 s21, s33, 102656
    s_lshl_b32 s35, s50, 11
    s_xor_b32 s19, s35, 2048
    s_add_u32 s19, s19, s21
    s_add_u32 s21, s21, s35
    s_mul_i32 s20, s34, 1638400
    s_add_u32 s20, s20, 16777216
    s_lshl_b32 s35, s3, 13
    s_add_u32 s20, s20, s35
    v_lshlrev_b32 v70, 13, v2
    v_lshl_add_u32 v70, v1, 3, v70
    s_lshl_b32 s35, s3, 10
    v_add_u32 v70, s35, v70
    v_lshrrev_b32 v4, 3, v0
    v_xor_b32 v4, v4, v2
    v_and_b32 v4, 1, v4
    v_bfe_u32 v5, v0, 2, 1
    v_lshl_or_b32 v4, v4, 1, v5
    v_mov_b32 v6, 0x3f80
    v_cmp_eq_u32 vcc, 0, v4
    s_nop 1
    v_cndmask_b32 v64, 0, v6, vcc
    v_cndmask_b32 v65, 0, v6, vcc
    v_cmp_eq_u32 vcc, 1, v4
    s_nop 1
    v_cndmask_b32 v66, 0, v6, vcc
    v_cndmask_b32 v67, 0, v6, vcc
    v_and_b32 v5, 3, v0
    v_mul_u32_u24 v68, 0x5555, v5

    s_cmp_lt_u32 s3, 4
    s_cbranch_scc1 standalone__deep_cross_pnn__recsys_kernel_k2n
    buffer_load_dwordx4 v[0:3], v69, s[12:15], s21 offen offset:0 sc1
    buffer_load_dwordx4 v[4:7], v69, s[12:15], s21 offen offset:1024 sc1
    buffer_load_dwordx4 v[8:11], v69, s[12:15], s19 offen offset:0 sc1
    buffer_load_dwordx4 v[12:15], v69, s[12:15], s19 offen offset:1024 sc1
    s_add_u32 s21, s21, 4096
    s_add_u32 s19, s19, 4096
    buffer_load_dwordx4 v[16:19], v69, s[12:15], s21 offen offset:0 sc1
    buffer_load_dwordx4 v[20:23], v69, s[12:15], s21 offen offset:1024 sc1
    buffer_load_dwordx4 v[24:27], v69, s[12:15], s19 offen offset:0 sc1
    buffer_load_dwordx4 v[28:31], v69, s[12:15], s19 offen offset:1024 sc1
    s_add_u32 s21, s21, 4096
    s_add_u32 s19, s19, 4096
    s_mov_b32 s44, s21
    s_mov_b32 s45, s19
    s_add_u32 s21, s21, 4096
    s_add_u32 s19, s19, 4096
    buffer_load_dwordx4 v[72:75], v69, s[12:15], s21 offen offset:0 sc1
    buffer_load_dwordx4 v[76:79], v69, s[12:15], s21 offen offset:1024 sc1
    buffer_load_dwordx4 v[80:83], v69, s[12:15], s19 offen offset:0 sc1
    buffer_load_dwordx4 v[84:87], v69, s[12:15], s19 offen offset:1024 sc1
    s_add_u32 s21, s21, 4096
    s_add_u32 s19, s19, 4096
    buffer_load_dwordx4 v[116:119], v69, s[12:15], s20 offen offset:0 sc1
    buffer_load_dwordx4 v[120:123], v69, s[12:15], s20 offen offset:1024 sc1
standalone__deep_cross_pnn__recsys_kernel_k2n:

    s_and_b32 s35, s3, 3
    s_lshl_b32 s35, s35, 14
    s_add_u32 s35, s35, 98304
    v_add_u32 v71, s35, v69
    s_lshl_b32 s35, s33, 3
    s_waitcnt lgkmcnt(0)
    s_add_u32 s8, s8, s35
    s_addc_u32 s9, s9, 0
    s_add_u32 s10, s10, s35
    s_addc_u32 s11, s11, 0
    s_barrier

    s_load_dwordx2 s[36:37], s[8:9], 0
    s_load_dwordx4 s[56:59], s[0:1], 48
    s_load_dwordx2 s[38:39], s[10:11], 0
    s_cmp_lt_u32 s3, 4
    s_cbranch_scc1 standalone__deep_cross_pnn__recsys_kernel_k2m

    s_waitcnt vmcnt(10)
    ds_write_b128 v71, v[32:35] offset:0
    ds_write_b128 v71, v[36:39] offset:1024
    ds_write_b128 v71, v[40:43] offset:2048
    ds_write_b128 v71, v[44:47] offset:3072
    v_mfma_f32_16x16x32_bf16 v[32:35], v[0:3], v[128:131], 0
    v_mfma_f32_16x16x32_bf16 v[36:39], v[0:3], v[144:147], 0
    ds_write_b128 v71, v[48:51] offset:4096
    v_mfma_f32_16x16x32_bf16 v[40:43], v[0:3], v[160:163], 0
    v_mfma_f32_16x16x32_bf16 v[44:47], v[0:3], v[176:179], 0
    ds_write_b128 v71, v[52:55] offset:5120
    v_mfma_f32_16x16x32_bf16 v[32:35], v[4:7], v[132:135], v[32:35]
    v_mfma_f32_16x16x32_bf16 v[36:39], v[4:7], v[148:151], v[36:39]
    ds_write_b128 v71, v[56:59] offset:6144
    v_mfma_f32_16x16x32_bf16 v[40:43], v[4:7], v[164:167], v[40:43]
    v_mfma_f32_16x16x32_bf16 v[44:47], v[4:7], v[180:183], v[44:47]
    ds_write_b128 v71, v[60:63] offset:7168
    v_mfma_f32_16x16x32_bf16 v[32:35], v[8:11], v[136:139], v[32:35]
    v_mfma_f32_16x16x32_bf16 v[36:39], v[8:11], v[152:155], v[36:39]
    ds_write_b128 v71, v[88:91] offset:8192
    v_mfma_f32_16x16x32_bf16 v[40:43], v[8:11], v[168:171], v[40:43]
    v_mfma_f32_16x16x32_bf16 v[44:47], v[8:11], v[184:187], v[44:47]
    ds_write_b128 v71, v[92:95] offset:9216
    v_mfma_f32_16x16x32_bf16 v[32:35], v[12:15], v[140:143], v[32:35]
    v_mfma_f32_16x16x32_bf16 v[36:39], v[12:15], v[156:159], v[36:39]
    ds_write_b128 v71, v[96:99] offset:10240
    v_mfma_f32_16x16x32_bf16 v[40:43], v[12:15], v[172:175], v[40:43]
    v_mfma_f32_16x16x32_bf16 v[44:47], v[12:15], v[188:191], v[44:47]
    ds_write_b128 v71, v[100:103] offset:11264
    v_mfma_f32_16x16x32_bf16 v[48:51], v[0:3], v[192:195], 0
    v_mfma_f32_16x16x32_bf16 v[52:55], v[0:3], v[208:211], 0
    ds_write_b128 v71, v[104:107] offset:12288
    v_mfma_f32_16x16x32_bf16 v[56:59], v[0:3], v[224:227], 0
    v_mfma_f32_16x16x32_bf16 v[60:63], v[0:3], v[240:243], 0
    ds_write_b128 v71, v[108:111] offset:13312
    v_mfma_f32_16x16x32_bf16 v[48:51], v[4:7], v[196:199], v[48:51]
    v_mfma_f32_16x16x32_bf16 v[52:55], v[4:7], v[212:215], v[52:55]
    ds_write_b128 v71, v[112:115] offset:14336
    v_mfma_f32_16x16x32_bf16 v[56:59], v[4:7], v[228:231], v[56:59]
    v_mfma_f32_16x16x32_bf16 v[60:63], v[4:7], v[244:247], v[60:63]
    ds_write_b128 v71, v[124:127] offset:15360
    v_mfma_f32_16x16x32_bf16 v[48:51], v[8:11], v[200:203], v[48:51]
    v_mfma_f32_16x16x32_bf16 v[52:55], v[8:11], v[216:219], v[52:55]
    v_mfma_f32_16x16x32_bf16 v[56:59], v[8:11], v[232:235], v[56:59]
    v_mfma_f32_16x16x32_bf16 v[60:63], v[8:11], v[248:251], v[60:63]
    s_waitcnt lgkmcnt(0)
    s_barrier
    v_mfma_f32_16x16x32_bf16 v[48:51], v[12:15], v[204:207], v[48:51]
    v_mfma_f32_16x16x32_bf16 v[52:55], v[12:15], v[220:223], v[52:55]
    v_mfma_f32_16x16x32_bf16 v[56:59], v[12:15], v[236:239], v[56:59]
    v_mfma_f32_16x16x32_bf16 v[60:63], v[12:15], v[252:255], v[60:63]
    buffer_load_dwordx4 v[124:127], v69, s[12:15], s20 offen offset:2048 sc1
    buffer_load_dwordx4 v[0:3], v69, s[12:15], s44 offen offset:0 sc1
    buffer_load_dwordx4 v[4:7], v69, s[12:15], s44 offen offset:1024 sc1
    buffer_load_dwordx4 v[8:11], v69, s[12:15], s45 offen offset:0 sc1
    buffer_load_dwordx4 v[12:15], v69, s[12:15], s45 offen offset:1024 sc1
    s_waitcnt vmcnt(11)
    s_lshl_b32 s24, s36, 16
    s_and_b32 s25, s36, 0xffff0000
    s_lshl_b32 s26, s37, 16
    s_and_b32 s27, s37, 0xffff0000

    v_mfma_f32_16x16x32_bf16 v[88:91], v[16:19], v[128:131], 0
    v_mfma_f32_16x16x32_bf16 v[92:95], v[16:19], v[144:147], 0
    v_mfma_f32_16x16x32_bf16 v[88:91], v[20:23], v[132:135], v[88:91]
    v_mfma_f32_16x16x32_bf16 v[92:95], v[20:23], v[148:151], v[92:95]
    v_mfma_f32_16x16x32_bf16 v[88:91], v[24:27], v[136:139], v[88:91]
    v_cvt_pk_bf16_f32 v32, v32, v33
    v_mfma_f32_16x16x32_bf16 v[92:95], v[24:27], v[152:155], v[92:95]
    v_cvt_pk_bf16_f32 v33, v34, v35
    v_mfma_f32_16x16x32_bf16 v[88:91], v[28:31], v[140:143], v[88:91]
    ds_write_b64 v70, v[32:33] offset:0
    v_mfma_f32_16x16x32_bf16 v[92:95], v[28:31], v[156:159], v[92:95]
    v_cvt_pk_bf16_f32 v36, v36, v37
    v_mfma_f32_16x16x32_bf16 v[96:99], v[16:19], v[160:163], 0
    v_cvt_pk_bf16_f32 v37, v38, v39
    v_mfma_f32_16x16x32_bf16 v[100:103], v[16:19], v[176:179], 0
    ds_write_b64 v70, v[36:37] offset:128
    v_mfma_f32_16x16x32_bf16 v[96:99], v[20:23], v[164:167], v[96:99]
    v_cvt_pk_bf16_f32 v88, v88, v89
    v_cvt_pk_bf16_f32 v40, v40, v41
    v_mfma_f32_16x16x32_bf16 v[100:103], v[20:23], v[180:183], v[100:103]
    v_cvt_pk_bf16_f32 v89, v90, v91
    v_cvt_pk_bf16_f32 v41, v42, v43
    v_mfma_f32_16x16x32_bf16 v[96:99], v[24:27], v[168:171], v[96:99]
    ds_write_b64 v70, v[88:89] offset:32768
    ds_write_b64 v70, v[40:41] offset:256
    v_mfma_f32_16x16x32_bf16 v[100:103], v[24:27], v[184:187], v[100:103]
    v_cvt_pk_bf16_f32 v92, v92, v93
    v_cvt_pk_bf16_f32 v44, v44, v45
    v_mfma_f32_16x16x32_bf16 v[96:99], v[28:31], v[172:175], v[96:99]
    v_cvt_pk_bf16_f32 v93, v94, v95
    v_cvt_pk_bf16_f32 v45, v46, v47
    v_mfma_f32_16x16x32_bf16 v[100:103], v[28:31], v[188:191], v[100:103]
    ds_write_b64 v70, v[92:93] offset:32896
    ds_write_b64 v70, v[44:45] offset:384
    v_mfma_f32_16x16x32_bf16 v[104:107], v[16:19], v[192:195], 0
    v_cvt_pk_bf16_f32 v48, v48, v49
    v_mfma_f32_16x16x32_bf16 v[108:111], v[16:19], v[208:211], 0
    v_cvt_pk_bf16_f32 v49, v50, v51
    v_mfma_f32_16x16x32_bf16 v[104:107], v[20:23], v[196:199], v[104:107]
    v_cvt_pk_bf16_f32 v96, v96, v97
    ds_write_b64 v70, v[48:49] offset:512
    v_mfma_f32_16x16x32_bf16 v[108:111], v[20:23], v[212:215], v[108:111]
    v_cvt_pk_bf16_f32 v97, v98, v99
    v_cvt_pk_bf16_f32 v52, v52, v53
    v_mfma_f32_16x16x32_bf16 v[104:107], v[24:27], v[200:203], v[104:107]
    ds_write_b64 v70, v[96:97] offset:33024
    v_cvt_pk_bf16_f32 v53, v54, v55
    v_mfma_f32_16x16x32_bf16 v[108:111], v[24:27], v[216:219], v[108:111]
    v_cvt_pk_bf16_f32 v100, v100, v101
    ds_write_b64 v70, v[52:53] offset:640
    v_mfma_f32_16x16x32_bf16 v[104:107], v[28:31], v[204:207], v[104:107]
    v_cvt_pk_bf16_f32 v101, v102, v103
    v_cvt_pk_bf16_f32 v56, v56, v57
    v_mfma_f32_16x16x32_bf16 v[108:111], v[28:31], v[220:223], v[108:111]
    ds_write_b64 v70, v[100:101] offset:33152
    v_cvt_pk_bf16_f32 v57, v58, v59
    v_mfma_f32_16x16x32_bf16 v[88:91], v[16:19], v[224:227], 0
    ds_write_b64 v70, v[56:57] offset:768
    v_mfma_f32_16x16x32_bf16 v[92:95], v[16:19], v[240:243], 0
    v_cvt_pk_bf16_f32 v60, v60, v61
    v_mfma_f32_16x16x32_bf16 v[88:91], v[20:23], v[228:231], v[88:91]
    v_cvt_pk_bf16_f32 v104, v104, v105
    v_cvt_pk_bf16_f32 v61, v62, v63
    v_mfma_f32_16x16x32_bf16 v[92:95], v[20:23], v[244:247], v[92:95]
    v_cvt_pk_bf16_f32 v105, v106, v107
    ds_write_b64 v70, v[60:61] offset:896
    v_mfma_f32_16x16x32_bf16 v[88:91], v[24:27], v[232:235], v[88:91]
    ds_write_b64 v70, v[104:105] offset:33280
    v_mfma_f32_16x16x32_bf16 v[92:95], v[24:27], v[248:251], v[92:95]
    v_cvt_pk_bf16_f32 v108, v108, v109
    v_mfma_f32_16x16x32_bf16 v[88:91], v[28:31], v[236:239], v[88:91]
    v_cvt_pk_bf16_f32 v109, v110, v111
    v_mfma_f32_16x16x32_bf16 v[92:95], v[28:31], v[252:255], v[92:95]
    ds_write_b64 v70, v[108:109] offset:33408
    v_add_u32 v70, 0x8000, v70
    s_waitcnt vmcnt(0)
    v_mfma_f32_16x16x32_bf16 v[96:99], v[0:3], v[128:131], 0
    v_mfma_f32_16x16x32_bf16 v[100:103], v[0:3], v[144:147], 0
    v_mfma_f32_16x16x32_bf16 v[96:99], v[4:7], v[132:135], v[96:99]
    v_cvt_pk_bf16_f32 v88, v88, v89
    v_mfma_f32_16x16x32_bf16 v[100:103], v[4:7], v[148:151], v[100:103]
    v_cvt_pk_bf16_f32 v89, v90, v91
    v_mfma_f32_16x16x32_bf16 v[96:99], v[8:11], v[136:139], v[96:99]
    ds_write_b64 v70, v[88:89] offset:768
    v_mov_b32 v16, s24
    v_mov_b32 v40, s24
    v_mfma_f32_16x16x32_bf16 v[100:103], v[8:11], v[152:155], v[100:103]
    v_cvt_pk_bf16_f32 v92, v92, v93
    v_mov_b32 v17, s25
    v_mov_b32 v41, s25
    v_mfma_f32_16x16x32_bf16 v[96:99], v[12:15], v[140:143], v[96:99]
    v_cvt_pk_bf16_f32 v93, v94, v95
    v_mov_b32 v18, s26
    v_mov_b32 v42, s26
    v_mfma_f32_16x16x32_bf16 v[100:103], v[12:15], v[156:159], v[100:103]
    ds_write_b64 v70, v[92:93] offset:896
    v_mov_b32 v19, s27
    v_mov_b32 v43, s27
    v_mfma_f32_16x16x32_bf16 v[104:107], v[0:3], v[160:163], 0
    v_mov_b32 v20, s24
    v_mov_b32 v44, s24
    v_mfma_f32_16x16x32_bf16 v[108:111], v[0:3], v[176:179], 0
    v_mov_b32 v21, s25
    v_mov_b32 v45, s25
    v_mfma_f32_16x16x32_bf16 v[104:107], v[4:7], v[164:167], v[104:107]
    v_cvt_pk_bf16_f32 v96, v96, v97
    v_mov_b32 v22, s26
    v_mov_b32 v46, s26
    v_mfma_f32_16x16x32_bf16 v[108:111], v[4:7], v[180:183], v[108:111]
    v_cvt_pk_bf16_f32 v97, v98, v99
    v_mov_b32 v23, s27
    v_mov_b32 v47, s27
    v_mfma_f32_16x16x32_bf16 v[104:107], v[8:11], v[168:171], v[104:107]
    ds_write_b64 v70, v[96:97] offset:32768
    v_mov_b32 v24, s24
    v_mov_b32 v48, s24
    v_mfma_f32_16x16x32_bf16 v[108:111], v[8:11], v[184:187], v[108:111]
    v_cvt_pk_bf16_f32 v100, v100, v101
    v_mov_b32 v25, s25
    v_mov_b32 v49, s25
    v_mfma_f32_16x16x32_bf16 v[104:107], v[12:15], v[172:175], v[104:107]
    v_cvt_pk_bf16_f32 v101, v102, v103
    v_mov_b32 v26, s26
    v_mov_b32 v50, s26
    v_mfma_f32_16x16x32_bf16 v[108:111], v[12:15], v[188:191], v[108:111]
    ds_write_b64 v70, v[100:101] offset:32896
    v_mov_b32 v27, s27
    v_mov_b32 v51, s27
    v_mfma_f32_16x16x32_bf16 v[88:91], v[0:3], v[192:195], 0
    v_mov_b32 v28, s24
    v_mov_b32 v52, s24
    v_mfma_f32_16x16x32_bf16 v[92:95], v[0:3], v[208:211], 0
    v_mov_b32 v29, s25
    v_mov_b32 v53, s25
    v_mfma_f32_16x16x32_bf16 v[88:91], v[4:7], v[196:199], v[88:91]
    v_cvt_pk_bf16_f32 v104, v104, v105
    v_mov_b32 v30, s26
    v_mov_b32 v54, s26
    v_mfma_f32_16x16x32_bf16 v[92:95], v[4:7], v[212:215], v[92:95]
    v_cvt_pk_bf16_f32 v105, v106, v107
    v_mov_b32 v31, s27
    v_mov_b32 v55, s27
    v_mfma_f32_16x16x32_bf16 v[88:91], v[8:11], v[200:203], v[88:91]
    ds_write_b64 v70, v[104:105] offset:33024
    v_mov_b32 v32, s24
    v_mov_b32 v56, s24
    v_mfma_f32_16x16x32_bf16 v[92:95], v[8:11], v[216:219], v[92:95]
    v_cvt_pk_bf16_f32 v108, v108, v109
    v_mov_b32 v33, s25
    v_mov_b32 v57, s25
    v_mfma_f32_16x16x32_bf16 v[88:91], v[12:15], v[204:207], v[88:91]
    v_cvt_pk_bf16_f32 v109, v110, v111
    v_mov_b32 v34, s26
    v_mov_b32 v58, s26
    v_mfma_f32_16x16x32_bf16 v[92:95], v[12:15], v[220:223], v[92:95]
    ds_write_b64 v70, v[108:109] offset:33152
    v_mov_b32 v35, s27
    v_mov_b32 v59, s27
    v_mfma_f32_16x16x32_bf16 v[96:99], v[0:3], v[224:227], 0
    v_mov_b32 v36, s24
    v_mov_b32 v60, s24
    v_mfma_f32_16x16x32_bf16 v[100:103], v[0:3], v[240:243], 0
    v_mov_b32 v37, s25
    v_mov_b32 v61, s25
    v_mfma_f32_16x16x32_bf16 v[96:99], v[4:7], v[228:231], v[96:99]
    v_cvt_pk_bf16_f32 v88, v88, v89
    v_mov_b32 v38, s26
    v_mov_b32 v62, s26
    v_mfma_f32_16x16x32_bf16 v[100:103], v[4:7], v[244:247], v[100:103]
    v_cvt_pk_bf16_f32 v89, v90, v91
    v_mov_b32 v39, s27
    v_mov_b32 v63, s27
    v_mfma_f32_16x16x32_bf16 v[96:99], v[8:11], v[232:235], v[96:99]
    ds_write_b64 v70, v[88:89] offset:33280
    s_nop 0
    v_mfma_f32_16x16x32_bf16 v[100:103], v[8:11], v[248:251], v[100:103]
    v_cvt_pk_bf16_f32 v92, v92, v93
    s_nop 0
    v_mfma_f32_16x16x32_bf16 v[96:99], v[12:15], v[236:239], v[96:99]
    v_cvt_pk_bf16_f32 v93, v94, v95
    s_nop 0
    v_mfma_f32_16x16x32_bf16 v[100:103], v[12:15], v[252:255], v[100:103]
    ds_write_b64 v70, v[92:93] offset:33408
    s_nop 0
    v_mov_b32 v0, s24
    v_mov_b32 v1, s25
    v_mov_b32 v2, s26
    v_mov_b32 v3, s27
    v_mov_b32 v4, s24
    v_mov_b32 v5, s25
    v_mov_b32 v6, s26
    v_mov_b32 v7, s27
    v_mov_b32 v8, s24
    v_mov_b32 v9, s25
    v_mov_b32 v10, s26
    v_mov_b32 v11, s27
    v_mov_b32 v12, s24
    v_mov_b32 v13, s25
    v_mov_b32 v14, s26
    v_mov_b32 v15, s27
    s_nop 7
    v_cvt_pk_bf16_f32 v96, v96, v97
    v_cvt_pk_bf16_f32 v97, v98, v99
    ds_write_b64 v70, v[96:97] offset:33536
    v_cvt_pk_bf16_f32 v100, v100, v101
    v_cvt_pk_bf16_f32 v101, v102, v103
    ds_write_b64 v70, v[100:101] offset:33664
    v_add_u32 v70, 0x10000, v70
    s_branch standalone__deep_cross_pnn__recsys_kernel_k2j
standalone__deep_cross_pnn__recsys_kernel_k2m:
    buffer_load_dwordx4 v[0:3], v69, s[12:15], s21 offen offset:0 sc1
    buffer_load_dwordx4 v[4:7], v69, s[12:15], s21 offen offset:1024 sc1
    buffer_load_dwordx4 v[8:11], v69, s[12:15], s19 offen offset:0 sc1
    buffer_load_dwordx4 v[12:15], v69, s[12:15], s19 offen offset:1024 sc1
    s_add_u32 s21, s21, 4096
    s_add_u32 s19, s19, 4096
    buffer_load_dwordx4 v[16:19], v69, s[12:15], s21 offen offset:0 sc1
    buffer_load_dwordx4 v[20:23], v69, s[12:15], s21 offen offset:1024 sc1
    buffer_load_dwordx4 v[24:27], v69, s[12:15], s19 offen offset:0 sc1
    buffer_load_dwordx4 v[28:31], v69, s[12:15], s19 offen offset:1024 sc1
    s_add_u32 s21, s21, 4096
    s_add_u32 s19, s19, 4096
    s_mov_b32 s44, s21
    s_mov_b32 s45, s19
    s_add_u32 s21, s21, 4096
    s_add_u32 s19, s19, 4096
    buffer_load_dwordx4 v[72:75], v69, s[12:15], s21 offen offset:0 sc1
    buffer_load_dwordx4 v[76:79], v69, s[12:15], s21 offen offset:1024 sc1
    buffer_load_dwordx4 v[80:83], v69, s[12:15], s19 offen offset:0 sc1
    buffer_load_dwordx4 v[84:87], v69, s[12:15], s19 offen offset:1024 sc1
    s_add_u32 s21, s21, 4096
    s_add_u32 s19, s19, 4096
    buffer_load_dwordx4 v[116:119], v69, s[12:15], s20 offen offset:0 sc1
    buffer_load_dwordx4 v[120:123], v69, s[12:15], s20 offen offset:1024 sc1
    buffer_load_dwordx4 v[124:127], v69, s[12:15], s20 offen offset:2048 sc1
    buffer_load_dwordx4 v[32:35], v69, s[12:15], s44 offen offset:0 sc1
    buffer_load_dwordx4 v[36:39], v69, s[12:15], s44 offen offset:1024 sc1
    buffer_load_dwordx4 v[40:43], v69, s[12:15], s45 offen offset:0 sc1
    buffer_load_dwordx4 v[44:47], v69, s[12:15], s45 offen offset:1024 sc1
    s_mov_b64 exec, s[46:47]
    buffer_store_dword v113, v112, s[12:15], s74 offen sc1
    s_mov_b64 exec, -1
    s_waitcnt lgkmcnt(0)
    s_barrier
    ds_read_b128 v[136:139], v71 offset:0
    ds_read_b128 v[140:143], v71 offset:1024
    ds_read_b128 v[152:155], v71 offset:2048
    ds_read_b128 v[156:159], v71 offset:3072
    ds_read_b128 v[168:171], v71 offset:4096
    ds_read_b128 v[172:175], v71 offset:5120
    ds_read_b128 v[184:187], v71 offset:6144
    ds_read_b128 v[188:191], v71 offset:7168
    ds_read_b128 v[200:203], v71 offset:8192
    ds_read_b128 v[204:207], v71 offset:9216
    ds_read_b128 v[216:219], v71 offset:10240
    ds_read_b128 v[220:223], v71 offset:11264
    ds_read_b128 v[232:235], v71 offset:12288
    ds_read_b128 v[236:239], v71 offset:13312
    ds_read_b128 v[248:251], v71 offset:14336
    ds_read_b128 v[252:255], v71 offset:15360
    s_waitcnt vmcnt(16)
    v_mfma_f32_16x16x32_bf16 v[48:51], v[0:3], v[128:131], 0
    v_mfma_f32_16x16x32_bf16 v[52:55], v[0:3], v[144:147], 0
    v_mfma_f32_16x16x32_bf16 v[56:59], v[0:3], v[160:163], 0
    v_mfma_f32_16x16x32_bf16 v[60:63], v[0:3], v[176:179], 0
    v_mfma_f32_16x16x32_bf16 v[88:91], v[0:3], v[192:195], 0
    v_mfma_f32_16x16x32_bf16 v[92:95], v[0:3], v[208:211], 0
    v_mfma_f32_16x16x32_bf16 v[96:99], v[0:3], v[224:227], 0
    v_mfma_f32_16x16x32_bf16 v[100:103], v[0:3], v[240:243], 0
    v_mfma_f32_16x16x32_bf16 v[48:51], v[4:7], v[132:135], v[48:51]
    v_mfma_f32_16x16x32_bf16 v[52:55], v[4:7], v[148:151], v[52:55]
    v_mfma_f32_16x16x32_bf16 v[56:59], v[4:7], v[164:167], v[56:59]
    v_mfma_f32_16x16x32_bf16 v[60:63], v[4:7], v[180:183], v[60:63]
    v_mfma_f32_16x16x32_bf16 v[88:91], v[4:7], v[196:199], v[88:91]
    v_mfma_f32_16x16x32_bf16 v[92:95], v[4:7], v[212:215], v[92:95]
    v_mfma_f32_16x16x32_bf16 v[96:99], v[4:7], v[228:231], v[96:99]
    v_mfma_f32_16x16x32_bf16 v[100:103], v[4:7], v[244:247], v[100:103]

    s_lshl_b32 s24, s36, 16
    s_and_b32 s25, s36, 0xffff0000
    s_lshl_b32 s26, s37, 16
    s_and_b32 s27, s37, 0xffff0000

    s_waitcnt lgkmcnt(12)
    v_mfma_f32_16x16x32_bf16 v[48:51], v[8:11], v[136:139], v[48:51]
    v_mfma_f32_16x16x32_bf16 v[52:55], v[8:11], v[152:155], v[52:55]
    v_mfma_f32_16x16x32_bf16 v[48:51], v[12:15], v[140:143], v[48:51]
    v_mfma_f32_16x16x32_bf16 v[52:55], v[12:15], v[156:159], v[52:55]
    s_waitcnt lgkmcnt(8)
    v_mfma_f32_16x16x32_bf16 v[56:59], v[8:11], v[168:171], v[56:59]
    v_mfma_f32_16x16x32_bf16 v[60:63], v[8:11], v[184:187], v[60:63]
    v_mfma_f32_16x16x32_bf16 v[56:59], v[12:15], v[172:175], v[56:59]
    v_mfma_f32_16x16x32_bf16 v[60:63], v[12:15], v[188:191], v[60:63]
    s_waitcnt lgkmcnt(4)
    v_mfma_f32_16x16x32_bf16 v[88:91], v[8:11], v[200:203], v[88:91]
    v_mfma_f32_16x16x32_bf16 v[92:95], v[8:11], v[216:219], v[92:95]
    v_mfma_f32_16x16x32_bf16 v[88:91], v[12:15], v[204:207], v[88:91]
    v_mfma_f32_16x16x32_bf16 v[92:95], v[12:15], v[220:223], v[92:95]
    v_cvt_pk_bf16_f32 v48, v48, v49
    v_cvt_pk_bf16_f32 v49, v50, v51
    ds_write_b64 v70, v[48:49] offset:0
    v_cvt_pk_bf16_f32 v52, v52, v53
    v_cvt_pk_bf16_f32 v53, v54, v55
    ds_write_b64 v70, v[52:53] offset:128
    s_waitcnt lgkmcnt(2)
    v_mfma_f32_16x16x32_bf16 v[96:99], v[8:11], v[232:235], v[96:99]
    v_mfma_f32_16x16x32_bf16 v[100:103], v[8:11], v[248:251], v[100:103]
    v_mfma_f32_16x16x32_bf16 v[96:99], v[12:15], v[236:239], v[96:99]
    v_mfma_f32_16x16x32_bf16 v[100:103], v[12:15], v[252:255], v[100:103]
    v_cvt_pk_bf16_f32 v56, v56, v57
    v_cvt_pk_bf16_f32 v57, v58, v59
    ds_write_b64 v70, v[56:57] offset:256
    v_cvt_pk_bf16_f32 v60, v60, v61
    v_cvt_pk_bf16_f32 v61, v62, v63
    ds_write_b64 v70, v[60:61] offset:384
    s_nop 3
    v_cvt_pk_bf16_f32 v88, v88, v89
    v_cvt_pk_bf16_f32 v89, v90, v91
    ds_write_b64 v70, v[88:89] offset:512
    v_cvt_pk_bf16_f32 v92, v92, v93
    v_cvt_pk_bf16_f32 v93, v94, v95
    ds_write_b64 v70, v[92:93] offset:640
    s_nop 3
    v_cvt_pk_bf16_f32 v96, v96, v97
    v_cvt_pk_bf16_f32 v97, v98, v99
    ds_write_b64 v70, v[96:97] offset:768
    v_cvt_pk_bf16_f32 v100, v100, v101
    v_cvt_pk_bf16_f32 v101, v102, v103
    ds_write_b64 v70, v[100:101] offset:896
    v_add_u32 v70, 0x8000, v70
    s_waitcnt vmcnt(12)
    v_mfma_f32_16x16x32_bf16 v[104:107], v[16:19], v[128:131], 0
    v_mfma_f32_16x16x32_bf16 v[108:111], v[16:19], v[144:147], 0
    v_mfma_f32_16x16x32_bf16 v[104:107], v[20:23], v[132:135], v[104:107]
    v_mfma_f32_16x16x32_bf16 v[108:111], v[20:23], v[148:151], v[108:111]
    v_mfma_f32_16x16x32_bf16 v[104:107], v[24:27], v[136:139], v[104:107]
    v_mov_b32 v48, s24
    v_mfma_f32_16x16x32_bf16 v[108:111], v[24:27], v[152:155], v[108:111]
    v_mov_b32 v49, s25
    v_mfma_f32_16x16x32_bf16 v[104:107], v[28:31], v[140:143], v[104:107]
    v_mov_b32 v50, s26
    v_mfma_f32_16x16x32_bf16 v[108:111], v[28:31], v[156:159], v[108:111]
    v_mov_b32 v51, s27
    v_mfma_f32_16x16x32_bf16 v[88:91], v[16:19], v[160:163], 0
    v_mov_b32 v52, s24
    v_mfma_f32_16x16x32_bf16 v[92:95], v[16:19], v[176:179], 0
    v_mov_b32 v53, s25
    v_mfma_f32_16x16x32_bf16 v[88:91], v[20:23], v[164:167], v[88:91]
    v_cvt_pk_bf16_f32 v104, v104, v105
    v_mov_b32 v54, s26
    v_mfma_f32_16x16x32_bf16 v[92:95], v[20:23], v[180:183], v[92:95]
    v_cvt_pk_bf16_f32 v105, v106, v107
    v_mov_b32 v55, s27
    v_mfma_f32_16x16x32_bf16 v[88:91], v[24:27], v[168:171], v[88:91]
    ds_write_b64 v70, v[104:105] offset:0
    v_mov_b32 v56, s24
    v_mfma_f32_16x16x32_bf16 v[92:95], v[24:27], v[184:187], v[92:95]
    v_cvt_pk_bf16_f32 v108, v108, v109
    v_mov_b32 v57, s25
    v_mfma_f32_16x16x32_bf16 v[88:91], v[28:31], v[172:175], v[88:91]
    v_cvt_pk_bf16_f32 v109, v110, v111
    v_mov_b32 v58, s26
    v_mfma_f32_16x16x32_bf16 v[92:95], v[28:31], v[188:191], v[92:95]
    ds_write_b64 v70, v[108:109] offset:128
    v_mov_b32 v59, s27
    v_mfma_f32_16x16x32_bf16 v[96:99], v[16:19], v[192:195], 0
    v_mov_b32 v60, s24
    v_mfma_f32_16x16x32_bf16 v[100:103], v[16:19], v[208:211], 0
    v_mov_b32 v61, s25
    v_mfma_f32_16x16x32_bf16 v[96:99], v[20:23], v[196:199], v[96:99]
    v_cvt_pk_bf16_f32 v88, v88, v89
    v_mov_b32 v62, s26
    v_mfma_f32_16x16x32_bf16 v[100:103], v[20:23], v[212:215], v[100:103]
    v_cvt_pk_bf16_f32 v89, v90, v91
    v_mov_b32 v63, s27
    v_mfma_f32_16x16x32_bf16 v[96:99], v[24:27], v[200:203], v[96:99]
    ds_write_b64 v70, v[88:89] offset:256
    v_mov_b32 v0, s24
    v_mfma_f32_16x16x32_bf16 v[100:103], v[24:27], v[216:219], v[100:103]
    v_cvt_pk_bf16_f32 v92, v92, v93
    v_mov_b32 v1, s25
    v_mfma_f32_16x16x32_bf16 v[96:99], v[28:31], v[204:207], v[96:99]
    v_cvt_pk_bf16_f32 v93, v94, v95
    v_mov_b32 v2, s26
    v_mfma_f32_16x16x32_bf16 v[100:103], v[28:31], v[220:223], v[100:103]
    ds_write_b64 v70, v[92:93] offset:384
    v_mov_b32 v3, s27
    v_mfma_f32_16x16x32_bf16 v[104:107], v[16:19], v[224:227], 0
    v_mov_b32 v4, s24
    v_mfma_f32_16x16x32_bf16 v[108:111], v[16:19], v[240:243], 0
    v_mov_b32 v5, s25
    v_mfma_f32_16x16x32_bf16 v[104:107], v[20:23], v[228:231], v[104:107]
    v_cvt_pk_bf16_f32 v96, v96, v97
    v_mov_b32 v6, s26
    v_mfma_f32_16x16x32_bf16 v[108:111], v[20:23], v[244:247], v[108:111]
    v_cvt_pk_bf16_f32 v97, v98, v99
    v_mov_b32 v7, s27
    v_mfma_f32_16x16x32_bf16 v[104:107], v[24:27], v[232:235], v[104:107]
    ds_write_b64 v70, v[96:97] offset:512
    v_mov_b32 v8, s24
    v_mfma_f32_16x16x32_bf16 v[108:111], v[24:27], v[248:251], v[108:111]
    v_cvt_pk_bf16_f32 v100, v100, v101
    v_mov_b32 v9, s25
    v_mfma_f32_16x16x32_bf16 v[104:107], v[28:31], v[236:239], v[104:107]
    v_cvt_pk_bf16_f32 v101, v102, v103
    v_mov_b32 v10, s26
    v_mfma_f32_16x16x32_bf16 v[108:111], v[28:31], v[252:255], v[108:111]
    ds_write_b64 v70, v[100:101] offset:640
    v_mov_b32 v11, s27
    s_waitcnt vmcnt(1)
    v_mfma_f32_16x16x32_bf16 v[88:91], v[32:35], v[128:131], 0
    v_mfma_f32_16x16x32_bf16 v[92:95], v[32:35], v[144:147], 0
    v_mfma_f32_16x16x32_bf16 v[88:91], v[36:39], v[132:135], v[88:91]
    v_cvt_pk_bf16_f32 v104, v104, v105
    v_mfma_f32_16x16x32_bf16 v[92:95], v[36:39], v[148:151], v[92:95]
    v_cvt_pk_bf16_f32 v105, v106, v107
    v_mfma_f32_16x16x32_bf16 v[88:91], v[40:43], v[136:139], v[88:91]
    ds_write_b64 v70, v[104:105] offset:768
    v_mov_b32 v12, s24
    v_mfma_f32_16x16x32_bf16 v[92:95], v[40:43], v[152:155], v[92:95]
    v_cvt_pk_bf16_f32 v108, v108, v109
    v_mov_b32 v13, s25
    v_mfma_f32_16x16x32_bf16 v[88:91], v[44:47], v[140:143], v[88:91]
    v_cvt_pk_bf16_f32 v109, v110, v111
    v_mov_b32 v14, s26
    v_mfma_f32_16x16x32_bf16 v[92:95], v[44:47], v[156:159], v[92:95]
    ds_write_b64 v70, v[108:109] offset:896
    v_mov_b32 v15, s27
    v_mfma_f32_16x16x32_bf16 v[96:99], v[32:35], v[160:163], 0
    v_mov_b32 v16, s24
    v_mfma_f32_16x16x32_bf16 v[100:103], v[32:35], v[176:179], 0
    v_mov_b32 v17, s25
    v_mfma_f32_16x16x32_bf16 v[96:99], v[36:39], v[164:167], v[96:99]
    v_cvt_pk_bf16_f32 v88, v88, v89
    v_mov_b32 v18, s26
    v_mfma_f32_16x16x32_bf16 v[100:103], v[36:39], v[180:183], v[100:103]
    v_cvt_pk_bf16_f32 v89, v90, v91
    v_mov_b32 v19, s27
    v_mfma_f32_16x16x32_bf16 v[96:99], v[40:43], v[168:171], v[96:99]
    ds_write_b64 v70, v[88:89] offset:32768
    v_mov_b32 v20, s24
    v_mfma_f32_16x16x32_bf16 v[100:103], v[40:43], v[184:187], v[100:103]
    v_cvt_pk_bf16_f32 v92, v92, v93
    v_mov_b32 v21, s25
    v_mfma_f32_16x16x32_bf16 v[96:99], v[44:47], v[172:175], v[96:99]
    v_cvt_pk_bf16_f32 v93, v94, v95
    v_mov_b32 v22, s26
    v_mfma_f32_16x16x32_bf16 v[100:103], v[44:47], v[188:191], v[100:103]
    ds_write_b64 v70, v[92:93] offset:32896
    v_mov_b32 v23, s27
    v_mfma_f32_16x16x32_bf16 v[104:107], v[32:35], v[192:195], 0
    v_mov_b32 v24, s24
    v_mfma_f32_16x16x32_bf16 v[108:111], v[32:35], v[208:211], 0
    v_mov_b32 v25, s25
    v_mfma_f32_16x16x32_bf16 v[104:107], v[36:39], v[196:199], v[104:107]
    v_cvt_pk_bf16_f32 v96, v96, v97
    v_mov_b32 v26, s26
    v_mfma_f32_16x16x32_bf16 v[108:111], v[36:39], v[212:215], v[108:111]
    v_cvt_pk_bf16_f32 v97, v98, v99
    v_mov_b32 v27, s27
    v_mfma_f32_16x16x32_bf16 v[104:107], v[40:43], v[200:203], v[104:107]
    ds_write_b64 v70, v[96:97] offset:33024
    v_mov_b32 v28, s24
    v_mfma_f32_16x16x32_bf16 v[108:111], v[40:43], v[216:219], v[108:111]
    v_cvt_pk_bf16_f32 v100, v100, v101
    v_mov_b32 v29, s25
    v_mfma_f32_16x16x32_bf16 v[104:107], v[44:47], v[204:207], v[104:107]
    v_cvt_pk_bf16_f32 v101, v102, v103
    v_mov_b32 v30, s26
    v_mfma_f32_16x16x32_bf16 v[108:111], v[44:47], v[220:223], v[108:111]
    ds_write_b64 v70, v[100:101] offset:33152
    v_mov_b32 v31, s27
    v_mfma_f32_16x16x32_bf16 v[88:91], v[32:35], v[224:227], 0
    s_nop 0
    v_mfma_f32_16x16x32_bf16 v[92:95], v[32:35], v[240:243], 0
    s_nop 0
    v_mfma_f32_16x16x32_bf16 v[88:91], v[36:39], v[228:231], v[88:91]
    v_cvt_pk_bf16_f32 v104, v104, v105
    s_nop 0
    v_mfma_f32_16x16x32_bf16 v[92:95], v[36:39], v[244:247], v[92:95]
    v_cvt_pk_bf16_f32 v105, v106, v107
    s_nop 0
    v_mfma_f32_16x16x32_bf16 v[88:91], v[40:43], v[232:235], v[88:91]
    ds_write_b64 v70, v[104:105] offset:33280
    s_nop 0
    v_mfma_f32_16x16x32_bf16 v[92:95], v[40:43], v[248:251], v[92:95]
    v_cvt_pk_bf16_f32 v108, v108, v109
    s_nop 0
    v_mfma_f32_16x16x32_bf16 v[88:91], v[44:47], v[236:239], v[88:91]
    v_cvt_pk_bf16_f32 v109, v110, v111
    s_nop 0
    v_mfma_f32_16x16x32_bf16 v[92:95], v[44:47], v[252:255], v[92:95]
    ds_write_b64 v70, v[108:109] offset:33408
    s_nop 0
    v_mov_b32 v32, s24
    v_mov_b32 v33, s25
    v_mov_b32 v34, s26
    v_mov_b32 v35, s27
    v_mov_b32 v36, s24
    v_mov_b32 v37, s25
    v_mov_b32 v38, s26
    v_mov_b32 v39, s27
    v_mov_b32 v40, s24
    v_mov_b32 v41, s25
    v_mov_b32 v42, s26
    v_mov_b32 v43, s27
    v_mov_b32 v44, s24
    v_mov_b32 v45, s25
    v_mov_b32 v46, s26
    v_mov_b32 v47, s27
    s_nop 7
    v_cvt_pk_bf16_f32 v88, v88, v89
    v_cvt_pk_bf16_f32 v89, v90, v91
    ds_write_b64 v70, v[88:89] offset:33536
    v_cvt_pk_bf16_f32 v92, v92, v93
    v_cvt_pk_bf16_f32 v93, v94, v95
    ds_write_b64 v70, v[92:93] offset:33664
    v_add_u32 v70, 0x10000, v70
standalone__deep_cross_pnn__recsys_kernel_k2j:

    s_mov_b32 s22, 0
    s_mov_b32 s23, 3
    s_waitcnt lgkmcnt(0)
    s_barrier

    v_lshlrev_b32_sdwa v88, 3, v116 dst_sel:DWORD dst_unused:UNUSED_PAD src0_sel:DWORD src1_sel:WORD_0
    v_lshlrev_b32_sdwa v90, 3, v116 dst_sel:DWORD dst_unused:UNUSED_PAD src0_sel:DWORD src1_sel:WORD_1
    v_lshlrev_b32_sdwa v92, 3, v117 dst_sel:DWORD dst_unused:UNUSED_PAD src0_sel:DWORD src1_sel:WORD_0
    v_lshlrev_b32_sdwa v94, 3, v117 dst_sel:DWORD dst_unused:UNUSED_PAD src0_sel:DWORD src1_sel:WORD_1
    ds_read_b64 v[88:89], v88
    ds_read_b64 v[90:91], v90
    ds_read_b64 v[92:93], v92
    ds_read_b64 v[94:95], v94
    v_lshlrev_b32_sdwa v96, 3, v118 dst_sel:DWORD dst_unused:UNUSED_PAD src0_sel:DWORD src1_sel:WORD_0
    v_lshlrev_b32_sdwa v98, 3, v118 dst_sel:DWORD dst_unused:UNUSED_PAD src0_sel:DWORD src1_sel:WORD_1
    v_lshlrev_b32_sdwa v100, 3, v119 dst_sel:DWORD dst_unused:UNUSED_PAD src0_sel:DWORD src1_sel:WORD_0
    v_lshlrev_b32_sdwa v102, 3, v119 dst_sel:DWORD dst_unused:UNUSED_PAD src0_sel:DWORD src1_sel:WORD_1
    ds_read_b64 v[96:97], v96
    ds_read_b64 v[98:99], v98
    ds_read_b64 v[100:101], v100
    ds_read_b64 v[102:103], v102
    buffer_load_dwordx4 v[116:119], v69, s[12:15], s20 offen offset:3072 sc1
    s_add_u32 s20, s20, 4096
standalone__deep_cross_pnn__recsys_kernel_gloop:
    s_setprio 3
    s_waitcnt vmcnt(6)
    v_lshlrev_b32_sdwa v104, 3, v120 dst_sel:DWORD dst_unused:UNUSED_PAD src0_sel:DWORD src1_sel:WORD_0
    v_lshlrev_b32_sdwa v106, 3, v120 dst_sel:DWORD dst_unused:UNUSED_PAD src0_sel:DWORD src1_sel:WORD_1
    ds_read_b64 v[104:105], v104
    ds_read_b64 v[106:107], v106
    v_lshlrev_b32_sdwa v108, 3, v121 dst_sel:DWORD dst_unused:UNUSED_PAD src0_sel:DWORD src1_sel:WORD_0
    v_lshlrev_b32_sdwa v110, 3, v121 dst_sel:DWORD dst_unused:UNUSED_PAD src0_sel:DWORD src1_sel:WORD_1
    ds_read_b64 v[108:109], v108
    ds_read_b64 v[110:111], v110
    s_waitcnt lgkmcnt(8)
    v_smfmac_f32_16x16x64_bf16 v[0:3], v[64:67], v[88:95], v68
    s_waitcnt vmcnt(5)
    v_mfma_f32_16x16x32_bf16 v[112:115], v[72:75], v[128:131], 0
    v_lshlrev_b32_sdwa v88, 3, v122 dst_sel:DWORD dst_unused:UNUSED_PAD src0_sel:DWORD src1_sel:WORD_0
    v_lshlrev_b32_sdwa v90, 3, v122 dst_sel:DWORD dst_unused:UNUSED_PAD src0_sel:DWORD src1_sel:WORD_1
    ds_read_b64 v[88:89], v88
    ds_read_b64 v[90:91], v90
    s_waitcnt vmcnt(4)
    v_mfma_f32_16x16x32_bf16 v[112:115], v[76:79], v[132:135], v[112:115]
    v_lshlrev_b32_sdwa v92, 3, v123 dst_sel:DWORD dst_unused:UNUSED_PAD src0_sel:DWORD src1_sel:WORD_0
    v_lshlrev_b32_sdwa v94, 3, v123 dst_sel:DWORD dst_unused:UNUSED_PAD src0_sel:DWORD src1_sel:WORD_1
    ds_read_b64 v[92:93], v92
    ds_read_b64 v[94:95], v94
    buffer_load_dwordx4 v[120:123], v69, s[12:15], s20 offen offset:0 sc1
    s_waitcnt lgkmcnt(8)
    v_smfmac_f32_16x16x64_bf16 v[4:7], v[64:67], v[96:103], v68
    s_waitcnt vmcnt(4)
    v_mfma_f32_16x16x32_bf16 v[112:115], v[80:83], v[136:139], v[112:115]
    s_waitcnt vmcnt(2)
    v_lshlrev_b32_sdwa v96, 3, v124 dst_sel:DWORD dst_unused:UNUSED_PAD src0_sel:DWORD src1_sel:WORD_0
    v_lshlrev_b32_sdwa v98, 3, v124 dst_sel:DWORD dst_unused:UNUSED_PAD src0_sel:DWORD src1_sel:WORD_1
    ds_read_b64 v[96:97], v96
    ds_read_b64 v[98:99], v98
    s_waitcnt vmcnt(3)
    v_mfma_f32_16x16x32_bf16 v[112:115], v[84:87], v[140:143], v[112:115]
    v_lshlrev_b32_sdwa v100, 3, v125 dst_sel:DWORD dst_unused:UNUSED_PAD src0_sel:DWORD src1_sel:WORD_0
    v_lshlrev_b32_sdwa v102, 3, v125 dst_sel:DWORD dst_unused:UNUSED_PAD src0_sel:DWORD src1_sel:WORD_1
    ds_read_b64 v[100:101], v100
    ds_read_b64 v[102:103], v102
    s_waitcnt lgkmcnt(8)
    v_smfmac_f32_16x16x64_bf16 v[8:11], v[64:67], v[104:111], v68
    s_nop 1
    v_cvt_pk_bf16_f32 v112, v112, v113
    v_cvt_pk_bf16_f32 v113, v114, v115
    ds_write_b64 v70, v[112:113] offset:0
    v_mfma_f32_16x16x32_bf16 v[112:115], v[72:75], v[144:147], 0
    v_mfma_f32_16x16x32_bf16 v[112:115], v[76:79], v[148:151], v[112:115]
    v_lshlrev_b32_sdwa v104, 3, v126 dst_sel:DWORD dst_unused:UNUSED_PAD src0_sel:DWORD src1_sel:WORD_0
    v_lshlrev_b32_sdwa v106, 3, v126 dst_sel:DWORD dst_unused:UNUSED_PAD src0_sel:DWORD src1_sel:WORD_1
    ds_read_b64 v[104:105], v104
    ds_read_b64 v[106:107], v106
    v_mfma_f32_16x16x32_bf16 v[112:115], v[80:83], v[152:155], v[112:115]
    v_mfma_f32_16x16x32_bf16 v[112:115], v[84:87], v[156:159], v[112:115]
    v_lshlrev_b32_sdwa v108, 3, v127 dst_sel:DWORD dst_unused:UNUSED_PAD src0_sel:DWORD src1_sel:WORD_0
    v_lshlrev_b32_sdwa v110, 3, v127 dst_sel:DWORD dst_unused:UNUSED_PAD src0_sel:DWORD src1_sel:WORD_1
    ds_read_b64 v[108:109], v108
    ds_read_b64 v[110:111], v110
    buffer_load_dwordx4 v[124:127], v69, s[12:15], s20 offen offset:1024 sc1
    s_waitcnt lgkmcnt(9)
    v_smfmac_f32_16x16x64_bf16 v[12:15], v[64:67], v[88:95], v68
    s_nop 0
    v_cvt_pk_bf16_f32 v112, v112, v113
    v_cvt_pk_bf16_f32 v113, v114, v115
    ds_write_b64 v70, v[112:113] offset:128
    v_mfma_f32_16x16x32_bf16 v[112:115], v[72:75], v[160:163], 0
    s_waitcnt vmcnt(2)
    v_lshlrev_b32_sdwa v88, 3, v116 dst_sel:DWORD dst_unused:UNUSED_PAD src0_sel:DWORD src1_sel:WORD_0
    v_lshlrev_b32_sdwa v90, 3, v116 dst_sel:DWORD dst_unused:UNUSED_PAD src0_sel:DWORD src1_sel:WORD_1
    ds_read_b64 v[88:89], v88
    ds_read_b64 v[90:91], v90
    v_mfma_f32_16x16x32_bf16 v[112:115], v[76:79], v[164:167], v[112:115]
    v_lshlrev_b32_sdwa v92, 3, v117 dst_sel:DWORD dst_unused:UNUSED_PAD src0_sel:DWORD src1_sel:WORD_0
    v_lshlrev_b32_sdwa v94, 3, v117 dst_sel:DWORD dst_unused:UNUSED_PAD src0_sel:DWORD src1_sel:WORD_1
    ds_read_b64 v[92:93], v92
    ds_read_b64 v[94:95], v94
    s_waitcnt lgkmcnt(10)
    v_smfmac_f32_16x16x64_bf16 v[16:19], v[64:67], v[96:103], v68
    v_mfma_f32_16x16x32_bf16 v[112:115], v[80:83], v[168:171], v[112:115]
    v_lshlrev_b32_sdwa v96, 3, v118 dst_sel:DWORD dst_unused:UNUSED_PAD src0_sel:DWORD src1_sel:WORD_0
    v_lshlrev_b32_sdwa v98, 3, v118 dst_sel:DWORD dst_unused:UNUSED_PAD src0_sel:DWORD src1_sel:WORD_1
    ds_read_b64 v[96:97], v96
    ds_read_b64 v[98:99], v98
    v_mfma_f32_16x16x32_bf16 v[112:115], v[84:87], v[172:175], v[112:115]
    v_lshlrev_b32_sdwa v100, 3, v119 dst_sel:DWORD dst_unused:UNUSED_PAD src0_sel:DWORD src1_sel:WORD_0
    v_lshlrev_b32_sdwa v102, 3, v119 dst_sel:DWORD dst_unused:UNUSED_PAD src0_sel:DWORD src1_sel:WORD_1
    ds_read_b64 v[100:101], v100
    ds_read_b64 v[102:103], v102
    buffer_load_dwordx4 v[116:119], v69, s[12:15], s20 offen offset:2048 sc1
    s_waitcnt lgkmcnt(9)
    v_smfmac_f32_16x16x64_bf16 v[20:23], v[64:67], v[104:111], v68
    s_nop 0
    v_cvt_pk_bf16_f32 v112, v112, v113
    v_cvt_pk_bf16_f32 v113, v114, v115
    ds_write_b64 v70, v[112:113] offset:256
    v_mfma_f32_16x16x32_bf16 v[112:115], v[72:75], v[176:179], 0
    v_mfma_f32_16x16x32_bf16 v[112:115], v[76:79], v[180:183], v[112:115]
    s_waitcnt vmcnt(2)
    v_lshlrev_b32_sdwa v104, 3, v120 dst_sel:DWORD dst_unused:UNUSED_PAD src0_sel:DWORD src1_sel:WORD_0
    v_lshlrev_b32_sdwa v106, 3, v120 dst_sel:DWORD dst_unused:UNUSED_PAD src0_sel:DWORD src1_sel:WORD_1
    ds_read_b64 v[104:105], v104
    ds_read_b64 v[106:107], v106
    v_mfma_f32_16x16x32_bf16 v[112:115], v[80:83], v[184:187], v[112:115]
    v_mfma_f32_16x16x32_bf16 v[112:115], v[84:87], v[188:191], v[112:115]
    v_lshlrev_b32_sdwa v108, 3, v121 dst_sel:DWORD dst_unused:UNUSED_PAD src0_sel:DWORD src1_sel:WORD_0
    v_lshlrev_b32_sdwa v110, 3, v121 dst_sel:DWORD dst_unused:UNUSED_PAD src0_sel:DWORD src1_sel:WORD_1
    ds_read_b64 v[108:109], v108
    ds_read_b64 v[110:111], v110
    s_waitcnt lgkmcnt(9)
    v_smfmac_f32_16x16x64_bf16 v[24:27], v[64:67], v[88:95], v68
    s_nop 1
    v_cvt_pk_bf16_f32 v112, v112, v113
    v_cvt_pk_bf16_f32 v113, v114, v115
    ds_write_b64 v70, v[112:113] offset:384
    v_mfma_f32_16x16x32_bf16 v[112:115], v[72:75], v[192:195], 0
    v_lshlrev_b32_sdwa v88, 3, v122 dst_sel:DWORD dst_unused:UNUSED_PAD src0_sel:DWORD src1_sel:WORD_0
    v_lshlrev_b32_sdwa v90, 3, v122 dst_sel:DWORD dst_unused:UNUSED_PAD src0_sel:DWORD src1_sel:WORD_1
    ds_read_b64 v[88:89], v88
    ds_read_b64 v[90:91], v90
    v_mfma_f32_16x16x32_bf16 v[112:115], v[76:79], v[196:199], v[112:115]
    v_lshlrev_b32_sdwa v92, 3, v123 dst_sel:DWORD dst_unused:UNUSED_PAD src0_sel:DWORD src1_sel:WORD_0
    v_lshlrev_b32_sdwa v94, 3, v123 dst_sel:DWORD dst_unused:UNUSED_PAD src0_sel:DWORD src1_sel:WORD_1
    ds_read_b64 v[92:93], v92
    ds_read_b64 v[94:95], v94
    buffer_load_dwordx4 v[120:123], v69, s[12:15], s20 offen offset:3072 sc1
    s_add_u32 s20, s20, 61440
    s_waitcnt lgkmcnt(10)
    v_smfmac_f32_16x16x64_bf16 v[28:31], v[64:67], v[96:103], v68
    s_setprio 2
    v_mfma_f32_16x16x32_bf16 v[112:115], v[80:83], v[200:203], v[112:115]
    s_waitcnt vmcnt(2)
    v_lshlrev_b32_sdwa v96, 3, v124 dst_sel:DWORD dst_unused:UNUSED_PAD src0_sel:DWORD src1_sel:WORD_0
    v_lshlrev_b32_sdwa v98, 3, v124 dst_sel:DWORD dst_unused:UNUSED_PAD src0_sel:DWORD src1_sel:WORD_1
    ds_read_b64 v[96:97], v96
    ds_read_b64 v[98:99], v98
    v_mfma_f32_16x16x32_bf16 v[112:115], v[84:87], v[204:207], v[112:115]
    v_lshlrev_b32_sdwa v100, 3, v125 dst_sel:DWORD dst_unused:UNUSED_PAD src0_sel:DWORD src1_sel:WORD_0
    v_lshlrev_b32_sdwa v102, 3, v125 dst_sel:DWORD dst_unused:UNUSED_PAD src0_sel:DWORD src1_sel:WORD_1
    ds_read_b64 v[100:101], v100
    ds_read_b64 v[102:103], v102
    s_waitcnt lgkmcnt(9)
    v_smfmac_f32_16x16x64_bf16 v[32:35], v[64:67], v[104:111], v68
    s_nop 1
    v_cvt_pk_bf16_f32 v112, v112, v113
    v_cvt_pk_bf16_f32 v113, v114, v115
    ds_write_b64 v70, v[112:113] offset:512
    v_mfma_f32_16x16x32_bf16 v[112:115], v[72:75], v[208:211], 0
    v_lshlrev_b32_sdwa v104, 3, v126 dst_sel:DWORD dst_unused:UNUSED_PAD src0_sel:DWORD src1_sel:WORD_0
    v_lshlrev_b32_sdwa v106, 3, v126 dst_sel:DWORD dst_unused:UNUSED_PAD src0_sel:DWORD src1_sel:WORD_1
    ds_read_b64 v[104:105], v104
    ds_read_b64 v[106:107], v106
    v_mfma_f32_16x16x32_bf16 v[112:115], v[76:79], v[212:215], v[112:115]
    v_lshlrev_b32_sdwa v108, 3, v127 dst_sel:DWORD dst_unused:UNUSED_PAD src0_sel:DWORD src1_sel:WORD_0
    v_lshlrev_b32_sdwa v110, 3, v127 dst_sel:DWORD dst_unused:UNUSED_PAD src0_sel:DWORD src1_sel:WORD_1
    ds_read_b64 v[108:109], v108
    ds_read_b64 v[110:111], v110
    buffer_load_dwordx4 v[124:127], v69, s[12:15], s20 offen offset:0 sc1
    s_waitcnt lgkmcnt(9)
    v_smfmac_f32_16x16x64_bf16 v[36:39], v[64:67], v[88:95], v68
    v_mfma_f32_16x16x32_bf16 v[112:115], v[80:83], v[216:219], v[112:115]
    s_waitcnt vmcnt(2)
    v_lshlrev_b32_sdwa v88, 3, v116 dst_sel:DWORD dst_unused:UNUSED_PAD src0_sel:DWORD src1_sel:WORD_0
    v_lshlrev_b32_sdwa v90, 3, v116 dst_sel:DWORD dst_unused:UNUSED_PAD src0_sel:DWORD src1_sel:WORD_1
    ds_read_b64 v[88:89], v88
    ds_read_b64 v[90:91], v90
    v_mfma_f32_16x16x32_bf16 v[112:115], v[84:87], v[220:223], v[112:115]
    v_lshlrev_b32_sdwa v92, 3, v117 dst_sel:DWORD dst_unused:UNUSED_PAD src0_sel:DWORD src1_sel:WORD_0
    v_lshlrev_b32_sdwa v94, 3, v117 dst_sel:DWORD dst_unused:UNUSED_PAD src0_sel:DWORD src1_sel:WORD_1
    ds_read_b64 v[92:93], v92
    ds_read_b64 v[94:95], v94
    s_waitcnt lgkmcnt(9)
    v_smfmac_f32_16x16x64_bf16 v[40:43], v[64:67], v[96:103], v68
    s_nop 1
    v_cvt_pk_bf16_f32 v112, v112, v113
    v_cvt_pk_bf16_f32 v113, v114, v115
    ds_write_b64 v70, v[112:113] offset:640
    v_mfma_f32_16x16x32_bf16 v[112:115], v[72:75], v[224:227], 0
    v_mfma_f32_16x16x32_bf16 v[112:115], v[76:79], v[228:231], v[112:115]
    v_lshlrev_b32_sdwa v96, 3, v118 dst_sel:DWORD dst_unused:UNUSED_PAD src0_sel:DWORD src1_sel:WORD_0
    v_lshlrev_b32_sdwa v98, 3, v118 dst_sel:DWORD dst_unused:UNUSED_PAD src0_sel:DWORD src1_sel:WORD_1
    ds_read_b64 v[96:97], v96
    ds_read_b64 v[98:99], v98
    v_mfma_f32_16x16x32_bf16 v[112:115], v[80:83], v[232:235], v[112:115]
    v_mfma_f32_16x16x32_bf16 v[112:115], v[84:87], v[236:239], v[112:115]
    v_lshlrev_b32_sdwa v100, 3, v119 dst_sel:DWORD dst_unused:UNUSED_PAD src0_sel:DWORD src1_sel:WORD_0
    v_lshlrev_b32_sdwa v102, 3, v119 dst_sel:DWORD dst_unused:UNUSED_PAD src0_sel:DWORD src1_sel:WORD_1
    ds_read_b64 v[100:101], v100
    ds_read_b64 v[102:103], v102
    buffer_load_dwordx4 v[116:119], v69, s[12:15], s20 offen offset:1024 sc1
    s_waitcnt lgkmcnt(9)
    v_smfmac_f32_16x16x64_bf16 v[44:47], v[64:67], v[104:111], v68
    s_nop 0
    v_cvt_pk_bf16_f32 v112, v112, v113
    v_cvt_pk_bf16_f32 v113, v114, v115
    ds_write_b64 v70, v[112:113] offset:768
    s_setprio 1
    v_mfma_f32_16x16x32_bf16 v[112:115], v[72:75], v[240:243], 0
    buffer_load_dwordx4 v[72:75], v69, s[12:15], s21 offen offset:0 sc1
    s_waitcnt vmcnt(3)
    v_lshlrev_b32_sdwa v104, 3, v120 dst_sel:DWORD dst_unused:UNUSED_PAD src0_sel:DWORD src1_sel:WORD_0
    v_lshlrev_b32_sdwa v106, 3, v120 dst_sel:DWORD dst_unused:UNUSED_PAD src0_sel:DWORD src1_sel:WORD_1
    ds_read_b64 v[104:105], v104
    ds_read_b64 v[106:107], v106
    v_mfma_f32_16x16x32_bf16 v[112:115], v[76:79], v[244:247], v[112:115]
    buffer_load_dwordx4 v[76:79], v69, s[12:15], s21 offen offset:1024 sc1
    v_lshlrev_b32_sdwa v108, 3, v121 dst_sel:DWORD dst_unused:UNUSED_PAD src0_sel:DWORD src1_sel:WORD_0
    v_lshlrev_b32_sdwa v110, 3, v121 dst_sel:DWORD dst_unused:UNUSED_PAD src0_sel:DWORD src1_sel:WORD_1
    ds_read_b64 v[108:109], v108
    ds_read_b64 v[110:111], v110
    s_waitcnt lgkmcnt(10)
    v_smfmac_f32_16x16x64_bf16 v[48:51], v[64:67], v[88:95], v68
    v_mfma_f32_16x16x32_bf16 v[112:115], v[80:83], v[248:251], v[112:115]
    buffer_load_dwordx4 v[80:83], v69, s[12:15], s19 offen offset:0 sc1
    v_lshlrev_b32_sdwa v88, 3, v122 dst_sel:DWORD dst_unused:UNUSED_PAD src0_sel:DWORD src1_sel:WORD_0
    v_lshlrev_b32_sdwa v90, 3, v122 dst_sel:DWORD dst_unused:UNUSED_PAD src0_sel:DWORD src1_sel:WORD_1
    ds_read_b64 v[88:89], v88
    ds_read_b64 v[90:91], v90
    v_mfma_f32_16x16x32_bf16 v[112:115], v[84:87], v[252:255], v[112:115]
    buffer_load_dwordx4 v[84:87], v69, s[12:15], s19 offen offset:1024 sc1
    s_add_u32 s21, s21, 4096
    s_add_u32 s19, s19, 4096
    v_lshlrev_b32_sdwa v92, 3, v123 dst_sel:DWORD dst_unused:UNUSED_PAD src0_sel:DWORD src1_sel:WORD_0
    v_lshlrev_b32_sdwa v94, 3, v123 dst_sel:DWORD dst_unused:UNUSED_PAD src0_sel:DWORD src1_sel:WORD_1
    ds_read_b64 v[92:93], v92
    ds_read_b64 v[94:95], v94
    buffer_load_dwordx4 v[120:123], v69, s[12:15], s20 offen offset:2048 sc1
    s_waitcnt lgkmcnt(9)
    v_smfmac_f32_16x16x64_bf16 v[52:55], v[64:67], v[96:103], v68
    v_cvt_pk_bf16_f32 v112, v112, v113
    v_cvt_pk_bf16_f32 v113, v114, v115
    ds_write_b64 v70, v[112:113] offset:896
    s_add_u32 s23, s23, 1
    s_cmp_eq_u32 s23, 5
    s_cselect_b32 s35, 4294836224, s32
    s_cselect_b32 s23, 0, s23
    v_add_u32 v70, s35, v70
    s_waitcnt vmcnt(6)
    v_lshlrev_b32_sdwa v96, 3, v124 dst_sel:DWORD dst_unused:UNUSED_PAD src0_sel:DWORD src1_sel:WORD_0
    v_lshlrev_b32_sdwa v98, 3, v124 dst_sel:DWORD dst_unused:UNUSED_PAD src0_sel:DWORD src1_sel:WORD_1
    ds_read_b64 v[96:97], v96
    ds_read_b64 v[98:99], v98
    v_lshlrev_b32_sdwa v100, 3, v125 dst_sel:DWORD dst_unused:UNUSED_PAD src0_sel:DWORD src1_sel:WORD_0
    v_lshlrev_b32_sdwa v102, 3, v125 dst_sel:DWORD dst_unused:UNUSED_PAD src0_sel:DWORD src1_sel:WORD_1
    ds_read_b64 v[100:101], v100
    ds_read_b64 v[102:103], v102
    s_waitcnt lgkmcnt(9)
    v_smfmac_f32_16x16x64_bf16 v[56:59], v[64:67], v[104:111], v68
    s_setprio 0
    v_lshlrev_b32_sdwa v104, 3, v126 dst_sel:DWORD dst_unused:UNUSED_PAD src0_sel:DWORD src1_sel:WORD_0
    v_lshlrev_b32_sdwa v106, 3, v126 dst_sel:DWORD dst_unused:UNUSED_PAD src0_sel:DWORD src1_sel:WORD_1
    ds_read_b64 v[104:105], v104
    ds_read_b64 v[106:107], v106
    v_lshlrev_b32_sdwa v108, 3, v127 dst_sel:DWORD dst_unused:UNUSED_PAD src0_sel:DWORD src1_sel:WORD_0
    v_lshlrev_b32_sdwa v110, 3, v127 dst_sel:DWORD dst_unused:UNUSED_PAD src0_sel:DWORD src1_sel:WORD_1
    ds_read_b64 v[108:109], v108
    ds_read_b64 v[110:111], v110
    buffer_load_dwordx4 v[124:127], v69, s[12:15], s20 offen offset:3072 sc1
    s_add_u32 s20, s20, 4096
    s_waitcnt lgkmcnt(9)
    v_smfmac_f32_16x16x64_bf16 v[60:63], v[64:67], v[88:95], v68
    s_waitcnt lgkmcnt(8)
    s_barrier

    s_cmp_eq_u32 s22, 7
    s_cbranch_scc1 standalone__deep_cross_pnn__recsys_kernel_fin

    s_setprio 3
    s_waitcnt vmcnt(6)
    v_lshlrev_b32_sdwa v88, 3, v116 dst_sel:DWORD dst_unused:UNUSED_PAD src0_sel:DWORD src1_sel:WORD_0
    v_lshlrev_b32_sdwa v90, 3, v116 dst_sel:DWORD dst_unused:UNUSED_PAD src0_sel:DWORD src1_sel:WORD_1
    ds_read_b64 v[88:89], v88
    ds_read_b64 v[90:91], v90
    v_lshlrev_b32_sdwa v92, 3, v117 dst_sel:DWORD dst_unused:UNUSED_PAD src0_sel:DWORD src1_sel:WORD_0
    v_lshlrev_b32_sdwa v94, 3, v117 dst_sel:DWORD dst_unused:UNUSED_PAD src0_sel:DWORD src1_sel:WORD_1
    ds_read_b64 v[92:93], v92
    ds_read_b64 v[94:95], v94
    s_waitcnt lgkmcnt(8)
    v_smfmac_f32_16x16x64_bf16 v[0:3], v[64:67], v[96:103], v68
    s_waitcnt vmcnt(5)
    v_mfma_f32_16x16x32_bf16 v[112:115], v[72:75], v[128:131], 0
    v_lshlrev_b32_sdwa v96, 3, v118 dst_sel:DWORD dst_unused:UNUSED_PAD src0_sel:DWORD src1_sel:WORD_0
    v_lshlrev_b32_sdwa v98, 3, v118 dst_sel:DWORD dst_unused:UNUSED_PAD src0_sel:DWORD src1_sel:WORD_1
    ds_read_b64 v[96:97], v96
    ds_read_b64 v[98:99], v98
    s_waitcnt vmcnt(4)
    v_mfma_f32_16x16x32_bf16 v[112:115], v[76:79], v[132:135], v[112:115]
    v_lshlrev_b32_sdwa v100, 3, v119 dst_sel:DWORD dst_unused:UNUSED_PAD src0_sel:DWORD src1_sel:WORD_0
    v_lshlrev_b32_sdwa v102, 3, v119 dst_sel:DWORD dst_unused:UNUSED_PAD src0_sel:DWORD src1_sel:WORD_1
    ds_read_b64 v[100:101], v100
    ds_read_b64 v[102:103], v102
    buffer_load_dwordx4 v[116:119], v69, s[12:15], s20 offen offset:0 sc1
    s_waitcnt lgkmcnt(8)
    v_smfmac_f32_16x16x64_bf16 v[4:7], v[64:67], v[104:111], v68
    s_waitcnt vmcnt(4)
    v_mfma_f32_16x16x32_bf16 v[112:115], v[80:83], v[136:139], v[112:115]
    s_waitcnt vmcnt(2)
    v_lshlrev_b32_sdwa v104, 3, v120 dst_sel:DWORD dst_unused:UNUSED_PAD src0_sel:DWORD src1_sel:WORD_0
    v_lshlrev_b32_sdwa v106, 3, v120 dst_sel:DWORD dst_unused:UNUSED_PAD src0_sel:DWORD src1_sel:WORD_1
    ds_read_b64 v[104:105], v104
    ds_read_b64 v[106:107], v106
    s_waitcnt vmcnt(3)
    v_mfma_f32_16x16x32_bf16 v[112:115], v[84:87], v[140:143], v[112:115]
    v_lshlrev_b32_sdwa v108, 3, v121 dst_sel:DWORD dst_unused:UNUSED_PAD src0_sel:DWORD src1_sel:WORD_0
    v_lshlrev_b32_sdwa v110, 3, v121 dst_sel:DWORD dst_unused:UNUSED_PAD src0_sel:DWORD src1_sel:WORD_1
    ds_read_b64 v[108:109], v108
    ds_read_b64 v[110:111], v110
    s_waitcnt lgkmcnt(8)
    v_smfmac_f32_16x16x64_bf16 v[8:11], v[64:67], v[88:95], v68
    s_nop 1
    v_cvt_pk_bf16_f32 v112, v112, v113
    v_cvt_pk_bf16_f32 v113, v114, v115
    ds_write_b64 v70, v[112:113] offset:0
    v_mfma_f32_16x16x32_bf16 v[112:115], v[72:75], v[144:147], 0
    v_mfma_f32_16x16x32_bf16 v[112:115], v[76:79], v[148:151], v[112:115]
    v_lshlrev_b32_sdwa v88, 3, v122 dst_sel:DWORD dst_unused:UNUSED_PAD src0_sel:DWORD src1_sel:WORD_0
    v_lshlrev_b32_sdwa v90, 3, v122 dst_sel:DWORD dst_unused:UNUSED_PAD src0_sel:DWORD src1_sel:WORD_1
    ds_read_b64 v[88:89], v88
    ds_read_b64 v[90:91], v90
    v_mfma_f32_16x16x32_bf16 v[112:115], v[80:83], v[152:155], v[112:115]
    v_mfma_f32_16x16x32_bf16 v[112:115], v[84:87], v[156:159], v[112:115]
    v_lshlrev_b32_sdwa v92, 3, v123 dst_sel:DWORD dst_unused:UNUSED_PAD src0_sel:DWORD src1_sel:WORD_0
    v_lshlrev_b32_sdwa v94, 3, v123 dst_sel:DWORD dst_unused:UNUSED_PAD src0_sel:DWORD src1_sel:WORD_1
    ds_read_b64 v[92:93], v92
    ds_read_b64 v[94:95], v94
    buffer_load_dwordx4 v[120:123], v69, s[12:15], s20 offen offset:1024 sc1
    s_waitcnt lgkmcnt(9)
    v_smfmac_f32_16x16x64_bf16 v[12:15], v[64:67], v[96:103], v68
    s_nop 0
    v_cvt_pk_bf16_f32 v112, v112, v113
    v_cvt_pk_bf16_f32 v113, v114, v115
    ds_write_b64 v70, v[112:113] offset:128
    v_mfma_f32_16x16x32_bf16 v[112:115], v[72:75], v[160:163], 0
    s_waitcnt vmcnt(2)
    v_lshlrev_b32_sdwa v96, 3, v124 dst_sel:DWORD dst_unused:UNUSED_PAD src0_sel:DWORD src1_sel:WORD_0
    v_lshlrev_b32_sdwa v98, 3, v124 dst_sel:DWORD dst_unused:UNUSED_PAD src0_sel:DWORD src1_sel:WORD_1
    ds_read_b64 v[96:97], v96
    ds_read_b64 v[98:99], v98
    v_mfma_f32_16x16x32_bf16 v[112:115], v[76:79], v[164:167], v[112:115]
    v_lshlrev_b32_sdwa v100, 3, v125 dst_sel:DWORD dst_unused:UNUSED_PAD src0_sel:DWORD src1_sel:WORD_0
    v_lshlrev_b32_sdwa v102, 3, v125 dst_sel:DWORD dst_unused:UNUSED_PAD src0_sel:DWORD src1_sel:WORD_1
    ds_read_b64 v[100:101], v100
    ds_read_b64 v[102:103], v102
    s_waitcnt lgkmcnt(10)
    v_smfmac_f32_16x16x64_bf16 v[16:19], v[64:67], v[104:111], v68
    v_mfma_f32_16x16x32_bf16 v[112:115], v[80:83], v[168:171], v[112:115]
    v_lshlrev_b32_sdwa v104, 3, v126 dst_sel:DWORD dst_unused:UNUSED_PAD src0_sel:DWORD src1_sel:WORD_0
    v_lshlrev_b32_sdwa v106, 3, v126 dst_sel:DWORD dst_unused:UNUSED_PAD src0_sel:DWORD src1_sel:WORD_1
    ds_read_b64 v[104:105], v104
    ds_read_b64 v[106:107], v106
    v_mfma_f32_16x16x32_bf16 v[112:115], v[84:87], v[172:175], v[112:115]
    v_lshlrev_b32_sdwa v108, 3, v127 dst_sel:DWORD dst_unused:UNUSED_PAD src0_sel:DWORD src1_sel:WORD_0
    v_lshlrev_b32_sdwa v110, 3, v127 dst_sel:DWORD dst_unused:UNUSED_PAD src0_sel:DWORD src1_sel:WORD_1
    ds_read_b64 v[108:109], v108
    ds_read_b64 v[110:111], v110
    buffer_load_dwordx4 v[124:127], v69, s[12:15], s20 offen offset:2048 sc1
    s_waitcnt lgkmcnt(9)
    v_smfmac_f32_16x16x64_bf16 v[20:23], v[64:67], v[88:95], v68
    s_nop 0
    v_cvt_pk_bf16_f32 v112, v112, v113
    v_cvt_pk_bf16_f32 v113, v114, v115
    ds_write_b64 v70, v[112:113] offset:256
    v_mfma_f32_16x16x32_bf16 v[112:115], v[72:75], v[176:179], 0
    v_mfma_f32_16x16x32_bf16 v[112:115], v[76:79], v[180:183], v[112:115]
    s_waitcnt vmcnt(2)
    v_lshlrev_b32_sdwa v88, 3, v116 dst_sel:DWORD dst_unused:UNUSED_PAD src0_sel:DWORD src1_sel:WORD_0
    v_lshlrev_b32_sdwa v90, 3, v116 dst_sel:DWORD dst_unused:UNUSED_PAD src0_sel:DWORD src1_sel:WORD_1
    ds_read_b64 v[88:89], v88
    ds_read_b64 v[90:91], v90
    v_mfma_f32_16x16x32_bf16 v[112:115], v[80:83], v[184:187], v[112:115]
    v_mfma_f32_16x16x32_bf16 v[112:115], v[84:87], v[188:191], v[112:115]
    v_lshlrev_b32_sdwa v92, 3, v117 dst_sel:DWORD dst_unused:UNUSED_PAD src0_sel:DWORD src1_sel:WORD_0
    v_lshlrev_b32_sdwa v94, 3, v117 dst_sel:DWORD dst_unused:UNUSED_PAD src0_sel:DWORD src1_sel:WORD_1
    ds_read_b64 v[92:93], v92
    ds_read_b64 v[94:95], v94
    s_waitcnt lgkmcnt(9)
    v_smfmac_f32_16x16x64_bf16 v[24:27], v[64:67], v[96:103], v68
    s_nop 1
    v_cvt_pk_bf16_f32 v112, v112, v113
    v_cvt_pk_bf16_f32 v113, v114, v115
    ds_write_b64 v70, v[112:113] offset:384
    v_mfma_f32_16x16x32_bf16 v[112:115], v[72:75], v[192:195], 0
    v_lshlrev_b32_sdwa v96, 3, v118 dst_sel:DWORD dst_unused:UNUSED_PAD src0_sel:DWORD src1_sel:WORD_0
    v_lshlrev_b32_sdwa v98, 3, v118 dst_sel:DWORD dst_unused:UNUSED_PAD src0_sel:DWORD src1_sel:WORD_1
    ds_read_b64 v[96:97], v96
    ds_read_b64 v[98:99], v98
    v_mfma_f32_16x16x32_bf16 v[112:115], v[76:79], v[196:199], v[112:115]
    v_lshlrev_b32_sdwa v100, 3, v119 dst_sel:DWORD dst_unused:UNUSED_PAD src0_sel:DWORD src1_sel:WORD_0
    v_lshlrev_b32_sdwa v102, 3, v119 dst_sel:DWORD dst_unused:UNUSED_PAD src0_sel:DWORD src1_sel:WORD_1
    ds_read_b64 v[100:101], v100
    ds_read_b64 v[102:103], v102
    buffer_load_dwordx4 v[116:119], v69, s[12:15], s20 offen offset:3072 sc1
    s_add_u32 s20, s20, 61440
    s_waitcnt lgkmcnt(10)
    v_smfmac_f32_16x16x64_bf16 v[28:31], v[64:67], v[104:111], v68
    s_setprio 2
    v_mfma_f32_16x16x32_bf16 v[112:115], v[80:83], v[200:203], v[112:115]
    s_waitcnt vmcnt(2)
    v_lshlrev_b32_sdwa v104, 3, v120 dst_sel:DWORD dst_unused:UNUSED_PAD src0_sel:DWORD src1_sel:WORD_0
    v_lshlrev_b32_sdwa v106, 3, v120 dst_sel:DWORD dst_unused:UNUSED_PAD src0_sel:DWORD src1_sel:WORD_1
    ds_read_b64 v[104:105], v104
    ds_read_b64 v[106:107], v106
    v_mfma_f32_16x16x32_bf16 v[112:115], v[84:87], v[204:207], v[112:115]
    v_lshlrev_b32_sdwa v108, 3, v121 dst_sel:DWORD dst_unused:UNUSED_PAD src0_sel:DWORD src1_sel:WORD_0
    v_lshlrev_b32_sdwa v110, 3, v121 dst_sel:DWORD dst_unused:UNUSED_PAD src0_sel:DWORD src1_sel:WORD_1
    ds_read_b64 v[108:109], v108
    ds_read_b64 v[110:111], v110
    s_waitcnt lgkmcnt(9)
    v_smfmac_f32_16x16x64_bf16 v[32:35], v[64:67], v[88:95], v68
    s_nop 1
    v_cvt_pk_bf16_f32 v112, v112, v113
    v_cvt_pk_bf16_f32 v113, v114, v115
    ds_write_b64 v70, v[112:113] offset:512
    v_mfma_f32_16x16x32_bf16 v[112:115], v[72:75], v[208:211], 0
    v_lshlrev_b32_sdwa v88, 3, v122 dst_sel:DWORD dst_unused:UNUSED_PAD src0_sel:DWORD src1_sel:WORD_0
    v_lshlrev_b32_sdwa v90, 3, v122 dst_sel:DWORD dst_unused:UNUSED_PAD src0_sel:DWORD src1_sel:WORD_1
    ds_read_b64 v[88:89], v88
    ds_read_b64 v[90:91], v90
    v_mfma_f32_16x16x32_bf16 v[112:115], v[76:79], v[212:215], v[112:115]
    v_lshlrev_b32_sdwa v92, 3, v123 dst_sel:DWORD dst_unused:UNUSED_PAD src0_sel:DWORD src1_sel:WORD_0
    v_lshlrev_b32_sdwa v94, 3, v123 dst_sel:DWORD dst_unused:UNUSED_PAD src0_sel:DWORD src1_sel:WORD_1
    ds_read_b64 v[92:93], v92
    ds_read_b64 v[94:95], v94
    buffer_load_dwordx4 v[120:123], v69, s[12:15], s20 offen offset:0 sc1
    s_waitcnt lgkmcnt(9)
    v_smfmac_f32_16x16x64_bf16 v[36:39], v[64:67], v[96:103], v68
    v_mfma_f32_16x16x32_bf16 v[112:115], v[80:83], v[216:219], v[112:115]
    s_waitcnt vmcnt(2)
    v_lshlrev_b32_sdwa v96, 3, v124 dst_sel:DWORD dst_unused:UNUSED_PAD src0_sel:DWORD src1_sel:WORD_0
    v_lshlrev_b32_sdwa v98, 3, v124 dst_sel:DWORD dst_unused:UNUSED_PAD src0_sel:DWORD src1_sel:WORD_1
    ds_read_b64 v[96:97], v96
    ds_read_b64 v[98:99], v98
    v_mfma_f32_16x16x32_bf16 v[112:115], v[84:87], v[220:223], v[112:115]
    v_lshlrev_b32_sdwa v100, 3, v125 dst_sel:DWORD dst_unused:UNUSED_PAD src0_sel:DWORD src1_sel:WORD_0
    v_lshlrev_b32_sdwa v102, 3, v125 dst_sel:DWORD dst_unused:UNUSED_PAD src0_sel:DWORD src1_sel:WORD_1
    ds_read_b64 v[100:101], v100
    ds_read_b64 v[102:103], v102
    s_waitcnt lgkmcnt(9)
    v_smfmac_f32_16x16x64_bf16 v[40:43], v[64:67], v[104:111], v68
    s_nop 1
    v_cvt_pk_bf16_f32 v112, v112, v113
    v_cvt_pk_bf16_f32 v113, v114, v115
    ds_write_b64 v70, v[112:113] offset:640
    v_mfma_f32_16x16x32_bf16 v[112:115], v[72:75], v[224:227], 0
    v_mfma_f32_16x16x32_bf16 v[112:115], v[76:79], v[228:231], v[112:115]
    v_lshlrev_b32_sdwa v104, 3, v126 dst_sel:DWORD dst_unused:UNUSED_PAD src0_sel:DWORD src1_sel:WORD_0
    v_lshlrev_b32_sdwa v106, 3, v126 dst_sel:DWORD dst_unused:UNUSED_PAD src0_sel:DWORD src1_sel:WORD_1
    ds_read_b64 v[104:105], v104
    ds_read_b64 v[106:107], v106
    v_mfma_f32_16x16x32_bf16 v[112:115], v[80:83], v[232:235], v[112:115]
    v_mfma_f32_16x16x32_bf16 v[112:115], v[84:87], v[236:239], v[112:115]
    v_lshlrev_b32_sdwa v108, 3, v127 dst_sel:DWORD dst_unused:UNUSED_PAD src0_sel:DWORD src1_sel:WORD_0
    v_lshlrev_b32_sdwa v110, 3, v127 dst_sel:DWORD dst_unused:UNUSED_PAD src0_sel:DWORD src1_sel:WORD_1
    ds_read_b64 v[108:109], v108
    ds_read_b64 v[110:111], v110
    buffer_load_dwordx4 v[124:127], v69, s[12:15], s20 offen offset:1024 sc1
    s_waitcnt lgkmcnt(9)
    v_smfmac_f32_16x16x64_bf16 v[44:47], v[64:67], v[88:95], v68
    s_nop 0
    v_cvt_pk_bf16_f32 v112, v112, v113
    v_cvt_pk_bf16_f32 v113, v114, v115
    ds_write_b64 v70, v[112:113] offset:768
    s_setprio 1
    v_mfma_f32_16x16x32_bf16 v[112:115], v[72:75], v[240:243], 0
    buffer_load_dwordx4 v[72:75], v69, s[12:15], s21 offen offset:0 sc1
    s_waitcnt vmcnt(3)
    v_lshlrev_b32_sdwa v88, 3, v116 dst_sel:DWORD dst_unused:UNUSED_PAD src0_sel:DWORD src1_sel:WORD_0
    v_lshlrev_b32_sdwa v90, 3, v116 dst_sel:DWORD dst_unused:UNUSED_PAD src0_sel:DWORD src1_sel:WORD_1
    ds_read_b64 v[88:89], v88
    ds_read_b64 v[90:91], v90
    v_mfma_f32_16x16x32_bf16 v[112:115], v[76:79], v[244:247], v[112:115]
    buffer_load_dwordx4 v[76:79], v69, s[12:15], s21 offen offset:1024 sc1
    v_lshlrev_b32_sdwa v92, 3, v117 dst_sel:DWORD dst_unused:UNUSED_PAD src0_sel:DWORD src1_sel:WORD_0
    v_lshlrev_b32_sdwa v94, 3, v117 dst_sel:DWORD dst_unused:UNUSED_PAD src0_sel:DWORD src1_sel:WORD_1
    ds_read_b64 v[92:93], v92
    ds_read_b64 v[94:95], v94
    s_waitcnt lgkmcnt(10)
    v_smfmac_f32_16x16x64_bf16 v[48:51], v[64:67], v[96:103], v68
    v_mfma_f32_16x16x32_bf16 v[112:115], v[80:83], v[248:251], v[112:115]
    buffer_load_dwordx4 v[80:83], v69, s[12:15], s19 offen offset:0 sc1
    v_lshlrev_b32_sdwa v96, 3, v118 dst_sel:DWORD dst_unused:UNUSED_PAD src0_sel:DWORD src1_sel:WORD_0
    v_lshlrev_b32_sdwa v98, 3, v118 dst_sel:DWORD dst_unused:UNUSED_PAD src0_sel:DWORD src1_sel:WORD_1
    ds_read_b64 v[96:97], v96
    ds_read_b64 v[98:99], v98
    v_mfma_f32_16x16x32_bf16 v[112:115], v[84:87], v[252:255], v[112:115]
    buffer_load_dwordx4 v[84:87], v69, s[12:15], s19 offen offset:1024 sc1
    s_add_u32 s21, s21, 4096
    s_add_u32 s19, s19, 4096
    v_lshlrev_b32_sdwa v100, 3, v119 dst_sel:DWORD dst_unused:UNUSED_PAD src0_sel:DWORD src1_sel:WORD_0
    v_lshlrev_b32_sdwa v102, 3, v119 dst_sel:DWORD dst_unused:UNUSED_PAD src0_sel:DWORD src1_sel:WORD_1
    ds_read_b64 v[100:101], v100
    ds_read_b64 v[102:103], v102
    buffer_load_dwordx4 v[116:119], v69, s[12:15], s20 offen offset:2048 sc1
    s_waitcnt lgkmcnt(9)
    v_smfmac_f32_16x16x64_bf16 v[52:55], v[64:67], v[104:111], v68
    v_cvt_pk_bf16_f32 v112, v112, v113
    v_cvt_pk_bf16_f32 v113, v114, v115
    ds_write_b64 v70, v[112:113] offset:896
    s_add_u32 s23, s23, 1
    s_cmp_eq_u32 s23, 5
    s_cselect_b32 s35, 4294836224, s32
    s_cselect_b32 s23, 0, s23
    v_add_u32 v70, s35, v70
    s_waitcnt vmcnt(6)
    v_lshlrev_b32_sdwa v104, 3, v120 dst_sel:DWORD dst_unused:UNUSED_PAD src0_sel:DWORD src1_sel:WORD_0
    v_lshlrev_b32_sdwa v106, 3, v120 dst_sel:DWORD dst_unused:UNUSED_PAD src0_sel:DWORD src1_sel:WORD_1
    ds_read_b64 v[104:105], v104
    ds_read_b64 v[106:107], v106
    v_lshlrev_b32_sdwa v108, 3, v121 dst_sel:DWORD dst_unused:UNUSED_PAD src0_sel:DWORD src1_sel:WORD_0
    v_lshlrev_b32_sdwa v110, 3, v121 dst_sel:DWORD dst_unused:UNUSED_PAD src0_sel:DWORD src1_sel:WORD_1
    ds_read_b64 v[108:109], v108
    ds_read_b64 v[110:111], v110
    s_waitcnt lgkmcnt(9)
    v_smfmac_f32_16x16x64_bf16 v[56:59], v[64:67], v[88:95], v68
    s_setprio 0
    v_lshlrev_b32_sdwa v88, 3, v122 dst_sel:DWORD dst_unused:UNUSED_PAD src0_sel:DWORD src1_sel:WORD_0
    v_lshlrev_b32_sdwa v90, 3, v122 dst_sel:DWORD dst_unused:UNUSED_PAD src0_sel:DWORD src1_sel:WORD_1
    ds_read_b64 v[88:89], v88
    ds_read_b64 v[90:91], v90
    v_lshlrev_b32_sdwa v92, 3, v123 dst_sel:DWORD dst_unused:UNUSED_PAD src0_sel:DWORD src1_sel:WORD_0
    v_lshlrev_b32_sdwa v94, 3, v123 dst_sel:DWORD dst_unused:UNUSED_PAD src0_sel:DWORD src1_sel:WORD_1
    ds_read_b64 v[92:93], v92
    ds_read_b64 v[94:95], v94
    buffer_load_dwordx4 v[120:123], v69, s[12:15], s20 offen offset:3072 sc1
    s_add_u32 s20, s20, 4096
    s_waitcnt lgkmcnt(9)
    v_smfmac_f32_16x16x64_bf16 v[60:63], v[64:67], v[96:103], v68
    s_waitcnt lgkmcnt(8)
    s_barrier
    s_setprio 3
    s_waitcnt vmcnt(6)
    v_lshlrev_b32_sdwa v96, 3, v124 dst_sel:DWORD dst_unused:UNUSED_PAD src0_sel:DWORD src1_sel:WORD_0
    v_lshlrev_b32_sdwa v98, 3, v124 dst_sel:DWORD dst_unused:UNUSED_PAD src0_sel:DWORD src1_sel:WORD_1
    ds_read_b64 v[96:97], v96
    ds_read_b64 v[98:99], v98
    v_lshlrev_b32_sdwa v100, 3, v125 dst_sel:DWORD dst_unused:UNUSED_PAD src0_sel:DWORD src1_sel:WORD_0
    v_lshlrev_b32_sdwa v102, 3, v125 dst_sel:DWORD dst_unused:UNUSED_PAD src0_sel:DWORD src1_sel:WORD_1
    ds_read_b64 v[100:101], v100
    ds_read_b64 v[102:103], v102
    s_waitcnt lgkmcnt(8)
    v_smfmac_f32_16x16x64_bf16 v[0:3], v[64:67], v[104:111], v68
    s_waitcnt vmcnt(5)
    v_mfma_f32_16x16x32_bf16 v[112:115], v[72:75], v[128:131], 0
    v_lshlrev_b32_sdwa v104, 3, v126 dst_sel:DWORD dst_unused:UNUSED_PAD src0_sel:DWORD src1_sel:WORD_0
    v_lshlrev_b32_sdwa v106, 3, v126 dst_sel:DWORD dst_unused:UNUSED_PAD src0_sel:DWORD src1_sel:WORD_1
    ds_read_b64 v[104:105], v104
    ds_read_b64 v[106:107], v106
    s_waitcnt vmcnt(4)
    v_mfma_f32_16x16x32_bf16 v[112:115], v[76:79], v[132:135], v[112:115]
    v_lshlrev_b32_sdwa v108, 3, v127 dst_sel:DWORD dst_unused:UNUSED_PAD src0_sel:DWORD src1_sel:WORD_0
    v_lshlrev_b32_sdwa v110, 3, v127 dst_sel:DWORD dst_unused:UNUSED_PAD src0_sel:DWORD src1_sel:WORD_1
    ds_read_b64 v[108:109], v108
    ds_read_b64 v[110:111], v110
    buffer_load_dwordx4 v[124:127], v69, s[12:15], s20 offen offset:0 sc1
    s_waitcnt lgkmcnt(8)
    v_smfmac_f32_16x16x64_bf16 v[4:7], v[64:67], v[88:95], v68
    s_waitcnt vmcnt(4)
    v_mfma_f32_16x16x32_bf16 v[112:115], v[80:83], v[136:139], v[112:115]
    s_waitcnt vmcnt(2)
    v_lshlrev_b32_sdwa v88, 3, v116 dst_sel:DWORD dst_unused:UNUSED_PAD src0_sel:DWORD src1_sel:WORD_0
    v_lshlrev_b32_sdwa v90, 3, v116 dst_sel:DWORD dst_unused:UNUSED_PAD src0_sel:DWORD src1_sel:WORD_1
    ds_read_b64 v[88:89], v88
    ds_read_b64 v[90:91], v90
    s_waitcnt vmcnt(3)
    v_mfma_f32_16x16x32_bf16 v[112:115], v[84:87], v[140:143], v[112:115]
    v_lshlrev_b32_sdwa v92, 3, v117 dst_sel:DWORD dst_unused:UNUSED_PAD src0_sel:DWORD src1_sel:WORD_0
    v_lshlrev_b32_sdwa v94, 3, v117 dst_sel:DWORD dst_unused:UNUSED_PAD src0_sel:DWORD src1_sel:WORD_1
    ds_read_b64 v[92:93], v92
    ds_read_b64 v[94:95], v94
    s_waitcnt lgkmcnt(8)
    v_smfmac_f32_16x16x64_bf16 v[8:11], v[64:67], v[96:103], v68
    s_nop 1
    v_cvt_pk_bf16_f32 v112, v112, v113
    v_cvt_pk_bf16_f32 v113, v114, v115
    ds_write_b64 v70, v[112:113] offset:0
    v_mfma_f32_16x16x32_bf16 v[112:115], v[72:75], v[144:147], 0
    v_mfma_f32_16x16x32_bf16 v[112:115], v[76:79], v[148:151], v[112:115]
    v_lshlrev_b32_sdwa v96, 3, v118 dst_sel:DWORD dst_unused:UNUSED_PAD src0_sel:DWORD src1_sel:WORD_0
    v_lshlrev_b32_sdwa v98, 3, v118 dst_sel:DWORD dst_unused:UNUSED_PAD src0_sel:DWORD src1_sel:WORD_1
    ds_read_b64 v[96:97], v96
    ds_read_b64 v[98:99], v98
    v_mfma_f32_16x16x32_bf16 v[112:115], v[80:83], v[152:155], v[112:115]
    v_mfma_f32_16x16x32_bf16 v[112:115], v[84:87], v[156:159], v[112:115]
    v_lshlrev_b32_sdwa v100, 3, v119 dst_sel:DWORD dst_unused:UNUSED_PAD src0_sel:DWORD src1_sel:WORD_0
    v_lshlrev_b32_sdwa v102, 3, v119 dst_sel:DWORD dst_unused:UNUSED_PAD src0_sel:DWORD src1_sel:WORD_1
    ds_read_b64 v[100:101], v100
    ds_read_b64 v[102:103], v102
    buffer_load_dwordx4 v[116:119], v69, s[12:15], s20 offen offset:1024 sc1
    s_waitcnt lgkmcnt(9)
    v_smfmac_f32_16x16x64_bf16 v[12:15], v[64:67], v[104:111], v68
    s_nop 0
    v_cvt_pk_bf16_f32 v112, v112, v113
    v_cvt_pk_bf16_f32 v113, v114, v115
    ds_write_b64 v70, v[112:113] offset:128
    v_mfma_f32_16x16x32_bf16 v[112:115], v[72:75], v[160:163], 0
    s_waitcnt vmcnt(2)
    v_lshlrev_b32_sdwa v104, 3, v120 dst_sel:DWORD dst_unused:UNUSED_PAD src0_sel:DWORD src1_sel:WORD_0
    v_lshlrev_b32_sdwa v106, 3, v120 dst_sel:DWORD dst_unused:UNUSED_PAD src0_sel:DWORD src1_sel:WORD_1
    ds_read_b64 v[104:105], v104
    ds_read_b64 v[106:107], v106
    v_mfma_f32_16x16x32_bf16 v[112:115], v[76:79], v[164:167], v[112:115]
    v_lshlrev_b32_sdwa v108, 3, v121 dst_sel:DWORD dst_unused:UNUSED_PAD src0_sel:DWORD src1_sel:WORD_0
    v_lshlrev_b32_sdwa v110, 3, v121 dst_sel:DWORD dst_unused:UNUSED_PAD src0_sel:DWORD src1_sel:WORD_1
    ds_read_b64 v[108:109], v108
    ds_read_b64 v[110:111], v110
    s_waitcnt lgkmcnt(10)
    v_smfmac_f32_16x16x64_bf16 v[16:19], v[64:67], v[88:95], v68
    v_mfma_f32_16x16x32_bf16 v[112:115], v[80:83], v[168:171], v[112:115]
    v_lshlrev_b32_sdwa v88, 3, v122 dst_sel:DWORD dst_unused:UNUSED_PAD src0_sel:DWORD src1_sel:WORD_0
    v_lshlrev_b32_sdwa v90, 3, v122 dst_sel:DWORD dst_unused:UNUSED_PAD src0_sel:DWORD src1_sel:WORD_1
    ds_read_b64 v[88:89], v88
    ds_read_b64 v[90:91], v90
    v_mfma_f32_16x16x32_bf16 v[112:115], v[84:87], v[172:175], v[112:115]
    v_lshlrev_b32_sdwa v92, 3, v123 dst_sel:DWORD dst_unused:UNUSED_PAD src0_sel:DWORD src1_sel:WORD_0
    v_lshlrev_b32_sdwa v94, 3, v123 dst_sel:DWORD dst_unused:UNUSED_PAD src0_sel:DWORD src1_sel:WORD_1
    ds_read_b64 v[92:93], v92
    ds_read_b64 v[94:95], v94
    buffer_load_dwordx4 v[120:123], v69, s[12:15], s20 offen offset:2048 sc1
    s_waitcnt lgkmcnt(9)
    v_smfmac_f32_16x16x64_bf16 v[20:23], v[64:67], v[96:103], v68
    s_nop 0
    v_cvt_pk_bf16_f32 v112, v112, v113
    v_cvt_pk_bf16_f32 v113, v114, v115
    ds_write_b64 v70, v[112:113] offset:256
    v_mfma_f32_16x16x32_bf16 v[112:115], v[72:75], v[176:179], 0
    v_mfma_f32_16x16x32_bf16 v[112:115], v[76:79], v[180:183], v[112:115]
    s_waitcnt vmcnt(2)
    v_lshlrev_b32_sdwa v96, 3, v124 dst_sel:DWORD dst_unused:UNUSED_PAD src0_sel:DWORD src1_sel:WORD_0
    v_lshlrev_b32_sdwa v98, 3, v124 dst_sel:DWORD dst_unused:UNUSED_PAD src0_sel:DWORD src1_sel:WORD_1
    ds_read_b64 v[96:97], v96
    ds_read_b64 v[98:99], v98
    v_mfma_f32_16x16x32_bf16 v[112:115], v[80:83], v[184:187], v[112:115]
    v_mfma_f32_16x16x32_bf16 v[112:115], v[84:87], v[188:191], v[112:115]
    v_lshlrev_b32_sdwa v100, 3, v125 dst_sel:DWORD dst_unused:UNUSED_PAD src0_sel:DWORD src1_sel:WORD_0
    v_lshlrev_b32_sdwa v102, 3, v125 dst_sel:DWORD dst_unused:UNUSED_PAD src0_sel:DWORD src1_sel:WORD_1
    ds_read_b64 v[100:101], v100
    ds_read_b64 v[102:103], v102
    s_waitcnt lgkmcnt(9)
    v_smfmac_f32_16x16x64_bf16 v[24:27], v[64:67], v[104:111], v68
    s_nop 1
    v_cvt_pk_bf16_f32 v112, v112, v113
    v_cvt_pk_bf16_f32 v113, v114, v115
    ds_write_b64 v70, v[112:113] offset:384
    v_mfma_f32_16x16x32_bf16 v[112:115], v[72:75], v[192:195], 0
    v_lshlrev_b32_sdwa v104, 3, v126 dst_sel:DWORD dst_unused:UNUSED_PAD src0_sel:DWORD src1_sel:WORD_0
    v_lshlrev_b32_sdwa v106, 3, v126 dst_sel:DWORD dst_unused:UNUSED_PAD src0_sel:DWORD src1_sel:WORD_1
    ds_read_b64 v[104:105], v104
    ds_read_b64 v[106:107], v106
    v_mfma_f32_16x16x32_bf16 v[112:115], v[76:79], v[196:199], v[112:115]
    v_lshlrev_b32_sdwa v108, 3, v127 dst_sel:DWORD dst_unused:UNUSED_PAD src0_sel:DWORD src1_sel:WORD_0
    v_lshlrev_b32_sdwa v110, 3, v127 dst_sel:DWORD dst_unused:UNUSED_PAD src0_sel:DWORD src1_sel:WORD_1
    ds_read_b64 v[108:109], v108
    ds_read_b64 v[110:111], v110
    buffer_load_dwordx4 v[124:127], v69, s[12:15], s20 offen offset:3072 sc1
    s_add_u32 s20, s20, 61440
    s_waitcnt lgkmcnt(10)
    v_smfmac_f32_16x16x64_bf16 v[28:31], v[64:67], v[88:95], v68
    s_setprio 2
    v_mfma_f32_16x16x32_bf16 v[112:115], v[80:83], v[200:203], v[112:115]
    s_waitcnt vmcnt(2)
    v_lshlrev_b32_sdwa v88, 3, v116 dst_sel:DWORD dst_unused:UNUSED_PAD src0_sel:DWORD src1_sel:WORD_0
    v_lshlrev_b32_sdwa v90, 3, v116 dst_sel:DWORD dst_unused:UNUSED_PAD src0_sel:DWORD src1_sel:WORD_1
    ds_read_b64 v[88:89], v88
    ds_read_b64 v[90:91], v90
    v_mfma_f32_16x16x32_bf16 v[112:115], v[84:87], v[204:207], v[112:115]
    v_lshlrev_b32_sdwa v92, 3, v117 dst_sel:DWORD dst_unused:UNUSED_PAD src0_sel:DWORD src1_sel:WORD_0
    v_lshlrev_b32_sdwa v94, 3, v117 dst_sel:DWORD dst_unused:UNUSED_PAD src0_sel:DWORD src1_sel:WORD_1
    ds_read_b64 v[92:93], v92
    ds_read_b64 v[94:95], v94
    s_waitcnt lgkmcnt(9)
    v_smfmac_f32_16x16x64_bf16 v[32:35], v[64:67], v[96:103], v68
    s_nop 1
    v_cvt_pk_bf16_f32 v112, v112, v113
    v_cvt_pk_bf16_f32 v113, v114, v115
    ds_write_b64 v70, v[112:113] offset:512
    v_mfma_f32_16x16x32_bf16 v[112:115], v[72:75], v[208:211], 0
    v_lshlrev_b32_sdwa v96, 3, v118 dst_sel:DWORD dst_unused:UNUSED_PAD src0_sel:DWORD src1_sel:WORD_0
    v_lshlrev_b32_sdwa v98, 3, v118 dst_sel:DWORD dst_unused:UNUSED_PAD src0_sel:DWORD src1_sel:WORD_1
    ds_read_b64 v[96:97], v96
    ds_read_b64 v[98:99], v98
    v_mfma_f32_16x16x32_bf16 v[112:115], v[76:79], v[212:215], v[112:115]
    v_lshlrev_b32_sdwa v100, 3, v119 dst_sel:DWORD dst_unused:UNUSED_PAD src0_sel:DWORD src1_sel:WORD_0
    v_lshlrev_b32_sdwa v102, 3, v119 dst_sel:DWORD dst_unused:UNUSED_PAD src0_sel:DWORD src1_sel:WORD_1
    ds_read_b64 v[100:101], v100
    ds_read_b64 v[102:103], v102
    buffer_load_dwordx4 v[116:119], v69, s[12:15], s20 offen offset:0 sc1
    s_waitcnt lgkmcnt(9)
    v_smfmac_f32_16x16x64_bf16 v[36:39], v[64:67], v[104:111], v68
    v_mfma_f32_16x16x32_bf16 v[112:115], v[80:83], v[216:219], v[112:115]
    s_waitcnt vmcnt(2)
    v_lshlrev_b32_sdwa v104, 3, v120 dst_sel:DWORD dst_unused:UNUSED_PAD src0_sel:DWORD src1_sel:WORD_0
    v_lshlrev_b32_sdwa v106, 3, v120 dst_sel:DWORD dst_unused:UNUSED_PAD src0_sel:DWORD src1_sel:WORD_1
    ds_read_b64 v[104:105], v104
    ds_read_b64 v[106:107], v106
    v_mfma_f32_16x16x32_bf16 v[112:115], v[84:87], v[220:223], v[112:115]
    v_lshlrev_b32_sdwa v108, 3, v121 dst_sel:DWORD dst_unused:UNUSED_PAD src0_sel:DWORD src1_sel:WORD_0
    v_lshlrev_b32_sdwa v110, 3, v121 dst_sel:DWORD dst_unused:UNUSED_PAD src0_sel:DWORD src1_sel:WORD_1
    ds_read_b64 v[108:109], v108
    ds_read_b64 v[110:111], v110
    s_waitcnt lgkmcnt(9)
    v_smfmac_f32_16x16x64_bf16 v[40:43], v[64:67], v[88:95], v68
    s_nop 1
    v_cvt_pk_bf16_f32 v112, v112, v113
    v_cvt_pk_bf16_f32 v113, v114, v115
    ds_write_b64 v70, v[112:113] offset:640
    v_mfma_f32_16x16x32_bf16 v[112:115], v[72:75], v[224:227], 0
    v_mfma_f32_16x16x32_bf16 v[112:115], v[76:79], v[228:231], v[112:115]
    v_lshlrev_b32_sdwa v88, 3, v122 dst_sel:DWORD dst_unused:UNUSED_PAD src0_sel:DWORD src1_sel:WORD_0
    v_lshlrev_b32_sdwa v90, 3, v122 dst_sel:DWORD dst_unused:UNUSED_PAD src0_sel:DWORD src1_sel:WORD_1
    ds_read_b64 v[88:89], v88
    ds_read_b64 v[90:91], v90
    v_mfma_f32_16x16x32_bf16 v[112:115], v[80:83], v[232:235], v[112:115]
    v_mfma_f32_16x16x32_bf16 v[112:115], v[84:87], v[236:239], v[112:115]
    v_lshlrev_b32_sdwa v92, 3, v123 dst_sel:DWORD dst_unused:UNUSED_PAD src0_sel:DWORD src1_sel:WORD_0
    v_lshlrev_b32_sdwa v94, 3, v123 dst_sel:DWORD dst_unused:UNUSED_PAD src0_sel:DWORD src1_sel:WORD_1
    ds_read_b64 v[92:93], v92
    ds_read_b64 v[94:95], v94
    buffer_load_dwordx4 v[120:123], v69, s[12:15], s20 offen offset:1024 sc1
    s_waitcnt lgkmcnt(9)
    v_smfmac_f32_16x16x64_bf16 v[44:47], v[64:67], v[96:103], v68
    s_nop 0
    v_cvt_pk_bf16_f32 v112, v112, v113
    v_cvt_pk_bf16_f32 v113, v114, v115
    ds_write_b64 v70, v[112:113] offset:768
    s_setprio 1
    v_mfma_f32_16x16x32_bf16 v[112:115], v[72:75], v[240:243], 0
    buffer_load_dwordx4 v[72:75], v69, s[12:15], s21 offen offset:0 sc1
    s_waitcnt vmcnt(3)
    v_lshlrev_b32_sdwa v96, 3, v124 dst_sel:DWORD dst_unused:UNUSED_PAD src0_sel:DWORD src1_sel:WORD_0
    v_lshlrev_b32_sdwa v98, 3, v124 dst_sel:DWORD dst_unused:UNUSED_PAD src0_sel:DWORD src1_sel:WORD_1
    ds_read_b64 v[96:97], v96
    ds_read_b64 v[98:99], v98
    v_mfma_f32_16x16x32_bf16 v[112:115], v[76:79], v[244:247], v[112:115]
    buffer_load_dwordx4 v[76:79], v69, s[12:15], s21 offen offset:1024 sc1
    v_lshlrev_b32_sdwa v100, 3, v125 dst_sel:DWORD dst_unused:UNUSED_PAD src0_sel:DWORD src1_sel:WORD_0
    v_lshlrev_b32_sdwa v102, 3, v125 dst_sel:DWORD dst_unused:UNUSED_PAD src0_sel:DWORD src1_sel:WORD_1
    ds_read_b64 v[100:101], v100
    ds_read_b64 v[102:103], v102
    s_waitcnt lgkmcnt(10)
    v_smfmac_f32_16x16x64_bf16 v[48:51], v[64:67], v[104:111], v68
    v_mfma_f32_16x16x32_bf16 v[112:115], v[80:83], v[248:251], v[112:115]
    buffer_load_dwordx4 v[80:83], v69, s[12:15], s19 offen offset:0 sc1
    v_lshlrev_b32_sdwa v104, 3, v126 dst_sel:DWORD dst_unused:UNUSED_PAD src0_sel:DWORD src1_sel:WORD_0
    v_lshlrev_b32_sdwa v106, 3, v126 dst_sel:DWORD dst_unused:UNUSED_PAD src0_sel:DWORD src1_sel:WORD_1
    ds_read_b64 v[104:105], v104
    ds_read_b64 v[106:107], v106
    v_mfma_f32_16x16x32_bf16 v[112:115], v[84:87], v[252:255], v[112:115]
    buffer_load_dwordx4 v[84:87], v69, s[12:15], s19 offen offset:1024 sc1
    s_add_u32 s21, s21, 4096
    s_add_u32 s19, s19, 4096
    v_lshlrev_b32_sdwa v108, 3, v127 dst_sel:DWORD dst_unused:UNUSED_PAD src0_sel:DWORD src1_sel:WORD_0
    v_lshlrev_b32_sdwa v110, 3, v127 dst_sel:DWORD dst_unused:UNUSED_PAD src0_sel:DWORD src1_sel:WORD_1
    ds_read_b64 v[108:109], v108
    ds_read_b64 v[110:111], v110
    buffer_load_dwordx4 v[124:127], v69, s[12:15], s20 offen offset:2048 sc1
    s_waitcnt lgkmcnt(9)
    v_smfmac_f32_16x16x64_bf16 v[52:55], v[64:67], v[88:95], v68
    v_cvt_pk_bf16_f32 v112, v112, v113
    v_cvt_pk_bf16_f32 v113, v114, v115
    ds_write_b64 v70, v[112:113] offset:896
    s_add_u32 s23, s23, 1
    s_cmp_eq_u32 s23, 5
    s_cselect_b32 s35, 4294836224, s32
    s_cselect_b32 s23, 0, s23
    v_add_u32 v70, s35, v70
    s_waitcnt vmcnt(6)
    v_lshlrev_b32_sdwa v88, 3, v116 dst_sel:DWORD dst_unused:UNUSED_PAD src0_sel:DWORD src1_sel:WORD_0
    v_lshlrev_b32_sdwa v90, 3, v116 dst_sel:DWORD dst_unused:UNUSED_PAD src0_sel:DWORD src1_sel:WORD_1
    ds_read_b64 v[88:89], v88
    ds_read_b64 v[90:91], v90
    v_lshlrev_b32_sdwa v92, 3, v117 dst_sel:DWORD dst_unused:UNUSED_PAD src0_sel:DWORD src1_sel:WORD_0
    v_lshlrev_b32_sdwa v94, 3, v117 dst_sel:DWORD dst_unused:UNUSED_PAD src0_sel:DWORD src1_sel:WORD_1
    ds_read_b64 v[92:93], v92
    ds_read_b64 v[94:95], v94
    s_waitcnt lgkmcnt(9)
    v_smfmac_f32_16x16x64_bf16 v[56:59], v[64:67], v[96:103], v68
    s_setprio 0
    v_lshlrev_b32_sdwa v96, 3, v118 dst_sel:DWORD dst_unused:UNUSED_PAD src0_sel:DWORD src1_sel:WORD_0
    v_lshlrev_b32_sdwa v98, 3, v118 dst_sel:DWORD dst_unused:UNUSED_PAD src0_sel:DWORD src1_sel:WORD_1
    ds_read_b64 v[96:97], v96
    ds_read_b64 v[98:99], v98
    v_lshlrev_b32_sdwa v100, 3, v119 dst_sel:DWORD dst_unused:UNUSED_PAD src0_sel:DWORD src1_sel:WORD_0
    v_lshlrev_b32_sdwa v102, 3, v119 dst_sel:DWORD dst_unused:UNUSED_PAD src0_sel:DWORD src1_sel:WORD_1
    ds_read_b64 v[100:101], v100
    ds_read_b64 v[102:103], v102
    buffer_load_dwordx4 v[116:119], v69, s[12:15], s20 offen offset:3072 sc1
    s_add_u32 s20, s20, 4096
    s_waitcnt lgkmcnt(9)
    v_smfmac_f32_16x16x64_bf16 v[60:63], v[64:67], v[104:111], v68
    s_waitcnt lgkmcnt(8)
    s_barrier

    s_add_u32 s22, s22, 1
    s_branch standalone__deep_cross_pnn__recsys_kernel_gloop

standalone__deep_cross_pnn__recsys_kernel_fin:

    s_add_u32 s40, s20, 61440
    s_add_u32 s41, s20, 65536
    s_add_u32 s44, s20, 126976
    s_add_u32 s45, s20, 131072

    s_lshl_b32 s28, s38, 16
    s_and_b32 s29, s38, 0xffff0000
    s_lshl_b32 s30, s39, 16
    s_and_b32 s31, s39, 0xffff0000
    s_lshl_b32 s35, s33, 16
    s_lshl_b32 s42, s34, 15
    s_add_u32 s35, s35, s42
    s_lshl_b32 s42, s3, 12
    s_add_u32 s35, s35, s42
    s_add_u32 s35, s35, 20971520

    s_setprio 3
    v_mov_b32 v128, 0xbdd2d3e8
    v_mov_b32 v129, 0xbdd2d3e8
    v_mov_b32 v130, 0xc0135761
    v_mov_b32 v131, 0xc0135761
    v_mov_b32 v132, 1.0
    v_mov_b32 v133, 1.0
    v_mov_b32 v134, s28
    v_mov_b32 v135, s29
    s_waitcnt vmcnt(6)
    v_lshlrev_b32_sdwa v88, 3, v116 dst_sel:DWORD dst_unused:UNUSED_PAD src0_sel:DWORD src1_sel:WORD_0
    v_lshlrev_b32_sdwa v90, 3, v116 dst_sel:DWORD dst_unused:UNUSED_PAD src0_sel:DWORD src1_sel:WORD_1
    ds_read_b64 v[88:89], v88
    ds_read_b64 v[90:91], v90
    v_lshlrev_b32_sdwa v92, 3, v117 dst_sel:DWORD dst_unused:UNUSED_PAD src0_sel:DWORD src1_sel:WORD_0
    v_lshlrev_b32_sdwa v94, 3, v117 dst_sel:DWORD dst_unused:UNUSED_PAD src0_sel:DWORD src1_sel:WORD_1
    ds_read_b64 v[92:93], v92
    ds_read_b64 v[94:95], v94
    s_waitcnt lgkmcnt(8)
    v_smfmac_f32_16x16x64_bf16 v[0:3], v[64:67], v[96:103], v68
    v_mov_b32 v136, s30
    v_mov_b32 v137, s31
    v_lshrrev_b32 v70, 2, v69
    v_and_b32 v71, 128, v70
    v_add_u32 v70, v70, v71
    v_rcp_f32 v134, v134
    v_rcp_f32 v135, v135
    v_rcp_f32 v136, v136
    v_lshlrev_b32_sdwa v96, 3, v118 dst_sel:DWORD dst_unused:UNUSED_PAD src0_sel:DWORD src1_sel:WORD_0
    v_lshlrev_b32_sdwa v98, 3, v118 dst_sel:DWORD dst_unused:UNUSED_PAD src0_sel:DWORD src1_sel:WORD_1
    ds_read_b64 v[96:97], v96
    ds_read_b64 v[98:99], v98
    v_lshlrev_b32_sdwa v100, 3, v119 dst_sel:DWORD dst_unused:UNUSED_PAD src0_sel:DWORD src1_sel:WORD_0
    v_lshlrev_b32_sdwa v102, 3, v119 dst_sel:DWORD dst_unused:UNUSED_PAD src0_sel:DWORD src1_sel:WORD_1
    ds_read_b64 v[100:101], v100
    ds_read_b64 v[102:103], v102
    buffer_load_dwordx4 v[116:119], v69, s[12:15], s40 offen offset:0 sc1
    s_waitcnt lgkmcnt(8)
    v_smfmac_f32_16x16x64_bf16 v[4:7], v[64:67], v[104:111], v68
    v_rcp_f32 v137, v137
    v_mov_b32 v132, 0x7f7fffff
    v_mov_b32 v133, 0xff7fffff
    v_med3_f32 v134, v134, v132, v133
    v_med3_f32 v135, v135, v132, v133
    v_med3_f32 v136, v136, v132, v133
    v_med3_f32 v137, v137, v132, v133
    s_waitcnt vmcnt(2)
    v_lshlrev_b32_sdwa v104, 3, v120 dst_sel:DWORD dst_unused:UNUSED_PAD src0_sel:DWORD src1_sel:WORD_0
    v_lshlrev_b32_sdwa v106, 3, v120 dst_sel:DWORD dst_unused:UNUSED_PAD src0_sel:DWORD src1_sel:WORD_1
    ds_read_b64 v[104:105], v104
    ds_read_b64 v[106:107], v106
    v_lshlrev_b32_sdwa v108, 3, v121 dst_sel:DWORD dst_unused:UNUSED_PAD src0_sel:DWORD src1_sel:WORD_0
    v_lshlrev_b32_sdwa v110, 3, v121 dst_sel:DWORD dst_unused:UNUSED_PAD src0_sel:DWORD src1_sel:WORD_1
    ds_read_b64 v[108:109], v108
    ds_read_b64 v[110:111], v110
    s_waitcnt lgkmcnt(8)
    v_smfmac_f32_16x16x64_bf16 v[8:11], v[64:67], v[88:95], v68
    v_lshlrev_b32_sdwa v88, 3, v122 dst_sel:DWORD dst_unused:UNUSED_PAD src0_sel:DWORD src1_sel:WORD_0
    v_lshlrev_b32_sdwa v90, 3, v122 dst_sel:DWORD dst_unused:UNUSED_PAD src0_sel:DWORD src1_sel:WORD_1
    ds_read_b64 v[88:89], v88
    ds_read_b64 v[90:91], v90
    v_lshlrev_b32_sdwa v92, 3, v123 dst_sel:DWORD dst_unused:UNUSED_PAD src0_sel:DWORD src1_sel:WORD_0
    v_lshlrev_b32_sdwa v94, 3, v123 dst_sel:DWORD dst_unused:UNUSED_PAD src0_sel:DWORD src1_sel:WORD_1
    ds_read_b64 v[92:93], v92
    ds_read_b64 v[94:95], v94
    buffer_load_dwordx4 v[120:123], v69, s[12:15], s44 offen offset:0 sc1
    s_waitcnt lgkmcnt(8)
    v_smfmac_f32_16x16x64_bf16 v[12:15], v[64:67], v[96:103], v68
    s_waitcnt vmcnt(2)
    v_lshlrev_b32_sdwa v96, 3, v124 dst_sel:DWORD dst_unused:UNUSED_PAD src0_sel:DWORD src1_sel:WORD_0
    v_lshlrev_b32_sdwa v98, 3, v124 dst_sel:DWORD dst_unused:UNUSED_PAD src0_sel:DWORD src1_sel:WORD_1
    ds_read_b64 v[96:97], v96
    ds_read_b64 v[98:99], v98
    v_lshlrev_b32_sdwa v100, 3, v125 dst_sel:DWORD dst_unused:UNUSED_PAD src0_sel:DWORD src1_sel:WORD_0
    v_lshlrev_b32_sdwa v102, 3, v125 dst_sel:DWORD dst_unused:UNUSED_PAD src0_sel:DWORD src1_sel:WORD_1
    ds_read_b64 v[100:101], v100
    ds_read_b64 v[102:103], v102
    s_waitcnt lgkmcnt(8)
    v_smfmac_f32_16x16x64_bf16 v[16:19], v[64:67], v[104:111], v68
    v_lshlrev_b32_sdwa v104, 3, v126 dst_sel:DWORD dst_unused:UNUSED_PAD src0_sel:DWORD src1_sel:WORD_0
    v_lshlrev_b32_sdwa v106, 3, v126 dst_sel:DWORD dst_unused:UNUSED_PAD src0_sel:DWORD src1_sel:WORD_1
    ds_read_b64 v[104:105], v104
    ds_read_b64 v[106:107], v106
    v_lshlrev_b32_sdwa v108, 3, v127 dst_sel:DWORD dst_unused:UNUSED_PAD src0_sel:DWORD src1_sel:WORD_0
    v_lshlrev_b32_sdwa v110, 3, v127 dst_sel:DWORD dst_unused:UNUSED_PAD src0_sel:DWORD src1_sel:WORD_1
    ds_read_b64 v[108:109], v108
    ds_read_b64 v[110:111], v110
    buffer_load_dwordx4 v[124:127], v69, s[12:15], s40 offen offset:1024 sc1
    s_waitcnt lgkmcnt(8)
    v_smfmac_f32_16x16x64_bf16 v[20:23], v[64:67], v[88:95], v68
    s_waitcnt vmcnt(2)
    v_lshlrev_b32_sdwa v88, 3, v116 dst_sel:DWORD dst_unused:UNUSED_PAD src0_sel:DWORD src1_sel:WORD_0
    v_lshlrev_b32_sdwa v90, 3, v116 dst_sel:DWORD dst_unused:UNUSED_PAD src0_sel:DWORD src1_sel:WORD_1
    ds_read_b64 v[88:89], v88
    ds_read_b64 v[90:91], v90
    v_lshlrev_b32_sdwa v92, 3, v117 dst_sel:DWORD dst_unused:UNUSED_PAD src0_sel:DWORD src1_sel:WORD_0
    v_lshlrev_b32_sdwa v94, 3, v117 dst_sel:DWORD dst_unused:UNUSED_PAD src0_sel:DWORD src1_sel:WORD_1
    ds_read_b64 v[92:93], v92
    ds_read_b64 v[94:95], v94
    s_waitcnt lgkmcnt(8)
    v_smfmac_f32_16x16x64_bf16 v[24:27], v[64:67], v[96:103], v68
    v_lshlrev_b32_sdwa v96, 3, v118 dst_sel:DWORD dst_unused:UNUSED_PAD src0_sel:DWORD src1_sel:WORD_0
    v_lshlrev_b32_sdwa v98, 3, v118 dst_sel:DWORD dst_unused:UNUSED_PAD src0_sel:DWORD src1_sel:WORD_1
    ds_read_b64 v[96:97], v96
    ds_read_b64 v[98:99], v98
    v_lshlrev_b32_sdwa v100, 3, v119 dst_sel:DWORD dst_unused:UNUSED_PAD src0_sel:DWORD src1_sel:WORD_0
    v_lshlrev_b32_sdwa v102, 3, v119 dst_sel:DWORD dst_unused:UNUSED_PAD src0_sel:DWORD src1_sel:WORD_1
    ds_read_b64 v[100:101], v100
    ds_read_b64 v[102:103], v102
    buffer_load_dwordx4 v[116:119], v69, s[12:15], s44 offen offset:1024 sc1
    s_waitcnt lgkmcnt(8)
    v_smfmac_f32_16x16x64_bf16 v[28:31], v[64:67], v[104:111], v68
    s_waitcnt vmcnt(2)
    v_lshlrev_b32_sdwa v104, 3, v120 dst_sel:DWORD dst_unused:UNUSED_PAD src0_sel:DWORD src1_sel:WORD_0
    v_lshlrev_b32_sdwa v106, 3, v120 dst_sel:DWORD dst_unused:UNUSED_PAD src0_sel:DWORD src1_sel:WORD_1
    ds_read_b64 v[104:105], v104
    ds_read_b64 v[106:107], v106
    v_lshlrev_b32_sdwa v108, 3, v121 dst_sel:DWORD dst_unused:UNUSED_PAD src0_sel:DWORD src1_sel:WORD_0
    v_lshlrev_b32_sdwa v110, 3, v121 dst_sel:DWORD dst_unused:UNUSED_PAD src0_sel:DWORD src1_sel:WORD_1
    ds_read_b64 v[108:109], v108
    ds_read_b64 v[110:111], v110
    s_waitcnt lgkmcnt(8)
    v_smfmac_f32_16x16x64_bf16 v[0:3], v[64:67], v[88:95], v68
    v_lshlrev_b32_sdwa v88, 3, v122 dst_sel:DWORD dst_unused:UNUSED_PAD src0_sel:DWORD src1_sel:WORD_0
    v_lshlrev_b32_sdwa v90, 3, v122 dst_sel:DWORD dst_unused:UNUSED_PAD src0_sel:DWORD src1_sel:WORD_1
    ds_read_b64 v[88:89], v88
    ds_read_b64 v[90:91], v90
    v_lshlrev_b32_sdwa v92, 3, v123 dst_sel:DWORD dst_unused:UNUSED_PAD src0_sel:DWORD src1_sel:WORD_0
    v_lshlrev_b32_sdwa v94, 3, v123 dst_sel:DWORD dst_unused:UNUSED_PAD src0_sel:DWORD src1_sel:WORD_1
    ds_read_b64 v[92:93], v92
    ds_read_b64 v[94:95], v94
    buffer_load_dwordx4 v[120:123], v69, s[12:15], s40 offen offset:2048 sc1
    s_waitcnt lgkmcnt(8)
    v_smfmac_f32_16x16x64_bf16 v[4:7], v[64:67], v[96:103], v68
    s_waitcnt vmcnt(2)
    v_lshlrev_b32_sdwa v96, 3, v124 dst_sel:DWORD dst_unused:UNUSED_PAD src0_sel:DWORD src1_sel:WORD_0
    v_lshlrev_b32_sdwa v98, 3, v124 dst_sel:DWORD dst_unused:UNUSED_PAD src0_sel:DWORD src1_sel:WORD_1
    ds_read_b64 v[96:97], v96
    ds_read_b64 v[98:99], v98
    v_lshlrev_b32_sdwa v100, 3, v125 dst_sel:DWORD dst_unused:UNUSED_PAD src0_sel:DWORD src1_sel:WORD_0
    v_lshlrev_b32_sdwa v102, 3, v125 dst_sel:DWORD dst_unused:UNUSED_PAD src0_sel:DWORD src1_sel:WORD_1
    ds_read_b64 v[100:101], v100
    ds_read_b64 v[102:103], v102
    s_waitcnt lgkmcnt(8)
    v_smfmac_f32_16x16x64_bf16 v[0:3], v[64:67], v[104:111], v68
    v_lshlrev_b32_sdwa v104, 3, v126 dst_sel:DWORD dst_unused:UNUSED_PAD src0_sel:DWORD src1_sel:WORD_0
    v_lshlrev_b32_sdwa v106, 3, v126 dst_sel:DWORD dst_unused:UNUSED_PAD src0_sel:DWORD src1_sel:WORD_1
    ds_read_b64 v[104:105], v104
    ds_read_b64 v[106:107], v106
    v_lshlrev_b32_sdwa v108, 3, v127 dst_sel:DWORD dst_unused:UNUSED_PAD src0_sel:DWORD src1_sel:WORD_0
    v_lshlrev_b32_sdwa v110, 3, v127 dst_sel:DWORD dst_unused:UNUSED_PAD src0_sel:DWORD src1_sel:WORD_1
    ds_read_b64 v[108:109], v108
    ds_read_b64 v[110:111], v110
    buffer_load_dwordx4 v[124:127], v69, s[12:15], s44 offen offset:2048 sc1
    s_waitcnt lgkmcnt(8)
    v_smfmac_f32_16x16x64_bf16 v[4:7], v[64:67], v[88:95], v68
    s_waitcnt vmcnt(2)
    v_lshlrev_b32_sdwa v88, 3, v116 dst_sel:DWORD dst_unused:UNUSED_PAD src0_sel:DWORD src1_sel:WORD_0
    v_lshlrev_b32_sdwa v90, 3, v116 dst_sel:DWORD dst_unused:UNUSED_PAD src0_sel:DWORD src1_sel:WORD_1
    ds_read_b64 v[88:89], v88
    ds_read_b64 v[90:91], v90
    v_lshlrev_b32_sdwa v92, 3, v117 dst_sel:DWORD dst_unused:UNUSED_PAD src0_sel:DWORD src1_sel:WORD_0
    v_lshlrev_b32_sdwa v94, 3, v117 dst_sel:DWORD dst_unused:UNUSED_PAD src0_sel:DWORD src1_sel:WORD_1
    ds_read_b64 v[92:93], v92
    ds_read_b64 v[94:95], v94
    s_waitcnt lgkmcnt(8)
    v_smfmac_f32_16x16x64_bf16 v[8:11], v[64:67], v[96:103], v68
    v_pk_mul_f32 v[140:141], v[0:1], v[0:1]
    v_pk_mul_f32 v[142:143], v[2:3], v[2:3]
    v_pk_fma_f32 v[140:141], v[140:141], v[128:129], v[130:131]
    v_pk_fma_f32 v[142:143], v[142:143], v[128:129], v[130:131]
    v_pk_mul_f32 v[140:141], v[140:141], v[0:1]
    v_pk_mul_f32 v[142:143], v[142:143], v[2:3]
    v_exp_f32 v140, v140
    v_pk_mul_f32 v[146:147], v[4:5], v[4:5]
    v_lshlrev_b32_sdwa v96, 3, v118 dst_sel:DWORD dst_unused:UNUSED_PAD src0_sel:DWORD src1_sel:WORD_0
    v_lshlrev_b32_sdwa v98, 3, v118 dst_sel:DWORD dst_unused:UNUSED_PAD src0_sel:DWORD src1_sel:WORD_1
    ds_read_b64 v[96:97], v96
    ds_read_b64 v[98:99], v98
    v_lshlrev_b32_sdwa v100, 3, v119 dst_sel:DWORD dst_unused:UNUSED_PAD src0_sel:DWORD src1_sel:WORD_0
    v_lshlrev_b32_sdwa v102, 3, v119 dst_sel:DWORD dst_unused:UNUSED_PAD src0_sel:DWORD src1_sel:WORD_1
    ds_read_b64 v[100:101], v100
    ds_read_b64 v[102:103], v102
    buffer_load_dwordx4 v[116:119], v69, s[12:15], s40 offen offset:3072 sc1
    s_waitcnt lgkmcnt(8)
    v_smfmac_f32_16x16x64_bf16 v[12:15], v[64:67], v[104:111], v68
    v_exp_f32 v141, v141
    v_pk_fma_f32 v[146:147], v[146:147], v[128:129], v[130:131]
    v_pk_mul_f32 v[148:149], v[6:7], v[6:7]
    v_exp_f32 v142, v142
    v_pk_fma_f32 v[140:141], v[140:141], v[134:135], v[134:135]
    v_pk_mul_f32 v[146:147], v[146:147], v[4:5]
    v_rcp_f32 v140, v140
    v_pk_fma_f32 v[148:149], v[148:149], v[128:129], v[130:131]
    s_waitcnt vmcnt(2)
    v_lshlrev_b32_sdwa v104, 3, v120 dst_sel:DWORD dst_unused:UNUSED_PAD src0_sel:DWORD src1_sel:WORD_0
    v_lshlrev_b32_sdwa v106, 3, v120 dst_sel:DWORD dst_unused:UNUSED_PAD src0_sel:DWORD src1_sel:WORD_1
    ds_read_b64 v[104:105], v104
    ds_read_b64 v[106:107], v106
    v_lshlrev_b32_sdwa v108, 3, v121 dst_sel:DWORD dst_unused:UNUSED_PAD src0_sel:DWORD src1_sel:WORD_0
    v_lshlrev_b32_sdwa v110, 3, v121 dst_sel:DWORD dst_unused:UNUSED_PAD src0_sel:DWORD src1_sel:WORD_1
    ds_read_b64 v[108:109], v108
    ds_read_b64 v[110:111], v110
    s_waitcnt lgkmcnt(8)
    v_smfmac_f32_16x16x64_bf16 v[8:11], v[64:67], v[88:95], v68
    v_rcp_f32 v141, v141
    v_pk_mul_f32 v[148:149], v[148:149], v[6:7]
    v_exp_f32 v143, v143
    v_pk_mul_f32 v[144:145], v[0:1], v[140:141]
    v_exp_f32 v146, v146
    v_pk_fma_f32 v[142:143], v[142:143], v[136:137], v[136:137]
    v_exp_f32 v147, v147
    v_rcp_f32 v142, v142
    v_lshlrev_b32_sdwa v88, 3, v122 dst_sel:DWORD dst_unused:UNUSED_PAD src0_sel:DWORD src1_sel:WORD_0
    v_lshlrev_b32_sdwa v90, 3, v122 dst_sel:DWORD dst_unused:UNUSED_PAD src0_sel:DWORD src1_sel:WORD_1
    ds_read_b64 v[88:89], v88
    ds_read_b64 v[90:91], v90
    v_lshlrev_b32_sdwa v92, 3, v123 dst_sel:DWORD dst_unused:UNUSED_PAD src0_sel:DWORD src1_sel:WORD_0
    v_lshlrev_b32_sdwa v94, 3, v123 dst_sel:DWORD dst_unused:UNUSED_PAD src0_sel:DWORD src1_sel:WORD_1
    ds_read_b64 v[92:93], v92
    ds_read_b64 v[94:95], v94
    buffer_load_dwordx4 v[120:123], v69, s[12:15], s44 offen offset:3072 sc1
    s_waitcnt lgkmcnt(8)
    v_smfmac_f32_16x16x64_bf16 v[12:15], v[64:67], v[96:103], v68
    v_rcp_f32 v143, v143
    v_pk_fma_f32 v[146:147], v[146:147], v[134:135], v[134:135]
    v_pk_mul_f32 v[152:153], v[8:9], v[8:9]
    v_rcp_f32 v146, v146
    v_pk_fma_f32 v[144:145], v[2:3], v[142:143], v[144:145]
    v_pk_fma_f32 v[152:153], v[152:153], v[128:129], v[130:131]
    v_rcp_f32 v147, v147
    v_add_f32 v144, v144, v145
    s_waitcnt vmcnt(2)
    v_lshlrev_b32_sdwa v96, 3, v124 dst_sel:DWORD dst_unused:UNUSED_PAD src0_sel:DWORD src1_sel:WORD_0
    v_lshlrev_b32_sdwa v98, 3, v124 dst_sel:DWORD dst_unused:UNUSED_PAD src0_sel:DWORD src1_sel:WORD_1
    ds_read_b64 v[96:97], v96
    ds_read_b64 v[98:99], v98
    v_lshlrev_b32_sdwa v100, 3, v125 dst_sel:DWORD dst_unused:UNUSED_PAD src0_sel:DWORD src1_sel:WORD_0
    v_lshlrev_b32_sdwa v102, 3, v125 dst_sel:DWORD dst_unused:UNUSED_PAD src0_sel:DWORD src1_sel:WORD_1
    ds_read_b64 v[100:101], v100
    ds_read_b64 v[102:103], v102
    s_waitcnt lgkmcnt(8)
    v_smfmac_f32_16x16x64_bf16 v[16:19], v[64:67], v[104:111], v68
    v_exp_f32 v148, v148
    buffer_store_dword v144, v70, s[12:15], s35 offen offset:0 sc1
    v_pk_mul_f32 v[150:151], v[4:5], v[146:147]
    v_exp_f32 v149, v149
    v_pk_mul_f32 v[152:153], v[152:153], v[8:9]
    v_pk_mul_f32 v[154:155], v[10:11], v[10:11]
    v_exp_f32 v152, v152
    v_pk_fma_f32 v[148:149], v[148:149], v[136:137], v[136:137]
    v_lshlrev_b32_sdwa v104, 3, v126 dst_sel:DWORD dst_unused:UNUSED_PAD src0_sel:DWORD src1_sel:WORD_0
    v_lshlrev_b32_sdwa v106, 3, v126 dst_sel:DWORD dst_unused:UNUSED_PAD src0_sel:DWORD src1_sel:WORD_1
    ds_read_b64 v[104:105], v104
    ds_read_b64 v[106:107], v106
    v_lshlrev_b32_sdwa v108, 3, v127 dst_sel:DWORD dst_unused:UNUSED_PAD src0_sel:DWORD src1_sel:WORD_0
    v_lshlrev_b32_sdwa v110, 3, v127 dst_sel:DWORD dst_unused:UNUSED_PAD src0_sel:DWORD src1_sel:WORD_1
    ds_read_b64 v[108:109], v108
    ds_read_b64 v[110:111], v110
    buffer_load_dwordx4 v[124:127], v69, s[12:15], s20 offen offset:0 sc1
    s_waitcnt lgkmcnt(8)
    v_smfmac_f32_16x16x64_bf16 v[20:23], v[64:67], v[88:95], v68
    v_rcp_f32 v148, v148
    v_pk_fma_f32 v[154:155], v[154:155], v[128:129], v[130:131]
    v_pk_mul_f32 v[158:159], v[12:13], v[12:13]
    v_rcp_f32 v149, v149
    v_pk_mul_f32 v[154:155], v[154:155], v[10:11]
    v_pk_fma_f32 v[158:159], v[158:159], v[128:129], v[130:131]
    v_exp_f32 v153, v153
    v_pk_fma_f32 v[150:151], v[6:7], v[148:149], v[150:151]
    s_waitcnt vmcnt(3)
    v_lshlrev_b32_sdwa v88, 3, v116 dst_sel:DWORD dst_unused:UNUSED_PAD src0_sel:DWORD src1_sel:WORD_0
    v_lshlrev_b32_sdwa v90, 3, v116 dst_sel:DWORD dst_unused:UNUSED_PAD src0_sel:DWORD src1_sel:WORD_1
    ds_read_b64 v[88:89], v88
    ds_read_b64 v[90:91], v90
    v_lshlrev_b32_sdwa v92, 3, v117 dst_sel:DWORD dst_unused:UNUSED_PAD src0_sel:DWORD src1_sel:WORD_0
    v_lshlrev_b32_sdwa v94, 3, v117 dst_sel:DWORD dst_unused:UNUSED_PAD src0_sel:DWORD src1_sel:WORD_1
    ds_read_b64 v[92:93], v92
    ds_read_b64 v[94:95], v94
    s_waitcnt lgkmcnt(8)
    v_smfmac_f32_16x16x64_bf16 v[16:19], v[64:67], v[96:103], v68
    v_exp_f32 v154, v154
    v_add_f32 v150, v150, v151
    v_pk_fma_f32 v[152:153], v[152:153], v[134:135], v[134:135]
    v_exp_f32 v155, v155
    buffer_store_dword v150, v70, s[12:15], s35 offen offset:128 sc1
    v_pk_mul_f32 v[158:159], v[158:159], v[12:13]
    v_rcp_f32 v152, v152
    v_pk_fma_f32 v[154:155], v[154:155], v[136:137], v[136:137]
    v_lshlrev_b32_sdwa v96, 3, v118 dst_sel:DWORD dst_unused:UNUSED_PAD src0_sel:DWORD src1_sel:WORD_0
    v_lshlrev_b32_sdwa v98, 3, v118 dst_sel:DWORD dst_unused:UNUSED_PAD src0_sel:DWORD src1_sel:WORD_1
    ds_read_b64 v[96:97], v96
    ds_read_b64 v[98:99], v98
    v_lshlrev_b32_sdwa v100, 3, v119 dst_sel:DWORD dst_unused:UNUSED_PAD src0_sel:DWORD src1_sel:WORD_0
    v_lshlrev_b32_sdwa v102, 3, v119 dst_sel:DWORD dst_unused:UNUSED_PAD src0_sel:DWORD src1_sel:WORD_1
    ds_read_b64 v[100:101], v100
    ds_read_b64 v[102:103], v102
    buffer_load_dwordx4 v[116:119], v69, s[12:15], s41 offen offset:0 sc1
    s_waitcnt lgkmcnt(8)
    v_smfmac_f32_16x16x64_bf16 v[20:23], v[64:67], v[104:111], v68
    v_rcp_f32 v153, v153
    v_pk_mul_f32 v[160:161], v[14:15], v[14:15]
    v_pk_mul_f32 v[164:165], v[16:17], v[16:17]
    v_rcp_f32 v154, v154
    v_pk_mul_f32 v[156:157], v[8:9], v[152:153]
    v_pk_fma_f32 v[160:161], v[160:161], v[128:129], v[130:131]
    v_rcp_f32 v155, v155
    v_pk_mul_f32 v[160:161], v[160:161], v[14:15]
    s_waitcnt vmcnt(4)
    v_lshlrev_b32_sdwa v104, 3, v120 dst_sel:DWORD dst_unused:UNUSED_PAD src0_sel:DWORD src1_sel:WORD_0
    v_lshlrev_b32_sdwa v106, 3, v120 dst_sel:DWORD dst_unused:UNUSED_PAD src0_sel:DWORD src1_sel:WORD_1
    ds_read_b64 v[104:105], v104
    ds_read_b64 v[106:107], v106
    v_lshlrev_b32_sdwa v108, 3, v121 dst_sel:DWORD dst_unused:UNUSED_PAD src0_sel:DWORD src1_sel:WORD_0
    v_lshlrev_b32_sdwa v110, 3, v121 dst_sel:DWORD dst_unused:UNUSED_PAD src0_sel:DWORD src1_sel:WORD_1
    ds_read_b64 v[108:109], v108
    ds_read_b64 v[110:111], v110
    s_waitcnt lgkmcnt(8)
    v_smfmac_f32_16x16x64_bf16 v[24:27], v[64:67], v[88:95], v68
    v_exp_f32 v158, v158
    v_pk_fma_f32 v[156:157], v[10:11], v[154:155], v[156:157]
    v_pk_fma_f32 v[164:165], v[164:165], v[128:129], v[130:131]
    v_exp_f32 v159, v159
    v_add_f32 v156, v156, v157
    v_pk_mul_f32 v[164:165], v[164:165], v[16:17]
    v_exp_f32 v160, v160
    buffer_store_dword v156, v70, s[12:15], s35 offen offset:512 sc1
    v_lshlrev_b32_sdwa v88, 3, v122 dst_sel:DWORD dst_unused:UNUSED_PAD src0_sel:DWORD src1_sel:WORD_0
    v_lshlrev_b32_sdwa v90, 3, v122 dst_sel:DWORD dst_unused:UNUSED_PAD src0_sel:DWORD src1_sel:WORD_1
    ds_read_b64 v[88:89], v88
    ds_read_b64 v[90:91], v90
    v_lshlrev_b32_sdwa v92, 3, v123 dst_sel:DWORD dst_unused:UNUSED_PAD src0_sel:DWORD src1_sel:WORD_0
    v_lshlrev_b32_sdwa v94, 3, v123 dst_sel:DWORD dst_unused:UNUSED_PAD src0_sel:DWORD src1_sel:WORD_1
    ds_read_b64 v[92:93], v92
    ds_read_b64 v[94:95], v94
    buffer_load_dwordx4 v[120:123], v69, s[12:15], s45 offen offset:0 sc1
    s_waitcnt lgkmcnt(8)
    v_smfmac_f32_16x16x64_bf16 v[28:31], v[64:67], v[96:103], v68
    v_exp_f32 v161, v161
    v_pk_fma_f32 v[158:159], v[158:159], v[134:135], v[134:135]
    v_pk_mul_f32 v[166:167], v[18:19], v[18:19]
    v_rcp_f32 v158, v158
    v_pk_fma_f32 v[160:161], v[160:161], v[136:137], v[136:137]
    v_pk_fma_f32 v[166:167], v[166:167], v[128:129], v[130:131]
    v_rcp_f32 v159, v159
    v_pk_mul_f32 v[166:167], v[166:167], v[18:19]
    s_waitcnt vmcnt(4)
    v_lshlrev_b32_sdwa v96, 3, v124 dst_sel:DWORD dst_unused:UNUSED_PAD src0_sel:DWORD src1_sel:WORD_0
    v_lshlrev_b32_sdwa v98, 3, v124 dst_sel:DWORD dst_unused:UNUSED_PAD src0_sel:DWORD src1_sel:WORD_1
    ds_read_b64 v[96:97], v96
    ds_read_b64 v[98:99], v98
    v_lshlrev_b32_sdwa v100, 3, v125 dst_sel:DWORD dst_unused:UNUSED_PAD src0_sel:DWORD src1_sel:WORD_0
    v_lshlrev_b32_sdwa v102, 3, v125 dst_sel:DWORD dst_unused:UNUSED_PAD src0_sel:DWORD src1_sel:WORD_1
    ds_read_b64 v[100:101], v100
    ds_read_b64 v[102:103], v102
    s_waitcnt lgkmcnt(8)
    v_smfmac_f32_16x16x64_bf16 v[24:27], v[64:67], v[104:111], v68
    v_rcp_f32 v160, v160
    v_pk_mul_f32 v[162:163], v[12:13], v[158:159]
    v_pk_mul_f32 v[170:171], v[20:21], v[20:21]
    v_rcp_f32 v161, v161
    v_pk_fma_f32 v[170:171], v[170:171], v[128:129], v[130:131]
    v_pk_mul_f32 v[172:173], v[22:23], v[22:23]
    v_exp_f32 v164, v164
    v_pk_fma_f32 v[162:163], v[14:15], v[160:161], v[162:163]
    v_lshlrev_b32_sdwa v104, 3, v126 dst_sel:DWORD dst_unused:UNUSED_PAD src0_sel:DWORD src1_sel:WORD_0
    v_lshlrev_b32_sdwa v106, 3, v126 dst_sel:DWORD dst_unused:UNUSED_PAD src0_sel:DWORD src1_sel:WORD_1
    ds_read_b64 v[104:105], v104
    ds_read_b64 v[106:107], v106
    v_lshlrev_b32_sdwa v108, 3, v127 dst_sel:DWORD dst_unused:UNUSED_PAD src0_sel:DWORD src1_sel:WORD_0
    v_lshlrev_b32_sdwa v110, 3, v127 dst_sel:DWORD dst_unused:UNUSED_PAD src0_sel:DWORD src1_sel:WORD_1
    ds_read_b64 v[108:109], v108
    ds_read_b64 v[110:111], v110
    buffer_load_dwordx4 v[124:127], v69, s[12:15], s20 offen offset:1024 sc1
    s_waitcnt lgkmcnt(8)
    v_smfmac_f32_16x16x64_bf16 v[28:31], v[64:67], v[88:95], v68
    s_setprio 2
    v_exp_f32 v165, v165
    v_add_f32 v162, v162, v163
    v_pk_mul_f32 v[170:171], v[170:171], v[20:21]
    v_exp_f32 v166, v166
    buffer_store_dword v162, v70, s[12:15], s35 offen offset:640 sc1
    v_pk_fma_f32 v[164:165], v[164:165], v[134:135], v[134:135]
    v_exp_f32 v167, v167
    v_pk_fma_f32 v[172:173], v[172:173], v[128:129], v[130:131]
    s_waitcnt vmcnt(4)
    v_lshlrev_b32_sdwa v88, 3, v116 dst_sel:DWORD dst_unused:UNUSED_PAD src0_sel:DWORD src1_sel:WORD_0
    v_lshlrev_b32_sdwa v90, 3, v116 dst_sel:DWORD dst_unused:UNUSED_PAD src0_sel:DWORD src1_sel:WORD_1
    ds_read_b64 v[88:89], v88
    ds_read_b64 v[90:91], v90
    v_lshlrev_b32_sdwa v92, 3, v117 dst_sel:DWORD dst_unused:UNUSED_PAD src0_sel:DWORD src1_sel:WORD_0
    v_lshlrev_b32_sdwa v94, 3, v117 dst_sel:DWORD dst_unused:UNUSED_PAD src0_sel:DWORD src1_sel:WORD_1
    ds_read_b64 v[92:93], v92
    ds_read_b64 v[94:95], v94
    s_waitcnt lgkmcnt(8)
    v_smfmac_f32_16x16x64_bf16 v[32:35], v[64:67], v[96:103], v68
    v_rcp_f32 v164, v164
    v_pk_fma_f32 v[166:167], v[166:167], v[136:137], v[136:137]
    v_pk_mul_f32 v[172:173], v[172:173], v[22:23]
    v_rcp_f32 v165, v165
    v_pk_mul_f32 v[140:141], v[24:25], v[24:25]
    v_pk_mul_f32 v[142:143], v[26:27], v[26:27]
    v_rcp_f32 v166, v166
    v_pk_mul_f32 v[168:169], v[16:17], v[164:165]
    v_lshlrev_b32_sdwa v96, 3, v118 dst_sel:DWORD dst_unused:UNUSED_PAD src0_sel:DWORD src1_sel:WORD_0
    v_lshlrev_b32_sdwa v98, 3, v118 dst_sel:DWORD dst_unused:UNUSED_PAD src0_sel:DWORD src1_sel:WORD_1
    ds_read_b64 v[96:97], v96
    ds_read_b64 v[98:99], v98
    v_lshlrev_b32_sdwa v100, 3, v119 dst_sel:DWORD dst_unused:UNUSED_PAD src0_sel:DWORD src1_sel:WORD_0
    v_lshlrev_b32_sdwa v102, 3, v119 dst_sel:DWORD dst_unused:UNUSED_PAD src0_sel:DWORD src1_sel:WORD_1
    ds_read_b64 v[100:101], v100
    ds_read_b64 v[102:103], v102
    buffer_load_dwordx4 v[116:119], v69, s[12:15], s41 offen offset:1024 sc1
    s_waitcnt lgkmcnt(8)
    v_smfmac_f32_16x16x64_bf16 v[36:39], v[64:67], v[104:111], v68
    v_rcp_f32 v167, v167
    v_pk_fma_f32 v[140:141], v[140:141], v[128:129], v[130:131]
    v_pk_fma_f32 v[142:143], v[142:143], v[128:129], v[130:131]
    v_exp_f32 v170, v170
    v_pk_fma_f32 v[168:169], v[18:19], v[166:167], v[168:169]
    v_pk_mul_f32 v[140:141], v[140:141], v[24:25]
    v_exp_f32 v171, v171
    v_add_f32 v168, v168, v169
    s_waitcnt vmcnt(3)
    v_lshlrev_b32_sdwa v104, 3, v120 dst_sel:DWORD dst_unused:UNUSED_PAD src0_sel:DWORD src1_sel:WORD_0
    v_lshlrev_b32_sdwa v106, 3, v120 dst_sel:DWORD dst_unused:UNUSED_PAD src0_sel:DWORD src1_sel:WORD_1
    ds_read_b64 v[104:105], v104
    ds_read_b64 v[106:107], v106
    v_lshlrev_b32_sdwa v108, 3, v121 dst_sel:DWORD dst_unused:UNUSED_PAD src0_sel:DWORD src1_sel:WORD_0
    v_lshlrev_b32_sdwa v110, 3, v121 dst_sel:DWORD dst_unused:UNUSED_PAD src0_sel:DWORD src1_sel:WORD_1
    ds_read_b64 v[108:109], v108
    ds_read_b64 v[110:111], v110
    s_waitcnt lgkmcnt(8)
    v_smfmac_f32_16x16x64_bf16 v[32:35], v[64:67], v[88:95], v68
    v_exp_f32 v172, v172
    buffer_store_dword v168, v70, s[12:15], s35 offen offset:1024 sc1
    v_pk_fma_f32 v[170:171], v[170:171], v[134:135], v[134:135]
    v_exp_f32 v173, v173
    v_pk_mul_f32 v[142:143], v[142:143], v[26:27]
    v_pk_mul_f32 v[146:147], v[28:29], v[28:29]
    v_rcp_f32 v170, v170
    v_pk_fma_f32 v[172:173], v[172:173], v[136:137], v[136:137]
    v_lshlrev_b32_sdwa v88, 3, v122 dst_sel:DWORD dst_unused:UNUSED_PAD src0_sel:DWORD src1_sel:WORD_0
    v_lshlrev_b32_sdwa v90, 3, v122 dst_sel:DWORD dst_unused:UNUSED_PAD src0_sel:DWORD src1_sel:WORD_1
    ds_read_b64 v[88:89], v88
    ds_read_b64 v[90:91], v90
    v_lshlrev_b32_sdwa v92, 3, v123 dst_sel:DWORD dst_unused:UNUSED_PAD src0_sel:DWORD src1_sel:WORD_0
    v_lshlrev_b32_sdwa v94, 3, v123 dst_sel:DWORD dst_unused:UNUSED_PAD src0_sel:DWORD src1_sel:WORD_1
    ds_read_b64 v[92:93], v92
    ds_read_b64 v[94:95], v94
    buffer_load_dwordx4 v[120:123], v69, s[12:15], s45 offen offset:1024 sc1
    s_waitcnt lgkmcnt(8)
    v_smfmac_f32_16x16x64_bf16 v[36:39], v[64:67], v[96:103], v68
    v_rcp_f32 v171, v171
    v_pk_fma_f32 v[146:147], v[146:147], v[128:129], v[130:131]
    v_pk_mul_f32 v[148:149], v[30:31], v[30:31]
    v_rcp_f32 v172, v172
    v_pk_mul_f32 v[174:175], v[20:21], v[170:171]
    v_pk_mul_f32 v[146:147], v[146:147], v[28:29]
    v_rcp_f32 v173, v173
    v_pk_fma_f32 v[148:149], v[148:149], v[128:129], v[130:131]
    s_waitcnt vmcnt(4)
    v_lshlrev_b32_sdwa v96, 3, v124 dst_sel:DWORD dst_unused:UNUSED_PAD src0_sel:DWORD src1_sel:WORD_0
    v_lshlrev_b32_sdwa v98, 3, v124 dst_sel:DWORD dst_unused:UNUSED_PAD src0_sel:DWORD src1_sel:WORD_1
    ds_read_b64 v[96:97], v96
    ds_read_b64 v[98:99], v98
    v_lshlrev_b32_sdwa v100, 3, v125 dst_sel:DWORD dst_unused:UNUSED_PAD src0_sel:DWORD src1_sel:WORD_0
    v_lshlrev_b32_sdwa v102, 3, v125 dst_sel:DWORD dst_unused:UNUSED_PAD src0_sel:DWORD src1_sel:WORD_1
    ds_read_b64 v[100:101], v100
    ds_read_b64 v[102:103], v102
    s_waitcnt lgkmcnt(8)
    v_smfmac_f32_16x16x64_bf16 v[32:35], v[64:67], v[104:111], v68
    v_exp_f32 v140, v140
    v_pk_fma_f32 v[174:175], v[22:23], v[172:173], v[174:175]
    v_pk_mul_f32 v[148:149], v[148:149], v[30:31]
    v_exp_f32 v141, v141
    v_add_f32 v174, v174, v175
    v_exp_f32 v142, v142
    buffer_store_dword v174, v70, s[12:15], s35 offen offset:1152 sc1
    v_pk_fma_f32 v[140:141], v[140:141], v[134:135], v[134:135]
    v_lshlrev_b32_sdwa v104, 3, v126 dst_sel:DWORD dst_unused:UNUSED_PAD src0_sel:DWORD src1_sel:WORD_0
    v_lshlrev_b32_sdwa v106, 3, v126 dst_sel:DWORD dst_unused:UNUSED_PAD src0_sel:DWORD src1_sel:WORD_1
    ds_read_b64 v[104:105], v104
    ds_read_b64 v[106:107], v106
    v_lshlrev_b32_sdwa v108, 3, v127 dst_sel:DWORD dst_unused:UNUSED_PAD src0_sel:DWORD src1_sel:WORD_0
    v_lshlrev_b32_sdwa v110, 3, v127 dst_sel:DWORD dst_unused:UNUSED_PAD src0_sel:DWORD src1_sel:WORD_1
    ds_read_b64 v[108:109], v108
    ds_read_b64 v[110:111], v110
    buffer_load_dwordx4 v[124:127], v69, s[12:15], s20 offen offset:2048 sc1
    s_waitcnt lgkmcnt(8)
    v_smfmac_f32_16x16x64_bf16 v[36:39], v[64:67], v[88:95], v68
    v_rcp_f32 v140, v140
    v_pk_mul_f32 v[152:153], v[32:33], v[32:33]
    v_pk_mul_f32 v[154:155], v[34:35], v[34:35]
    v_rcp_f32 v141, v141
    v_pk_fma_f32 v[152:153], v[152:153], v[128:129], v[130:131]
    v_pk_fma_f32 v[154:155], v[154:155], v[128:129], v[130:131]
    v_exp_f32 v143, v143
    v_pk_mul_f32 v[144:145], v[24:25], v[140:141]
    s_waitcnt vmcnt(4)
    v_lshlrev_b32_sdwa v88, 3, v116 dst_sel:DWORD dst_unused:UNUSED_PAD src0_sel:DWORD src1_sel:WORD_0
    v_lshlrev_b32_sdwa v90, 3, v116 dst_sel:DWORD dst_unused:UNUSED_PAD src0_sel:DWORD src1_sel:WORD_1
    ds_read_b64 v[88:89], v88
    ds_read_b64 v[90:91], v90
    v_lshlrev_b32_sdwa v92, 3, v117 dst_sel:DWORD dst_unused:UNUSED_PAD src0_sel:DWORD src1_sel:WORD_0
    v_lshlrev_b32_sdwa v94, 3, v117 dst_sel:DWORD dst_unused:UNUSED_PAD src0_sel:DWORD src1_sel:WORD_1
    ds_read_b64 v[92:93], v92
    ds_read_b64 v[94:95], v94
    s_waitcnt lgkmcnt(8)
    v_smfmac_f32_16x16x64_bf16 v[40:43], v[64:67], v[96:103], v68
    v_exp_f32 v146, v146
    v_pk_fma_f32 v[142:143], v[142:143], v[136:137], v[136:137]
    v_pk_mul_f32 v[152:153], v[152:153], v[32:33]
    v_rcp_f32 v142, v142
    v_pk_mul_f32 v[154:155], v[154:155], v[34:35]
    v_pk_mul_f32 v[158:159], v[36:37], v[36:37]
    v_rcp_f32 v143, v143
    v_pk_fma_f32 v[158:159], v[158:159], v[128:129], v[130:131]
    v_lshlrev_b32_sdwa v96, 3, v118 dst_sel:DWORD dst_unused:UNUSED_PAD src0_sel:DWORD src1_sel:WORD_0
    v_lshlrev_b32_sdwa v98, 3, v118 dst_sel:DWORD dst_unused:UNUSED_PAD src0_sel:DWORD src1_sel:WORD_1
    ds_read_b64 v[96:97], v96
    ds_read_b64 v[98:99], v98
    v_lshlrev_b32_sdwa v100, 3, v119 dst_sel:DWORD dst_unused:UNUSED_PAD src0_sel:DWORD src1_sel:WORD_0
    v_lshlrev_b32_sdwa v102, 3, v119 dst_sel:DWORD dst_unused:UNUSED_PAD src0_sel:DWORD src1_sel:WORD_1
    ds_read_b64 v[100:101], v100
    ds_read_b64 v[102:103], v102
    buffer_load_dwordx4 v[116:119], v69, s[12:15], s41 offen offset:2048 sc1
    s_waitcnt lgkmcnt(8)
    v_smfmac_f32_16x16x64_bf16 v[44:47], v[64:67], v[104:111], v68
    v_exp_f32 v147, v147
    v_pk_fma_f32 v[144:145], v[26:27], v[142:143], v[144:145]
    v_pk_mul_f32 v[158:159], v[158:159], v[36:37]
    v_exp_f32 v148, v148
    v_add_f32 v144, v144, v145
    v_pk_fma_f32 v[146:147], v[146:147], v[134:135], v[134:135]
    v_exp_f32 v149, v149
    buffer_store_dword v144, v70, s[12:15], s35 offen offset:1536 sc1
    s_waitcnt vmcnt(4)
    v_lshlrev_b32_sdwa v104, 3, v120 dst_sel:DWORD dst_unused:UNUSED_PAD src0_sel:DWORD src1_sel:WORD_0
    v_lshlrev_b32_sdwa v106, 3, v120 dst_sel:DWORD dst_unused:UNUSED_PAD src0_sel:DWORD src1_sel:WORD_1
    ds_read_b64 v[104:105], v104
    ds_read_b64 v[106:107], v106
    v_lshlrev_b32_sdwa v108, 3, v121 dst_sel:DWORD dst_unused:UNUSED_PAD src0_sel:DWORD src1_sel:WORD_0
    v_lshlrev_b32_sdwa v110, 3, v121 dst_sel:DWORD dst_unused:UNUSED_PAD src0_sel:DWORD src1_sel:WORD_1
    ds_read_b64 v[108:109], v108
    ds_read_b64 v[110:111], v110
    s_waitcnt lgkmcnt(8)
    v_smfmac_f32_16x16x64_bf16 v[40:43], v[64:67], v[88:95], v68
    v_rcp_f32 v146, v146
    v_pk_fma_f32 v[148:149], v[148:149], v[136:137], v[136:137]
    v_pk_mul_f32 v[160:161], v[38:39], v[38:39]
    v_rcp_f32 v147, v147
    v_pk_fma_f32 v[160:161], v[160:161], v[128:129], v[130:131]
    v_rcp_f32 v148, v148
    v_pk_mul_f32 v[150:151], v[28:29], v[146:147]
    v_pk_mul_f32 v[160:161], v[160:161], v[38:39]
    v_lshlrev_b32_sdwa v88, 3, v122 dst_sel:DWORD dst_unused:UNUSED_PAD src0_sel:DWORD src1_sel:WORD_0
    v_lshlrev_b32_sdwa v90, 3, v122 dst_sel:DWORD dst_unused:UNUSED_PAD src0_sel:DWORD src1_sel:WORD_1
    ds_read_b64 v[88:89], v88
    ds_read_b64 v[90:91], v90
    v_lshlrev_b32_sdwa v92, 3, v123 dst_sel:DWORD dst_unused:UNUSED_PAD src0_sel:DWORD src1_sel:WORD_0
    v_lshlrev_b32_sdwa v94, 3, v123 dst_sel:DWORD dst_unused:UNUSED_PAD src0_sel:DWORD src1_sel:WORD_1
    ds_read_b64 v[92:93], v92
    ds_read_b64 v[94:95], v94
    buffer_load_dwordx4 v[120:123], v69, s[12:15], s45 offen offset:2048 sc1
    s_waitcnt lgkmcnt(8)
    v_smfmac_f32_16x16x64_bf16 v[44:47], v[64:67], v[96:103], v68
    v_rcp_f32 v149, v149
    v_exp_f32 v152, v152
    v_exp_f32 v153, v153
    v_pk_fma_f32 v[150:151], v[30:31], v[148:149], v[150:151]
    v_exp_f32 v154, v154
    v_add_f32 v150, v150, v151
    v_pk_fma_f32 v[152:153], v[152:153], v[134:135], v[134:135]
    v_exp_f32 v155, v155
    s_waitcnt vmcnt(3)
    v_lshlrev_b32_sdwa v96, 3, v124 dst_sel:DWORD dst_unused:UNUSED_PAD src0_sel:DWORD src1_sel:WORD_0
    v_lshlrev_b32_sdwa v98, 3, v124 dst_sel:DWORD dst_unused:UNUSED_PAD src0_sel:DWORD src1_sel:WORD_1
    ds_read_b64 v[96:97], v96
    ds_read_b64 v[98:99], v98
    v_lshlrev_b32_sdwa v100, 3, v125 dst_sel:DWORD dst_unused:UNUSED_PAD src0_sel:DWORD src1_sel:WORD_0
    v_lshlrev_b32_sdwa v102, 3, v125 dst_sel:DWORD dst_unused:UNUSED_PAD src0_sel:DWORD src1_sel:WORD_1
    ds_read_b64 v[100:101], v100
    ds_read_b64 v[102:103], v102
    s_waitcnt lgkmcnt(8)
    v_smfmac_f32_16x16x64_bf16 v[40:43], v[64:67], v[104:111], v68
    v_rcp_f32 v152, v152
    buffer_store_dword v150, v70, s[12:15], s35 offen offset:1664 sc1
    v_pk_fma_f32 v[154:155], v[154:155], v[136:137], v[136:137]
    v_rcp_f32 v153, v153
    v_rcp_f32 v154, v154
    v_rcp_f32 v155, v155
    v_pk_mul_f32 v[156:157], v[32:33], v[152:153]
    v_exp_f32 v158, v158
    v_lshlrev_b32_sdwa v104, 3, v126 dst_sel:DWORD dst_unused:UNUSED_PAD src0_sel:DWORD src1_sel:WORD_0
    v_lshlrev_b32_sdwa v106, 3, v126 dst_sel:DWORD dst_unused:UNUSED_PAD src0_sel:DWORD src1_sel:WORD_1
    ds_read_b64 v[104:105], v104
    ds_read_b64 v[106:107], v106
    v_lshlrev_b32_sdwa v108, 3, v127 dst_sel:DWORD dst_unused:UNUSED_PAD src0_sel:DWORD src1_sel:WORD_0
    v_lshlrev_b32_sdwa v110, 3, v127 dst_sel:DWORD dst_unused:UNUSED_PAD src0_sel:DWORD src1_sel:WORD_1
    ds_read_b64 v[108:109], v108
    ds_read_b64 v[110:111], v110
    buffer_load_dwordx4 v[124:127], v69, s[12:15], s20 offen offset:3072 sc1
    s_waitcnt lgkmcnt(8)
    v_smfmac_f32_16x16x64_bf16 v[44:47], v[64:67], v[88:95], v68
    v_exp_f32 v159, v159
    v_pk_fma_f32 v[156:157], v[34:35], v[154:155], v[156:157]
    v_pk_mul_f32 v[164:165], v[40:41], v[40:41]
    v_exp_f32 v160, v160
    v_add_f32 v156, v156, v157
    v_pk_fma_f32 v[158:159], v[158:159], v[134:135], v[134:135]
    v_exp_f32 v161, v161
    buffer_store_dword v156, v70, s[12:15], s35 offen offset:2048 sc1
    s_waitcnt vmcnt(5)
    v_lshlrev_b32_sdwa v88, 3, v116 dst_sel:DWORD dst_unused:UNUSED_PAD src0_sel:DWORD src1_sel:WORD_0
    v_lshlrev_b32_sdwa v90, 3, v116 dst_sel:DWORD dst_unused:UNUSED_PAD src0_sel:DWORD src1_sel:WORD_1
    ds_read_b64 v[88:89], v88
    ds_read_b64 v[90:91], v90
    v_lshlrev_b32_sdwa v92, 3, v117 dst_sel:DWORD dst_unused:UNUSED_PAD src0_sel:DWORD src1_sel:WORD_0
    v_lshlrev_b32_sdwa v94, 3, v117 dst_sel:DWORD dst_unused:UNUSED_PAD src0_sel:DWORD src1_sel:WORD_1
    ds_read_b64 v[92:93], v92
    ds_read_b64 v[94:95], v94
    s_waitcnt lgkmcnt(8)
    v_smfmac_f32_16x16x64_bf16 v[48:51], v[64:67], v[96:103], v68
    v_rcp_f32 v158, v158
    v_pk_fma_f32 v[160:161], v[160:161], v[136:137], v[136:137]
    v_pk_fma_f32 v[164:165], v[164:165], v[128:129], v[130:131]
    v_rcp_f32 v159, v159
    v_pk_mul_f32 v[164:165], v[164:165], v[40:41]
    v_pk_mul_f32 v[166:167], v[42:43], v[42:43]
    v_rcp_f32 v160, v160
    v_pk_mul_f32 v[162:163], v[36:37], v[158:159]
    v_lshlrev_b32_sdwa v96, 3, v118 dst_sel:DWORD dst_unused:UNUSED_PAD src0_sel:DWORD src1_sel:WORD_0
    v_lshlrev_b32_sdwa v98, 3, v118 dst_sel:DWORD dst_unused:UNUSED_PAD src0_sel:DWORD src1_sel:WORD_1
    ds_read_b64 v[96:97], v96
    ds_read_b64 v[98:99], v98
    v_lshlrev_b32_sdwa v100, 3, v119 dst_sel:DWORD dst_unused:UNUSED_PAD src0_sel:DWORD src1_sel:WORD_0
    v_lshlrev_b32_sdwa v102, 3, v119 dst_sel:DWORD dst_unused:UNUSED_PAD src0_sel:DWORD src1_sel:WORD_1
    ds_read_b64 v[100:101], v100
    ds_read_b64 v[102:103], v102
    buffer_load_dwordx4 v[116:119], v69, s[12:15], s41 offen offset:3072 sc1
    s_waitcnt lgkmcnt(8)
    v_smfmac_f32_16x16x64_bf16 v[52:55], v[64:67], v[104:111], v68
    s_setprio 1
    v_rcp_f32 v161, v161
    v_pk_fma_f32 v[166:167], v[166:167], v[128:129], v[130:131]
    v_pk_mul_f32 v[170:171], v[44:45], v[44:45]
    v_exp_f32 v164, v164
    v_pk_fma_f32 v[162:163], v[38:39], v[160:161], v[162:163]
    v_pk_mul_f32 v[166:167], v[166:167], v[42:43]
    v_exp_f32 v165, v165
    v_add_f32 v162, v162, v163
    s_waitcnt vmcnt(4)
    v_lshlrev_b32_sdwa v104, 3, v120 dst_sel:DWORD dst_unused:UNUSED_PAD src0_sel:DWORD src1_sel:WORD_0
    v_lshlrev_b32_sdwa v106, 3, v120 dst_sel:DWORD dst_unused:UNUSED_PAD src0_sel:DWORD src1_sel:WORD_1
    ds_read_b64 v[104:105], v104
    ds_read_b64 v[106:107], v106
    v_lshlrev_b32_sdwa v108, 3, v121 dst_sel:DWORD dst_unused:UNUSED_PAD src0_sel:DWORD src1_sel:WORD_0
    v_lshlrev_b32_sdwa v110, 3, v121 dst_sel:DWORD dst_unused:UNUSED_PAD src0_sel:DWORD src1_sel:WORD_1
    ds_read_b64 v[108:109], v108
    ds_read_b64 v[110:111], v110
    s_waitcnt lgkmcnt(8)
    v_smfmac_f32_16x16x64_bf16 v[48:51], v[64:67], v[88:95], v68
    v_exp_f32 v166, v166
    buffer_store_dword v162, v70, s[12:15], s35 offen offset:2176 sc1
    v_pk_fma_f32 v[164:165], v[164:165], v[134:135], v[134:135]
    v_exp_f32 v167, v167
    v_pk_fma_f32 v[170:171], v[170:171], v[128:129], v[130:131]
    v_pk_mul_f32 v[172:173], v[46:47], v[46:47]
    v_rcp_f32 v164, v164
    v_pk_fma_f32 v[166:167], v[166:167], v[136:137], v[136:137]
    v_lshlrev_b32_sdwa v88, 3, v122 dst_sel:DWORD dst_unused:UNUSED_PAD src0_sel:DWORD src1_sel:WORD_0
    v_lshlrev_b32_sdwa v90, 3, v122 dst_sel:DWORD dst_unused:UNUSED_PAD src0_sel:DWORD src1_sel:WORD_1
    ds_read_b64 v[88:89], v88
    ds_read_b64 v[90:91], v90
    v_lshlrev_b32_sdwa v92, 3, v123 dst_sel:DWORD dst_unused:UNUSED_PAD src0_sel:DWORD src1_sel:WORD_0
    v_lshlrev_b32_sdwa v94, 3, v123 dst_sel:DWORD dst_unused:UNUSED_PAD src0_sel:DWORD src1_sel:WORD_1
    ds_read_b64 v[92:93], v92
    ds_read_b64 v[94:95], v94
    buffer_load_dwordx4 v[120:123], v69, s[12:15], s45 offen offset:3072 sc1
    s_waitcnt lgkmcnt(8)
    v_smfmac_f32_16x16x64_bf16 v[52:55], v[64:67], v[96:103], v68
    v_rcp_f32 v165, v165
    v_pk_mul_f32 v[170:171], v[170:171], v[44:45]
    v_pk_fma_f32 v[172:173], v[172:173], v[128:129], v[130:131]
    v_rcp_f32 v166, v166
    v_pk_mul_f32 v[168:169], v[40:41], v[164:165]
    v_pk_mul_f32 v[172:173], v[172:173], v[46:47]
    v_rcp_f32 v167, v167
    v_exp_f32 v170, v170
    s_waitcnt vmcnt(4)
    v_lshlrev_b32_sdwa v96, 3, v124 dst_sel:DWORD dst_unused:UNUSED_PAD src0_sel:DWORD src1_sel:WORD_0
    v_lshlrev_b32_sdwa v98, 3, v124 dst_sel:DWORD dst_unused:UNUSED_PAD src0_sel:DWORD src1_sel:WORD_1
    ds_read_b64 v[96:97], v96
    ds_read_b64 v[98:99], v98
    v_lshlrev_b32_sdwa v100, 3, v125 dst_sel:DWORD dst_unused:UNUSED_PAD src0_sel:DWORD src1_sel:WORD_0
    v_lshlrev_b32_sdwa v102, 3, v125 dst_sel:DWORD dst_unused:UNUSED_PAD src0_sel:DWORD src1_sel:WORD_1
    ds_read_b64 v[100:101], v100
    ds_read_b64 v[102:103], v102
    s_waitcnt lgkmcnt(8)
    v_smfmac_f32_16x16x64_bf16 v[48:51], v[64:67], v[104:111], v68
    v_exp_f32 v171, v171
    v_pk_fma_f32 v[168:169], v[42:43], v[166:167], v[168:169]
    v_exp_f32 v172, v172
    v_add_f32 v168, v168, v169
    v_pk_fma_f32 v[170:171], v[170:171], v[134:135], v[134:135]
    v_exp_f32 v173, v173
    buffer_store_dword v168, v70, s[12:15], s35 offen offset:2560 sc1
    v_rcp_f32 v170, v170
    v_lshlrev_b32_sdwa v104, 3, v126 dst_sel:DWORD dst_unused:UNUSED_PAD src0_sel:DWORD src1_sel:WORD_0
    v_lshlrev_b32_sdwa v106, 3, v126 dst_sel:DWORD dst_unused:UNUSED_PAD src0_sel:DWORD src1_sel:WORD_1
    ds_read_b64 v[104:105], v104
    ds_read_b64 v[106:107], v106
    v_lshlrev_b32_sdwa v108, 3, v127 dst_sel:DWORD dst_unused:UNUSED_PAD src0_sel:DWORD src1_sel:WORD_0
    v_lshlrev_b32_sdwa v110, 3, v127 dst_sel:DWORD dst_unused:UNUSED_PAD src0_sel:DWORD src1_sel:WORD_1
    ds_read_b64 v[108:109], v108
    ds_read_b64 v[110:111], v110
    s_waitcnt lgkmcnt(8)
    v_smfmac_f32_16x16x64_bf16 v[52:55], v[64:67], v[88:95], v68
    v_rcp_f32 v171, v171
    v_pk_fma_f32 v[172:173], v[172:173], v[136:137], v[136:137]
    v_pk_mul_f32 v[140:141], v[48:49], v[48:49]
    v_rcp_f32 v172, v172
    v_pk_mul_f32 v[174:175], v[44:45], v[170:171]
    v_pk_fma_f32 v[140:141], v[140:141], v[128:129], v[130:131]
    v_rcp_f32 v173, v173
    v_pk_mul_f32 v[140:141], v[140:141], v[48:49]
    s_waitcnt vmcnt(3)
    v_lshlrev_b32_sdwa v88, 3, v116 dst_sel:DWORD dst_unused:UNUSED_PAD src0_sel:DWORD src1_sel:WORD_0
    v_lshlrev_b32_sdwa v90, 3, v116 dst_sel:DWORD dst_unused:UNUSED_PAD src0_sel:DWORD src1_sel:WORD_1
    ds_read_b64 v[88:89], v88
    ds_read_b64 v[90:91], v90
    v_lshlrev_b32_sdwa v92, 3, v117 dst_sel:DWORD dst_unused:UNUSED_PAD src0_sel:DWORD src1_sel:WORD_0
    v_lshlrev_b32_sdwa v94, 3, v117 dst_sel:DWORD dst_unused:UNUSED_PAD src0_sel:DWORD src1_sel:WORD_1
    ds_read_b64 v[92:93], v92
    ds_read_b64 v[94:95], v94
    s_waitcnt lgkmcnt(8)
    v_smfmac_f32_16x16x64_bf16 v[56:59], v[64:67], v[96:103], v68
    v_exp_f32 v140, v140
    v_pk_fma_f32 v[174:175], v[46:47], v[172:173], v[174:175]
    v_pk_mul_f32 v[142:143], v[50:51], v[50:51]
    v_exp_f32 v141, v141
    v_add_f32 v174, v174, v175
    v_pk_fma_f32 v[142:143], v[142:143], v[128:129], v[130:131]
    buffer_store_dword v174, v70, s[12:15], s35 offen offset:2688 sc1
    v_pk_fma_f32 v[140:141], v[140:141], v[134:135], v[134:135]
    v_lshlrev_b32_sdwa v96, 3, v118 dst_sel:DWORD dst_unused:UNUSED_PAD src0_sel:DWORD src1_sel:WORD_0
    v_lshlrev_b32_sdwa v98, 3, v118 dst_sel:DWORD dst_unused:UNUSED_PAD src0_sel:DWORD src1_sel:WORD_1
    ds_read_b64 v[96:97], v96
    ds_read_b64 v[98:99], v98
    v_lshlrev_b32_sdwa v100, 3, v119 dst_sel:DWORD dst_unused:UNUSED_PAD src0_sel:DWORD src1_sel:WORD_0
    v_lshlrev_b32_sdwa v102, 3, v119 dst_sel:DWORD dst_unused:UNUSED_PAD src0_sel:DWORD src1_sel:WORD_1
    ds_read_b64 v[100:101], v100
    ds_read_b64 v[102:103], v102
    s_waitcnt lgkmcnt(8)
    v_smfmac_f32_16x16x64_bf16 v[60:63], v[64:67], v[104:111], v68
    v_rcp_f32 v140, v140
    v_pk_mul_f32 v[142:143], v[142:143], v[50:51]
    v_pk_mul_f32 v[146:147], v[52:53], v[52:53]
    v_rcp_f32 v141, v141
    v_pk_fma_f32 v[146:147], v[146:147], v[128:129], v[130:131]
    v_pk_mul_f32 v[148:149], v[54:55], v[54:55]
    v_exp_f32 v142, v142
    v_pk_mul_f32 v[144:145], v[48:49], v[140:141]
    s_waitcnt vmcnt(2)
    v_lshlrev_b32_sdwa v104, 3, v120 dst_sel:DWORD dst_unused:UNUSED_PAD src0_sel:DWORD src1_sel:WORD_0
    v_lshlrev_b32_sdwa v106, 3, v120 dst_sel:DWORD dst_unused:UNUSED_PAD src0_sel:DWORD src1_sel:WORD_1
    ds_read_b64 v[104:105], v104
    ds_read_b64 v[106:107], v106
    v_lshlrev_b32_sdwa v108, 3, v121 dst_sel:DWORD dst_unused:UNUSED_PAD src0_sel:DWORD src1_sel:WORD_0
    v_lshlrev_b32_sdwa v110, 3, v121 dst_sel:DWORD dst_unused:UNUSED_PAD src0_sel:DWORD src1_sel:WORD_1
    ds_read_b64 v[108:109], v108
    ds_read_b64 v[110:111], v110
    s_waitcnt lgkmcnt(8)
    v_smfmac_f32_16x16x64_bf16 v[56:59], v[64:67], v[88:95], v68
    v_exp_f32 v143, v143
    v_pk_mul_f32 v[146:147], v[146:147], v[52:53]
    v_pk_fma_f32 v[148:149], v[148:149], v[128:129], v[130:131]
    v_exp_f32 v146, v146
    v_pk_fma_f32 v[142:143], v[142:143], v[136:137], v[136:137]
    v_pk_mul_f32 v[148:149], v[148:149], v[54:55]
    v_rcp_f32 v142, v142
    v_rcp_f32 v143, v143
    v_lshlrev_b32_sdwa v88, 3, v122 dst_sel:DWORD dst_unused:UNUSED_PAD src0_sel:DWORD src1_sel:WORD_0
    v_lshlrev_b32_sdwa v90, 3, v122 dst_sel:DWORD dst_unused:UNUSED_PAD src0_sel:DWORD src1_sel:WORD_1
    ds_read_b64 v[88:89], v88
    ds_read_b64 v[90:91], v90
    v_lshlrev_b32_sdwa v92, 3, v123 dst_sel:DWORD dst_unused:UNUSED_PAD src0_sel:DWORD src1_sel:WORD_0
    v_lshlrev_b32_sdwa v94, 3, v123 dst_sel:DWORD dst_unused:UNUSED_PAD src0_sel:DWORD src1_sel:WORD_1
    ds_read_b64 v[92:93], v92
    ds_read_b64 v[94:95], v94
    s_waitcnt lgkmcnt(8)
    v_smfmac_f32_16x16x64_bf16 v[60:63], v[64:67], v[96:103], v68
    s_setprio 0
    v_exp_f32 v147, v147
    v_pk_fma_f32 v[144:145], v[50:51], v[142:143], v[144:145]
    v_exp_f32 v148, v148
    v_add_f32 v144, v144, v145
    v_pk_fma_f32 v[146:147], v[146:147], v[134:135], v[134:135]
    v_exp_f32 v149, v149
    buffer_store_dword v144, v70, s[12:15], s35 offen offset:3072 sc1
    v_rcp_f32 v146, v146
    s_waitcnt lgkmcnt(4)
    v_smfmac_f32_16x16x64_bf16 v[56:59], v[64:67], v[104:111], v68
    v_rcp_f32 v147, v147
    v_pk_fma_f32 v[148:149], v[148:149], v[136:137], v[136:137]
    s_waitcnt lgkmcnt(0)
    v_smfmac_f32_16x16x64_bf16 v[60:63], v[64:67], v[88:95], v68
    v_rcp_f32 v148, v148
    v_pk_mul_f32 v[150:151], v[52:53], v[146:147]
    v_rcp_f32 v149, v149
    s_nop 0
    s_nop 0
    v_pk_fma_f32 v[150:151], v[54:55], v[148:149], v[150:151]
    s_nop 0
    v_add_f32 v150, v150, v151
    v_pk_mul_f32 v[152:153], v[56:57], v[56:57]
    buffer_store_dword v150, v70, s[12:15], s35 offen offset:3200 sc1
    v_pk_fma_f32 v[152:153], v[152:153], v[128:129], v[130:131]
    v_pk_mul_f32 v[154:155], v[58:59], v[58:59]
    v_pk_mul_f32 v[152:153], v[152:153], v[56:57]
    v_pk_fma_f32 v[154:155], v[154:155], v[128:129], v[130:131]
    v_exp_f32 v152, v152
    v_pk_mul_f32 v[154:155], v[154:155], v[58:59]
    v_pk_mul_f32 v[158:159], v[60:61], v[60:61]
    v_exp_f32 v153, v153
    v_pk_fma_f32 v[158:159], v[158:159], v[128:129], v[130:131]
    v_pk_mul_f32 v[160:161], v[62:63], v[62:63]
    v_exp_f32 v154, v154
    v_pk_fma_f32 v[152:153], v[152:153], v[134:135], v[134:135]
    v_pk_mul_f32 v[158:159], v[158:159], v[60:61]
    v_rcp_f32 v152, v152
    v_pk_fma_f32 v[160:161], v[160:161], v[128:129], v[130:131]
    v_rcp_f32 v153, v153
    v_pk_mul_f32 v[160:161], v[160:161], v[62:63]
    v_exp_f32 v155, v155
    v_pk_mul_f32 v[156:157], v[56:57], v[152:153]
    v_exp_f32 v158, v158
    v_pk_fma_f32 v[154:155], v[154:155], v[136:137], v[136:137]
    v_exp_f32 v159, v159
    v_rcp_f32 v154, v154
    v_rcp_f32 v155, v155
    v_pk_fma_f32 v[158:159], v[158:159], v[134:135], v[134:135]
    v_exp_f32 v160, v160
    v_pk_fma_f32 v[156:157], v[58:59], v[154:155], v[156:157]
    v_rcp_f32 v158, v158
    v_add_f32 v156, v156, v157
    v_rcp_f32 v159, v159
    buffer_store_dword v156, v70, s[12:15], s35 offen offset:3584 sc1
    v_exp_f32 v161, v161
    v_pk_mul_f32 v[162:163], v[60:61], v[158:159]
    s_nop 0
    v_pk_fma_f32 v[160:161], v[160:161], v[136:137], v[136:137]
    s_nop 0
    v_rcp_f32 v160, v160
    v_rcp_f32 v161, v161
    s_nop 0
    s_nop 0
    v_pk_fma_f32 v[162:163], v[62:63], v[160:161], v[162:163]
    s_nop 0
    v_add_f32 v162, v162, v163
    s_nop 0
    buffer_store_dword v162, v70, s[12:15], s35 offen offset:3712 sc1

    v_and_b32 v193, 0xf0, v69
    v_lshrrev_b32 v197, 8, v69
    v_lshl_or_b32 v192, v197, 16, v193
    v_lshrrev_b32 v198, 1, v197
    v_and_b32 v197, 1, v197
    v_lshl_or_b32 v193, v198, 2, v193
    v_lshl_or_b32 v193, v197, 3, v193
    v_mov_b32 v196, 0
    s_mov_b32 s65, 0

    s_lshl_b32 s68, s2, 8
    s_add_u32 s66, s68, 29360128
    s_add_u32 s67, s66, 65536
    s_add_u32 s60, s68, 20971520
    s_lshr_b32 s68, s68, 1

    s_lshl_b32 s61, s3, 20
    s_add_u32 s60, s60, s61

    s_add_u32 s61, s60, 262144
    s_add_u32 s62, s60, 524288
    s_add_u32 s63, s60, 786432

    s_mov_b32 s76, s56
    s_and_b32 s77, s57, 0xffff
    s_mov_b32 s78, 2
    s_mov_b32 s79, 0x00020000
    s_mov_b32 s72, s58
    s_and_b32 s73, s59, 0xffff
    s_mov_b32 s74, 32768
    s_mov_b32 s75, 0x00020000

    v_mov_b32 v176, -1
    buffer_load_short_d16_hi v196, v196, s[76:79], 0 offen
    s_bitcmp1_b32 s64, 30
    s_cbranch_scc0 standalone__deep_cross_pnn__recsys_kernel_rd

standalone__deep_cross_pnn__recsys_kernel_rp:
    buffer_load_dwordx4 v[176:179], v192, s[12:15], s60 offen sc1
    buffer_load_dwordx4 v[180:183], v192, s[12:15], s61 offen sc1
    buffer_load_dwordx4 v[184:187], v192, s[12:15], s62 offen sc1
    buffer_load_dwordx4 v[188:191], v192, s[12:15], s63 offen sc1
    buffer_load_dword v194, v193, s[12:15], s66 offen sc1
    buffer_load_dword v195, v193, s[12:15], s67 offen sc1
    s_waitcnt vmcnt(4)
    v_add_f32 v176, v176, v180
    v_add_f32 v177, v177, v181
    v_add_f32 v178, v178, v182
    v_add_f32 v179, v179, v183
    s_waitcnt vmcnt(2)
    v_add_f32 v184, v184, v188
    v_add_f32 v185, v185, v189
    v_add_f32 v186, v186, v190
    v_add_f32 v187, v187, v191
    v_add_f32 v176, v176, v184
    v_add_f32 v177, v177, v185
    v_add_f32 v178, v178, v186
    v_add_f32 v179, v179, v187

    s_nop 0
    v_permlane32_swap_b32 v176, v177
    v_permlane32_swap_b32 v178, v179
    v_add_f32 v176, v176, v177
    v_add_f32 v178, v178, v179
    s_nop 1
    v_permlane16_swap_b32 v176, v178
    s_nop 0
    v_add_f32 v176, v176, v178

    s_waitcnt vmcnt(0)
    v_add_f32 v194, v194, v195
    s_add_u32 s65, s65, 1
    v_add_f32 v197, v194, v176
    v_cmp_u_f32 vcc, v197, v197
    s_cbranch_vccz standalone__deep_cross_pnn__recsys_kernel_rd
    s_cmp_lt_u32 s65, 300
    s_cbranch_scc1 standalone__deep_cross_pnn__recsys_kernel_rp
    v_mov_b32 v176, -1

standalone__deep_cross_pnn__recsys_kernel_rd:

    v_lshrrev_b32 v197, 2, v69
    s_lshl_b32 s69, s3, 8
    v_add_u32 v198, s69, v197
    ds_write_b32 v198, v176
    s_waitcnt vmcnt(0) lgkmcnt(0)

    s_barrier
    s_cmp_lg_u32 s3, 0
    s_cbranch_scc1 standalone__deep_cross_pnn__recsys_kernel_end

    ds_read_b32 v208, v197 offset:0
    ds_read_b32 v209, v197 offset:256
    ds_read_b32 v210, v197 offset:512
    ds_read_b32 v211, v197 offset:768
    ds_read_b32 v212, v197 offset:1024
    ds_read_b32 v213, v197 offset:1280
    ds_read_b32 v214, v197 offset:1536
    ds_read_b32 v215, v197 offset:1792

    v_mov_b32 v199, 1
    v_mov_b32 v198, 0

    s_waitcnt lgkmcnt(6)
    v_add_f32 v200, v208, v209
    s_waitcnt lgkmcnt(5)
    v_add_f32 v200, v200, v210
    s_waitcnt lgkmcnt(4)
    v_add_f32 v200, v200, v211
    s_waitcnt lgkmcnt(3)
    v_add_f32 v200, v200, v212
    s_waitcnt lgkmcnt(2)
    v_add_f32 v200, v200, v213
    s_waitcnt lgkmcnt(1)
    v_add_f32 v200, v200, v214
    s_waitcnt lgkmcnt(0)
    v_add_f32 v200, v200, v215

    v_cmp_u_f32 vcc, v200, v200
    s_cbranch_vccnz standalone__deep_cross_pnn__recsys_kernel_rf
    s_mov_b64 exec, 1
    buffer_atomic_add v199, v198, s[52:55], 0 offen offset:96 sc0
    s_mov_b64 exec, -1

    v_cvt_pk_bf16_f32 v197, v200, v194
    v_lshlrev_b32 v198, 16, v197
    v_and_b32 v197, 0xffff0000, v197
    v_add_f32 v198, v198, v196
    v_cvt_pk_bf16_f32 v198, v198, v198
    v_lshlrev_b32 v198, 16, v198
    v_add_f32 v198, v198, v197
    v_cvt_pk_bf16_f32 v198, v198, v198
    v_lshrrev_b32 v197, 1, v193
    buffer_store_short v198, v197, s[72:75], s68 offen

    s_waitcnt vmcnt(1)
    v_readfirstlane_b32 s69, v199
    s_cmp_lt_u32 s69, 256
    s_cbranch_scc1 standalone__deep_cross_pnn__recsys_kernel_end
    s_branch standalone__deep_cross_pnn__recsys_kernel_rl

standalone__deep_cross_pnn__recsys_kernel_rf:

    s_lshr_b32 s69, s2, 5
    s_lshl_b32 s69, s69, 2
    s_lshl_b32 s70, 1, s2
    v_mov_b32 v199, s70
    s_mov_b64 exec, 1
    buffer_atomic_or v199, v198, s[52:55], s69 offen offset:64 sc0
    s_waitcnt vmcnt(0)
    v_mov_b32 v199, 0x10001
    buffer_atomic_add v199, v198, s[52:55], 0 offen offset:96 sc0
    s_mov_b64 exec, -1
    s_waitcnt vmcnt(0)
    v_readfirstlane_b32 s69, v199

standalone__deep_cross_pnn__recsys_kernel_rl:

    s_and_b32 s69, s69, 0xffff
    s_cmp_lg_u32 s69, 255
    s_cbranch_scc1 standalone__deep_cross_pnn__recsys_kernel_end
    v_lshrrev_b32 v197, 2, v69
    v_mov_b32 v199, 0
    s_mov_b64 exec, 0xff
    buffer_atomic_or v199, v197, s[52:55], 0 offen offset:64 sc0
    s_mov_b64 exec, -1
    s_waitcnt vmcnt(0)

standalone__deep_cross_pnn__recsys_kernel_rn:

    v_cmp_ne_u32 vcc, 0, v199
    s_cbranch_vccz standalone__deep_cross_pnn__recsys_kernel_end
    s_ff1_i32_b64 s69, vcc
    s_mov_b32 m0, s69
    s_nop 3
    v_readlane_b32 s70, v199, s69
    s_ff1_i32_b32 s71, s70
    s_bitset0_b32 s70, s71
    s_nop 3
    v_writelane_b32 v199, s70, m0
    s_lshl_b32 s69, s69, 5
    s_add_u32 s69, s69, s71

    s_lshl_b32 s68, s69, 8
    s_add_u32 s66, s68, 29360128
    s_add_u32 s67, s66, 65536
    s_add_u32 s60, s68, 20971520
    s_lshr_b32 s68, s68, 1

    s_add_u32 s61, s60, 262144
    s_add_u32 s62, s60, 524288
    s_add_u32 s63, s60, 786432

    buffer_load_dword v194, v193, s[12:15], s66 offen sc1
    buffer_load_dword v195, v193, s[12:15], s67 offen sc1
    s_mov_b32 s65, 0
standalone__deep_cross_pnn__recsys_kernel_rw:
    buffer_load_dwordx4 v[176:179], v192, s[12:15], s60 offen sc1
    buffer_load_dwordx4 v[180:183], v192, s[12:15], s61 offen sc1
    buffer_load_dwordx4 v[184:187], v192, s[12:15], s62 offen sc1
    buffer_load_dwordx4 v[188:191], v192, s[12:15], s63 offen sc1
    s_waitcnt vmcnt(2)
    v_add_f32 v176, v176, v180
    v_add_f32 v177, v177, v181
    v_add_f32 v178, v178, v182
    v_add_f32 v179, v179, v183
    s_waitcnt vmcnt(0)
    v_add_f32 v184, v184, v188
    v_add_f32 v185, v185, v189
    v_add_f32 v186, v186, v190
    v_add_f32 v187, v187, v191
    v_add_f32 v176, v176, v184
    v_add_f32 v177, v177, v185
    v_add_f32 v178, v178, v186
    v_add_f32 v179, v179, v187

    s_nop 0
    v_permlane32_swap_b32 v176, v177
    v_permlane32_swap_b32 v178, v179
    v_add_f32 v176, v176, v177
    v_add_f32 v178, v178, v179
    s_nop 1
    v_permlane16_swap_b32 v176, v178
    s_nop 0
    v_add_f32 v176, v176, v178

    s_cmp_eq_u32 s65, 0
    s_cselect_b64 vcc, -1, 0
    v_add_f32 v200, v200, v176
    v_cndmask_b32 v200, v200, v176, vcc
    s_add_u32 s60, s60, 1048576
    s_add_u32 s61, s61, 1048576
    s_add_u32 s62, s62, 1048576
    s_add_u32 s63, s63, 1048576
    s_add_u32 s65, s65, 1
    s_cmp_lt_u32 s65, 8
    s_cbranch_scc1 standalone__deep_cross_pnn__recsys_kernel_rw
    v_add_f32 v194, v194, v195

    v_cvt_pk_bf16_f32 v197, v200, v194
    v_lshlrev_b32 v198, 16, v197
    v_and_b32 v197, 0xffff0000, v197
    v_add_f32 v198, v198, v196
    v_cvt_pk_bf16_f32 v198, v198, v198
    v_lshlrev_b32 v198, 16, v198
    v_add_f32 v198, v198, v197
    v_cvt_pk_bf16_f32 v198, v198, v198
    v_lshrrev_b32 v197, 1, v193
    buffer_store_short v198, v197, s[72:75], s68 offen

    s_nop 1
    s_branch standalone__deep_cross_pnn__recsys_kernel_rn
standalone__deep_cross_pnn__recsys_kernel_end:
    s_endpgm
.section .rodata,"a"
.p2align 6
.amdhsa_kernel standalone__deep_cross_pnn__recsys_kernel
  .amdhsa_next_free_vgpr 256
  .amdhsa_next_free_sgpr 102
  .amdhsa_accum_offset 256
  .amdhsa_group_segment_fixed_size 0
  .amdhsa_kernarg_size 80
  .amdhsa_user_sgpr_count 2
  .amdhsa_user_sgpr_kernarg_segment_ptr 1
  .amdhsa_system_sgpr_workgroup_id_x 1
.end_amdhsa_kernel
```

```asm
; @launch grid=(256,1,1) block=(512,1,1) lds=163840
.amdgcn_target "amdgcn-amd-amdhsa--gfx950"
.text
.globl standalone__deep_cross_pnn__recsys_kernel
.p2align 8
.type standalone__deep_cross_pnn__recsys_kernel,@function
standalone__deep_cross_pnn__recsys_kernel:

    s_cmp_ge_u32 s2, 256
    s_cbranch_scc1 standalone__deep_cross_pnn__recsys_kernel_end
    s_load_dwordx8 s[4:11], s[0:1], 0
    s_load_dwordx2 s[12:13], s[0:1], 72
    s_load_dwordx2 s[52:53], s[0:1], 64
    v_lshrrev_b32 v1, 6, v0
    v_and_b32 v255, 63, v0
    s_bfe_u32 s36, s2, 0x10003
    v_readfirstlane_b32 s3, v1
    s_lshr_b32 s37, s2, 4
    s_lshl_b32 s37, s37, 3
    s_and_b32 s38, s2, 7
    s_or_b32 s37, s37, s38
    v_lshlrev_b32 v254, 4, v255
    v_mov_b32 v252, 163712
    v_mov_b32 v253, 1
    v_mov_b32 v40, 0
    v_cmp_gt_u32 vcc, 8, v0
    v_lshl_add_u32 v41, v0, 2, v252
    s_and_saveexec_b64 s[46:47], vcc
    ds_write_b32 v41, v40
    s_mov_b64 exec, s[46:47]
    v_mul_u32_u24 v6, 57, v255
    v_lshrrev_b32 v6, 9, v6
    v_mul_u32_u24 v5, 9, v6
    v_sub_u32 v5, v255, v5
    v_cmp_gt_u32 s[40:41], 8, v5
    v_lshlrev_b32 v5, 4, v5
    v_lshl_add_u32 v83, v6, 8, v5
    s_and_b32 s56, s3, 3
    s_mul_i32 s42, s56, 1792
    s_mul_i32 s43, s56, 1008
    s_lshl_b32 s38, s36, 7
    s_add_u32 s42, s42, s38
    s_bitset0_b32 s41, 31
    s_waitcnt lgkmcnt(0)

    s_mov_b32 s16, s4
    s_and_b32 s17, s5, 0xffff
    s_mov_b32 s18, 6553600
    s_mov_b32 s19, 0x00020000
    s_mov_b32 s20, s6
    s_and_b32 s21, s7, 0xffff
    s_mov_b32 s22, 256000
    s_mov_b32 s23, 0x00020000
    s_mov_b32 s24, s8
    s_and_b32 s25, s9, 0xffff
    s_mov_b32 s26, 20000
    s_mov_b32 s27, 0x00020000
    s_mov_b32 s28, s10
    s_and_b32 s29, s11, 0xffff
    s_mov_b32 s30, 13107200
    s_mov_b32 s31, 0x00020000
    s_mov_b32 s32, s12
    s_and_b32 s33, s13, 0xffff
    s_mov_b32 s34, 268435456
    s_mov_b32 s35, 0x00020000
    s_mov_b32 s12, s12
    s_and_b32 s13, s13, 0xffff
    s_mov_b32 s14, 268435456
    s_mov_b32 s15, 0x00020000
    s_mov_b32 s52, s52
    s_and_b32 s53, s53, 0xffff
    s_mov_b32 s54, 256
    s_mov_b32 s55, 0x00020000
    s_mov_b32 s50, s36

    s_cmp_ge_u32 s3, 4
    s_cbranch_scc1 standalone__deep_cross_pnn__recsys_kernel_aux

    s_setprio 3
    s_lshl_b32 s38, s3, 10
    s_add_u32 m0, s38, 144144
    v_and_b32 v5, 15, v255

    buffer_load_dwordx4 v254, s[24:27], s38 offen lds
    s_add_u32 m0, m0, 4096
    s_add_u32 s38, s38, 4096
    buffer_load_dwordx4 v254, s[24:27], s38 offen lds
    s_add_u32 m0, m0, 4096
    s_add_u32 s38, s38, 4096
    buffer_load_dwordx4 v254, s[24:27], s38 offen lds
    s_add_u32 m0, m0, 4096
    s_add_u32 s38, s38, 4096
    buffer_load_dwordx4 v254, s[24:27], s38 offen lds
    s_add_u32 m0, m0, 4096
    s_add_u32 s38, s38, 4096
    s_cmp_eq_u32 s3, 3
    s_cselect_b32 s45, 1024, 0
    s_sub_u32 m0, m0, s45
    s_sub_u32 s38, s38, s45
    buffer_load_dwordx4 v254, s[24:27], s38 offen lds

    v_lshrrev_b32 v6, 4, v255
    v_and_b32 v8, 3, v255
    v_bfe_u32 v7, v255, 2, 2
    v_mul_u32_u24 v245, 24, v5
    s_movk_i32 s45, 400
    v_lshlrev_b32 v246, 2, v7
    v_mad_u32_u24 v246, v8, s45, v246
    s_lshl_b32 s72, s37, 7
    s_lshl_b32 s73, s3, 5
    s_add_u32 s72, s72, s73
    s_mul_i32 s74, s72, 400
    s_add_u32 s58, s74, 12800
    s_mov_b32 s18, s58
    v_mul_u32_u24 v184, 12, v5
    s_movk_i32 s45, 200
    v_mad_u32_u24 v185, v6, s45, v184
    v_lshlrev_b32 v186, 1, v7
    v_mad_u32_u24 v186, v6, s45, v186
    v_mov_b32 v90, 0
    s_movk_i32 s45, 19200

    buffer_load_dwordx3 v[188:190], v185, s[24:27], s45 offen
    buffer_load_short_d16_hi v90, v186, s[24:27], s45 offen offset:192
    buffer_load_dwordx4 v[192:195], v245, s[16:19], s74 offen
    buffer_load_dwordx2 v[196:197], v245, s[16:19], s74 offen offset:16
    buffer_load_dword v198, v246, s[16:19], s74 offen offset:384
    buffer_load_dwordx4 v[218:221], v245, s[16:19], s74 offen offset:400
    buffer_load_dwordx2 v[222:223], v245, s[16:19], s74 offen offset:416
    buffer_load_dwordx4 v[224:227], v245, s[16:19], s74 offen offset:800
    buffer_load_dwordx2 v[228:229], v245, s[16:19], s74 offen offset:816
    buffer_load_dwordx4 v[230:233], v245, s[16:19], s74 offen offset:1200
    buffer_load_dwordx2 v[234:235], v245, s[16:19], s74 offen offset:1216
    buffer_load_dwordx4 v[212:215], v245, s[16:19], s74 offen offset:1600
    buffer_load_dwordx2 v[216:217], v245, s[16:19], s74 offen offset:1616
    buffer_load_dword v236, v246, s[16:19], s74 offen offset:1984

    v_add_u32 v184, 144144, v184
    s_movk_i32 s45, 4800
    v_mad_u32_u24 v184, v6, s45, v184
    v_mul_u32_u24 v186, 1200, v5
    v_add_u32 v186, 144144, v186
    v_mad_u32_u24 v185, v6, 48, v186
    v_lshl_add_u32 v186, v6, 1, v186
    v_and_b32 v244, 48, v255
    s_movk_i32 s57, 144
    v_cmp_eq_u32 s[60:61], 0, v8
    v_cmp_eq_u32 s[62:63], 1, v8
    v_cmp_eq_u32 s[66:67], 2, v8
    v_cmp_eq_u32 s[68:69], 3, v8
    s_mov_b32 s70, 0x00010001
    s_mov_b32 s71, 0x00010001

    v_mov_b32 v0, 0
    v_mov_b32 v1, 0
    v_mov_b32 v2, 0
    v_mov_b32 v3, 0
    v_mov_b32 v4, 0
    v_mov_b32 v5, 0
    v_mov_b32 v6, 0
    v_mov_b32 v7, 0
    v_mov_b32 v8, 0
    v_mov_b32 v9, 0
    v_mov_b32 v10, 0
    v_mov_b32 v11, 0
    v_mov_b32 v12, 0
    v_mov_b32 v13, 0
    v_mov_b32 v14, 0
    v_mov_b32 v15, 0
    v_mov_b32 v16, 0
    v_mov_b32 v17, 0
    v_mov_b32 v18, 0
    v_mov_b32 v19, 0
    v_mov_b32 v20, 0
    v_mov_b32 v21, 0
    v_mov_b32 v22, 0
    v_mov_b32 v23, 0
    v_mov_b32 v24, 0
    v_mov_b32 v25, 0
    v_mov_b32 v26, 0
    v_mov_b32 v27, 0
    v_mov_b32 v28, 0
    v_mov_b32 v29, 0
    v_mov_b32 v30, 0
    v_mov_b32 v31, 0
    v_mov_b32 v32, 0
    v_mov_b32 v33, 0
    v_mov_b32 v34, 0
    v_mov_b32 v35, 0
    v_mov_b32 v36, 0
    v_mov_b32 v37, 0
    v_mov_b32 v38, 0
    v_mov_b32 v39, 0
    v_mov_b32 v40, 0
    v_mov_b32 v41, 0
    v_mov_b32 v42, 0
    v_mov_b32 v43, 0
    v_mov_b32 v44, 0
    v_mov_b32 v45, 0
    v_mov_b32 v46, 0
    v_mov_b32 v47, 0
    v_mov_b32 v48, 0
    v_mov_b32 v49, 0
    v_mov_b32 v50, 0
    v_mov_b32 v51, 0
    v_mov_b32 v52, 0
    v_mov_b32 v53, 0
    v_mov_b32 v54, 0
    v_mov_b32 v55, 0
    v_mov_b32 v56, 0
    v_mov_b32 v57, 0
    v_mov_b32 v58, 0
    v_mov_b32 v59, 0
    v_mov_b32 v60, 0
    v_mov_b32 v61, 0
    v_mov_b32 v62, 0
    v_mov_b32 v63, 0
    v_mov_b32 v64, 0
    v_mov_b32 v65, 0
    v_mov_b32 v66, 0
    v_mov_b32 v67, 0
    v_mov_b32 v68, 0
    v_mov_b32 v69, 0
    v_mov_b32 v70, 0
    v_mov_b32 v71, 0
    v_mov_b32 v72, 0
    v_mov_b32 v73, 0
    v_mov_b32 v74, 0
    v_mov_b32 v75, 0
    v_mov_b32 v76, 0
    v_mov_b32 v77, 0
    v_mov_b32 v78, 0
    v_mov_b32 v79, 0
    v_mov_b32 v80, 0
    v_mov_b32 v81, 0
    v_mov_b32 v82, 0
    v_mov_b32 v83, 0
    v_mov_b32 v84, 0
    v_mov_b32 v85, 0
    v_mov_b32 v86, 0
    v_mov_b32 v87, 0
    v_mov_b32 v88, 0
    v_mov_b32 v89, 0
    s_waitcnt vmcnt(14)
    s_barrier
    ds_read_b64 v[96:97], v185 offset:200
    ds_read_b64 v[98:99], v185 offset:208
    ds_read_b64 v[100:101], v185 offset:224
    ds_read_b64 v[102:103], v185 offset:232
    ds_read_b64 v[104:105], v185 offset:400
    ds_read_b64 v[106:107], v185 offset:408
    ds_read_b64 v[108:109], v185 offset:424
    ds_read_b64 v[110:111], v185 offset:432
    ds_read_b64 v[112:113], v185 offset:600
    ds_read_b64 v[114:115], v185 offset:608
    ds_read_b64 v[116:117], v185 offset:616
    ds_read_b64 v[118:119], v185 offset:624
    ds_read_b64 v[120:121], v185 offset:632
    ds_read_b64 v[122:123], v185 offset:640
    ds_read_b64 v[124:125], v185 offset:800
    ds_read_b64 v[126:127], v185 offset:808
    ds_read_b64 v[128:129], v185 offset:816
    ds_read_b64 v[130:131], v185 offset:824
    ds_read_b64 v[132:133], v185 offset:832
    ds_read_b64 v[134:135], v185 offset:840
    ds_read_b64 v[136:137], v185 offset:1000
    ds_read_b64 v[138:139], v185 offset:1008
    ds_read_b64 v[140:141], v185 offset:1016
    ds_read_b64 v[142:143], v185 offset:1024
    ds_read_b64 v[144:145], v185 offset:1032
    ds_read_b64 v[146:147], v185 offset:1040
    ds_read_u16_d16_hi v84, v186 offset:192
    ds_read_u16_d16_hi v85, v186 offset:392
    ds_read_u16_d16_hi v86, v186 offset:592
    ds_read_u16_d16_hi v87, v186 offset:792
    ds_read_u16_d16_hi v88, v186 offset:992
    ds_read_u16_d16_hi v89, v186 offset:1192
    ds_read_u16_d16_hi v4, v184 offset:2
    ds_read_u16_d16_hi v5, v184 offset:1202
    ds_read_u16_d16_hi v6, v184 offset:2402
    ds_read_u16_d16_hi v7, v184 offset:3602
    ds_read_u16_d16_hi v8, v184 offset:4
    ds_read_u16_d16_hi v9, v184 offset:1204
    ds_read_u16_d16_hi v10, v184 offset:2404
    ds_read_u16_d16_hi v11, v184 offset:3604
    ds_read_u16_d16_hi v12, v184 offset:6
    ds_read_u16_d16_hi v13, v184 offset:1206
    ds_read_u16_d16_hi v14, v184 offset:2406
    ds_read_u16_d16_hi v15, v184 offset:3606
    ds_read_u16_d16_hi v16, v184 offset:8
    ds_read_u16_d16_hi v17, v184 offset:1208
    ds_read_u16_d16_hi v18, v184 offset:2408
    ds_read_u16_d16_hi v19, v184 offset:3608
    ds_read_u16_d16_hi v20, v184 offset:10
    ds_read_u16_d16_hi v21, v184 offset:1210
    ds_read_u16_d16_hi v22, v184 offset:2410
    ds_read_u16_d16_hi v23, v184 offset:3610
    ds_read_u16_d16_hi v28, v184 offset:204
    ds_read_u16_d16_hi v29, v184 offset:1404
    ds_read_u16_d16_hi v30, v184 offset:2604
    ds_read_u16_d16_hi v31, v184 offset:3804
    ds_read_u16_d16_hi v32, v184 offset:206
    ds_read_u16_d16_hi v33, v184 offset:1406
    ds_read_u16_d16_hi v34, v184 offset:2606
    ds_read_u16_d16_hi v35, v184 offset:3806
    ds_read_u16_d16_hi v36, v184 offset:208
    ds_read_u16_d16_hi v37, v184 offset:1408
    ds_read_u16_d16_hi v38, v184 offset:2608
    ds_read_u16_d16_hi v39, v184 offset:3808
    ds_read_u16_d16_hi v40, v184 offset:210
    ds_read_u16_d16_hi v41, v184 offset:1410
    ds_read_u16_d16_hi v42, v184 offset:2610
    ds_read_u16_d16_hi v43, v184 offset:3810
    ds_read_u16_d16_hi v48, v184 offset:406
    ds_read_u16_d16_hi v49, v184 offset:1606
    ds_read_u16_d16_hi v50, v184 offset:2806
    ds_read_u16_d16_hi v51, v184 offset:4006
    ds_read_u16_d16_hi v52, v184 offset:408
    ds_read_u16_d16_hi v53, v184 offset:1608
    ds_read_u16_d16_hi v54, v184 offset:2808
    ds_read_u16_d16_hi v55, v184 offset:4008
    ds_read_u16_d16_hi v56, v184 offset:410
    ds_read_u16_d16_hi v57, v184 offset:1610
    ds_read_u16_d16_hi v58, v184 offset:2810
    ds_read_u16_d16_hi v59, v184 offset:4010
    ds_read_u16_d16_hi v64, v184 offset:608
    ds_read_u16_d16_hi v65, v184 offset:1808
    ds_read_u16_d16_hi v66, v184 offset:3008
    ds_read_u16_d16_hi v67, v184 offset:4208
    ds_read_u16_d16_hi v68, v184 offset:610
    ds_read_u16_d16_hi v69, v184 offset:1810
    ds_read_u16_d16_hi v70, v184 offset:3010
    ds_read_u16_d16_hi v71, v184 offset:4210
    ds_read_u16_d16_hi v76, v184 offset:810
    ds_read_u16_d16_hi v77, v184 offset:2010
    ds_read_u16_d16_hi v78, v184 offset:3210
    ds_read_u16_d16_hi v79, v184 offset:4410
    ds_read_u16_d16_hi v0, v184 offset:0
    ds_read_u16_d16_hi v1, v184 offset:1200
    ds_read_u16_d16_hi v2, v184 offset:2400
    ds_read_u16_d16_hi v3, v184 offset:3600
    ds_read_u16_d16_hi v24, v184 offset:202
    ds_read_u16_d16_hi v25, v184 offset:1402
    ds_read_u16_d16_hi v26, v184 offset:2602
    ds_read_u16_d16_hi v27, v184 offset:3802
    ds_read_u16_d16_hi v44, v184 offset:404
    ds_read_u16_d16_hi v45, v184 offset:1604
    ds_read_u16_d16_hi v46, v184 offset:2804
    ds_read_u16_d16_hi v47, v184 offset:4004
    ds_read_u16_d16_hi v60, v184 offset:606
    ds_read_u16_d16_hi v61, v184 offset:1806
    ds_read_u16_d16_hi v62, v184 offset:3006
    ds_read_u16_d16_hi v63, v184 offset:4206
    ds_read_u16_d16_hi v72, v184 offset:808
    ds_read_u16_d16_hi v73, v184 offset:2008
    ds_read_u16_d16_hi v74, v184 offset:3208
    ds_read_u16_d16_hi v75, v184 offset:4408
    ds_read_u16_d16_hi v80, v184 offset:1010
    ds_read_u16_d16_hi v81, v184 offset:2210
    ds_read_u16_d16_hi v82, v184 offset:3410
    ds_read_u16_d16_hi v83, v184 offset:4610
    s_waitcnt vmcnt(9) lgkmcnt(15)
    v_lshlrev_b32 v200, 16, v96
    v_add_f32 v4, v4, v200
    v_lshlrev_b32 v201, 16, v99
    v_add_f32 v5, v5, v201
    v_lshlrev_b32 v200, 16, v100
    v_add_f32 v6, v6, v200
    v_lshlrev_b32 v201, 16, v103
    v_add_f32 v7, v7, v201
    v_lshlrev_b32 v200, 16, v104
    v_add_f32 v8, v8, v200
    v_lshlrev_b32 v201, 16, v107
    v_add_f32 v9, v9, v201
    v_lshlrev_b32 v200, 16, v108
    v_add_f32 v10, v10, v200
    v_lshlrev_b32 v201, 16, v111
    v_add_f32 v11, v11, v201
    v_lshlrev_b32 v200, 16, v112
    v_add_f32 v12, v12, v200
    v_lshlrev_b32 v201, 16, v115
    v_add_f32 v13, v13, v201
    v_lshlrev_b32 v200, 16, v118
    v_add_f32 v14, v14, v200
    v_lshlrev_b32 v201, 16, v121
    v_add_f32 v15, v15, v201
    v_lshlrev_b32 v200, 16, v124
    v_add_f32 v16, v16, v200
    v_lshlrev_b32 v201, 16, v127
    v_add_f32 v17, v17, v201
    v_lshlrev_b32 v200, 16, v130
    v_add_f32 v18, v18, v200
    v_lshlrev_b32 v201, 16, v133
    v_add_f32 v19, v19, v201
    v_lshlrev_b32 v200, 16, v136
    v_add_f32 v20, v20, v200
    v_lshlrev_b32 v201, 16, v139
    v_add_f32 v21, v21, v201
    v_lshlrev_b32 v200, 16, v142
    v_add_f32 v22, v22, v200
    v_lshlrev_b32 v201, 16, v145
    v_add_f32 v23, v23, v201
    v_and_b32 v200, 0xffff0000, v104
    v_add_f32 v28, v28, v200
    v_and_b32 v201, 0xffff0000, v107
    v_add_f32 v29, v29, v201
    v_and_b32 v200, 0xffff0000, v108
    v_add_f32 v30, v30, v200
    v_and_b32 v201, 0xffff0000, v111
    v_add_f32 v31, v31, v201
    v_and_b32 v200, 0xffff0000, v112
    v_add_f32 v32, v32, v200
    v_and_b32 v201, 0xffff0000, v115
    v_add_f32 v33, v33, v201
    v_and_b32 v200, 0xffff0000, v118
    v_add_f32 v34, v34, v200
    v_and_b32 v201, 0xffff0000, v121
    v_add_f32 v35, v35, v201
    v_and_b32 v200, 0xffff0000, v124
    v_add_f32 v36, v36, v200
    v_and_b32 v201, 0xffff0000, v127
    v_add_f32 v37, v37, v201
    v_and_b32 v200, 0xffff0000, v130
    v_add_f32 v38, v38, v200
    v_and_b32 v201, 0xffff0000, v133
    v_add_f32 v39, v39, v201
    v_and_b32 v200, 0xffff0000, v136
    v_add_f32 v40, v40, v200
    v_and_b32 v201, 0xffff0000, v139
    v_add_f32 v41, v41, v201
    v_and_b32 v200, 0xffff0000, v142
    v_add_f32 v42, v42, v200
    v_and_b32 v201, 0xffff0000, v145
    v_add_f32 v43, v43, v201
    v_lshlrev_b32 v200, 16, v113
    v_add_f32 v48, v48, v200
    v_lshlrev_b32 v201, 16, v116
    v_add_f32 v49, v49, v201
    v_lshlrev_b32 v200, 16, v119
    v_add_f32 v50, v50, v200
    v_lshlrev_b32 v201, 16, v122
    v_add_f32 v51, v51, v201
    v_lshlrev_b32 v200, 16, v125
    v_add_f32 v52, v52, v200
    v_lshlrev_b32 v201, 16, v128
    v_add_f32 v53, v53, v201
    v_lshlrev_b32 v200, 16, v131
    v_add_f32 v54, v54, v200
    v_lshlrev_b32 v201, 16, v134
    v_add_f32 v55, v55, v201
    v_lshlrev_b32 v200, 16, v137
    v_add_f32 v56, v56, v200
    v_lshlrev_b32 v201, 16, v140
    v_add_f32 v57, v57, v201
    v_lshlrev_b32 v200, 16, v143
    v_add_f32 v58, v58, v200
    v_lshlrev_b32 v201, 16, v146
    v_add_f32 v59, v59, v201
    v_and_b32 v200, 0xffff0000, v125
    v_add_f32 v64, v64, v200
    v_and_b32 v201, 0xffff0000, v128
    v_add_f32 v65, v65, v201
    v_and_b32 v200, 0xffff0000, v131
    v_add_f32 v66, v66, v200
    v_and_b32 v201, 0xffff0000, v134
    v_add_f32 v67, v67, v201
    v_and_b32 v200, 0xffff0000, v137
    v_add_f32 v68, v68, v200
    v_and_b32 v201, 0xffff0000, v140
    v_add_f32 v69, v69, v201
    v_and_b32 v200, 0xffff0000, v143
    v_add_f32 v70, v70, v200
    v_and_b32 v201, 0xffff0000, v146
    v_add_f32 v71, v71, v201
    v_lshlrev_b32 v200, 16, v138
    v_add_f32 v76, v76, v200
    v_lshlrev_b32 v201, 16, v141
    v_add_f32 v77, v77, v201
    v_lshlrev_b32 v200, 16, v144
    v_add_f32 v78, v78, v200
    v_lshlrev_b32 v201, 16, v147
    v_add_f32 v79, v79, v201
    v_lshlrev_b32 v200, 16, v188
    v_add_f32 v84, v84, v200
    v_and_b32 v201, 0xffff0000, v188
    v_add_f32 v85, v85, v201
    v_lshlrev_b32 v200, 16, v189
    v_add_f32 v86, v86, v200
    v_and_b32 v201, 0xffff0000, v189
    v_add_f32 v87, v87, v201
    v_lshlrev_b32 v200, 16, v190
    v_add_f32 v88, v88, v200
    v_and_b32 v201, 0xffff0000, v190
    v_add_f32 v89, v89, v201
    v_mad_u32_u24 v192, v192, s57, v244
    v_mad_u32_u24 v193, v193, s57, v244
    v_mad_u32_u24 v194, v194, s57, v244
    v_mad_u32_u24 v195, v195, s57, v244
    v_mad_u32_u24 v196, v196, s57, v244
    v_mad_u32_u24 v197, v197, s57, v244
    v_mad_u32_u24 v198, v198, s57, v244
    v_cndmask_b32 v93, 0, v90, s[68:69]
    v_cndmask_b32 v92, 0, v90, s[66:67]
    v_cndmask_b32 v91, 0, v90, s[62:63]
    v_cndmask_b32 v90, 0, v90, s[60:61]
    s_waitcnt lgkmcnt(0)
    s_barrier
    s_setprio 0
    ds_read_b128 v[96:99], v192 offset:0
    ds_read_b128 v[100:103], v192 offset:64
    ds_read_b128 v[104:107], v193 offset:0
    ds_read_b128 v[108:111], v193 offset:64
    ds_read_b128 v[112:115], v194 offset:0
    ds_read_b128 v[116:119], v194 offset:64
    ds_read_b128 v[128:131], v195 offset:0
    ds_read_b128 v[132:135], v195 offset:64
    ds_read_b128 v[144:147], v196 offset:0
    ds_read_b128 v[148:151], v196 offset:64
    ds_read_b128 v[160:163], v197 offset:0
    ds_read_b128 v[164:167], v197 offset:64
    ds_read_b128 v[176:179], v198 offset:0
    ds_read_b128 v[180:183], v198 offset:64
    s_waitcnt vmcnt(7) lgkmcnt(0)
standalone__deep_cross_pnn__recsys_kernel_loop:
    v_mfma_f32_16x16x32_bf16 v[184:187], v[96:99], v[96:99], 0
    v_fmac_f32 v240, v188, v64
    v_fmac_f32 v240, v189, v65
    v_mfma_f32_16x16x32_bf16 v[184:187], v[100:103], v[100:103], v[184:187]
    v_fmac_f32 v240, v190, v66
    v_fmac_f32 v240, v191, v67
    v_mfma_f32_16x16x32_bf16 v[188:191], v[96:99], v[104:107], 0
    v_fmac_f32 v240, v192, v68
    v_fmac_f32 v240, v193, v69
    v_fmac_f32 v240, v194, v70
    v_fmac_f32 v240, v195, v71
    v_mad_u32_u24 v220, v220, s57, v244
    v_mfma_f32_16x16x32_bf16 v[188:191], v[100:103], v[108:111], v[188:191]
    ds_read_b128 v[120:123], v220 offset:0
    ds_read_b128 v[124:127], v220 offset:64
    v_mfma_f32_16x16x32_bf16 v[192:195], v[96:99], v[112:115], 0
    v_fmac_f32 v240, v196, v72
    v_fmac_f32 v240, v197, v73
    v_mfma_f32_16x16x32_bf16 v[192:195], v[100:103], v[116:119], v[192:195]
    v_fmac_f32 v240, v198, v74
    v_fmac_f32 v240, v199, v75
    v_mfma_f32_16x16x32_bf16 v[196:199], v[176:179], v[96:99], 0
    v_fmac_f32 v240, v200, v76
    v_fmac_f32 v240, v201, v77
    v_mfma_f32_16x16x32_bf16 v[196:199], v[180:183], v[100:103], v[196:199]
    v_fmac_f32 v240, v202, v78
    v_fmac_f32 v240, v203, v79
    v_mad_u32_u24 v221, v221, s57, v244
    v_mfma_f32_16x16x32_bf16 v[200:203], v[96:99], v[128:131], 0
    ds_read_b128 v[136:139], v221 offset:0
    ds_read_b128 v[140:143], v221 offset:64
    v_mfma_f32_16x16x32_bf16 v[200:203], v[100:103], v[132:135], v[200:203]
    v_fmac_f32 v240, v204, v80
    v_fmac_f32 v240, v205, v81
    v_fmac_f32 v240, v206, v82
    v_fmac_f32 v240, v207, v83
    v_mfma_f32_16x16x32_bf16 v[204:207], v[96:99], v[144:147], 0
    v_mad_u32_u24 v218, v218, s57, v244
    v_mul_f32 v237, v184, v0
    v_mfma_f32_16x16x32_bf16 v[204:207], v[100:103], v[148:151], v[204:207]
    v_fmac_f32 v237, v185, v1
    v_fmac_f32 v237, v186, v2
    v_mfma_f32_16x16x32_bf16 v[208:211], v[96:99], v[160:163], 0
    v_fmac_f32 v237, v187, v3
    v_fmac_f32 v237, v188, v4
    v_mfma_f32_16x16x32_bf16 v[208:211], v[100:103], v[164:167], v[208:211]
    ds_read_b128 v[96:99], v218 offset:0
    ds_read_b128 v[100:103], v218 offset:64
    v_mfma_f32_16x16x32_bf16 v[184:187], v[104:107], v[104:107], 0
    v_fmac_f32 v237, v189, v5
    v_fmac_f32 v237, v190, v6
    v_mfma_f32_16x16x32_bf16 v[184:187], v[108:111], v[108:111], v[184:187]
    v_fmac_f32 v237, v191, v7
    v_fmac_f32 v237, v192, v8
    v_mfma_f32_16x16x32_bf16 v[188:191], v[104:107], v[112:115], 0
    v_fmac_f32 v237, v193, v9
    v_fmac_f32 v237, v194, v10
    v_mfma_f32_16x16x32_bf16 v[188:191], v[108:111], v[116:119], v[188:191]
    v_fmac_f32 v237, v195, v11
    v_mad_u32_u24 v222, v222, s57, v244
    v_mfma_f32_16x16x32_bf16 v[192:195], v[176:179], v[104:107], 0
    v_fmac_f32 v237, v196, v84
    v_fmac_f32 v237, v200, v12
    v_mfma_f32_16x16x32_bf16 v[192:195], v[180:183], v[108:111], v[192:195]
    ds_read_b128 v[152:155], v222 offset:0
    ds_read_b128 v[156:159], v222 offset:64
    v_mfma_f32_16x16x32_bf16 v[196:199], v[104:107], v[128:131], 0
    v_fmac_f32 v237, v201, v13
    v_fmac_f32 v237, v202, v14
    v_mfma_f32_16x16x32_bf16 v[196:199], v[108:111], v[132:135], v[196:199]
    v_fmac_f32 v237, v203, v15
    v_fmac_f32 v237, v204, v16
    v_mfma_f32_16x16x32_bf16 v[200:203], v[104:107], v[144:147], 0
    v_fmac_f32 v237, v205, v17
    v_fmac_f32 v237, v206, v18
    v_mfma_f32_16x16x32_bf16 v[200:203], v[108:111], v[148:151], v[200:203]
    v_fmac_f32 v237, v207, v19
    v_mad_u32_u24 v219, v219, s57, v244
    v_mfma_f32_16x16x32_bf16 v[204:207], v[104:107], v[160:163], 0
    v_fmac_f32 v237, v208, v20
    v_fmac_f32 v237, v209, v21
    v_fmac_f32 v237, v210, v22
    v_fmac_f32 v237, v211, v23
    v_mfma_f32_16x16x32_bf16 v[204:207], v[108:111], v[164:167], v[204:207]
    ds_read_b128 v[104:107], v219 offset:0
    ds_read_b128 v[108:111], v219 offset:64
    v_mfma_f32_16x16x32_bf16 v[208:211], v[112:115], v[112:115], 0
    v_fmac_f32 v237, v184, v24
    v_fmac_f32 v237, v185, v25
    v_mfma_f32_16x16x32_bf16 v[208:211], v[116:119], v[116:119], v[208:211]
    v_fmac_f32 v237, v186, v26
    v_fmac_f32 v237, v187, v27
    v_mfma_f32_16x16x32_bf16 v[184:187], v[176:179], v[112:115], 0
    v_fmac_f32 v237, v188, v28
    v_fmac_f32 v237, v189, v29
    v_mfma_f32_16x16x32_bf16 v[184:187], v[180:183], v[116:119], v[184:187]
    v_fmac_f32 v237, v190, v30
    v_fmac_f32 v237, v191, v31
    v_mfma_f32_16x16x32_bf16 v[188:191], v[112:115], v[128:131], 0
    v_permlane32_swap_b32 v239, v240
    v_mad_u32_u24 v223, v223, s57, v244
    v_fmac_f32 v237, v192, v85
    v_mfma_f32_16x16x32_bf16 v[188:191], v[116:119], v[132:135], v[188:191]
    ds_read_b128 v[168:171], v223 offset:0
    ds_read_b128 v[172:175], v223 offset:64
    v_mfma_f32_16x16x32_bf16 v[192:195], v[112:115], v[144:147], 0
    v_add_f32 v242, v239, v240
    v_fmac_f32 v237, v196, v32
    v_fmac_f32 v237, v197, v33
    v_fmac_f32 v237, v198, v34
    v_fmac_f32 v237, v199, v35
    v_mfma_f32_16x16x32_bf16 v[192:195], v[116:119], v[148:151], v[192:195]
    buffer_load_dwordx4 v[218:221], v245, s[16:19], s74 offen offset:2000
    buffer_load_dwordx2 v[222:223], v245, s[16:19], s74 offen offset:2016
    v_mfma_f32_16x16x32_bf16 v[196:199], v[176:179], v[128:131], 0
    v_permlane16_swap_b32 v241, v242
    v_mfma_f32_16x16x32_bf16 v[196:199], v[180:183], v[132:135], v[196:199]
    v_fmac_f32 v237, v200, v36
    v_fmac_f32 v237, v201, v37
    v_fmac_f32 v237, v202, v38
    v_fmac_f32 v237, v203, v39
    v_mfma_f32_16x16x32_bf16 v[200:203], v[112:115], v[160:163], 0
    v_add_f32 v241, v241, v242
    v_fmac_f32 v237, v204, v40
    v_mfma_f32_16x16x32_bf16 v[200:203], v[116:119], v[164:167], v[200:203]
    v_fmac_f32 v237, v205, v41
    v_fmac_f32 v237, v206, v42
    v_fmac_f32 v237, v207, v43
    v_mfma_f32_16x16x32_bf16 v[204:207], v[128:131], v[128:131], 0
    v_add_f32_dpp v241, v241, v241 row_ror:8 row_mask:0xf bank_mask:0xf
    v_fmac_f32 v237, v208, v44
    v_mfma_f32_16x16x32_bf16 v[204:207], v[132:135], v[132:135], v[204:207]
    v_fmac_f32 v237, v209, v45
    v_fmac_f32 v237, v210, v46
    v_fmac_f32 v237, v211, v47
    v_mfma_f32_16x16x32_bf16 v[208:211], v[176:179], v[144:147], 0
    v_add_f32_dpp v241, v241, v241 row_ror:4 row_mask:0xf bank_mask:0xf
    v_fmac_f32 v237, v184, v86
    v_mfma_f32_16x16x32_bf16 v[208:211], v[180:183], v[148:151], v[208:211]
    v_fmac_f32 v237, v188, v48
    v_fmac_f32 v237, v189, v49
    v_mfma_f32_16x16x32_bf16 v[184:187], v[128:131], v[144:147], 0
    v_add_f32_dpp v241, v241, v241 row_ror:2 row_mask:0xf bank_mask:0xf
    v_fmac_f32 v237, v190, v50
    v_mfma_f32_16x16x32_bf16 v[184:187], v[132:135], v[148:151], v[184:187]
    v_fmac_f32 v237, v191, v51
    v_fmac_f32 v237, v192, v52
    v_mfma_f32_16x16x32_bf16 v[188:191], v[128:131], v[160:163], 0
    v_add_f32_dpp v241, v241, v241 row_ror:1 row_mask:0xf bank_mask:0xf
    v_fmac_f32 v237, v193, v53
    v_mfma_f32_16x16x32_bf16 v[188:191], v[132:135], v[164:167], v[188:191]
    v_fmac_f32 v237, v194, v54
    v_fmac_f32 v237, v195, v55
    v_mfma_f32_16x16x32_bf16 v[192:195], v[176:179], v[160:163], 0
    v_cndmask_b32 v243, v243, v241, s[70:71]
    v_fmac_f32 v237, v196, v87
    v_mfma_f32_16x16x32_bf16 v[192:195], v[180:183], v[164:167], v[192:195]
    s_lshl_b64 s[70:71], s[70:71], 1
    v_fmac_f32 v237, v200, v56
    v_mfma_f32_16x16x32_bf16 v[196:199], v[144:147], v[144:147], 0
    v_fmac_f32 v237, v201, v57
    v_fmac_f32 v237, v202, v58
    v_mfma_f32_16x16x32_bf16 v[196:199], v[148:151], v[148:151], v[196:199]
    v_fmac_f32 v237, v203, v59
    v_fmac_f32 v237, v204, v60
    v_mfma_f32_16x16x32_bf16 v[200:203], v[144:147], v[160:163], 0
    v_fmac_f32 v237, v205, v61
    v_fmac_f32 v237, v206, v62
    v_mfma_f32_16x16x32_bf16 v[200:203], v[148:151], v[164:167], v[200:203]
    v_fmac_f32 v237, v207, v63
    v_fmac_f32 v237, v208, v88
    v_mfma_f32_16x16x32_bf16 v[204:207], v[160:163], v[160:163], 0
    v_fmac_f32 v237, v184, v64
    v_fmac_f32 v237, v185, v65
    v_mfma_f32_16x16x32_bf16 v[204:207], v[164:167], v[164:167], v[204:207]
    v_fmac_f32 v237, v186, v66
    s_waitcnt vmcnt(7) lgkmcnt(0)
    v_mfma_f32_16x16x32_bf16 v[208:211], v[96:99], v[96:99], 0
    v_fmac_f32 v237, v187, v67
    v_mad_u32_u24 v226, v226, s57, v244
    v_mfma_f32_16x16x32_bf16 v[208:211], v[100:103], v[100:103], v[208:211]
    v_fmac_f32 v237, v188, v68
    v_fmac_f32 v237, v189, v69
    v_mfma_f32_16x16x32_bf16 v[184:187], v[96:99], v[104:107], 0
    v_fmac_f32 v237, v190, v70
    v_fmac_f32 v237, v191, v71
    v_mfma_f32_16x16x32_bf16 v[184:187], v[100:103], v[108:111], v[184:187]
    ds_read_b128 v[112:115], v226 offset:0
    ds_read_b128 v[116:119], v226 offset:64
    v_mfma_f32_16x16x32_bf16 v[188:191], v[96:99], v[120:123], 0
    v_fmac_f32 v237, v192, v89
    v_mad_u32_u24 v227, v227, s57, v244
    v_mfma_f32_16x16x32_bf16 v[188:191], v[100:103], v[124:127], v[188:191]
    v_fmac_f32 v237, v196, v72
    v_fmac_f32 v237, v197, v73
    v_mfma_f32_16x16x32_bf16 v[192:195], v[176:179], v[96:99], 0
    v_fmac_f32 v237, v198, v74
    v_fmac_f32 v237, v199, v75
    v_mfma_f32_16x16x32_bf16 v[192:195], v[180:183], v[100:103], v[192:195]
    v_fmac_f32 v237, v200, v76
    v_fmac_f32 v237, v201, v77
    v_mfma_f32_16x16x32_bf16 v[196:199], v[96:99], v[136:139], 0
    ds_read_b128 v[128:131], v227 offset:0
    ds_read_b128 v[132:135], v227 offset:64
    v_mfma_f32_16x16x32_bf16 v[196:199], v[100:103], v[140:143], v[196:199]
    v_fmac_f32 v237, v202, v78
    v_fmac_f32 v237, v203, v79
    v_mfma_f32_16x16x32_bf16 v[200:203], v[96:99], v[152:155], 0
    v_fmac_f32 v237, v204, v80
    v_fmac_f32 v237, v205, v81
    v_mfma_f32_16x16x32_bf16 v[200:203], v[100:103], v[156:159], v[200:203]
    v_fmac_f32 v237, v206, v82
    v_fmac_f32 v237, v207, v83
    v_mfma_f32_16x16x32_bf16 v[204:207], v[96:99], v[168:171], 0
    v_mad_u32_u24 v224, v224, s57, v244
    v_mul_f32 v238, v208, v0
    v_fmac_f32 v238, v209, v1
    v_fmac_f32 v238, v210, v2
    v_fmac_f32 v238, v211, v3
    v_mfma_f32_16x16x32_bf16 v[204:207], v[100:103], v[172:175], v[204:207]
    ds_read_b128 v[96:99], v224 offset:0
    ds_read_b128 v[100:103], v224 offset:64
    v_mfma_f32_16x16x32_bf16 v[208:211], v[104:107], v[104:107], 0
    v_fmac_f32 v238, v184, v4
    v_fmac_f32 v238, v185, v5
    v_mfma_f32_16x16x32_bf16 v[208:211], v[108:111], v[108:111], v[208:211]
    v_fmac_f32 v238, v186, v6
    v_fmac_f32 v238, v187, v7
    v_mfma_f32_16x16x32_bf16 v[184:187], v[104:107], v[120:123], 0
    v_fmac_f32 v238, v188, v8
    v_fmac_f32 v238, v189, v9
    v_mfma_f32_16x16x32_bf16 v[184:187], v[108:111], v[124:127], v[184:187]
    v_fmac_f32 v238, v190, v10
    v_fmac_f32 v238, v191, v11
    v_mfma_f32_16x16x32_bf16 v[188:191], v[176:179], v[104:107], 0
    v_mad_u32_u24 v228, v228, s57, v244
    v_fmac_f32 v238, v193, v84
    v_mfma_f32_16x16x32_bf16 v[188:191], v[180:183], v[108:111], v[188:191]
    ds_read_b128 v[144:147], v228 offset:0
    ds_read_b128 v[148:151], v228 offset:64
    v_mfma_f32_16x16x32_bf16 v[192:195], v[104:107], v[136:139], 0
    v_fmac_f32 v238, v196, v12
    v_fmac_f32 v238, v197, v13
    v_mfma_f32_16x16x32_bf16 v[192:195], v[108:111], v[140:143], v[192:195]
    v_fmac_f32 v238, v198, v14
    v_fmac_f32 v238, v199, v15
    v_mfma_f32_16x16x32_bf16 v[196:199], v[104:107], v[152:155], 0
    v_fmac_f32 v238, v200, v16
    v_fmac_f32 v238, v201, v17
    v_mfma_f32_16x16x32_bf16 v[196:199], v[108:111], v[156:159], v[196:199]
    v_fmac_f32 v238, v202, v18
    v_fmac_f32 v238, v203, v19
    v_mfma_f32_16x16x32_bf16 v[200:203], v[104:107], v[168:171], 0
    v_mad_u32_u24 v225, v225, s57, v244
    v_fmac_f32 v238, v204, v20
    v_fmac_f32 v238, v205, v21
    v_fmac_f32 v238, v206, v22
    v_fmac_f32 v238, v207, v23
    v_mfma_f32_16x16x32_bf16 v[200:203], v[108:111], v[172:175], v[200:203]
    ds_read_b128 v[104:107], v225 offset:0
    ds_read_b128 v[108:111], v225 offset:64
    v_mfma_f32_16x16x32_bf16 v[204:207], v[120:123], v[120:123], 0
    v_fmac_f32 v238, v208, v24
    v_fmac_f32 v238, v209, v25
    v_mfma_f32_16x16x32_bf16 v[204:207], v[124:127], v[124:127], v[204:207]
    v_fmac_f32 v238, v210, v26
    v_fmac_f32 v238, v211, v27
    v_fmac_f32 v238, v184, v28
    v_fmac_f32 v238, v185, v29
    v_fmac_f32 v238, v186, v30
    v_fmac_f32 v238, v187, v31
    v_mfma_f32_16x16x32_bf16 v[184:187], v[176:179], v[120:123], 0
    v_fmac_f32 v238, v189, v85
    v_mad_u32_u24 v229, v229, s57, v244
    v_mfma_f32_16x16x32_bf16 v[184:187], v[180:183], v[124:127], v[184:187]
    v_fmac_f32 v238, v192, v32
    v_fmac_f32 v238, v193, v33
    v_mfma_f32_16x16x32_bf16 v[188:191], v[120:123], v[136:139], 0
    v_fmac_f32 v238, v194, v34
    v_fmac_f32 v238, v195, v35
    v_mfma_f32_16x16x32_bf16 v[188:191], v[124:127], v[140:143], v[188:191]
    ds_read_b128 v[160:163], v229 offset:0
    ds_read_b128 v[164:167], v229 offset:64
    v_mfma_f32_16x16x32_bf16 v[192:195], v[120:123], v[152:155], 0
    v_fmac_f32 v238, v196, v36
    v_fmac_f32 v238, v197, v37
    v_fmac_f32 v238, v198, v38
    v_fmac_f32 v238, v199, v39
    v_mfma_f32_16x16x32_bf16 v[192:195], v[124:127], v[156:159], v[192:195]
    buffer_load_dwordx4 v[224:227], v245, s[16:19], s74 offen offset:2400
    buffer_load_dwordx2 v[228:229], v245, s[16:19], s74 offen offset:2416
    v_mfma_f32_16x16x32_bf16 v[196:199], v[176:179], v[136:139], 0
    v_fmac_f32 v238, v200, v40
    v_fmac_f32 v238, v201, v41
    v_mfma_f32_16x16x32_bf16 v[196:199], v[180:183], v[140:143], v[196:199]
    v_fmac_f32 v238, v202, v42
    v_fmac_f32 v238, v203, v43
    v_mfma_f32_16x16x32_bf16 v[200:203], v[120:123], v[168:171], 0
    v_fmac_f32 v238, v204, v44
    v_fmac_f32 v238, v205, v45
    v_mfma_f32_16x16x32_bf16 v[200:203], v[124:127], v[172:175], v[200:203]
    v_fmac_f32 v238, v206, v46
    v_fmac_f32 v238, v207, v47
    v_mfma_f32_16x16x32_bf16 v[204:207], v[136:139], v[136:139], 0
    v_fmac_f32 v238, v185, v86
    v_fmac_f32 v238, v188, v48
    v_mfma_f32_16x16x32_bf16 v[204:207], v[140:143], v[140:143], v[204:207]
    v_fmac_f32 v238, v189, v49
    v_fmac_f32 v238, v190, v50
    v_mfma_f32_16x16x32_bf16 v[208:211], v[176:179], v[176:179], 0
    v_fmac_f32 v238, v191, v51
    v_fmac_f32 v238, v192, v52
    v_mfma_f32_16x16x32_bf16 v[208:211], v[180:183], v[180:183], v[208:211]
    v_fmac_f32 v238, v193, v53
    v_fmac_f32 v238, v194, v54
    v_mfma_f32_16x16x32_bf16 v[184:187], v[176:179], v[152:155], 0
    v_fmac_f32 v238, v195, v55
    v_fmac_f32 v238, v197, v87
    v_mfma_f32_16x16x32_bf16 v[184:187], v[180:183], v[156:159], v[184:187]
    v_fmac_f32 v238, v200, v56
    v_fmac_f32 v238, v201, v57
    v_mfma_f32_16x16x32_bf16 v[188:191], v[136:139], v[152:155], 0
    v_fmac_f32 v238, v202, v58
    v_fmac_f32 v238, v203, v59
    v_mfma_f32_16x16x32_bf16 v[188:191], v[140:143], v[156:159], v[188:191]
    v_fmac_f32 v238, v204, v60
    v_fmac_f32 v238, v205, v61
    v_mfma_f32_16x16x32_bf16 v[192:195], v[136:139], v[168:171], 0
    v_fmac_f32 v238, v206, v62
    v_fmac_f32 v238, v207, v63
    v_mfma_f32_16x16x32_bf16 v[192:195], v[140:143], v[172:175], v[192:195]
    v_fmac_f32 v237, v208, v90
    v_fmac_f32 v238, v209, v91
    v_mfma_f32_16x16x32_bf16 v[196:199], v[176:179], v[168:171], 0
    v_mul_f32 v239, v210, v92
    v_mul_f32 v240, v211, v93
    v_mfma_f32_16x16x32_bf16 v[196:199], v[180:183], v[172:175], v[196:199]
    v_fmac_f32 v238, v185, v88
    v_fmac_f32 v238, v188, v64
    v_mfma_f32_16x16x32_bf16 v[200:203], v[152:155], v[152:155], 0
    v_fmac_f32 v238, v189, v65
    v_fmac_f32 v238, v190, v66
    v_mfma_f32_16x16x32_bf16 v[200:203], v[156:159], v[156:159], v[200:203]
    v_fmac_f32 v238, v191, v67
    v_fmac_f32 v238, v192, v68
    v_mfma_f32_16x16x32_bf16 v[204:207], v[152:155], v[168:171], 0
    v_fmac_f32 v238, v193, v69
    v_fmac_f32 v238, v194, v70
    v_mfma_f32_16x16x32_bf16 v[204:207], v[156:159], v[172:175], v[204:207]
    v_fmac_f32 v238, v195, v71
    v_fmac_f32 v238, v197, v89
    v_mfma_f32_16x16x32_bf16 v[208:211], v[168:171], v[168:171], 0
    v_fmac_f32 v238, v200, v72
    v_fmac_f32 v238, v201, v73
    v_mfma_f32_16x16x32_bf16 v[208:211], v[172:175], v[172:175], v[208:211]
    v_fmac_f32 v238, v202, v74
    s_waitcnt vmcnt(7) lgkmcnt(0)
    v_mfma_f32_16x16x32_bf16 v[184:187], v[96:99], v[96:99], 0
    v_mad_u32_u24 v232, v232, s57, v244
    v_mad_u32_u24 v233, v233, s57, v244
    v_mfma_f32_16x16x32_bf16 v[184:187], v[100:103], v[100:103], v[184:187]
    v_fmac_f32 v238, v203, v75
    v_fmac_f32 v238, v204, v76
    v_mfma_f32_16x16x32_bf16 v[188:191], v[96:99], v[104:107], 0
    v_fmac_f32 v238, v205, v77
    v_fmac_f32 v238, v206, v78
    v_mfma_f32_16x16x32_bf16 v[188:191], v[100:103], v[108:111], v[188:191]
    ds_read_b128 v[120:123], v232 offset:0
    ds_read_b128 v[124:127], v232 offset:64
    v_mfma_f32_16x16x32_bf16 v[192:195], v[96:99], v[112:115], 0
    v_fmac_f32 v238, v207, v79
    v_fmac_f32 v238, v208, v80
    v_mfma_f32_16x16x32_bf16 v[192:195], v[100:103], v[116:119], v[192:195]
    v_fmac_f32 v238, v209, v81
    v_fmac_f32 v238, v210, v82
    v_mfma_f32_16x16x32_bf16 v[196:199], v[176:179], v[96:99], 0
    v_fmac_f32 v238, v211, v83
    v_mad_u32_u24 v230, v230, s57, v244
    v_mfma_f32_16x16x32_bf16 v[196:199], v[180:183], v[100:103], v[196:199]
    v_fmac_f32 v239, v184, v0
    v_fmac_f32 v239, v185, v1
    v_mfma_f32_16x16x32_bf16 v[200:203], v[96:99], v[128:131], 0
    ds_read_b128 v[136:139], v233 offset:0
    ds_read_b128 v[140:143], v233 offset:64
    v_mfma_f32_16x16x32_bf16 v[200:203], v[100:103], v[132:135], v[200:203]
    v_fmac_f32 v239, v186, v2
    v_fmac_f32 v239, v187, v3
    v_mfma_f32_16x16x32_bf16 v[204:207], v[96:99], v[144:147], 0
    v_fmac_f32 v239, v188, v4
    v_fmac_f32 v239, v189, v5
    v_mfma_f32_16x16x32_bf16 v[204:207], v[100:103], v[148:151], v[204:207]
    v_fmac_f32 v239, v190, v6
    v_fmac_f32 v239, v191, v7
    v_mfma_f32_16x16x32_bf16 v[208:211], v[96:99], v[160:163], 0
    v_fmac_f32 v239, v192, v8
    v_fmac_f32 v239, v193, v9
    v_mfma_f32_16x16x32_bf16 v[208:211], v[100:103], v[164:167], v[208:211]
    ds_read_b128 v[96:99], v230 offset:0
    ds_read_b128 v[100:103], v230 offset:64
    v_mfma_f32_16x16x32_bf16 v[184:187], v[104:107], v[104:107], 0
    v_fmac_f32 v239, v194, v10
    v_fmac_f32 v239, v195, v11
    v_mfma_f32_16x16x32_bf16 v[184:187], v[108:111], v[108:111], v[184:187]
    v_mad_u32_u24 v234, v234, s57, v244
    v_fmac_f32 v239, v198, v84
    v_mfma_f32_16x16x32_bf16 v[188:191], v[104:107], v[112:115], 0
    v_fmac_f32 v239, v200, v12
    v_fmac_f32 v239, v201, v13
    v_mfma_f32_16x16x32_bf16 v[188:191], v[108:111], v[116:119], v[188:191]
    v_fmac_f32 v239, v202, v14
    v_fmac_f32 v239, v203, v15
    v_mfma_f32_16x16x32_bf16 v[192:195], v[176:179], v[104:107], 0
    v_fmac_f32 v239, v204, v16
    v_fmac_f32 v239, v205, v17
    v_mfma_f32_16x16x32_bf16 v[192:195], v[180:183], v[108:111], v[192:195]
    ds_read_b128 v[152:155], v234 offset:0
    ds_read_b128 v[156:159], v234 offset:64
    v_mfma_f32_16x16x32_bf16 v[196:199], v[104:107], v[128:131], 0
    v_fmac_f32 v239, v206, v18
    v_fmac_f32 v239, v207, v19
    v_mfma_f32_16x16x32_bf16 v[196:199], v[108:111], v[132:135], v[196:199]
    v_mad_u32_u24 v231, v231, s57, v244
    v_fmac_f32 v239, v208, v20
    v_mfma_f32_16x16x32_bf16 v[200:203], v[104:107], v[144:147], 0
    v_fmac_f32 v239, v209, v21
    v_fmac_f32 v239, v210, v22
    v_mfma_f32_16x16x32_bf16 v[200:203], v[108:111], v[148:151], v[200:203]
    v_fmac_f32 v239, v211, v23
    v_fmac_f32 v239, v184, v24
    v_mfma_f32_16x16x32_bf16 v[204:207], v[104:107], v[160:163], 0
    v_fmac_f32 v239, v185, v25
    v_fmac_f32 v239, v186, v26
    v_mfma_f32_16x16x32_bf16 v[204:207], v[108:111], v[164:167], v[204:207]
    ds_read_b128 v[104:107], v231 offset:0
    ds_read_b128 v[108:111], v231 offset:64
    v_mfma_f32_16x16x32_bf16 v[208:211], v[112:115], v[112:115], 0
    v_fmac_f32 v239, v187, v27
    v_fmac_f32 v239, v188, v28
    v_mfma_f32_16x16x32_bf16 v[208:211], v[116:119], v[116:119], v[208:211]
    v_fmac_f32 v239, v189, v29
    v_fmac_f32 v239, v190, v30
    v_mfma_f32_16x16x32_bf16 v[184:187], v[176:179], v[112:115], 0
    v_fmac_f32 v239, v191, v31
    v_mad_u32_u24 v235, v235, s57, v244
    v_mfma_f32_16x16x32_bf16 v[184:187], v[180:183], v[116:119], v[184:187]
    v_fmac_f32 v239, v194, v85
    v_fmac_f32 v239, v196, v32
    v_mfma_f32_16x16x32_bf16 v[188:191], v[112:115], v[128:131], 0
    v_fmac_f32 v239, v197, v33
    v_fmac_f32 v239, v198, v34
    v_mfma_f32_16x16x32_bf16 v[188:191], v[116:119], v[132:135], v[188:191]
    ds_read_b128 v[168:171], v235 offset:0
    ds_read_b128 v[172:175], v235 offset:64
    v_mfma_f32_16x16x32_bf16 v[192:195], v[112:115], v[144:147], 0
    v_fmac_f32 v239, v199, v35
    v_fmac_f32 v239, v200, v36
    v_mfma_f32_16x16x32_bf16 v[192:195], v[116:119], v[148:151], v[192:195]
    buffer_load_dwordx4 v[230:233], v245, s[16:19], s74 offen offset:2800
    buffer_load_dwordx2 v[234:235], v245, s[16:19], s74 offen offset:2816
    v_mfma_f32_16x16x32_bf16 v[196:199], v[176:179], v[128:131], 0
    v_fmac_f32 v239, v201, v37
    v_fmac_f32 v239, v202, v38
    v_mfma_f32_16x16x32_bf16 v[196:199], v[180:183], v[132:135], v[196:199]
    v_fmac_f32 v239, v203, v39
    v_fmac_f32 v239, v204, v40
    v_mfma_f32_16x16x32_bf16 v[200:203], v[112:115], v[160:163], 0
    v_fmac_f32 v239, v205, v41
    v_fmac_f32 v239, v206, v42
    v_mfma_f32_16x16x32_bf16 v[200:203], v[116:119], v[164:167], v[200:203]
    v_fmac_f32 v239, v207, v43
    v_fmac_f32 v239, v208, v44
    v_mfma_f32_16x16x32_bf16 v[204:207], v[128:131], v[128:131], 0
    v_fmac_f32 v239, v209, v45
    v_fmac_f32 v239, v210, v46
    v_mfma_f32_16x16x32_bf16 v[204:207], v[132:135], v[132:135], v[204:207]
    v_fmac_f32 v239, v211, v47
    v_fmac_f32 v239, v186, v86
    v_mfma_f32_16x16x32_bf16 v[184:187], v[176:179], v[144:147], 0
    v_fmac_f32 v239, v188, v48
    v_fmac_f32 v239, v189, v49
    v_mfma_f32_16x16x32_bf16 v[184:187], v[180:183], v[148:151], v[184:187]
    v_fmac_f32 v239, v190, v50
    v_fmac_f32 v239, v191, v51
    v_mfma_f32_16x16x32_bf16 v[188:191], v[128:131], v[144:147], 0
    v_fmac_f32 v239, v192, v52
    v_fmac_f32 v239, v193, v53
    v_mfma_f32_16x16x32_bf16 v[188:191], v[132:135], v[148:151], v[188:191]
    v_fmac_f32 v239, v194, v54
    v_fmac_f32 v239, v195, v55
    v_mfma_f32_16x16x32_bf16 v[192:195], v[128:131], v[160:163], 0
    v_fmac_f32 v239, v198, v87
    v_fmac_f32 v239, v200, v56
    v_mfma_f32_16x16x32_bf16 v[192:195], v[132:135], v[164:167], v[192:195]
    v_fmac_f32 v239, v201, v57
    v_fmac_f32 v239, v202, v58
    v_mfma_f32_16x16x32_bf16 v[196:199], v[176:179], v[160:163], 0
    v_fmac_f32 v239, v203, v59
    v_fmac_f32 v239, v204, v60
    v_mfma_f32_16x16x32_bf16 v[196:199], v[180:183], v[164:167], v[196:199]
    v_fmac_f32 v239, v205, v61
    v_fmac_f32 v239, v206, v62
    v_mfma_f32_16x16x32_bf16 v[200:203], v[144:147], v[144:147], 0
    v_fmac_f32 v239, v207, v63
    v_fmac_f32 v239, v186, v88
    v_mfma_f32_16x16x32_bf16 v[200:203], v[148:151], v[148:151], v[200:203]
    v_fmac_f32 v239, v188, v64
    v_fmac_f32 v239, v189, v65
    v_mfma_f32_16x16x32_bf16 v[204:207], v[144:147], v[160:163], 0
    v_fmac_f32 v239, v190, v66
    v_fmac_f32 v239, v191, v67
    v_mfma_f32_16x16x32_bf16 v[204:207], v[148:151], v[164:167], v[204:207]
    v_fmac_f32 v239, v192, v68
    v_fmac_f32 v239, v193, v69
    v_mfma_f32_16x16x32_bf16 v[208:211], v[160:163], v[160:163], 0
    v_fmac_f32 v239, v194, v70
    v_fmac_f32 v239, v195, v71
    v_mfma_f32_16x16x32_bf16 v[208:211], v[164:167], v[164:167], v[208:211]
    v_fmac_f32 v239, v198, v89
    s_waitcnt vmcnt(6) lgkmcnt(0)
    v_mfma_f32_16x16x32_bf16 v[184:187], v[96:99], v[96:99], 0
    v_mad_u32_u24 v214, v214, s57, v244
    v_mad_u32_u24 v215, v215, s57, v244
    v_mfma_f32_16x16x32_bf16 v[184:187], v[100:103], v[100:103], v[184:187]
    v_fmac_f32 v239, v200, v72
    v_fmac_f32 v239, v201, v73
    v_mfma_f32_16x16x32_bf16 v[188:191], v[96:99], v[104:107], 0
    v_fmac_f32 v239, v202, v74
    v_fmac_f32 v239, v203, v75
    v_mfma_f32_16x16x32_bf16 v[188:191], v[100:103], v[108:111], v[188:191]
    ds_read_b128 v[112:115], v214 offset:0
    ds_read_b128 v[116:119], v214 offset:64
    v_mfma_f32_16x16x32_bf16 v[192:195], v[176:179], v[120:123], 0
    v_fmac_f32 v239, v204, v76
    v_fmac_f32 v239, v205, v77
    v_mfma_f32_16x16x32_bf16 v[192:195], v[180:183], v[124:127], v[192:195]
    v_fmac_f32 v239, v206, v78
    v_fmac_f32 v239, v207, v79
    v_mfma_f32_16x16x32_bf16 v[196:199], v[96:99], v[120:123], 0
    v_fmac_f32 v239, v208, v80
    v_fmac_f32 v239, v209, v81
    v_mfma_f32_16x16x32_bf16 v[196:199], v[100:103], v[124:127], v[196:199]
    v_fmac_f32 v239, v210, v82
    v_fmac_f32 v239, v211, v83
    v_mfma_f32_16x16x32_bf16 v[200:203], v[176:179], v[96:99], 0
    ds_read_b128 v[128:131], v215 offset:0
    ds_read_b128 v[132:135], v215 offset:64
    v_mfma_f32_16x16x32_bf16 v[200:203], v[180:183], v[100:103], v[200:203]
    v_fmac_f32 v240, v184, v0
    v_fmac_f32 v240, v185, v1
    v_mfma_f32_16x16x32_bf16 v[204:207], v[96:99], v[136:139], 0
    v_fmac_f32 v240, v186, v2
    v_fmac_f32 v240, v187, v3
    v_mfma_f32_16x16x32_bf16 v[204:207], v[100:103], v[140:143], v[204:207]
    v_fmac_f32 v240, v188, v4
    v_fmac_f32 v240, v189, v5
    v_mfma_f32_16x16x32_bf16 v[208:211], v[176:179], v[136:139], 0
    v_fmac_f32 v240, v190, v6
    v_fmac_f32 v240, v191, v7
    v_mfma_f32_16x16x32_bf16 v[208:211], v[180:183], v[140:143], v[208:211]
    v_mad_u32_u24 v212, v212, s57, v244
    v_fmac_f32 v240, v195, v86
    v_mfma_f32_16x16x32_bf16 v[184:187], v[96:99], v[152:155], 0
    v_mad_u32_u24 v216, v216, s57, v244
    v_fmac_f32 v240, v196, v8
    v_mfma_f32_16x16x32_bf16 v[184:187], v[100:103], v[156:159], v[184:187]
    v_fmac_f32 v240, v197, v9
    v_fmac_f32 v240, v198, v10
    v_mfma_f32_16x16x32_bf16 v[188:191], v[96:99], v[168:171], 0
    v_fmac_f32 v240, v199, v11
    v_fmac_f32 v240, v203, v84
    v_mfma_f32_16x16x32_bf16 v[188:191], v[100:103], v[172:175], v[188:191]
    ds_read_b128 v[96:99], v212 offset:0
    ds_read_b128 v[100:103], v212 offset:64
    v_mfma_f32_16x16x32_bf16 v[192:195], v[104:107], v[104:107], 0
    v_fmac_f32 v240, v204, v12
    v_fmac_f32 v240, v205, v13
    v_mfma_f32_16x16x32_bf16 v[192:195], v[108:111], v[108:111], v[192:195]
    ds_read_b128 v[144:147], v216 offset:0
    ds_read_b128 v[148:151], v216 offset:64
    v_mfma_f32_16x16x32_bf16 v[196:199], v[104:107], v[120:123], 0
    v_fmac_f32 v240, v206, v14
    v_fmac_f32 v240, v207, v15
    v_mfma_f32_16x16x32_bf16 v[196:199], v[108:111], v[124:127], v[196:199]
    v_fmac_f32 v240, v211, v87
    v_fmac_f32 v240, v184, v16
    v_mfma_f32_16x16x32_bf16 v[200:203], v[176:179], v[152:155], 0
    v_fmac_f32 v240, v185, v17
    v_fmac_f32 v240, v186, v18
    v_mfma_f32_16x16x32_bf16 v[200:203], v[180:183], v[156:159], v[200:203]
    v_fmac_f32 v240, v187, v19
    v_fmac_f32 v240, v188, v20
    v_mfma_f32_16x16x32_bf16 v[204:207], v[176:179], v[104:107], 0
    v_fmac_f32 v240, v189, v21
    v_fmac_f32 v240, v190, v22
    v_mfma_f32_16x16x32_bf16 v[204:207], v[180:183], v[108:111], v[204:207]
    v_fmac_f32 v240, v191, v23
    v_mad_u32_u24 v217, v217, s57, v244
    v_mfma_f32_16x16x32_bf16 v[208:211], v[104:107], v[136:139], 0
    v_mad_u32_u24 v236, v236, s57, v244
    v_mad_u32_u24 v213, v213, s57, v244
    v_mfma_f32_16x16x32_bf16 v[208:211], v[108:111], v[140:143], v[208:211]
    v_fmac_f32 v240, v192, v24
    v_fmac_f32 v240, v193, v25
    v_mfma_f32_16x16x32_bf16 v[184:187], v[104:107], v[152:155], 0
    v_fmac_f32 v240, v194, v26
    v_fmac_f32 v240, v195, v27
    v_mfma_f32_16x16x32_bf16 v[184:187], v[108:111], v[156:159], v[184:187]
    v_fmac_f32 v240, v196, v28
    v_fmac_f32 v240, v197, v29
    v_mfma_f32_16x16x32_bf16 v[188:191], v[176:179], v[168:171], 0
    v_fmac_f32 v240, v198, v30
    v_fmac_f32 v240, v199, v31
    v_mfma_f32_16x16x32_bf16 v[188:191], v[180:183], v[172:175], v[188:191]
    ds_read_b128 v[160:163], v217 offset:0
    ds_read_b128 v[164:167], v217 offset:64
    v_mfma_f32_16x16x32_bf16 v[192:195], v[104:107], v[168:171], 0
    ds_read_b128 v[176:179], v236 offset:0
    ds_read_b128 v[180:183], v236 offset:64
    v_mfma_f32_16x16x32_bf16 v[192:195], v[108:111], v[172:175], v[192:195]
    ds_read_b128 v[104:107], v213 offset:0
    ds_read_b128 v[108:111], v213 offset:64
    v_mfma_f32_16x16x32_bf16 v[196:199], v[120:123], v[120:123], 0
    v_fmac_f32 v240, v203, v88
    v_fmac_f32 v240, v207, v85
    v_mfma_f32_16x16x32_bf16 v[196:199], v[124:127], v[124:127], v[196:199]
    buffer_load_dwordx4 v[212:215], v245, s[16:19], s74 offen offset:3200
    buffer_load_dwordx2 v[216:217], v245, s[16:19], s74 offen offset:3216
    buffer_load_dword v236, v246, s[16:19], s74 offen offset:3584
    v_mfma_f32_16x16x32_bf16 v[200:203], v[120:123], v[136:139], 0
    v_fmac_f32 v240, v208, v32
    v_fmac_f32 v240, v209, v33
    v_mfma_f32_16x16x32_bf16 v[200:203], v[124:127], v[140:143], v[200:203]
    v_fmac_f32 v240, v210, v34
    v_fmac_f32 v240, v211, v35
    v_mfma_f32_16x16x32_bf16 v[204:207], v[120:123], v[152:155], 0
    v_fmac_f32 v240, v184, v36
    v_fmac_f32 v240, v185, v37
    v_mfma_f32_16x16x32_bf16 v[204:207], v[124:127], v[156:159], v[204:207]
    v_fmac_f32 v240, v186, v38
    v_fmac_f32 v240, v187, v39
    v_mfma_f32_16x16x32_bf16 v[208:211], v[120:123], v[168:171], 0
    v_fmac_f32 v240, v191, v89
    v_fmac_f32 v240, v192, v40
    v_mfma_f32_16x16x32_bf16 v[208:211], v[124:127], v[172:175], v[208:211]
    v_fmac_f32 v240, v193, v41
    v_fmac_f32 v240, v194, v42
    v_mfma_f32_16x16x32_bf16 v[184:187], v[136:139], v[136:139], 0
    v_fmac_f32 v240, v195, v43
    v_permlane32_swap_b32 v237, v238
    v_mfma_f32_16x16x32_bf16 v[184:187], v[140:143], v[140:143], v[184:187]
    s_add_u32 s74, s74, 1600
    v_fmac_f32 v240, v196, v44
    v_mfma_f32_16x16x32_bf16 v[188:191], v[136:139], v[152:155], 0
    v_fmac_f32 v240, v197, v45
    v_fmac_f32 v240, v198, v46
    v_mfma_f32_16x16x32_bf16 v[188:191], v[140:143], v[156:159], v[188:191]
    v_fmac_f32 v240, v199, v47
    v_add_f32 v241, v237, v238
    v_mfma_f32_16x16x32_bf16 v[192:195], v[136:139], v[168:171], 0
    s_cmp_lt_u32 s74, s58
    v_fmac_f32 v240, v200, v48
    v_mfma_f32_16x16x32_bf16 v[192:195], v[140:143], v[172:175], v[192:195]
    v_fmac_f32 v240, v201, v49
    v_fmac_f32 v240, v202, v50
    v_mfma_f32_16x16x32_bf16 v[196:199], v[152:155], v[152:155], 0
    v_fmac_f32 v240, v203, v51
    v_fmac_f32 v240, v204, v52
    v_mfma_f32_16x16x32_bf16 v[196:199], v[156:159], v[156:159], v[196:199]
    v_fmac_f32 v240, v205, v53
    v_fmac_f32 v240, v206, v54
    v_mfma_f32_16x16x32_bf16 v[200:203], v[152:155], v[168:171], 0
    v_fmac_f32 v240, v207, v55
    v_fmac_f32 v240, v208, v56
    v_mfma_f32_16x16x32_bf16 v[200:203], v[156:159], v[172:175], v[200:203]
    v_fmac_f32 v240, v209, v57
    v_fmac_f32 v240, v210, v58
    v_mfma_f32_16x16x32_bf16 v[204:207], v[168:171], v[168:171], 0
    v_fmac_f32 v240, v211, v59
    v_fmac_f32 v240, v184, v60
    v_mfma_f32_16x16x32_bf16 v[204:207], v[172:175], v[172:175], v[204:207]
    v_fmac_f32 v240, v185, v61
    v_fmac_f32 v240, v186, v62
    v_fmac_f32 v240, v187, v63
    s_waitcnt vmcnt(7) lgkmcnt(0)
    s_cbranch_scc1 standalone__deep_cross_pnn__recsys_kernel_loop
    s_nop 7
    v_fmac_f32 v240, v188, v64
    v_fmac_f32 v240, v189, v65
    v_fmac_f32 v240, v190, v66
    v_fmac_f32 v240, v191, v67
    v_fmac_f32 v240, v192, v68
    v_fmac_f32 v240, v193, v69
    v_fmac_f32 v240, v194, v70
    v_fmac_f32 v240, v195, v71
    v_fmac_f32 v240, v196, v72
    v_fmac_f32 v240, v197, v73
    v_fmac_f32 v240, v198, v74
    v_fmac_f32 v240, v199, v75
    v_fmac_f32 v240, v200, v76
    v_fmac_f32 v240, v201, v77
    v_fmac_f32 v240, v202, v78
    v_fmac_f32 v240, v203, v79
    v_fmac_f32 v240, v204, v80
    v_fmac_f32 v240, v205, v81
    v_fmac_f32 v240, v206, v82
    v_fmac_f32 v240, v207, v83
    s_nop 1
    v_permlane32_swap_b32 v239, v240
    s_nop 1
    v_add_f32 v242, v239, v240
    s_nop 1
    v_permlane16_swap_b32 v241, v242
    s_nop 1
    v_add_f32 v241, v241, v242
    s_nop 1
    v_add_f32_dpp v241, v241, v241 row_ror:8 row_mask:0xf bank_mask:0xf
    s_nop 1
    v_add_f32_dpp v241, v241, v241 row_ror:4 row_mask:0xf bank_mask:0xf
    s_nop 1
    v_add_f32_dpp v241, v241, v241 row_ror:2 row_mask:0xf bank_mask:0xf
    s_nop 1
    v_add_f32_dpp v241, v241, v241 row_ror:1 row_mask:0xf bank_mask:0xf
    s_nop 1
    v_cndmask_b32 v243, v243, v241, s[70:71]

    v_and_b32 v40, 15, v255
    v_add_u32 v40, -1, v40
    v_cmp_gt_u32 vcc, 8, v40
    s_lshl_b32 s74, s72, 2
    s_lshl_b32 s76, s36, 16
    s_add_u32 s74, s74, s76
    s_add_u32 s74, s74, 29360128
    v_lshlrev_b32 v40, 4, v40
    v_lshrrev_b32 v41, 5, v255
    v_lshl_add_u32 v40, v41, 2, v40
    v_bfe_u32 v41, v255, 4, 1
    v_lshl_add_u32 v112, v41, 3, v40
    s_mov_b64 s[46:47], vcc
    v_mov_b32 v113, v243
    s_mov_b32 s64, 0x40000000
    s_waitcnt vmcnt(0)

    s_branch standalone__deep_cross_pnn__recsys_kernel_k2
standalone__deep_cross_pnn__recsys_kernel_aux:

    s_setprio 0
    v_mov_b32 v8, v255
    v_mov_b32 v9, v254
    v_mov_b32 v10, v253
    v_mov_b32 v11, v252
    s_mov_b32 s51, s2
    s_mov_b32 s64, 0
    s_mov_b32 s65, 0

    v_mov_b32 v35, v83
    s_lshr_b32 s72, s2, 3
    s_mul_i32 s72, s72, 36
    s_lshr_b32 s72, s72, 5
    s_lshl_b32 s75, s36, 7
    s_add_u32 s75, s75, 254464
    s_mov_b32 s76, 143136
    s_lshl_b32 s6, s2, 15
    s_lshl_b32 s7, s56, 13
    s_add_u32 s6, s6, s7
    s_add_u32 s6, s6, 20971520
    s_add_u32 s7, s6, 4096
    s_lshl_b32 s8, s36, 7
    s_add_u32 s8, s8, s37
    s_lshl_b32 s8, s8, 9
    s_add_u32 s8, s8, 29360128
    s_and_b32 s9, s2, 63
    s_lshl_b32 s9, s9, 5
    s_lshr_b32 s10, s2, 6
    s_add_u32 s9, s9, s10
    s_lshl_b32 s9, s9, 2
    s_add_u32 s9, s9, 14680064
    v_mov_b32 v112, 0

standalone__deep_cross_pnn__recsys_kernel_unit:

    s_bfe_u32 s36, s51, 0x10003

    s_lshr_b32 s38, s51, 4
    s_and_b32 s39, s51, 7
    s_sub_u32 s57, 2, s36
    s_lshl_b32 s57, s39, s57
    s_lshl_b32 s37, s36, 5
    s_add_u32 s57, s57, s37
    s_add_u32 s57, s57, s56
    s_mul_i32 s37, s38, 48
    s_add_u32 s37, s37, s57
    s_lshl_b32 s38, s38, 1
    s_lshr_b32 s39, s39, 2
    s_add_u32 s38, s38, s39
    s_add_u32 s38, s38, 768
    s_and_b32 s57, s57, 7
    s_cmp_eq_u32 s57, 2
    s_cselect_b32 s38, s38, 1000
    s_lshl_b32 s39, s36, 1
    s_and_b32 s39, s39, s56
    s_cselect_b32 s57, s38, s37

    s_lshr_b32 s37, s51, 4
    s_lshl_b32 s37, s37, 3
    s_and_b32 s38, s51, 7
    s_or_b32 s37, s37, s38
    s_and_b32 s58, s56, 1
    s_lshl_b32 s59, s37, 1
    s_add_u32 s58, s58, s59
    s_lshr_b32 s59, s56, 1
    s_xor_b32 s60, s36, 1
    s_mul_i32 s46, s60, 13
    s_lshl_b32 s60, s60, 1
    s_add_u32 s59, s59, s60
    s_add_u32 s61, s46, 6
    s_add_u32 s60, s46, 12
    s_bitcmp1_b32 s59, 0
    s_cselect_b32 s46, s60, s46
    s_cselect_b32 s63, -1, 1
    s_cselect_b32 s61, 24, s61
    v_lshrrev_b32 v1, 3, v8
    v_and_b32 v2, 7, v8
    v_mul_i32_i24 v7, s63, v2
    v_add_u32 v7, s46, v7
    v_cmp_ge_u32 s[48:49], s61, v7
    s_mul_i32 s60, s58, 25600
    s_movk_i32 s61, 400
    s_lshl_b32 s63, s63, 16
    v_mul_u32_u24 v0, s61, v1
    v_lshl_add_u32 v0, v7, 4, v0
    v_and_b32 v5, 15, v8
    v_and_b32 v6, 48, v8
    v_lshl_add_u32 v56, v5, 8, v6
    s_lshr_b32 s44, s37, 1
    s_lshl_b32 s44, s44, 12
    s_lshl_b32 s38, s36, 1
    s_and_b32 s39, s37, 1
    s_add_u32 s38, s38, s39
    s_lshl_b32 s38, s38, 6
    s_add_u32 s44, s44, s38
    s_lshl_b32 s47, s36, 7
    s_add_u32 s47, s47, s37
    s_lshl_b32 s47, s47, 10
    s_add_u32 s47, s47, 15204352

    s_cmp_eq_u32 s56, 0
    s_cselect_b64 s[4:5], -1, 0
    s_cmp_lg_u32 s64, 0
    s_cbranch_scc1 standalone__deep_cross_pnn__recsys_kernel_nd1
    s_mov_b64 exec, s[40:41]

    s_mul_i32 s73, s72, 4032
    s_mul_i32 s74, s72, 7168
    s_add_u32 s73, s73, s43
    s_add_u32 s74, s74, s42
    s_min_u32 m0, s73, s76
    s_min_u32 s74, s74, s75
    s_add_u32 s72, s72, 1

    buffer_load_dwordx4 v35, s[20:23], s74 offen lds
    s_cmp_eq_u32 s72, 36
    s_cselect_b32 s72, 0, s72

    s_mul_i32 s73, s72, 4032
    s_mul_i32 s74, s72, 7168
    s_add_u32 s73, s73, s43
    s_add_u32 s74, s74, s42
    s_min_u32 m0, s73, s76
    s_min_u32 s74, s74, s75
    s_add_u32 s72, s72, 1

    buffer_load_dwordx4 v35, s[20:23], s74 offen lds
    s_cmp_eq_u32 s72, 36
    s_cselect_b32 s72, 0, s72

    s_mul_i32 s73, s72, 4032
    s_mul_i32 s74, s72, 7168
    s_add_u32 s73, s73, s43
    s_add_u32 s74, s74, s42
    s_min_u32 m0, s73, s76
    s_min_u32 s74, s74, s75
    s_add_u32 s72, s72, 1

    buffer_load_dwordx4 v35, s[20:23], s74 offen lds
    s_cmp_eq_u32 s72, 36
    s_cselect_b32 s72, 0, s72

    s_mul_i32 s73, s72, 4032
    s_mul_i32 s74, s72, 7168
    s_add_u32 s73, s73, s43
    s_add_u32 s74, s74, s42
    s_min_u32 m0, s73, s76
    s_min_u32 s74, s74, s75
    s_add_u32 s72, s72, 1

    buffer_load_dwordx4 v35, s[20:23], s74 offen lds
    s_cmp_eq_u32 s72, 36
    s_cselect_b32 s72, 0, s72

    s_mul_i32 s73, s72, 4032
    s_mul_i32 s74, s72, 7168
    s_add_u32 s73, s73, s43
    s_add_u32 s74, s74, s42
    s_min_u32 m0, s73, s76
    s_min_u32 s74, s74, s75
    s_add_u32 s72, s72, 1

    buffer_load_dwordx4 v35, s[20:23], s74 offen lds
    s_cmp_eq_u32 s72, 36
    s_cselect_b32 s72, 0, s72

    s_mul_i32 s73, s72, 4032
    s_mul_i32 s74, s72, 7168
    s_add_u32 s73, s73, s43
    s_add_u32 s74, s74, s42
    s_min_u32 m0, s73, s76
    s_min_u32 s74, s74, s75
    s_add_u32 s72, s72, 1

    buffer_load_dwordx4 v35, s[20:23], s74 offen lds
    s_cmp_eq_u32 s72, 36
    s_cselect_b32 s72, 0, s72

    s_mul_i32 s73, s72, 4032
    s_mul_i32 s74, s72, 7168
    s_add_u32 s73, s73, s43
    s_add_u32 s74, s74, s42
    s_min_u32 m0, s73, s76
    s_min_u32 s74, s74, s75
    s_add_u32 s72, s72, 1

    buffer_load_dwordx4 v35, s[20:23], s74 offen lds
    s_cmp_eq_u32 s72, 36
    s_cselect_b32 s72, 0, s72

    s_mul_i32 s73, s72, 4032
    s_mul_i32 s74, s72, 7168
    s_add_u32 s73, s73, s43
    s_add_u32 s74, s74, s42
    s_min_u32 m0, s73, s76
    s_min_u32 s74, s74, s75
    s_add_u32 s72, s72, 1

    buffer_load_dwordx4 v35, s[20:23], s74 offen lds
    s_cmp_eq_u32 s72, 36
    s_cselect_b32 s72, 0, s72

    s_mul_i32 s73, s72, 4032
    s_mul_i32 s74, s72, 7168
    s_add_u32 s73, s73, s43
    s_add_u32 s74, s74, s42
    s_min_u32 m0, s73, s76
    s_min_u32 s74, s74, s75
    s_add_u32 s72, s72, 1
    s_barrier

    buffer_load_dwordx4 v35, s[20:23], s74 offen lds
    s_cmp_eq_u32 s72, 36
    s_cselect_b32 s72, 0, s72

    s_mul_i32 s73, s72, 4032
    s_mul_i32 s74, s72, 7168
    s_add_u32 s73, s73, s43
    s_add_u32 s74, s74, s42
    s_min_u32 m0, s73, s76
    s_min_u32 s74, s74, s75
    s_add_u32 s72, s72, 1

    buffer_load_dwordx4 v35, s[20:23], s74 offen lds
    s_cmp_eq_u32 s72, 36
    s_cselect_b32 s72, 0, s72

    s_mul_i32 s73, s72, 4032
    s_mul_i32 s74, s72, 7168
    s_add_u32 s73, s73, s43
    s_add_u32 s74, s74, s42
    s_min_u32 m0, s73, s76
    s_min_u32 s74, s74, s75
    s_add_u32 s72, s72, 1

    buffer_load_dwordx4 v35, s[20:23], s74 offen lds
    s_cmp_eq_u32 s72, 36
    s_cselect_b32 s72, 0, s72

    s_mul_i32 s73, s72, 4032
    s_mul_i32 s74, s72, 7168
    s_add_u32 s73, s73, s43
    s_add_u32 s74, s74, s42
    s_min_u32 m0, s73, s76
    s_min_u32 s74, s74, s75
    s_add_u32 s72, s72, 1

    buffer_load_dwordx4 v35, s[20:23], s74 offen lds
    s_cmp_eq_u32 s72, 36
    s_cselect_b32 s72, 0, s72

    s_mov_b64 exec, -1
standalone__deep_cross_pnn__recsys_kernel_nd1:

    s_lshr_b32 s78, s57, 5
    s_bfe_u32 s79, s57, 0x20003
    s_bfe_u32 s80, s57, 0x20001
    s_and_b32 s81, s57, 1
    s_lshl_b32 s77, s78, 2
    s_lshl_b32 s83, s81, 1
    s_add_u32 s77, s77, s83
    s_lshl_b32 s77, s77, 7
    s_lshl_b32 s83, s79, 5
    s_add_u32 s77, s77, s83
    s_lshl_b32 s83, s80, 3
    s_add_u32 s77, s77, s83
    s_lshl_b32 s77, s77, 10
    s_lshl_b32 s82, s78, 12
    s_lshl_b32 s83, s79, 10
    s_add_u32 s82, s82, s83
    s_lshl_b32 s83, s80, 8
    s_add_u32 s82, s82, s83
    s_lshl_b32 s83, s81, 7
    s_add_u32 s82, s82, s83
    s_mov_b32 s84, 205312
    v_lshrrev_b32 v3, 2, v8
    v_and_b32 v4, 3, v8
    v_mul_lo_u32 v14, v3, s84
    v_lshl_add_u32 v14, v4, 4, v14
    s_cmp_ge_u32 s57, 800
    s_cselect_b32 s83, 0x40000000, 0
    v_or_b32 v14, s83, v14
    s_mul_i32 s61, s56, 4608
    s_add_u32 s61, s61, 144256
    v_and_b32 v3, 3, v3
    v_lshlrev_b32 v36, 6, v8
    v_lshl_add_u32 v36, v3, 4, v36
    v_add_u32 v36, s61, v36
    v_xor_b32 v37, 16, v36
    v_xor_b32 v38, 32, v36
    v_xor_b32 v39, 48, v36
    v_and_b32 v3, 48, v8
    v_xor_b32 v15, v3, v9
    v_add_u32 v15, s61, v15
    s_mov_b32 s84, 0x05040100
    s_mov_b32 s85, 0x07060302

    s_cmp_lg_u32 s64, 0
    s_cbranch_scc1 standalone__deep_cross_pnn__recsys_kernel_nd2
    s_mov_b64 exec, s[40:41]

    s_mul_i32 s73, s72, 4032
    s_mul_i32 s74, s72, 7168
    s_add_u32 s73, s73, s43
    s_add_u32 s74, s74, s42
    s_min_u32 m0, s73, s76
    s_min_u32 s74, s74, s75
    s_add_u32 s72, s72, 1

    buffer_load_dwordx4 v35, s[20:23], s74 offen lds
    s_cmp_eq_u32 s72, 36
    s_cselect_b32 s72, 0, s72

    s_mul_i32 s73, s72, 4032
    s_mul_i32 s74, s72, 7168
    s_add_u32 s73, s73, s43
    s_add_u32 s74, s74, s42
    s_min_u32 m0, s73, s76
    s_min_u32 s74, s74, s75
    s_add_u32 s72, s72, 1

    buffer_load_dwordx4 v35, s[20:23], s74 offen lds
    s_cmp_eq_u32 s72, 36
    s_cselect_b32 s72, 0, s72

    s_mul_i32 s73, s72, 4032
    s_mul_i32 s74, s72, 7168
    s_add_u32 s73, s73, s43
    s_add_u32 s74, s74, s42
    s_min_u32 m0, s73, s76
    s_min_u32 s74, s74, s75
    s_add_u32 s72, s72, 1

    buffer_load_dwordx4 v35, s[20:23], s74 offen lds
    s_cmp_eq_u32 s72, 36
    s_cselect_b32 s72, 0, s72

    s_mul_i32 s73, s72, 4032
    s_mul_i32 s74, s72, 7168
    s_add_u32 s73, s73, s43
    s_add_u32 s74, s74, s42
    s_min_u32 m0, s73, s76
    s_min_u32 s74, s74, s75
    s_add_u32 s72, s72, 1

    buffer_load_dwordx4 v35, s[20:23], s74 offen lds
    s_cmp_eq_u32 s72, 36
    s_cselect_b32 s72, 0, s72

    s_mul_i32 s73, s72, 4032
    s_mul_i32 s74, s72, 7168
    s_add_u32 s73, s73, s43
    s_add_u32 s74, s74, s42
    s_min_u32 m0, s73, s76
    s_min_u32 s74, s74, s75
    s_add_u32 s72, s72, 1

    buffer_load_dwordx4 v35, s[20:23], s74 offen lds
    s_cmp_eq_u32 s72, 36
    s_cselect_b32 s72, 0, s72

    s_mul_i32 s73, s72, 4032
    s_mul_i32 s74, s72, 7168
    s_add_u32 s73, s73, s43
    s_add_u32 s74, s74, s42
    s_min_u32 m0, s73, s76
    s_min_u32 s74, s74, s75
    s_add_u32 s72, s72, 1

    buffer_load_dwordx4 v35, s[20:23], s74 offen lds
    s_cmp_eq_u32 s72, 36
    s_cselect_b32 s72, 0, s72

    s_mul_i32 s73, s72, 4032
    s_mul_i32 s74, s72, 7168
    s_add_u32 s73, s73, s43
    s_add_u32 s74, s74, s42
    s_min_u32 m0, s73, s76
    s_min_u32 s74, s74, s75
    s_add_u32 s72, s72, 1

    buffer_load_dwordx4 v35, s[20:23], s74 offen lds
    s_cmp_eq_u32 s72, 36
    s_cselect_b32 s72, 0, s72

    s_mul_i32 s73, s72, 4032
    s_mul_i32 s74, s72, 7168
    s_add_u32 s73, s73, s43
    s_add_u32 s74, s74, s42
    s_min_u32 m0, s73, s76
    s_min_u32 s74, s74, s75
    s_add_u32 s72, s72, 1

    buffer_load_dwordx4 v35, s[20:23], s74 offen lds
    s_cmp_eq_u32 s72, 36
    s_cselect_b32 s72, 0, s72

    s_mul_i32 s73, s72, 4032
    s_mul_i32 s74, s72, 7168
    s_add_u32 s73, s73, s43
    s_add_u32 s74, s74, s42
    s_min_u32 m0, s73, s76
    s_min_u32 s74, s74, s75
    s_add_u32 s72, s72, 1

    buffer_load_dwordx4 v35, s[20:23], s74 offen lds
    s_cmp_eq_u32 s72, 36
    s_cselect_b32 s72, 0, s72

    s_mul_i32 s73, s72, 4032
    s_mul_i32 s74, s72, 7168
    s_add_u32 s73, s73, s43
    s_add_u32 s74, s74, s42
    s_min_u32 m0, s73, s76
    s_min_u32 s74, s74, s75
    s_add_u32 s72, s72, 1

    buffer_load_dwordx4 v35, s[20:23], s74 offen lds
    s_cmp_eq_u32 s72, 36
    s_cselect_b32 s72, 0, s72

    s_mul_i32 s73, s72, 4032
    s_mul_i32 s74, s72, 7168
    s_add_u32 s73, s73, s43
    s_add_u32 s74, s74, s42
    s_min_u32 m0, s73, s76
    s_min_u32 s74, s74, s75
    s_add_u32 s72, s72, 1

    buffer_load_dwordx4 v35, s[20:23], s74 offen lds
    s_cmp_eq_u32 s72, 36
    s_cselect_b32 s72, 0, s72

    s_mul_i32 s73, s72, 4032
    s_mul_i32 s74, s72, 7168
    s_add_u32 s73, s73, s43
    s_add_u32 s74, s74, s42
    s_min_u32 m0, s73, s76
    s_min_u32 s74, s74, s75
    s_add_u32 s72, s72, 1

    buffer_load_dwordx4 v35, s[20:23], s74 offen lds
    s_cmp_eq_u32 s72, 36
    s_cselect_b32 s72, 0, s72

    s_mul_i32 s73, s72, 4032
    s_mul_i32 s74, s72, 7168
    s_add_u32 s73, s73, s43
    s_add_u32 s74, s74, s42
    s_min_u32 m0, s73, s76
    s_min_u32 s74, s74, s75
    s_add_u32 s72, s72, 1

    buffer_load_dwordx4 v35, s[20:23], s74 offen lds
    s_cmp_eq_u32 s72, 36
    s_cselect_b32 s72, 0, s72

    s_mul_i32 s73, s72, 4032
    s_mul_i32 s74, s72, 7168
    s_add_u32 s73, s73, s43
    s_add_u32 s74, s74, s42
    s_min_u32 m0, s73, s76
    s_min_u32 s74, s74, s75
    s_add_u32 s72, s72, 1

    buffer_load_dwordx4 v35, s[20:23], s74 offen lds
    s_cmp_eq_u32 s72, 36
    s_cselect_b32 s72, 0, s72

    s_mul_i32 s73, s72, 4032
    s_mul_i32 s74, s72, 7168
    s_add_u32 s73, s73, s43
    s_add_u32 s74, s74, s42
    s_min_u32 m0, s73, s76
    s_min_u32 s74, s74, s75
    s_add_u32 s72, s72, 1

    buffer_load_dwordx4 v35, s[20:23], s74 offen lds
    s_cmp_eq_u32 s72, 36
    s_cselect_b32 s72, 0, s72

    s_mul_i32 s73, s72, 4032
    s_mul_i32 s74, s72, 7168
    s_add_u32 s73, s73, s43
    s_add_u32 s74, s74, s42
    s_min_u32 m0, s73, s76
    s_min_u32 s74, s74, s75
    s_add_u32 s72, s72, 1

    buffer_load_dwordx4 v35, s[20:23], s74 offen lds
    s_cmp_eq_u32 s72, 36
    s_cselect_b32 s72, 0, s72

    s_mul_i32 s73, s72, 4032
    s_mul_i32 s74, s72, 7168
    s_add_u32 s73, s73, s43
    s_add_u32 s74, s74, s42
    s_min_u32 m0, s73, s76
    s_min_u32 s74, s74, s75
    s_add_u32 s72, s72, 1

    buffer_load_dwordx4 v35, s[20:23], s74 offen lds
    s_cmp_eq_u32 s72, 36
    s_cselect_b32 s72, 0, s72

    s_mul_i32 s73, s72, 4032
    s_mul_i32 s74, s72, 7168
    s_add_u32 s73, s73, s43
    s_add_u32 s74, s74, s42
    s_min_u32 m0, s73, s76
    s_min_u32 s74, s74, s75
    s_add_u32 s72, s72, 1

    buffer_load_dwordx4 v35, s[20:23], s74 offen lds
    s_cmp_eq_u32 s72, 36
    s_cselect_b32 s72, 0, s72

    s_mul_i32 s73, s72, 4032
    s_mul_i32 s74, s72, 7168
    s_add_u32 s73, s73, s43
    s_add_u32 s74, s74, s42
    s_min_u32 m0, s73, s76
    s_min_u32 s74, s74, s75
    s_add_u32 s72, s72, 1

    buffer_load_dwordx4 v35, s[20:23], s74 offen lds
    s_cmp_eq_u32 s72, 36
    s_cselect_b32 s72, 0, s72

    s_mul_i32 s73, s72, 4032
    s_mul_i32 s74, s72, 7168
    s_add_u32 s73, s73, s43
    s_add_u32 s74, s74, s42
    s_min_u32 m0, s73, s76
    s_min_u32 s74, s74, s75
    s_add_u32 s72, s72, 1

    buffer_load_dwordx4 v35, s[20:23], s74 offen lds
    s_cmp_eq_u32 s72, 36
    s_cselect_b32 s72, 0, s72

    s_mul_i32 s73, s72, 4032
    s_mul_i32 s74, s72, 7168
    s_add_u32 s73, s73, s43
    s_add_u32 s74, s74, s42
    s_min_u32 m0, s73, s76
    s_min_u32 s74, s74, s75
    s_add_u32 s72, s72, 1

    buffer_load_dwordx4 v35, s[20:23], s74 offen lds
    s_cmp_eq_u32 s72, 36
    s_cselect_b32 s72, 0, s72

    s_mul_i32 s73, s72, 4032
    s_mul_i32 s74, s72, 7168
    s_add_u32 s73, s73, s43
    s_add_u32 s74, s74, s42
    s_min_u32 m0, s73, s76
    s_min_u32 s74, s74, s75
    s_add_u32 s72, s72, 1

    buffer_load_dwordx4 v35, s[20:23], s74 offen lds
    s_cmp_eq_u32 s72, 36
    s_cselect_b32 s72, 0, s72

    s_mul_i32 s73, s72, 4032
    s_mul_i32 s74, s72, 7168
    s_add_u32 s73, s73, s43
    s_add_u32 s74, s74, s42
    s_min_u32 m0, s73, s76
    s_min_u32 s74, s74, s75
    s_add_u32 s72, s72, 1

    buffer_load_dwordx4 v35, s[20:23], s74 offen lds
    s_cmp_eq_u32 s72, 36
    s_cselect_b32 s72, 0, s72

    s_mul_i32 s73, s72, 4032
    s_mul_i32 s74, s72, 7168
    s_add_u32 s73, s73, s43
    s_add_u32 s74, s74, s42
    s_min_u32 m0, s73, s76
    s_min_u32 s74, s74, s75
    s_add_u32 s72, s72, 1

    buffer_load_dwordx4 v35, s[20:23], s74 offen lds
    s_cmp_eq_u32 s72, 36
    s_cselect_b32 s72, 0, s72

    s_mov_b64 exec, -1
standalone__deep_cross_pnn__recsys_kernel_nd2:

    s_cmp_lg_u32 s64, 0
    s_cbranch_scc1 standalone__deep_cross_pnn__recsys_kernel_nsig
    s_waitcnt vmcnt(0)
    s_barrier

standalone__deep_cross_pnn__recsys_kernel_nsig:
    s_mov_b64 exec, s[48:49]
    buffer_load_dwordx4 v[224:227], v0, s[16:19], s60 offen
    s_add_u32 s60, s60, 3200
    buffer_load_dwordx4 v[228:231], v0, s[16:19], s60 offen
    s_add_u32 s60, s60, 3200
    buffer_load_dwordx4 v[232:235], v0, s[16:19], s60 offen
    s_add_u32 s60, s60, 3200
    buffer_load_dwordx4 v[236:239], v0, s[16:19], s60 offen
    s_add_u32 s60, s60, 3200
    buffer_load_dwordx4 v[240:243], v0, s[16:19], s60 offen
    s_add_u32 s60, s60, 3200
    buffer_load_dwordx4 v[244:247], v0, s[16:19], s60 offen
    s_add_u32 s60, s60, 3200
    buffer_load_dwordx4 v[248:251], v0, s[16:19], s60 offen
    s_add_u32 s60, s60, 3200
    buffer_load_dwordx4 v[252:255], v0, s[16:19], s60 offen
    s_add_u32 s60, s60, 3200
    s_mov_b64 exec, -1
    s_setprio 1

    s_lshl_b32 s61, s56, 8
    s_add_u32 s61, s61, 162688
    v_lshlrev_b32 v86, 2, v8
    v_add_u32 v86, s61, v86
    v_and_b32 v85, 0xffffff80, v86
    v_lshrrev_b32 v27, 5, v8
    v_mul_u32_u24 v27, 0x40404, v27
    v_lshl_or_b32 v27, v27, 8, v27
    s_mul_i32 s61, s56, 4608
    s_add_u32 s61, s61, 144256
    v_mul_u32_u24 v31, 72, v8
    v_add3_u32 v31, s61, v31, -8
    v_mul_u32_u24 v34, 72, v1
    v_lshl_add_u32 v34, v2, 3, v34
    v_add_u32 v34, s61, v34
    v_mul_u32_u24 v3, 52, v7
    v_lshrrev_b32 v3, 8, v3
    v_mad_i32_i24 v2, v3, -5, v7
    v_mov_b32 v13, 0
    v_mul_u32_u24 v2, 0x10001, v2
    v_lshlrev_b32 v2, 12, v2
    v_add_u32 v32, 67108864, v2
    v_add_u32 v33, 201328640, v2
    s_cmp_eq_u32 s59, 3
    s_cselect_b32 s61, 0x0fffff00, -16
    s_cmp_eq_u32 s59, 1
    s_cselect_b32 s61, 0x0ffffff0, s61
    v_mov_b32 v59, s61
    s_lshr_b32 s62, s58, 7
    s_mul_i32 s62, s62, 25
    s_min_u32 s46, s46, 24
    s_add_u32 s62, s62, s46
    s_lshl_b32 s62, s62, 3
    s_bfe_u32 s61, s58, 0x30004
    s_add_u32 s62, s62, s61
    s_lshl_b32 s62, s62, 13
    s_bfe_u32 s61, s58, 0x30001
    s_lshl_b32 s61, s61, 10
    s_add_u32 s62, s62, s61
    s_and_b32 s61, s58, 1
    s_lshl_b32 s46, s61, 2
    s_add_u32 s46, s46, 163712
    s_lshl_b32 s61, s61, 9
    s_add_u32 s62, s62, s61
    s_add_u32 s62, s62, 16777216
    v_and_b32 v30, 31, v8
    v_lshrrev_b32 v3, 5, v8
    v_lshlrev_b32 v30, 4, v30
    v_lshl_add_u32 v30, v3, 3, v30
    s_movk_i32 s66, 0x7c
    s_mov_b32 s67, 0x03030303
    s_mov_b32 s75, 0x06040200
    v_mov_b32 v57, 0x08040201
    v_mov_b32 v58, 0x80402010
    v_mov_b32 v108, 0xff800001
    v_mov_b32 v109, 0xff800001
    v_mov_b32 v110, 0xff800001
    v_mov_b32 v111, 0xff800001
    s_mov_b64 exec, s[48:49]

    s_waitcnt vmcnt(7)
    v_lshl_or_b32 v224, v225, 16, v224
    v_lshl_or_b32 v225, v227, 16, v226
    v_add_u32 v224, v32, v224
    v_add_u32 v225, v33, v225
    ds_write_b64 v34, v[224:225] offset:0

    s_waitcnt vmcnt(6)
    v_lshl_or_b32 v228, v229, 16, v228
    v_lshl_or_b32 v229, v231, 16, v230
    v_add_u32 v228, v32, v228
    v_add_u32 v229, v33, v229
    ds_write_b64 v34, v[228:229] offset:576

    s_waitcnt vmcnt(5)
    v_lshl_or_b32 v232, v233, 16, v232
    v_lshl_or_b32 v233, v235, 16, v234
    v_add_u32 v232, v32, v232
    v_add_u32 v233, v33, v233
    ds_write_b64 v34, v[232:233] offset:1152

    s_waitcnt vmcnt(4)
    v_lshl_or_b32 v236, v237, 16, v236
    v_lshl_or_b32 v237, v239, 16, v238
    v_add_u32 v236, v32, v236
    v_add_u32 v237, v33, v237
    ds_write_b64 v34, v[236:237] offset:1728

    s_waitcnt vmcnt(3)
    v_lshl_or_b32 v240, v241, 16, v240
    v_lshl_or_b32 v241, v243, 16, v242
    v_add_u32 v240, v32, v240
    v_add_u32 v241, v33, v241
    ds_write_b64 v34, v[240:241] offset:2304

    s_waitcnt vmcnt(2)
    v_lshl_or_b32 v244, v245, 16, v244
    v_lshl_or_b32 v245, v247, 16, v246
    v_add_u32 v244, v32, v244
    v_add_u32 v245, v33, v245
    ds_write_b64 v34, v[244:245] offset:2880

    s_waitcnt vmcnt(1)
    v_lshl_or_b32 v248, v249, 16, v248
    v_lshl_or_b32 v249, v251, 16, v250
    v_add_u32 v248, v32, v248
    v_add_u32 v249, v33, v249
    ds_write_b64 v34, v[248:249] offset:3456

    s_waitcnt vmcnt(0)
    v_lshl_or_b32 v252, v253, 16, v252
    v_lshl_or_b32 v253, v255, 16, v254
    v_add_u32 v252, v32, v252
    v_add_u32 v253, v33, v253
    ds_write_b64 v34, v[252:253] offset:4032

    s_mov_b64 exec, -1
    ds_read_b64 v[40:41], v31 offset:8
    ds_read_b64 v[42:43], v31 offset:16
    ds_read_b64 v[44:45], v31 offset:24
    ds_read_b64 v[46:47], v31 offset:32
    ds_read_b64 v[48:49], v31 offset:40
    ds_read_b64 v[50:51], v31 offset:48
    ds_read_b64 v[52:53], v31 offset:56
    ds_read_b64 v[54:55], v31 offset:64

    s_waitcnt lgkmcnt(7)
    v_perm_b32 v60, v41, v40, s75
    v_lshlrev_b32 v72, 2, v60

    v_lshrrev_b32 v61, 3, v60
    v_and_b32 v60, 0x07070707, v60
    v_and_or_b32 v0, v61, s67, v27
    v_perm_b32 v16, v58, v57, v60
    v_add_u32 v64, v57, v16

    s_waitcnt lgkmcnt(6)
    v_perm_b32 v60, v43, v42, s75
    v_lshlrev_b32 v73, 2, v60

    v_lshrrev_b32 v61, 3, v60
    v_and_b32 v60, 0x07070707, v60
    v_and_or_b32 v1, v61, s67, v27
    v_perm_b32 v17, v58, v57, v60
    v_add_u32 v65, v57, v17

    s_waitcnt lgkmcnt(5)
    v_perm_b32 v60, v45, v44, s75
    v_lshlrev_b32 v74, 2, v60

    v_lshrrev_b32 v61, 3, v60
    v_and_b32 v60, 0x07070707, v60
    v_and_or_b32 v2, v61, s67, v27
    v_perm_b32 v18, v58, v57, v60
    v_add_u32 v66, v57, v18

    s_waitcnt lgkmcnt(4)
    v_perm_b32 v60, v47, v46, s75
    v_lshlrev_b32 v75, 2, v60

    v_lshrrev_b32 v61, 3, v60
    v_and_b32 v60, 0x07070707, v60
    v_and_or_b32 v3, v61, s67, v27
    v_perm_b32 v19, v58, v57, v60
    v_add_u32 v67, v57, v19

    s_waitcnt lgkmcnt(3)
    v_perm_b32 v60, v49, v48, s75
    v_lshlrev_b32 v76, 2, v60

    v_lshrrev_b32 v61, 3, v60
    v_and_b32 v60, 0x07070707, v60
    v_and_or_b32 v4, v61, s67, v27
    v_perm_b32 v20, v58, v57, v60
    v_add_u32 v68, v57, v20

    s_waitcnt lgkmcnt(2)
    v_perm_b32 v60, v51, v50, s75
    v_lshlrev_b32 v77, 2, v60

    v_lshrrev_b32 v61, 3, v60
    v_and_b32 v60, 0x07070707, v60
    v_and_or_b32 v5, v61, s67, v27
    v_perm_b32 v21, v58, v57, v60
    v_add_u32 v69, v57, v21

    s_waitcnt lgkmcnt(1)
    v_perm_b32 v60, v53, v52, s75
    v_lshlrev_b32 v78, 2, v60

    v_lshrrev_b32 v61, 3, v60
    v_and_b32 v60, 0x07070707, v60
    v_and_or_b32 v6, v61, s67, v27
    v_perm_b32 v22, v58, v57, v60
    v_add_u32 v70, v57, v22

    s_waitcnt lgkmcnt(0)
    v_perm_b32 v60, v55, v54, s75
    v_lshlrev_b32 v79, 2, v60

    v_lshrrev_b32 v61, 3, v60
    v_and_b32 v60, 0x07070707, v60
    v_and_or_b32 v7, v61, s67, v27
    v_perm_b32 v23, v58, v57, v60
    v_add_u32 v71, v57, v23

    ds_write_b32 v86, v13
    s_cmp_eq_u32 s59, 3
    s_cbranch_scc1 standalone__deep_cross_pnn__recsys_kernel_sk1
    v_add_u32 v63, v58, v16
    v_ffbl_b32 v84, v59
    v_perm_b32 v60, v72, v72, v84
    v_and_or_b32 v60, v60, s66, v85
    ds_add_rtn_u32 v87, v60, v10
    ds_wrxchg_rtn_b32 v116, v86, v13

    s_waitcnt lgkmcnt(0)
    v_cmp_gt_u32 s[68:69], 2, v116

    s_nop 0
    v_cmpx_le_u32 vcc, 2, v87
    v_mov_b32 v62, s69
    v_perm_b32 v121, v62, s68, v1
    v_perm_b32 v122, v62, s68, v0
    v_and_b32 v121, v121, v17
    v_and_b32 v122, v122, v16
    v_msad_u8 v120, v65, v121, 0
    v_lshlrev_b32 v120, 8, v120
    v_msad_u8 v120, v63, v122, v120
    v_and_b32 v120, v120, v59

    v_ffbl_b32 v120, v120
    v_max_i32 v84, v84, v120
    s_mov_b64 exec, -1
    v_lshl_add_u32 v59, -1, v84, v59

    v_lshl_add_u32 v61, v84, 1, v31
    ds_read_u16 v80, v61 offset:0
    s_setprio 0
    v_ffbl_b32 v84, v59
    v_perm_b32 v60, v72, v72, v84
    v_and_or_b32 v60, v60, s66, v85
    ds_add_rtn_u32 v87, v60, v10
    ds_wrxchg_rtn_b32 v116, v86, v13

    s_waitcnt lgkmcnt(0)
    v_cmp_gt_u32 s[68:69], 2, v116

    s_nop 0
    v_cmpx_le_u32 vcc, 2, v87
    v_mov_b32 v62, s69
    v_perm_b32 v121, v62, s68, v1
    v_perm_b32 v122, v62, s68, v0
    v_and_b32 v121, v121, v17
    v_and_b32 v122, v122, v16
    v_msad_u8 v120, v65, v121, 0
    v_lshlrev_b32 v120, 8, v120
    v_msad_u8 v120, v63, v122, v120
    v_and_b32 v120, v120, v59

    v_ffbl_b32 v120, v120
    v_max_i32 v84, v84, v120
    s_mov_b64 exec, -1
    v_lshl_add_u32 v59, -1, v84, v59

    v_lshl_add_u32 v61, v84, 1, v31
    ds_read_u16 v81, v61 offset:0
    s_setprio 1
    v_ffbl_b32 v84, v59
    v_perm_b32 v60, v72, v72, v84
    v_and_or_b32 v60, v60, s66, v85
    ds_add_rtn_u32 v87, v60, v10
    ds_wrxchg_rtn_b32 v116, v86, v13

    s_waitcnt lgkmcnt(0)
    v_cmp_gt_u32 s[68:69], 2, v116

    s_nop 0
    v_cmpx_le_u32 vcc, 2, v87
    v_mov_b32 v62, s69
    v_perm_b32 v121, v62, s68, v1
    v_perm_b32 v122, v62, s68, v0
    v_and_b32 v121, v121, v17
    v_and_b32 v122, v122, v16
    v_msad_u8 v120, v65, v121, 0
    v_lshlrev_b32 v120, 8, v120
    v_msad_u8 v120, v63, v122, v120
    v_and_b32 v120, v120, v59

    v_ffbl_b32 v120, v120
    v_max_i32 v84, v84, v120
    s_mov_b64 exec, -1
    v_lshl_add_u32 v59, -1, v84, v59

    v_lshl_add_u32 v61, v84, 1, v31
    ds_read_u16 v82, v61 offset:0
    s_setprio 0
    v_ffbl_b32 v84, v59
    v_perm_b32 v60, v72, v72, v84
    v_and_or_b32 v60, v60, s66, v85
    ds_add_rtn_u32 v87, v60, v10
    ds_wrxchg_rtn_b32 v116, v86, v13

    s_waitcnt lgkmcnt(0)
    v_cmp_gt_u32 s[68:69], 2, v116

    s_nop 0
    v_cmpx_le_u32 vcc, 2, v87
    v_mov_b32 v62, s69
    v_perm_b32 v121, v62, s68, v1
    v_and_b32 v121, v121, v17
    v_msad_u8 v120, v65, v121, 0
    v_and_b32_sdwa v120, v120, v59 dst_sel:BYTE_1 dst_unused:UNUSED_PAD src0_sel:DWORD src1_sel:BYTE_1
    s_nop 0

    v_ffbl_b32 v120, v120
    v_max_i32 v84, v84, v120
    s_mov_b64 exec, -1
    v_lshl_add_u32 v59, -1, v84, v59

    v_lshl_add_u32 v61, v84, 1, v31
    ds_read_u16 v83, v61 offset:0
standalone__deep_cross_pnn__recsys_kernel_sk1:
    v_lshrrev_b32 v59, 4, v59
    v_add_u32 v63, v58, v17
    s_setprio 1
    v_ffbl_b32 v84, v59
    v_perm_b32 v60, v73, v72, v84
    v_and_or_b32 v60, v60, s66, v85

    v_cmpx_ge_u32 vcc, 0, v84
    ds_add_u32 v60, v10
    s_not_b64 s[70:71], vcc
    s_mov_b64 exec, s[70:71]
    ds_add_rtn_u32 v87, v60, v10
    s_mov_b64 exec, -1

    ds_wrxchg_rtn_b32 v116, v86, v13
    v_lshlrev_b32 v104, 13, v8
    s_cmp_eq_u32 s64, 0
    s_cselect_b32 s45, s4, 0
    s_and_b32 exec_lo, s45, 3
    s_mov_b32 exec_hi, 0
    buffer_store_dword v13, v104, s[12:15], s9 offen sc1
    s_mov_b64 exec, -1
    buffer_load_dwordx4 v[128:131], v9, s[28:31], s77 offen offset:0
    buffer_load_dwordx4 v[132:135], v9, s[28:31], s77 offen offset:1024

    s_waitcnt lgkmcnt(0)
    v_cmp_gt_u32 s[68:69], 2, v116

    s_cmp_eq_u32 s59, 3
    s_cbranch_scc1 standalone__deep_cross_pnn__recsys_kernel_nf1
    v_lshl_or_b32 v24, v81, 16, v80
    v_lshl_or_b32 v25, v83, 16, v82
    buffer_store_dwordx2 v[24:25], v30, s[32:35], s62 offen sc1
    s_add_u32 s62, s62, s63
standalone__deep_cross_pnn__recsys_kernel_nf1:
    s_mov_b64 exec, s[70:71]
    v_cmpx_le_u32 vcc, 2, v87
    v_mov_b32 v62, s69
    v_perm_b32 v121, v62, s68, v2
    v_perm_b32 v122, v62, s68, v1
    v_and_b32 v121, v121, v18
    v_and_b32 v122, v122, v17
    v_msad_u8 v120, v66, v121, 0
    v_lshlrev_b32 v120, 8, v120
    v_msad_u8 v120, v63, v122, v120
    v_and_b32 v120, v120, v59

    v_ffbl_b32 v120, v120
    v_max_i32 v84, v84, v120
    s_mov_b64 exec, -1
    v_lshl_add_u32 v59, -1, v84, v59

    v_lshl_add_u32 v61, v84, 1, v31
    ds_read_u16 v80, v61 offset:8
    s_setprio 0
    v_ffbl_b32 v84, v59
    v_perm_b32 v60, v73, v72, v84
    v_and_or_b32 v60, v60, s66, v85

    v_cmpx_ge_u32 vcc, 1, v84
    ds_add_u32 v60, v10
    s_not_b64 s[70:71], vcc
    s_mov_b64 exec, s[70:71]
    ds_add_rtn_u32 v87, v60, v10
    s_mov_b64 exec, -1

    ds_wrxchg_rtn_b32 v116, v86, v13
    s_mov_b64 exec, s[4:5]
    buffer_load_dwordx4 v[104:107], v56, s[20:23], s44 offen
    s_mov_b64 exec, -1
    buffer_load_dwordx4 v[136:139], v9, s[28:31], s77 offen offset:2048
    buffer_load_dwordx4 v[140:143], v9, s[28:31], s77 offen offset:3072
    s_add_u32 s77, s77, 4096

    s_waitcnt lgkmcnt(0)
    v_cmp_gt_u32 s[68:69], 2, v116

    s_mov_b64 exec, s[70:71]
    v_cmpx_le_u32 vcc, 2, v87
    v_mov_b32 v62, s69
    v_perm_b32 v121, v62, s68, v2
    v_perm_b32 v122, v62, s68, v1
    v_and_b32 v121, v121, v18
    v_and_b32 v122, v122, v17
    v_msad_u8 v120, v66, v121, 0
    v_lshlrev_b32 v120, 8, v120
    v_msad_u8 v120, v63, v122, v120
    v_and_b32 v120, v120, v59

    v_ffbl_b32 v120, v120
    v_max_i32 v84, v84, v120
    s_mov_b64 exec, -1
    v_lshl_add_u32 v59, -1, v84, v59

    v_lshl_add_u32 v61, v84, 1, v31
    ds_read_u16 v81, v61 offset:8
    s_setprio 1
    v_ffbl_b32 v84, v59
    v_perm_b32 v60, v73, v72, v84
    v_and_or_b32 v60, v60, s66, v85

    v_cmpx_ge_u32 vcc, 2, v84
    ds_add_u32 v60, v10
    s_not_b64 s[70:71], vcc
    s_mov_b64 exec, s[70:71]
    ds_add_rtn_u32 v87, v60, v10
    s_mov_b64 exec, -1

    ds_wrxchg_rtn_b32 v116, v86, v13
    buffer_load_dwordx4 v[144:147], v9, s[28:31], s77 offen offset:0
    buffer_load_dwordx4 v[148:151], v9, s[28:31], s77 offen offset:1024

    s_waitcnt lgkmcnt(0)
    v_cmp_gt_u32 s[68:69], 2, v116

    s_mov_b64 exec, s[70:71]
    v_cmpx_le_u32 vcc, 2, v87
    v_mov_b32 v62, s69
    v_perm_b32 v121, v62, s68, v2
    v_perm_b32 v122, v62, s68, v1
    v_and_b32 v121, v121, v18
    v_and_b32 v122, v122, v17
    v_msad_u8 v120, v66, v121, 0
    v_lshlrev_b32 v120, 8, v120
    v_msad_u8 v120, v63, v122, v120
    v_and_b32 v120, v120, v59

    v_ffbl_b32 v120, v120
    v_max_i32 v84, v84, v120
    s_mov_b64 exec, -1
    v_lshl_add_u32 v59, -1, v84, v59

    v_lshl_add_u32 v61, v84, 1, v31
    ds_read_u16 v82, v61 offset:8
    s_setprio 0
    v_ffbl_b32 v84, v59
    v_perm_b32 v60, v73, v72, v84
    v_and_or_b32 v60, v60, s66, v85

    v_cmpx_ge_u32 vcc, 3, v84
    ds_add_u32 v60, v10
    s_not_b64 s[70:71], vcc
    s_mov_b64 exec, s[70:71]
    ds_add_rtn_u32 v87, v60, v10
    s_mov_b64 exec, -1

    ds_wrxchg_rtn_b32 v116, v86, v13
    buffer_load_dwordx4 v[152:155], v9, s[28:31], s77 offen offset:2048
    buffer_load_dwordx4 v[156:159], v9, s[28:31], s77 offen offset:3072
    s_add_u32 s77, s77, 126976

    s_waitcnt lgkmcnt(0)
    v_cmp_gt_u32 s[68:69], 2, v116

    s_mov_b64 exec, s[70:71]
    v_cmpx_le_u32 vcc, 2, v87
    v_mov_b32 v62, s69
    v_perm_b32 v121, v62, s68, v2
    v_and_b32 v121, v121, v18
    v_msad_u8 v120, v66, v121, 0
    v_and_b32_sdwa v120, v120, v59 dst_sel:BYTE_1 dst_unused:UNUSED_PAD src0_sel:DWORD src1_sel:BYTE_1
    s_nop 0

    v_ffbl_b32 v120, v120
    v_max_i32 v84, v84, v120
    s_mov_b64 exec, -1
    v_lshl_add_u32 v59, -1, v84, v59

    v_lshl_add_u32 v61, v84, 1, v31
    ds_read_u16 v83, v61 offset:8
    v_lshrrev_b32 v59, 4, v59
    v_add_u32 v63, v58, v18
    s_setprio 1
    v_ffbl_b32 v84, v59
    v_perm_b32 v60, v74, v73, v84
    v_and_or_b32 v60, v60, s66, v85

    v_cmpx_ge_u32 vcc, 0, v84
    ds_add_u32 v60, v10
    s_not_b64 s[70:71], vcc
    s_mov_b64 exec, s[70:71]
    ds_add_rtn_u32 v87, v60, v10
    s_mov_b64 exec, -1

    ds_wrxchg_rtn_b32 v116, v86, v13
    buffer_load_dwordx4 v[160:163], v9, s[28:31], s77 offen offset:0
    buffer_load_dwordx4 v[164:167], v9, s[28:31], s77 offen offset:1024

    s_waitcnt lgkmcnt(0)
    v_cmp_gt_u32 s[68:69], 2, v116

    v_lshl_or_b32 v24, v81, 16, v80
    v_lshl_or_b32 v25, v83, 16, v82
    buffer_store_dwordx2 v[24:25], v30, s[32:35], s62 offen sc1
    s_add_u32 s62, s62, s63
    s_mov_b64 exec, s[70:71]
    v_cmpx_le_u32 vcc, 2, v87
    v_mov_b32 v62, s69
    v_perm_b32 v121, v62, s68, v3
    v_perm_b32 v122, v62, s68, v2
    v_and_b32 v121, v121, v19
    v_and_b32 v122, v122, v18
    v_msad_u8 v120, v67, v121, 0
    v_lshlrev_b32 v120, 8, v120
    v_msad_u8 v120, v63, v122, v120
    v_and_b32 v120, v120, v59

    v_ffbl_b32 v120, v120
    v_max_i32 v84, v84, v120
    s_mov_b64 exec, -1
    v_lshl_add_u32 v59, -1, v84, v59

    v_lshl_add_u32 v61, v84, 1, v31
    ds_read_u16 v80, v61 offset:16
    s_setprio 0
    v_ffbl_b32 v84, v59
    v_perm_b32 v60, v74, v73, v84
    v_and_or_b32 v60, v60, s66, v85

    v_cmpx_ge_u32 vcc, 1, v84
    ds_add_u32 v60, v10
    s_not_b64 s[70:71], vcc
    s_mov_b64 exec, s[70:71]
    ds_add_rtn_u32 v87, v60, v10
    s_mov_b64 exec, -1

    ds_wrxchg_rtn_b32 v116, v86, v13
    buffer_load_dwordx4 v[168:171], v9, s[28:31], s77 offen offset:2048
    buffer_load_dwordx4 v[172:175], v9, s[28:31], s77 offen offset:3072
    s_add_u32 s77, s77, 4096

    s_waitcnt lgkmcnt(0)
    v_cmp_gt_u32 s[68:69], 2, v116

    s_mov_b64 exec, s[70:71]
    v_cmpx_le_u32 vcc, 2, v87
    v_mov_b32 v62, s69
    v_perm_b32 v121, v62, s68, v3
    v_perm_b32 v122, v62, s68, v2
    v_and_b32 v121, v121, v19
    v_and_b32 v122, v122, v18
    v_msad_u8 v120, v67, v121, 0
    v_lshlrev_b32 v120, 8, v120
    v_msad_u8 v120, v63, v122, v120
    v_and_b32 v120, v120, v59

    v_ffbl_b32 v120, v120
    v_max_i32 v84, v84, v120
    s_mov_b64 exec, -1
    v_lshl_add_u32 v59, -1, v84, v59

    v_lshl_add_u32 v61, v84, 1, v31
    ds_read_u16 v81, v61 offset:16
    s_setprio 1
    v_ffbl_b32 v84, v59
    v_perm_b32 v60, v74, v73, v84
    v_and_or_b32 v60, v60, s66, v85

    v_cmpx_ge_u32 vcc, 2, v84
    ds_add_u32 v60, v10
    s_not_b64 s[70:71], vcc
    s_mov_b64 exec, s[70:71]
    ds_add_rtn_u32 v87, v60, v10
    s_mov_b64 exec, -1

    ds_wrxchg_rtn_b32 v116, v86, v13
    s_waitcnt vmcnt(11)
    s_mov_b64 exec, s[4:5]
    buffer_store_dwordx4 v[104:107], v9, s[32:35], s47 offen sc1
    s_mov_b64 exec, -1
    buffer_load_dwordx4 v[176:179], v9, s[28:31], s77 offen offset:0
    buffer_load_dwordx4 v[180:183], v9, s[28:31], s77 offen offset:1024

    s_waitcnt lgkmcnt(0)
    v_cmp_gt_u32 s[68:69], 2, v116

    s_mov_b64 exec, s[70:71]
    v_cmpx_le_u32 vcc, 2, v87
    v_mov_b32 v62, s69
    v_perm_b32 v121, v62, s68, v3
    v_perm_b32 v122, v62, s68, v2
    v_and_b32 v121, v121, v19
    v_and_b32 v122, v122, v18
    v_msad_u8 v120, v67, v121, 0
    v_lshlrev_b32 v120, 8, v120
    v_msad_u8 v120, v63, v122, v120
    v_and_b32 v120, v120, v59

    v_ffbl_b32 v120, v120
    v_max_i32 v84, v84, v120
    s_mov_b64 exec, -1
    v_lshl_add_u32 v59, -1, v84, v59

    v_lshl_add_u32 v61, v84, 1, v31
    ds_read_u16 v82, v61 offset:16
    s_setprio 0
    v_ffbl_b32 v84, v59
    v_perm_b32 v60, v74, v73, v84
    v_and_or_b32 v60, v60, s66, v85

    v_cmpx_ge_u32 vcc, 3, v84
    ds_add_u32 v60, v10
    s_not_b64 s[70:71], vcc
    s_mov_b64 exec, s[70:71]
    ds_add_rtn_u32 v87, v60, v10
    s_mov_b64 exec, -1

    ds_wrxchg_rtn_b32 v116, v86, v13
    buffer_load_dwordx4 v[184:187], v9, s[28:31], s77 offen offset:2048
    buffer_load_dwordx4 v[188:191], v9, s[28:31], s77 offen offset:3072

    s_waitcnt lgkmcnt(0)
    v_cmp_gt_u32 s[68:69], 2, v116

    s_mov_b64 exec, s[70:71]
    v_cmpx_le_u32 vcc, 2, v87
    v_mov_b32 v62, s69
    v_perm_b32 v121, v62, s68, v3
    v_and_b32 v121, v121, v19
    v_msad_u8 v120, v67, v121, 0
    v_and_b32_sdwa v120, v120, v59 dst_sel:BYTE_1 dst_unused:UNUSED_PAD src0_sel:DWORD src1_sel:BYTE_1
    s_nop 0

    v_ffbl_b32 v120, v120
    v_max_i32 v84, v84, v120
    s_mov_b64 exec, -1
    v_lshl_add_u32 v59, -1, v84, v59

    v_lshl_add_u32 v61, v84, 1, v31
    ds_read_u16 v83, v61 offset:16
    v_lshrrev_b32 v59, 4, v59
    v_add_u32 v63, v58, v19
    s_setprio 1
    v_ffbl_b32 v84, v59
    v_perm_b32 v60, v75, v74, v84
    v_and_or_b32 v60, v60, s66, v85

    v_cmpx_ge_u32 vcc, 0, v84
    ds_add_u32 v60, v10
    s_not_b64 s[70:71], vcc
    s_mov_b64 exec, s[70:71]
    ds_add_rtn_u32 v87, v60, v10
    s_mov_b64 exec, -1

    ds_wrxchg_rtn_b32 v116, v86, v13

    s_waitcnt lgkmcnt(0)
    v_cmp_gt_u32 s[68:69], 2, v116

    v_lshl_or_b32 v24, v81, 16, v80
    v_lshl_or_b32 v25, v83, 16, v82
    buffer_store_dwordx2 v[24:25], v30, s[32:35], s62 offen sc1
    s_add_u32 s62, s62, s63
    s_mov_b64 exec, s[70:71]
    v_cmpx_le_u32 vcc, 2, v87
    v_mov_b32 v62, s69
    v_perm_b32 v121, v62, s68, v4
    v_perm_b32 v122, v62, s68, v3
    v_and_b32 v121, v121, v20
    v_and_b32 v122, v122, v19
    v_msad_u8 v120, v68, v121, 0
    v_lshlrev_b32 v120, 8, v120
    v_msad_u8 v120, v63, v122, v120
    v_and_b32 v120, v120, v59

    v_ffbl_b32 v120, v120
    v_max_i32 v84, v84, v120
    s_mov_b64 exec, -1
    v_lshl_add_u32 v59, -1, v84, v59

    v_lshl_add_u32 v61, v84, 1, v31
    ds_read_u16 v80, v61 offset:24
    s_setprio 0
    v_ffbl_b32 v84, v59
    v_perm_b32 v60, v75, v74, v84
    v_and_or_b32 v60, v60, s66, v85

    v_cmpx_ge_u32 vcc, 1, v84
    ds_add_u32 v60, v10
    s_not_b64 s[70:71], vcc
    s_mov_b64 exec, s[70:71]
    ds_add_rtn_u32 v87, v60, v10
    s_mov_b64 exec, -1

    ds_wrxchg_rtn_b32 v116, v86, v13

    s_waitcnt lgkmcnt(0)
    v_cmp_gt_u32 s[68:69], 2, v116

    s_mov_b64 exec, s[70:71]
    v_cmpx_le_u32 vcc, 2, v87
    v_mov_b32 v62, s69
    v_perm_b32 v121, v62, s68, v4
    v_perm_b32 v122, v62, s68, v3
    v_and_b32 v121, v121, v20
    v_and_b32 v122, v122, v19
    v_msad_u8 v120, v68, v121, 0
    v_lshlrev_b32 v120, 8, v120
    v_msad_u8 v120, v63, v122, v120
    v_and_b32 v120, v120, v59

    v_ffbl_b32 v120, v120
    v_max_i32 v84, v84, v120
    s_mov_b64 exec, -1
    v_lshl_add_u32 v59, -1, v84, v59

    v_lshl_add_u32 v61, v84, 1, v31
    ds_read_u16 v81, v61 offset:24
    s_setprio 1

    s_cmp_ge_u32 s57, 800
    s_cbranch_scc1 standalone__deep_cross_pnn__recsys_kernel_norl
    s_waitcnt vmcnt(0)

    s_lshl_b32 s39, 1, s2
    s_cmp_eq_u32 s64, 0
    s_cselect_b32 s39, s39, 0

    s_lshr_b32 s38, s2, 5
    v_mov_b32 v60, s39
    s_lshl_b32 s38, s38, 4
    s_and_b64 exec, s[4:5], 1
    buffer_atomic_or v60, v13, s[52:55], s38 offen offset:128
    s_mov_b64 exec, -1

    v_perm_b32 v88, v132, v128, s84
    v_perm_b32 v89, v140, v136, s84
    v_perm_b32 v90, v148, v144, s84
    v_perm_b32 v91, v156, v152, s84
    v_perm_b32 v92, v132, v128, s85
    v_perm_b32 v93, v140, v136, s85
    v_perm_b32 v94, v148, v144, s85
    v_perm_b32 v95, v156, v152, s85
    v_perm_b32 v96, v133, v129, s84
    v_perm_b32 v97, v141, v137, s84
    v_perm_b32 v98, v149, v145, s84
    v_perm_b32 v99, v157, v153, s84
    v_perm_b32 v100, v133, v129, s85
    v_perm_b32 v101, v141, v137, s85
    v_perm_b32 v102, v149, v145, s85
    v_perm_b32 v103, v157, v153, s85
    ds_write_b128 v36, v[88:91]
    ds_write_b128 v37, v[92:95]
    ds_write_b128 v38, v[96:99]
    ds_write_b128 v39, v[100:103]
    ds_read_b128 v[192:195], v15 offset:0
    ds_read_b128 v[196:199], v15 offset:1024
    ds_read_b128 v[200:203], v15 offset:2048
    ds_read_b128 v[204:207], v15 offset:3072
    s_waitcnt lgkmcnt(4)
    v_perm_b32 v88, v164, v160, s84
    v_perm_b32 v89, v172, v168, s84
    v_perm_b32 v90, v180, v176, s84
    v_perm_b32 v91, v188, v184, s84
    v_perm_b32 v92, v164, v160, s85
    v_perm_b32 v93, v172, v168, s85
    v_perm_b32 v94, v180, v176, s85
    v_perm_b32 v95, v188, v184, s85
    v_perm_b32 v96, v165, v161, s84
    v_perm_b32 v97, v173, v169, s84
    v_perm_b32 v98, v181, v177, s84
    v_perm_b32 v99, v189, v185, s84
    v_perm_b32 v100, v165, v161, s85
    v_perm_b32 v101, v173, v169, s85
    v_perm_b32 v102, v181, v177, s85
    v_perm_b32 v103, v189, v185, s85
    ds_write_b128 v36, v[88:91]
    ds_write_b128 v37, v[92:95]
    ds_write_b128 v38, v[96:99]
    ds_write_b128 v39, v[100:103]
    ds_read_b128 v[208:211], v15 offset:0
    ds_read_b128 v[212:215], v15 offset:1024
    ds_read_b128 v[216:219], v15 offset:2048
    ds_read_b128 v[220:223], v15 offset:3072
    s_waitcnt lgkmcnt(4)
    v_perm_b32 v88, v134, v130, s84
    v_perm_b32 v89, v142, v138, s84
    v_perm_b32 v90, v150, v146, s84
    v_perm_b32 v91, v158, v154, s84
    v_perm_b32 v92, v134, v130, s85
    v_perm_b32 v93, v142, v138, s85
    v_perm_b32 v94, v150, v146, s85
    v_perm_b32 v95, v158, v154, s85
    v_perm_b32 v96, v135, v131, s84
    v_perm_b32 v97, v143, v139, s84
    v_perm_b32 v98, v151, v147, s84
    v_perm_b32 v99, v159, v155, s84
    v_perm_b32 v100, v135, v131, s85
    v_perm_b32 v101, v143, v139, s85
    v_perm_b32 v102, v151, v147, s85
    v_perm_b32 v103, v159, v155, s85
    ds_write_b128 v36, v[88:91]
    ds_write_b128 v37, v[92:95]
    ds_write_b128 v38, v[96:99]
    ds_write_b128 v39, v[100:103]
    ds_read_b128 v[224:227], v15 offset:0
    ds_read_b128 v[228:231], v15 offset:1024
    ds_read_b128 v[232:235], v15 offset:2048
    ds_read_b128 v[236:239], v15 offset:3072
    s_waitcnt lgkmcnt(4)
    v_perm_b32 v88, v166, v162, s84
    v_perm_b32 v89, v174, v170, s84
    v_perm_b32 v90, v182, v178, s84
    v_perm_b32 v91, v190, v186, s84
    v_perm_b32 v92, v166, v162, s85
    v_perm_b32 v93, v174, v170, s85
    v_perm_b32 v94, v182, v178, s85
    v_perm_b32 v95, v190, v186, s85
    v_perm_b32 v96, v167, v163, s84
    v_perm_b32 v97, v175, v171, s84
    v_perm_b32 v98, v183, v179, s84
    v_perm_b32 v99, v191, v187, s84
    v_perm_b32 v100, v167, v163, s85
    v_perm_b32 v101, v175, v171, s85
    v_perm_b32 v102, v183, v179, s85
    v_perm_b32 v103, v191, v187, s85
    ds_write_b128 v36, v[88:91]
    ds_write_b128 v37, v[92:95]
    ds_write_b128 v38, v[96:99]
    ds_write_b128 v39, v[100:103]
    ds_read_b128 v[240:243], v15 offset:0
    ds_read_b128 v[244:247], v15 offset:1024
    ds_read_b128 v[248:251], v15 offset:2048
    ds_read_b128 v[252:255], v15 offset:3072
    ds_write_b64 v31, v[44:45] offset:24
    ds_write_b64 v31, v[46:47] offset:32
    ds_write_b64 v31, v[48:49] offset:40
    ds_write_b64 v31, v[50:51] offset:48
    ds_write_b64 v31, v[52:53] offset:56
    ds_write_b64 v31, v[54:55] offset:64
    s_waitcnt lgkmcnt(6)
standalone__deep_cross_pnn__recsys_kernel_norl:
standalone__deep_cross_pnn__recsys_kernel_rld:
    v_ffbl_b32 v84, v59
    v_perm_b32 v60, v75, v74, v84
    v_and_or_b32 v60, v60, s66, v85

    v_cmpx_ge_u32 vcc, 2, v84
    ds_add_u32 v60, v10
    s_not_b64 s[70:71], vcc
    s_mov_b64 exec, s[70:71]
    ds_add_rtn_u32 v87, v60, v10
    s_mov_b64 exec, -1

    ds_wrxchg_rtn_b32 v116, v86, v13
    s_add_u32 s83, s82, 0
    buffer_store_dwordx4 v[192:195], v14, s[32:35], s83 offen sc1
    s_add_u32 s83, s82, 64
    buffer_store_dwordx4 v[208:211], v14, s[32:35], s83 offen sc1

    s_waitcnt lgkmcnt(0)
    v_cmp_gt_u32 s[68:69], 2, v116

    s_mov_b64 exec, s[70:71]
    v_cmpx_le_u32 vcc, 2, v87
    v_mov_b32 v62, s69
    v_perm_b32 v121, v62, s68, v4
    v_perm_b32 v122, v62, s68, v3
    v_and_b32 v121, v121, v20
    v_and_b32 v122, v122, v19
    v_msad_u8 v120, v68, v121, 0
    v_lshlrev_b32 v120, 8, v120
    v_msad_u8 v120, v63, v122, v120
    v_and_b32 v120, v120, v59

    v_ffbl_b32 v120, v120
    v_max_i32 v84, v84, v120
    s_mov_b64 exec, -1
    v_lshl_add_u32 v59, -1, v84, v59

    v_lshl_add_u32 v61, v84, 1, v31
    ds_read_u16 v82, v61 offset:24
    s_setprio 0
    v_ffbl_b32 v84, v59
    v_perm_b32 v60, v75, v74, v84
    v_and_or_b32 v60, v60, s66, v85

    v_cmpx_ge_u32 vcc, 3, v84
    ds_add_u32 v60, v10
    s_not_b64 s[70:71], vcc
    s_mov_b64 exec, s[70:71]
    ds_add_rtn_u32 v87, v60, v10
    s_mov_b64 exec, -1

    ds_wrxchg_rtn_b32 v116, v86, v13
    s_add_u32 s83, s82, 3284992
    buffer_store_dwordx4 v[196:199], v14, s[32:35], s83 offen sc1
    s_add_u32 s83, s82, 3285056
    buffer_store_dwordx4 v[212:215], v14, s[32:35], s83 offen sc1

    s_waitcnt lgkmcnt(0)
    v_cmp_gt_u32 s[68:69], 2, v116

    s_mov_b64 exec, s[70:71]
    v_cmpx_le_u32 vcc, 2, v87
    v_mov_b32 v62, s69
    v_perm_b32 v121, v62, s68, v4
    v_and_b32 v121, v121, v20
    v_msad_u8 v120, v68, v121, 0
    v_and_b32_sdwa v120, v120, v59 dst_sel:BYTE_1 dst_unused:UNUSED_PAD src0_sel:DWORD src1_sel:BYTE_1
    s_nop 0

    v_ffbl_b32 v120, v120
    v_max_i32 v84, v84, v120
    s_mov_b64 exec, -1
    v_lshl_add_u32 v59, -1, v84, v59

    v_lshl_add_u32 v61, v84, 1, v31
    ds_read_u16 v83, v61 offset:24
    v_lshrrev_b32 v59, 4, v59
    v_add_u32 v63, v58, v20
    s_setprio 1
    v_ffbl_b32 v84, v59
    v_perm_b32 v60, v76, v75, v84
    v_and_or_b32 v60, v60, s66, v85

    v_cmpx_ge_u32 vcc, 0, v84
    ds_add_u32 v60, v10
    s_not_b64 s[70:71], vcc
    s_mov_b64 exec, s[70:71]
    ds_add_rtn_u32 v87, v60, v10
    s_mov_b64 exec, -1

    ds_wrxchg_rtn_b32 v116, v86, v13
    s_add_u32 s83, s82, 6569984
    buffer_store_dwordx4 v[200:203], v14, s[32:35], s83 offen sc1
    s_add_u32 s83, s82, 6570048
    buffer_store_dwordx4 v[216:219], v14, s[32:35], s83 offen sc1

    s_waitcnt lgkmcnt(0)
    v_cmp_gt_u32 s[68:69], 2, v116

    v_lshl_or_b32 v24, v81, 16, v80
    v_lshl_or_b32 v25, v83, 16, v82
    buffer_store_dwordx2 v[24:25], v30, s[32:35], s62 offen sc1
    s_add_u32 s62, s62, s63
    s_mov_b64 exec, s[70:71]
    v_cmpx_le_u32 vcc, 2, v87
    v_mov_b32 v62, s69
    v_perm_b32 v121, v62, s68, v5
    v_perm_b32 v122, v62, s68, v4
    v_and_b32 v121, v121, v21
    v_and_b32 v122, v122, v20
    v_msad_u8 v120, v69, v121, 0
    v_lshlrev_b32 v120, 8, v120
    v_msad_u8 v120, v63, v122, v120
    v_and_b32 v120, v120, v59

    v_ffbl_b32 v120, v120
    v_max_i32 v84, v84, v120
    s_mov_b64 exec, -1
    v_lshl_add_u32 v59, -1, v84, v59

    v_lshl_add_u32 v61, v84, 1, v31
    ds_read_u16 v80, v61 offset:32
    s_setprio 0
    v_ffbl_b32 v84, v59
    v_perm_b32 v60, v76, v75, v84
    v_and_or_b32 v60, v60, s66, v85

    v_cmpx_ge_u32 vcc, 1, v84
    ds_add_u32 v60, v10
    s_not_b64 s[70:71], vcc
    s_mov_b64 exec, s[70:71]
    ds_add_rtn_u32 v87, v60, v10
    s_mov_b64 exec, -1

    ds_wrxchg_rtn_b32 v116, v86, v13
    s_add_u32 s83, s82, 9854976
    buffer_store_dwordx4 v[204:207], v14, s[32:35], s83 offen sc1
    s_add_u32 s83, s82, 9855040
    buffer_store_dwordx4 v[220:223], v14, s[32:35], s83 offen sc1

    s_waitcnt lgkmcnt(0)
    v_cmp_gt_u32 s[68:69], 2, v116

    s_mov_b64 exec, s[70:71]
    v_cmpx_le_u32 vcc, 2, v87
    v_mov_b32 v62, s69
    v_perm_b32 v121, v62, s68, v5
    v_perm_b32 v122, v62, s68, v4
    v_and_b32 v121, v121, v21
    v_and_b32 v122, v122, v20
    v_msad_u8 v120, v69, v121, 0
    v_lshlrev_b32 v120, 8, v120
    v_msad_u8 v120, v63, v122, v120
    v_and_b32 v120, v120, v59

    v_ffbl_b32 v120, v120
    v_max_i32 v84, v84, v120
    s_mov_b64 exec, -1
    v_lshl_add_u32 v59, -1, v84, v59

    v_lshl_add_u32 v61, v84, 1, v31
    ds_read_u16 v81, v61 offset:32
    s_setprio 1
    v_ffbl_b32 v84, v59
    v_perm_b32 v60, v76, v75, v84
    v_and_or_b32 v60, v60, s66, v85

    v_cmpx_ge_u32 vcc, 2, v84
    ds_add_u32 v60, v10
    s_not_b64 s[70:71], vcc
    s_mov_b64 exec, s[70:71]
    ds_add_rtn_u32 v87, v60, v10
    s_mov_b64 exec, -1

    ds_wrxchg_rtn_b32 v116, v86, v13
    s_add_u32 s83, s82, 102656
    buffer_store_dwordx4 v[224:227], v14, s[32:35], s83 offen sc1
    s_add_u32 s83, s82, 102720
    buffer_store_dwordx4 v[240:243], v14, s[32:35], s83 offen sc1

    s_waitcnt lgkmcnt(0)
    v_cmp_gt_u32 s[68:69], 2, v116

    s_mov_b64 exec, s[70:71]
    v_cmpx_le_u32 vcc, 2, v87
    v_mov_b32 v62, s69
    v_perm_b32 v121, v62, s68, v5
    v_perm_b32 v122, v62, s68, v4
    v_and_b32 v121, v121, v21
    v_and_b32 v122, v122, v20
    v_msad_u8 v120, v69, v121, 0
    v_lshlrev_b32 v120, 8, v120
    v_msad_u8 v120, v63, v122, v120
    v_and_b32 v120, v120, v59

    v_ffbl_b32 v120, v120
    v_max_i32 v84, v84, v120
    s_mov_b64 exec, -1
    v_lshl_add_u32 v59, -1, v84, v59

    v_lshl_add_u32 v61, v84, 1, v31
    ds_read_u16 v82, v61 offset:32
    s_setprio 0
    v_ffbl_b32 v84, v59
    v_perm_b32 v60, v76, v75, v84
    v_and_or_b32 v60, v60, s66, v85

    v_cmpx_ge_u32 vcc, 3, v84
    ds_add_u32 v60, v10
    s_not_b64 s[70:71], vcc
    s_mov_b64 exec, s[70:71]
    ds_add_rtn_u32 v87, v60, v10
    s_mov_b64 exec, -1

    ds_wrxchg_rtn_b32 v116, v86, v13
    s_add_u32 s83, s82, 3387648
    buffer_store_dwordx4 v[228:231], v14, s[32:35], s83 offen sc1
    s_add_u32 s83, s82, 3387712
    buffer_store_dwordx4 v[244:247], v14, s[32:35], s83 offen sc1

    s_waitcnt lgkmcnt(0)
    v_cmp_gt_u32 s[68:69], 2, v116

    s_mov_b64 exec, s[70:71]
    v_cmpx_le_u32 vcc, 2, v87
    v_mov_b32 v62, s69
    v_perm_b32 v121, v62, s68, v5
    v_and_b32 v121, v121, v21
    v_msad_u8 v120, v69, v121, 0
    v_and_b32_sdwa v120, v120, v59 dst_sel:BYTE_1 dst_unused:UNUSED_PAD src0_sel:DWORD src1_sel:BYTE_1
    s_nop 0

    v_ffbl_b32 v120, v120
    v_max_i32 v84, v84, v120
    s_mov_b64 exec, -1
    v_lshl_add_u32 v59, -1, v84, v59

    v_lshl_add_u32 v61, v84, 1, v31
    ds_read_u16 v83, v61 offset:32
    v_lshrrev_b32 v59, 4, v59
    v_add_u32 v63, v58, v21

    s_bitcmp0_b32 s59, 0
    s_cbranch_scc1 standalone__deep_cross_pnn__recsys_kernel_mg2
    v_mov_b32 v60, s46
    v_subrev_u32 v61, 512, v86

standalone__deep_cross_pnn__recsys_kernel_mg1:

    ds_read_b32 v12, v60
    ds_read_b32 v120, v61
    s_waitcnt lgkmcnt(0)
    v_readfirstlane_b32 s45, v12
    s_cmp_lg_u32 s45, 0
    s_cbranch_scc1 standalone__deep_cross_pnn__recsys_kernel_mg3
    s_sleep 2
    s_branch standalone__deep_cross_pnn__recsys_kernel_mg1

standalone__deep_cross_pnn__recsys_kernel_mg3:

    ds_write_b32 v60, v13
    s_mov_b32 s45, 0xff00
    v_lshl_or_b32 v120, v120, 8, v120
    v_and_or_b32 v59, v120, s45, v59

standalone__deep_cross_pnn__recsys_kernel_mg2:
    s_setprio 1
    v_ffbl_b32 v84, v59
    v_perm_b32 v60, v77, v76, v84
    v_and_or_b32 v60, v60, s66, v85

    v_cmpx_ge_u32 vcc, 0, v84
    ds_add_u32 v60, v10
    s_not_b64 s[70:71], vcc
    s_mov_b64 exec, s[70:71]
    ds_add_rtn_u32 v87, v60, v10
    s_mov_b64 exec, -1

    ds_wrxchg_rtn_b32 v116, v86, v13
    s_add_u32 s83, s82, 6672640
    buffer_store_dwordx4 v[232:235], v14, s[32:35], s83 offen sc1
    s_add_u32 s83, s82, 6672704
    buffer_store_dwordx4 v[248:251], v14, s[32:35], s83 offen sc1
    buffer_store_dwordx4 v[108:111], v9, s[12:15], s6 offen offset:0 sc1
    buffer_store_dwordx4 v[108:111], v9, s[12:15], s6 offen offset:1024 sc1

    s_waitcnt lgkmcnt(0)
    v_cmp_gt_u32 s[68:69], 2, v116

    v_lshl_or_b32 v24, v81, 16, v80
    v_lshl_or_b32 v25, v83, 16, v82
    buffer_store_dwordx2 v[24:25], v30, s[32:35], s62 offen sc1
    s_add_u32 s62, s62, s63
    s_mov_b64 exec, s[70:71]
    v_cmpx_le_u32 vcc, 2, v87
    v_mov_b32 v62, s69
    v_perm_b32 v121, v62, s68, v6
    v_perm_b32 v122, v62, s68, v5
    v_and_b32 v121, v121, v22
    v_and_b32 v122, v122, v21
    v_msad_u8 v120, v70, v121, 0
    v_lshlrev_b32 v120, 8, v120
    v_msad_u8 v120, v63, v122, v120
    v_and_b32 v120, v120, v59

    v_ffbl_b32 v120, v120
    v_max_i32 v84, v84, v120
    s_mov_b64 exec, -1
    v_lshl_add_u32 v59, -1, v84, v59

    v_lshl_add_u32 v61, v84, 1, v31
    ds_read_u16 v80, v61 offset:40
    s_setprio 0
    v_ffbl_b32 v84, v59
    v_perm_b32 v60, v77, v76, v84
    v_and_or_b32 v60, v60, s66, v85

    v_cmpx_ge_u32 vcc, 1, v84
    ds_add_u32 v60, v10
    s_not_b64 s[70:71], vcc
    s_mov_b64 exec, s[70:71]
    ds_add_rtn_u32 v87, v60, v10
    s_mov_b64 exec, -1

    ds_wrxchg_rtn_b32 v116, v86, v13
    s_add_u32 s83, s82, 9957632
    buffer_store_dwordx4 v[236:239], v14, s[32:35], s83 offen sc1
    s_add_u32 s83, s82, 9957696
    buffer_store_dwordx4 v[252:255], v14, s[32:35], s83 offen sc1
    buffer_store_dwordx4 v[108:111], v9, s[12:15], s6 offen offset:2048 sc1
    buffer_store_dwordx4 v[108:111], v9, s[12:15], s6 offen offset:3072 sc1

    s_waitcnt lgkmcnt(0)
    v_cmp_gt_u32 s[68:69], 2, v116

    s_mov_b64 exec, s[70:71]
    v_cmpx_le_u32 vcc, 2, v87
    v_mov_b32 v62, s69
    v_perm_b32 v121, v62, s68, v6
    v_perm_b32 v122, v62, s68, v5
    v_and_b32 v121, v121, v22
    v_and_b32 v122, v122, v21
    v_msad_u8 v120, v70, v121, 0
    v_lshlrev_b32 v120, 8, v120
    v_msad_u8 v120, v63, v122, v120
    v_and_b32 v120, v120, v59

    v_ffbl_b32 v120, v120
    v_max_i32 v84, v84, v120
    s_mov_b64 exec, -1
    v_lshl_add_u32 v59, -1, v84, v59

    v_lshl_add_u32 v61, v84, 1, v31
    ds_read_u16 v81, v61 offset:40
    s_setprio 1
    v_ffbl_b32 v84, v59
    v_perm_b32 v60, v77, v76, v84
    v_and_or_b32 v60, v60, s66, v85

    v_cmpx_ge_u32 vcc, 2, v84
    ds_add_u32 v60, v10
    s_not_b64 s[70:71], vcc
    s_mov_b64 exec, s[70:71]
    ds_add_rtn_u32 v87, v60, v10
    s_mov_b64 exec, -1

    ds_wrxchg_rtn_b32 v116, v86, v13
    buffer_store_dwordx4 v[108:111], v9, s[12:15], s7 offen offset:0 sc1
    buffer_store_dwordx4 v[108:111], v9, s[12:15], s7 offen offset:1024 sc1

    s_waitcnt lgkmcnt(0)
    v_cmp_gt_u32 s[68:69], 2, v116

    s_mov_b64 exec, s[70:71]
    v_cmpx_le_u32 vcc, 2, v87
    v_mov_b32 v62, s69
    v_perm_b32 v121, v62, s68, v6
    v_perm_b32 v122, v62, s68, v5
    v_and_b32 v121, v121, v22
    v_and_b32 v122, v122, v21
    v_msad_u8 v120, v70, v121, 0
    v_lshlrev_b32 v120, 8, v120
    v_msad_u8 v120, v63, v122, v120
    v_and_b32 v120, v120, v59

    v_ffbl_b32 v120, v120
    v_max_i32 v84, v84, v120
    s_mov_b64 exec, -1
    v_lshl_add_u32 v59, -1, v84, v59

    v_lshl_add_u32 v61, v84, 1, v31
    ds_read_u16 v82, v61 offset:40
    s_setprio 0
    v_ffbl_b32 v84, v59
    v_perm_b32 v60, v77, v76, v84
    v_and_or_b32 v60, v60, s66, v85

    v_cmpx_ge_u32 vcc, 3, v84
    ds_add_u32 v60, v10
    s_not_b64 s[70:71], vcc
    s_mov_b64 exec, s[70:71]
    ds_add_rtn_u32 v87, v60, v10
    s_mov_b64 exec, -1

    ds_wrxchg_rtn_b32 v116, v86, v13
    buffer_store_dwordx4 v[108:111], v9, s[12:15], s7 offen offset:2048 sc1
    buffer_store_dwordx4 v[108:111], v9, s[12:15], s7 offen offset:3072 sc1
    buffer_store_dwordx2 v[108:109], v30, s[12:15], s8 offen sc1
    s_mov_b64 exec, 0xff
    buffer_load_dword v104, v9, s[52:55], 0 offen offset:128 sc1
    s_mov_b64 exec, -1

    s_waitcnt lgkmcnt(0)
    v_cmp_gt_u32 s[68:69], 2, v116

    s_mov_b64 exec, s[70:71]
    v_cmpx_le_u32 vcc, 2, v87
    v_mov_b32 v62, s69
    v_perm_b32 v121, v62, s68, v6
    v_and_b32 v121, v121, v22
    v_msad_u8 v120, v70, v121, 0
    v_and_b32_sdwa v120, v120, v59 dst_sel:BYTE_1 dst_unused:UNUSED_PAD src0_sel:DWORD src1_sel:BYTE_1
    s_nop 0

    v_ffbl_b32 v120, v120
    v_max_i32 v84, v84, v120
    s_mov_b64 exec, -1
    v_lshl_add_u32 v59, -1, v84, v59

    v_lshl_add_u32 v61, v84, 1, v31
    ds_read_u16 v83, v61 offset:40

    s_bitcmp1_b32 s59, 0
    s_cbranch_scc1 standalone__deep_cross_pnn__recsys_kernel_sk6
    v_mov_b32 v60, s46
    ds_write_b32 v86, v59
    ds_write_b32 v60, v10
    s_branch standalone__deep_cross_pnn__recsys_kernel_sdone

standalone__deep_cross_pnn__recsys_kernel_sk6:
    v_lshrrev_b32 v59, 4, v59
    v_add_u32 v63, v58, v22
    s_setprio 1
    v_ffbl_b32 v84, v59
    v_perm_b32 v60, v78, v77, v84

    v_cmp_lt_u32 vcc, 7, v84
    v_alignbyte_b32 v61, v79, v79, v84
    s_nop 0
    v_cndmask_b32 v60, v60, v61, vcc

    v_and_or_b32 v60, v60, s66, v85
    ds_add_rtn_u32 v87, v60, v10
    ds_wrxchg_rtn_b32 v116, v86, v13

    s_waitcnt lgkmcnt(0)
    v_cmp_gt_u32 s[68:69], 2, v116

    v_lshl_or_b32 v24, v81, 16, v80
    v_lshl_or_b32 v25, v83, 16, v82
    buffer_store_dwordx2 v[24:25], v30, s[32:35], s62 offen sc1
    s_add_u32 s62, s62, s63
    s_nop 0
    v_cmpx_le_u32 vcc, 2, v87
    v_mov_b32 v62, s69
    v_perm_b32 v121, v62, s68, v7
    v_perm_b32 v122, v62, s68, v6
    v_perm_b32 v123, v62, s68, v5
    v_and_b32 v121, v121, v23
    v_and_b32 v122, v122, v22
    v_and_b32 v123, v123, v21
    v_msad_u8 v120, v71, v121, 0
    v_lshlrev_b32 v120, 8, v120
    v_msad_u8 v120, v63, v122, v120
    v_msad_u8 v120, v69, v123, v120
    v_and_b32 v120, v120, v59

    v_ffbl_b32 v120, v120
    v_max_i32 v84, v84, v120
    s_mov_b64 exec, -1
    v_lshl_add_u32 v59, -1, v84, v59

    v_lshl_add_u32 v61, v84, 1, v31
    ds_read_u16 v80, v61 offset:48
    s_setprio 0
    v_ffbl_b32 v84, v59
    v_perm_b32 v60, v78, v77, v84

    v_cmp_lt_u32 vcc, 7, v84
    v_alignbyte_b32 v61, v79, v79, v84
    s_nop 0
    v_cndmask_b32 v60, v60, v61, vcc

    v_and_or_b32 v60, v60, s66, v85
    ds_add_rtn_u32 v87, v60, v10
    ds_wrxchg_rtn_b32 v116, v86, v13

    s_waitcnt lgkmcnt(0)
    v_cmp_gt_u32 s[68:69], 2, v116

    s_nop 0
    v_cmpx_le_u32 vcc, 2, v87
    v_mov_b32 v62, s69
    v_perm_b32 v121, v62, s68, v7
    v_perm_b32 v122, v62, s68, v6
    v_perm_b32 v123, v62, s68, v5
    v_and_b32 v121, v121, v23
    v_and_b32 v122, v122, v22
    v_and_b32 v123, v123, v21
    v_msad_u8 v120, v71, v121, 0
    v_lshlrev_b32 v120, 8, v120
    v_msad_u8 v120, v63, v122, v120
    v_msad_u8 v120, v69, v123, v120
    v_and_b32 v120, v120, v59

    v_ffbl_b32 v120, v120
    v_max_i32 v84, v84, v120
    s_mov_b64 exec, -1
    v_lshl_add_u32 v59, -1, v84, v59

    v_lshl_add_u32 v61, v84, 1, v31
    ds_read_u16 v81, v61 offset:48
    s_setprio 1
    v_ffbl_b32 v84, v59
    v_perm_b32 v60, v78, v77, v84

    v_cmp_lt_u32 vcc, 7, v84
    v_alignbyte_b32 v61, v79, v79, v84
    s_nop 0
    v_cndmask_b32 v60, v60, v61, vcc

    v_and_or_b32 v60, v60, s66, v85
    ds_add_rtn_u32 v87, v60, v10
    ds_wrxchg_rtn_b32 v116, v86, v13

    s_waitcnt lgkmcnt(0)
    v_cmp_gt_u32 s[68:69], 2, v116

    s_nop 0
    v_cmpx_le_u32 vcc, 2, v87
    v_mov_b32 v62, s69
    v_perm_b32 v121, v62, s68, v7
    v_perm_b32 v122, v62, s68, v6
    v_perm_b32 v123, v62, s68, v5
    v_and_b32 v121, v121, v23
    v_and_b32 v122, v122, v22
    v_and_b32 v123, v123, v21
    v_msad_u8 v120, v71, v121, 0
    v_lshlrev_b32 v120, 8, v120
    v_msad_u8 v120, v63, v122, v120
    v_msad_u8 v120, v69, v123, v120
    v_and_b32 v120, v120, v59

    v_ffbl_b32 v120, v120
    v_max_i32 v84, v84, v120
    s_mov_b64 exec, -1
    v_lshl_add_u32 v59, -1, v84, v59

    v_lshl_add_u32 v61, v84, 1, v31
    ds_read_u16 v82, v61 offset:48
    v_ffbl_b32 v84, v59
    v_lshl_add_u32 v61, v84, 1, v31
    ds_read_u16 v83, v61 offset:48
standalone__deep_cross_pnn__recsys_kernel_sdone:
    s_waitcnt lgkmcnt(0)
    v_lshl_or_b32 v24, v81, 16, v80
    v_lshl_or_b32 v25, v83, 16, v82
    buffer_store_dwordx2 v[24:25], v30, s[32:35], s62 offen sc1
    s_add_u32 s62, s62, s63
standalone__deep_cross_pnn__recsys_kernel_udone:
    s_setprio 0

    s_waitcnt vmcnt(0)

    s_mov_b64 exec, 1
    ds_add_rtn_u32 v12, v11, v10 offset:20
    s_mov_b32 s49, 0
    s_waitcnt lgkmcnt(0)
    v_readfirstlane_b32 s48, v12
    s_and_b32 s48, s48, 3

    s_mov_b64 exec, 0xff
standalone__deep_cross_pnn__recsys_kernel_ec1:

    v_cmp_ne_u32 vcc, -1, v104
    s_cbranch_vccz standalone__deep_cross_pnn__recsys_kernel_tbl
    buffer_load_dword v104, v9, s[52:55], 0 offen offset:128 sc1
    s_add_u32 s49, s49, 1
    s_waitcnt vmcnt(0)
    s_cmp_lt_u32 s49, 12
    s_cbranch_scc1 standalone__deep_cross_pnn__recsys_kernel_ec1
    s_branch standalone__deep_cross_pnn__recsys_kernel_enx

standalone__deep_cross_pnn__recsys_kernel_hset:

    s_lshl_b32 s39, 1, s51
    s_lshr_b32 s38, s51, 5
    v_mov_b32 v1, s39
    s_lshl_b32 s38, s38, 4
    s_mov_b64 exec, 1
    buffer_atomic_or v1, v13, s[52:55], s38 offen offset:132
    s_mov_b64 exec, -1
    s_waitcnt vmcnt(0)
    s_branch standalone__deep_cross_pnn__recsys_kernel_slow

standalone__deep_cross_pnn__recsys_kernel_tbl:
    s_mov_b64 exec, -1
    s_mov_b32 s49, -1

    s_xor_b32 s44, s50, 1
    s_lshl_b32 s44, s44, 3
    s_add_u32 s44, s44, s56
    s_lshl_b32 s44, s44, 14
    s_add_u32 s44, s44, 15204352
    s_add_u32 s47, s44, 65536

    buffer_load_dwordx4 v[32:35], v9, s[12:15], s44 offen offset:0 sc1
    buffer_load_dwordx4 v[36:39], v9, s[12:15], s44 offen offset:1024 sc1
    buffer_load_dwordx4 v[40:43], v9, s[12:15], s44 offen offset:2048 sc1
    buffer_load_dwordx4 v[44:47], v9, s[12:15], s44 offen offset:3072 sc1
    s_add_u32 s44, s44, 4096
    buffer_load_dwordx4 v[48:51], v9, s[12:15], s44 offen offset:0 sc1
    buffer_load_dwordx4 v[52:55], v9, s[12:15], s44 offen offset:1024 sc1
    buffer_load_dwordx4 v[56:59], v9, s[12:15], s44 offen offset:2048 sc1
    buffer_load_dwordx4 v[60:63], v9, s[12:15], s44 offen offset:3072 sc1
    s_add_u32 s44, s44, 4096
    s_waitcnt vmcnt(7)
    buffer_load_dwordx4 v[88:91], v9, s[12:15], s44 offen offset:0 sc1
    s_waitcnt vmcnt(7)
    buffer_load_dwordx4 v[92:95], v9, s[12:15], s44 offen offset:1024 sc1
    s_waitcnt vmcnt(7)
    buffer_load_dwordx4 v[96:99], v9, s[12:15], s44 offen offset:2048 sc1
    s_waitcnt vmcnt(7)
    buffer_load_dwordx4 v[100:103], v9, s[12:15], s44 offen offset:3072 sc1
    s_add_u32 s44, s44, 4096
    s_waitcnt vmcnt(7)
    buffer_load_dwordx4 v[104:107], v9, s[12:15], s44 offen offset:0 sc1
    s_waitcnt vmcnt(7)
    buffer_load_dwordx4 v[108:111], v9, s[12:15], s44 offen offset:1024 sc1
    s_waitcnt vmcnt(7)
    buffer_load_dwordx4 v[112:115], v9, s[12:15], s44 offen offset:2048 sc1
    s_waitcnt vmcnt(7)
    buffer_load_dwordx4 v[124:127], v9, s[12:15], s44 offen offset:3072 sc1
    s_add_u32 s44, s44, 4096
    s_waitcnt vmcnt(7)
    buffer_load_dwordx4 v[136:139], v9, s[12:15], s47 offen offset:0 sc1
    s_waitcnt vmcnt(7)
    buffer_load_dwordx4 v[140:143], v9, s[12:15], s47 offen offset:1024 sc1
    s_waitcnt vmcnt(7)
    buffer_load_dwordx4 v[152:155], v9, s[12:15], s47 offen offset:2048 sc1
    s_waitcnt vmcnt(7)
    buffer_load_dwordx4 v[156:159], v9, s[12:15], s47 offen offset:3072 sc1
    s_add_u32 s47, s47, 4096
    s_waitcnt vmcnt(7)
    buffer_load_dwordx4 v[168:171], v9, s[12:15], s47 offen offset:0 sc1
    s_waitcnt vmcnt(7)
    buffer_load_dwordx4 v[172:175], v9, s[12:15], s47 offen offset:1024 sc1
    s_waitcnt vmcnt(7)
    buffer_load_dwordx4 v[184:187], v9, s[12:15], s47 offen offset:2048 sc1
    s_waitcnt vmcnt(7)
    buffer_load_dwordx4 v[188:191], v9, s[12:15], s47 offen offset:3072 sc1
    s_add_u32 s47, s47, 4096
    s_waitcnt vmcnt(7)
    buffer_load_dwordx4 v[200:203], v9, s[12:15], s47 offen offset:0 sc1
    s_waitcnt vmcnt(7)
    buffer_load_dwordx4 v[204:207], v9, s[12:15], s47 offen offset:1024 sc1
    s_waitcnt vmcnt(7)
    buffer_load_dwordx4 v[216:219], v9, s[12:15], s47 offen offset:2048 sc1
    s_waitcnt vmcnt(7)
    buffer_load_dwordx4 v[220:223], v9, s[12:15], s47 offen offset:3072 sc1
    s_add_u32 s47, s47, 4096
    s_waitcnt vmcnt(7)
    buffer_load_dwordx4 v[232:235], v9, s[12:15], s47 offen offset:0 sc1
    s_waitcnt vmcnt(7)
    buffer_load_dwordx4 v[236:239], v9, s[12:15], s47 offen offset:1024 sc1
    s_waitcnt vmcnt(7)
    buffer_load_dwordx4 v[248:251], v9, s[12:15], s47 offen offset:2048 sc1
    s_waitcnt vmcnt(7)
    buffer_load_dwordx4 v[252:255], v9, s[12:15], s47 offen offset:3072 sc1
    s_add_u32 s47, s47, 4096
standalone__deep_cross_pnn__recsys_kernel_enx:

    s_cmp_lg_u32 s48, 0
    s_cbranch_scc1 standalone__deep_cross_pnn__recsys_kernel_wdec
    s_mov_b64 exec, -1
    v_lshlrev_b32 v0, 7, v8
    v_lshrrev_b32 v2, 5, v8
    v_lshlrev_b32 v2, 4, v2
    v_lshlrev_b32 v3, 2, v8
    s_mov_b32 s44, 14680064
    s_bfe_u32 s46, s2, 131072
    s_lshl_b32 s47, s46, 7
    s_add_u32 s47, s47, 14688256
    s_lshl_b32 s46, s46, 2
    s_mov_b32 s38, 3221225472

standalone__deep_cross_pnn__recsys_kernel_p0:

    ds_read_b32 v12, v11 offset:20
    s_waitcnt lgkmcnt(0)
    v_readfirstlane_b32 s45, v12
    s_and_b32 s45, s45, 3
    s_cbranch_scc0 standalone__deep_cross_pnn__recsys_kernel_p1s
    s_sleep 1
    s_branch standalone__deep_cross_pnn__recsys_kernel_p0

standalone__deep_cross_pnn__recsys_kernel_p1s:

    s_cmp_lg_u32 s64, 0
    s_cbranch_scc1 standalone__deep_cross_pnn__recsys_kernel_hset

    s_mov_b64 exec, 1
    s_cmp_lg_u32 s49, -1
    s_cbranch_scc1 standalone__deep_cross_pnn__recsys_kernel_nfp
    v_mov_b32 v1, 1
    buffer_atomic_add v1, v13, s[12:15], s47 offen sc0
    buffer_store_dword v10, v13, s[12:15], s9 offen sc1
    s_waitcnt vmcnt(1)
    v_cmpx_eq_u32 vcc, 63, v1
    buffer_store_dword v10, v13, s[52:55], s46 offen sc1
    s_mov_b64 exec, 0xf

standalone__deep_cross_pnn__recsys_kernel_p1:

    buffer_load_dword v1, v3, s[52:55], 0 offen sc1
    s_add_u32 s65, s65, 1
    s_waitcnt vmcnt(0)
    v_cmp_eq_u32 vcc, 0, v1
    s_cbranch_vccz standalone__deep_cross_pnn__recsys_kernel_dec
    s_sleep 4
    s_cmp_lt_u32 s65, 200
    s_cbranch_scc1 standalone__deep_cross_pnn__recsys_kernel_p1
    s_mov_b64 exec, 1

standalone__deep_cross_pnn__recsys_kernel_nfp:

    buffer_store_dword v10, v13, s[12:15], s9 offen sc1
    s_mov_b64 exec, -1

standalone__deep_cross_pnn__recsys_kernel_slow:
    buffer_load_dwordx2 v[16:17], v2, s[52:55], 0 offen offset:128 sc1
    buffer_load_dwordx2 v[18:19], v2, s[52:55], 0 offen offset:160 sc1
    buffer_load_dwordx2 v[20:21], v2, s[52:55], 0 offen offset:192 sc1
    buffer_load_dwordx2 v[22:23], v2, s[52:55], 0 offen offset:224 sc1

    s_waitcnt vmcnt(0)
    buffer_load_dwordx4 v[4:7], v0, s[12:15], s44 offen sc1
    s_add_u32 s65, s65, 1
    s_waitcnt vmcnt(0)

    v_bfe_u32 v16, v16, v8, 1
    v_bfe_u32 v17, v17, v8, 1
    v_and_b32 v4, v4, v16
    v_or_b32 v17, v17, v4

    v_bfe_u32 v18, v18, v8, 1
    v_bfe_u32 v19, v19, v8, 1
    v_and_b32 v5, v5, v18
    v_or_b32 v19, v19, v5

    v_bfe_u32 v20, v20, v8, 1
    v_bfe_u32 v21, v21, v8, 1
    v_and_b32 v6, v6, v20
    v_or_b32 v21, v21, v6

    v_bfe_u32 v22, v22, v8, 1
    v_bfe_u32 v23, v23, v8, 1
    v_and_b32 v7, v7, v22
    v_or_b32 v23, v23, v7

    v_min3_u32 v1, v4, v5, v6
    v_min_u32 v1, v1, v7
    v_cmp_eq_u32 vcc, 0, v1
    s_mov_b32 s38, 3221225472
    s_cbranch_vccz standalone__deep_cross_pnn__recsys_kernel_dec
    v_min3_u32 v1, v17, v19, v21
    v_min_u32 v1, v1, v23
    v_cmp_eq_u32 vcc, 0, v1
    s_mov_b32 s38, 2147483648
    s_cbranch_vccz standalone__deep_cross_pnn__recsys_kernel_dec
    s_cmp_lt_u32 s65, 200
    s_cbranch_scc1 standalone__deep_cross_pnn__recsys_kernel_slow

    v_cmp_eq_u32 vcc, 0, v17
    s_movk_i32 s38, 0
    s_cbranch_vccnz standalone__deep_cross_pnn__recsys_kernel_fnd
    v_cmp_eq_u32 vcc, 0, v19
    s_movk_i32 s38, 64
    s_cbranch_vccnz standalone__deep_cross_pnn__recsys_kernel_fnd
    v_cmp_eq_u32 vcc, 0, v21
    s_movk_i32 s38, 128
    s_cbranch_vccnz standalone__deep_cross_pnn__recsys_kernel_fnd
    v_cmp_eq_u32 vcc, 0, v23
    s_movk_i32 s38, 192
standalone__deep_cross_pnn__recsys_kernel_fnd:

    s_ff1_i32_b64 s39, vcc
    s_add_u32 s38, s38, s39
    s_andn2_b32 s39, s64, 255
    s_add_u32 s39, s39, 256
    s_or_b32 s38, s38, s39

standalone__deep_cross_pnn__recsys_kernel_dec:

    s_mov_b64 exec, 1
    v_mov_b32 v1, s38
    ds_write_b32 v11, v1 offset:24

standalone__deep_cross_pnn__recsys_kernel_wdec:

    s_mov_b64 exec, -1
    ds_read_b32 v12, v11 offset:24
    s_waitcnt lgkmcnt(0)
    v_readfirstlane_b32 s45, v12
    s_cmp_lg_u32 s45, s64
    s_cbranch_scc1 standalone__deep_cross_pnn__recsys_kernel_gotd
    s_sleep 2
    s_branch standalone__deep_cross_pnn__recsys_kernel_wdec

standalone__deep_cross_pnn__recsys_kernel_hlp:
    s_waitcnt vmcnt(0)
    s_branch standalone__deep_cross_pnn__recsys_kernel_unit
standalone__deep_cross_pnn__recsys_kernel_gotd:

    s_mov_b32 s64, s45
    s_and_b32 s51, s45, 255

    s_mov_b32 s65, 200
    s_bitcmp0_b32 s45, 31
    s_cbranch_scc1 standalone__deep_cross_pnn__recsys_kernel_hlp

    s_cmp_eq_u32 s49, -1
    s_cbranch_scc1 standalone__deep_cross_pnn__recsys_kernel_k2

    s_xor_b32 s44, s50, 1
    s_lshl_b32 s44, s44, 3
    s_add_u32 s44, s44, s56
    s_lshl_b32 s44, s44, 14
    s_add_u32 s44, s44, 15204352
    s_add_u32 s47, s44, 65536

    buffer_load_dwordx4 v[32:35], v9, s[12:15], s44 offen offset:0 sc1
    buffer_load_dwordx4 v[36:39], v9, s[12:15], s44 offen offset:1024 sc1
    buffer_load_dwordx4 v[40:43], v9, s[12:15], s44 offen offset:2048 sc1
    buffer_load_dwordx4 v[44:47], v9, s[12:15], s44 offen offset:3072 sc1
    s_add_u32 s44, s44, 4096
    buffer_load_dwordx4 v[48:51], v9, s[12:15], s44 offen offset:0 sc1
    buffer_load_dwordx4 v[52:55], v9, s[12:15], s44 offen offset:1024 sc1
    buffer_load_dwordx4 v[56:59], v9, s[12:15], s44 offen offset:2048 sc1
    buffer_load_dwordx4 v[60:63], v9, s[12:15], s44 offen offset:3072 sc1
    s_add_u32 s44, s44, 4096
    s_waitcnt vmcnt(7)
    buffer_load_dwordx4 v[88:91], v9, s[12:15], s44 offen offset:0 sc1
    s_waitcnt vmcnt(7)
    buffer_load_dwordx4 v[92:95], v9, s[12:15], s44 offen offset:1024 sc1
    s_waitcnt vmcnt(7)
    buffer_load_dwordx4 v[96:99], v9, s[12:15], s44 offen offset:2048 sc1
    s_waitcnt vmcnt(7)
    buffer_load_dwordx4 v[100:103], v9, s[12:15], s44 offen offset:3072 sc1
    s_add_u32 s44, s44, 4096
    s_waitcnt vmcnt(7)
    buffer_load_dwordx4 v[104:107], v9, s[12:15], s44 offen offset:0 sc1
    s_waitcnt vmcnt(7)
    buffer_load_dwordx4 v[108:111], v9, s[12:15], s44 offen offset:1024 sc1
    s_waitcnt vmcnt(7)
    buffer_load_dwordx4 v[112:115], v9, s[12:15], s44 offen offset:2048 sc1
    s_waitcnt vmcnt(7)
    buffer_load_dwordx4 v[124:127], v9, s[12:15], s44 offen offset:3072 sc1
    s_add_u32 s44, s44, 4096
    s_waitcnt vmcnt(7)
    buffer_load_dwordx4 v[136:139], v9, s[12:15], s47 offen offset:0 sc1
    s_waitcnt vmcnt(7)
    buffer_load_dwordx4 v[140:143], v9, s[12:15], s47 offen offset:1024 sc1
    s_waitcnt vmcnt(7)
    buffer_load_dwordx4 v[152:155], v9, s[12:15], s47 offen offset:2048 sc1
    s_waitcnt vmcnt(7)
    buffer_load_dwordx4 v[156:159], v9, s[12:15], s47 offen offset:3072 sc1
    s_add_u32 s47, s47, 4096
    s_waitcnt vmcnt(7)
    buffer_load_dwordx4 v[168:171], v9, s[12:15], s47 offen offset:0 sc1
    s_waitcnt vmcnt(7)
    buffer_load_dwordx4 v[172:175], v9, s[12:15], s47 offen offset:1024 sc1
    s_waitcnt vmcnt(7)
    buffer_load_dwordx4 v[184:187], v9, s[12:15], s47 offen offset:2048 sc1
    s_waitcnt vmcnt(7)
    buffer_load_dwordx4 v[188:191], v9, s[12:15], s47 offen offset:3072 sc1
    s_add_u32 s47, s47, 4096
    s_waitcnt vmcnt(7)
    buffer_load_dwordx4 v[200:203], v9, s[12:15], s47 offen offset:0 sc1
    s_waitcnt vmcnt(7)
    buffer_load_dwordx4 v[204:207], v9, s[12:15], s47 offen offset:1024 sc1
    s_waitcnt vmcnt(7)
    buffer_load_dwordx4 v[216:219], v9, s[12:15], s47 offen offset:2048 sc1
    s_waitcnt vmcnt(7)
    buffer_load_dwordx4 v[220:223], v9, s[12:15], s47 offen offset:3072 sc1
    s_add_u32 s47, s47, 4096
    s_waitcnt vmcnt(7)
    buffer_load_dwordx4 v[232:235], v9, s[12:15], s47 offen offset:0 sc1
    s_waitcnt vmcnt(7)
    buffer_load_dwordx4 v[236:239], v9, s[12:15], s47 offen offset:1024 sc1
    s_waitcnt vmcnt(7)
    buffer_load_dwordx4 v[248:251], v9, s[12:15], s47 offen offset:2048 sc1
    s_waitcnt vmcnt(7)
    buffer_load_dwordx4 v[252:255], v9, s[12:15], s47 offen offset:3072 sc1
    s_add_u32 s47, s47, 4096
standalone__deep_cross_pnn__recsys_kernel_k2:

    s_setprio 0
    s_load_dwordx4 s[8:11], s[0:1], 32
    v_mbcnt_lo_u32_b32 v0, -1, 0
    v_mbcnt_hi_u32_b32 v0, -1, v0
    s_mul_i32 s35, s3, 18432
    v_and_b32 v1, 15, v0
    v_lshrrev_b32 v2, 4, v0
    v_mul_u32_u24 v71, 144, v1
    v_lshl_add_u32 v71, v2, 4, v71
    v_add_u32 v71, s35, v71

    ds_read_b128 v[128:131], v71 offset:0
    ds_read_b128 v[132:135], v71 offset:64
    ds_read_b128 v[144:147], v71 offset:2304
    ds_read_b128 v[148:151], v71 offset:2368
    ds_read_b128 v[160:163], v71 offset:4608
    ds_read_b128 v[164:167], v71 offset:4672
    ds_read_b128 v[176:179], v71 offset:6912
    ds_read_b128 v[180:183], v71 offset:6976
    ds_read_b128 v[192:195], v71 offset:9216
    ds_read_b128 v[196:199], v71 offset:9280
    ds_read_b128 v[208:211], v71 offset:11520
    ds_read_b128 v[212:215], v71 offset:11584
    ds_read_b128 v[224:227], v71 offset:13824
    ds_read_b128 v[228:231], v71 offset:13888
    ds_read_b128 v[240:243], v71 offset:16128
    ds_read_b128 v[244:247], v71 offset:16192

    s_lshr_b32 s33, s2, 1
    s_and_b32 s34, s2, 1
    s_mov_b32 s32, 0x8000
    v_lshlrev_b32 v69, 4, v0
    s_mul_i32 s21, s33, 102656
    s_lshl_b32 s35, s50, 11
    s_xor_b32 s19, s35, 2048
    s_add_u32 s19, s19, s21
    s_add_u32 s21, s21, s35
    s_mul_i32 s20, s34, 1638400
    s_add_u32 s20, s20, 16777216
    s_lshl_b32 s35, s3, 13
    s_add_u32 s20, s20, s35
    v_lshlrev_b32 v70, 13, v2
    v_lshl_add_u32 v70, v1, 3, v70
    s_lshl_b32 s35, s3, 10
    v_add_u32 v70, s35, v70
    v_lshrrev_b32 v4, 3, v0
    v_xor_b32 v4, v4, v2
    v_and_b32 v4, 1, v4
    v_bfe_u32 v5, v0, 2, 1
    v_lshl_or_b32 v4, v4, 1, v5
    v_mov_b32 v6, 0x3f80
    v_cmp_eq_u32 vcc, 0, v4
    s_nop 1
    v_cndmask_b32 v64, 0, v6, vcc
    v_cndmask_b32 v65, 0, v6, vcc
    v_cmp_eq_u32 vcc, 1, v4
    s_nop 1
    v_cndmask_b32 v66, 0, v6, vcc
    v_cndmask_b32 v67, 0, v6, vcc
    v_and_b32 v5, 3, v0
    v_mul_u32_u24 v68, 0x5555, v5

    s_cmp_lt_u32 s3, 4
    s_cbranch_scc1 standalone__deep_cross_pnn__recsys_kernel_k2n
    buffer_load_dwordx4 v[0:3], v69, s[12:15], s21 offen offset:0 sc1
    buffer_load_dwordx4 v[4:7], v69, s[12:15], s21 offen offset:1024 sc1
    buffer_load_dwordx4 v[8:11], v69, s[12:15], s19 offen offset:0 sc1
    buffer_load_dwordx4 v[12:15], v69, s[12:15], s19 offen offset:1024 sc1
    s_add_u32 s21, s21, 4096
    s_add_u32 s19, s19, 4096
    buffer_load_dwordx4 v[16:19], v69, s[12:15], s21 offen offset:0 sc1
    buffer_load_dwordx4 v[20:23], v69, s[12:15], s21 offen offset:1024 sc1
    buffer_load_dwordx4 v[24:27], v69, s[12:15], s19 offen offset:0 sc1
    buffer_load_dwordx4 v[28:31], v69, s[12:15], s19 offen offset:1024 sc1
    s_add_u32 s21, s21, 4096
    s_add_u32 s19, s19, 4096
    s_mov_b32 s44, s21
    s_mov_b32 s45, s19
    s_add_u32 s21, s21, 4096
    s_add_u32 s19, s19, 4096
    buffer_load_dwordx4 v[72:75], v69, s[12:15], s21 offen offset:0 sc1
    buffer_load_dwordx4 v[76:79], v69, s[12:15], s21 offen offset:1024 sc1
    buffer_load_dwordx4 v[80:83], v69, s[12:15], s19 offen offset:0 sc1
    buffer_load_dwordx4 v[84:87], v69, s[12:15], s19 offen offset:1024 sc1
    s_add_u32 s21, s21, 4096
    s_add_u32 s19, s19, 4096
    buffer_load_dwordx4 v[116:119], v69, s[12:15], s20 offen offset:0 sc1
    buffer_load_dwordx4 v[120:123], v69, s[12:15], s20 offen offset:1024 sc1
standalone__deep_cross_pnn__recsys_kernel_k2n:

    s_and_b32 s35, s3, 3
    s_lshl_b32 s35, s35, 14
    s_add_u32 s35, s35, 98304
    v_add_u32 v71, s35, v69
    s_lshl_b32 s35, s33, 3
    s_waitcnt lgkmcnt(0)
    s_add_u32 s8, s8, s35
    s_addc_u32 s9, s9, 0
    s_add_u32 s10, s10, s35
    s_addc_u32 s11, s11, 0
    s_barrier

    s_load_dwordx2 s[36:37], s[8:9], 0
    s_load_dwordx4 s[56:59], s[0:1], 48
    s_load_dwordx2 s[38:39], s[10:11], 0
    s_cmp_lt_u32 s3, 4
    s_cbranch_scc1 standalone__deep_cross_pnn__recsys_kernel_k2m

    s_waitcnt vmcnt(10)
    ds_write_b128 v71, v[32:35] offset:0
    ds_write_b128 v71, v[36:39] offset:1024
    ds_write_b128 v71, v[40:43] offset:2048
    ds_write_b128 v71, v[44:47] offset:3072
    v_mfma_f32_16x16x32_bf16 v[32:35], v[0:3], v[128:131], 0
    v_mfma_f32_16x16x32_bf16 v[36:39], v[0:3], v[144:147], 0
    ds_write_b128 v71, v[48:51] offset:4096
    v_mfma_f32_16x16x32_bf16 v[40:43], v[0:3], v[160:163], 0
    v_mfma_f32_16x16x32_bf16 v[44:47], v[0:3], v[176:179], 0
    ds_write_b128 v71, v[52:55] offset:5120
    v_mfma_f32_16x16x32_bf16 v[32:35], v[4:7], v[132:135], v[32:35]
    v_mfma_f32_16x16x32_bf16 v[36:39], v[4:7], v[148:151], v[36:39]
    ds_write_b128 v71, v[56:59] offset:6144
    v_mfma_f32_16x16x32_bf16 v[40:43], v[4:7], v[164:167], v[40:43]
    v_mfma_f32_16x16x32_bf16 v[44:47], v[4:7], v[180:183], v[44:47]
    ds_write_b128 v71, v[60:63] offset:7168
    v_mfma_f32_16x16x32_bf16 v[32:35], v[8:11], v[136:139], v[32:35]
    v_mfma_f32_16x16x32_bf16 v[36:39], v[8:11], v[152:155], v[36:39]
    ds_write_b128 v71, v[88:91] offset:8192
    v_mfma_f32_16x16x32_bf16 v[40:43], v[8:11], v[168:171], v[40:43]
    v_mfma_f32_16x16x32_bf16 v[44:47], v[8:11], v[184:187], v[44:47]
    ds_write_b128 v71, v[92:95] offset:9216
    v_mfma_f32_16x16x32_bf16 v[32:35], v[12:15], v[140:143], v[32:35]
    v_mfma_f32_16x16x32_bf16 v[36:39], v[12:15], v[156:159], v[36:39]
    ds_write_b128 v71, v[96:99] offset:10240
    v_mfma_f32_16x16x32_bf16 v[40:43], v[12:15], v[172:175], v[40:43]
    v_mfma_f32_16x16x32_bf16 v[44:47], v[12:15], v[188:191], v[44:47]
    ds_write_b128 v71, v[100:103] offset:11264
    v_mfma_f32_16x16x32_bf16 v[48:51], v[0:3], v[192:195], 0
    v_mfma_f32_16x16x32_bf16 v[52:55], v[0:3], v[208:211], 0
    ds_write_b128 v71, v[104:107] offset:12288
    v_mfma_f32_16x16x32_bf16 v[56:59], v[0:3], v[224:227], 0
    v_mfma_f32_16x16x32_bf16 v[60:63], v[0:3], v[240:243], 0
    ds_write_b128 v71, v[108:111] offset:13312
    v_mfma_f32_16x16x32_bf16 v[48:51], v[4:7], v[196:199], v[48:51]
    v_mfma_f32_16x16x32_bf16 v[52:55], v[4:7], v[212:215], v[52:55]
    ds_write_b128 v71, v[112:115] offset:14336
    v_mfma_f32_16x16x32_bf16 v[56:59], v[4:7], v[228:231], v[56:59]
    v_mfma_f32_16x16x32_bf16 v[60:63], v[4:7], v[244:247], v[60:63]
    ds_write_b128 v71, v[124:127] offset:15360
    v_mfma_f32_16x16x32_bf16 v[48:51], v[8:11], v[200:203], v[48:51]
    v_mfma_f32_16x16x32_bf16 v[52:55], v[8:11], v[216:219], v[52:55]
    v_mfma_f32_16x16x32_bf16 v[56:59], v[8:11], v[232:235], v[56:59]
    v_mfma_f32_16x16x32_bf16 v[60:63], v[8:11], v[248:251], v[60:63]
    s_waitcnt lgkmcnt(0)
    s_barrier
    v_mfma_f32_16x16x32_bf16 v[48:51], v[12:15], v[204:207], v[48:51]
    v_mfma_f32_16x16x32_bf16 v[52:55], v[12:15], v[220:223], v[52:55]
    v_mfma_f32_16x16x32_bf16 v[56:59], v[12:15], v[236:239], v[56:59]
    v_mfma_f32_16x16x32_bf16 v[60:63], v[12:15], v[252:255], v[60:63]
    buffer_load_dwordx4 v[124:127], v69, s[12:15], s20 offen offset:2048 sc1
    buffer_load_dwordx4 v[0:3], v69, s[12:15], s44 offen offset:0 sc1
    buffer_load_dwordx4 v[4:7], v69, s[12:15], s44 offen offset:1024 sc1
    buffer_load_dwordx4 v[8:11], v69, s[12:15], s45 offen offset:0 sc1
    buffer_load_dwordx4 v[12:15], v69, s[12:15], s45 offen offset:1024 sc1
    s_waitcnt vmcnt(11)
    s_lshl_b32 s24, s36, 16
    s_and_b32 s25, s36, 0xffff0000
    s_lshl_b32 s26, s37, 16
    s_and_b32 s27, s37, 0xffff0000

    v_mfma_f32_16x16x32_bf16 v[88:91], v[16:19], v[128:131], 0
    v_mfma_f32_16x16x32_bf16 v[92:95], v[16:19], v[144:147], 0
    v_mfma_f32_16x16x32_bf16 v[88:91], v[20:23], v[132:135], v[88:91]
    v_mfma_f32_16x16x32_bf16 v[92:95], v[20:23], v[148:151], v[92:95]
    v_mfma_f32_16x16x32_bf16 v[88:91], v[24:27], v[136:139], v[88:91]
    v_cvt_pk_bf16_f32 v32, v32, v33
    v_mfma_f32_16x16x32_bf16 v[92:95], v[24:27], v[152:155], v[92:95]
    v_cvt_pk_bf16_f32 v33, v34, v35
    v_mfma_f32_16x16x32_bf16 v[88:91], v[28:31], v[140:143], v[88:91]
    ds_write_b64 v70, v[32:33] offset:0
    v_mfma_f32_16x16x32_bf16 v[92:95], v[28:31], v[156:159], v[92:95]
    v_cvt_pk_bf16_f32 v36, v36, v37
    v_mfma_f32_16x16x32_bf16 v[96:99], v[16:19], v[160:163], 0
    v_cvt_pk_bf16_f32 v37, v38, v39
    v_mfma_f32_16x16x32_bf16 v[100:103], v[16:19], v[176:179], 0
    ds_write_b64 v70, v[36:37] offset:128
    v_mfma_f32_16x16x32_bf16 v[96:99], v[20:23], v[164:167], v[96:99]
    v_cvt_pk_bf16_f32 v88, v88, v89
    v_cvt_pk_bf16_f32 v40, v40, v41
    v_mfma_f32_16x16x32_bf16 v[100:103], v[20:23], v[180:183], v[100:103]
    v_cvt_pk_bf16_f32 v89, v90, v91
    v_cvt_pk_bf16_f32 v41, v42, v43
    v_mfma_f32_16x16x32_bf16 v[96:99], v[24:27], v[168:171], v[96:99]
    ds_write_b64 v70, v[88:89] offset:32768
    ds_write_b64 v70, v[40:41] offset:256
    v_mfma_f32_16x16x32_bf16 v[100:103], v[24:27], v[184:187], v[100:103]
    v_cvt_pk_bf16_f32 v92, v92, v93
    v_cvt_pk_bf16_f32 v44, v44, v45
    v_mfma_f32_16x16x32_bf16 v[96:99], v[28:31], v[172:175], v[96:99]
    v_cvt_pk_bf16_f32 v93, v94, v95
    v_cvt_pk_bf16_f32 v45, v46, v47
    v_mfma_f32_16x16x32_bf16 v[100:103], v[28:31], v[188:191], v[100:103]
    ds_write_b64 v70, v[92:93] offset:32896
    ds_write_b64 v70, v[44:45] offset:384
    v_mfma_f32_16x16x32_bf16 v[104:107], v[16:19], v[192:195], 0
    v_cvt_pk_bf16_f32 v48, v48, v49
    v_mfma_f32_16x16x32_bf16 v[108:111], v[16:19], v[208:211], 0
    v_cvt_pk_bf16_f32 v49, v50, v51
    v_mfma_f32_16x16x32_bf16 v[104:107], v[20:23], v[196:199], v[104:107]
    v_cvt_pk_bf16_f32 v96, v96, v97
    ds_write_b64 v70, v[48:49] offset:512
    v_mfma_f32_16x16x32_bf16 v[108:111], v[20:23], v[212:215], v[108:111]
    v_cvt_pk_bf16_f32 v97, v98, v99
    v_cvt_pk_bf16_f32 v52, v52, v53
    v_mfma_f32_16x16x32_bf16 v[104:107], v[24:27], v[200:203], v[104:107]
    ds_write_b64 v70, v[96:97] offset:33024
    v_cvt_pk_bf16_f32 v53, v54, v55
    v_mfma_f32_16x16x32_bf16 v[108:111], v[24:27], v[216:219], v[108:111]
    v_cvt_pk_bf16_f32 v100, v100, v101
    ds_write_b64 v70, v[52:53] offset:640
    v_mfma_f32_16x16x32_bf16 v[104:107], v[28:31], v[204:207], v[104:107]
    v_cvt_pk_bf16_f32 v101, v102, v103
    v_cvt_pk_bf16_f32 v56, v56, v57
    v_mfma_f32_16x16x32_bf16 v[108:111], v[28:31], v[220:223], v[108:111]
    ds_write_b64 v70, v[100:101] offset:33152
    v_cvt_pk_bf16_f32 v57, v58, v59
    v_mfma_f32_16x16x32_bf16 v[88:91], v[16:19], v[224:227], 0
    ds_write_b64 v70, v[56:57] offset:768
    v_mfma_f32_16x16x32_bf16 v[92:95], v[16:19], v[240:243], 0
    v_cvt_pk_bf16_f32 v60, v60, v61
    v_mfma_f32_16x16x32_bf16 v[88:91], v[20:23], v[228:231], v[88:91]
    v_cvt_pk_bf16_f32 v104, v104, v105
    v_cvt_pk_bf16_f32 v61, v62, v63
    v_mfma_f32_16x16x32_bf16 v[92:95], v[20:23], v[244:247], v[92:95]
    v_cvt_pk_bf16_f32 v105, v106, v107
    ds_write_b64 v70, v[60:61] offset:896
    v_mfma_f32_16x16x32_bf16 v[88:91], v[24:27], v[232:235], v[88:91]
    ds_write_b64 v70, v[104:105] offset:33280
    v_mfma_f32_16x16x32_bf16 v[92:95], v[24:27], v[248:251], v[92:95]
    v_cvt_pk_bf16_f32 v108, v108, v109
    v_mfma_f32_16x16x32_bf16 v[88:91], v[28:31], v[236:239], v[88:91]
    v_cvt_pk_bf16_f32 v109, v110, v111
    v_mfma_f32_16x16x32_bf16 v[92:95], v[28:31], v[252:255], v[92:95]
    ds_write_b64 v70, v[108:109] offset:33408
    v_add_u32 v70, 0x8000, v70
    s_waitcnt vmcnt(0)
    v_mfma_f32_16x16x32_bf16 v[96:99], v[0:3], v[128:131], 0
    v_mfma_f32_16x16x32_bf16 v[100:103], v[0:3], v[144:147], 0
    v_mfma_f32_16x16x32_bf16 v[96:99], v[4:7], v[132:135], v[96:99]
    v_cvt_pk_bf16_f32 v88, v88, v89
    v_mfma_f32_16x16x32_bf16 v[100:103], v[4:7], v[148:151], v[100:103]
    v_cvt_pk_bf16_f32 v89, v90, v91
    v_mfma_f32_16x16x32_bf16 v[96:99], v[8:11], v[136:139], v[96:99]
    ds_write_b64 v70, v[88:89] offset:768
    v_mov_b32 v16, s24
    v_mov_b32 v40, s24
    v_mfma_f32_16x16x32_bf16 v[100:103], v[8:11], v[152:155], v[100:103]
    v_cvt_pk_bf16_f32 v92, v92, v93
    v_mov_b32 v17, s25
    v_mov_b32 v41, s25
    v_mfma_f32_16x16x32_bf16 v[96:99], v[12:15], v[140:143], v[96:99]
    v_cvt_pk_bf16_f32 v93, v94, v95
    v_mov_b32 v18, s26
    v_mov_b32 v42, s26
    v_mfma_f32_16x16x32_bf16 v[100:103], v[12:15], v[156:159], v[100:103]
    ds_write_b64 v70, v[92:93] offset:896
    v_mov_b32 v19, s27
    v_mov_b32 v43, s27
    v_mfma_f32_16x16x32_bf16 v[104:107], v[0:3], v[160:163], 0
    v_mov_b32 v20, s24
    v_mov_b32 v44, s24
    v_mfma_f32_16x16x32_bf16 v[108:111], v[0:3], v[176:179], 0
    v_mov_b32 v21, s25
    v_mov_b32 v45, s25
    v_mfma_f32_16x16x32_bf16 v[104:107], v[4:7], v[164:167], v[104:107]
    v_cvt_pk_bf16_f32 v96, v96, v97
    v_mov_b32 v22, s26
    v_mov_b32 v46, s26
    v_mfma_f32_16x16x32_bf16 v[108:111], v[4:7], v[180:183], v[108:111]
    v_cvt_pk_bf16_f32 v97, v98, v99
    v_mov_b32 v23, s27
    v_mov_b32 v47, s27
    v_mfma_f32_16x16x32_bf16 v[104:107], v[8:11], v[168:171], v[104:107]
    ds_write_b64 v70, v[96:97] offset:32768
    v_mov_b32 v24, s24
    v_mov_b32 v48, s24
    v_mfma_f32_16x16x32_bf16 v[108:111], v[8:11], v[184:187], v[108:111]
    v_cvt_pk_bf16_f32 v100, v100, v101
    v_mov_b32 v25, s25
    v_mov_b32 v49, s25
    v_mfma_f32_16x16x32_bf16 v[104:107], v[12:15], v[172:175], v[104:107]
    v_cvt_pk_bf16_f32 v101, v102, v103
    v_mov_b32 v26, s26
    v_mov_b32 v50, s26
    v_mfma_f32_16x16x32_bf16 v[108:111], v[12:15], v[188:191], v[108:111]
    ds_write_b64 v70, v[100:101] offset:32896
    v_mov_b32 v27, s27
    v_mov_b32 v51, s27
    v_mfma_f32_16x16x32_bf16 v[88:91], v[0:3], v[192:195], 0
    v_mov_b32 v28, s24
    v_mov_b32 v52, s24
    v_mfma_f32_16x16x32_bf16 v[92:95], v[0:3], v[208:211], 0
    v_mov_b32 v29, s25
    v_mov_b32 v53, s25
    v_mfma_f32_16x16x32_bf16 v[88:91], v[4:7], v[196:199], v[88:91]
    v_cvt_pk_bf16_f32 v104, v104, v105
    v_mov_b32 v30, s26
    v_mov_b32 v54, s26
    v_mfma_f32_16x16x32_bf16 v[92:95], v[4:7], v[212:215], v[92:95]
    v_cvt_pk_bf16_f32 v105, v106, v107
    v_mov_b32 v31, s27
    v_mov_b32 v55, s27
    v_mfma_f32_16x16x32_bf16 v[88:91], v[8:11], v[200:203], v[88:91]
    ds_write_b64 v70, v[104:105] offset:33024
    v_mov_b32 v32, s24
    v_mov_b32 v56, s24
    v_mfma_f32_16x16x32_bf16 v[92:95], v[8:11], v[216:219], v[92:95]
    v_cvt_pk_bf16_f32 v108, v108, v109
    v_mov_b32 v33, s25
    v_mov_b32 v57, s25
    v_mfma_f32_16x16x32_bf16 v[88:91], v[12:15], v[204:207], v[88:91]
    v_cvt_pk_bf16_f32 v109, v110, v111
    v_mov_b32 v34, s26
    v_mov_b32 v58, s26
    v_mfma_f32_16x16x32_bf16 v[92:95], v[12:15], v[220:223], v[92:95]
    ds_write_b64 v70, v[108:109] offset:33152
    v_mov_b32 v35, s27
    v_mov_b32 v59, s27
    v_mfma_f32_16x16x32_bf16 v[96:99], v[0:3], v[224:227], 0
    v_mov_b32 v36, s24
    v_mov_b32 v60, s24
    v_mfma_f32_16x16x32_bf16 v[100:103], v[0:3], v[240:243], 0
    v_mov_b32 v37, s25
    v_mov_b32 v61, s25
    v_mfma_f32_16x16x32_bf16 v[96:99], v[4:7], v[228:231], v[96:99]
    v_cvt_pk_bf16_f32 v88, v88, v89
    v_mov_b32 v38, s26
    v_mov_b32 v62, s26
    v_mfma_f32_16x16x32_bf16 v[100:103], v[4:7], v[244:247], v[100:103]
    v_cvt_pk_bf16_f32 v89, v90, v91
    v_mov_b32 v39, s27
    v_mov_b32 v63, s27
    v_mfma_f32_16x16x32_bf16 v[96:99], v[8:11], v[232:235], v[96:99]
    ds_write_b64 v70, v[88:89] offset:33280
    s_nop 0
    v_mfma_f32_16x16x32_bf16 v[100:103], v[8:11], v[248:251], v[100:103]
    v_cvt_pk_bf16_f32 v92, v92, v93
    s_nop 0
    v_mfma_f32_16x16x32_bf16 v[96:99], v[12:15], v[236:239], v[96:99]
    v_cvt_pk_bf16_f32 v93, v94, v95
    s_nop 0
    v_mfma_f32_16x16x32_bf16 v[100:103], v[12:15], v[252:255], v[100:103]
    ds_write_b64 v70, v[92:93] offset:33408
    s_nop 0
    v_mov_b32 v0, s24
    v_mov_b32 v1, s25
    v_mov_b32 v2, s26
    v_mov_b32 v3, s27
    v_mov_b32 v4, s24
    v_mov_b32 v5, s25
    v_mov_b32 v6, s26
    v_mov_b32 v7, s27
    v_mov_b32 v8, s24
    v_mov_b32 v9, s25
    v_mov_b32 v10, s26
    v_mov_b32 v11, s27
    v_mov_b32 v12, s24
    v_mov_b32 v13, s25
    v_mov_b32 v14, s26
    v_mov_b32 v15, s27
    s_nop 7
    v_cvt_pk_bf16_f32 v96, v96, v97
    v_cvt_pk_bf16_f32 v97, v98, v99
    ds_write_b64 v70, v[96:97] offset:33536
    v_cvt_pk_bf16_f32 v100, v100, v101
    v_cvt_pk_bf16_f32 v101, v102, v103
    ds_write_b64 v70, v[100:101] offset:33664
    v_add_u32 v70, 0x10000, v70
    s_branch standalone__deep_cross_pnn__recsys_kernel_k2j
standalone__deep_cross_pnn__recsys_kernel_k2m:
    buffer_load_dwordx4 v[0:3], v69, s[12:15], s21 offen offset:0 sc1
    buffer_load_dwordx4 v[4:7], v69, s[12:15], s21 offen offset:1024 sc1
    buffer_load_dwordx4 v[8:11], v69, s[12:15], s19 offen offset:0 sc1
    buffer_load_dwordx4 v[12:15], v69, s[12:15], s19 offen offset:1024 sc1
    s_add_u32 s21, s21, 4096
    s_add_u32 s19, s19, 4096
    buffer_load_dwordx4 v[16:19], v69, s[12:15], s21 offen offset:0 sc1
    buffer_load_dwordx4 v[20:23], v69, s[12:15], s21 offen offset:1024 sc1
    buffer_load_dwordx4 v[24:27], v69, s[12:15], s19 offen offset:0 sc1
    buffer_load_dwordx4 v[28:31], v69, s[12:15], s19 offen offset:1024 sc1
    s_add_u32 s21, s21, 4096
    s_add_u32 s19, s19, 4096
    s_mov_b32 s44, s21
    s_mov_b32 s45, s19
    s_add_u32 s21, s21, 4096
    s_add_u32 s19, s19, 4096
    buffer_load_dwordx4 v[72:75], v69, s[12:15], s21 offen offset:0 sc1
    buffer_load_dwordx4 v[76:79], v69, s[12:15], s21 offen offset:1024 sc1
    buffer_load_dwordx4 v[80:83], v69, s[12:15], s19 offen offset:0 sc1
    buffer_load_dwordx4 v[84:87], v69, s[12:15], s19 offen offset:1024 sc1
    s_add_u32 s21, s21, 4096
    s_add_u32 s19, s19, 4096
    buffer_load_dwordx4 v[116:119], v69, s[12:15], s20 offen offset:0 sc1
    buffer_load_dwordx4 v[120:123], v69, s[12:15], s20 offen offset:1024 sc1
    buffer_load_dwordx4 v[124:127], v69, s[12:15], s20 offen offset:2048 sc1
    buffer_load_dwordx4 v[32:35], v69, s[12:15], s44 offen offset:0 sc1
    buffer_load_dwordx4 v[36:39], v69, s[12:15], s44 offen offset:1024 sc1
    buffer_load_dwordx4 v[40:43], v69, s[12:15], s45 offen offset:0 sc1
    buffer_load_dwordx4 v[44:47], v69, s[12:15], s45 offen offset:1024 sc1
    s_mov_b64 exec, s[46:47]
    buffer_store_dword v113, v112, s[12:15], s74 offen sc1
    s_mov_b64 exec, -1
    s_waitcnt lgkmcnt(0)
    s_barrier
    ds_read_b128 v[136:139], v71 offset:0
    ds_read_b128 v[140:143], v71 offset:1024
    ds_read_b128 v[152:155], v71 offset:2048
    ds_read_b128 v[156:159], v71 offset:3072
    ds_read_b128 v[168:171], v71 offset:4096
    ds_read_b128 v[172:175], v71 offset:5120
    ds_read_b128 v[184:187], v71 offset:6144
    ds_read_b128 v[188:191], v71 offset:7168
    ds_read_b128 v[200:203], v71 offset:8192
    ds_read_b128 v[204:207], v71 offset:9216
    ds_read_b128 v[216:219], v71 offset:10240
    ds_read_b128 v[220:223], v71 offset:11264
    ds_read_b128 v[232:235], v71 offset:12288
    ds_read_b128 v[236:239], v71 offset:13312
    ds_read_b128 v[248:251], v71 offset:14336
    ds_read_b128 v[252:255], v71 offset:15360
    s_waitcnt vmcnt(16)
    v_mfma_f32_16x16x32_bf16 v[48:51], v[0:3], v[128:131], 0
    v_mfma_f32_16x16x32_bf16 v[52:55], v[0:3], v[144:147], 0
    v_mfma_f32_16x16x32_bf16 v[56:59], v[0:3], v[160:163], 0
    v_mfma_f32_16x16x32_bf16 v[60:63], v[0:3], v[176:179], 0
    v_mfma_f32_16x16x32_bf16 v[88:91], v[0:3], v[192:195], 0
    v_mfma_f32_16x16x32_bf16 v[92:95], v[0:3], v[208:211], 0
    v_mfma_f32_16x16x32_bf16 v[96:99], v[0:3], v[224:227], 0
    v_mfma_f32_16x16x32_bf16 v[100:103], v[0:3], v[240:243], 0
    v_mfma_f32_16x16x32_bf16 v[48:51], v[4:7], v[132:135], v[48:51]
    v_mfma_f32_16x16x32_bf16 v[52:55], v[4:7], v[148:151], v[52:55]
    v_mfma_f32_16x16x32_bf16 v[56:59], v[4:7], v[164:167], v[56:59]
    v_mfma_f32_16x16x32_bf16 v[60:63], v[4:7], v[180:183], v[60:63]
    v_mfma_f32_16x16x32_bf16 v[88:91], v[4:7], v[196:199], v[88:91]
    v_mfma_f32_16x16x32_bf16 v[92:95], v[4:7], v[212:215], v[92:95]
    v_mfma_f32_16x16x32_bf16 v[96:99], v[4:7], v[228:231], v[96:99]
    v_mfma_f32_16x16x32_bf16 v[100:103], v[4:7], v[244:247], v[100:103]

    s_lshl_b32 s24, s36, 16
    s_and_b32 s25, s36, 0xffff0000
    s_lshl_b32 s26, s37, 16
    s_and_b32 s27, s37, 0xffff0000

    s_waitcnt lgkmcnt(12)
    v_mfma_f32_16x16x32_bf16 v[48:51], v[8:11], v[136:139], v[48:51]
    v_mfma_f32_16x16x32_bf16 v[52:55], v[8:11], v[152:155], v[52:55]
    v_mfma_f32_16x16x32_bf16 v[48:51], v[12:15], v[140:143], v[48:51]
    v_mfma_f32_16x16x32_bf16 v[52:55], v[12:15], v[156:159], v[52:55]
    s_waitcnt lgkmcnt(8)
    v_mfma_f32_16x16x32_bf16 v[56:59], v[8:11], v[168:171], v[56:59]
    v_mfma_f32_16x16x32_bf16 v[60:63], v[8:11], v[184:187], v[60:63]
    v_mfma_f32_16x16x32_bf16 v[56:59], v[12:15], v[172:175], v[56:59]
    v_mfma_f32_16x16x32_bf16 v[60:63], v[12:15], v[188:191], v[60:63]
    s_waitcnt lgkmcnt(4)
    v_mfma_f32_16x16x32_bf16 v[88:91], v[8:11], v[200:203], v[88:91]
    v_mfma_f32_16x16x32_bf16 v[92:95], v[8:11], v[216:219], v[92:95]
    v_mfma_f32_16x16x32_bf16 v[88:91], v[12:15], v[204:207], v[88:91]
    v_mfma_f32_16x16x32_bf16 v[92:95], v[12:15], v[220:223], v[92:95]
    v_cvt_pk_bf16_f32 v48, v48, v49
    v_cvt_pk_bf16_f32 v49, v50, v51
    ds_write_b64 v70, v[48:49] offset:0
    v_cvt_pk_bf16_f32 v52, v52, v53
    v_cvt_pk_bf16_f32 v53, v54, v55
    ds_write_b64 v70, v[52:53] offset:128
    s_waitcnt lgkmcnt(2)
    v_mfma_f32_16x16x32_bf16 v[96:99], v[8:11], v[232:235], v[96:99]
    v_mfma_f32_16x16x32_bf16 v[100:103], v[8:11], v[248:251], v[100:103]
    v_mfma_f32_16x16x32_bf16 v[96:99], v[12:15], v[236:239], v[96:99]
    v_mfma_f32_16x16x32_bf16 v[100:103], v[12:15], v[252:255], v[100:103]
    v_cvt_pk_bf16_f32 v56, v56, v57
    v_cvt_pk_bf16_f32 v57, v58, v59
    ds_write_b64 v70, v[56:57] offset:256
    v_cvt_pk_bf16_f32 v60, v60, v61
    v_cvt_pk_bf16_f32 v61, v62, v63
    ds_write_b64 v70, v[60:61] offset:384
    s_nop 3
    v_cvt_pk_bf16_f32 v88, v88, v89
    v_cvt_pk_bf16_f32 v89, v90, v91
    ds_write_b64 v70, v[88:89] offset:512
    v_cvt_pk_bf16_f32 v92, v92, v93
    v_cvt_pk_bf16_f32 v93, v94, v95
    ds_write_b64 v70, v[92:93] offset:640
    s_nop 3
    v_cvt_pk_bf16_f32 v96, v96, v97
    v_cvt_pk_bf16_f32 v97, v98, v99
    ds_write_b64 v70, v[96:97] offset:768
    v_cvt_pk_bf16_f32 v100, v100, v101
    v_cvt_pk_bf16_f32 v101, v102, v103
    ds_write_b64 v70, v[100:101] offset:896
    v_add_u32 v70, 0x8000, v70
    s_waitcnt vmcnt(12)
    v_mfma_f32_16x16x32_bf16 v[104:107], v[16:19], v[128:131], 0
    v_mfma_f32_16x16x32_bf16 v[108:111], v[16:19], v[144:147], 0
    v_mfma_f32_16x16x32_bf16 v[104:107], v[20:23], v[132:135], v[104:107]
    v_mfma_f32_16x16x32_bf16 v[108:111], v[20:23], v[148:151], v[108:111]
    v_mfma_f32_16x16x32_bf16 v[104:107], v[24:27], v[136:139], v[104:107]
    v_mov_b32 v48, s24
    v_mfma_f32_16x16x32_bf16 v[108:111], v[24:27], v[152:155], v[108:111]
    v_mov_b32 v49, s25
    v_mfma_f32_16x16x32_bf16 v[104:107], v[28:31], v[140:143], v[104:107]
    v_mov_b32 v50, s26
    v_mfma_f32_16x16x32_bf16 v[108:111], v[28:31], v[156:159], v[108:111]
    v_mov_b32 v51, s27
    v_mfma_f32_16x16x32_bf16 v[88:91], v[16:19], v[160:163], 0
    v_mov_b32 v52, s24
    v_mfma_f32_16x16x32_bf16 v[92:95], v[16:19], v[176:179], 0
    v_mov_b32 v53, s25
    v_mfma_f32_16x16x32_bf16 v[88:91], v[20:23], v[164:167], v[88:91]
    v_cvt_pk_bf16_f32 v104, v104, v105
    v_mov_b32 v54, s26
    v_mfma_f32_16x16x32_bf16 v[92:95], v[20:23], v[180:183], v[92:95]
    v_cvt_pk_bf16_f32 v105, v106, v107
    v_mov_b32 v55, s27
    v_mfma_f32_16x16x32_bf16 v[88:91], v[24:27], v[168:171], v[88:91]
    ds_write_b64 v70, v[104:105] offset:0
    v_mov_b32 v56, s24
    v_mfma_f32_16x16x32_bf16 v[92:95], v[24:27], v[184:187], v[92:95]
    v_cvt_pk_bf16_f32 v108, v108, v109
    v_mov_b32 v57, s25
    v_mfma_f32_16x16x32_bf16 v[88:91], v[28:31], v[172:175], v[88:91]
    v_cvt_pk_bf16_f32 v109, v110, v111
    v_mov_b32 v58, s26
    v_mfma_f32_16x16x32_bf16 v[92:95], v[28:31], v[188:191], v[92:95]
    ds_write_b64 v70, v[108:109] offset:128
    v_mov_b32 v59, s27
    v_mfma_f32_16x16x32_bf16 v[96:99], v[16:19], v[192:195], 0
    v_mov_b32 v60, s24
    v_mfma_f32_16x16x32_bf16 v[100:103], v[16:19], v[208:211], 0
    v_mov_b32 v61, s25
    v_mfma_f32_16x16x32_bf16 v[96:99], v[20:23], v[196:199], v[96:99]
    v_cvt_pk_bf16_f32 v88, v88, v89
    v_mov_b32 v62, s26
    v_mfma_f32_16x16x32_bf16 v[100:103], v[20:23], v[212:215], v[100:103]
    v_cvt_pk_bf16_f32 v89, v90, v91
    v_mov_b32 v63, s27
    v_mfma_f32_16x16x32_bf16 v[96:99], v[24:27], v[200:203], v[96:99]
    ds_write_b64 v70, v[88:89] offset:256
    v_mov_b32 v0, s24
    v_mfma_f32_16x16x32_bf16 v[100:103], v[24:27], v[216:219], v[100:103]
    v_cvt_pk_bf16_f32 v92, v92, v93
    v_mov_b32 v1, s25
    v_mfma_f32_16x16x32_bf16 v[96:99], v[28:31], v[204:207], v[96:99]
    v_cvt_pk_bf16_f32 v93, v94, v95
    v_mov_b32 v2, s26
    v_mfma_f32_16x16x32_bf16 v[100:103], v[28:31], v[220:223], v[100:103]
    ds_write_b64 v70, v[92:93] offset:384
    v_mov_b32 v3, s27
    v_mfma_f32_16x16x32_bf16 v[104:107], v[16:19], v[224:227], 0
    v_mov_b32 v4, s24
    v_mfma_f32_16x16x32_bf16 v[108:111], v[16:19], v[240:243], 0
    v_mov_b32 v5, s25
    v_mfma_f32_16x16x32_bf16 v[104:107], v[20:23], v[228:231], v[104:107]
    v_cvt_pk_bf16_f32 v96, v96, v97
    v_mov_b32 v6, s26
    v_mfma_f32_16x16x32_bf16 v[108:111], v[20:23], v[244:247], v[108:111]
    v_cvt_pk_bf16_f32 v97, v98, v99
    v_mov_b32 v7, s27
    v_mfma_f32_16x16x32_bf16 v[104:107], v[24:27], v[232:235], v[104:107]
    ds_write_b64 v70, v[96:97] offset:512
    v_mov_b32 v8, s24
    v_mfma_f32_16x16x32_bf16 v[108:111], v[24:27], v[248:251], v[108:111]
    v_cvt_pk_bf16_f32 v100, v100, v101
    v_mov_b32 v9, s25
    v_mfma_f32_16x16x32_bf16 v[104:107], v[28:31], v[236:239], v[104:107]
    v_cvt_pk_bf16_f32 v101, v102, v103
    v_mov_b32 v10, s26
    v_mfma_f32_16x16x32_bf16 v[108:111], v[28:31], v[252:255], v[108:111]
    ds_write_b64 v70, v[100:101] offset:640
    v_mov_b32 v11, s27
    s_waitcnt vmcnt(1)
    v_mfma_f32_16x16x32_bf16 v[88:91], v[32:35], v[128:131], 0
    v_mfma_f32_16x16x32_bf16 v[92:95], v[32:35], v[144:147], 0
    v_mfma_f32_16x16x32_bf16 v[88:91], v[36:39], v[132:135], v[88:91]
    v_cvt_pk_bf16_f32 v104, v104, v105
    v_mfma_f32_16x16x32_bf16 v[92:95], v[36:39], v[148:151], v[92:95]
    v_cvt_pk_bf16_f32 v105, v106, v107
    v_mfma_f32_16x16x32_bf16 v[88:91], v[40:43], v[136:139], v[88:91]
    ds_write_b64 v70, v[104:105] offset:768
    v_mov_b32 v12, s24
    v_mfma_f32_16x16x32_bf16 v[92:95], v[40:43], v[152:155], v[92:95]
    v_cvt_pk_bf16_f32 v108, v108, v109
    v_mov_b32 v13, s25
    v_mfma_f32_16x16x32_bf16 v[88:91], v[44:47], v[140:143], v[88:91]
    v_cvt_pk_bf16_f32 v109, v110, v111
    v_mov_b32 v14, s26
    v_mfma_f32_16x16x32_bf16 v[92:95], v[44:47], v[156:159], v[92:95]
    ds_write_b64 v70, v[108:109] offset:896
    v_mov_b32 v15, s27
    v_mfma_f32_16x16x32_bf16 v[96:99], v[32:35], v[160:163], 0
    v_mov_b32 v16, s24
    v_mfma_f32_16x16x32_bf16 v[100:103], v[32:35], v[176:179], 0
    v_mov_b32 v17, s25
    v_mfma_f32_16x16x32_bf16 v[96:99], v[36:39], v[164:167], v[96:99]
    v_cvt_pk_bf16_f32 v88, v88, v89
    v_mov_b32 v18, s26
    v_mfma_f32_16x16x32_bf16 v[100:103], v[36:39], v[180:183], v[100:103]
    v_cvt_pk_bf16_f32 v89, v90, v91
    v_mov_b32 v19, s27
    v_mfma_f32_16x16x32_bf16 v[96:99], v[40:43], v[168:171], v[96:99]
    ds_write_b64 v70, v[88:89] offset:32768
    v_mov_b32 v20, s24
    v_mfma_f32_16x16x32_bf16 v[100:103], v[40:43], v[184:187], v[100:103]
    v_cvt_pk_bf16_f32 v92, v92, v93
    v_mov_b32 v21, s25
    v_mfma_f32_16x16x32_bf16 v[96:99], v[44:47], v[172:175], v[96:99]
    v_cvt_pk_bf16_f32 v93, v94, v95
    v_mov_b32 v22, s26
    v_mfma_f32_16x16x32_bf16 v[100:103], v[44:47], v[188:191], v[100:103]
    ds_write_b64 v70, v[92:93] offset:32896
    v_mov_b32 v23, s27
    v_mfma_f32_16x16x32_bf16 v[104:107], v[32:35], v[192:195], 0
    v_mov_b32 v24, s24
    v_mfma_f32_16x16x32_bf16 v[108:111], v[32:35], v[208:211], 0
    v_mov_b32 v25, s25
    v_mfma_f32_16x16x32_bf16 v[104:107], v[36:39], v[196:199], v[104:107]
    v_cvt_pk_bf16_f32 v96, v96, v97
    v_mov_b32 v26, s26
    v_mfma_f32_16x16x32_bf16 v[108:111], v[36:39], v[212:215], v[108:111]
    v_cvt_pk_bf16_f32 v97, v98, v99
    v_mov_b32 v27, s27
    v_mfma_f32_16x16x32_bf16 v[104:107], v[40:43], v[200:203], v[104:107]
    ds_write_b64 v70, v[96:97] offset:33024
    v_mov_b32 v28, s24
    v_mfma_f32_16x16x32_bf16 v[108:111], v[40:43], v[216:219], v[108:111]
    v_cvt_pk_bf16_f32 v100, v100, v101
    v_mov_b32 v29, s25
    v_mfma_f32_16x16x32_bf16 v[104:107], v[44:47], v[204:207], v[104:107]
    v_cvt_pk_bf16_f32 v101, v102, v103
    v_mov_b32 v30, s26
    v_mfma_f32_16x16x32_bf16 v[108:111], v[44:47], v[220:223], v[108:111]
    ds_write_b64 v70, v[100:101] offset:33152
    v_mov_b32 v31, s27
    v_mfma_f32_16x16x32_bf16 v[88:91], v[32:35], v[224:227], 0
    s_nop 0
    v_mfma_f32_16x16x32_bf16 v[92:95], v[32:35], v[240:243], 0
    s_nop 0
    v_mfma_f32_16x16x32_bf16 v[88:91], v[36:39], v[228:231], v[88:91]
    v_cvt_pk_bf16_f32 v104, v104, v105
    s_nop 0
    v_mfma_f32_16x16x32_bf16 v[92:95], v[36:39], v[244:247], v[92:95]
    v_cvt_pk_bf16_f32 v105, v106, v107
    s_nop 0
    v_mfma_f32_16x16x32_bf16 v[88:91], v[40:43], v[232:235], v[88:91]
    ds_write_b64 v70, v[104:105] offset:33280
    s_nop 0
    v_mfma_f32_16x16x32_bf16 v[92:95], v[40:43], v[248:251], v[92:95]
    v_cvt_pk_bf16_f32 v108, v108, v109
    s_nop 0
    v_mfma_f32_16x16x32_bf16 v[88:91], v[44:47], v[236:239], v[88:91]
    v_cvt_pk_bf16_f32 v109, v110, v111
    s_nop 0
    v_mfma_f32_16x16x32_bf16 v[92:95], v[44:47], v[252:255], v[92:95]
    ds_write_b64 v70, v[108:109] offset:33408
    s_nop 0
    v_mov_b32 v32, s24
    v_mov_b32 v33, s25
    v_mov_b32 v34, s26
    v_mov_b32 v35, s27
    v_mov_b32 v36, s24
    v_mov_b32 v37, s25
    v_mov_b32 v38, s26
    v_mov_b32 v39, s27
    v_mov_b32 v40, s24
    v_mov_b32 v41, s25
    v_mov_b32 v42, s26
    v_mov_b32 v43, s27
    v_mov_b32 v44, s24
    v_mov_b32 v45, s25
    v_mov_b32 v46, s26
    v_mov_b32 v47, s27
    s_nop 7
    v_cvt_pk_bf16_f32 v88, v88, v89
    v_cvt_pk_bf16_f32 v89, v90, v91
    ds_write_b64 v70, v[88:89] offset:33536
    v_cvt_pk_bf16_f32 v92, v92, v93
    v_cvt_pk_bf16_f32 v93, v94, v95
    ds_write_b64 v70, v[92:93] offset:33664
    v_add_u32 v70, 0x10000, v70
standalone__deep_cross_pnn__recsys_kernel_k2j:

    s_mov_b32 s22, 0
    s_mov_b32 s23, 3
    s_waitcnt lgkmcnt(0)
    s_barrier

    v_lshlrev_b32_sdwa v88, 3, v116 dst_sel:DWORD dst_unused:UNUSED_PAD src0_sel:DWORD src1_sel:WORD_0
    v_lshlrev_b32_sdwa v90, 3, v116 dst_sel:DWORD dst_unused:UNUSED_PAD src0_sel:DWORD src1_sel:WORD_1
    v_lshlrev_b32_sdwa v92, 3, v117 dst_sel:DWORD dst_unused:UNUSED_PAD src0_sel:DWORD src1_sel:WORD_0
    v_lshlrev_b32_sdwa v94, 3, v117 dst_sel:DWORD dst_unused:UNUSED_PAD src0_sel:DWORD src1_sel:WORD_1
    ds_read_b64 v[88:89], v88
    ds_read_b64 v[90:91], v90
    ds_read_b64 v[92:93], v92
    ds_read_b64 v[94:95], v94
    v_lshlrev_b32_sdwa v96, 3, v118 dst_sel:DWORD dst_unused:UNUSED_PAD src0_sel:DWORD src1_sel:WORD_0
    v_lshlrev_b32_sdwa v98, 3, v118 dst_sel:DWORD dst_unused:UNUSED_PAD src0_sel:DWORD src1_sel:WORD_1
    v_lshlrev_b32_sdwa v100, 3, v119 dst_sel:DWORD dst_unused:UNUSED_PAD src0_sel:DWORD src1_sel:WORD_0
    v_lshlrev_b32_sdwa v102, 3, v119 dst_sel:DWORD dst_unused:UNUSED_PAD src0_sel:DWORD src1_sel:WORD_1
    ds_read_b64 v[96:97], v96
    ds_read_b64 v[98:99], v98
    ds_read_b64 v[100:101], v100
    ds_read_b64 v[102:103], v102
    buffer_load_dwordx4 v[116:119], v69, s[12:15], s20 offen offset:3072 sc1
    s_add_u32 s20, s20, 4096
standalone__deep_cross_pnn__recsys_kernel_gloop:
    s_setprio 3
    s_waitcnt vmcnt(6)
    v_lshlrev_b32_sdwa v104, 3, v120 dst_sel:DWORD dst_unused:UNUSED_PAD src0_sel:DWORD src1_sel:WORD_0
    v_lshlrev_b32_sdwa v106, 3, v120 dst_sel:DWORD dst_unused:UNUSED_PAD src0_sel:DWORD src1_sel:WORD_1
    ds_read_b64 v[104:105], v104
    ds_read_b64 v[106:107], v106
    v_lshlrev_b32_sdwa v108, 3, v121 dst_sel:DWORD dst_unused:UNUSED_PAD src0_sel:DWORD src1_sel:WORD_0
    v_lshlrev_b32_sdwa v110, 3, v121 dst_sel:DWORD dst_unused:UNUSED_PAD src0_sel:DWORD src1_sel:WORD_1
    ds_read_b64 v[108:109], v108
    ds_read_b64 v[110:111], v110
    s_waitcnt lgkmcnt(8)
    v_smfmac_f32_16x16x64_bf16 v[0:3], v[64:67], v[88:95], v68
    s_waitcnt vmcnt(5)
    v_mfma_f32_16x16x32_bf16 v[112:115], v[72:75], v[128:131], 0
    v_lshlrev_b32_sdwa v88, 3, v122 dst_sel:DWORD dst_unused:UNUSED_PAD src0_sel:DWORD src1_sel:WORD_0
    v_lshlrev_b32_sdwa v90, 3, v122 dst_sel:DWORD dst_unused:UNUSED_PAD src0_sel:DWORD src1_sel:WORD_1
    ds_read_b64 v[88:89], v88
    ds_read_b64 v[90:91], v90
    s_waitcnt vmcnt(4)
    v_mfma_f32_16x16x32_bf16 v[112:115], v[76:79], v[132:135], v[112:115]
    v_lshlrev_b32_sdwa v92, 3, v123 dst_sel:DWORD dst_unused:UNUSED_PAD src0_sel:DWORD src1_sel:WORD_0
    v_lshlrev_b32_sdwa v94, 3, v123 dst_sel:DWORD dst_unused:UNUSED_PAD src0_sel:DWORD src1_sel:WORD_1
    ds_read_b64 v[92:93], v92
    ds_read_b64 v[94:95], v94
    buffer_load_dwordx4 v[120:123], v69, s[12:15], s20 offen offset:0 sc1
    s_waitcnt lgkmcnt(8)
    v_smfmac_f32_16x16x64_bf16 v[4:7], v[64:67], v[96:103], v68
    s_waitcnt vmcnt(4)
    v_mfma_f32_16x16x32_bf16 v[112:115], v[80:83], v[136:139], v[112:115]
    s_waitcnt vmcnt(2)
    v_lshlrev_b32_sdwa v96, 3, v124 dst_sel:DWORD dst_unused:UNUSED_PAD src0_sel:DWORD src1_sel:WORD_0
    v_lshlrev_b32_sdwa v98, 3, v124 dst_sel:DWORD dst_unused:UNUSED_PAD src0_sel:DWORD src1_sel:WORD_1
    ds_read_b64 v[96:97], v96
    ds_read_b64 v[98:99], v98
    s_waitcnt vmcnt(3)
    v_mfma_f32_16x16x32_bf16 v[112:115], v[84:87], v[140:143], v[112:115]
    v_lshlrev_b32_sdwa v100, 3, v125 dst_sel:DWORD dst_unused:UNUSED_PAD src0_sel:DWORD src1_sel:WORD_0
    v_lshlrev_b32_sdwa v102, 3, v125 dst_sel:DWORD dst_unused:UNUSED_PAD src0_sel:DWORD src1_sel:WORD_1
    ds_read_b64 v[100:101], v100
    ds_read_b64 v[102:103], v102
    s_waitcnt lgkmcnt(8)
    v_smfmac_f32_16x16x64_bf16 v[8:11], v[64:67], v[104:111], v68
    s_nop 1
    v_cvt_pk_bf16_f32 v112, v112, v113
    v_cvt_pk_bf16_f32 v113, v114, v115
    ds_write_b64 v70, v[112:113] offset:0
    v_mfma_f32_16x16x32_bf16 v[112:115], v[72:75], v[144:147], 0
    v_mfma_f32_16x16x32_bf16 v[112:115], v[76:79], v[148:151], v[112:115]
    v_lshlrev_b32_sdwa v104, 3, v126 dst_sel:DWORD dst_unused:UNUSED_PAD src0_sel:DWORD src1_sel:WORD_0
    v_lshlrev_b32_sdwa v106, 3, v126 dst_sel:DWORD dst_unused:UNUSED_PAD src0_sel:DWORD src1_sel:WORD_1
    ds_read_b64 v[104:105], v104
    ds_read_b64 v[106:107], v106
    v_mfma_f32_16x16x32_bf16 v[112:115], v[80:83], v[152:155], v[112:115]
    v_mfma_f32_16x16x32_bf16 v[112:115], v[84:87], v[156:159], v[112:115]
    v_lshlrev_b32_sdwa v108, 3, v127 dst_sel:DWORD dst_unused:UNUSED_PAD src0_sel:DWORD src1_sel:WORD_0
    v_lshlrev_b32_sdwa v110, 3, v127 dst_sel:DWORD dst_unused:UNUSED_PAD src0_sel:DWORD src1_sel:WORD_1
    ds_read_b64 v[108:109], v108
    ds_read_b64 v[110:111], v110
    buffer_load_dwordx4 v[124:127], v69, s[12:15], s20 offen offset:1024 sc1
    s_waitcnt lgkmcnt(9)
    v_smfmac_f32_16x16x64_bf16 v[12:15], v[64:67], v[88:95], v68
    s_nop 0
    v_cvt_pk_bf16_f32 v112, v112, v113
    v_cvt_pk_bf16_f32 v113, v114, v115
    ds_write_b64 v70, v[112:113] offset:128
    v_mfma_f32_16x16x32_bf16 v[112:115], v[72:75], v[160:163], 0
    s_waitcnt vmcnt(2)
    v_lshlrev_b32_sdwa v88, 3, v116 dst_sel:DWORD dst_unused:UNUSED_PAD src0_sel:DWORD src1_sel:WORD_0
    v_lshlrev_b32_sdwa v90, 3, v116 dst_sel:DWORD dst_unused:UNUSED_PAD src0_sel:DWORD src1_sel:WORD_1
    ds_read_b64 v[88:89], v88
    ds_read_b64 v[90:91], v90
    v_mfma_f32_16x16x32_bf16 v[112:115], v[76:79], v[164:167], v[112:115]
    v_lshlrev_b32_sdwa v92, 3, v117 dst_sel:DWORD dst_unused:UNUSED_PAD src0_sel:DWORD src1_sel:WORD_0
    v_lshlrev_b32_sdwa v94, 3, v117 dst_sel:DWORD dst_unused:UNUSED_PAD src0_sel:DWORD src1_sel:WORD_1
    ds_read_b64 v[92:93], v92
    ds_read_b64 v[94:95], v94
    s_waitcnt lgkmcnt(10)
    v_smfmac_f32_16x16x64_bf16 v[16:19], v[64:67], v[96:103], v68
    v_mfma_f32_16x16x32_bf16 v[112:115], v[80:83], v[168:171], v[112:115]
    v_lshlrev_b32_sdwa v96, 3, v118 dst_sel:DWORD dst_unused:UNUSED_PAD src0_sel:DWORD src1_sel:WORD_0
    v_lshlrev_b32_sdwa v98, 3, v118 dst_sel:DWORD dst_unused:UNUSED_PAD src0_sel:DWORD src1_sel:WORD_1
    ds_read_b64 v[96:97], v96
    ds_read_b64 v[98:99], v98
    v_mfma_f32_16x16x32_bf16 v[112:115], v[84:87], v[172:175], v[112:115]
    v_lshlrev_b32_sdwa v100, 3, v119 dst_sel:DWORD dst_unused:UNUSED_PAD src0_sel:DWORD src1_sel:WORD_0
    v_lshlrev_b32_sdwa v102, 3, v119 dst_sel:DWORD dst_unused:UNUSED_PAD src0_sel:DWORD src1_sel:WORD_1
    ds_read_b64 v[100:101], v100
    ds_read_b64 v[102:103], v102
    buffer_load_dwordx4 v[116:119], v69, s[12:15], s20 offen offset:2048 sc1
    s_waitcnt lgkmcnt(9)
    v_smfmac_f32_16x16x64_bf16 v[20:23], v[64:67], v[104:111], v68
    s_nop 0
    v_cvt_pk_bf16_f32 v112, v112, v113
    v_cvt_pk_bf16_f32 v113, v114, v115
    ds_write_b64 v70, v[112:113] offset:256
    v_mfma_f32_16x16x32_bf16 v[112:115], v[72:75], v[176:179], 0
    v_mfma_f32_16x16x32_bf16 v[112:115], v[76:79], v[180:183], v[112:115]
    s_waitcnt vmcnt(2)
    v_lshlrev_b32_sdwa v104, 3, v120 dst_sel:DWORD dst_unused:UNUSED_PAD src0_sel:DWORD src1_sel:WORD_0
    v_lshlrev_b32_sdwa v106, 3, v120 dst_sel:DWORD dst_unused:UNUSED_PAD src0_sel:DWORD src1_sel:WORD_1
    ds_read_b64 v[104:105], v104
    ds_read_b64 v[106:107], v106
    v_mfma_f32_16x16x32_bf16 v[112:115], v[80:83], v[184:187], v[112:115]
    v_mfma_f32_16x16x32_bf16 v[112:115], v[84:87], v[188:191], v[112:115]
    v_lshlrev_b32_sdwa v108, 3, v121 dst_sel:DWORD dst_unused:UNUSED_PAD src0_sel:DWORD src1_sel:WORD_0
    v_lshlrev_b32_sdwa v110, 3, v121 dst_sel:DWORD dst_unused:UNUSED_PAD src0_sel:DWORD src1_sel:WORD_1
    ds_read_b64 v[108:109], v108
    ds_read_b64 v[110:111], v110
    s_waitcnt lgkmcnt(9)
    v_smfmac_f32_16x16x64_bf16 v[24:27], v[64:67], v[88:95], v68
    s_nop 1
    v_cvt_pk_bf16_f32 v112, v112, v113
    v_cvt_pk_bf16_f32 v113, v114, v115
    ds_write_b64 v70, v[112:113] offset:384
    v_mfma_f32_16x16x32_bf16 v[112:115], v[72:75], v[192:195], 0
    v_lshlrev_b32_sdwa v88, 3, v122 dst_sel:DWORD dst_unused:UNUSED_PAD src0_sel:DWORD src1_sel:WORD_0
    v_lshlrev_b32_sdwa v90, 3, v122 dst_sel:DWORD dst_unused:UNUSED_PAD src0_sel:DWORD src1_sel:WORD_1
    ds_read_b64 v[88:89], v88
    ds_read_b64 v[90:91], v90
    v_mfma_f32_16x16x32_bf16 v[112:115], v[76:79], v[196:199], v[112:115]
    v_lshlrev_b32_sdwa v92, 3, v123 dst_sel:DWORD dst_unused:UNUSED_PAD src0_sel:DWORD src1_sel:WORD_0
    v_lshlrev_b32_sdwa v94, 3, v123 dst_sel:DWORD dst_unused:UNUSED_PAD src0_sel:DWORD src1_sel:WORD_1
    ds_read_b64 v[92:93], v92
    ds_read_b64 v[94:95], v94
    buffer_load_dwordx4 v[120:123], v69, s[12:15], s20 offen offset:3072 sc1
    s_add_u32 s20, s20, 61440
    s_waitcnt lgkmcnt(10)
    v_smfmac_f32_16x16x64_bf16 v[28:31], v[64:67], v[96:103], v68
    s_setprio 2
    v_mfma_f32_16x16x32_bf16 v[112:115], v[80:83], v[200:203], v[112:115]
    s_waitcnt vmcnt(2)
    v_lshlrev_b32_sdwa v96, 3, v124 dst_sel:DWORD dst_unused:UNUSED_PAD src0_sel:DWORD src1_sel:WORD_0
    v_lshlrev_b32_sdwa v98, 3, v124 dst_sel:DWORD dst_unused:UNUSED_PAD src0_sel:DWORD src1_sel:WORD_1
    ds_read_b64 v[96:97], v96
    ds_read_b64 v[98:99], v98
    v_mfma_f32_16x16x32_bf16 v[112:115], v[84:87], v[204:207], v[112:115]
    v_lshlrev_b32_sdwa v100, 3, v125 dst_sel:DWORD dst_unused:UNUSED_PAD src0_sel:DWORD src1_sel:WORD_0
    v_lshlrev_b32_sdwa v102, 3, v125 dst_sel:DWORD dst_unused:UNUSED_PAD src0_sel:DWORD src1_sel:WORD_1
    ds_read_b64 v[100:101], v100
    ds_read_b64 v[102:103], v102
    s_waitcnt lgkmcnt(9)
    v_smfmac_f32_16x16x64_bf16 v[32:35], v[64:67], v[104:111], v68
    s_nop 1
    v_cvt_pk_bf16_f32 v112, v112, v113
    v_cvt_pk_bf16_f32 v113, v114, v115
    ds_write_b64 v70, v[112:113] offset:512
    v_mfma_f32_16x16x32_bf16 v[112:115], v[72:75], v[208:211], 0
    v_lshlrev_b32_sdwa v104, 3, v126 dst_sel:DWORD dst_unused:UNUSED_PAD src0_sel:DWORD src1_sel:WORD_0
    v_lshlrev_b32_sdwa v106, 3, v126 dst_sel:DWORD dst_unused:UNUSED_PAD src0_sel:DWORD src1_sel:WORD_1
    ds_read_b64 v[104:105], v104
    ds_read_b64 v[106:107], v106
    v_mfma_f32_16x16x32_bf16 v[112:115], v[76:79], v[212:215], v[112:115]
    v_lshlrev_b32_sdwa v108, 3, v127 dst_sel:DWORD dst_unused:UNUSED_PAD src0_sel:DWORD src1_sel:WORD_0
    v_lshlrev_b32_sdwa v110, 3, v127 dst_sel:DWORD dst_unused:UNUSED_PAD src0_sel:DWORD src1_sel:WORD_1
    ds_read_b64 v[108:109], v108
    ds_read_b64 v[110:111], v110
    buffer_load_dwordx4 v[124:127], v69, s[12:15], s20 offen offset:0 sc1
    s_waitcnt lgkmcnt(9)
    v_smfmac_f32_16x16x64_bf16 v[36:39], v[64:67], v[88:95], v68
    v_mfma_f32_16x16x32_bf16 v[112:115], v[80:83], v[216:219], v[112:115]
    s_waitcnt vmcnt(2)
    v_lshlrev_b32_sdwa v88, 3, v116 dst_sel:DWORD dst_unused:UNUSED_PAD src0_sel:DWORD src1_sel:WORD_0
    v_lshlrev_b32_sdwa v90, 3, v116 dst_sel:DWORD dst_unused:UNUSED_PAD src0_sel:DWORD src1_sel:WORD_1
    ds_read_b64 v[88:89], v88
    ds_read_b64 v[90:91], v90
    v_mfma_f32_16x16x32_bf16 v[112:115], v[84:87], v[220:223], v[112:115]
    v_lshlrev_b32_sdwa v92, 3, v117 dst_sel:DWORD dst_unused:UNUSED_PAD src0_sel:DWORD src1_sel:WORD_0
    v_lshlrev_b32_sdwa v94, 3, v117 dst_sel:DWORD dst_unused:UNUSED_PAD src0_sel:DWORD src1_sel:WORD_1
    ds_read_b64 v[92:93], v92
    ds_read_b64 v[94:95], v94
    s_waitcnt lgkmcnt(9)
    v_smfmac_f32_16x16x64_bf16 v[40:43], v[64:67], v[96:103], v68
    s_nop 1
    v_cvt_pk_bf16_f32 v112, v112, v113
    v_cvt_pk_bf16_f32 v113, v114, v115
    ds_write_b64 v70, v[112:113] offset:640
    v_mfma_f32_16x16x32_bf16 v[112:115], v[72:75], v[224:227], 0
    v_mfma_f32_16x16x32_bf16 v[112:115], v[76:79], v[228:231], v[112:115]
    v_lshlrev_b32_sdwa v96, 3, v118 dst_sel:DWORD dst_unused:UNUSED_PAD src0_sel:DWORD src1_sel:WORD_0
    v_lshlrev_b32_sdwa v98, 3, v118 dst_sel:DWORD dst_unused:UNUSED_PAD src0_sel:DWORD src1_sel:WORD_1
    ds_read_b64 v[96:97], v96
    ds_read_b64 v[98:99], v98
    v_mfma_f32_16x16x32_bf16 v[112:115], v[80:83], v[232:235], v[112:115]
    v_mfma_f32_16x16x32_bf16 v[112:115], v[84:87], v[236:239], v[112:115]
    v_lshlrev_b32_sdwa v100, 3, v119 dst_sel:DWORD dst_unused:UNUSED_PAD src0_sel:DWORD src1_sel:WORD_0
    v_lshlrev_b32_sdwa v102, 3, v119 dst_sel:DWORD dst_unused:UNUSED_PAD src0_sel:DWORD src1_sel:WORD_1
    ds_read_b64 v[100:101], v100
    ds_read_b64 v[102:103], v102
    buffer_load_dwordx4 v[116:119], v69, s[12:15], s20 offen offset:1024 sc1
    s_waitcnt lgkmcnt(9)
    v_smfmac_f32_16x16x64_bf16 v[44:47], v[64:67], v[104:111], v68
    s_nop 0
    v_cvt_pk_bf16_f32 v112, v112, v113
    v_cvt_pk_bf16_f32 v113, v114, v115
    ds_write_b64 v70, v[112:113] offset:768
    s_setprio 1
    v_mfma_f32_16x16x32_bf16 v[112:115], v[72:75], v[240:243], 0
    buffer_load_dwordx4 v[72:75], v69, s[12:15], s21 offen offset:0 sc1
    s_waitcnt vmcnt(3)
    v_lshlrev_b32_sdwa v104, 3, v120 dst_sel:DWORD dst_unused:UNUSED_PAD src0_sel:DWORD src1_sel:WORD_0
    v_lshlrev_b32_sdwa v106, 3, v120 dst_sel:DWORD dst_unused:UNUSED_PAD src0_sel:DWORD src1_sel:WORD_1
    ds_read_b64 v[104:105], v104
    ds_read_b64 v[106:107], v106
    v_mfma_f32_16x16x32_bf16 v[112:115], v[76:79], v[244:247], v[112:115]
    buffer_load_dwordx4 v[76:79], v69, s[12:15], s21 offen offset:1024 sc1
    v_lshlrev_b32_sdwa v108, 3, v121 dst_sel:DWORD dst_unused:UNUSED_PAD src0_sel:DWORD src1_sel:WORD_0
    v_lshlrev_b32_sdwa v110, 3, v121 dst_sel:DWORD dst_unused:UNUSED_PAD src0_sel:DWORD src1_sel:WORD_1
    ds_read_b64 v[108:109], v108
    ds_read_b64 v[110:111], v110
    s_waitcnt lgkmcnt(10)
    v_smfmac_f32_16x16x64_bf16 v[48:51], v[64:67], v[88:95], v68
    v_mfma_f32_16x16x32_bf16 v[112:115], v[80:83], v[248:251], v[112:115]
    buffer_load_dwordx4 v[80:83], v69, s[12:15], s19 offen offset:0 sc1
    v_lshlrev_b32_sdwa v88, 3, v122 dst_sel:DWORD dst_unused:UNUSED_PAD src0_sel:DWORD src1_sel:WORD_0
    v_lshlrev_b32_sdwa v90, 3, v122 dst_sel:DWORD dst_unused:UNUSED_PAD src0_sel:DWORD src1_sel:WORD_1
    ds_read_b64 v[88:89], v88
    ds_read_b64 v[90:91], v90
    v_mfma_f32_16x16x32_bf16 v[112:115], v[84:87], v[252:255], v[112:115]
    buffer_load_dwordx4 v[84:87], v69, s[12:15], s19 offen offset:1024 sc1
    s_add_u32 s21, s21, 4096
    s_add_u32 s19, s19, 4096
    v_lshlrev_b32_sdwa v92, 3, v123 dst_sel:DWORD dst_unused:UNUSED_PAD src0_sel:DWORD src1_sel:WORD_0
    v_lshlrev_b32_sdwa v94, 3, v123 dst_sel:DWORD dst_unused:UNUSED_PAD src0_sel:DWORD src1_sel:WORD_1
    ds_read_b64 v[92:93], v92
    ds_read_b64 v[94:95], v94
    buffer_load_dwordx4 v[120:123], v69, s[12:15], s20 offen offset:2048 sc1
    s_waitcnt lgkmcnt(9)
    v_smfmac_f32_16x16x64_bf16 v[52:55], v[64:67], v[96:103], v68
    v_cvt_pk_bf16_f32 v112, v112, v113
    v_cvt_pk_bf16_f32 v113, v114, v115
    ds_write_b64 v70, v[112:113] offset:896
    s_add_u32 s23, s23, 1
    s_cmp_eq_u32 s23, 5
    s_cselect_b32 s35, 4294836224, s32
    s_cselect_b32 s23, 0, s23
    v_add_u32 v70, s35, v70
    s_waitcnt vmcnt(6)
    v_lshlrev_b32_sdwa v96, 3, v124 dst_sel:DWORD dst_unused:UNUSED_PAD src0_sel:DWORD src1_sel:WORD_0
    v_lshlrev_b32_sdwa v98, 3, v124 dst_sel:DWORD dst_unused:UNUSED_PAD src0_sel:DWORD src1_sel:WORD_1
    ds_read_b64 v[96:97], v96
    ds_read_b64 v[98:99], v98
    v_lshlrev_b32_sdwa v100, 3, v125 dst_sel:DWORD dst_unused:UNUSED_PAD src0_sel:DWORD src1_sel:WORD_0
    v_lshlrev_b32_sdwa v102, 3, v125 dst_sel:DWORD dst_unused:UNUSED_PAD src0_sel:DWORD src1_sel:WORD_1
    ds_read_b64 v[100:101], v100
    ds_read_b64 v[102:103], v102
    s_waitcnt lgkmcnt(9)
    v_smfmac_f32_16x16x64_bf16 v[56:59], v[64:67], v[104:111], v68
    s_setprio 0
    v_lshlrev_b32_sdwa v104, 3, v126 dst_sel:DWORD dst_unused:UNUSED_PAD src0_sel:DWORD src1_sel:WORD_0
    v_lshlrev_b32_sdwa v106, 3, v126 dst_sel:DWORD dst_unused:UNUSED_PAD src0_sel:DWORD src1_sel:WORD_1
    ds_read_b64 v[104:105], v104
    ds_read_b64 v[106:107], v106
    v_lshlrev_b32_sdwa v108, 3, v127 dst_sel:DWORD dst_unused:UNUSED_PAD src0_sel:DWORD src1_sel:WORD_0
    v_lshlrev_b32_sdwa v110, 3, v127 dst_sel:DWORD dst_unused:UNUSED_PAD src0_sel:DWORD src1_sel:WORD_1
    ds_read_b64 v[108:109], v108
    ds_read_b64 v[110:111], v110
    buffer_load_dwordx4 v[124:127], v69, s[12:15], s20 offen offset:3072 sc1
    s_add_u32 s20, s20, 4096
    s_waitcnt lgkmcnt(9)
    v_smfmac_f32_16x16x64_bf16 v[60:63], v[64:67], v[88:95], v68
    s_waitcnt lgkmcnt(8)
    s_barrier

    s_cmp_eq_u32 s22, 7
    s_cbranch_scc1 standalone__deep_cross_pnn__recsys_kernel_fin

    s_setprio 3
    s_waitcnt vmcnt(6)
    v_lshlrev_b32_sdwa v88, 3, v116 dst_sel:DWORD dst_unused:UNUSED_PAD src0_sel:DWORD src1_sel:WORD_0
    v_lshlrev_b32_sdwa v90, 3, v116 dst_sel:DWORD dst_unused:UNUSED_PAD src0_sel:DWORD src1_sel:WORD_1
    ds_read_b64 v[88:89], v88
    ds_read_b64 v[90:91], v90
    v_lshlrev_b32_sdwa v92, 3, v117 dst_sel:DWORD dst_unused:UNUSED_PAD src0_sel:DWORD src1_sel:WORD_0
    v_lshlrev_b32_sdwa v94, 3, v117 dst_sel:DWORD dst_unused:UNUSED_PAD src0_sel:DWORD src1_sel:WORD_1
    ds_read_b64 v[92:93], v92
    ds_read_b64 v[94:95], v94
    s_waitcnt lgkmcnt(8)
    v_smfmac_f32_16x16x64_bf16 v[0:3], v[64:67], v[96:103], v68
    s_waitcnt vmcnt(5)
    v_mfma_f32_16x16x32_bf16 v[112:115], v[72:75], v[128:131], 0
    v_lshlrev_b32_sdwa v96, 3, v118 dst_sel:DWORD dst_unused:UNUSED_PAD src0_sel:DWORD src1_sel:WORD_0
    v_lshlrev_b32_sdwa v98, 3, v118 dst_sel:DWORD dst_unused:UNUSED_PAD src0_sel:DWORD src1_sel:WORD_1
    ds_read_b64 v[96:97], v96
    ds_read_b64 v[98:99], v98
    s_waitcnt vmcnt(4)
    v_mfma_f32_16x16x32_bf16 v[112:115], v[76:79], v[132:135], v[112:115]
    v_lshlrev_b32_sdwa v100, 3, v119 dst_sel:DWORD dst_unused:UNUSED_PAD src0_sel:DWORD src1_sel:WORD_0
    v_lshlrev_b32_sdwa v102, 3, v119 dst_sel:DWORD dst_unused:UNUSED_PAD src0_sel:DWORD src1_sel:WORD_1
    ds_read_b64 v[100:101], v100
    ds_read_b64 v[102:103], v102
    buffer_load_dwordx4 v[116:119], v69, s[12:15], s20 offen offset:0 sc1
    s_waitcnt lgkmcnt(8)
    v_smfmac_f32_16x16x64_bf16 v[4:7], v[64:67], v[104:111], v68
    s_waitcnt vmcnt(4)
    v_mfma_f32_16x16x32_bf16 v[112:115], v[80:83], v[136:139], v[112:115]
    s_waitcnt vmcnt(2)
    v_lshlrev_b32_sdwa v104, 3, v120 dst_sel:DWORD dst_unused:UNUSED_PAD src0_sel:DWORD src1_sel:WORD_0
    v_lshlrev_b32_sdwa v106, 3, v120 dst_sel:DWORD dst_unused:UNUSED_PAD src0_sel:DWORD src1_sel:WORD_1
    ds_read_b64 v[104:105], v104
    ds_read_b64 v[106:107], v106
    s_waitcnt vmcnt(3)
    v_mfma_f32_16x16x32_bf16 v[112:115], v[84:87], v[140:143], v[112:115]
    v_lshlrev_b32_sdwa v108, 3, v121 dst_sel:DWORD dst_unused:UNUSED_PAD src0_sel:DWORD src1_sel:WORD_0
    v_lshlrev_b32_sdwa v110, 3, v121 dst_sel:DWORD dst_unused:UNUSED_PAD src0_sel:DWORD src1_sel:WORD_1
    ds_read_b64 v[108:109], v108
    ds_read_b64 v[110:111], v110
    s_waitcnt lgkmcnt(8)
    v_smfmac_f32_16x16x64_bf16 v[8:11], v[64:67], v[88:95], v68
    s_nop 1
    v_cvt_pk_bf16_f32 v112, v112, v113
    v_cvt_pk_bf16_f32 v113, v114, v115
    ds_write_b64 v70, v[112:113] offset:0
    v_mfma_f32_16x16x32_bf16 v[112:115], v[72:75], v[144:147], 0
    v_mfma_f32_16x16x32_bf16 v[112:115], v[76:79], v[148:151], v[112:115]
    v_lshlrev_b32_sdwa v88, 3, v122 dst_sel:DWORD dst_unused:UNUSED_PAD src0_sel:DWORD src1_sel:WORD_0
    v_lshlrev_b32_sdwa v90, 3, v122 dst_sel:DWORD dst_unused:UNUSED_PAD src0_sel:DWORD src1_sel:WORD_1
    ds_read_b64 v[88:89], v88
    ds_read_b64 v[90:91], v90
    v_mfma_f32_16x16x32_bf16 v[112:115], v[80:83], v[152:155], v[112:115]
    v_mfma_f32_16x16x32_bf16 v[112:115], v[84:87], v[156:159], v[112:115]
    v_lshlrev_b32_sdwa v92, 3, v123 dst_sel:DWORD dst_unused:UNUSED_PAD src0_sel:DWORD src1_sel:WORD_0
    v_lshlrev_b32_sdwa v94, 3, v123 dst_sel:DWORD dst_unused:UNUSED_PAD src0_sel:DWORD src1_sel:WORD_1
    ds_read_b64 v[92:93], v92
    ds_read_b64 v[94:95], v94
    buffer_load_dwordx4 v[120:123], v69, s[12:15], s20 offen offset:1024 sc1
    s_waitcnt lgkmcnt(9)
    v_smfmac_f32_16x16x64_bf16 v[12:15], v[64:67], v[96:103], v68
    s_nop 0
    v_cvt_pk_bf16_f32 v112, v112, v113
    v_cvt_pk_bf16_f32 v113, v114, v115
    ds_write_b64 v70, v[112:113] offset:128
    v_mfma_f32_16x16x32_bf16 v[112:115], v[72:75], v[160:163], 0
    s_waitcnt vmcnt(2)
    v_lshlrev_b32_sdwa v96, 3, v124 dst_sel:DWORD dst_unused:UNUSED_PAD src0_sel:DWORD src1_sel:WORD_0
    v_lshlrev_b32_sdwa v98, 3, v124 dst_sel:DWORD dst_unused:UNUSED_PAD src0_sel:DWORD src1_sel:WORD_1
    ds_read_b64 v[96:97], v96
    ds_read_b64 v[98:99], v98
    v_mfma_f32_16x16x32_bf16 v[112:115], v[76:79], v[164:167], v[112:115]
    v_lshlrev_b32_sdwa v100, 3, v125 dst_sel:DWORD dst_unused:UNUSED_PAD src0_sel:DWORD src1_sel:WORD_0
    v_lshlrev_b32_sdwa v102, 3, v125 dst_sel:DWORD dst_unused:UNUSED_PAD src0_sel:DWORD src1_sel:WORD_1
    ds_read_b64 v[100:101], v100
    ds_read_b64 v[102:103], v102
    s_waitcnt lgkmcnt(10)
    v_smfmac_f32_16x16x64_bf16 v[16:19], v[64:67], v[104:111], v68
    v_mfma_f32_16x16x32_bf16 v[112:115], v[80:83], v[168:171], v[112:115]
    v_lshlrev_b32_sdwa v104, 3, v126 dst_sel:DWORD dst_unused:UNUSED_PAD src0_sel:DWORD src1_sel:WORD_0
    v_lshlrev_b32_sdwa v106, 3, v126 dst_sel:DWORD dst_unused:UNUSED_PAD src0_sel:DWORD src1_sel:WORD_1
    ds_read_b64 v[104:105], v104
    ds_read_b64 v[106:107], v106
    v_mfma_f32_16x16x32_bf16 v[112:115], v[84:87], v[172:175], v[112:115]
    v_lshlrev_b32_sdwa v108, 3, v127 dst_sel:DWORD dst_unused:UNUSED_PAD src0_sel:DWORD src1_sel:WORD_0
    v_lshlrev_b32_sdwa v110, 3, v127 dst_sel:DWORD dst_unused:UNUSED_PAD src0_sel:DWORD src1_sel:WORD_1
    ds_read_b64 v[108:109], v108
    ds_read_b64 v[110:111], v110
    buffer_load_dwordx4 v[124:127], v69, s[12:15], s20 offen offset:2048 sc1
    s_waitcnt lgkmcnt(9)
    v_smfmac_f32_16x16x64_bf16 v[20:23], v[64:67], v[88:95], v68
    s_nop 0
    v_cvt_pk_bf16_f32 v112, v112, v113
    v_cvt_pk_bf16_f32 v113, v114, v115
    ds_write_b64 v70, v[112:113] offset:256
    v_mfma_f32_16x16x32_bf16 v[112:115], v[72:75], v[176:179], 0
    v_mfma_f32_16x16x32_bf16 v[112:115], v[76:79], v[180:183], v[112:115]
    s_waitcnt vmcnt(2)
    v_lshlrev_b32_sdwa v88, 3, v116 dst_sel:DWORD dst_unused:UNUSED_PAD src0_sel:DWORD src1_sel:WORD_0
    v_lshlrev_b32_sdwa v90, 3, v116 dst_sel:DWORD dst_unused:UNUSED_PAD src0_sel:DWORD src1_sel:WORD_1
    ds_read_b64 v[88:89], v88
    ds_read_b64 v[90:91], v90
    v_mfma_f32_16x16x32_bf16 v[112:115], v[80:83], v[184:187], v[112:115]
    v_mfma_f32_16x16x32_bf16 v[112:115], v[84:87], v[188:191], v[112:115]
    v_lshlrev_b32_sdwa v92, 3, v117 dst_sel:DWORD dst_unused:UNUSED_PAD src0_sel:DWORD src1_sel:WORD_0
    v_lshlrev_b32_sdwa v94, 3, v117 dst_sel:DWORD dst_unused:UNUSED_PAD src0_sel:DWORD src1_sel:WORD_1
    ds_read_b64 v[92:93], v92
    ds_read_b64 v[94:95], v94
    s_waitcnt lgkmcnt(9)
    v_smfmac_f32_16x16x64_bf16 v[24:27], v[64:67], v[96:103], v68
    s_nop 1
    v_cvt_pk_bf16_f32 v112, v112, v113
    v_cvt_pk_bf16_f32 v113, v114, v115
    ds_write_b64 v70, v[112:113] offset:384
    v_mfma_f32_16x16x32_bf16 v[112:115], v[72:75], v[192:195], 0
    v_lshlrev_b32_sdwa v96, 3, v118 dst_sel:DWORD dst_unused:UNUSED_PAD src0_sel:DWORD src1_sel:WORD_0
    v_lshlrev_b32_sdwa v98, 3, v118 dst_sel:DWORD dst_unused:UNUSED_PAD src0_sel:DWORD src1_sel:WORD_1
    ds_read_b64 v[96:97], v96
    ds_read_b64 v[98:99], v98
    v_mfma_f32_16x16x32_bf16 v[112:115], v[76:79], v[196:199], v[112:115]
    v_lshlrev_b32_sdwa v100, 3, v119 dst_sel:DWORD dst_unused:UNUSED_PAD src0_sel:DWORD src1_sel:WORD_0
    v_lshlrev_b32_sdwa v102, 3, v119 dst_sel:DWORD dst_unused:UNUSED_PAD src0_sel:DWORD src1_sel:WORD_1
    ds_read_b64 v[100:101], v100
    ds_read_b64 v[102:103], v102
    buffer_load_dwordx4 v[116:119], v69, s[12:15], s20 offen offset:3072 sc1
    s_add_u32 s20, s20, 61440
    s_waitcnt lgkmcnt(10)
    v_smfmac_f32_16x16x64_bf16 v[28:31], v[64:67], v[104:111], v68
    s_setprio 2
    v_mfma_f32_16x16x32_bf16 v[112:115], v[80:83], v[200:203], v[112:115]
    s_waitcnt vmcnt(2)
    v_lshlrev_b32_sdwa v104, 3, v120 dst_sel:DWORD dst_unused:UNUSED_PAD src0_sel:DWORD src1_sel:WORD_0
    v_lshlrev_b32_sdwa v106, 3, v120 dst_sel:DWORD dst_unused:UNUSED_PAD src0_sel:DWORD src1_sel:WORD_1
    ds_read_b64 v[104:105], v104
    ds_read_b64 v[106:107], v106
    v_mfma_f32_16x16x32_bf16 v[112:115], v[84:87], v[204:207], v[112:115]
    v_lshlrev_b32_sdwa v108, 3, v121 dst_sel:DWORD dst_unused:UNUSED_PAD src0_sel:DWORD src1_sel:WORD_0
    v_lshlrev_b32_sdwa v110, 3, v121 dst_sel:DWORD dst_unused:UNUSED_PAD src0_sel:DWORD src1_sel:WORD_1
    ds_read_b64 v[108:109], v108
    ds_read_b64 v[110:111], v110
    s_waitcnt lgkmcnt(9)
    v_smfmac_f32_16x16x64_bf16 v[32:35], v[64:67], v[88:95], v68
    s_nop 1
    v_cvt_pk_bf16_f32 v112, v112, v113
    v_cvt_pk_bf16_f32 v113, v114, v115
    ds_write_b64 v70, v[112:113] offset:512
    v_mfma_f32_16x16x32_bf16 v[112:115], v[72:75], v[208:211], 0
    v_lshlrev_b32_sdwa v88, 3, v122 dst_sel:DWORD dst_unused:UNUSED_PAD src0_sel:DWORD src1_sel:WORD_0
    v_lshlrev_b32_sdwa v90, 3, v122 dst_sel:DWORD dst_unused:UNUSED_PAD src0_sel:DWORD src1_sel:WORD_1
    ds_read_b64 v[88:89], v88
    ds_read_b64 v[90:91], v90
    v_mfma_f32_16x16x32_bf16 v[112:115], v[76:79], v[212:215], v[112:115]
    v_lshlrev_b32_sdwa v92, 3, v123 dst_sel:DWORD dst_unused:UNUSED_PAD src0_sel:DWORD src1_sel:WORD_0
    v_lshlrev_b32_sdwa v94, 3, v123 dst_sel:DWORD dst_unused:UNUSED_PAD src0_sel:DWORD src1_sel:WORD_1
    ds_read_b64 v[92:93], v92
    ds_read_b64 v[94:95], v94
    buffer_load_dwordx4 v[120:123], v69, s[12:15], s20 offen offset:0 sc1
    s_waitcnt lgkmcnt(9)
    v_smfmac_f32_16x16x64_bf16 v[36:39], v[64:67], v[96:103], v68
    v_mfma_f32_16x16x32_bf16 v[112:115], v[80:83], v[216:219], v[112:115]
    s_waitcnt vmcnt(2)
    v_lshlrev_b32_sdwa v96, 3, v124 dst_sel:DWORD dst_unused:UNUSED_PAD src0_sel:DWORD src1_sel:WORD_0
    v_lshlrev_b32_sdwa v98, 3, v124 dst_sel:DWORD dst_unused:UNUSED_PAD src0_sel:DWORD src1_sel:WORD_1
    ds_read_b64 v[96:97], v96
    ds_read_b64 v[98:99], v98
    v_mfma_f32_16x16x32_bf16 v[112:115], v[84:87], v[220:223], v[112:115]
    v_lshlrev_b32_sdwa v100, 3, v125 dst_sel:DWORD dst_unused:UNUSED_PAD src0_sel:DWORD src1_sel:WORD_0
    v_lshlrev_b32_sdwa v102, 3, v125 dst_sel:DWORD dst_unused:UNUSED_PAD src0_sel:DWORD src1_sel:WORD_1
    ds_read_b64 v[100:101], v100
    ds_read_b64 v[102:103], v102
    s_waitcnt lgkmcnt(9)
    v_smfmac_f32_16x16x64_bf16 v[40:43], v[64:67], v[104:111], v68
    s_nop 1
    v_cvt_pk_bf16_f32 v112, v112, v113
    v_cvt_pk_bf16_f32 v113, v114, v115
    ds_write_b64 v70, v[112:113] offset:640
    v_mfma_f32_16x16x32_bf16 v[112:115], v[72:75], v[224:227], 0
    v_mfma_f32_16x16x32_bf16 v[112:115], v[76:79], v[228:231], v[112:115]
    v_lshlrev_b32_sdwa v104, 3, v126 dst_sel:DWORD dst_unused:UNUSED_PAD src0_sel:DWORD src1_sel:WORD_0
    v_lshlrev_b32_sdwa v106, 3, v126 dst_sel:DWORD dst_unused:UNUSED_PAD src0_sel:DWORD src1_sel:WORD_1
    ds_read_b64 v[104:105], v104
    ds_read_b64 v[106:107], v106
    v_mfma_f32_16x16x32_bf16 v[112:115], v[80:83], v[232:235], v[112:115]
    v_mfma_f32_16x16x32_bf16 v[112:115], v[84:87], v[236:239], v[112:115]
    v_lshlrev_b32_sdwa v108, 3, v127 dst_sel:DWORD dst_unused:UNUSED_PAD src0_sel:DWORD src1_sel:WORD_0
    v_lshlrev_b32_sdwa v110, 3, v127 dst_sel:DWORD dst_unused:UNUSED_PAD src0_sel:DWORD src1_sel:WORD_1
    ds_read_b64 v[108:109], v108
    ds_read_b64 v[110:111], v110
    buffer_load_dwordx4 v[124:127], v69, s[12:15], s20 offen offset:1024 sc1
    s_waitcnt lgkmcnt(9)
    v_smfmac_f32_16x16x64_bf16 v[44:47], v[64:67], v[88:95], v68
    s_nop 0
    v_cvt_pk_bf16_f32 v112, v112, v113
    v_cvt_pk_bf16_f32 v113, v114, v115
    ds_write_b64 v70, v[112:113] offset:768
    s_setprio 1
    v_mfma_f32_16x16x32_bf16 v[112:115], v[72:75], v[240:243], 0
    buffer_load_dwordx4 v[72:75], v69, s[12:15], s21 offen offset:0 sc1
    s_waitcnt vmcnt(3)
    v_lshlrev_b32_sdwa v88, 3, v116 dst_sel:DWORD dst_unused:UNUSED_PAD src0_sel:DWORD src1_sel:WORD_0
    v_lshlrev_b32_sdwa v90, 3, v116 dst_sel:DWORD dst_unused:UNUSED_PAD src0_sel:DWORD src1_sel:WORD_1
    ds_read_b64 v[88:89], v88
    ds_read_b64 v[90:91], v90
    v_mfma_f32_16x16x32_bf16 v[112:115], v[76:79], v[244:247], v[112:115]
    buffer_load_dwordx4 v[76:79], v69, s[12:15], s21 offen offset:1024 sc1
    v_lshlrev_b32_sdwa v92, 3, v117 dst_sel:DWORD dst_unused:UNUSED_PAD src0_sel:DWORD src1_sel:WORD_0
    v_lshlrev_b32_sdwa v94, 3, v117 dst_sel:DWORD dst_unused:UNUSED_PAD src0_sel:DWORD src1_sel:WORD_1
    ds_read_b64 v[92:93], v92
    ds_read_b64 v[94:95], v94
    s_waitcnt lgkmcnt(10)
    v_smfmac_f32_16x16x64_bf16 v[48:51], v[64:67], v[96:103], v68
    v_mfma_f32_16x16x32_bf16 v[112:115], v[80:83], v[248:251], v[112:115]
    buffer_load_dwordx4 v[80:83], v69, s[12:15], s19 offen offset:0 sc1
    v_lshlrev_b32_sdwa v96, 3, v118 dst_sel:DWORD dst_unused:UNUSED_PAD src0_sel:DWORD src1_sel:WORD_0
    v_lshlrev_b32_sdwa v98, 3, v118 dst_sel:DWORD dst_unused:UNUSED_PAD src0_sel:DWORD src1_sel:WORD_1
    ds_read_b64 v[96:97], v96
    ds_read_b64 v[98:99], v98
    v_mfma_f32_16x16x32_bf16 v[112:115], v[84:87], v[252:255], v[112:115]
    buffer_load_dwordx4 v[84:87], v69, s[12:15], s19 offen offset:1024 sc1
    s_add_u32 s21, s21, 4096
    s_add_u32 s19, s19, 4096
    v_lshlrev_b32_sdwa v100, 3, v119 dst_sel:DWORD dst_unused:UNUSED_PAD src0_sel:DWORD src1_sel:WORD_0
    v_lshlrev_b32_sdwa v102, 3, v119 dst_sel:DWORD dst_unused:UNUSED_PAD src0_sel:DWORD src1_sel:WORD_1
    ds_read_b64 v[100:101], v100
    ds_read_b64 v[102:103], v102
    buffer_load_dwordx4 v[116:119], v69, s[12:15], s20 offen offset:2048 sc1
    s_waitcnt lgkmcnt(9)
    v_smfmac_f32_16x16x64_bf16 v[52:55], v[64:67], v[104:111], v68
    v_cvt_pk_bf16_f32 v112, v112, v113
    v_cvt_pk_bf16_f32 v113, v114, v115
    ds_write_b64 v70, v[112:113] offset:896
    s_add_u32 s23, s23, 1
    s_cmp_eq_u32 s23, 5
    s_cselect_b32 s35, 4294836224, s32
    s_cselect_b32 s23, 0, s23
    v_add_u32 v70, s35, v70
    s_waitcnt vmcnt(6)
    v_lshlrev_b32_sdwa v104, 3, v120 dst_sel:DWORD dst_unused:UNUSED_PAD src0_sel:DWORD src1_sel:WORD_0
    v_lshlrev_b32_sdwa v106, 3, v120 dst_sel:DWORD dst_unused:UNUSED_PAD src0_sel:DWORD src1_sel:WORD_1
    ds_read_b64 v[104:105], v104
    ds_read_b64 v[106:107], v106
    v_lshlrev_b32_sdwa v108, 3, v121 dst_sel:DWORD dst_unused:UNUSED_PAD src0_sel:DWORD src1_sel:WORD_0
    v_lshlrev_b32_sdwa v110, 3, v121 dst_sel:DWORD dst_unused:UNUSED_PAD src0_sel:DWORD src1_sel:WORD_1
    ds_read_b64 v[108:109], v108
    ds_read_b64 v[110:111], v110
    s_waitcnt lgkmcnt(9)
    v_smfmac_f32_16x16x64_bf16 v[56:59], v[64:67], v[88:95], v68
    s_setprio 0
    v_lshlrev_b32_sdwa v88, 3, v122 dst_sel:DWORD dst_unused:UNUSED_PAD src0_sel:DWORD src1_sel:WORD_0
    v_lshlrev_b32_sdwa v90, 3, v122 dst_sel:DWORD dst_unused:UNUSED_PAD src0_sel:DWORD src1_sel:WORD_1
    ds_read_b64 v[88:89], v88
    ds_read_b64 v[90:91], v90
    v_lshlrev_b32_sdwa v92, 3, v123 dst_sel:DWORD dst_unused:UNUSED_PAD src0_sel:DWORD src1_sel:WORD_0
    v_lshlrev_b32_sdwa v94, 3, v123 dst_sel:DWORD dst_unused:UNUSED_PAD src0_sel:DWORD src1_sel:WORD_1
    ds_read_b64 v[92:93], v92
    ds_read_b64 v[94:95], v94
    buffer_load_dwordx4 v[120:123], v69, s[12:15], s20 offen offset:3072 sc1
    s_add_u32 s20, s20, 4096
    s_waitcnt lgkmcnt(9)
    v_smfmac_f32_16x16x64_bf16 v[60:63], v[64:67], v[96:103], v68
    s_waitcnt lgkmcnt(8)
    s_barrier
    s_setprio 3
    s_waitcnt vmcnt(6)
    v_lshlrev_b32_sdwa v96, 3, v124 dst_sel:DWORD dst_unused:UNUSED_PAD src0_sel:DWORD src1_sel:WORD_0
    v_lshlrev_b32_sdwa v98, 3, v124 dst_sel:DWORD dst_unused:UNUSED_PAD src0_sel:DWORD src1_sel:WORD_1
    ds_read_b64 v[96:97], v96
    ds_read_b64 v[98:99], v98
    v_lshlrev_b32_sdwa v100, 3, v125 dst_sel:DWORD dst_unused:UNUSED_PAD src0_sel:DWORD src1_sel:WORD_0
    v_lshlrev_b32_sdwa v102, 3, v125 dst_sel:DWORD dst_unused:UNUSED_PAD src0_sel:DWORD src1_sel:WORD_1
    ds_read_b64 v[100:101], v100
    ds_read_b64 v[102:103], v102
    s_waitcnt lgkmcnt(8)
    v_smfmac_f32_16x16x64_bf16 v[0:3], v[64:67], v[104:111], v68
    s_waitcnt vmcnt(5)
    v_mfma_f32_16x16x32_bf16 v[112:115], v[72:75], v[128:131], 0
    v_lshlrev_b32_sdwa v104, 3, v126 dst_sel:DWORD dst_unused:UNUSED_PAD src0_sel:DWORD src1_sel:WORD_0
    v_lshlrev_b32_sdwa v106, 3, v126 dst_sel:DWORD dst_unused:UNUSED_PAD src0_sel:DWORD src1_sel:WORD_1
    ds_read_b64 v[104:105], v104
    ds_read_b64 v[106:107], v106
    s_waitcnt vmcnt(4)
    v_mfma_f32_16x16x32_bf16 v[112:115], v[76:79], v[132:135], v[112:115]
    v_lshlrev_b32_sdwa v108, 3, v127 dst_sel:DWORD dst_unused:UNUSED_PAD src0_sel:DWORD src1_sel:WORD_0
    v_lshlrev_b32_sdwa v110, 3, v127 dst_sel:DWORD dst_unused:UNUSED_PAD src0_sel:DWORD src1_sel:WORD_1
    ds_read_b64 v[108:109], v108
    ds_read_b64 v[110:111], v110
    buffer_load_dwordx4 v[124:127], v69, s[12:15], s20 offen offset:0 sc1
    s_waitcnt lgkmcnt(8)
    v_smfmac_f32_16x16x64_bf16 v[4:7], v[64:67], v[88:95], v68
    s_waitcnt vmcnt(4)
    v_mfma_f32_16x16x32_bf16 v[112:115], v[80:83], v[136:139], v[112:115]
    s_waitcnt vmcnt(2)
    v_lshlrev_b32_sdwa v88, 3, v116 dst_sel:DWORD dst_unused:UNUSED_PAD src0_sel:DWORD src1_sel:WORD_0
    v_lshlrev_b32_sdwa v90, 3, v116 dst_sel:DWORD dst_unused:UNUSED_PAD src0_sel:DWORD src1_sel:WORD_1
    ds_read_b64 v[88:89], v88
    ds_read_b64 v[90:91], v90
    s_waitcnt vmcnt(3)
    v_mfma_f32_16x16x32_bf16 v[112:115], v[84:87], v[140:143], v[112:115]
    v_lshlrev_b32_sdwa v92, 3, v117 dst_sel:DWORD dst_unused:UNUSED_PAD src0_sel:DWORD src1_sel:WORD_0
    v_lshlrev_b32_sdwa v94, 3, v117 dst_sel:DWORD dst_unused:UNUSED_PAD src0_sel:DWORD src1_sel:WORD_1
    ds_read_b64 v[92:93], v92
    ds_read_b64 v[94:95], v94
    s_waitcnt lgkmcnt(8)
    v_smfmac_f32_16x16x64_bf16 v[8:11], v[64:67], v[96:103], v68
    s_nop 1
    v_cvt_pk_bf16_f32 v112, v112, v113
    v_cvt_pk_bf16_f32 v113, v114, v115
    ds_write_b64 v70, v[112:113] offset:0
    v_mfma_f32_16x16x32_bf16 v[112:115], v[72:75], v[144:147], 0
    v_mfma_f32_16x16x32_bf16 v[112:115], v[76:79], v[148:151], v[112:115]
    v_lshlrev_b32_sdwa v96, 3, v118 dst_sel:DWORD dst_unused:UNUSED_PAD src0_sel:DWORD src1_sel:WORD_0
    v_lshlrev_b32_sdwa v98, 3, v118 dst_sel:DWORD dst_unused:UNUSED_PAD src0_sel:DWORD src1_sel:WORD_1
    ds_read_b64 v[96:97], v96
    ds_read_b64 v[98:99], v98
    v_mfma_f32_16x16x32_bf16 v[112:115], v[80:83], v[152:155], v[112:115]
    v_mfma_f32_16x16x32_bf16 v[112:115], v[84:87], v[156:159], v[112:115]
    v_lshlrev_b32_sdwa v100, 3, v119 dst_sel:DWORD dst_unused:UNUSED_PAD src0_sel:DWORD src1_sel:WORD_0
    v_lshlrev_b32_sdwa v102, 3, v119 dst_sel:DWORD dst_unused:UNUSED_PAD src0_sel:DWORD src1_sel:WORD_1
    ds_read_b64 v[100:101], v100
    ds_read_b64 v[102:103], v102
    buffer_load_dwordx4 v[116:119], v69, s[12:15], s20 offen offset:1024 sc1
    s_waitcnt lgkmcnt(9)
    v_smfmac_f32_16x16x64_bf16 v[12:15], v[64:67], v[104:111], v68
    s_nop 0
    v_cvt_pk_bf16_f32 v112, v112, v113
    v_cvt_pk_bf16_f32 v113, v114, v115
    ds_write_b64 v70, v[112:113] offset:128
    v_mfma_f32_16x16x32_bf16 v[112:115], v[72:75], v[160:163], 0
    s_waitcnt vmcnt(2)
    v_lshlrev_b32_sdwa v104, 3, v120 dst_sel:DWORD dst_unused:UNUSED_PAD src0_sel:DWORD src1_sel:WORD_0
    v_lshlrev_b32_sdwa v106, 3, v120 dst_sel:DWORD dst_unused:UNUSED_PAD src0_sel:DWORD src1_sel:WORD_1
    ds_read_b64 v[104:105], v104
    ds_read_b64 v[106:107], v106
    v_mfma_f32_16x16x32_bf16 v[112:115], v[76:79], v[164:167], v[112:115]
    v_lshlrev_b32_sdwa v108, 3, v121 dst_sel:DWORD dst_unused:UNUSED_PAD src0_sel:DWORD src1_sel:WORD_0
    v_lshlrev_b32_sdwa v110, 3, v121 dst_sel:DWORD dst_unused:UNUSED_PAD src0_sel:DWORD src1_sel:WORD_1
    ds_read_b64 v[108:109], v108
    ds_read_b64 v[110:111], v110
    s_waitcnt lgkmcnt(10)
    v_smfmac_f32_16x16x64_bf16 v[16:19], v[64:67], v[88:95], v68
    v_mfma_f32_16x16x32_bf16 v[112:115], v[80:83], v[168:171], v[112:115]
    v_lshlrev_b32_sdwa v88, 3, v122 dst_sel:DWORD dst_unused:UNUSED_PAD src0_sel:DWORD src1_sel:WORD_0
    v_lshlrev_b32_sdwa v90, 3, v122 dst_sel:DWORD dst_unused:UNUSED_PAD src0_sel:DWORD src1_sel:WORD_1
    ds_read_b64 v[88:89], v88
    ds_read_b64 v[90:91], v90
    v_mfma_f32_16x16x32_bf16 v[112:115], v[84:87], v[172:175], v[112:115]
    v_lshlrev_b32_sdwa v92, 3, v123 dst_sel:DWORD dst_unused:UNUSED_PAD src0_sel:DWORD src1_sel:WORD_0
    v_lshlrev_b32_sdwa v94, 3, v123 dst_sel:DWORD dst_unused:UNUSED_PAD src0_sel:DWORD src1_sel:WORD_1
    ds_read_b64 v[92:93], v92
    ds_read_b64 v[94:95], v94
    buffer_load_dwordx4 v[120:123], v69, s[12:15], s20 offen offset:2048 sc1
    s_waitcnt lgkmcnt(9)
    v_smfmac_f32_16x16x64_bf16 v[20:23], v[64:67], v[96:103], v68
    s_nop 0
    v_cvt_pk_bf16_f32 v112, v112, v113
    v_cvt_pk_bf16_f32 v113, v114, v115
    ds_write_b64 v70, v[112:113] offset:256
    v_mfma_f32_16x16x32_bf16 v[112:115], v[72:75], v[176:179], 0
    v_mfma_f32_16x16x32_bf16 v[112:115], v[76:79], v[180:183], v[112:115]
    s_waitcnt vmcnt(2)
    v_lshlrev_b32_sdwa v96, 3, v124 dst_sel:DWORD dst_unused:UNUSED_PAD src0_sel:DWORD src1_sel:WORD_0
    v_lshlrev_b32_sdwa v98, 3, v124 dst_sel:DWORD dst_unused:UNUSED_PAD src0_sel:DWORD src1_sel:WORD_1
    ds_read_b64 v[96:97], v96
    ds_read_b64 v[98:99], v98
    v_mfma_f32_16x16x32_bf16 v[112:115], v[80:83], v[184:187], v[112:115]
    v_mfma_f32_16x16x32_bf16 v[112:115], v[84:87], v[188:191], v[112:115]
    v_lshlrev_b32_sdwa v100, 3, v125 dst_sel:DWORD dst_unused:UNUSED_PAD src0_sel:DWORD src1_sel:WORD_0
    v_lshlrev_b32_sdwa v102, 3, v125 dst_sel:DWORD dst_unused:UNUSED_PAD src0_sel:DWORD src1_sel:WORD_1
    ds_read_b64 v[100:101], v100
    ds_read_b64 v[102:103], v102
    s_waitcnt lgkmcnt(9)
    v_smfmac_f32_16x16x64_bf16 v[24:27], v[64:67], v[104:111], v68
    s_nop 1
    v_cvt_pk_bf16_f32 v112, v112, v113
    v_cvt_pk_bf16_f32 v113, v114, v115
    ds_write_b64 v70, v[112:113] offset:384
    v_mfma_f32_16x16x32_bf16 v[112:115], v[72:75], v[192:195], 0
    v_lshlrev_b32_sdwa v104, 3, v126 dst_sel:DWORD dst_unused:UNUSED_PAD src0_sel:DWORD src1_sel:WORD_0
    v_lshlrev_b32_sdwa v106, 3, v126 dst_sel:DWORD dst_unused:UNUSED_PAD src0_sel:DWORD src1_sel:WORD_1
    ds_read_b64 v[104:105], v104
    ds_read_b64 v[106:107], v106
    v_mfma_f32_16x16x32_bf16 v[112:115], v[76:79], v[196:199], v[112:115]
    v_lshlrev_b32_sdwa v108, 3, v127 dst_sel:DWORD dst_unused:UNUSED_PAD src0_sel:DWORD src1_sel:WORD_0
    v_lshlrev_b32_sdwa v110, 3, v127 dst_sel:DWORD dst_unused:UNUSED_PAD src0_sel:DWORD src1_sel:WORD_1
    ds_read_b64 v[108:109], v108
    ds_read_b64 v[110:111], v110
    buffer_load_dwordx4 v[124:127], v69, s[12:15], s20 offen offset:3072 sc1
    s_add_u32 s20, s20, 61440
    s_waitcnt lgkmcnt(10)
    v_smfmac_f32_16x16x64_bf16 v[28:31], v[64:67], v[88:95], v68
    s_setprio 2
    v_mfma_f32_16x16x32_bf16 v[112:115], v[80:83], v[200:203], v[112:115]
    s_waitcnt vmcnt(2)
    v_lshlrev_b32_sdwa v88, 3, v116 dst_sel:DWORD dst_unused:UNUSED_PAD src0_sel:DWORD src1_sel:WORD_0
    v_lshlrev_b32_sdwa v90, 3, v116 dst_sel:DWORD dst_unused:UNUSED_PAD src0_sel:DWORD src1_sel:WORD_1
    ds_read_b64 v[88:89], v88
    ds_read_b64 v[90:91], v90
    v_mfma_f32_16x16x32_bf16 v[112:115], v[84:87], v[204:207], v[112:115]
    v_lshlrev_b32_sdwa v92, 3, v117 dst_sel:DWORD dst_unused:UNUSED_PAD src0_sel:DWORD src1_sel:WORD_0
    v_lshlrev_b32_sdwa v94, 3, v117 dst_sel:DWORD dst_unused:UNUSED_PAD src0_sel:DWORD src1_sel:WORD_1
    ds_read_b64 v[92:93], v92
    ds_read_b64 v[94:95], v94
    s_waitcnt lgkmcnt(9)
    v_smfmac_f32_16x16x64_bf16 v[32:35], v[64:67], v[96:103], v68
    s_nop 1
    v_cvt_pk_bf16_f32 v112, v112, v113
    v_cvt_pk_bf16_f32 v113, v114, v115
    ds_write_b64 v70, v[112:113] offset:512
    v_mfma_f32_16x16x32_bf16 v[112:115], v[72:75], v[208:211], 0
    v_lshlrev_b32_sdwa v96, 3, v118 dst_sel:DWORD dst_unused:UNUSED_PAD src0_sel:DWORD src1_sel:WORD_0
    v_lshlrev_b32_sdwa v98, 3, v118 dst_sel:DWORD dst_unused:UNUSED_PAD src0_sel:DWORD src1_sel:WORD_1
    ds_read_b64 v[96:97], v96
    ds_read_b64 v[98:99], v98
    v_mfma_f32_16x16x32_bf16 v[112:115], v[76:79], v[212:215], v[112:115]
    v_lshlrev_b32_sdwa v100, 3, v119 dst_sel:DWORD dst_unused:UNUSED_PAD src0_sel:DWORD src1_sel:WORD_0
    v_lshlrev_b32_sdwa v102, 3, v119 dst_sel:DWORD dst_unused:UNUSED_PAD src0_sel:DWORD src1_sel:WORD_1
    ds_read_b64 v[100:101], v100
    ds_read_b64 v[102:103], v102
    buffer_load_dwordx4 v[116:119], v69, s[12:15], s20 offen offset:0 sc1
    s_waitcnt lgkmcnt(9)
    v_smfmac_f32_16x16x64_bf16 v[36:39], v[64:67], v[104:111], v68
    v_mfma_f32_16x16x32_bf16 v[112:115], v[80:83], v[216:219], v[112:115]
    s_waitcnt vmcnt(2)
    v_lshlrev_b32_sdwa v104, 3, v120 dst_sel:DWORD dst_unused:UNUSED_PAD src0_sel:DWORD src1_sel:WORD_0
    v_lshlrev_b32_sdwa v106, 3, v120 dst_sel:DWORD dst_unused:UNUSED_PAD src0_sel:DWORD src1_sel:WORD_1
    ds_read_b64 v[104:105], v104
    ds_read_b64 v[106:107], v106
    v_mfma_f32_16x16x32_bf16 v[112:115], v[84:87], v[220:223], v[112:115]
    v_lshlrev_b32_sdwa v108, 3, v121 dst_sel:DWORD dst_unused:UNUSED_PAD src0_sel:DWORD src1_sel:WORD_0
    v_lshlrev_b32_sdwa v110, 3, v121 dst_sel:DWORD dst_unused:UNUSED_PAD src0_sel:DWORD src1_sel:WORD_1
    ds_read_b64 v[108:109], v108
    ds_read_b64 v[110:111], v110
    s_waitcnt lgkmcnt(9)
    v_smfmac_f32_16x16x64_bf16 v[40:43], v[64:67], v[88:95], v68
    s_nop 1
    v_cvt_pk_bf16_f32 v112, v112, v113
    v_cvt_pk_bf16_f32 v113, v114, v115
    ds_write_b64 v70, v[112:113] offset:640
    v_mfma_f32_16x16x32_bf16 v[112:115], v[72:75], v[224:227], 0
    v_mfma_f32_16x16x32_bf16 v[112:115], v[76:79], v[228:231], v[112:115]
    v_lshlrev_b32_sdwa v88, 3, v122 dst_sel:DWORD dst_unused:UNUSED_PAD src0_sel:DWORD src1_sel:WORD_0
    v_lshlrev_b32_sdwa v90, 3, v122 dst_sel:DWORD dst_unused:UNUSED_PAD src0_sel:DWORD src1_sel:WORD_1
    ds_read_b64 v[88:89], v88
    ds_read_b64 v[90:91], v90
    v_mfma_f32_16x16x32_bf16 v[112:115], v[80:83], v[232:235], v[112:115]
    v_mfma_f32_16x16x32_bf16 v[112:115], v[84:87], v[236:239], v[112:115]
    v_lshlrev_b32_sdwa v92, 3, v123 dst_sel:DWORD dst_unused:UNUSED_PAD src0_sel:DWORD src1_sel:WORD_0
    v_lshlrev_b32_sdwa v94, 3, v123 dst_sel:DWORD dst_unused:UNUSED_PAD src0_sel:DWORD src1_sel:WORD_1
    ds_read_b64 v[92:93], v92
    ds_read_b64 v[94:95], v94
    buffer_load_dwordx4 v[120:123], v69, s[12:15], s20 offen offset:1024 sc1
    s_waitcnt lgkmcnt(9)
    v_smfmac_f32_16x16x64_bf16 v[44:47], v[64:67], v[96:103], v68
    s_nop 0
    v_cvt_pk_bf16_f32 v112, v112, v113
    v_cvt_pk_bf16_f32 v113, v114, v115
    ds_write_b64 v70, v[112:113] offset:768
    s_setprio 1
    v_mfma_f32_16x16x32_bf16 v[112:115], v[72:75], v[240:243], 0
    buffer_load_dwordx4 v[72:75], v69, s[12:15], s21 offen offset:0 sc1
    s_waitcnt vmcnt(3)
    v_lshlrev_b32_sdwa v96, 3, v124 dst_sel:DWORD dst_unused:UNUSED_PAD src0_sel:DWORD src1_sel:WORD_0
    v_lshlrev_b32_sdwa v98, 3, v124 dst_sel:DWORD dst_unused:UNUSED_PAD src0_sel:DWORD src1_sel:WORD_1
    ds_read_b64 v[96:97], v96
    ds_read_b64 v[98:99], v98
    v_mfma_f32_16x16x32_bf16 v[112:115], v[76:79], v[244:247], v[112:115]
    buffer_load_dwordx4 v[76:79], v69, s[12:15], s21 offen offset:1024 sc1
    v_lshlrev_b32_sdwa v100, 3, v125 dst_sel:DWORD dst_unused:UNUSED_PAD src0_sel:DWORD src1_sel:WORD_0
    v_lshlrev_b32_sdwa v102, 3, v125 dst_sel:DWORD dst_unused:UNUSED_PAD src0_sel:DWORD src1_sel:WORD_1
    ds_read_b64 v[100:101], v100
    ds_read_b64 v[102:103], v102
    s_waitcnt lgkmcnt(10)
    v_smfmac_f32_16x16x64_bf16 v[48:51], v[64:67], v[104:111], v68
    v_mfma_f32_16x16x32_bf16 v[112:115], v[80:83], v[248:251], v[112:115]
    buffer_load_dwordx4 v[80:83], v69, s[12:15], s19 offen offset:0 sc1
    v_lshlrev_b32_sdwa v104, 3, v126 dst_sel:DWORD dst_unused:UNUSED_PAD src0_sel:DWORD src1_sel:WORD_0
    v_lshlrev_b32_sdwa v106, 3, v126 dst_sel:DWORD dst_unused:UNUSED_PAD src0_sel:DWORD src1_sel:WORD_1
    ds_read_b64 v[104:105], v104
    ds_read_b64 v[106:107], v106
    v_mfma_f32_16x16x32_bf16 v[112:115], v[84:87], v[252:255], v[112:115]
    buffer_load_dwordx4 v[84:87], v69, s[12:15], s19 offen offset:1024 sc1
    s_add_u32 s21, s21, 4096
    s_add_u32 s19, s19, 4096
    v_lshlrev_b32_sdwa v108, 3, v127 dst_sel:DWORD dst_unused:UNUSED_PAD src0_sel:DWORD src1_sel:WORD_0
    v_lshlrev_b32_sdwa v110, 3, v127 dst_sel:DWORD dst_unused:UNUSED_PAD src0_sel:DWORD src1_sel:WORD_1
    ds_read_b64 v[108:109], v108
    ds_read_b64 v[110:111], v110
    buffer_load_dwordx4 v[124:127], v69, s[12:15], s20 offen offset:2048 sc1
    s_waitcnt lgkmcnt(9)
    v_smfmac_f32_16x16x64_bf16 v[52:55], v[64:67], v[88:95], v68
    v_cvt_pk_bf16_f32 v112, v112, v113
    v_cvt_pk_bf16_f32 v113, v114, v115
    ds_write_b64 v70, v[112:113] offset:896
    s_add_u32 s23, s23, 1
    s_cmp_eq_u32 s23, 5
    s_cselect_b32 s35, 4294836224, s32
    s_cselect_b32 s23, 0, s23
    v_add_u32 v70, s35, v70
    s_waitcnt vmcnt(6)
    v_lshlrev_b32_sdwa v88, 3, v116 dst_sel:DWORD dst_unused:UNUSED_PAD src0_sel:DWORD src1_sel:WORD_0
    v_lshlrev_b32_sdwa v90, 3, v116 dst_sel:DWORD dst_unused:UNUSED_PAD src0_sel:DWORD src1_sel:WORD_1
    ds_read_b64 v[88:89], v88
    ds_read_b64 v[90:91], v90
    v_lshlrev_b32_sdwa v92, 3, v117 dst_sel:DWORD dst_unused:UNUSED_PAD src0_sel:DWORD src1_sel:WORD_0
    v_lshlrev_b32_sdwa v94, 3, v117 dst_sel:DWORD dst_unused:UNUSED_PAD src0_sel:DWORD src1_sel:WORD_1
    ds_read_b64 v[92:93], v92
    ds_read_b64 v[94:95], v94
    s_waitcnt lgkmcnt(9)
    v_smfmac_f32_16x16x64_bf16 v[56:59], v[64:67], v[96:103], v68
    s_setprio 0
    v_lshlrev_b32_sdwa v96, 3, v118 dst_sel:DWORD dst_unused:UNUSED_PAD src0_sel:DWORD src1_sel:WORD_0
    v_lshlrev_b32_sdwa v98, 3, v118 dst_sel:DWORD dst_unused:UNUSED_PAD src0_sel:DWORD src1_sel:WORD_1
    ds_read_b64 v[96:97], v96
    ds_read_b64 v[98:99], v98
    v_lshlrev_b32_sdwa v100, 3, v119 dst_sel:DWORD dst_unused:UNUSED_PAD src0_sel:DWORD src1_sel:WORD_0
    v_lshlrev_b32_sdwa v102, 3, v119 dst_sel:DWORD dst_unused:UNUSED_PAD src0_sel:DWORD src1_sel:WORD_1
    ds_read_b64 v[100:101], v100
    ds_read_b64 v[102:103], v102
    buffer_load_dwordx4 v[116:119], v69, s[12:15], s20 offen offset:3072 sc1
    s_add_u32 s20, s20, 4096
    s_waitcnt lgkmcnt(9)
    v_smfmac_f32_16x16x64_bf16 v[60:63], v[64:67], v[104:111], v68
    s_waitcnt lgkmcnt(8)
    s_barrier

    s_add_u32 s22, s22, 1
    s_branch standalone__deep_cross_pnn__recsys_kernel_gloop

standalone__deep_cross_pnn__recsys_kernel_fin:

    s_add_u32 s40, s20, 61440
    s_add_u32 s41, s20, 65536
    s_add_u32 s44, s20, 126976
    s_add_u32 s45, s20, 131072

    s_lshl_b32 s28, s38, 16
    s_and_b32 s29, s38, 0xffff0000
    s_lshl_b32 s30, s39, 16
    s_and_b32 s31, s39, 0xffff0000
    s_lshl_b32 s35, s33, 16
    s_lshl_b32 s42, s34, 15
    s_add_u32 s35, s35, s42
    s_lshl_b32 s42, s3, 12
    s_add_u32 s35, s35, s42
    s_add_u32 s35, s35, 20971520

    s_setprio 3
    v_mov_b32 v128, 0xbdd2d3e8
    v_mov_b32 v129, 0xbdd2d3e8
    v_mov_b32 v130, 0xc0135761
    v_mov_b32 v131, 0xc0135761
    v_mov_b32 v132, 1.0
    v_mov_b32 v133, 1.0
    v_mov_b32 v134, s28
    v_mov_b32 v135, s29
    s_waitcnt vmcnt(6)
    v_lshlrev_b32_sdwa v88, 3, v116 dst_sel:DWORD dst_unused:UNUSED_PAD src0_sel:DWORD src1_sel:WORD_0
    v_lshlrev_b32_sdwa v90, 3, v116 dst_sel:DWORD dst_unused:UNUSED_PAD src0_sel:DWORD src1_sel:WORD_1
    ds_read_b64 v[88:89], v88
    ds_read_b64 v[90:91], v90
    v_lshlrev_b32_sdwa v92, 3, v117 dst_sel:DWORD dst_unused:UNUSED_PAD src0_sel:DWORD src1_sel:WORD_0
    v_lshlrev_b32_sdwa v94, 3, v117 dst_sel:DWORD dst_unused:UNUSED_PAD src0_sel:DWORD src1_sel:WORD_1
    ds_read_b64 v[92:93], v92
    ds_read_b64 v[94:95], v94
    s_waitcnt lgkmcnt(8)
    v_smfmac_f32_16x16x64_bf16 v[0:3], v[64:67], v[96:103], v68
    v_mov_b32 v136, s30
    v_mov_b32 v137, s31
    v_lshrrev_b32 v70, 2, v69
    v_and_b32 v71, 128, v70
    v_add_u32 v70, v70, v71
    v_rcp_f32 v134, v134
    v_rcp_f32 v135, v135
    v_rcp_f32 v136, v136
    v_lshlrev_b32_sdwa v96, 3, v118 dst_sel:DWORD dst_unused:UNUSED_PAD src0_sel:DWORD src1_sel:WORD_0
    v_lshlrev_b32_sdwa v98, 3, v118 dst_sel:DWORD dst_unused:UNUSED_PAD src0_sel:DWORD src1_sel:WORD_1
    ds_read_b64 v[96:97], v96
    ds_read_b64 v[98:99], v98
    v_lshlrev_b32_sdwa v100, 3, v119 dst_sel:DWORD dst_unused:UNUSED_PAD src0_sel:DWORD src1_sel:WORD_0
    v_lshlrev_b32_sdwa v102, 3, v119 dst_sel:DWORD dst_unused:UNUSED_PAD src0_sel:DWORD src1_sel:WORD_1
    ds_read_b64 v[100:101], v100
    ds_read_b64 v[102:103], v102
    buffer_load_dwordx4 v[116:119], v69, s[12:15], s40 offen offset:0 sc1
    s_waitcnt lgkmcnt(8)
    v_smfmac_f32_16x16x64_bf16 v[4:7], v[64:67], v[104:111], v68
    v_rcp_f32 v137, v137
    v_mov_b32 v132, 0x7f7fffff
    v_mov_b32 v133, 0xff7fffff
    v_med3_f32 v134, v134, v132, v133
    v_med3_f32 v135, v135, v132, v133
    v_med3_f32 v136, v136, v132, v133
    v_med3_f32 v137, v137, v132, v133
    s_waitcnt vmcnt(2)
    v_lshlrev_b32_sdwa v104, 3, v120 dst_sel:DWORD dst_unused:UNUSED_PAD src0_sel:DWORD src1_sel:WORD_0
    v_lshlrev_b32_sdwa v106, 3, v120 dst_sel:DWORD dst_unused:UNUSED_PAD src0_sel:DWORD src1_sel:WORD_1
    ds_read_b64 v[104:105], v104
    ds_read_b64 v[106:107], v106
    v_lshlrev_b32_sdwa v108, 3, v121 dst_sel:DWORD dst_unused:UNUSED_PAD src0_sel:DWORD src1_sel:WORD_0
    v_lshlrev_b32_sdwa v110, 3, v121 dst_sel:DWORD dst_unused:UNUSED_PAD src0_sel:DWORD src1_sel:WORD_1
    ds_read_b64 v[108:109], v108
    ds_read_b64 v[110:111], v110
    s_waitcnt lgkmcnt(8)
    v_smfmac_f32_16x16x64_bf16 v[8:11], v[64:67], v[88:95], v68
    v_lshlrev_b32_sdwa v88, 3, v122 dst_sel:DWORD dst_unused:UNUSED_PAD src0_sel:DWORD src1_sel:WORD_0
    v_lshlrev_b32_sdwa v90, 3, v122 dst_sel:DWORD dst_unused:UNUSED_PAD src0_sel:DWORD src1_sel:WORD_1
    ds_read_b64 v[88:89], v88
    ds_read_b64 v[90:91], v90
    v_lshlrev_b32_sdwa v92, 3, v123 dst_sel:DWORD dst_unused:UNUSED_PAD src0_sel:DWORD src1_sel:WORD_0
    v_lshlrev_b32_sdwa v94, 3, v123 dst_sel:DWORD dst_unused:UNUSED_PAD src0_sel:DWORD src1_sel:WORD_1
    ds_read_b64 v[92:93], v92
    ds_read_b64 v[94:95], v94
    buffer_load_dwordx4 v[120:123], v69, s[12:15], s44 offen offset:0 sc1
    s_waitcnt lgkmcnt(8)
    v_smfmac_f32_16x16x64_bf16 v[12:15], v[64:67], v[96:103], v68
    s_waitcnt vmcnt(2)
    v_lshlrev_b32_sdwa v96, 3, v124 dst_sel:DWORD dst_unused:UNUSED_PAD src0_sel:DWORD src1_sel:WORD_0
    v_lshlrev_b32_sdwa v98, 3, v124 dst_sel:DWORD dst_unused:UNUSED_PAD src0_sel:DWORD src1_sel:WORD_1
    ds_read_b64 v[96:97], v96
    ds_read_b64 v[98:99], v98
    v_lshlrev_b32_sdwa v100, 3, v125 dst_sel:DWORD dst_unused:UNUSED_PAD src0_sel:DWORD src1_sel:WORD_0
    v_lshlrev_b32_sdwa v102, 3, v125 dst_sel:DWORD dst_unused:UNUSED_PAD src0_sel:DWORD src1_sel:WORD_1
    ds_read_b64 v[100:101], v100
    ds_read_b64 v[102:103], v102
    s_waitcnt lgkmcnt(8)
    v_smfmac_f32_16x16x64_bf16 v[16:19], v[64:67], v[104:111], v68
    v_lshlrev_b32_sdwa v104, 3, v126 dst_sel:DWORD dst_unused:UNUSED_PAD src0_sel:DWORD src1_sel:WORD_0
    v_lshlrev_b32_sdwa v106, 3, v126 dst_sel:DWORD dst_unused:UNUSED_PAD src0_sel:DWORD src1_sel:WORD_1
    ds_read_b64 v[104:105], v104
    ds_read_b64 v[106:107], v106
    v_lshlrev_b32_sdwa v108, 3, v127 dst_sel:DWORD dst_unused:UNUSED_PAD src0_sel:DWORD src1_sel:WORD_0
    v_lshlrev_b32_sdwa v110, 3, v127 dst_sel:DWORD dst_unused:UNUSED_PAD src0_sel:DWORD src1_sel:WORD_1
    ds_read_b64 v[108:109], v108
    ds_read_b64 v[110:111], v110
    buffer_load_dwordx4 v[124:127], v69, s[12:15], s40 offen offset:1024 sc1
    s_waitcnt lgkmcnt(8)
    v_smfmac_f32_16x16x64_bf16 v[20:23], v[64:67], v[88:95], v68
    s_waitcnt vmcnt(2)
    v_lshlrev_b32_sdwa v88, 3, v116 dst_sel:DWORD dst_unused:UNUSED_PAD src0_sel:DWORD src1_sel:WORD_0
    v_lshlrev_b32_sdwa v90, 3, v116 dst_sel:DWORD dst_unused:UNUSED_PAD src0_sel:DWORD src1_sel:WORD_1
    ds_read_b64 v[88:89], v88
    ds_read_b64 v[90:91], v90
    v_lshlrev_b32_sdwa v92, 3, v117 dst_sel:DWORD dst_unused:UNUSED_PAD src0_sel:DWORD src1_sel:WORD_0
    v_lshlrev_b32_sdwa v94, 3, v117 dst_sel:DWORD dst_unused:UNUSED_PAD src0_sel:DWORD src1_sel:WORD_1
    ds_read_b64 v[92:93], v92
    ds_read_b64 v[94:95], v94
    s_waitcnt lgkmcnt(8)
    v_smfmac_f32_16x16x64_bf16 v[24:27], v[64:67], v[96:103], v68
    v_lshlrev_b32_sdwa v96, 3, v118 dst_sel:DWORD dst_unused:UNUSED_PAD src0_sel:DWORD src1_sel:WORD_0
    v_lshlrev_b32_sdwa v98, 3, v118 dst_sel:DWORD dst_unused:UNUSED_PAD src0_sel:DWORD src1_sel:WORD_1
    ds_read_b64 v[96:97], v96
    ds_read_b64 v[98:99], v98
    v_lshlrev_b32_sdwa v100, 3, v119 dst_sel:DWORD dst_unused:UNUSED_PAD src0_sel:DWORD src1_sel:WORD_0
    v_lshlrev_b32_sdwa v102, 3, v119 dst_sel:DWORD dst_unused:UNUSED_PAD src0_sel:DWORD src1_sel:WORD_1
    ds_read_b64 v[100:101], v100
    ds_read_b64 v[102:103], v102
    buffer_load_dwordx4 v[116:119], v69, s[12:15], s44 offen offset:1024 sc1
    s_waitcnt lgkmcnt(8)
    v_smfmac_f32_16x16x64_bf16 v[28:31], v[64:67], v[104:111], v68
    s_waitcnt vmcnt(2)
    v_lshlrev_b32_sdwa v104, 3, v120 dst_sel:DWORD dst_unused:UNUSED_PAD src0_sel:DWORD src1_sel:WORD_0
    v_lshlrev_b32_sdwa v106, 3, v120 dst_sel:DWORD dst_unused:UNUSED_PAD src0_sel:DWORD src1_sel:WORD_1
    ds_read_b64 v[104:105], v104
    ds_read_b64 v[106:107], v106
    v_lshlrev_b32_sdwa v108, 3, v121 dst_sel:DWORD dst_unused:UNUSED_PAD src0_sel:DWORD src1_sel:WORD_0
    v_lshlrev_b32_sdwa v110, 3, v121 dst_sel:DWORD dst_unused:UNUSED_PAD src0_sel:DWORD src1_sel:WORD_1
    ds_read_b64 v[108:109], v108
    ds_read_b64 v[110:111], v110
    s_waitcnt lgkmcnt(8)
    v_smfmac_f32_16x16x64_bf16 v[0:3], v[64:67], v[88:95], v68
    v_lshlrev_b32_sdwa v88, 3, v122 dst_sel:DWORD dst_unused:UNUSED_PAD src0_sel:DWORD src1_sel:WORD_0
    v_lshlrev_b32_sdwa v90, 3, v122 dst_sel:DWORD dst_unused:UNUSED_PAD src0_sel:DWORD src1_sel:WORD_1
    ds_read_b64 v[88:89], v88
    ds_read_b64 v[90:91], v90
    v_lshlrev_b32_sdwa v92, 3, v123 dst_sel:DWORD dst_unused:UNUSED_PAD src0_sel:DWORD src1_sel:WORD_0
    v_lshlrev_b32_sdwa v94, 3, v123 dst_sel:DWORD dst_unused:UNUSED_PAD src0_sel:DWORD src1_sel:WORD_1
    ds_read_b64 v[92:93], v92
    ds_read_b64 v[94:95], v94
    buffer_load_dwordx4 v[120:123], v69, s[12:15], s40 offen offset:2048 sc1
    s_waitcnt lgkmcnt(8)
    v_smfmac_f32_16x16x64_bf16 v[4:7], v[64:67], v[96:103], v68
    s_waitcnt vmcnt(2)
    v_lshlrev_b32_sdwa v96, 3, v124 dst_sel:DWORD dst_unused:UNUSED_PAD src0_sel:DWORD src1_sel:WORD_0
    v_lshlrev_b32_sdwa v98, 3, v124 dst_sel:DWORD dst_unused:UNUSED_PAD src0_sel:DWORD src1_sel:WORD_1
    ds_read_b64 v[96:97], v96
    ds_read_b64 v[98:99], v98
    v_lshlrev_b32_sdwa v100, 3, v125 dst_sel:DWORD dst_unused:UNUSED_PAD src0_sel:DWORD src1_sel:WORD_0
    v_lshlrev_b32_sdwa v102, 3, v125 dst_sel:DWORD dst_unused:UNUSED_PAD src0_sel:DWORD src1_sel:WORD_1
    ds_read_b64 v[100:101], v100
    ds_read_b64 v[102:103], v102
    s_waitcnt lgkmcnt(8)
    v_smfmac_f32_16x16x64_bf16 v[0:3], v[64:67], v[104:111], v68
    v_lshlrev_b32_sdwa v104, 3, v126 dst_sel:DWORD dst_unused:UNUSED_PAD src0_sel:DWORD src1_sel:WORD_0
    v_lshlrev_b32_sdwa v106, 3, v126 dst_sel:DWORD dst_unused:UNUSED_PAD src0_sel:DWORD src1_sel:WORD_1
    ds_read_b64 v[104:105], v104
    ds_read_b64 v[106:107], v106
    v_lshlrev_b32_sdwa v108, 3, v127 dst_sel:DWORD dst_unused:UNUSED_PAD src0_sel:DWORD src1_sel:WORD_0
    v_lshlrev_b32_sdwa v110, 3, v127 dst_sel:DWORD dst_unused:UNUSED_PAD src0_sel:DWORD src1_sel:WORD_1
    ds_read_b64 v[108:109], v108
    ds_read_b64 v[110:111], v110
    buffer_load_dwordx4 v[124:127], v69, s[12:15], s44 offen offset:2048 sc1
    s_waitcnt lgkmcnt(8)
    v_smfmac_f32_16x16x64_bf16 v[4:7], v[64:67], v[88:95], v68
    s_waitcnt vmcnt(2)
    v_lshlrev_b32_sdwa v88, 3, v116 dst_sel:DWORD dst_unused:UNUSED_PAD src0_sel:DWORD src1_sel:WORD_0
    v_lshlrev_b32_sdwa v90, 3, v116 dst_sel:DWORD dst_unused:UNUSED_PAD src0_sel:DWORD src1_sel:WORD_1
    ds_read_b64 v[88:89], v88
    ds_read_b64 v[90:91], v90
    v_lshlrev_b32_sdwa v92, 3, v117 dst_sel:DWORD dst_unused:UNUSED_PAD src0_sel:DWORD src1_sel:WORD_0
    v_lshlrev_b32_sdwa v94, 3, v117 dst_sel:DWORD dst_unused:UNUSED_PAD src0_sel:DWORD src1_sel:WORD_1
    ds_read_b64 v[92:93], v92
    ds_read_b64 v[94:95], v94
    s_waitcnt lgkmcnt(8)
    v_smfmac_f32_16x16x64_bf16 v[8:11], v[64:67], v[96:103], v68
    v_pk_mul_f32 v[140:141], v[0:1], v[0:1]
    v_pk_mul_f32 v[142:143], v[2:3], v[2:3]
    v_pk_fma_f32 v[140:141], v[140:141], v[128:129], v[130:131]
    v_pk_fma_f32 v[142:143], v[142:143], v[128:129], v[130:131]
    v_pk_mul_f32 v[140:141], v[140:141], v[0:1]
    v_pk_mul_f32 v[142:143], v[142:143], v[2:3]
    v_exp_f32 v140, v140
    v_pk_mul_f32 v[146:147], v[4:5], v[4:5]
    v_lshlrev_b32_sdwa v96, 3, v118 dst_sel:DWORD dst_unused:UNUSED_PAD src0_sel:DWORD src1_sel:WORD_0
    v_lshlrev_b32_sdwa v98, 3, v118 dst_sel:DWORD dst_unused:UNUSED_PAD src0_sel:DWORD src1_sel:WORD_1
    ds_read_b64 v[96:97], v96
    ds_read_b64 v[98:99], v98
    v_lshlrev_b32_sdwa v100, 3, v119 dst_sel:DWORD dst_unused:UNUSED_PAD src0_sel:DWORD src1_sel:WORD_0
    v_lshlrev_b32_sdwa v102, 3, v119 dst_sel:DWORD dst_unused:UNUSED_PAD src0_sel:DWORD src1_sel:WORD_1
    ds_read_b64 v[100:101], v100
    ds_read_b64 v[102:103], v102
    buffer_load_dwordx4 v[116:119], v69, s[12:15], s40 offen offset:3072 sc1
    s_waitcnt lgkmcnt(8)
    v_smfmac_f32_16x16x64_bf16 v[12:15], v[64:67], v[104:111], v68
    v_exp_f32 v141, v141
    v_pk_fma_f32 v[146:147], v[146:147], v[128:129], v[130:131]
    v_pk_mul_f32 v[148:149], v[6:7], v[6:7]
    v_exp_f32 v142, v142
    v_pk_fma_f32 v[140:141], v[140:141], v[134:135], v[134:135]
    v_pk_mul_f32 v[146:147], v[146:147], v[4:5]
    v_rcp_f32 v140, v140
    v_pk_fma_f32 v[148:149], v[148:149], v[128:129], v[130:131]
    s_waitcnt vmcnt(2)
    v_lshlrev_b32_sdwa v104, 3, v120 dst_sel:DWORD dst_unused:UNUSED_PAD src0_sel:DWORD src1_sel:WORD_0
    v_lshlrev_b32_sdwa v106, 3, v120 dst_sel:DWORD dst_unused:UNUSED_PAD src0_sel:DWORD src1_sel:WORD_1
    ds_read_b64 v[104:105], v104
    ds_read_b64 v[106:107], v106
    v_lshlrev_b32_sdwa v108, 3, v121 dst_sel:DWORD dst_unused:UNUSED_PAD src0_sel:DWORD src1_sel:WORD_0
    v_lshlrev_b32_sdwa v110, 3, v121 dst_sel:DWORD dst_unused:UNUSED_PAD src0_sel:DWORD src1_sel:WORD_1
    ds_read_b64 v[108:109], v108
    ds_read_b64 v[110:111], v110
    s_waitcnt lgkmcnt(8)
    v_smfmac_f32_16x16x64_bf16 v[8:11], v[64:67], v[88:95], v68
    v_rcp_f32 v141, v141
    v_pk_mul_f32 v[148:149], v[148:149], v[6:7]
    v_exp_f32 v143, v143
    v_pk_mul_f32 v[144:145], v[0:1], v[140:141]
    v_exp_f32 v146, v146
    v_pk_fma_f32 v[142:143], v[142:143], v[136:137], v[136:137]
    v_exp_f32 v147, v147
    v_rcp_f32 v142, v142
    v_lshlrev_b32_sdwa v88, 3, v122 dst_sel:DWORD dst_unused:UNUSED_PAD src0_sel:DWORD src1_sel:WORD_0
    v_lshlrev_b32_sdwa v90, 3, v122 dst_sel:DWORD dst_unused:UNUSED_PAD src0_sel:DWORD src1_sel:WORD_1
    ds_read_b64 v[88:89], v88
    ds_read_b64 v[90:91], v90
    v_lshlrev_b32_sdwa v92, 3, v123 dst_sel:DWORD dst_unused:UNUSED_PAD src0_sel:DWORD src1_sel:WORD_0
    v_lshlrev_b32_sdwa v94, 3, v123 dst_sel:DWORD dst_unused:UNUSED_PAD src0_sel:DWORD src1_sel:WORD_1
    ds_read_b64 v[92:93], v92
    ds_read_b64 v[94:95], v94
    buffer_load_dwordx4 v[120:123], v69, s[12:15], s44 offen offset:3072 sc1
    s_waitcnt lgkmcnt(8)
    v_smfmac_f32_16x16x64_bf16 v[12:15], v[64:67], v[96:103], v68
    v_rcp_f32 v143, v143
    v_pk_fma_f32 v[146:147], v[146:147], v[134:135], v[134:135]
    v_pk_mul_f32 v[152:153], v[8:9], v[8:9]
    v_rcp_f32 v146, v146
    v_pk_fma_f32 v[144:145], v[2:3], v[142:143], v[144:145]
    v_pk_fma_f32 v[152:153], v[152:153], v[128:129], v[130:131]
    v_rcp_f32 v147, v147
    v_add_f32 v144, v144, v145
    s_waitcnt vmcnt(2)
    v_lshlrev_b32_sdwa v96, 3, v124 dst_sel:DWORD dst_unused:UNUSED_PAD src0_sel:DWORD src1_sel:WORD_0
    v_lshlrev_b32_sdwa v98, 3, v124 dst_sel:DWORD dst_unused:UNUSED_PAD src0_sel:DWORD src1_sel:WORD_1
    ds_read_b64 v[96:97], v96
    ds_read_b64 v[98:99], v98
    v_lshlrev_b32_sdwa v100, 3, v125 dst_sel:DWORD dst_unused:UNUSED_PAD src0_sel:DWORD src1_sel:WORD_0
    v_lshlrev_b32_sdwa v102, 3, v125 dst_sel:DWORD dst_unused:UNUSED_PAD src0_sel:DWORD src1_sel:WORD_1
    ds_read_b64 v[100:101], v100
    ds_read_b64 v[102:103], v102
    s_waitcnt lgkmcnt(8)
    v_smfmac_f32_16x16x64_bf16 v[16:19], v[64:67], v[104:111], v68
    v_exp_f32 v148, v148
    buffer_store_dword v144, v70, s[12:15], s35 offen offset:0 sc1
    v_pk_mul_f32 v[150:151], v[4:5], v[146:147]
    v_exp_f32 v149, v149
    v_pk_mul_f32 v[152:153], v[152:153], v[8:9]
    v_pk_mul_f32 v[154:155], v[10:11], v[10:11]
    v_exp_f32 v152, v152
    v_pk_fma_f32 v[148:149], v[148:149], v[136:137], v[136:137]
    v_lshlrev_b32_sdwa v104, 3, v126 dst_sel:DWORD dst_unused:UNUSED_PAD src0_sel:DWORD src1_sel:WORD_0
    v_lshlrev_b32_sdwa v106, 3, v126 dst_sel:DWORD dst_unused:UNUSED_PAD src0_sel:DWORD src1_sel:WORD_1
    ds_read_b64 v[104:105], v104
    ds_read_b64 v[106:107], v106
    v_lshlrev_b32_sdwa v108, 3, v127 dst_sel:DWORD dst_unused:UNUSED_PAD src0_sel:DWORD src1_sel:WORD_0
    v_lshlrev_b32_sdwa v110, 3, v127 dst_sel:DWORD dst_unused:UNUSED_PAD src0_sel:DWORD src1_sel:WORD_1
    ds_read_b64 v[108:109], v108
    ds_read_b64 v[110:111], v110
    buffer_load_dwordx4 v[124:127], v69, s[12:15], s20 offen offset:0 sc1
    s_waitcnt lgkmcnt(8)
    v_smfmac_f32_16x16x64_bf16 v[20:23], v[64:67], v[88:95], v68
    v_rcp_f32 v148, v148
    v_pk_fma_f32 v[154:155], v[154:155], v[128:129], v[130:131]
    v_pk_mul_f32 v[158:159], v[12:13], v[12:13]
    v_rcp_f32 v149, v149
    v_pk_mul_f32 v[154:155], v[154:155], v[10:11]
    v_pk_fma_f32 v[158:159], v[158:159], v[128:129], v[130:131]
    v_exp_f32 v153, v153
    v_pk_fma_f32 v[150:151], v[6:7], v[148:149], v[150:151]
    s_waitcnt vmcnt(3)
    v_lshlrev_b32_sdwa v88, 3, v116 dst_sel:DWORD dst_unused:UNUSED_PAD src0_sel:DWORD src1_sel:WORD_0
    v_lshlrev_b32_sdwa v90, 3, v116 dst_sel:DWORD dst_unused:UNUSED_PAD src0_sel:DWORD src1_sel:WORD_1
    ds_read_b64 v[88:89], v88
    ds_read_b64 v[90:91], v90
    v_lshlrev_b32_sdwa v92, 3, v117 dst_sel:DWORD dst_unused:UNUSED_PAD src0_sel:DWORD src1_sel:WORD_0
    v_lshlrev_b32_sdwa v94, 3, v117 dst_sel:DWORD dst_unused:UNUSED_PAD src0_sel:DWORD src1_sel:WORD_1
    ds_read_b64 v[92:93], v92
    ds_read_b64 v[94:95], v94
    s_waitcnt lgkmcnt(8)
    v_smfmac_f32_16x16x64_bf16 v[16:19], v[64:67], v[96:103], v68
    v_exp_f32 v154, v154
    v_add_f32 v150, v150, v151
    v_pk_fma_f32 v[152:153], v[152:153], v[134:135], v[134:135]
    v_exp_f32 v155, v155
    buffer_store_dword v150, v70, s[12:15], s35 offen offset:128 sc1
    v_pk_mul_f32 v[158:159], v[158:159], v[12:13]
    v_rcp_f32 v152, v152
    v_pk_fma_f32 v[154:155], v[154:155], v[136:137], v[136:137]
    v_lshlrev_b32_sdwa v96, 3, v118 dst_sel:DWORD dst_unused:UNUSED_PAD src0_sel:DWORD src1_sel:WORD_0
    v_lshlrev_b32_sdwa v98, 3, v118 dst_sel:DWORD dst_unused:UNUSED_PAD src0_sel:DWORD src1_sel:WORD_1
    ds_read_b64 v[96:97], v96
    ds_read_b64 v[98:99], v98
    v_lshlrev_b32_sdwa v100, 3, v119 dst_sel:DWORD dst_unused:UNUSED_PAD src0_sel:DWORD src1_sel:WORD_0
    v_lshlrev_b32_sdwa v102, 3, v119 dst_sel:DWORD dst_unused:UNUSED_PAD src0_sel:DWORD src1_sel:WORD_1
    ds_read_b64 v[100:101], v100
    ds_read_b64 v[102:103], v102
    buffer_load_dwordx4 v[116:119], v69, s[12:15], s41 offen offset:0 sc1
    s_waitcnt lgkmcnt(8)
    v_smfmac_f32_16x16x64_bf16 v[20:23], v[64:67], v[104:111], v68
    v_rcp_f32 v153, v153
    v_pk_mul_f32 v[160:161], v[14:15], v[14:15]
    v_pk_mul_f32 v[164:165], v[16:17], v[16:17]
    v_rcp_f32 v154, v154
    v_pk_mul_f32 v[156:157], v[8:9], v[152:153]
    v_pk_fma_f32 v[160:161], v[160:161], v[128:129], v[130:131]
    v_rcp_f32 v155, v155
    v_pk_mul_f32 v[160:161], v[160:161], v[14:15]
    s_waitcnt vmcnt(4)
    v_lshlrev_b32_sdwa v104, 3, v120 dst_sel:DWORD dst_unused:UNUSED_PAD src0_sel:DWORD src1_sel:WORD_0
    v_lshlrev_b32_sdwa v106, 3, v120 dst_sel:DWORD dst_unused:UNUSED_PAD src0_sel:DWORD src1_sel:WORD_1
    ds_read_b64 v[104:105], v104
    ds_read_b64 v[106:107], v106
    v_lshlrev_b32_sdwa v108, 3, v121 dst_sel:DWORD dst_unused:UNUSED_PAD src0_sel:DWORD src1_sel:WORD_0
    v_lshlrev_b32_sdwa v110, 3, v121 dst_sel:DWORD dst_unused:UNUSED_PAD src0_sel:DWORD src1_sel:WORD_1
    ds_read_b64 v[108:109], v108
    ds_read_b64 v[110:111], v110
    s_waitcnt lgkmcnt(8)
    v_smfmac_f32_16x16x64_bf16 v[24:27], v[64:67], v[88:95], v68
    v_exp_f32 v158, v158
    v_pk_fma_f32 v[156:157], v[10:11], v[154:155], v[156:157]
    v_pk_fma_f32 v[164:165], v[164:165], v[128:129], v[130:131]
    v_exp_f32 v159, v159
    v_add_f32 v156, v156, v157
    v_pk_mul_f32 v[164:165], v[164:165], v[16:17]
    v_exp_f32 v160, v160
    buffer_store_dword v156, v70, s[12:15], s35 offen offset:512 sc1
    v_lshlrev_b32_sdwa v88, 3, v122 dst_sel:DWORD dst_unused:UNUSED_PAD src0_sel:DWORD src1_sel:WORD_0
    v_lshlrev_b32_sdwa v90, 3, v122 dst_sel:DWORD dst_unused:UNUSED_PAD src0_sel:DWORD src1_sel:WORD_1
    ds_read_b64 v[88:89], v88
    ds_read_b64 v[90:91], v90
    v_lshlrev_b32_sdwa v92, 3, v123 dst_sel:DWORD dst_unused:UNUSED_PAD src0_sel:DWORD src1_sel:WORD_0
    v_lshlrev_b32_sdwa v94, 3, v123 dst_sel:DWORD dst_unused:UNUSED_PAD src0_sel:DWORD src1_sel:WORD_1
    ds_read_b64 v[92:93], v92
    ds_read_b64 v[94:95], v94
    buffer_load_dwordx4 v[120:123], v69, s[12:15], s45 offen offset:0 sc1
    s_waitcnt lgkmcnt(8)
    v_smfmac_f32_16x16x64_bf16 v[28:31], v[64:67], v[96:103], v68
    v_exp_f32 v161, v161
    v_pk_fma_f32 v[158:159], v[158:159], v[134:135], v[134:135]
    v_pk_mul_f32 v[166:167], v[18:19], v[18:19]
    v_rcp_f32 v158, v158
    v_pk_fma_f32 v[160:161], v[160:161], v[136:137], v[136:137]
    v_pk_fma_f32 v[166:167], v[166:167], v[128:129], v[130:131]
    v_rcp_f32 v159, v159
    v_pk_mul_f32 v[166:167], v[166:167], v[18:19]
    s_waitcnt vmcnt(4)
    v_lshlrev_b32_sdwa v96, 3, v124 dst_sel:DWORD dst_unused:UNUSED_PAD src0_sel:DWORD src1_sel:WORD_0
    v_lshlrev_b32_sdwa v98, 3, v124 dst_sel:DWORD dst_unused:UNUSED_PAD src0_sel:DWORD src1_sel:WORD_1
    ds_read_b64 v[96:97], v96
    ds_read_b64 v[98:99], v98
    v_lshlrev_b32_sdwa v100, 3, v125 dst_sel:DWORD dst_unused:UNUSED_PAD src0_sel:DWORD src1_sel:WORD_0
    v_lshlrev_b32_sdwa v102, 3, v125 dst_sel:DWORD dst_unused:UNUSED_PAD src0_sel:DWORD src1_sel:WORD_1
    ds_read_b64 v[100:101], v100
    ds_read_b64 v[102:103], v102
    s_waitcnt lgkmcnt(8)
    v_smfmac_f32_16x16x64_bf16 v[24:27], v[64:67], v[104:111], v68
    v_rcp_f32 v160, v160
    v_pk_mul_f32 v[162:163], v[12:13], v[158:159]
    v_pk_mul_f32 v[170:171], v[20:21], v[20:21]
    v_rcp_f32 v161, v161
    v_pk_fma_f32 v[170:171], v[170:171], v[128:129], v[130:131]
    v_pk_mul_f32 v[172:173], v[22:23], v[22:23]
    v_exp_f32 v164, v164
    v_pk_fma_f32 v[162:163], v[14:15], v[160:161], v[162:163]
    v_lshlrev_b32_sdwa v104, 3, v126 dst_sel:DWORD dst_unused:UNUSED_PAD src0_sel:DWORD src1_sel:WORD_0
    v_lshlrev_b32_sdwa v106, 3, v126 dst_sel:DWORD dst_unused:UNUSED_PAD src0_sel:DWORD src1_sel:WORD_1
    ds_read_b64 v[104:105], v104
    ds_read_b64 v[106:107], v106
    v_lshlrev_b32_sdwa v108, 3, v127 dst_sel:DWORD dst_unused:UNUSED_PAD src0_sel:DWORD src1_sel:WORD_0
    v_lshlrev_b32_sdwa v110, 3, v127 dst_sel:DWORD dst_unused:UNUSED_PAD src0_sel:DWORD src1_sel:WORD_1
    ds_read_b64 v[108:109], v108
    ds_read_b64 v[110:111], v110
    buffer_load_dwordx4 v[124:127], v69, s[12:15], s20 offen offset:1024 sc1
    s_waitcnt lgkmcnt(8)
    v_smfmac_f32_16x16x64_bf16 v[28:31], v[64:67], v[88:95], v68
    s_setprio 2
    v_exp_f32 v165, v165
    v_add_f32 v162, v162, v163
    v_pk_mul_f32 v[170:171], v[170:171], v[20:21]
    v_exp_f32 v166, v166
    buffer_store_dword v162, v70, s[12:15], s35 offen offset:640 sc1
    v_pk_fma_f32 v[164:165], v[164:165], v[134:135], v[134:135]
    v_exp_f32 v167, v167
    v_pk_fma_f32 v[172:173], v[172:173], v[128:129], v[130:131]
    s_waitcnt vmcnt(4)
    v_lshlrev_b32_sdwa v88, 3, v116 dst_sel:DWORD dst_unused:UNUSED_PAD src0_sel:DWORD src1_sel:WORD_0
    v_lshlrev_b32_sdwa v90, 3, v116 dst_sel:DWORD dst_unused:UNUSED_PAD src0_sel:DWORD src1_sel:WORD_1
    ds_read_b64 v[88:89], v88
    ds_read_b64 v[90:91], v90
    v_lshlrev_b32_sdwa v92, 3, v117 dst_sel:DWORD dst_unused:UNUSED_PAD src0_sel:DWORD src1_sel:WORD_0
    v_lshlrev_b32_sdwa v94, 3, v117 dst_sel:DWORD dst_unused:UNUSED_PAD src0_sel:DWORD src1_sel:WORD_1
    ds_read_b64 v[92:93], v92
    ds_read_b64 v[94:95], v94
    s_waitcnt lgkmcnt(8)
    v_smfmac_f32_16x16x64_bf16 v[32:35], v[64:67], v[96:103], v68
    v_rcp_f32 v164, v164
    v_pk_fma_f32 v[166:167], v[166:167], v[136:137], v[136:137]
    v_pk_mul_f32 v[172:173], v[172:173], v[22:23]
    v_rcp_f32 v165, v165
    v_pk_mul_f32 v[140:141], v[24:25], v[24:25]
    v_pk_mul_f32 v[142:143], v[26:27], v[26:27]
    v_rcp_f32 v166, v166
    v_pk_mul_f32 v[168:169], v[16:17], v[164:165]
    v_lshlrev_b32_sdwa v96, 3, v118 dst_sel:DWORD dst_unused:UNUSED_PAD src0_sel:DWORD src1_sel:WORD_0
    v_lshlrev_b32_sdwa v98, 3, v118 dst_sel:DWORD dst_unused:UNUSED_PAD src0_sel:DWORD src1_sel:WORD_1
    ds_read_b64 v[96:97], v96
    ds_read_b64 v[98:99], v98
    v_lshlrev_b32_sdwa v100, 3, v119 dst_sel:DWORD dst_unused:UNUSED_PAD src0_sel:DWORD src1_sel:WORD_0
    v_lshlrev_b32_sdwa v102, 3, v119 dst_sel:DWORD dst_unused:UNUSED_PAD src0_sel:DWORD src1_sel:WORD_1
    ds_read_b64 v[100:101], v100
    ds_read_b64 v[102:103], v102
    buffer_load_dwordx4 v[116:119], v69, s[12:15], s41 offen offset:1024 sc1
    s_waitcnt lgkmcnt(8)
    v_smfmac_f32_16x16x64_bf16 v[36:39], v[64:67], v[104:111], v68
    v_rcp_f32 v167, v167
    v_pk_fma_f32 v[140:141], v[140:141], v[128:129], v[130:131]
    v_pk_fma_f32 v[142:143], v[142:143], v[128:129], v[130:131]
    v_exp_f32 v170, v170
    v_pk_fma_f32 v[168:169], v[18:19], v[166:167], v[168:169]
    v_pk_mul_f32 v[140:141], v[140:141], v[24:25]
    v_exp_f32 v171, v171
    v_add_f32 v168, v168, v169
    s_waitcnt vmcnt(3)
    v_lshlrev_b32_sdwa v104, 3, v120 dst_sel:DWORD dst_unused:UNUSED_PAD src0_sel:DWORD src1_sel:WORD_0
    v_lshlrev_b32_sdwa v106, 3, v120 dst_sel:DWORD dst_unused:UNUSED_PAD src0_sel:DWORD src1_sel:WORD_1
    ds_read_b64 v[104:105], v104
    ds_read_b64 v[106:107], v106
    v_lshlrev_b32_sdwa v108, 3, v121 dst_sel:DWORD dst_unused:UNUSED_PAD src0_sel:DWORD src1_sel:WORD_0
    v_lshlrev_b32_sdwa v110, 3, v121 dst_sel:DWORD dst_unused:UNUSED_PAD src0_sel:DWORD src1_sel:WORD_1
    ds_read_b64 v[108:109], v108
    ds_read_b64 v[110:111], v110
    s_waitcnt lgkmcnt(8)
    v_smfmac_f32_16x16x64_bf16 v[32:35], v[64:67], v[88:95], v68
    v_exp_f32 v172, v172
    buffer_store_dword v168, v70, s[12:15], s35 offen offset:1024 sc1
    v_pk_fma_f32 v[170:171], v[170:171], v[134:135], v[134:135]
    v_exp_f32 v173, v173
    v_pk_mul_f32 v[142:143], v[142:143], v[26:27]
    v_pk_mul_f32 v[146:147], v[28:29], v[28:29]
    v_rcp_f32 v170, v170
    v_pk_fma_f32 v[172:173], v[172:173], v[136:137], v[136:137]
    v_lshlrev_b32_sdwa v88, 3, v122 dst_sel:DWORD dst_unused:UNUSED_PAD src0_sel:DWORD src1_sel:WORD_0
    v_lshlrev_b32_sdwa v90, 3, v122 dst_sel:DWORD dst_unused:UNUSED_PAD src0_sel:DWORD src1_sel:WORD_1
    ds_read_b64 v[88:89], v88
    ds_read_b64 v[90:91], v90
    v_lshlrev_b32_sdwa v92, 3, v123 dst_sel:DWORD dst_unused:UNUSED_PAD src0_sel:DWORD src1_sel:WORD_0
    v_lshlrev_b32_sdwa v94, 3, v123 dst_sel:DWORD dst_unused:UNUSED_PAD src0_sel:DWORD src1_sel:WORD_1
    ds_read_b64 v[92:93], v92
    ds_read_b64 v[94:95], v94
    buffer_load_dwordx4 v[120:123], v69, s[12:15], s45 offen offset:1024 sc1
    s_waitcnt lgkmcnt(8)
    v_smfmac_f32_16x16x64_bf16 v[36:39], v[64:67], v[96:103], v68
    v_rcp_f32 v171, v171
    v_pk_fma_f32 v[146:147], v[146:147], v[128:129], v[130:131]
    v_pk_mul_f32 v[148:149], v[30:31], v[30:31]
    v_rcp_f32 v172, v172
    v_pk_mul_f32 v[174:175], v[20:21], v[170:171]
    v_pk_mul_f32 v[146:147], v[146:147], v[28:29]
    v_rcp_f32 v173, v173
    v_pk_fma_f32 v[148:149], v[148:149], v[128:129], v[130:131]
    s_waitcnt vmcnt(4)
    v_lshlrev_b32_sdwa v96, 3, v124 dst_sel:DWORD dst_unused:UNUSED_PAD src0_sel:DWORD src1_sel:WORD_0
    v_lshlrev_b32_sdwa v98, 3, v124 dst_sel:DWORD dst_unused:UNUSED_PAD src0_sel:DWORD src1_sel:WORD_1
    ds_read_b64 v[96:97], v96
    ds_read_b64 v[98:99], v98
    v_lshlrev_b32_sdwa v100, 3, v125 dst_sel:DWORD dst_unused:UNUSED_PAD src0_sel:DWORD src1_sel:WORD_0
    v_lshlrev_b32_sdwa v102, 3, v125 dst_sel:DWORD dst_unused:UNUSED_PAD src0_sel:DWORD src1_sel:WORD_1
    ds_read_b64 v[100:101], v100
    ds_read_b64 v[102:103], v102
    s_waitcnt lgkmcnt(8)
    v_smfmac_f32_16x16x64_bf16 v[32:35], v[64:67], v[104:111], v68
    v_exp_f32 v140, v140
    v_pk_fma_f32 v[174:175], v[22:23], v[172:173], v[174:175]
    v_pk_mul_f32 v[148:149], v[148:149], v[30:31]
    v_exp_f32 v141, v141
    v_add_f32 v174, v174, v175
    v_exp_f32 v142, v142
    buffer_store_dword v174, v70, s[12:15], s35 offen offset:1152 sc1
    v_pk_fma_f32 v[140:141], v[140:141], v[134:135], v[134:135]
    v_lshlrev_b32_sdwa v104, 3, v126 dst_sel:DWORD dst_unused:UNUSED_PAD src0_sel:DWORD src1_sel:WORD_0
    v_lshlrev_b32_sdwa v106, 3, v126 dst_sel:DWORD dst_unused:UNUSED_PAD src0_sel:DWORD src1_sel:WORD_1
    ds_read_b64 v[104:105], v104
    ds_read_b64 v[106:107], v106
    v_lshlrev_b32_sdwa v108, 3, v127 dst_sel:DWORD dst_unused:UNUSED_PAD src0_sel:DWORD src1_sel:WORD_0
    v_lshlrev_b32_sdwa v110, 3, v127 dst_sel:DWORD dst_unused:UNUSED_PAD src0_sel:DWORD src1_sel:WORD_1
    ds_read_b64 v[108:109], v108
    ds_read_b64 v[110:111], v110
    buffer_load_dwordx4 v[124:127], v69, s[12:15], s20 offen offset:2048 sc1
    s_waitcnt lgkmcnt(8)
    v_smfmac_f32_16x16x64_bf16 v[36:39], v[64:67], v[88:95], v68
    v_rcp_f32 v140, v140
    v_pk_mul_f32 v[152:153], v[32:33], v[32:33]
    v_pk_mul_f32 v[154:155], v[34:35], v[34:35]
    v_rcp_f32 v141, v141
    v_pk_fma_f32 v[152:153], v[152:153], v[128:129], v[130:131]
    v_pk_fma_f32 v[154:155], v[154:155], v[128:129], v[130:131]
    v_exp_f32 v143, v143
    v_pk_mul_f32 v[144:145], v[24:25], v[140:141]
    s_waitcnt vmcnt(4)
    v_lshlrev_b32_sdwa v88, 3, v116 dst_sel:DWORD dst_unused:UNUSED_PAD src0_sel:DWORD src1_sel:WORD_0
    v_lshlrev_b32_sdwa v90, 3, v116 dst_sel:DWORD dst_unused:UNUSED_PAD src0_sel:DWORD src1_sel:WORD_1
    ds_read_b64 v[88:89], v88
    ds_read_b64 v[90:91], v90
    v_lshlrev_b32_sdwa v92, 3, v117 dst_sel:DWORD dst_unused:UNUSED_PAD src0_sel:DWORD src1_sel:WORD_0
    v_lshlrev_b32_sdwa v94, 3, v117 dst_sel:DWORD dst_unused:UNUSED_PAD src0_sel:DWORD src1_sel:WORD_1
    ds_read_b64 v[92:93], v92
    ds_read_b64 v[94:95], v94
    s_waitcnt lgkmcnt(8)
    v_smfmac_f32_16x16x64_bf16 v[40:43], v[64:67], v[96:103], v68
    v_exp_f32 v146, v146
    v_pk_fma_f32 v[142:143], v[142:143], v[136:137], v[136:137]
    v_pk_mul_f32 v[152:153], v[152:153], v[32:33]
    v_rcp_f32 v142, v142
    v_pk_mul_f32 v[154:155], v[154:155], v[34:35]
    v_pk_mul_f32 v[158:159], v[36:37], v[36:37]
    v_rcp_f32 v143, v143
    v_pk_fma_f32 v[158:159], v[158:159], v[128:129], v[130:131]
    v_lshlrev_b32_sdwa v96, 3, v118 dst_sel:DWORD dst_unused:UNUSED_PAD src0_sel:DWORD src1_sel:WORD_0
    v_lshlrev_b32_sdwa v98, 3, v118 dst_sel:DWORD dst_unused:UNUSED_PAD src0_sel:DWORD src1_sel:WORD_1
    ds_read_b64 v[96:97], v96
    ds_read_b64 v[98:99], v98
    v_lshlrev_b32_sdwa v100, 3, v119 dst_sel:DWORD dst_unused:UNUSED_PAD src0_sel:DWORD src1_sel:WORD_0
    v_lshlrev_b32_sdwa v102, 3, v119 dst_sel:DWORD dst_unused:UNUSED_PAD src0_sel:DWORD src1_sel:WORD_1
    ds_read_b64 v[100:101], v100
    ds_read_b64 v[102:103], v102
    buffer_load_dwordx4 v[116:119], v69, s[12:15], s41 offen offset:2048 sc1
    s_waitcnt lgkmcnt(8)
    v_smfmac_f32_16x16x64_bf16 v[44:47], v[64:67], v[104:111], v68
    v_exp_f32 v147, v147
    v_pk_fma_f32 v[144:145], v[26:27], v[142:143], v[144:145]
    v_pk_mul_f32 v[158:159], v[158:159], v[36:37]
    v_exp_f32 v148, v148
    v_add_f32 v144, v144, v145
    v_pk_fma_f32 v[146:147], v[146:147], v[134:135], v[134:135]
    v_exp_f32 v149, v149
    buffer_store_dword v144, v70, s[12:15], s35 offen offset:1536 sc1
    s_waitcnt vmcnt(4)
    v_lshlrev_b32_sdwa v104, 3, v120 dst_sel:DWORD dst_unused:UNUSED_PAD src0_sel:DWORD src1_sel:WORD_0
    v_lshlrev_b32_sdwa v106, 3, v120 dst_sel:DWORD dst_unused:UNUSED_PAD src0_sel:DWORD src1_sel:WORD_1
    ds_read_b64 v[104:105], v104
    ds_read_b64 v[106:107], v106
    v_lshlrev_b32_sdwa v108, 3, v121 dst_sel:DWORD dst_unused:UNUSED_PAD src0_sel:DWORD src1_sel:WORD_0
    v_lshlrev_b32_sdwa v110, 3, v121 dst_sel:DWORD dst_unused:UNUSED_PAD src0_sel:DWORD src1_sel:WORD_1
    ds_read_b64 v[108:109], v108
    ds_read_b64 v[110:111], v110
    s_waitcnt lgkmcnt(8)
    v_smfmac_f32_16x16x64_bf16 v[40:43], v[64:67], v[88:95], v68
    v_rcp_f32 v146, v146
    v_pk_fma_f32 v[148:149], v[148:149], v[136:137], v[136:137]
    v_pk_mul_f32 v[160:161], v[38:39], v[38:39]
    v_rcp_f32 v147, v147
    v_pk_fma_f32 v[160:161], v[160:161], v[128:129], v[130:131]
    v_rcp_f32 v148, v148
    v_pk_mul_f32 v[150:151], v[28:29], v[146:147]
    v_pk_mul_f32 v[160:161], v[160:161], v[38:39]
    v_lshlrev_b32_sdwa v88, 3, v122 dst_sel:DWORD dst_unused:UNUSED_PAD src0_sel:DWORD src1_sel:WORD_0
    v_lshlrev_b32_sdwa v90, 3, v122 dst_sel:DWORD dst_unused:UNUSED_PAD src0_sel:DWORD src1_sel:WORD_1
    ds_read_b64 v[88:89], v88
    ds_read_b64 v[90:91], v90
    v_lshlrev_b32_sdwa v92, 3, v123 dst_sel:DWORD dst_unused:UNUSED_PAD src0_sel:DWORD src1_sel:WORD_0
    v_lshlrev_b32_sdwa v94, 3, v123 dst_sel:DWORD dst_unused:UNUSED_PAD src0_sel:DWORD src1_sel:WORD_1
    ds_read_b64 v[92:93], v92
    ds_read_b64 v[94:95], v94
    buffer_load_dwordx4 v[120:123], v69, s[12:15], s45 offen offset:2048 sc1
    s_waitcnt lgkmcnt(8)
    v_smfmac_f32_16x16x64_bf16 v[44:47], v[64:67], v[96:103], v68
    v_rcp_f32 v149, v149
    v_exp_f32 v152, v152
    v_exp_f32 v153, v153
    v_pk_fma_f32 v[150:151], v[30:31], v[148:149], v[150:151]
    v_exp_f32 v154, v154
    v_add_f32 v150, v150, v151
    v_pk_fma_f32 v[152:153], v[152:153], v[134:135], v[134:135]
    v_exp_f32 v155, v155
    s_waitcnt vmcnt(3)
    v_lshlrev_b32_sdwa v96, 3, v124 dst_sel:DWORD dst_unused:UNUSED_PAD src0_sel:DWORD src1_sel:WORD_0
    v_lshlrev_b32_sdwa v98, 3, v124 dst_sel:DWORD dst_unused:UNUSED_PAD src0_sel:DWORD src1_sel:WORD_1
    ds_read_b64 v[96:97], v96
    ds_read_b64 v[98:99], v98
    v_lshlrev_b32_sdwa v100, 3, v125 dst_sel:DWORD dst_unused:UNUSED_PAD src0_sel:DWORD src1_sel:WORD_0
    v_lshlrev_b32_sdwa v102, 3, v125 dst_sel:DWORD dst_unused:UNUSED_PAD src0_sel:DWORD src1_sel:WORD_1
    ds_read_b64 v[100:101], v100
    ds_read_b64 v[102:103], v102
    s_waitcnt lgkmcnt(8)
    v_smfmac_f32_16x16x64_bf16 v[40:43], v[64:67], v[104:111], v68
    v_rcp_f32 v152, v152
    buffer_store_dword v150, v70, s[12:15], s35 offen offset:1664 sc1
    v_pk_fma_f32 v[154:155], v[154:155], v[136:137], v[136:137]
    v_rcp_f32 v153, v153
    v_rcp_f32 v154, v154
    v_rcp_f32 v155, v155
    v_pk_mul_f32 v[156:157], v[32:33], v[152:153]
    v_exp_f32 v158, v158
    v_lshlrev_b32_sdwa v104, 3, v126 dst_sel:DWORD dst_unused:UNUSED_PAD src0_sel:DWORD src1_sel:WORD_0
    v_lshlrev_b32_sdwa v106, 3, v126 dst_sel:DWORD dst_unused:UNUSED_PAD src0_sel:DWORD src1_sel:WORD_1
    ds_read_b64 v[104:105], v104
    ds_read_b64 v[106:107], v106
    v_lshlrev_b32_sdwa v108, 3, v127 dst_sel:DWORD dst_unused:UNUSED_PAD src0_sel:DWORD src1_sel:WORD_0
    v_lshlrev_b32_sdwa v110, 3, v127 dst_sel:DWORD dst_unused:UNUSED_PAD src0_sel:DWORD src1_sel:WORD_1
    ds_read_b64 v[108:109], v108
    ds_read_b64 v[110:111], v110
    buffer_load_dwordx4 v[124:127], v69, s[12:15], s20 offen offset:3072 sc1
    s_waitcnt lgkmcnt(8)
    v_smfmac_f32_16x16x64_bf16 v[44:47], v[64:67], v[88:95], v68
    v_exp_f32 v159, v159
    v_pk_fma_f32 v[156:157], v[34:35], v[154:155], v[156:157]
    v_pk_mul_f32 v[164:165], v[40:41], v[40:41]
    v_exp_f32 v160, v160
    v_add_f32 v156, v156, v157
    v_pk_fma_f32 v[158:159], v[158:159], v[134:135], v[134:135]
    v_exp_f32 v161, v161
    buffer_store_dword v156, v70, s[12:15], s35 offen offset:2048 sc1
    s_waitcnt vmcnt(5)
    v_lshlrev_b32_sdwa v88, 3, v116 dst_sel:DWORD dst_unused:UNUSED_PAD src0_sel:DWORD src1_sel:WORD_0
    v_lshlrev_b32_sdwa v90, 3, v116 dst_sel:DWORD dst_unused:UNUSED_PAD src0_sel:DWORD src1_sel:WORD_1
    ds_read_b64 v[88:89], v88
    ds_read_b64 v[90:91], v90
    v_lshlrev_b32_sdwa v92, 3, v117 dst_sel:DWORD dst_unused:UNUSED_PAD src0_sel:DWORD src1_sel:WORD_0
    v_lshlrev_b32_sdwa v94, 3, v117 dst_sel:DWORD dst_unused:UNUSED_PAD src0_sel:DWORD src1_sel:WORD_1
    ds_read_b64 v[92:93], v92
    ds_read_b64 v[94:95], v94
    s_waitcnt lgkmcnt(8)
    v_smfmac_f32_16x16x64_bf16 v[48:51], v[64:67], v[96:103], v68
    v_rcp_f32 v158, v158
    v_pk_fma_f32 v[160:161], v[160:161], v[136:137], v[136:137]
    v_pk_fma_f32 v[164:165], v[164:165], v[128:129], v[130:131]
    v_rcp_f32 v159, v159
    v_pk_mul_f32 v[164:165], v[164:165], v[40:41]
    v_pk_mul_f32 v[166:167], v[42:43], v[42:43]
    v_rcp_f32 v160, v160
    v_pk_mul_f32 v[162:163], v[36:37], v[158:159]
    v_lshlrev_b32_sdwa v96, 3, v118 dst_sel:DWORD dst_unused:UNUSED_PAD src0_sel:DWORD src1_sel:WORD_0
    v_lshlrev_b32_sdwa v98, 3, v118 dst_sel:DWORD dst_unused:UNUSED_PAD src0_sel:DWORD src1_sel:WORD_1
    ds_read_b64 v[96:97], v96
    ds_read_b64 v[98:99], v98
    v_lshlrev_b32_sdwa v100, 3, v119 dst_sel:DWORD dst_unused:UNUSED_PAD src0_sel:DWORD src1_sel:WORD_0
    v_lshlrev_b32_sdwa v102, 3, v119 dst_sel:DWORD dst_unused:UNUSED_PAD src0_sel:DWORD src1_sel:WORD_1
    ds_read_b64 v[100:101], v100
    ds_read_b64 v[102:103], v102
    buffer_load_dwordx4 v[116:119], v69, s[12:15], s41 offen offset:3072 sc1
    s_waitcnt lgkmcnt(8)
    v_smfmac_f32_16x16x64_bf16 v[52:55], v[64:67], v[104:111], v68
    s_setprio 1
    v_rcp_f32 v161, v161
    v_pk_fma_f32 v[166:167], v[166:167], v[128:129], v[130:131]
    v_pk_mul_f32 v[170:171], v[44:45], v[44:45]
    v_exp_f32 v164, v164
    v_pk_fma_f32 v[162:163], v[38:39], v[160:161], v[162:163]
    v_pk_mul_f32 v[166:167], v[166:167], v[42:43]
    v_exp_f32 v165, v165
    v_add_f32 v162, v162, v163
    s_waitcnt vmcnt(4)
    v_lshlrev_b32_sdwa v104, 3, v120 dst_sel:DWORD dst_unused:UNUSED_PAD src0_sel:DWORD src1_sel:WORD_0
    v_lshlrev_b32_sdwa v106, 3, v120 dst_sel:DWORD dst_unused:UNUSED_PAD src0_sel:DWORD src1_sel:WORD_1
    ds_read_b64 v[104:105], v104
    ds_read_b64 v[106:107], v106
    v_lshlrev_b32_sdwa v108, 3, v121 dst_sel:DWORD dst_unused:UNUSED_PAD src0_sel:DWORD src1_sel:WORD_0
    v_lshlrev_b32_sdwa v110, 3, v121 dst_sel:DWORD dst_unused:UNUSED_PAD src0_sel:DWORD src1_sel:WORD_1
    ds_read_b64 v[108:109], v108
    ds_read_b64 v[110:111], v110
    s_waitcnt lgkmcnt(8)
    v_smfmac_f32_16x16x64_bf16 v[48:51], v[64:67], v[88:95], v68
    v_exp_f32 v166, v166
    buffer_store_dword v162, v70, s[12:15], s35 offen offset:2176 sc1
    v_pk_fma_f32 v[164:165], v[164:165], v[134:135], v[134:135]
    v_exp_f32 v167, v167
    v_pk_fma_f32 v[170:171], v[170:171], v[128:129], v[130:131]
    v_pk_mul_f32 v[172:173], v[46:47], v[46:47]
    v_rcp_f32 v164, v164
    v_pk_fma_f32 v[166:167], v[166:167], v[136:137], v[136:137]
    v_lshlrev_b32_sdwa v88, 3, v122 dst_sel:DWORD dst_unused:UNUSED_PAD src0_sel:DWORD src1_sel:WORD_0
    v_lshlrev_b32_sdwa v90, 3, v122 dst_sel:DWORD dst_unused:UNUSED_PAD src0_sel:DWORD src1_sel:WORD_1
    ds_read_b64 v[88:89], v88
    ds_read_b64 v[90:91], v90
    v_lshlrev_b32_sdwa v92, 3, v123 dst_sel:DWORD dst_unused:UNUSED_PAD src0_sel:DWORD src1_sel:WORD_0
    v_lshlrev_b32_sdwa v94, 3, v123 dst_sel:DWORD dst_unused:UNUSED_PAD src0_sel:DWORD src1_sel:WORD_1
    ds_read_b64 v[92:93], v92
    ds_read_b64 v[94:95], v94
    buffer_load_dwordx4 v[120:123], v69, s[12:15], s45 offen offset:3072 sc1
    s_waitcnt lgkmcnt(8)
    v_smfmac_f32_16x16x64_bf16 v[52:55], v[64:67], v[96:103], v68
    v_rcp_f32 v165, v165
    v_pk_mul_f32 v[170:171], v[170:171], v[44:45]
    v_pk_fma_f32 v[172:173], v[172:173], v[128:129], v[130:131]
    v_rcp_f32 v166, v166
    v_pk_mul_f32 v[168:169], v[40:41], v[164:165]
    v_pk_mul_f32 v[172:173], v[172:173], v[46:47]
    v_rcp_f32 v167, v167
    v_exp_f32 v170, v170
    s_waitcnt vmcnt(4)
    v_lshlrev_b32_sdwa v96, 3, v124 dst_sel:DWORD dst_unused:UNUSED_PAD src0_sel:DWORD src1_sel:WORD_0
    v_lshlrev_b32_sdwa v98, 3, v124 dst_sel:DWORD dst_unused:UNUSED_PAD src0_sel:DWORD src1_sel:WORD_1
    ds_read_b64 v[96:97], v96
    ds_read_b64 v[98:99], v98
    v_lshlrev_b32_sdwa v100, 3, v125 dst_sel:DWORD dst_unused:UNUSED_PAD src0_sel:DWORD src1_sel:WORD_0
    v_lshlrev_b32_sdwa v102, 3, v125 dst_sel:DWORD dst_unused:UNUSED_PAD src0_sel:DWORD src1_sel:WORD_1
    ds_read_b64 v[100:101], v100
    ds_read_b64 v[102:103], v102
    s_waitcnt lgkmcnt(8)
    v_smfmac_f32_16x16x64_bf16 v[48:51], v[64:67], v[104:111], v68
    v_exp_f32 v171, v171
    v_pk_fma_f32 v[168:169], v[42:43], v[166:167], v[168:169]
    v_exp_f32 v172, v172
    v_add_f32 v168, v168, v169
    v_pk_fma_f32 v[170:171], v[170:171], v[134:135], v[134:135]
    v_exp_f32 v173, v173
    buffer_store_dword v168, v70, s[12:15], s35 offen offset:2560 sc1
    v_rcp_f32 v170, v170
    v_lshlrev_b32_sdwa v104, 3, v126 dst_sel:DWORD dst_unused:UNUSED_PAD src0_sel:DWORD src1_sel:WORD_0
    v_lshlrev_b32_sdwa v106, 3, v126 dst_sel:DWORD dst_unused:UNUSED_PAD src0_sel:DWORD src1_sel:WORD_1
    ds_read_b64 v[104:105], v104
    ds_read_b64 v[106:107], v106
    v_lshlrev_b32_sdwa v108, 3, v127 dst_sel:DWORD dst_unused:UNUSED_PAD src0_sel:DWORD src1_sel:WORD_0
    v_lshlrev_b32_sdwa v110, 3, v127 dst_sel:DWORD dst_unused:UNUSED_PAD src0_sel:DWORD src1_sel:WORD_1
    ds_read_b64 v[108:109], v108
    ds_read_b64 v[110:111], v110
    s_waitcnt lgkmcnt(8)
    v_smfmac_f32_16x16x64_bf16 v[52:55], v[64:67], v[88:95], v68
    v_rcp_f32 v171, v171
    v_pk_fma_f32 v[172:173], v[172:173], v[136:137], v[136:137]
    v_pk_mul_f32 v[140:141], v[48:49], v[48:49]
    v_rcp_f32 v172, v172
    v_pk_mul_f32 v[174:175], v[44:45], v[170:171]
    v_pk_fma_f32 v[140:141], v[140:141], v[128:129], v[130:131]
    v_rcp_f32 v173, v173
    v_pk_mul_f32 v[140:141], v[140:141], v[48:49]
    s_waitcnt vmcnt(3)
    v_lshlrev_b32_sdwa v88, 3, v116 dst_sel:DWORD dst_unused:UNUSED_PAD src0_sel:DWORD src1_sel:WORD_0
    v_lshlrev_b32_sdwa v90, 3, v116 dst_sel:DWORD dst_unused:UNUSED_PAD src0_sel:DWORD src1_sel:WORD_1
    ds_read_b64 v[88:89], v88
    ds_read_b64 v[90:91], v90
    v_lshlrev_b32_sdwa v92, 3, v117 dst_sel:DWORD dst_unused:UNUSED_PAD src0_sel:DWORD src1_sel:WORD_0
    v_lshlrev_b32_sdwa v94, 3, v117 dst_sel:DWORD dst_unused:UNUSED_PAD src0_sel:DWORD src1_sel:WORD_1
    ds_read_b64 v[92:93], v92
    ds_read_b64 v[94:95], v94
    s_waitcnt lgkmcnt(8)
    v_smfmac_f32_16x16x64_bf16 v[56:59], v[64:67], v[96:103], v68
    v_exp_f32 v140, v140
    v_pk_fma_f32 v[174:175], v[46:47], v[172:173], v[174:175]
    v_pk_mul_f32 v[142:143], v[50:51], v[50:51]
    v_exp_f32 v141, v141
    v_add_f32 v174, v174, v175
    v_pk_fma_f32 v[142:143], v[142:143], v[128:129], v[130:131]
    buffer_store_dword v174, v70, s[12:15], s35 offen offset:2688 sc1
    v_pk_fma_f32 v[140:141], v[140:141], v[134:135], v[134:135]
    v_lshlrev_b32_sdwa v96, 3, v118 dst_sel:DWORD dst_unused:UNUSED_PAD src0_sel:DWORD src1_sel:WORD_0
    v_lshlrev_b32_sdwa v98, 3, v118 dst_sel:DWORD dst_unused:UNUSED_PAD src0_sel:DWORD src1_sel:WORD_1
    ds_read_b64 v[96:97], v96
    ds_read_b64 v[98:99], v98
    v_lshlrev_b32_sdwa v100, 3, v119 dst_sel:DWORD dst_unused:UNUSED_PAD src0_sel:DWORD src1_sel:WORD_0
    v_lshlrev_b32_sdwa v102, 3, v119 dst_sel:DWORD dst_unused:UNUSED_PAD src0_sel:DWORD src1_sel:WORD_1
    ds_read_b64 v[100:101], v100
    ds_read_b64 v[102:103], v102
    s_waitcnt lgkmcnt(8)
    v_smfmac_f32_16x16x64_bf16 v[60:63], v[64:67], v[104:111], v68
    v_rcp_f32 v140, v140
    v_pk_mul_f32 v[142:143], v[142:143], v[50:51]
    v_pk_mul_f32 v[146:147], v[52:53], v[52:53]
    v_rcp_f32 v141, v141
    v_pk_fma_f32 v[146:147], v[146:147], v[128:129], v[130:131]
    v_pk_mul_f32 v[148:149], v[54:55], v[54:55]
    v_exp_f32 v142, v142
    v_pk_mul_f32 v[144:145], v[48:49], v[140:141]
    s_waitcnt vmcnt(2)
    v_lshlrev_b32_sdwa v104, 3, v120 dst_sel:DWORD dst_unused:UNUSED_PAD src0_sel:DWORD src1_sel:WORD_0
    v_lshlrev_b32_sdwa v106, 3, v120 dst_sel:DWORD dst_unused:UNUSED_PAD src0_sel:DWORD src1_sel:WORD_1
    ds_read_b64 v[104:105], v104
    ds_read_b64 v[106:107], v106
    v_lshlrev_b32_sdwa v108, 3, v121 dst_sel:DWORD dst_unused:UNUSED_PAD src0_sel:DWORD src1_sel:WORD_0
    v_lshlrev_b32_sdwa v110, 3, v121 dst_sel:DWORD dst_unused:UNUSED_PAD src0_sel:DWORD src1_sel:WORD_1
    ds_read_b64 v[108:109], v108
    ds_read_b64 v[110:111], v110
    s_waitcnt lgkmcnt(8)
    v_smfmac_f32_16x16x64_bf16 v[56:59], v[64:67], v[88:95], v68
    v_exp_f32 v143, v143
    v_pk_mul_f32 v[146:147], v[146:147], v[52:53]
    v_pk_fma_f32 v[148:149], v[148:149], v[128:129], v[130:131]
    v_exp_f32 v146, v146
    v_pk_fma_f32 v[142:143], v[142:143], v[136:137], v[136:137]
    v_pk_mul_f32 v[148:149], v[148:149], v[54:55]
    v_rcp_f32 v142, v142
    v_rcp_f32 v143, v143
    v_lshlrev_b32_sdwa v88, 3, v122 dst_sel:DWORD dst_unused:UNUSED_PAD src0_sel:DWORD src1_sel:WORD_0
    v_lshlrev_b32_sdwa v90, 3, v122 dst_sel:DWORD dst_unused:UNUSED_PAD src0_sel:DWORD src1_sel:WORD_1
    ds_read_b64 v[88:89], v88
    ds_read_b64 v[90:91], v90
    v_lshlrev_b32_sdwa v92, 3, v123 dst_sel:DWORD dst_unused:UNUSED_PAD src0_sel:DWORD src1_sel:WORD_0
    v_lshlrev_b32_sdwa v94, 3, v123 dst_sel:DWORD dst_unused:UNUSED_PAD src0_sel:DWORD src1_sel:WORD_1
    ds_read_b64 v[92:93], v92
    ds_read_b64 v[94:95], v94
    s_waitcnt lgkmcnt(8)
    v_smfmac_f32_16x16x64_bf16 v[60:63], v[64:67], v[96:103], v68
    s_setprio 0
    v_exp_f32 v147, v147
    v_pk_fma_f32 v[144:145], v[50:51], v[142:143], v[144:145]
    v_exp_f32 v148, v148
    v_add_f32 v144, v144, v145
    v_pk_fma_f32 v[146:147], v[146:147], v[134:135], v[134:135]
    v_exp_f32 v149, v149
    buffer_store_dword v144, v70, s[12:15], s35 offen offset:3072 sc1
    v_rcp_f32 v146, v146
    s_waitcnt lgkmcnt(4)
    v_smfmac_f32_16x16x64_bf16 v[56:59], v[64:67], v[104:111], v68
    v_rcp_f32 v147, v147
    v_pk_fma_f32 v[148:149], v[148:149], v[136:137], v[136:137]
    s_waitcnt lgkmcnt(0)
    v_smfmac_f32_16x16x64_bf16 v[60:63], v[64:67], v[88:95], v68
    v_rcp_f32 v148, v148
    v_pk_mul_f32 v[150:151], v[52:53], v[146:147]
    v_rcp_f32 v149, v149
    s_nop 0
    s_nop 0
    v_pk_fma_f32 v[150:151], v[54:55], v[148:149], v[150:151]
    s_nop 0
    v_add_f32 v150, v150, v151
    v_pk_mul_f32 v[152:153], v[56:57], v[56:57]
    buffer_store_dword v150, v70, s[12:15], s35 offen offset:3200 sc1
    v_pk_fma_f32 v[152:153], v[152:153], v[128:129], v[130:131]
    v_pk_mul_f32 v[154:155], v[58:59], v[58:59]
    v_pk_mul_f32 v[152:153], v[152:153], v[56:57]
    v_pk_fma_f32 v[154:155], v[154:155], v[128:129], v[130:131]
    v_exp_f32 v152, v152
    v_pk_mul_f32 v[154:155], v[154:155], v[58:59]
    v_pk_mul_f32 v[158:159], v[60:61], v[60:61]
    v_exp_f32 v153, v153
    v_pk_fma_f32 v[158:159], v[158:159], v[128:129], v[130:131]
    v_pk_mul_f32 v[160:161], v[62:63], v[62:63]
    v_exp_f32 v154, v154
    v_pk_fma_f32 v[152:153], v[152:153], v[134:135], v[134:135]
    v_pk_mul_f32 v[158:159], v[158:159], v[60:61]
    v_rcp_f32 v152, v152
    v_pk_fma_f32 v[160:161], v[160:161], v[128:129], v[130:131]
    v_rcp_f32 v153, v153
    v_pk_mul_f32 v[160:161], v[160:161], v[62:63]
    v_exp_f32 v155, v155
    v_pk_mul_f32 v[156:157], v[56:57], v[152:153]
    v_exp_f32 v158, v158
    v_pk_fma_f32 v[154:155], v[154:155], v[136:137], v[136:137]
    v_exp_f32 v159, v159
    v_rcp_f32 v154, v154
    v_rcp_f32 v155, v155
    v_pk_fma_f32 v[158:159], v[158:159], v[134:135], v[134:135]
    v_exp_f32 v160, v160
    v_pk_fma_f32 v[156:157], v[58:59], v[154:155], v[156:157]
    v_rcp_f32 v158, v158
    v_add_f32 v156, v156, v157
    v_rcp_f32 v159, v159
    buffer_store_dword v156, v70, s[12:15], s35 offen offset:3584 sc1
    v_exp_f32 v161, v161
    v_pk_mul_f32 v[162:163], v[60:61], v[158:159]
    s_nop 0
    v_pk_fma_f32 v[160:161], v[160:161], v[136:137], v[136:137]
    s_nop 0
    v_rcp_f32 v160, v160
    v_rcp_f32 v161, v161
    s_nop 0
    s_nop 0
    v_pk_fma_f32 v[162:163], v[62:63], v[160:161], v[162:163]
    s_nop 0
    v_add_f32 v162, v162, v163
    s_nop 0
    buffer_store_dword v162, v70, s[12:15], s35 offen offset:3712 sc1

    v_and_b32 v193, 0xf0, v69
    v_lshrrev_b32 v197, 8, v69
    v_lshl_or_b32 v192, v197, 16, v193
    v_lshrrev_b32 v198, 1, v197
    v_and_b32 v197, 1, v197
    v_lshl_or_b32 v193, v198, 2, v193
    v_lshl_or_b32 v193, v197, 3, v193
    v_mov_b32 v196, 0
    s_mov_b32 s65, 0

    s_lshl_b32 s68, s2, 8
    s_add_u32 s66, s68, 29360128
    s_add_u32 s67, s66, 65536
    s_add_u32 s60, s68, 20971520
    s_lshr_b32 s68, s68, 1

    s_lshl_b32 s61, s3, 20
    s_add_u32 s60, s60, s61

    s_add_u32 s61, s60, 262144
    s_add_u32 s62, s60, 524288
    s_add_u32 s63, s60, 786432

    s_mov_b32 s76, s56
    s_and_b32 s77, s57, 0xffff
    s_mov_b32 s78, 2
    s_mov_b32 s79, 0x00020000
    s_mov_b32 s72, s58
    s_and_b32 s73, s59, 0xffff
    s_mov_b32 s74, 32768
    s_mov_b32 s75, 0x00020000
    s_mov_b64 s[20:21], -1
    s_mov_b64 s[22:23], -1
    s_mov_b64 s[24:25], -1
    s_mov_b64 s[26:27], -1
    s_mov_b64 s[28:29], -1

    v_mov_b32 v216, -1
    buffer_load_short_d16_hi v196, v196, s[76:79], 0 offen
    s_bitcmp1_b32 s64, 30
    s_cbranch_scc0 standalone__deep_cross_pnn__recsys_kernel_rd

standalone__deep_cross_pnn__recsys_kernel_rp:
    s_mov_b64 exec, s[20:21]
    buffer_load_dwordx4 v[176:179], v192, s[12:15], s60 offen sc1
    s_mov_b64 exec, s[22:23]
    buffer_load_dwordx4 v[180:183], v192, s[12:15], s61 offen sc1
    s_mov_b64 exec, s[24:25]
    buffer_load_dwordx4 v[184:187], v192, s[12:15], s62 offen sc1
    s_mov_b64 exec, s[26:27]
    buffer_load_dwordx4 v[188:191], v192, s[12:15], s63 offen sc1
    s_mov_b64 exec, s[28:29]
    buffer_load_dword v194, v193, s[12:15], s66 offen sc1
    buffer_load_dword v195, v193, s[12:15], s67 offen sc1
    s_mov_b64 exec, -1
    s_waitcnt vmcnt(4)
    v_add_f32 v216, v176, v180
    v_add_f32 v217, v177, v181
    v_add_f32 v218, v178, v182
    v_add_f32 v219, v179, v183
    s_waitcnt vmcnt(2)
    v_add_f32 v220, v184, v188
    v_add_f32 v221, v185, v189
    v_add_f32 v222, v186, v190
    v_add_f32 v223, v187, v191
    v_add_f32 v216, v216, v220
    v_add_f32 v217, v217, v221
    v_add_f32 v218, v218, v222
    v_add_f32 v219, v219, v223

    s_nop 0
    v_permlane32_swap_b32 v216, v217
    v_permlane32_swap_b32 v218, v219
    v_add_f32 v216, v216, v217
    v_add_f32 v218, v218, v219
    s_nop 1
    v_permlane16_swap_b32 v216, v218
    s_nop 0
    v_add_f32 v216, v216, v218

    s_waitcnt vmcnt(0)
    v_add_f32 v201, v194, v195
    s_add_u32 s65, s65, 1
    v_add_f32 v197, v201, v216
    v_cmp_u_f32 vcc, v197, v197
    s_cbranch_vccz standalone__deep_cross_pnn__recsys_kernel_rd

    v_cmp_u_f32 s[20:21], v176, v177
    v_cmp_u_f32 vcc, v178, v179
    s_or_b64 s[20:21], s[20:21], vcc

    v_cmp_u_f32 s[22:23], v180, v181
    v_cmp_u_f32 vcc, v182, v183
    s_or_b64 s[22:23], s[22:23], vcc

    v_cmp_u_f32 s[24:25], v184, v185
    v_cmp_u_f32 vcc, v186, v187
    s_or_b64 s[24:25], s[24:25], vcc

    v_cmp_u_f32 s[26:27], v188, v189
    v_cmp_u_f32 vcc, v190, v191
    s_or_b64 s[26:27], s[26:27], vcc

    v_cmp_u_f32 s[28:29], v194, v195

    s_cmp_lt_u32 s65, 300
    s_cbranch_scc1 standalone__deep_cross_pnn__recsys_kernel_rp
    v_mov_b32 v216, -1

standalone__deep_cross_pnn__recsys_kernel_rd:

    v_lshrrev_b32 v197, 2, v69
    s_lshl_b32 s69, s3, 8
    v_add_u32 v198, s69, v197
    ds_write_b32 v198, v216
    v_mov_b32 v199, 0
    s_waitcnt vmcnt(0) lgkmcnt(0)

    s_barrier
    s_cmp_eq_u32 s3, 1
    s_cbranch_scc1 standalone__deep_cross_pnn__recsys_kernel_rc
    s_cmp_lg_u32 s3, 0
    s_cbranch_scc1 standalone__deep_cross_pnn__recsys_kernel_end

    ds_read_b32 v208, v197 offset:0
    ds_read_b32 v209, v197 offset:256
    ds_read_b32 v210, v197 offset:512
    ds_read_b32 v211, v197 offset:768
    ds_read_b32 v212, v197 offset:1024
    ds_read_b32 v213, v197 offset:1280
    ds_read_b32 v214, v197 offset:1536
    ds_read_b32 v215, v197 offset:1792
    s_waitcnt lgkmcnt(6)
    v_add_f32 v200, v208, v209
    s_waitcnt lgkmcnt(5)
    v_add_f32 v200, v200, v210
    s_waitcnt lgkmcnt(4)
    v_add_f32 v200, v200, v211
    s_waitcnt lgkmcnt(3)
    v_add_f32 v200, v200, v212
    s_waitcnt lgkmcnt(2)
    v_add_f32 v200, v200, v213
    s_waitcnt lgkmcnt(1)
    v_add_f32 v200, v200, v214
    s_waitcnt lgkmcnt(0)
    v_add_f32 v200, v200, v215

    v_cmp_u_f32 vcc, v200, v200
    s_cbranch_vccnz standalone__deep_cross_pnn__recsys_kernel_rf

    v_cvt_pk_bf16_f32 v197, v200, v201
    v_lshlrev_b32 v198, 16, v197
    v_and_b32 v197, 0xffff0000, v197
    v_add_f32 v198, v198, v196
    v_cvt_pk_bf16_f32 v198, v198, v198
    v_lshlrev_b32 v198, 16, v198
    v_add_f32 v198, v198, v197
    v_cvt_pk_bf16_f32 v198, v198, v198
    v_lshrrev_b32 v197, 1, v193
    buffer_store_short v198, v197, s[72:75], s68 offen

    s_endpgm
standalone__deep_cross_pnn__recsys_kernel_rf:

    s_lshr_b32 s69, s2, 5
    s_lshl_b32 s69, s69, 4
    s_lshl_b32 s70, 1, s2
    v_mov_b32 v198, s70
    s_mov_b64 exec, 1
    buffer_atomic_or v198, v199, s[52:55], s69 offen offset:136 sc0
    s_waitcnt vmcnt(0)

standalone__deep_cross_pnn__recsys_kernel_rc:

    s_mov_b64 exec, 0xff
    buffer_load_dwordx4 v[176:179], v69, s[52:55], 0 offen offset:128 sc1
    s_waitcnt vmcnt(0)
    v_cmp_ne_u32 vcc, 0, v178
    s_cbranch_vccz standalone__deep_cross_pnn__recsys_kernel_end
    v_cmp_ne_u32 vcc, -1, v176
    s_cbranch_vccnz standalone__deep_cross_pnn__recsys_kernel_end
    v_mov_b32 v199, v178
    s_mov_b64 exec, -1
    v_lshlrev_b32 v198, 3, v69
    s_mov_b32 s69, 14680064
    buffer_load_dwordx4 v[176:179], v198, s[12:15], s69 offen sc1
    s_waitcnt vmcnt(0)
    v_min3_u32 v198, v176, v177, v178
    v_min_u32 v198, v198, v179
    v_cmp_eq_u32 vcc, 0, v198
    s_cbranch_vccnz standalone__deep_cross_pnn__recsys_kernel_end

standalone__deep_cross_pnn__recsys_kernel_rn:

    v_cmp_ne_u32 vcc, 0, v199
    s_cbranch_vccz standalone__deep_cross_pnn__recsys_kernel_end
    s_ff1_i32_b64 s69, vcc
    s_mov_b32 m0, s69
    s_nop 3
    v_readlane_b32 s70, v199, s69
    s_ff1_i32_b32 s71, s70
    s_bitset0_b32 s70, s71
    s_nop 3
    v_writelane_b32 v199, s70, m0
    s_lshl_b32 s69, s69, 5
    s_add_u32 s69, s69, s71

    s_lshl_b32 s68, s69, 8
    s_add_u32 s66, s68, 29360128
    s_add_u32 s67, s66, 65536
    s_add_u32 s60, s68, 20971520
    s_lshr_b32 s68, s68, 1

    s_add_u32 s61, s60, 262144
    s_add_u32 s62, s60, 524288
    s_add_u32 s63, s60, 786432

    buffer_load_dword v194, v193, s[12:15], s66 offen sc1
    buffer_load_dword v195, v193, s[12:15], s67 offen sc1
    s_mov_b32 s65, 0
standalone__deep_cross_pnn__recsys_kernel_rw:
    buffer_load_dwordx4 v[176:179], v192, s[12:15], s60 offen sc1
    buffer_load_dwordx4 v[180:183], v192, s[12:15], s61 offen sc1
    buffer_load_dwordx4 v[184:187], v192, s[12:15], s62 offen sc1
    buffer_load_dwordx4 v[188:191], v192, s[12:15], s63 offen sc1
    s_waitcnt vmcnt(2)
    v_add_f32 v216, v176, v180
    v_add_f32 v217, v177, v181
    v_add_f32 v218, v178, v182
    v_add_f32 v219, v179, v183
    s_waitcnt vmcnt(0)
    v_add_f32 v220, v184, v188
    v_add_f32 v221, v185, v189
    v_add_f32 v222, v186, v190
    v_add_f32 v223, v187, v191
    v_add_f32 v216, v216, v220
    v_add_f32 v217, v217, v221
    v_add_f32 v218, v218, v222
    v_add_f32 v219, v219, v223

    s_nop 0
    v_permlane32_swap_b32 v216, v217
    v_permlane32_swap_b32 v218, v219
    v_add_f32 v216, v216, v217
    v_add_f32 v218, v218, v219
    s_nop 1
    v_permlane16_swap_b32 v216, v218
    s_nop 0
    v_add_f32 v216, v216, v218

    s_mov_b32 s70, 0xff800001
    s_mov_b64 s[20:21], 0
    v_cmp_eq_u32 vcc, s70, v194
    s_or_b64 s[20:21], s[20:21], vcc
    v_cmp_eq_u32 vcc, s70, v195
    s_or_b64 s[20:21], s[20:21], vcc
    v_cmp_eq_u32 vcc, s70, v176
    s_or_b64 s[20:21], s[20:21], vcc
    v_cmp_eq_u32 vcc, s70, v177
    s_or_b64 s[20:21], s[20:21], vcc
    v_cmp_eq_u32 vcc, s70, v178
    s_or_b64 s[20:21], s[20:21], vcc
    v_cmp_eq_u32 vcc, s70, v179
    s_or_b64 s[20:21], s[20:21], vcc
    v_cmp_eq_u32 vcc, s70, v180
    s_or_b64 s[20:21], s[20:21], vcc
    v_cmp_eq_u32 vcc, s70, v181
    s_or_b64 s[20:21], s[20:21], vcc
    v_cmp_eq_u32 vcc, s70, v182
    s_or_b64 s[20:21], s[20:21], vcc
    v_cmp_eq_u32 vcc, s70, v183
    s_or_b64 s[20:21], s[20:21], vcc
    v_cmp_eq_u32 vcc, s70, v184
    s_or_b64 s[20:21], s[20:21], vcc
    v_cmp_eq_u32 vcc, s70, v185
    s_or_b64 s[20:21], s[20:21], vcc
    v_cmp_eq_u32 vcc, s70, v186
    s_or_b64 s[20:21], s[20:21], vcc
    v_cmp_eq_u32 vcc, s70, v187
    s_or_b64 s[20:21], s[20:21], vcc
    v_cmp_eq_u32 vcc, s70, v188
    s_or_b64 s[20:21], s[20:21], vcc
    v_cmp_eq_u32 vcc, s70, v189
    s_or_b64 s[20:21], s[20:21], vcc
    v_cmp_eq_u32 vcc, s70, v190
    s_or_b64 s[20:21], s[20:21], vcc
    v_cmp_eq_u32 vcc, s70, v191
    s_or_b64 s[20:21], s[20:21], vcc

    s_cbranch_scc1 standalone__deep_cross_pnn__recsys_kernel_end
    s_cmp_eq_u32 s65, 0
    s_cselect_b64 vcc, -1, 0
    v_add_f32 v200, v200, v216
    v_cndmask_b32 v200, v200, v216, vcc
    s_add_u32 s60, s60, 1048576
    s_add_u32 s61, s61, 1048576
    s_add_u32 s62, s62, 1048576
    s_add_u32 s63, s63, 1048576
    s_add_u32 s65, s65, 1
    s_cmp_lt_u32 s65, 8
    s_cbranch_scc1 standalone__deep_cross_pnn__recsys_kernel_rw
    v_add_f32 v201, v194, v195

    v_cvt_pk_bf16_f32 v197, v200, v201
    v_lshlrev_b32 v198, 16, v197
    v_and_b32 v197, 0xffff0000, v197
    v_add_f32 v198, v198, v196
    v_cvt_pk_bf16_f32 v198, v198, v198
    v_lshlrev_b32 v198, 16, v198
    v_add_f32 v198, v198, v197
    v_cvt_pk_bf16_f32 v198, v198, v198
    v_lshrrev_b32 v197, 1, v193
    buffer_store_short v198, v197, s[72:75], s68 offen

    s_nop 1
    s_branch standalone__deep_cross_pnn__recsys_kernel_rn
standalone__deep_cross_pnn__recsys_kernel_end:
    s_endpgm
.section .rodata,"a"
.p2align 6
.amdhsa_kernel standalone__deep_cross_pnn__recsys_kernel
  .amdhsa_next_free_vgpr 256
  .amdhsa_next_free_sgpr 102
  .amdhsa_accum_offset 256
  .amdhsa_group_segment_fixed_size 0
  .amdhsa_kernarg_size 80
  .amdhsa_user_sgpr_count 2
  .amdhsa_user_sgpr_kernarg_segment_ptr 1
  .amdhsa_system_sgpr_workgroup_id_x 1
.end_amdhsa_kernel
```

```asm
; @launch grid=(256,1,1) block=(512,1,1) lds=163840
.amdgcn_target "amdgcn-amd-amdhsa--gfx950"
.text
.globl standalone__deep_cross_pnn__recsys_kernel
.p2align 8
.type standalone__deep_cross_pnn__recsys_kernel,@function
standalone__deep_cross_pnn__recsys_kernel:

    s_cmp_ge_u32 s2, 256
    s_cbranch_scc1 standalone__deep_cross_pnn__recsys_kernel_end
    s_load_dwordx8 s[4:11], s[0:1], 0
    s_load_dwordx2 s[12:13], s[0:1], 72
    s_load_dwordx2 s[52:53], s[0:1], 64
    s_load_dwordx4 s[60:63], s[0:1], 32
    v_lshrrev_b32 v1, 6, v0
    v_and_b32 v255, 63, v0
    s_bfe_u32 s36, s2, 0x10003
    v_readfirstlane_b32 s3, v1
    s_lshr_b32 s37, s2, 4
    s_lshl_b32 s37, s37, 3
    s_and_b32 s38, s2, 7
    s_or_b32 s37, s37, s38
    v_lshlrev_b32 v254, 4, v255
    v_mov_b32 v252, 163712
    v_mov_b32 v253, 1
    v_mov_b32 v40, 0
    v_cmp_gt_u32 vcc, 8, v0
    v_lshl_add_u32 v41, v0, 2, v252
    s_and_saveexec_b64 s[46:47], vcc
    ds_write_b32 v41, v40
    s_mov_b64 exec, s[46:47]
    v_mul_u32_u24 v6, 57, v255
    v_lshrrev_b32 v6, 9, v6
    v_mul_u32_u24 v5, 9, v6
    v_sub_u32 v5, v255, v5
    v_cmp_gt_u32 s[40:41], 8, v5
    v_lshlrev_b32 v5, 4, v5
    v_lshl_add_u32 v83, v6, 8, v5
    s_and_b32 s56, s3, 3
    s_mul_i32 s42, s56, 1792
    s_mul_i32 s43, s56, 1008
    s_lshl_b32 s38, s36, 7
    s_add_u32 s42, s42, s38
    s_bitset0_b32 s41, 31
    s_waitcnt lgkmcnt(0)

    s_mov_b32 s16, s4
    s_and_b32 s17, s5, 0xffff
    s_mov_b32 s18, 6553600
    s_mov_b32 s19, 0x00020000
    s_mov_b32 s20, s6
    s_and_b32 s21, s7, 0xffff
    s_mov_b32 s22, 256000
    s_mov_b32 s23, 0x00020000
    s_mov_b32 s24, s8
    s_and_b32 s25, s9, 0xffff
    s_mov_b32 s26, 20000
    s_mov_b32 s27, 0x00020000
    s_mov_b32 s28, s10
    s_and_b32 s29, s11, 0xffff
    s_mov_b32 s30, 13107200
    s_mov_b32 s31, 0x00020000
    s_mov_b32 s32, s12
    s_and_b32 s33, s13, 0xffff
    s_mov_b32 s34, 268435456
    s_mov_b32 s35, 0x00020000
    s_mov_b32 s12, s12
    s_and_b32 s13, s13, 0xffff
    s_mov_b32 s14, 268435456
    s_mov_b32 s15, 0x00020000
    s_mov_b32 s52, s52
    s_and_b32 s53, s53, 0xffff
    s_mov_b32 s54, 256
    s_mov_b32 s55, 0x00020000

    s_mov_b32 s50, s36
    s_lshr_b32 s44, s2, 1
    s_lshl_b32 s44, s44, 3

    s_cmp_ge_u32 s3, 4
    s_cbranch_scc1 standalone__deep_cross_pnn__recsys_kernel_aux

    s_setprio 3
    s_lshl_b32 s38, s3, 10
    s_add_u32 m0, s38, 144144
    v_and_b32 v5, 15, v255

    buffer_load_dwordx4 v254, s[24:27], s38 offen lds
    s_add_u32 m0, m0, 4096
    s_add_u32 s38, s38, 4096
    buffer_load_dwordx4 v254, s[24:27], s38 offen lds
    s_add_u32 m0, m0, 4096
    s_add_u32 s38, s38, 4096
    buffer_load_dwordx4 v254, s[24:27], s38 offen lds
    s_add_u32 m0, m0, 4096
    s_add_u32 s38, s38, 4096
    buffer_load_dwordx4 v254, s[24:27], s38 offen lds
    s_add_u32 m0, m0, 4096
    s_add_u32 s38, s38, 4096
    s_cmp_eq_u32 s3, 3
    s_cselect_b32 s45, 1024, 0
    s_sub_u32 m0, m0, s45
    s_sub_u32 s38, s38, s45
    buffer_load_dwordx4 v254, s[24:27], s38 offen lds

    v_lshrrev_b32 v6, 4, v255
    v_and_b32 v8, 3, v255
    v_bfe_u32 v7, v255, 2, 2
    v_mul_u32_u24 v245, 24, v5
    s_movk_i32 s45, 400
    v_lshlrev_b32 v246, 2, v7
    v_mad_u32_u24 v246, v8, s45, v246
    s_lshl_b32 s72, s37, 7
    s_lshl_b32 s73, s3, 5
    s_add_u32 s72, s72, s73
    s_mul_i32 s74, s72, 400
    s_add_u32 s58, s74, 12800
    s_mov_b32 s18, s58
    v_mul_u32_u24 v184, 12, v5
    s_movk_i32 s45, 200
    v_mad_u32_u24 v185, v6, s45, v184
    v_lshlrev_b32 v186, 1, v7
    v_mad_u32_u24 v186, v6, s45, v186
    v_mov_b32 v90, 0
    s_movk_i32 s45, 19200

    buffer_load_dwordx3 v[188:190], v185, s[24:27], s45 offen
    buffer_load_short_d16_hi v90, v186, s[24:27], s45 offen offset:192
    buffer_load_dwordx4 v[192:195], v245, s[16:19], s74 offen
    buffer_load_dwordx2 v[196:197], v245, s[16:19], s74 offen offset:16
    buffer_load_dword v198, v246, s[16:19], s74 offen offset:384
    buffer_load_dwordx4 v[218:221], v245, s[16:19], s74 offen offset:400
    buffer_load_dwordx2 v[222:223], v245, s[16:19], s74 offen offset:416
    buffer_load_dwordx4 v[224:227], v245, s[16:19], s74 offen offset:800
    buffer_load_dwordx2 v[228:229], v245, s[16:19], s74 offen offset:816
    buffer_load_dwordx4 v[230:233], v245, s[16:19], s74 offen offset:1200
    buffer_load_dwordx2 v[234:235], v245, s[16:19], s74 offen offset:1216
    buffer_load_dwordx4 v[212:215], v245, s[16:19], s74 offen offset:1600
    buffer_load_dwordx2 v[216:217], v245, s[16:19], s74 offen offset:1616
    buffer_load_dword v236, v246, s[16:19], s74 offen offset:1984
    s_load_dwordx2 s[24:25], s[60:61], s44
    s_load_dwordx2 s[26:27], s[62:63], s44

    v_add_u32 v40, -1, v5
    v_cmp_gt_u32 s[46:47], 8, v40
    s_lshl_b32 s76, s36, 14
    s_add_u32 s76, s76, s72
    s_lshl_b32 s76, s76, 2
    s_add_u32 s76, s76, 29360128
    v_lshlrev_b32 v40, 4, v40
    v_lshrrev_b32 v41, 5, v255
    v_lshl_add_u32 v40, v41, 2, v40
    v_bfe_u32 v41, v255, 4, 1
    v_lshl_add_u32 v94, v41, 3, v40
    s_add_u32 s45, s3, 4
    s_mul_i32 s44, s45, 18432
    v_mul_u32_u24 v95, 144, v5
    v_lshl_add_u32 v95, v6, 4, v95
    v_add_u32 v95, s44, v95
    s_xor_b32 s44, s36, 1
    s_lshl_b32 s44, s44, 3
    s_add_u32 s44, s44, s45
    s_lshl_b32 s44, s44, 14
    s_add_u32 s44, s44, 15204352
    s_mov_b32 s64, 0x40000000
    v_add_u32 v184, 144144, v184
    s_movk_i32 s45, 4800
    v_mad_u32_u24 v184, v6, s45, v184
    v_mul_u32_u24 v186, 1200, v5
    v_add_u32 v186, 144144, v186
    v_mad_u32_u24 v185, v6, 48, v186
    v_lshl_add_u32 v186, v6, 1, v186
    v_and_b32 v244, 48, v255
    s_movk_i32 s57, 144
    v_cmp_eq_u32 s[60:61], 0, v8
    v_cmp_eq_u32 s[62:63], 1, v8
    v_cmp_eq_u32 s[66:67], 2, v8
    v_cmp_eq_u32 s[68:69], 3, v8
    s_mov_b32 s70, 0x00010001
    s_mov_b32 s71, 0x00010001

    s_lshr_b32 s79, s2, 1
    s_mul_i32 s77, s79, 102656
    s_lshl_b32 s85, s50, 11
    s_xor_b32 s78, s85, 2048
    s_add_u32 s78, s78, s77
    s_add_u32 s77, s77, s85
    s_and_b32 s79, s2, 1
    s_mul_i32 s79, s79, 1638400
    s_add_u32 s79, s79, 16777216
    s_lshl_b32 s85, s3, 13
    s_add_u32 s79, s79, s85
    s_xor_b32 s85, s3, 4
    s_lshl_b32 s85, s85, 10
    v_mov_b32 v0, 0
    v_mov_b32 v1, 0
    v_mov_b32 v2, 0
    v_mov_b32 v3, 0
    v_mov_b32 v4, 0
    v_mov_b32 v5, 0
    v_mov_b32 v6, 0
    v_mov_b32 v7, 0
    v_mov_b32 v8, 0
    v_mov_b32 v9, 0
    v_mov_b32 v10, 0
    v_mov_b32 v11, 0
    v_mov_b32 v12, 0
    v_mov_b32 v13, 0
    v_mov_b32 v14, 0
    v_mov_b32 v15, 0
    v_mov_b32 v16, 0
    v_mov_b32 v17, 0
    v_mov_b32 v18, 0
    v_mov_b32 v19, 0
    v_mov_b32 v20, 0
    v_mov_b32 v21, 0
    v_mov_b32 v22, 0
    v_mov_b32 v23, 0
    v_mov_b32 v24, 0
    v_mov_b32 v25, 0
    v_mov_b32 v26, 0
    v_mov_b32 v27, 0
    v_mov_b32 v28, 0
    v_mov_b32 v29, 0
    v_mov_b32 v30, 0
    v_mov_b32 v31, 0
    v_mov_b32 v32, 0
    v_mov_b32 v33, 0
    v_mov_b32 v34, 0
    v_mov_b32 v35, 0
    v_mov_b32 v36, 0
    v_mov_b32 v37, 0
    v_mov_b32 v38, 0
    v_mov_b32 v39, 0
    v_mov_b32 v40, 0
    v_mov_b32 v41, 0
    v_mov_b32 v42, 0
    v_mov_b32 v43, 0
    v_mov_b32 v44, 0
    v_mov_b32 v45, 0
    v_mov_b32 v46, 0
    v_mov_b32 v47, 0
    v_mov_b32 v48, 0
    v_mov_b32 v49, 0
    v_mov_b32 v50, 0
    v_mov_b32 v51, 0
    v_mov_b32 v52, 0
    v_mov_b32 v53, 0
    v_mov_b32 v54, 0
    v_mov_b32 v55, 0
    v_mov_b32 v56, 0
    v_mov_b32 v57, 0
    v_mov_b32 v58, 0
    v_mov_b32 v59, 0
    v_mov_b32 v60, 0
    v_mov_b32 v61, 0
    v_mov_b32 v62, 0
    v_mov_b32 v63, 0
    v_mov_b32 v64, 0
    v_mov_b32 v65, 0
    v_mov_b32 v66, 0
    v_mov_b32 v67, 0
    v_mov_b32 v68, 0
    v_mov_b32 v69, 0
    v_mov_b32 v70, 0
    v_mov_b32 v71, 0
    v_mov_b32 v72, 0
    v_mov_b32 v73, 0
    v_mov_b32 v74, 0
    v_mov_b32 v75, 0
    v_mov_b32 v76, 0
    v_mov_b32 v77, 0
    v_mov_b32 v78, 0
    v_mov_b32 v79, 0
    v_mov_b32 v80, 0
    v_mov_b32 v81, 0
    v_mov_b32 v82, 0
    v_mov_b32 v83, 0
    v_mov_b32 v84, 0
    v_mov_b32 v85, 0
    v_mov_b32 v86, 0
    v_mov_b32 v87, 0
    v_mov_b32 v88, 0
    v_mov_b32 v89, 0
    s_waitcnt vmcnt(14)
    s_barrier
    ds_read_b64 v[96:97], v185 offset:200
    ds_read_b64 v[98:99], v185 offset:208
    ds_read_b64 v[100:101], v185 offset:224
    ds_read_b64 v[102:103], v185 offset:232
    ds_read_b64 v[104:105], v185 offset:400
    ds_read_b64 v[106:107], v185 offset:408
    ds_read_b64 v[108:109], v185 offset:424
    ds_read_b64 v[110:111], v185 offset:432
    ds_read_b64 v[112:113], v185 offset:600
    ds_read_b64 v[114:115], v185 offset:608
    ds_read_b64 v[116:117], v185 offset:616
    ds_read_b64 v[118:119], v185 offset:624
    ds_read_b64 v[120:121], v185 offset:632
    ds_read_b64 v[122:123], v185 offset:640
    ds_read_b64 v[124:125], v185 offset:800
    ds_read_b64 v[126:127], v185 offset:808
    ds_read_b64 v[128:129], v185 offset:816
    ds_read_b64 v[130:131], v185 offset:824
    ds_read_b64 v[132:133], v185 offset:832
    ds_read_b64 v[134:135], v185 offset:840
    ds_read_b64 v[136:137], v185 offset:1000
    ds_read_b64 v[138:139], v185 offset:1008
    ds_read_b64 v[140:141], v185 offset:1016
    ds_read_b64 v[142:143], v185 offset:1024
    ds_read_b64 v[144:145], v185 offset:1032
    ds_read_b64 v[146:147], v185 offset:1040
    ds_read_u16_d16_hi v84, v186 offset:192
    ds_read_u16_d16_hi v85, v186 offset:392
    ds_read_u16_d16_hi v86, v186 offset:592
    ds_read_u16_d16_hi v87, v186 offset:792
    ds_read_u16_d16_hi v88, v186 offset:992
    ds_read_u16_d16_hi v89, v186 offset:1192
    ds_read_u16_d16_hi v4, v184 offset:2
    ds_read_u16_d16_hi v5, v184 offset:1202
    ds_read_u16_d16_hi v6, v184 offset:2402
    ds_read_u16_d16_hi v7, v184 offset:3602
    ds_read_u16_d16_hi v8, v184 offset:4
    ds_read_u16_d16_hi v9, v184 offset:1204
    ds_read_u16_d16_hi v10, v184 offset:2404
    ds_read_u16_d16_hi v11, v184 offset:3604
    ds_read_u16_d16_hi v12, v184 offset:6
    ds_read_u16_d16_hi v13, v184 offset:1206
    ds_read_u16_d16_hi v14, v184 offset:2406
    ds_read_u16_d16_hi v15, v184 offset:3606
    ds_read_u16_d16_hi v16, v184 offset:8
    ds_read_u16_d16_hi v17, v184 offset:1208
    ds_read_u16_d16_hi v18, v184 offset:2408
    ds_read_u16_d16_hi v19, v184 offset:3608
    ds_read_u16_d16_hi v20, v184 offset:10
    ds_read_u16_d16_hi v21, v184 offset:1210
    ds_read_u16_d16_hi v22, v184 offset:2410
    ds_read_u16_d16_hi v23, v184 offset:3610
    ds_read_u16_d16_hi v28, v184 offset:204
    ds_read_u16_d16_hi v29, v184 offset:1404
    ds_read_u16_d16_hi v30, v184 offset:2604
    ds_read_u16_d16_hi v31, v184 offset:3804
    ds_read_u16_d16_hi v32, v184 offset:206
    ds_read_u16_d16_hi v33, v184 offset:1406
    ds_read_u16_d16_hi v34, v184 offset:2606
    ds_read_u16_d16_hi v35, v184 offset:3806
    ds_read_u16_d16_hi v36, v184 offset:208
    ds_read_u16_d16_hi v37, v184 offset:1408
    ds_read_u16_d16_hi v38, v184 offset:2608
    ds_read_u16_d16_hi v39, v184 offset:3808
    ds_read_u16_d16_hi v40, v184 offset:210
    ds_read_u16_d16_hi v41, v184 offset:1410
    ds_read_u16_d16_hi v42, v184 offset:2610
    ds_read_u16_d16_hi v43, v184 offset:3810
    ds_read_u16_d16_hi v48, v184 offset:406
    ds_read_u16_d16_hi v49, v184 offset:1606
    ds_read_u16_d16_hi v50, v184 offset:2806
    ds_read_u16_d16_hi v51, v184 offset:4006
    ds_read_u16_d16_hi v52, v184 offset:408
    ds_read_u16_d16_hi v53, v184 offset:1608
    ds_read_u16_d16_hi v54, v184 offset:2808
    ds_read_u16_d16_hi v55, v184 offset:4008
    ds_read_u16_d16_hi v56, v184 offset:410
    ds_read_u16_d16_hi v57, v184 offset:1610
    ds_read_u16_d16_hi v58, v184 offset:2810
    ds_read_u16_d16_hi v59, v184 offset:4010
    ds_read_u16_d16_hi v64, v184 offset:608
    ds_read_u16_d16_hi v65, v184 offset:1808
    ds_read_u16_d16_hi v66, v184 offset:3008
    ds_read_u16_d16_hi v67, v184 offset:4208
    ds_read_u16_d16_hi v68, v184 offset:610
    ds_read_u16_d16_hi v69, v184 offset:1810
    ds_read_u16_d16_hi v70, v184 offset:3010
    ds_read_u16_d16_hi v71, v184 offset:4210
    ds_read_u16_d16_hi v76, v184 offset:810
    ds_read_u16_d16_hi v77, v184 offset:2010
    ds_read_u16_d16_hi v78, v184 offset:3210
    ds_read_u16_d16_hi v79, v184 offset:4410
    ds_read_u16_d16_hi v0, v184 offset:0
    ds_read_u16_d16_hi v1, v184 offset:1200
    ds_read_u16_d16_hi v2, v184 offset:2400
    ds_read_u16_d16_hi v3, v184 offset:3600
    ds_read_u16_d16_hi v24, v184 offset:202
    ds_read_u16_d16_hi v25, v184 offset:1402
    ds_read_u16_d16_hi v26, v184 offset:2602
    ds_read_u16_d16_hi v27, v184 offset:3802
    ds_read_u16_d16_hi v44, v184 offset:404
    ds_read_u16_d16_hi v45, v184 offset:1604
    ds_read_u16_d16_hi v46, v184 offset:2804
    ds_read_u16_d16_hi v47, v184 offset:4004
    ds_read_u16_d16_hi v60, v184 offset:606
    ds_read_u16_d16_hi v61, v184 offset:1806
    ds_read_u16_d16_hi v62, v184 offset:3006
    ds_read_u16_d16_hi v63, v184 offset:4206
    ds_read_u16_d16_hi v72, v184 offset:808
    ds_read_u16_d16_hi v73, v184 offset:2008
    ds_read_u16_d16_hi v74, v184 offset:3208
    ds_read_u16_d16_hi v75, v184 offset:4408
    ds_read_u16_d16_hi v80, v184 offset:1010
    ds_read_u16_d16_hi v81, v184 offset:2210
    ds_read_u16_d16_hi v82, v184 offset:3410
    ds_read_u16_d16_hi v83, v184 offset:4610
    s_waitcnt vmcnt(9) lgkmcnt(15)
    v_lshlrev_b32 v200, 16, v96
    v_add_f32 v4, v4, v200
    v_lshlrev_b32 v201, 16, v99
    v_add_f32 v5, v5, v201
    v_lshlrev_b32 v200, 16, v100
    v_add_f32 v6, v6, v200
    v_lshlrev_b32 v201, 16, v103
    v_add_f32 v7, v7, v201
    v_lshlrev_b32 v200, 16, v104
    v_add_f32 v8, v8, v200
    v_lshlrev_b32 v201, 16, v107
    v_add_f32 v9, v9, v201
    v_lshlrev_b32 v200, 16, v108
    v_add_f32 v10, v10, v200
    v_lshlrev_b32 v201, 16, v111
    v_add_f32 v11, v11, v201
    v_lshlrev_b32 v200, 16, v112
    v_add_f32 v12, v12, v200
    v_lshlrev_b32 v201, 16, v115
    v_add_f32 v13, v13, v201
    v_lshlrev_b32 v200, 16, v118
    v_add_f32 v14, v14, v200
    v_lshlrev_b32 v201, 16, v121
    v_add_f32 v15, v15, v201
    v_lshlrev_b32 v200, 16, v124
    v_add_f32 v16, v16, v200
    v_lshlrev_b32 v201, 16, v127
    v_add_f32 v17, v17, v201
    v_lshlrev_b32 v200, 16, v130
    v_add_f32 v18, v18, v200
    v_lshlrev_b32 v201, 16, v133
    v_add_f32 v19, v19, v201
    v_lshlrev_b32 v200, 16, v136
    v_add_f32 v20, v20, v200
    v_lshlrev_b32 v201, 16, v139
    v_add_f32 v21, v21, v201
    v_lshlrev_b32 v200, 16, v142
    v_add_f32 v22, v22, v200
    v_lshlrev_b32 v201, 16, v145
    v_add_f32 v23, v23, v201
    v_and_b32 v200, 0xffff0000, v104
    v_add_f32 v28, v28, v200
    v_and_b32 v201, 0xffff0000, v107
    v_add_f32 v29, v29, v201
    v_and_b32 v200, 0xffff0000, v108
    v_add_f32 v30, v30, v200
    v_and_b32 v201, 0xffff0000, v111
    v_add_f32 v31, v31, v201
    v_and_b32 v200, 0xffff0000, v112
    v_add_f32 v32, v32, v200
    v_and_b32 v201, 0xffff0000, v115
    v_add_f32 v33, v33, v201
    v_and_b32 v200, 0xffff0000, v118
    v_add_f32 v34, v34, v200
    v_and_b32 v201, 0xffff0000, v121
    v_add_f32 v35, v35, v201
    v_and_b32 v200, 0xffff0000, v124
    v_add_f32 v36, v36, v200
    v_and_b32 v201, 0xffff0000, v127
    v_add_f32 v37, v37, v201
    v_and_b32 v200, 0xffff0000, v130
    v_add_f32 v38, v38, v200
    v_and_b32 v201, 0xffff0000, v133
    v_add_f32 v39, v39, v201
    v_and_b32 v200, 0xffff0000, v136
    v_add_f32 v40, v40, v200
    v_and_b32 v201, 0xffff0000, v139
    v_add_f32 v41, v41, v201
    v_and_b32 v200, 0xffff0000, v142
    v_add_f32 v42, v42, v200
    v_and_b32 v201, 0xffff0000, v145
    v_add_f32 v43, v43, v201
    v_lshlrev_b32 v200, 16, v113
    v_add_f32 v48, v48, v200
    v_lshlrev_b32 v201, 16, v116
    v_add_f32 v49, v49, v201
    v_lshlrev_b32 v200, 16, v119
    v_add_f32 v50, v50, v200
    v_lshlrev_b32 v201, 16, v122
    v_add_f32 v51, v51, v201
    v_lshlrev_b32 v200, 16, v125
    v_add_f32 v52, v52, v200
    v_lshlrev_b32 v201, 16, v128
    v_add_f32 v53, v53, v201
    v_lshlrev_b32 v200, 16, v131
    v_add_f32 v54, v54, v200
    v_lshlrev_b32 v201, 16, v134
    v_add_f32 v55, v55, v201
    v_lshlrev_b32 v200, 16, v137
    v_add_f32 v56, v56, v200
    v_lshlrev_b32 v201, 16, v140
    v_add_f32 v57, v57, v201
    v_lshlrev_b32 v200, 16, v143
    v_add_f32 v58, v58, v200
    v_lshlrev_b32 v201, 16, v146
    v_add_f32 v59, v59, v201
    v_and_b32 v200, 0xffff0000, v125
    v_add_f32 v64, v64, v200
    v_and_b32 v201, 0xffff0000, v128
    v_add_f32 v65, v65, v201
    v_and_b32 v200, 0xffff0000, v131
    v_add_f32 v66, v66, v200
    v_and_b32 v201, 0xffff0000, v134
    v_add_f32 v67, v67, v201
    v_and_b32 v200, 0xffff0000, v137
    v_add_f32 v68, v68, v200
    v_and_b32 v201, 0xffff0000, v140
    v_add_f32 v69, v69, v201
    v_and_b32 v200, 0xffff0000, v143
    v_add_f32 v70, v70, v200
    v_and_b32 v201, 0xffff0000, v146
    v_add_f32 v71, v71, v201
    v_lshlrev_b32 v200, 16, v138
    v_add_f32 v76, v76, v200
    v_lshlrev_b32 v201, 16, v141
    v_add_f32 v77, v77, v201
    v_lshlrev_b32 v200, 16, v144
    v_add_f32 v78, v78, v200
    v_lshlrev_b32 v201, 16, v147
    v_add_f32 v79, v79, v201
    v_lshlrev_b32 v200, 16, v188
    v_add_f32 v84, v84, v200
    v_and_b32 v201, 0xffff0000, v188
    v_add_f32 v85, v85, v201
    v_lshlrev_b32 v200, 16, v189
    v_add_f32 v86, v86, v200
    v_and_b32 v201, 0xffff0000, v189
    v_add_f32 v87, v87, v201
    v_lshlrev_b32 v200, 16, v190
    v_add_f32 v88, v88, v200
    v_and_b32 v201, 0xffff0000, v190
    v_add_f32 v89, v89, v201
    v_mad_u32_u24 v192, v192, s57, v244
    v_mad_u32_u24 v193, v193, s57, v244
    v_mad_u32_u24 v194, v194, s57, v244
    v_mad_u32_u24 v195, v195, s57, v244
    v_mad_u32_u24 v196, v196, s57, v244
    v_mad_u32_u24 v197, v197, s57, v244
    v_mad_u32_u24 v198, v198, s57, v244
    v_cndmask_b32 v93, 0, v90, s[68:69]
    v_cndmask_b32 v92, 0, v90, s[66:67]
    v_cndmask_b32 v91, 0, v90, s[62:63]
    v_cndmask_b32 v90, 0, v90, s[60:61]
    s_waitcnt lgkmcnt(0)
    s_lshl_b32 s80, s24, 16
    s_and_b32 s81, s24, 0xffff0000
    s_lshl_b32 s82, s25, 16
    s_and_b32 s83, s25, 0xffff0000
    s_barrier
    s_setprio 0
    ds_read_b128 v[96:99], v192 offset:0
    ds_read_b128 v[100:103], v192 offset:64
    ds_read_b128 v[104:107], v193 offset:0
    ds_read_b128 v[108:111], v193 offset:64
    ds_read_b128 v[112:115], v194 offset:0
    ds_read_b128 v[116:119], v194 offset:64
    ds_read_b128 v[128:131], v195 offset:0
    ds_read_b128 v[132:135], v195 offset:64
    ds_read_b128 v[144:147], v196 offset:0
    ds_read_b128 v[148:151], v196 offset:64
    ds_read_b128 v[160:163], v197 offset:0
    ds_read_b128 v[164:167], v197 offset:64
    ds_read_b128 v[176:179], v198 offset:0
    ds_read_b128 v[180:183], v198 offset:64
    s_waitcnt vmcnt(7) lgkmcnt(0)
standalone__deep_cross_pnn__recsys_kernel_loop:
    v_mfma_f32_16x16x32_bf16 v[184:187], v[96:99], v[96:99], 0
    v_fmac_f32 v240, v188, v64
    v_fmac_f32 v240, v189, v65
    v_mfma_f32_16x16x32_bf16 v[184:187], v[100:103], v[100:103], v[184:187]
    v_fmac_f32 v240, v190, v66
    v_fmac_f32 v240, v191, v67
    v_mfma_f32_16x16x32_bf16 v[188:191], v[96:99], v[104:107], 0
    v_fmac_f32 v240, v192, v68
    v_fmac_f32 v240, v193, v69
    v_fmac_f32 v240, v194, v70
    v_fmac_f32 v240, v195, v71
    v_mad_u32_u24 v220, v220, s57, v244
    v_mfma_f32_16x16x32_bf16 v[188:191], v[100:103], v[108:111], v[188:191]
    ds_read_b128 v[120:123], v220 offset:0
    ds_read_b128 v[124:127], v220 offset:64
    v_mfma_f32_16x16x32_bf16 v[192:195], v[96:99], v[112:115], 0
    v_fmac_f32 v240, v196, v72
    v_fmac_f32 v240, v197, v73
    v_mfma_f32_16x16x32_bf16 v[192:195], v[100:103], v[116:119], v[192:195]
    v_fmac_f32 v240, v198, v74
    v_fmac_f32 v240, v199, v75
    v_mfma_f32_16x16x32_bf16 v[196:199], v[176:179], v[96:99], 0
    v_fmac_f32 v240, v200, v76
    v_fmac_f32 v240, v201, v77
    v_mfma_f32_16x16x32_bf16 v[196:199], v[180:183], v[100:103], v[196:199]
    v_fmac_f32 v240, v202, v78
    v_fmac_f32 v240, v203, v79
    v_mad_u32_u24 v221, v221, s57, v244
    v_mfma_f32_16x16x32_bf16 v[200:203], v[96:99], v[128:131], 0
    ds_read_b128 v[136:139], v221 offset:0
    ds_read_b128 v[140:143], v221 offset:64
    v_mfma_f32_16x16x32_bf16 v[200:203], v[100:103], v[132:135], v[200:203]
    v_fmac_f32 v240, v204, v80
    v_fmac_f32 v240, v205, v81
    v_fmac_f32 v240, v206, v82
    v_fmac_f32 v240, v207, v83
    v_mfma_f32_16x16x32_bf16 v[204:207], v[96:99], v[144:147], 0
    v_mad_u32_u24 v218, v218, s57, v244
    v_mul_f32 v237, v184, v0
    v_mfma_f32_16x16x32_bf16 v[204:207], v[100:103], v[148:151], v[204:207]
    v_fmac_f32 v237, v185, v1
    v_fmac_f32 v237, v186, v2
    v_mfma_f32_16x16x32_bf16 v[208:211], v[96:99], v[160:163], 0
    v_fmac_f32 v237, v187, v3
    v_fmac_f32 v237, v188, v4
    v_mfma_f32_16x16x32_bf16 v[208:211], v[100:103], v[164:167], v[208:211]
    ds_read_b128 v[96:99], v218 offset:0
    ds_read_b128 v[100:103], v218 offset:64
    v_mfma_f32_16x16x32_bf16 v[184:187], v[104:107], v[104:107], 0
    v_fmac_f32 v237, v189, v5
    v_fmac_f32 v237, v190, v6
    v_mfma_f32_16x16x32_bf16 v[184:187], v[108:111], v[108:111], v[184:187]
    v_fmac_f32 v237, v191, v7
    v_fmac_f32 v237, v192, v8
    v_mfma_f32_16x16x32_bf16 v[188:191], v[104:107], v[112:115], 0
    v_fmac_f32 v237, v193, v9
    v_fmac_f32 v237, v194, v10
    v_mfma_f32_16x16x32_bf16 v[188:191], v[108:111], v[116:119], v[188:191]
    v_fmac_f32 v237, v195, v11
    v_mad_u32_u24 v222, v222, s57, v244
    v_mfma_f32_16x16x32_bf16 v[192:195], v[176:179], v[104:107], 0
    v_fmac_f32 v237, v196, v84
    v_fmac_f32 v237, v200, v12
    v_mfma_f32_16x16x32_bf16 v[192:195], v[180:183], v[108:111], v[192:195]
    ds_read_b128 v[152:155], v222 offset:0
    ds_read_b128 v[156:159], v222 offset:64
    v_mfma_f32_16x16x32_bf16 v[196:199], v[104:107], v[128:131], 0
    v_fmac_f32 v237, v201, v13
    v_fmac_f32 v237, v202, v14
    v_mfma_f32_16x16x32_bf16 v[196:199], v[108:111], v[132:135], v[196:199]
    v_fmac_f32 v237, v203, v15
    v_fmac_f32 v237, v204, v16
    v_mfma_f32_16x16x32_bf16 v[200:203], v[104:107], v[144:147], 0
    v_fmac_f32 v237, v205, v17
    v_fmac_f32 v237, v206, v18
    v_mfma_f32_16x16x32_bf16 v[200:203], v[108:111], v[148:151], v[200:203]
    v_fmac_f32 v237, v207, v19
    v_mad_u32_u24 v219, v219, s57, v244
    v_mfma_f32_16x16x32_bf16 v[204:207], v[104:107], v[160:163], 0
    v_fmac_f32 v237, v208, v20
    v_fmac_f32 v237, v209, v21
    v_fmac_f32 v237, v210, v22
    v_fmac_f32 v237, v211, v23
    v_mfma_f32_16x16x32_bf16 v[204:207], v[108:111], v[164:167], v[204:207]
    ds_read_b128 v[104:107], v219 offset:0
    ds_read_b128 v[108:111], v219 offset:64
    v_mfma_f32_16x16x32_bf16 v[208:211], v[112:115], v[112:115], 0
    v_fmac_f32 v237, v184, v24
    v_fmac_f32 v237, v185, v25
    v_mfma_f32_16x16x32_bf16 v[208:211], v[116:119], v[116:119], v[208:211]
    v_fmac_f32 v237, v186, v26
    v_fmac_f32 v237, v187, v27
    v_mfma_f32_16x16x32_bf16 v[184:187], v[176:179], v[112:115], 0
    v_fmac_f32 v237, v188, v28
    v_fmac_f32 v237, v189, v29
    v_mfma_f32_16x16x32_bf16 v[184:187], v[180:183], v[116:119], v[184:187]
    v_fmac_f32 v237, v190, v30
    v_fmac_f32 v237, v191, v31
    v_mfma_f32_16x16x32_bf16 v[188:191], v[112:115], v[128:131], 0
    v_permlane32_swap_b32 v239, v240
    v_mad_u32_u24 v223, v223, s57, v244
    v_fmac_f32 v237, v192, v85
    v_mfma_f32_16x16x32_bf16 v[188:191], v[116:119], v[132:135], v[188:191]
    ds_read_b128 v[168:171], v223 offset:0
    ds_read_b128 v[172:175], v223 offset:64
    v_mfma_f32_16x16x32_bf16 v[192:195], v[112:115], v[144:147], 0
    v_add_f32 v242, v239, v240
    v_fmac_f32 v237, v196, v32
    v_fmac_f32 v237, v197, v33
    v_fmac_f32 v237, v198, v34
    v_fmac_f32 v237, v199, v35
    v_mfma_f32_16x16x32_bf16 v[192:195], v[116:119], v[148:151], v[192:195]
    buffer_load_dwordx4 v[218:221], v245, s[16:19], s74 offen offset:2000
    buffer_load_dwordx2 v[222:223], v245, s[16:19], s74 offen offset:2016
    v_mfma_f32_16x16x32_bf16 v[196:199], v[176:179], v[128:131], 0
    v_permlane16_swap_b32 v241, v242
    v_mfma_f32_16x16x32_bf16 v[196:199], v[180:183], v[132:135], v[196:199]
    v_fmac_f32 v237, v200, v36
    v_fmac_f32 v237, v201, v37
    v_fmac_f32 v237, v202, v38
    v_fmac_f32 v237, v203, v39
    v_mfma_f32_16x16x32_bf16 v[200:203], v[112:115], v[160:163], 0
    v_add_f32 v241, v241, v242
    v_fmac_f32 v237, v204, v40
    v_mfma_f32_16x16x32_bf16 v[200:203], v[116:119], v[164:167], v[200:203]
    v_fmac_f32 v237, v205, v41
    v_fmac_f32 v237, v206, v42
    v_fmac_f32 v237, v207, v43
    v_mfma_f32_16x16x32_bf16 v[204:207], v[128:131], v[128:131], 0
    v_add_f32_dpp v241, v241, v241 row_ror:8 row_mask:0xf bank_mask:0xf
    v_fmac_f32 v237, v208, v44
    v_mfma_f32_16x16x32_bf16 v[204:207], v[132:135], v[132:135], v[204:207]
    v_fmac_f32 v237, v209, v45
    v_fmac_f32 v237, v210, v46
    v_fmac_f32 v237, v211, v47
    v_mfma_f32_16x16x32_bf16 v[208:211], v[176:179], v[144:147], 0
    v_add_f32_dpp v241, v241, v241 row_ror:4 row_mask:0xf bank_mask:0xf
    v_fmac_f32 v237, v184, v86
    v_mfma_f32_16x16x32_bf16 v[208:211], v[180:183], v[148:151], v[208:211]
    v_fmac_f32 v237, v188, v48
    v_fmac_f32 v237, v189, v49
    v_mfma_f32_16x16x32_bf16 v[184:187], v[128:131], v[144:147], 0
    v_add_f32_dpp v241, v241, v241 row_ror:2 row_mask:0xf bank_mask:0xf
    v_fmac_f32 v237, v190, v50
    v_mfma_f32_16x16x32_bf16 v[184:187], v[132:135], v[148:151], v[184:187]
    v_fmac_f32 v237, v191, v51
    v_fmac_f32 v237, v192, v52
    v_mfma_f32_16x16x32_bf16 v[188:191], v[128:131], v[160:163], 0
    v_add_f32_dpp v241, v241, v241 row_ror:1 row_mask:0xf bank_mask:0xf
    v_fmac_f32 v237, v193, v53
    v_mfma_f32_16x16x32_bf16 v[188:191], v[132:135], v[164:167], v[188:191]
    v_fmac_f32 v237, v194, v54
    v_fmac_f32 v237, v195, v55
    v_mfma_f32_16x16x32_bf16 v[192:195], v[176:179], v[160:163], 0
    v_cndmask_b32 v243, v243, v241, s[70:71]
    v_fmac_f32 v237, v196, v87
    v_mfma_f32_16x16x32_bf16 v[192:195], v[180:183], v[164:167], v[192:195]
    s_lshl_b64 s[70:71], s[70:71], 1
    v_fmac_f32 v237, v200, v56
    v_mfma_f32_16x16x32_bf16 v[196:199], v[144:147], v[144:147], 0
    v_fmac_f32 v237, v201, v57
    v_fmac_f32 v237, v202, v58
    v_mfma_f32_16x16x32_bf16 v[196:199], v[148:151], v[148:151], v[196:199]
    v_fmac_f32 v237, v203, v59
    v_fmac_f32 v237, v204, v60
    v_mfma_f32_16x16x32_bf16 v[200:203], v[144:147], v[160:163], 0
    v_fmac_f32 v237, v205, v61
    v_fmac_f32 v237, v206, v62
    v_mfma_f32_16x16x32_bf16 v[200:203], v[148:151], v[164:167], v[200:203]
    v_fmac_f32 v237, v207, v63
    v_fmac_f32 v237, v208, v88
    v_mfma_f32_16x16x32_bf16 v[204:207], v[160:163], v[160:163], 0
    v_fmac_f32 v237, v184, v64
    v_fmac_f32 v237, v185, v65
    v_mfma_f32_16x16x32_bf16 v[204:207], v[164:167], v[164:167], v[204:207]
    v_fmac_f32 v237, v186, v66
    s_waitcnt vmcnt(7) lgkmcnt(0)
    v_mfma_f32_16x16x32_bf16 v[208:211], v[96:99], v[96:99], 0
    v_fmac_f32 v237, v187, v67
    v_mad_u32_u24 v226, v226, s57, v244
    v_mfma_f32_16x16x32_bf16 v[208:211], v[100:103], v[100:103], v[208:211]
    v_fmac_f32 v237, v188, v68
    v_fmac_f32 v237, v189, v69
    v_mfma_f32_16x16x32_bf16 v[184:187], v[96:99], v[104:107], 0
    v_fmac_f32 v237, v190, v70
    v_fmac_f32 v237, v191, v71
    v_mfma_f32_16x16x32_bf16 v[184:187], v[100:103], v[108:111], v[184:187]
    ds_read_b128 v[112:115], v226 offset:0
    ds_read_b128 v[116:119], v226 offset:64
    v_mfma_f32_16x16x32_bf16 v[188:191], v[96:99], v[120:123], 0
    v_fmac_f32 v237, v192, v89
    v_mad_u32_u24 v227, v227, s57, v244
    v_mfma_f32_16x16x32_bf16 v[188:191], v[100:103], v[124:127], v[188:191]
    v_fmac_f32 v237, v196, v72
    v_fmac_f32 v237, v197, v73
    v_mfma_f32_16x16x32_bf16 v[192:195], v[176:179], v[96:99], 0
    v_fmac_f32 v237, v198, v74
    v_fmac_f32 v237, v199, v75
    v_mfma_f32_16x16x32_bf16 v[192:195], v[180:183], v[100:103], v[192:195]
    v_fmac_f32 v237, v200, v76
    v_fmac_f32 v237, v201, v77
    v_mfma_f32_16x16x32_bf16 v[196:199], v[96:99], v[136:139], 0
    ds_read_b128 v[128:131], v227 offset:0
    ds_read_b128 v[132:135], v227 offset:64
    v_mfma_f32_16x16x32_bf16 v[196:199], v[100:103], v[140:143], v[196:199]
    v_fmac_f32 v237, v202, v78
    v_fmac_f32 v237, v203, v79
    v_mfma_f32_16x16x32_bf16 v[200:203], v[96:99], v[152:155], 0
    v_fmac_f32 v237, v204, v80
    v_fmac_f32 v237, v205, v81
    v_mfma_f32_16x16x32_bf16 v[200:203], v[100:103], v[156:159], v[200:203]
    v_fmac_f32 v237, v206, v82
    v_fmac_f32 v237, v207, v83
    v_mfma_f32_16x16x32_bf16 v[204:207], v[96:99], v[168:171], 0
    v_mad_u32_u24 v224, v224, s57, v244
    v_mul_f32 v238, v208, v0
    v_fmac_f32 v238, v209, v1
    v_fmac_f32 v238, v210, v2
    v_fmac_f32 v238, v211, v3
    v_mfma_f32_16x16x32_bf16 v[204:207], v[100:103], v[172:175], v[204:207]
    ds_read_b128 v[96:99], v224 offset:0
    ds_read_b128 v[100:103], v224 offset:64
    v_mfma_f32_16x16x32_bf16 v[208:211], v[104:107], v[104:107], 0
    v_fmac_f32 v238, v184, v4
    v_fmac_f32 v238, v185, v5
    v_mfma_f32_16x16x32_bf16 v[208:211], v[108:111], v[108:111], v[208:211]
    v_fmac_f32 v238, v186, v6
    v_fmac_f32 v238, v187, v7
    v_mfma_f32_16x16x32_bf16 v[184:187], v[104:107], v[120:123], 0
    v_fmac_f32 v238, v188, v8
    v_fmac_f32 v238, v189, v9
    v_mfma_f32_16x16x32_bf16 v[184:187], v[108:111], v[124:127], v[184:187]
    v_fmac_f32 v238, v190, v10
    v_fmac_f32 v238, v191, v11
    v_mfma_f32_16x16x32_bf16 v[188:191], v[176:179], v[104:107], 0
    v_mad_u32_u24 v228, v228, s57, v244
    v_fmac_f32 v238, v193, v84
    v_mfma_f32_16x16x32_bf16 v[188:191], v[180:183], v[108:111], v[188:191]
    ds_read_b128 v[144:147], v228 offset:0
    ds_read_b128 v[148:151], v228 offset:64
    v_mfma_f32_16x16x32_bf16 v[192:195], v[104:107], v[136:139], 0
    v_fmac_f32 v238, v196, v12
    v_fmac_f32 v238, v197, v13
    v_mfma_f32_16x16x32_bf16 v[192:195], v[108:111], v[140:143], v[192:195]
    v_fmac_f32 v238, v198, v14
    v_fmac_f32 v238, v199, v15
    v_mfma_f32_16x16x32_bf16 v[196:199], v[104:107], v[152:155], 0
    v_fmac_f32 v238, v200, v16
    v_fmac_f32 v238, v201, v17
    v_mfma_f32_16x16x32_bf16 v[196:199], v[108:111], v[156:159], v[196:199]
    v_fmac_f32 v238, v202, v18
    v_fmac_f32 v238, v203, v19
    v_mfma_f32_16x16x32_bf16 v[200:203], v[104:107], v[168:171], 0
    v_mad_u32_u24 v225, v225, s57, v244
    v_fmac_f32 v238, v204, v20
    v_fmac_f32 v238, v205, v21
    v_fmac_f32 v238, v206, v22
    v_fmac_f32 v238, v207, v23
    v_mfma_f32_16x16x32_bf16 v[200:203], v[108:111], v[172:175], v[200:203]
    ds_read_b128 v[104:107], v225 offset:0
    ds_read_b128 v[108:111], v225 offset:64
    v_mfma_f32_16x16x32_bf16 v[204:207], v[120:123], v[120:123], 0
    v_fmac_f32 v238, v208, v24
    v_fmac_f32 v238, v209, v25
    v_mfma_f32_16x16x32_bf16 v[204:207], v[124:127], v[124:127], v[204:207]
    v_fmac_f32 v238, v210, v26
    v_fmac_f32 v238, v211, v27
    v_fmac_f32 v238, v184, v28
    v_fmac_f32 v238, v185, v29
    v_fmac_f32 v238, v186, v30
    v_fmac_f32 v238, v187, v31
    v_mfma_f32_16x16x32_bf16 v[184:187], v[176:179], v[120:123], 0
    v_fmac_f32 v238, v189, v85
    v_mad_u32_u24 v229, v229, s57, v244
    v_mfma_f32_16x16x32_bf16 v[184:187], v[180:183], v[124:127], v[184:187]
    v_fmac_f32 v238, v192, v32
    v_fmac_f32 v238, v193, v33
    v_mfma_f32_16x16x32_bf16 v[188:191], v[120:123], v[136:139], 0
    v_fmac_f32 v238, v194, v34
    v_fmac_f32 v238, v195, v35
    v_mfma_f32_16x16x32_bf16 v[188:191], v[124:127], v[140:143], v[188:191]
    ds_read_b128 v[160:163], v229 offset:0
    ds_read_b128 v[164:167], v229 offset:64
    v_mfma_f32_16x16x32_bf16 v[192:195], v[120:123], v[152:155], 0
    v_fmac_f32 v238, v196, v36
    v_fmac_f32 v238, v197, v37
    v_fmac_f32 v238, v198, v38
    v_fmac_f32 v238, v199, v39
    v_mfma_f32_16x16x32_bf16 v[192:195], v[124:127], v[156:159], v[192:195]
    buffer_load_dwordx4 v[224:227], v245, s[16:19], s74 offen offset:2400
    buffer_load_dwordx2 v[228:229], v245, s[16:19], s74 offen offset:2416
    v_mfma_f32_16x16x32_bf16 v[196:199], v[176:179], v[136:139], 0
    v_fmac_f32 v238, v200, v40
    v_fmac_f32 v238, v201, v41
    v_mfma_f32_16x16x32_bf16 v[196:199], v[180:183], v[140:143], v[196:199]
    v_fmac_f32 v238, v202, v42
    v_fmac_f32 v238, v203, v43
    v_mfma_f32_16x16x32_bf16 v[200:203], v[120:123], v[168:171], 0
    v_fmac_f32 v238, v204, v44
    v_fmac_f32 v238, v205, v45
    v_mfma_f32_16x16x32_bf16 v[200:203], v[124:127], v[172:175], v[200:203]
    v_fmac_f32 v238, v206, v46
    v_fmac_f32 v238, v207, v47
    v_mfma_f32_16x16x32_bf16 v[204:207], v[136:139], v[136:139], 0
    v_fmac_f32 v238, v185, v86
    v_fmac_f32 v238, v188, v48
    v_mfma_f32_16x16x32_bf16 v[204:207], v[140:143], v[140:143], v[204:207]
    v_fmac_f32 v238, v189, v49
    v_fmac_f32 v238, v190, v50
    v_mfma_f32_16x16x32_bf16 v[208:211], v[176:179], v[176:179], 0
    v_fmac_f32 v238, v191, v51
    v_fmac_f32 v238, v192, v52
    v_mfma_f32_16x16x32_bf16 v[208:211], v[180:183], v[180:183], v[208:211]
    v_fmac_f32 v238, v193, v53
    v_fmac_f32 v238, v194, v54
    v_mfma_f32_16x16x32_bf16 v[184:187], v[176:179], v[152:155], 0
    v_fmac_f32 v238, v195, v55
    v_fmac_f32 v238, v197, v87
    v_mfma_f32_16x16x32_bf16 v[184:187], v[180:183], v[156:159], v[184:187]
    v_fmac_f32 v238, v200, v56
    v_fmac_f32 v238, v201, v57
    v_mfma_f32_16x16x32_bf16 v[188:191], v[136:139], v[152:155], 0
    v_fmac_f32 v238, v202, v58
    v_fmac_f32 v238, v203, v59
    v_mfma_f32_16x16x32_bf16 v[188:191], v[140:143], v[156:159], v[188:191]
    v_fmac_f32 v238, v204, v60
    v_fmac_f32 v238, v205, v61
    v_mfma_f32_16x16x32_bf16 v[192:195], v[136:139], v[168:171], 0
    v_fmac_f32 v238, v206, v62
    v_fmac_f32 v238, v207, v63
    v_mfma_f32_16x16x32_bf16 v[192:195], v[140:143], v[172:175], v[192:195]
    v_fmac_f32 v237, v208, v90
    v_fmac_f32 v238, v209, v91
    v_mfma_f32_16x16x32_bf16 v[196:199], v[176:179], v[168:171], 0
    v_mul_f32 v239, v210, v92
    v_mul_f32 v240, v211, v93
    v_mfma_f32_16x16x32_bf16 v[196:199], v[180:183], v[172:175], v[196:199]
    v_fmac_f32 v238, v185, v88
    v_fmac_f32 v238, v188, v64
    v_mfma_f32_16x16x32_bf16 v[200:203], v[152:155], v[152:155], 0
    v_fmac_f32 v238, v189, v65
    v_fmac_f32 v238, v190, v66
    v_mfma_f32_16x16x32_bf16 v[200:203], v[156:159], v[156:159], v[200:203]
    v_fmac_f32 v238, v191, v67
    v_fmac_f32 v238, v192, v68
    v_mfma_f32_16x16x32_bf16 v[204:207], v[152:155], v[168:171], 0
    v_fmac_f32 v238, v193, v69
    v_fmac_f32 v238, v194, v70
    v_mfma_f32_16x16x32_bf16 v[204:207], v[156:159], v[172:175], v[204:207]
    v_fmac_f32 v238, v195, v71
    v_fmac_f32 v238, v197, v89
    v_mfma_f32_16x16x32_bf16 v[208:211], v[168:171], v[168:171], 0
    v_fmac_f32 v238, v200, v72
    v_fmac_f32 v238, v201, v73
    v_mfma_f32_16x16x32_bf16 v[208:211], v[172:175], v[172:175], v[208:211]
    v_fmac_f32 v238, v202, v74
    s_waitcnt vmcnt(7) lgkmcnt(0)
    v_mfma_f32_16x16x32_bf16 v[184:187], v[96:99], v[96:99], 0
    v_mad_u32_u24 v232, v232, s57, v244
    v_mad_u32_u24 v233, v233, s57, v244
    v_mfma_f32_16x16x32_bf16 v[184:187], v[100:103], v[100:103], v[184:187]
    v_fmac_f32 v238, v203, v75
    v_fmac_f32 v238, v204, v76
    v_mfma_f32_16x16x32_bf16 v[188:191], v[96:99], v[104:107], 0
    v_fmac_f32 v238, v205, v77
    v_fmac_f32 v238, v206, v78
    v_mfma_f32_16x16x32_bf16 v[188:191], v[100:103], v[108:111], v[188:191]
    ds_read_b128 v[120:123], v232 offset:0
    ds_read_b128 v[124:127], v232 offset:64
    v_mfma_f32_16x16x32_bf16 v[192:195], v[96:99], v[112:115], 0
    v_fmac_f32 v238, v207, v79
    v_fmac_f32 v238, v208, v80
    v_mfma_f32_16x16x32_bf16 v[192:195], v[100:103], v[116:119], v[192:195]
    v_fmac_f32 v238, v209, v81
    v_fmac_f32 v238, v210, v82
    v_mfma_f32_16x16x32_bf16 v[196:199], v[176:179], v[96:99], 0
    v_fmac_f32 v238, v211, v83
    v_mad_u32_u24 v230, v230, s57, v244
    v_mfma_f32_16x16x32_bf16 v[196:199], v[180:183], v[100:103], v[196:199]
    v_fmac_f32 v239, v184, v0
    v_fmac_f32 v239, v185, v1
    v_mfma_f32_16x16x32_bf16 v[200:203], v[96:99], v[128:131], 0
    ds_read_b128 v[136:139], v233 offset:0
    ds_read_b128 v[140:143], v233 offset:64
    v_mfma_f32_16x16x32_bf16 v[200:203], v[100:103], v[132:135], v[200:203]
    v_fmac_f32 v239, v186, v2
    v_fmac_f32 v239, v187, v3
    v_mfma_f32_16x16x32_bf16 v[204:207], v[96:99], v[144:147], 0
    v_fmac_f32 v239, v188, v4
    v_fmac_f32 v239, v189, v5
    v_mfma_f32_16x16x32_bf16 v[204:207], v[100:103], v[148:151], v[204:207]
    v_fmac_f32 v239, v190, v6
    v_fmac_f32 v239, v191, v7
    v_mfma_f32_16x16x32_bf16 v[208:211], v[96:99], v[160:163], 0
    v_fmac_f32 v239, v192, v8
    v_fmac_f32 v239, v193, v9
    v_mfma_f32_16x16x32_bf16 v[208:211], v[100:103], v[164:167], v[208:211]
    ds_read_b128 v[96:99], v230 offset:0
    ds_read_b128 v[100:103], v230 offset:64
    v_mfma_f32_16x16x32_bf16 v[184:187], v[104:107], v[104:107], 0
    v_fmac_f32 v239, v194, v10
    v_fmac_f32 v239, v195, v11
    v_mfma_f32_16x16x32_bf16 v[184:187], v[108:111], v[108:111], v[184:187]
    v_mad_u32_u24 v234, v234, s57, v244
    v_fmac_f32 v239, v198, v84
    v_mfma_f32_16x16x32_bf16 v[188:191], v[104:107], v[112:115], 0
    v_fmac_f32 v239, v200, v12
    v_fmac_f32 v239, v201, v13
    v_mfma_f32_16x16x32_bf16 v[188:191], v[108:111], v[116:119], v[188:191]
    v_fmac_f32 v239, v202, v14
    v_fmac_f32 v239, v203, v15
    v_mfma_f32_16x16x32_bf16 v[192:195], v[176:179], v[104:107], 0
    v_fmac_f32 v239, v204, v16
    v_fmac_f32 v239, v205, v17
    v_mfma_f32_16x16x32_bf16 v[192:195], v[180:183], v[108:111], v[192:195]
    ds_read_b128 v[152:155], v234 offset:0
    ds_read_b128 v[156:159], v234 offset:64
    v_mfma_f32_16x16x32_bf16 v[196:199], v[104:107], v[128:131], 0
    v_fmac_f32 v239, v206, v18
    v_fmac_f32 v239, v207, v19
    v_mfma_f32_16x16x32_bf16 v[196:199], v[108:111], v[132:135], v[196:199]
    v_mad_u32_u24 v231, v231, s57, v244
    v_fmac_f32 v239, v208, v20
    v_mfma_f32_16x16x32_bf16 v[200:203], v[104:107], v[144:147], 0
    v_fmac_f32 v239, v209, v21
    v_fmac_f32 v239, v210, v22
    v_mfma_f32_16x16x32_bf16 v[200:203], v[108:111], v[148:151], v[200:203]
    v_fmac_f32 v239, v211, v23
    v_fmac_f32 v239, v184, v24
    v_mfma_f32_16x16x32_bf16 v[204:207], v[104:107], v[160:163], 0
    v_fmac_f32 v239, v185, v25
    v_fmac_f32 v239, v186, v26
    v_mfma_f32_16x16x32_bf16 v[204:207], v[108:111], v[164:167], v[204:207]
    ds_read_b128 v[104:107], v231 offset:0
    ds_read_b128 v[108:111], v231 offset:64
    v_mfma_f32_16x16x32_bf16 v[208:211], v[112:115], v[112:115], 0
    v_fmac_f32 v239, v187, v27
    v_fmac_f32 v239, v188, v28
    v_mfma_f32_16x16x32_bf16 v[208:211], v[116:119], v[116:119], v[208:211]
    v_fmac_f32 v239, v189, v29
    v_fmac_f32 v239, v190, v30
    v_mfma_f32_16x16x32_bf16 v[184:187], v[176:179], v[112:115], 0
    v_fmac_f32 v239, v191, v31
    v_mad_u32_u24 v235, v235, s57, v244
    v_mfma_f32_16x16x32_bf16 v[184:187], v[180:183], v[116:119], v[184:187]
    v_fmac_f32 v239, v194, v85
    v_fmac_f32 v239, v196, v32
    v_mfma_f32_16x16x32_bf16 v[188:191], v[112:115], v[128:131], 0
    v_fmac_f32 v239, v197, v33
    v_fmac_f32 v239, v198, v34
    v_mfma_f32_16x16x32_bf16 v[188:191], v[116:119], v[132:135], v[188:191]
    ds_read_b128 v[168:171], v235 offset:0
    ds_read_b128 v[172:175], v235 offset:64
    v_mfma_f32_16x16x32_bf16 v[192:195], v[112:115], v[144:147], 0
    v_fmac_f32 v239, v199, v35
    v_fmac_f32 v239, v200, v36
    v_mfma_f32_16x16x32_bf16 v[192:195], v[116:119], v[148:151], v[192:195]
    buffer_load_dwordx4 v[230:233], v245, s[16:19], s74 offen offset:2800
    buffer_load_dwordx2 v[234:235], v245, s[16:19], s74 offen offset:2816
    v_mfma_f32_16x16x32_bf16 v[196:199], v[176:179], v[128:131], 0
    v_fmac_f32 v239, v201, v37
    v_fmac_f32 v239, v202, v38
    v_mfma_f32_16x16x32_bf16 v[196:199], v[180:183], v[132:135], v[196:199]
    v_fmac_f32 v239, v203, v39
    v_fmac_f32 v239, v204, v40
    v_mfma_f32_16x16x32_bf16 v[200:203], v[112:115], v[160:163], 0
    v_fmac_f32 v239, v205, v41
    v_fmac_f32 v239, v206, v42
    v_mfma_f32_16x16x32_bf16 v[200:203], v[116:119], v[164:167], v[200:203]
    v_fmac_f32 v239, v207, v43
    v_fmac_f32 v239, v208, v44
    v_mfma_f32_16x16x32_bf16 v[204:207], v[128:131], v[128:131], 0
    v_fmac_f32 v239, v209, v45
    v_fmac_f32 v239, v210, v46
    v_mfma_f32_16x16x32_bf16 v[204:207], v[132:135], v[132:135], v[204:207]
    v_fmac_f32 v239, v211, v47
    v_fmac_f32 v239, v186, v86
    v_mfma_f32_16x16x32_bf16 v[184:187], v[176:179], v[144:147], 0
    v_fmac_f32 v239, v188, v48
    v_fmac_f32 v239, v189, v49
    v_mfma_f32_16x16x32_bf16 v[184:187], v[180:183], v[148:151], v[184:187]
    v_fmac_f32 v239, v190, v50
    v_fmac_f32 v239, v191, v51
    v_mfma_f32_16x16x32_bf16 v[188:191], v[128:131], v[144:147], 0
    v_fmac_f32 v239, v192, v52
    v_fmac_f32 v239, v193, v53
    v_mfma_f32_16x16x32_bf16 v[188:191], v[132:135], v[148:151], v[188:191]
    v_fmac_f32 v239, v194, v54
    v_fmac_f32 v239, v195, v55
    v_mfma_f32_16x16x32_bf16 v[192:195], v[128:131], v[160:163], 0
    v_fmac_f32 v239, v198, v87
    v_fmac_f32 v239, v200, v56
    v_mfma_f32_16x16x32_bf16 v[192:195], v[132:135], v[164:167], v[192:195]
    v_fmac_f32 v239, v201, v57
    v_fmac_f32 v239, v202, v58
    v_mfma_f32_16x16x32_bf16 v[196:199], v[176:179], v[160:163], 0
    v_fmac_f32 v239, v203, v59
    v_fmac_f32 v239, v204, v60
    v_mfma_f32_16x16x32_bf16 v[196:199], v[180:183], v[164:167], v[196:199]
    v_fmac_f32 v239, v205, v61
    v_fmac_f32 v239, v206, v62
    v_mfma_f32_16x16x32_bf16 v[200:203], v[144:147], v[144:147], 0
    v_fmac_f32 v239, v207, v63
    v_fmac_f32 v239, v186, v88
    v_mfma_f32_16x16x32_bf16 v[200:203], v[148:151], v[148:151], v[200:203]
    v_fmac_f32 v239, v188, v64
    v_fmac_f32 v239, v189, v65
    v_mfma_f32_16x16x32_bf16 v[204:207], v[144:147], v[160:163], 0
    v_fmac_f32 v239, v190, v66
    v_fmac_f32 v239, v191, v67
    v_mfma_f32_16x16x32_bf16 v[204:207], v[148:151], v[164:167], v[204:207]
    v_fmac_f32 v239, v192, v68
    v_fmac_f32 v239, v193, v69
    v_mfma_f32_16x16x32_bf16 v[208:211], v[160:163], v[160:163], 0
    v_fmac_f32 v239, v194, v70
    v_fmac_f32 v239, v195, v71
    v_mfma_f32_16x16x32_bf16 v[208:211], v[164:167], v[164:167], v[208:211]
    v_fmac_f32 v239, v198, v89
    s_waitcnt vmcnt(6) lgkmcnt(0)
    v_mfma_f32_16x16x32_bf16 v[184:187], v[96:99], v[96:99], 0
    v_mad_u32_u24 v214, v214, s57, v244
    v_mad_u32_u24 v215, v215, s57, v244
    v_mfma_f32_16x16x32_bf16 v[184:187], v[100:103], v[100:103], v[184:187]
    v_fmac_f32 v239, v200, v72
    v_fmac_f32 v239, v201, v73
    v_mfma_f32_16x16x32_bf16 v[188:191], v[96:99], v[104:107], 0
    v_fmac_f32 v239, v202, v74
    v_fmac_f32 v239, v203, v75
    v_mfma_f32_16x16x32_bf16 v[188:191], v[100:103], v[108:111], v[188:191]
    ds_read_b128 v[112:115], v214 offset:0
    ds_read_b128 v[116:119], v214 offset:64
    v_mfma_f32_16x16x32_bf16 v[192:195], v[176:179], v[120:123], 0
    v_fmac_f32 v239, v204, v76
    v_fmac_f32 v239, v205, v77
    v_mfma_f32_16x16x32_bf16 v[192:195], v[180:183], v[124:127], v[192:195]
    v_fmac_f32 v239, v206, v78
    v_fmac_f32 v239, v207, v79
    v_mfma_f32_16x16x32_bf16 v[196:199], v[96:99], v[120:123], 0
    v_fmac_f32 v239, v208, v80
    v_fmac_f32 v239, v209, v81
    v_mfma_f32_16x16x32_bf16 v[196:199], v[100:103], v[124:127], v[196:199]
    v_fmac_f32 v239, v210, v82
    v_fmac_f32 v239, v211, v83
    v_mfma_f32_16x16x32_bf16 v[200:203], v[176:179], v[96:99], 0
    ds_read_b128 v[128:131], v215 offset:0
    ds_read_b128 v[132:135], v215 offset:64
    v_mfma_f32_16x16x32_bf16 v[200:203], v[180:183], v[100:103], v[200:203]
    v_fmac_f32 v240, v184, v0
    v_fmac_f32 v240, v185, v1
    v_mfma_f32_16x16x32_bf16 v[204:207], v[96:99], v[136:139], 0
    v_fmac_f32 v240, v186, v2
    v_fmac_f32 v240, v187, v3
    v_mfma_f32_16x16x32_bf16 v[204:207], v[100:103], v[140:143], v[204:207]
    v_fmac_f32 v240, v188, v4
    v_fmac_f32 v240, v189, v5
    v_mfma_f32_16x16x32_bf16 v[208:211], v[176:179], v[136:139], 0
    v_fmac_f32 v240, v190, v6
    v_fmac_f32 v240, v191, v7
    v_mfma_f32_16x16x32_bf16 v[208:211], v[180:183], v[140:143], v[208:211]
    v_mad_u32_u24 v212, v212, s57, v244
    v_fmac_f32 v240, v195, v86
    v_mfma_f32_16x16x32_bf16 v[184:187], v[96:99], v[152:155], 0
    v_mad_u32_u24 v216, v216, s57, v244
    v_fmac_f32 v240, v196, v8
    v_mfma_f32_16x16x32_bf16 v[184:187], v[100:103], v[156:159], v[184:187]
    v_fmac_f32 v240, v197, v9
    v_fmac_f32 v240, v198, v10
    v_mfma_f32_16x16x32_bf16 v[188:191], v[96:99], v[168:171], 0
    v_fmac_f32 v240, v199, v11
    v_fmac_f32 v240, v203, v84
    v_mfma_f32_16x16x32_bf16 v[188:191], v[100:103], v[172:175], v[188:191]
    ds_read_b128 v[96:99], v212 offset:0
    ds_read_b128 v[100:103], v212 offset:64
    v_mfma_f32_16x16x32_bf16 v[192:195], v[104:107], v[104:107], 0
    v_fmac_f32 v240, v204, v12
    v_fmac_f32 v240, v205, v13
    v_mfma_f32_16x16x32_bf16 v[192:195], v[108:111], v[108:111], v[192:195]
    ds_read_b128 v[144:147], v216 offset:0
    ds_read_b128 v[148:151], v216 offset:64
    v_mfma_f32_16x16x32_bf16 v[196:199], v[104:107], v[120:123], 0
    v_fmac_f32 v240, v206, v14
    v_fmac_f32 v240, v207, v15
    v_mfma_f32_16x16x32_bf16 v[196:199], v[108:111], v[124:127], v[196:199]
    v_fmac_f32 v240, v211, v87
    v_fmac_f32 v240, v184, v16
    v_mfma_f32_16x16x32_bf16 v[200:203], v[176:179], v[152:155], 0
    v_fmac_f32 v240, v185, v17
    v_fmac_f32 v240, v186, v18
    v_mfma_f32_16x16x32_bf16 v[200:203], v[180:183], v[156:159], v[200:203]
    v_fmac_f32 v240, v187, v19
    v_fmac_f32 v240, v188, v20
    v_mfma_f32_16x16x32_bf16 v[204:207], v[176:179], v[104:107], 0
    v_fmac_f32 v240, v189, v21
    v_fmac_f32 v240, v190, v22
    v_mfma_f32_16x16x32_bf16 v[204:207], v[180:183], v[108:111], v[204:207]
    v_fmac_f32 v240, v191, v23
    v_mad_u32_u24 v217, v217, s57, v244
    v_mfma_f32_16x16x32_bf16 v[208:211], v[104:107], v[136:139], 0
    v_mad_u32_u24 v236, v236, s57, v244
    v_mad_u32_u24 v213, v213, s57, v244
    v_mfma_f32_16x16x32_bf16 v[208:211], v[108:111], v[140:143], v[208:211]
    v_fmac_f32 v240, v192, v24
    v_fmac_f32 v240, v193, v25
    v_mfma_f32_16x16x32_bf16 v[184:187], v[104:107], v[152:155], 0
    v_fmac_f32 v240, v194, v26
    v_fmac_f32 v240, v195, v27
    v_mfma_f32_16x16x32_bf16 v[184:187], v[108:111], v[156:159], v[184:187]
    v_fmac_f32 v240, v196, v28
    v_fmac_f32 v240, v197, v29
    v_mfma_f32_16x16x32_bf16 v[188:191], v[176:179], v[168:171], 0
    v_fmac_f32 v240, v198, v30
    v_fmac_f32 v240, v199, v31
    v_mfma_f32_16x16x32_bf16 v[188:191], v[180:183], v[172:175], v[188:191]
    ds_read_b128 v[160:163], v217 offset:0
    ds_read_b128 v[164:167], v217 offset:64
    v_mfma_f32_16x16x32_bf16 v[192:195], v[104:107], v[168:171], 0
    ds_read_b128 v[176:179], v236 offset:0
    ds_read_b128 v[180:183], v236 offset:64
    v_mfma_f32_16x16x32_bf16 v[192:195], v[108:111], v[172:175], v[192:195]
    ds_read_b128 v[104:107], v213 offset:0
    ds_read_b128 v[108:111], v213 offset:64
    v_mfma_f32_16x16x32_bf16 v[196:199], v[120:123], v[120:123], 0
    v_fmac_f32 v240, v203, v88
    v_fmac_f32 v240, v207, v85
    v_mfma_f32_16x16x32_bf16 v[196:199], v[124:127], v[124:127], v[196:199]
    buffer_load_dwordx4 v[212:215], v245, s[16:19], s74 offen offset:3200
    buffer_load_dwordx2 v[216:217], v245, s[16:19], s74 offen offset:3216
    buffer_load_dword v236, v246, s[16:19], s74 offen offset:3584
    v_mfma_f32_16x16x32_bf16 v[200:203], v[120:123], v[136:139], 0
    v_fmac_f32 v240, v208, v32
    v_fmac_f32 v240, v209, v33
    v_mfma_f32_16x16x32_bf16 v[200:203], v[124:127], v[140:143], v[200:203]
    v_fmac_f32 v240, v210, v34
    v_fmac_f32 v240, v211, v35
    v_mfma_f32_16x16x32_bf16 v[204:207], v[120:123], v[152:155], 0
    v_fmac_f32 v240, v184, v36
    v_fmac_f32 v240, v185, v37
    v_mfma_f32_16x16x32_bf16 v[204:207], v[124:127], v[156:159], v[204:207]
    v_fmac_f32 v240, v186, v38
    v_fmac_f32 v240, v187, v39
    v_mfma_f32_16x16x32_bf16 v[208:211], v[120:123], v[168:171], 0
    v_fmac_f32 v240, v191, v89
    v_fmac_f32 v240, v192, v40
    v_mfma_f32_16x16x32_bf16 v[208:211], v[124:127], v[172:175], v[208:211]
    v_fmac_f32 v240, v193, v41
    v_fmac_f32 v240, v194, v42
    v_mfma_f32_16x16x32_bf16 v[184:187], v[136:139], v[136:139], 0
    v_fmac_f32 v240, v195, v43
    v_permlane32_swap_b32 v237, v238
    v_mfma_f32_16x16x32_bf16 v[184:187], v[140:143], v[140:143], v[184:187]
    s_add_u32 s74, s74, 1600
    v_fmac_f32 v240, v196, v44
    v_mfma_f32_16x16x32_bf16 v[188:191], v[136:139], v[152:155], 0
    v_fmac_f32 v240, v197, v45
    v_fmac_f32 v240, v198, v46
    v_mfma_f32_16x16x32_bf16 v[188:191], v[140:143], v[156:159], v[188:191]
    v_fmac_f32 v240, v199, v47
    v_add_f32 v241, v237, v238
    v_mfma_f32_16x16x32_bf16 v[192:195], v[136:139], v[168:171], 0
    s_cmp_lt_u32 s74, s58
    v_fmac_f32 v240, v200, v48
    v_mfma_f32_16x16x32_bf16 v[192:195], v[140:143], v[172:175], v[192:195]
    v_fmac_f32 v240, v201, v49
    v_fmac_f32 v240, v202, v50
    v_mfma_f32_16x16x32_bf16 v[196:199], v[152:155], v[152:155], 0
    v_fmac_f32 v240, v203, v51
    v_fmac_f32 v240, v204, v52
    v_mfma_f32_16x16x32_bf16 v[196:199], v[156:159], v[156:159], v[196:199]
    v_fmac_f32 v240, v205, v53
    v_fmac_f32 v240, v206, v54
    v_mfma_f32_16x16x32_bf16 v[200:203], v[152:155], v[168:171], 0
    v_fmac_f32 v240, v207, v55
    v_fmac_f32 v240, v208, v56
    v_mfma_f32_16x16x32_bf16 v[200:203], v[156:159], v[172:175], v[200:203]
    v_fmac_f32 v240, v209, v57
    v_fmac_f32 v240, v210, v58
    v_mfma_f32_16x16x32_bf16 v[204:207], v[168:171], v[168:171], 0
    v_fmac_f32 v240, v211, v59
    v_fmac_f32 v240, v184, v60
    v_mfma_f32_16x16x32_bf16 v[204:207], v[172:175], v[172:175], v[204:207]
    v_fmac_f32 v240, v185, v61
    v_fmac_f32 v240, v186, v62
    v_fmac_f32 v240, v187, v63
    s_waitcnt vmcnt(7) lgkmcnt(0)
    s_cbranch_scc1 standalone__deep_cross_pnn__recsys_kernel_loop
    s_branch standalone__deep_cross_pnn__recsys_kernel_k2m
standalone__deep_cross_pnn__recsys_kernel_aux:

    s_setprio 0
    s_load_dwordx2 s[24:25], s[60:61], s44
    s_load_dwordx2 s[26:27], s[62:63], s44
    v_mov_b32 v8, v255
    v_mov_b32 v9, v254
    v_mov_b32 v10, v253
    v_mov_b32 v11, v252
    s_mov_b32 s51, s2
    s_mov_b32 s64, 0
    s_mov_b32 s65, 0

    v_mov_b32 v35, v83
    s_lshr_b32 s72, s2, 3
    s_mul_i32 s72, s72, 36
    s_lshr_b32 s72, s72, 5
    s_lshl_b32 s75, s36, 7
    s_add_u32 s75, s75, 254464
    s_mov_b32 s76, 143136
    s_lshl_b32 s6, s2, 15
    s_lshl_b32 s7, s56, 13
    s_add_u32 s6, s6, s7
    s_add_u32 s6, s6, 20971520
    s_add_u32 s7, s6, 4096
    s_lshl_b32 s8, s36, 7
    s_add_u32 s8, s8, s37
    s_lshl_b32 s8, s8, 9
    s_add_u32 s8, s8, 29360128
    s_and_b32 s9, s2, 63
    s_lshl_b32 s9, s9, 5
    s_lshr_b32 s10, s2, 6
    s_add_u32 s9, s9, s10
    s_lshl_b32 s9, s9, 2
    s_add_u32 s9, s9, 14680064
    v_mov_b32 v112, 0

standalone__deep_cross_pnn__recsys_kernel_unit:

    s_bfe_u32 s36, s51, 0x10003

    s_lshr_b32 s38, s51, 4
    s_and_b32 s39, s51, 7
    s_sub_u32 s57, 2, s36
    s_lshl_b32 s57, s39, s57
    s_lshl_b32 s37, s36, 5
    s_add_u32 s57, s57, s37
    s_add_u32 s57, s57, s56
    s_mul_i32 s37, s38, 48
    s_add_u32 s37, s37, s57
    s_lshl_b32 s38, s38, 1
    s_lshr_b32 s39, s39, 2
    s_add_u32 s38, s38, s39
    s_add_u32 s38, s38, 768
    s_and_b32 s57, s57, 7
    s_cmp_eq_u32 s57, 2
    s_cselect_b32 s38, s38, 1000
    s_lshl_b32 s39, s36, 1
    s_and_b32 s39, s39, s56
    s_cselect_b32 s57, s38, s37

    s_lshr_b32 s37, s51, 4
    s_lshl_b32 s37, s37, 3
    s_and_b32 s38, s51, 7
    s_or_b32 s37, s37, s38
    s_and_b32 s58, s56, 1
    s_lshl_b32 s59, s37, 1
    s_add_u32 s58, s58, s59
    s_lshr_b32 s59, s56, 1
    s_xor_b32 s60, s36, 1
    s_mul_i32 s46, s60, 13
    s_lshl_b32 s60, s60, 1
    s_add_u32 s59, s59, s60
    s_add_u32 s61, s46, 6
    s_add_u32 s60, s46, 12
    s_bitcmp1_b32 s59, 0
    s_cselect_b32 s46, s60, s46
    s_cselect_b32 s63, -1, 1
    s_cselect_b32 s61, 24, s61
    v_lshrrev_b32 v1, 3, v8
    v_and_b32 v2, 7, v8
    v_mul_i32_i24 v7, s63, v2
    v_add_u32 v7, s46, v7
    v_cmp_ge_u32 s[48:49], s61, v7
    s_mul_i32 s60, s58, 25600
    s_movk_i32 s61, 400
    s_lshl_b32 s63, s63, 16
    v_mul_u32_u24 v0, s61, v1
    v_lshl_add_u32 v0, v7, 4, v0
    v_and_b32 v5, 15, v8
    v_and_b32 v6, 48, v8
    v_lshl_add_u32 v56, v5, 8, v6
    s_lshr_b32 s44, s37, 1
    s_lshl_b32 s44, s44, 12
    s_lshl_b32 s38, s36, 1
    s_and_b32 s39, s37, 1
    s_add_u32 s38, s38, s39
    s_lshl_b32 s38, s38, 6
    s_add_u32 s44, s44, s38
    s_lshl_b32 s47, s36, 7
    s_add_u32 s47, s47, s37
    s_lshl_b32 s47, s47, 10
    s_add_u32 s47, s47, 15204352

    s_cmp_eq_u32 s56, 0
    s_cselect_b64 s[4:5], -1, 0
    s_cmp_lg_u32 s64, 0
    s_cbranch_scc1 standalone__deep_cross_pnn__recsys_kernel_nd1
    s_mov_b64 exec, s[40:41]

    s_mul_i32 s73, s72, 4032
    s_mul_i32 s74, s72, 7168
    s_add_u32 s73, s73, s43
    s_add_u32 s74, s74, s42
    s_min_u32 m0, s73, s76
    s_min_u32 s74, s74, s75
    s_add_u32 s72, s72, 1

    buffer_load_dwordx4 v35, s[20:23], s74 offen lds
    s_cmp_eq_u32 s72, 36
    s_cselect_b32 s72, 0, s72

    s_mul_i32 s73, s72, 4032
    s_mul_i32 s74, s72, 7168
    s_add_u32 s73, s73, s43
    s_add_u32 s74, s74, s42
    s_min_u32 m0, s73, s76
    s_min_u32 s74, s74, s75
    s_add_u32 s72, s72, 1

    buffer_load_dwordx4 v35, s[20:23], s74 offen lds
    s_cmp_eq_u32 s72, 36
    s_cselect_b32 s72, 0, s72

    s_mul_i32 s73, s72, 4032
    s_mul_i32 s74, s72, 7168
    s_add_u32 s73, s73, s43
    s_add_u32 s74, s74, s42
    s_min_u32 m0, s73, s76
    s_min_u32 s74, s74, s75
    s_add_u32 s72, s72, 1

    buffer_load_dwordx4 v35, s[20:23], s74 offen lds
    s_cmp_eq_u32 s72, 36
    s_cselect_b32 s72, 0, s72

    s_mul_i32 s73, s72, 4032
    s_mul_i32 s74, s72, 7168
    s_add_u32 s73, s73, s43
    s_add_u32 s74, s74, s42
    s_min_u32 m0, s73, s76
    s_min_u32 s74, s74, s75
    s_add_u32 s72, s72, 1

    buffer_load_dwordx4 v35, s[20:23], s74 offen lds
    s_cmp_eq_u32 s72, 36
    s_cselect_b32 s72, 0, s72

    s_mul_i32 s73, s72, 4032
    s_mul_i32 s74, s72, 7168
    s_add_u32 s73, s73, s43
    s_add_u32 s74, s74, s42
    s_min_u32 m0, s73, s76
    s_min_u32 s74, s74, s75
    s_add_u32 s72, s72, 1

    buffer_load_dwordx4 v35, s[20:23], s74 offen lds
    s_cmp_eq_u32 s72, 36
    s_cselect_b32 s72, 0, s72

    s_mul_i32 s73, s72, 4032
    s_mul_i32 s74, s72, 7168
    s_add_u32 s73, s73, s43
    s_add_u32 s74, s74, s42
    s_min_u32 m0, s73, s76
    s_min_u32 s74, s74, s75
    s_add_u32 s72, s72, 1

    buffer_load_dwordx4 v35, s[20:23], s74 offen lds
    s_cmp_eq_u32 s72, 36
    s_cselect_b32 s72, 0, s72

    s_mul_i32 s73, s72, 4032
    s_mul_i32 s74, s72, 7168
    s_add_u32 s73, s73, s43
    s_add_u32 s74, s74, s42
    s_min_u32 m0, s73, s76
    s_min_u32 s74, s74, s75
    s_add_u32 s72, s72, 1

    buffer_load_dwordx4 v35, s[20:23], s74 offen lds
    s_cmp_eq_u32 s72, 36
    s_cselect_b32 s72, 0, s72

    s_mul_i32 s73, s72, 4032
    s_mul_i32 s74, s72, 7168
    s_add_u32 s73, s73, s43
    s_add_u32 s74, s74, s42
    s_min_u32 m0, s73, s76
    s_min_u32 s74, s74, s75
    s_add_u32 s72, s72, 1

    buffer_load_dwordx4 v35, s[20:23], s74 offen lds
    s_cmp_eq_u32 s72, 36
    s_cselect_b32 s72, 0, s72

    s_mul_i32 s73, s72, 4032
    s_mul_i32 s74, s72, 7168
    s_add_u32 s73, s73, s43
    s_add_u32 s74, s74, s42
    s_min_u32 m0, s73, s76
    s_min_u32 s74, s74, s75
    s_add_u32 s72, s72, 1
    s_barrier

    buffer_load_dwordx4 v35, s[20:23], s74 offen lds
    s_cmp_eq_u32 s72, 36
    s_cselect_b32 s72, 0, s72

    s_mul_i32 s73, s72, 4032
    s_mul_i32 s74, s72, 7168
    s_add_u32 s73, s73, s43
    s_add_u32 s74, s74, s42
    s_min_u32 m0, s73, s76
    s_min_u32 s74, s74, s75
    s_add_u32 s72, s72, 1

    buffer_load_dwordx4 v35, s[20:23], s74 offen lds
    s_cmp_eq_u32 s72, 36
    s_cselect_b32 s72, 0, s72

    s_mul_i32 s73, s72, 4032
    s_mul_i32 s74, s72, 7168
    s_add_u32 s73, s73, s43
    s_add_u32 s74, s74, s42
    s_min_u32 m0, s73, s76
    s_min_u32 s74, s74, s75
    s_add_u32 s72, s72, 1

    buffer_load_dwordx4 v35, s[20:23], s74 offen lds
    s_cmp_eq_u32 s72, 36
    s_cselect_b32 s72, 0, s72

    s_mul_i32 s73, s72, 4032
    s_mul_i32 s74, s72, 7168
    s_add_u32 s73, s73, s43
    s_add_u32 s74, s74, s42
    s_min_u32 m0, s73, s76
    s_min_u32 s74, s74, s75
    s_add_u32 s72, s72, 1

    buffer_load_dwordx4 v35, s[20:23], s74 offen lds
    s_cmp_eq_u32 s72, 36
    s_cselect_b32 s72, 0, s72

    s_mov_b64 exec, -1
standalone__deep_cross_pnn__recsys_kernel_nd1:

    s_lshr_b32 s78, s57, 5
    s_bfe_u32 s79, s57, 0x20003
    s_bfe_u32 s80, s57, 0x20001
    s_and_b32 s81, s57, 1
    s_lshl_b32 s77, s78, 2
    s_lshl_b32 s83, s81, 1
    s_add_u32 s77, s77, s83
    s_lshl_b32 s77, s77, 7
    s_lshl_b32 s83, s79, 5
    s_add_u32 s77, s77, s83
    s_lshl_b32 s83, s80, 3
    s_add_u32 s77, s77, s83
    s_lshl_b32 s77, s77, 10
    s_lshl_b32 s82, s78, 12
    s_lshl_b32 s83, s79, 10
    s_add_u32 s82, s82, s83
    s_lshl_b32 s83, s80, 8
    s_add_u32 s82, s82, s83
    s_lshl_b32 s83, s81, 7
    s_add_u32 s82, s82, s83
    s_mov_b32 s84, 205312
    v_lshrrev_b32 v3, 2, v8
    v_and_b32 v4, 3, v8
    v_mul_lo_u32 v14, v3, s84
    v_lshl_add_u32 v14, v4, 4, v14
    s_cmp_ge_u32 s57, 800
    s_cselect_b32 s83, 0x40000000, 0
    v_or_b32 v14, s83, v14
    s_mul_i32 s61, s56, 4608
    s_add_u32 s61, s61, 144256
    v_and_b32 v3, 3, v3
    v_lshlrev_b32 v36, 6, v8
    v_lshl_add_u32 v36, v3, 4, v36
    v_add_u32 v36, s61, v36
    v_xor_b32 v37, 16, v36
    v_xor_b32 v38, 32, v36
    v_xor_b32 v39, 48, v36
    v_and_b32 v3, 48, v8
    v_xor_b32 v15, v3, v9
    v_add_u32 v15, s61, v15
    s_mov_b32 s84, 0x05040100
    s_mov_b32 s85, 0x07060302

    s_cmp_lg_u32 s64, 0
    s_cbranch_scc1 standalone__deep_cross_pnn__recsys_kernel_nd2
    s_mov_b64 exec, s[40:41]

    s_mul_i32 s73, s72, 4032
    s_mul_i32 s74, s72, 7168
    s_add_u32 s73, s73, s43
    s_add_u32 s74, s74, s42
    s_min_u32 m0, s73, s76
    s_min_u32 s74, s74, s75
    s_add_u32 s72, s72, 1

    buffer_load_dwordx4 v35, s[20:23], s74 offen lds
    s_cmp_eq_u32 s72, 36
    s_cselect_b32 s72, 0, s72

    s_mul_i32 s73, s72, 4032
    s_mul_i32 s74, s72, 7168
    s_add_u32 s73, s73, s43
    s_add_u32 s74, s74, s42
    s_min_u32 m0, s73, s76
    s_min_u32 s74, s74, s75
    s_add_u32 s72, s72, 1

    buffer_load_dwordx4 v35, s[20:23], s74 offen lds
    s_cmp_eq_u32 s72, 36
    s_cselect_b32 s72, 0, s72

    s_mul_i32 s73, s72, 4032
    s_mul_i32 s74, s72, 7168
    s_add_u32 s73, s73, s43
    s_add_u32 s74, s74, s42
    s_min_u32 m0, s73, s76
    s_min_u32 s74, s74, s75
    s_add_u32 s72, s72, 1

    buffer_load_dwordx4 v35, s[20:23], s74 offen lds
    s_cmp_eq_u32 s72, 36
    s_cselect_b32 s72, 0, s72

    s_mul_i32 s73, s72, 4032
    s_mul_i32 s74, s72, 7168
    s_add_u32 s73, s73, s43
    s_add_u32 s74, s74, s42
    s_min_u32 m0, s73, s76
    s_min_u32 s74, s74, s75
    s_add_u32 s72, s72, 1

    buffer_load_dwordx4 v35, s[20:23], s74 offen lds
    s_cmp_eq_u32 s72, 36
    s_cselect_b32 s72, 0, s72

    s_mul_i32 s73, s72, 4032
    s_mul_i32 s74, s72, 7168
    s_add_u32 s73, s73, s43
    s_add_u32 s74, s74, s42
    s_min_u32 m0, s73, s76
    s_min_u32 s74, s74, s75
    s_add_u32 s72, s72, 1

    buffer_load_dwordx4 v35, s[20:23], s74 offen lds
    s_cmp_eq_u32 s72, 36
    s_cselect_b32 s72, 0, s72

    s_mul_i32 s73, s72, 4032
    s_mul_i32 s74, s72, 7168
    s_add_u32 s73, s73, s43
    s_add_u32 s74, s74, s42
    s_min_u32 m0, s73, s76
    s_min_u32 s74, s74, s75
    s_add_u32 s72, s72, 1

    buffer_load_dwordx4 v35, s[20:23], s74 offen lds
    s_cmp_eq_u32 s72, 36
    s_cselect_b32 s72, 0, s72

    s_mul_i32 s73, s72, 4032
    s_mul_i32 s74, s72, 7168
    s_add_u32 s73, s73, s43
    s_add_u32 s74, s74, s42
    s_min_u32 m0, s73, s76
    s_min_u32 s74, s74, s75
    s_add_u32 s72, s72, 1

    buffer_load_dwordx4 v35, s[20:23], s74 offen lds
    s_cmp_eq_u32 s72, 36
    s_cselect_b32 s72, 0, s72

    s_mul_i32 s73, s72, 4032
    s_mul_i32 s74, s72, 7168
    s_add_u32 s73, s73, s43
    s_add_u32 s74, s74, s42
    s_min_u32 m0, s73, s76
    s_min_u32 s74, s74, s75
    s_add_u32 s72, s72, 1

    buffer_load_dwordx4 v35, s[20:23], s74 offen lds
    s_cmp_eq_u32 s72, 36
    s_cselect_b32 s72, 0, s72

    s_mul_i32 s73, s72, 4032
    s_mul_i32 s74, s72, 7168
    s_add_u32 s73, s73, s43
    s_add_u32 s74, s74, s42
    s_min_u32 m0, s73, s76
    s_min_u32 s74, s74, s75
    s_add_u32 s72, s72, 1

    buffer_load_dwordx4 v35, s[20:23], s74 offen lds
    s_cmp_eq_u32 s72, 36
    s_cselect_b32 s72, 0, s72

    s_mul_i32 s73, s72, 4032
    s_mul_i32 s74, s72, 7168
    s_add_u32 s73, s73, s43
    s_add_u32 s74, s74, s42
    s_min_u32 m0, s73, s76
    s_min_u32 s74, s74, s75
    s_add_u32 s72, s72, 1

    buffer_load_dwordx4 v35, s[20:23], s74 offen lds
    s_cmp_eq_u32 s72, 36
    s_cselect_b32 s72, 0, s72

    s_mul_i32 s73, s72, 4032
    s_mul_i32 s74, s72, 7168
    s_add_u32 s73, s73, s43
    s_add_u32 s74, s74, s42
    s_min_u32 m0, s73, s76
    s_min_u32 s74, s74, s75
    s_add_u32 s72, s72, 1

    buffer_load_dwordx4 v35, s[20:23], s74 offen lds
    s_cmp_eq_u32 s72, 36
    s_cselect_b32 s72, 0, s72

    s_mul_i32 s73, s72, 4032
    s_mul_i32 s74, s72, 7168
    s_add_u32 s73, s73, s43
    s_add_u32 s74, s74, s42
    s_min_u32 m0, s73, s76
    s_min_u32 s74, s74, s75
    s_add_u32 s72, s72, 1

    buffer_load_dwordx4 v35, s[20:23], s74 offen lds
    s_cmp_eq_u32 s72, 36
    s_cselect_b32 s72, 0, s72

    s_mul_i32 s73, s72, 4032
    s_mul_i32 s74, s72, 7168
    s_add_u32 s73, s73, s43
    s_add_u32 s74, s74, s42
    s_min_u32 m0, s73, s76
    s_min_u32 s74, s74, s75
    s_add_u32 s72, s72, 1

    buffer_load_dwordx4 v35, s[20:23], s74 offen lds
    s_cmp_eq_u32 s72, 36
    s_cselect_b32 s72, 0, s72

    s_mul_i32 s73, s72, 4032
    s_mul_i32 s74, s72, 7168
    s_add_u32 s73, s73, s43
    s_add_u32 s74, s74, s42
    s_min_u32 m0, s73, s76
    s_min_u32 s74, s74, s75
    s_add_u32 s72, s72, 1

    buffer_load_dwordx4 v35, s[20:23], s74 offen lds
    s_cmp_eq_u32 s72, 36
    s_cselect_b32 s72, 0, s72

    s_mul_i32 s73, s72, 4032
    s_mul_i32 s74, s72, 7168
    s_add_u32 s73, s73, s43
    s_add_u32 s74, s74, s42
    s_min_u32 m0, s73, s76
    s_min_u32 s74, s74, s75
    s_add_u32 s72, s72, 1

    buffer_load_dwordx4 v35, s[20:23], s74 offen lds
    s_cmp_eq_u32 s72, 36
    s_cselect_b32 s72, 0, s72

    s_mul_i32 s73, s72, 4032
    s_mul_i32 s74, s72, 7168
    s_add_u32 s73, s73, s43
    s_add_u32 s74, s74, s42
    s_min_u32 m0, s73, s76
    s_min_u32 s74, s74, s75
    s_add_u32 s72, s72, 1

    buffer_load_dwordx4 v35, s[20:23], s74 offen lds
    s_cmp_eq_u32 s72, 36
    s_cselect_b32 s72, 0, s72

    s_mul_i32 s73, s72, 4032
    s_mul_i32 s74, s72, 7168
    s_add_u32 s73, s73, s43
    s_add_u32 s74, s74, s42
    s_min_u32 m0, s73, s76
    s_min_u32 s74, s74, s75
    s_add_u32 s72, s72, 1

    buffer_load_dwordx4 v35, s[20:23], s74 offen lds
    s_cmp_eq_u32 s72, 36
    s_cselect_b32 s72, 0, s72

    s_mul_i32 s73, s72, 4032
    s_mul_i32 s74, s72, 7168
    s_add_u32 s73, s73, s43
    s_add_u32 s74, s74, s42
    s_min_u32 m0, s73, s76
    s_min_u32 s74, s74, s75
    s_add_u32 s72, s72, 1

    buffer_load_dwordx4 v35, s[20:23], s74 offen lds
    s_cmp_eq_u32 s72, 36
    s_cselect_b32 s72, 0, s72

    s_mul_i32 s73, s72, 4032
    s_mul_i32 s74, s72, 7168
    s_add_u32 s73, s73, s43
    s_add_u32 s74, s74, s42
    s_min_u32 m0, s73, s76
    s_min_u32 s74, s74, s75
    s_add_u32 s72, s72, 1

    buffer_load_dwordx4 v35, s[20:23], s74 offen lds
    s_cmp_eq_u32 s72, 36
    s_cselect_b32 s72, 0, s72

    s_mul_i32 s73, s72, 4032
    s_mul_i32 s74, s72, 7168
    s_add_u32 s73, s73, s43
    s_add_u32 s74, s74, s42
    s_min_u32 m0, s73, s76
    s_min_u32 s74, s74, s75
    s_add_u32 s72, s72, 1

    buffer_load_dwordx4 v35, s[20:23], s74 offen lds
    s_cmp_eq_u32 s72, 36
    s_cselect_b32 s72, 0, s72

    s_mul_i32 s73, s72, 4032
    s_mul_i32 s74, s72, 7168
    s_add_u32 s73, s73, s43
    s_add_u32 s74, s74, s42
    s_min_u32 m0, s73, s76
    s_min_u32 s74, s74, s75
    s_add_u32 s72, s72, 1

    buffer_load_dwordx4 v35, s[20:23], s74 offen lds
    s_cmp_eq_u32 s72, 36
    s_cselect_b32 s72, 0, s72

    s_mul_i32 s73, s72, 4032
    s_mul_i32 s74, s72, 7168
    s_add_u32 s73, s73, s43
    s_add_u32 s74, s74, s42
    s_min_u32 m0, s73, s76
    s_min_u32 s74, s74, s75
    s_add_u32 s72, s72, 1

    buffer_load_dwordx4 v35, s[20:23], s74 offen lds
    s_cmp_eq_u32 s72, 36
    s_cselect_b32 s72, 0, s72

    s_mul_i32 s73, s72, 4032
    s_mul_i32 s74, s72, 7168
    s_add_u32 s73, s73, s43
    s_add_u32 s74, s74, s42
    s_min_u32 m0, s73, s76
    s_min_u32 s74, s74, s75
    s_add_u32 s72, s72, 1

    buffer_load_dwordx4 v35, s[20:23], s74 offen lds
    s_cmp_eq_u32 s72, 36
    s_cselect_b32 s72, 0, s72

    s_mul_i32 s73, s72, 4032
    s_mul_i32 s74, s72, 7168
    s_add_u32 s73, s73, s43
    s_add_u32 s74, s74, s42
    s_min_u32 m0, s73, s76
    s_min_u32 s74, s74, s75
    s_add_u32 s72, s72, 1

    buffer_load_dwordx4 v35, s[20:23], s74 offen lds
    s_cmp_eq_u32 s72, 36
    s_cselect_b32 s72, 0, s72

    s_mov_b64 exec, -1
standalone__deep_cross_pnn__recsys_kernel_nd2:

    s_cmp_lg_u32 s64, 0
    s_cbranch_scc1 standalone__deep_cross_pnn__recsys_kernel_nsig
    s_waitcnt vmcnt(0)
    s_barrier

standalone__deep_cross_pnn__recsys_kernel_nsig:
    s_mov_b64 exec, s[48:49]
    buffer_load_dwordx4 v[224:227], v0, s[16:19], s60 offen
    s_add_u32 s60, s60, 3200
    buffer_load_dwordx4 v[228:231], v0, s[16:19], s60 offen
    s_add_u32 s60, s60, 3200
    buffer_load_dwordx4 v[232:235], v0, s[16:19], s60 offen
    s_add_u32 s60, s60, 3200
    buffer_load_dwordx4 v[236:239], v0, s[16:19], s60 offen
    s_add_u32 s60, s60, 3200
    buffer_load_dwordx4 v[240:243], v0, s[16:19], s60 offen
    s_add_u32 s60, s60, 3200
    buffer_load_dwordx4 v[244:247], v0, s[16:19], s60 offen
    s_add_u32 s60, s60, 3200
    buffer_load_dwordx4 v[248:251], v0, s[16:19], s60 offen
    s_add_u32 s60, s60, 3200
    buffer_load_dwordx4 v[252:255], v0, s[16:19], s60 offen
    s_add_u32 s60, s60, 3200
    s_mov_b64 exec, -1
    s_setprio 1

    s_lshl_b32 s61, s56, 8
    s_add_u32 s61, s61, 162688
    v_lshlrev_b32 v86, 2, v8
    v_add_u32 v86, s61, v86
    v_and_b32 v85, 0xffffff80, v86
    v_lshrrev_b32 v27, 5, v8
    v_mul_u32_u24 v27, 0x40404, v27
    v_lshl_or_b32 v27, v27, 8, v27
    s_mul_i32 s61, s56, 4608
    s_add_u32 s61, s61, 144256
    v_mul_u32_u24 v31, 72, v8
    v_add3_u32 v31, s61, v31, -8
    v_mul_u32_u24 v34, 72, v1
    v_lshl_add_u32 v34, v2, 3, v34
    v_add_u32 v34, s61, v34
    v_mul_u32_u24 v3, 52, v7
    v_lshrrev_b32 v3, 8, v3
    v_mad_i32_i24 v2, v3, -5, v7
    v_mov_b32 v13, 0
    v_mul_u32_u24 v2, 0x10001, v2
    v_lshlrev_b32 v2, 12, v2
    v_add_u32 v32, 67108864, v2
    v_add_u32 v33, 201328640, v2
    s_cmp_eq_u32 s59, 3
    s_cselect_b32 s61, 0x0fffff00, -16
    s_cmp_eq_u32 s59, 1
    s_cselect_b32 s61, 0x0ffffff0, s61
    v_mov_b32 v59, s61
    s_lshr_b32 s62, s58, 7
    s_mul_i32 s62, s62, 25
    s_min_u32 s46, s46, 24
    s_add_u32 s62, s62, s46
    s_lshl_b32 s62, s62, 3
    s_bfe_u32 s61, s58, 0x30004
    s_add_u32 s62, s62, s61
    s_lshl_b32 s62, s62, 13
    s_bfe_u32 s61, s58, 0x30001
    s_lshl_b32 s61, s61, 10
    s_add_u32 s62, s62, s61
    s_and_b32 s61, s58, 1
    s_lshl_b32 s46, s61, 2
    s_add_u32 s46, s46, 163712
    s_lshl_b32 s61, s61, 9
    s_add_u32 s62, s62, s61
    s_add_u32 s62, s62, 16777216
    v_and_b32 v30, 31, v8
    v_lshrrev_b32 v3, 5, v8
    v_lshlrev_b32 v30, 4, v30
    v_lshl_add_u32 v30, v3, 3, v30
    s_movk_i32 s66, 0x7c
    s_mov_b32 s67, 0x03030303
    s_mov_b32 s75, 0x06040200
    v_mov_b32 v57, 0x08040201
    v_mov_b32 v58, 0x80402010
    v_mov_b32 v108, 0xff800001
    v_mov_b32 v109, 0xff800001
    v_mov_b32 v110, 0xff800001
    v_mov_b32 v111, 0xff800001
    s_mov_b64 exec, s[48:49]

    s_waitcnt vmcnt(7)
    v_lshl_or_b32 v224, v225, 16, v224
    v_lshl_or_b32 v225, v227, 16, v226
    v_add_u32 v224, v32, v224
    v_add_u32 v225, v33, v225
    ds_write_b64 v34, v[224:225] offset:0

    s_waitcnt vmcnt(6)
    v_lshl_or_b32 v228, v229, 16, v228
    v_lshl_or_b32 v229, v231, 16, v230
    v_add_u32 v228, v32, v228
    v_add_u32 v229, v33, v229
    ds_write_b64 v34, v[228:229] offset:576

    s_waitcnt vmcnt(5)
    v_lshl_or_b32 v232, v233, 16, v232
    v_lshl_or_b32 v233, v235, 16, v234
    v_add_u32 v232, v32, v232
    v_add_u32 v233, v33, v233
    ds_write_b64 v34, v[232:233] offset:1152

    s_waitcnt vmcnt(4)
    v_lshl_or_b32 v236, v237, 16, v236
    v_lshl_or_b32 v237, v239, 16, v238
    v_add_u32 v236, v32, v236
    v_add_u32 v237, v33, v237
    ds_write_b64 v34, v[236:237] offset:1728

    s_waitcnt vmcnt(3)
    v_lshl_or_b32 v240, v241, 16, v240
    v_lshl_or_b32 v241, v243, 16, v242
    v_add_u32 v240, v32, v240
    v_add_u32 v241, v33, v241
    ds_write_b64 v34, v[240:241] offset:2304

    s_waitcnt vmcnt(2)
    v_lshl_or_b32 v244, v245, 16, v244
    v_lshl_or_b32 v245, v247, 16, v246
    v_add_u32 v244, v32, v244
    v_add_u32 v245, v33, v245
    ds_write_b64 v34, v[244:245] offset:2880

    s_waitcnt vmcnt(1)
    v_lshl_or_b32 v248, v249, 16, v248
    v_lshl_or_b32 v249, v251, 16, v250
    v_add_u32 v248, v32, v248
    v_add_u32 v249, v33, v249
    ds_write_b64 v34, v[248:249] offset:3456

    s_waitcnt vmcnt(0)
    v_lshl_or_b32 v252, v253, 16, v252
    v_lshl_or_b32 v253, v255, 16, v254
    v_add_u32 v252, v32, v252
    v_add_u32 v253, v33, v253
    ds_write_b64 v34, v[252:253] offset:4032

    s_mov_b64 exec, -1
    ds_read_b64 v[40:41], v31 offset:8
    ds_read_b64 v[42:43], v31 offset:16
    ds_read_b64 v[44:45], v31 offset:24
    ds_read_b64 v[46:47], v31 offset:32
    ds_read_b64 v[48:49], v31 offset:40
    ds_read_b64 v[50:51], v31 offset:48
    ds_read_b64 v[52:53], v31 offset:56
    ds_read_b64 v[54:55], v31 offset:64

    s_waitcnt lgkmcnt(7)
    v_perm_b32 v60, v41, v40, s75
    v_lshlrev_b32 v72, 2, v60

    v_lshrrev_b32 v61, 3, v60
    v_and_b32 v60, 0x07070707, v60
    v_and_or_b32 v0, v61, s67, v27
    v_perm_b32 v16, v58, v57, v60
    v_add_u32 v64, v57, v16

    s_waitcnt lgkmcnt(6)
    v_perm_b32 v60, v43, v42, s75
    v_lshlrev_b32 v73, 2, v60

    v_lshrrev_b32 v61, 3, v60
    v_and_b32 v60, 0x07070707, v60
    v_and_or_b32 v1, v61, s67, v27
    v_perm_b32 v17, v58, v57, v60
    v_add_u32 v65, v57, v17

    s_waitcnt lgkmcnt(5)
    v_perm_b32 v60, v45, v44, s75
    v_lshlrev_b32 v74, 2, v60

    v_lshrrev_b32 v61, 3, v60
    v_and_b32 v60, 0x07070707, v60
    v_and_or_b32 v2, v61, s67, v27
    v_perm_b32 v18, v58, v57, v60
    v_add_u32 v66, v57, v18

    s_waitcnt lgkmcnt(4)
    v_perm_b32 v60, v47, v46, s75
    v_lshlrev_b32 v75, 2, v60

    v_lshrrev_b32 v61, 3, v60
    v_and_b32 v60, 0x07070707, v60
    v_and_or_b32 v3, v61, s67, v27
    v_perm_b32 v19, v58, v57, v60
    v_add_u32 v67, v57, v19

    s_waitcnt lgkmcnt(3)
    v_perm_b32 v60, v49, v48, s75
    v_lshlrev_b32 v76, 2, v60

    v_lshrrev_b32 v61, 3, v60
    v_and_b32 v60, 0x07070707, v60
    v_and_or_b32 v4, v61, s67, v27
    v_perm_b32 v20, v58, v57, v60
    v_add_u32 v68, v57, v20

    s_waitcnt lgkmcnt(2)
    v_perm_b32 v60, v51, v50, s75
    v_lshlrev_b32 v77, 2, v60

    v_lshrrev_b32 v61, 3, v60
    v_and_b32 v60, 0x07070707, v60
    v_and_or_b32 v5, v61, s67, v27
    v_perm_b32 v21, v58, v57, v60
    v_add_u32 v69, v57, v21

    s_waitcnt lgkmcnt(1)
    v_perm_b32 v60, v53, v52, s75
    v_lshlrev_b32 v78, 2, v60

    v_lshrrev_b32 v61, 3, v60
    v_and_b32 v60, 0x07070707, v60
    v_and_or_b32 v6, v61, s67, v27
    v_perm_b32 v22, v58, v57, v60
    v_add_u32 v70, v57, v22

    s_waitcnt lgkmcnt(0)
    v_perm_b32 v60, v55, v54, s75
    v_lshlrev_b32 v79, 2, v60

    v_lshrrev_b32 v61, 3, v60
    v_and_b32 v60, 0x07070707, v60
    v_and_or_b32 v7, v61, s67, v27
    v_perm_b32 v23, v58, v57, v60
    v_add_u32 v71, v57, v23

    ds_write_b32 v86, v13
    s_cmp_eq_u32 s59, 3
    s_cbranch_scc1 standalone__deep_cross_pnn__recsys_kernel_sk1
    v_add_u32 v63, v58, v16
    v_ffbl_b32 v84, v59
    v_perm_b32 v60, v72, v72, v84
    v_and_or_b32 v60, v60, s66, v85
    ds_add_rtn_u32 v87, v60, v10
    ds_wrxchg_rtn_b32 v116, v86, v13

    s_waitcnt lgkmcnt(0)
    v_cmp_gt_u32 s[68:69], 2, v116

    s_nop 0
    v_cmpx_le_u32 vcc, 2, v87
    v_mov_b32 v62, s69
    v_perm_b32 v121, v62, s68, v1
    v_perm_b32 v122, v62, s68, v0
    v_and_b32 v121, v121, v17
    v_and_b32 v122, v122, v16
    v_msad_u8 v120, v65, v121, 0
    v_lshlrev_b32 v120, 8, v120
    v_msad_u8 v120, v63, v122, v120
    v_and_b32 v120, v120, v59

    v_ffbl_b32 v120, v120
    v_max_i32 v84, v84, v120
    s_mov_b64 exec, -1
    v_lshl_add_u32 v59, -1, v84, v59

    v_lshl_add_u32 v61, v84, 1, v31
    ds_read_u16 v80, v61 offset:0
    s_setprio 0
    v_ffbl_b32 v84, v59
    v_perm_b32 v60, v72, v72, v84
    v_and_or_b32 v60, v60, s66, v85
    ds_add_rtn_u32 v87, v60, v10
    ds_wrxchg_rtn_b32 v116, v86, v13

    s_waitcnt lgkmcnt(0)
    v_cmp_gt_u32 s[68:69], 2, v116

    s_nop 0
    v_cmpx_le_u32 vcc, 2, v87
    v_mov_b32 v62, s69
    v_perm_b32 v121, v62, s68, v1
    v_perm_b32 v122, v62, s68, v0
    v_and_b32 v121, v121, v17
    v_and_b32 v122, v122, v16
    v_msad_u8 v120, v65, v121, 0
    v_lshlrev_b32 v120, 8, v120
    v_msad_u8 v120, v63, v122, v120
    v_and_b32 v120, v120, v59

    v_ffbl_b32 v120, v120
    v_max_i32 v84, v84, v120
    s_mov_b64 exec, -1
    v_lshl_add_u32 v59, -1, v84, v59

    v_lshl_add_u32 v61, v84, 1, v31
    ds_read_u16 v81, v61 offset:0
    s_setprio 1
    v_ffbl_b32 v84, v59
    v_perm_b32 v60, v72, v72, v84
    v_and_or_b32 v60, v60, s66, v85
    ds_add_rtn_u32 v87, v60, v10
    ds_wrxchg_rtn_b32 v116, v86, v13

    s_waitcnt lgkmcnt(0)
    v_cmp_gt_u32 s[68:69], 2, v116

    s_nop 0
    v_cmpx_le_u32 vcc, 2, v87
    v_mov_b32 v62, s69
    v_perm_b32 v121, v62, s68, v1
    v_perm_b32 v122, v62, s68, v0
    v_and_b32 v121, v121, v17
    v_and_b32 v122, v122, v16
    v_msad_u8 v120, v65, v121, 0
    v_lshlrev_b32 v120, 8, v120
    v_msad_u8 v120, v63, v122, v120
    v_and_b32 v120, v120, v59

    v_ffbl_b32 v120, v120
    v_max_i32 v84, v84, v120
    s_mov_b64 exec, -1
    v_lshl_add_u32 v59, -1, v84, v59

    v_lshl_add_u32 v61, v84, 1, v31
    ds_read_u16 v82, v61 offset:0
    s_setprio 0
    v_ffbl_b32 v84, v59
    v_perm_b32 v60, v72, v72, v84
    v_and_or_b32 v60, v60, s66, v85
    ds_add_rtn_u32 v87, v60, v10
    ds_wrxchg_rtn_b32 v116, v86, v13

    s_waitcnt lgkmcnt(0)
    v_cmp_gt_u32 s[68:69], 2, v116

    s_nop 0
    v_cmpx_le_u32 vcc, 2, v87
    v_mov_b32 v62, s69
    v_perm_b32 v121, v62, s68, v1
    v_and_b32 v121, v121, v17
    v_msad_u8 v120, v65, v121, 0
    v_and_b32_sdwa v120, v120, v59 dst_sel:BYTE_1 dst_unused:UNUSED_PAD src0_sel:DWORD src1_sel:BYTE_1
    s_nop 0

    v_ffbl_b32 v120, v120
    v_max_i32 v84, v84, v120
    s_mov_b64 exec, -1
    v_lshl_add_u32 v59, -1, v84, v59

    v_lshl_add_u32 v61, v84, 1, v31
    ds_read_u16 v83, v61 offset:0
standalone__deep_cross_pnn__recsys_kernel_sk1:
    v_lshrrev_b32 v59, 4, v59
    v_add_u32 v63, v58, v17
    s_setprio 1
    v_ffbl_b32 v84, v59
    v_perm_b32 v60, v73, v72, v84
    v_and_or_b32 v60, v60, s66, v85

    v_cmpx_ge_u32 vcc, 0, v84
    ds_add_u32 v60, v10
    s_not_b64 s[70:71], vcc
    s_mov_b64 exec, s[70:71]
    ds_add_rtn_u32 v87, v60, v10
    s_mov_b64 exec, -1

    ds_wrxchg_rtn_b32 v116, v86, v13
    v_lshlrev_b32 v104, 13, v8
    s_cmp_eq_u32 s64, 0
    s_cselect_b32 s45, s4, 0
    s_and_b32 exec_lo, s45, 3
    s_mov_b32 exec_hi, 0
    buffer_store_dword v13, v104, s[12:15], s9 offen sc1
    s_mov_b64 exec, -1
    buffer_load_dwordx4 v[128:131], v9, s[28:31], s77 offen offset:0
    buffer_load_dwordx4 v[132:135], v9, s[28:31], s77 offen offset:1024

    s_waitcnt lgkmcnt(0)
    v_cmp_gt_u32 s[68:69], 2, v116

    s_cmp_eq_u32 s59, 3
    s_cbranch_scc1 standalone__deep_cross_pnn__recsys_kernel_nf1
    v_lshl_or_b32 v24, v81, 16, v80
    v_lshl_or_b32 v25, v83, 16, v82
    buffer_store_dwordx2 v[24:25], v30, s[32:35], s62 offen sc1
    s_add_u32 s62, s62, s63
standalone__deep_cross_pnn__recsys_kernel_nf1:
    s_mov_b64 exec, s[70:71]
    v_cmpx_le_u32 vcc, 2, v87
    v_mov_b32 v62, s69
    v_perm_b32 v121, v62, s68, v2
    v_perm_b32 v122, v62, s68, v1
    v_and_b32 v121, v121, v18
    v_and_b32 v122, v122, v17
    v_msad_u8 v120, v66, v121, 0
    v_lshlrev_b32 v120, 8, v120
    v_msad_u8 v120, v63, v122, v120
    v_and_b32 v120, v120, v59

    v_ffbl_b32 v120, v120
    v_max_i32 v84, v84, v120
    s_mov_b64 exec, -1
    v_lshl_add_u32 v59, -1, v84, v59

    v_lshl_add_u32 v61, v84, 1, v31
    ds_read_u16 v80, v61 offset:8
    s_setprio 0
    v_ffbl_b32 v84, v59
    v_perm_b32 v60, v73, v72, v84
    v_and_or_b32 v60, v60, s66, v85

    v_cmpx_ge_u32 vcc, 1, v84
    ds_add_u32 v60, v10
    s_not_b64 s[70:71], vcc
    s_mov_b64 exec, s[70:71]
    ds_add_rtn_u32 v87, v60, v10
    s_mov_b64 exec, -1

    ds_wrxchg_rtn_b32 v116, v86, v13
    s_mov_b64 exec, s[4:5]
    buffer_load_dwordx4 v[104:107], v56, s[20:23], s44 offen
    s_mov_b64 exec, -1
    buffer_load_dwordx4 v[136:139], v9, s[28:31], s77 offen offset:2048
    buffer_load_dwordx4 v[140:143], v9, s[28:31], s77 offen offset:3072
    s_add_u32 s77, s77, 4096

    s_waitcnt lgkmcnt(0)
    v_cmp_gt_u32 s[68:69], 2, v116

    s_mov_b64 exec, s[70:71]
    v_cmpx_le_u32 vcc, 2, v87
    v_mov_b32 v62, s69
    v_perm_b32 v121, v62, s68, v2
    v_perm_b32 v122, v62, s68, v1
    v_and_b32 v121, v121, v18
    v_and_b32 v122, v122, v17
    v_msad_u8 v120, v66, v121, 0
    v_lshlrev_b32 v120, 8, v120
    v_msad_u8 v120, v63, v122, v120
    v_and_b32 v120, v120, v59

    v_ffbl_b32 v120, v120
    v_max_i32 v84, v84, v120
    s_mov_b64 exec, -1
    v_lshl_add_u32 v59, -1, v84, v59

    v_lshl_add_u32 v61, v84, 1, v31
    ds_read_u16 v81, v61 offset:8
    s_setprio 1
    v_ffbl_b32 v84, v59
    v_perm_b32 v60, v73, v72, v84
    v_and_or_b32 v60, v60, s66, v85

    v_cmpx_ge_u32 vcc, 2, v84
    ds_add_u32 v60, v10
    s_not_b64 s[70:71], vcc
    s_mov_b64 exec, s[70:71]
    ds_add_rtn_u32 v87, v60, v10
    s_mov_b64 exec, -1

    ds_wrxchg_rtn_b32 v116, v86, v13
    buffer_load_dwordx4 v[144:147], v9, s[28:31], s77 offen offset:0
    buffer_load_dwordx4 v[148:151], v9, s[28:31], s77 offen offset:1024

    s_waitcnt lgkmcnt(0)
    v_cmp_gt_u32 s[68:69], 2, v116

    s_mov_b64 exec, s[70:71]
    v_cmpx_le_u32 vcc, 2, v87
    v_mov_b32 v62, s69
    v_perm_b32 v121, v62, s68, v2
    v_perm_b32 v122, v62, s68, v1
    v_and_b32 v121, v121, v18
    v_and_b32 v122, v122, v17
    v_msad_u8 v120, v66, v121, 0
    v_lshlrev_b32 v120, 8, v120
    v_msad_u8 v120, v63, v122, v120
    v_and_b32 v120, v120, v59

    v_ffbl_b32 v120, v120
    v_max_i32 v84, v84, v120
    s_mov_b64 exec, -1
    v_lshl_add_u32 v59, -1, v84, v59

    v_lshl_add_u32 v61, v84, 1, v31
    ds_read_u16 v82, v61 offset:8
    s_setprio 0
    v_ffbl_b32 v84, v59
    v_perm_b32 v60, v73, v72, v84
    v_and_or_b32 v60, v60, s66, v85

    v_cmpx_ge_u32 vcc, 3, v84
    ds_add_u32 v60, v10
    s_not_b64 s[70:71], vcc
    s_mov_b64 exec, s[70:71]
    ds_add_rtn_u32 v87, v60, v10
    s_mov_b64 exec, -1

    ds_wrxchg_rtn_b32 v116, v86, v13
    buffer_load_dwordx4 v[152:155], v9, s[28:31], s77 offen offset:2048
    buffer_load_dwordx4 v[156:159], v9, s[28:31], s77 offen offset:3072
    s_add_u32 s77, s77, 126976

    s_waitcnt lgkmcnt(0)
    v_cmp_gt_u32 s[68:69], 2, v116

    s_mov_b64 exec, s[70:71]
    v_cmpx_le_u32 vcc, 2, v87
    v_mov_b32 v62, s69
    v_perm_b32 v121, v62, s68, v2
    v_and_b32 v121, v121, v18
    v_msad_u8 v120, v66, v121, 0
    v_and_b32_sdwa v120, v120, v59 dst_sel:BYTE_1 dst_unused:UNUSED_PAD src0_sel:DWORD src1_sel:BYTE_1
    s_nop 0

    v_ffbl_b32 v120, v120
    v_max_i32 v84, v84, v120
    s_mov_b64 exec, -1
    v_lshl_add_u32 v59, -1, v84, v59

    v_lshl_add_u32 v61, v84, 1, v31
    ds_read_u16 v83, v61 offset:8
    v_lshrrev_b32 v59, 4, v59
    v_add_u32 v63, v58, v18
    s_setprio 1
    v_ffbl_b32 v84, v59
    v_perm_b32 v60, v74, v73, v84
    v_and_or_b32 v60, v60, s66, v85

    v_cmpx_ge_u32 vcc, 0, v84
    ds_add_u32 v60, v10
    s_not_b64 s[70:71], vcc
    s_mov_b64 exec, s[70:71]
    ds_add_rtn_u32 v87, v60, v10
    s_mov_b64 exec, -1

    ds_wrxchg_rtn_b32 v116, v86, v13
    buffer_load_dwordx4 v[160:163], v9, s[28:31], s77 offen offset:0
    buffer_load_dwordx4 v[164:167], v9, s[28:31], s77 offen offset:1024

    s_waitcnt lgkmcnt(0)
    v_cmp_gt_u32 s[68:69], 2, v116

    v_lshl_or_b32 v24, v81, 16, v80
    v_lshl_or_b32 v25, v83, 16, v82
    buffer_store_dwordx2 v[24:25], v30, s[32:35], s62 offen sc1
    s_add_u32 s62, s62, s63
    s_mov_b64 exec, s[70:71]
    v_cmpx_le_u32 vcc, 2, v87
    v_mov_b32 v62, s69
    v_perm_b32 v121, v62, s68, v3
    v_perm_b32 v122, v62, s68, v2
    v_and_b32 v121, v121, v19
    v_and_b32 v122, v122, v18
    v_msad_u8 v120, v67, v121, 0
    v_lshlrev_b32 v120, 8, v120
    v_msad_u8 v120, v63, v122, v120
    v_and_b32 v120, v120, v59

    v_ffbl_b32 v120, v120
    v_max_i32 v84, v84, v120
    s_mov_b64 exec, -1
    v_lshl_add_u32 v59, -1, v84, v59

    v_lshl_add_u32 v61, v84, 1, v31
    ds_read_u16 v80, v61 offset:16
    s_setprio 0
    v_ffbl_b32 v84, v59
    v_perm_b32 v60, v74, v73, v84
    v_and_or_b32 v60, v60, s66, v85

    v_cmpx_ge_u32 vcc, 1, v84
    ds_add_u32 v60, v10
    s_not_b64 s[70:71], vcc
    s_mov_b64 exec, s[70:71]
    ds_add_rtn_u32 v87, v60, v10
    s_mov_b64 exec, -1

    ds_wrxchg_rtn_b32 v116, v86, v13
    buffer_load_dwordx4 v[168:171], v9, s[28:31], s77 offen offset:2048
    buffer_load_dwordx4 v[172:175], v9, s[28:31], s77 offen offset:3072
    s_add_u32 s77, s77, 4096

    s_waitcnt lgkmcnt(0)
    v_cmp_gt_u32 s[68:69], 2, v116

    s_mov_b64 exec, s[70:71]
    v_cmpx_le_u32 vcc, 2, v87
    v_mov_b32 v62, s69
    v_perm_b32 v121, v62, s68, v3
    v_perm_b32 v122, v62, s68, v2
    v_and_b32 v121, v121, v19
    v_and_b32 v122, v122, v18
    v_msad_u8 v120, v67, v121, 0
    v_lshlrev_b32 v120, 8, v120
    v_msad_u8 v120, v63, v122, v120
    v_and_b32 v120, v120, v59

    v_ffbl_b32 v120, v120
    v_max_i32 v84, v84, v120
    s_mov_b64 exec, -1
    v_lshl_add_u32 v59, -1, v84, v59

    v_lshl_add_u32 v61, v84, 1, v31
    ds_read_u16 v81, v61 offset:16
    s_setprio 1
    v_ffbl_b32 v84, v59
    v_perm_b32 v60, v74, v73, v84
    v_and_or_b32 v60, v60, s66, v85

    v_cmpx_ge_u32 vcc, 2, v84
    ds_add_u32 v60, v10
    s_not_b64 s[70:71], vcc
    s_mov_b64 exec, s[70:71]
    ds_add_rtn_u32 v87, v60, v10
    s_mov_b64 exec, -1

    ds_wrxchg_rtn_b32 v116, v86, v13
    s_waitcnt vmcnt(11)
    s_mov_b64 exec, s[4:5]
    buffer_store_dwordx4 v[104:107], v9, s[32:35], s47 offen sc1
    s_mov_b64 exec, -1
    buffer_load_dwordx4 v[176:179], v9, s[28:31], s77 offen offset:0
    buffer_load_dwordx4 v[180:183], v9, s[28:31], s77 offen offset:1024

    s_waitcnt lgkmcnt(0)
    v_cmp_gt_u32 s[68:69], 2, v116

    s_mov_b64 exec, s[70:71]
    v_cmpx_le_u32 vcc, 2, v87
    v_mov_b32 v62, s69
    v_perm_b32 v121, v62, s68, v3
    v_perm_b32 v122, v62, s68, v2
    v_and_b32 v121, v121, v19
    v_and_b32 v122, v122, v18
    v_msad_u8 v120, v67, v121, 0
    v_lshlrev_b32 v120, 8, v120
    v_msad_u8 v120, v63, v122, v120
    v_and_b32 v120, v120, v59

    v_ffbl_b32 v120, v120
    v_max_i32 v84, v84, v120
    s_mov_b64 exec, -1
    v_lshl_add_u32 v59, -1, v84, v59

    v_lshl_add_u32 v61, v84, 1, v31
    ds_read_u16 v82, v61 offset:16
    s_setprio 0
    v_ffbl_b32 v84, v59
    v_perm_b32 v60, v74, v73, v84
    v_and_or_b32 v60, v60, s66, v85

    v_cmpx_ge_u32 vcc, 3, v84
    ds_add_u32 v60, v10
    s_not_b64 s[70:71], vcc
    s_mov_b64 exec, s[70:71]
    ds_add_rtn_u32 v87, v60, v10
    s_mov_b64 exec, -1

    ds_wrxchg_rtn_b32 v116, v86, v13
    buffer_load_dwordx4 v[184:187], v9, s[28:31], s77 offen offset:2048
    buffer_load_dwordx4 v[188:191], v9, s[28:31], s77 offen offset:3072

    s_waitcnt lgkmcnt(0)
    v_cmp_gt_u32 s[68:69], 2, v116

    s_mov_b64 exec, s[70:71]
    v_cmpx_le_u32 vcc, 2, v87
    v_mov_b32 v62, s69
    v_perm_b32 v121, v62, s68, v3
    v_and_b32 v121, v121, v19
    v_msad_u8 v120, v67, v121, 0
    v_and_b32_sdwa v120, v120, v59 dst_sel:BYTE_1 dst_unused:UNUSED_PAD src0_sel:DWORD src1_sel:BYTE_1
    s_nop 0

    v_ffbl_b32 v120, v120
    v_max_i32 v84, v84, v120
    s_mov_b64 exec, -1
    v_lshl_add_u32 v59, -1, v84, v59

    v_lshl_add_u32 v61, v84, 1, v31
    ds_read_u16 v83, v61 offset:16
    v_lshrrev_b32 v59, 4, v59
    v_add_u32 v63, v58, v19
    s_setprio 1
    v_ffbl_b32 v84, v59
    v_perm_b32 v60, v75, v74, v84
    v_and_or_b32 v60, v60, s66, v85

    v_cmpx_ge_u32 vcc, 0, v84
    ds_add_u32 v60, v10
    s_not_b64 s[70:71], vcc
    s_mov_b64 exec, s[70:71]
    ds_add_rtn_u32 v87, v60, v10
    s_mov_b64 exec, -1

    ds_wrxchg_rtn_b32 v116, v86, v13

    s_waitcnt lgkmcnt(0)
    v_cmp_gt_u32 s[68:69], 2, v116

    v_lshl_or_b32 v24, v81, 16, v80
    v_lshl_or_b32 v25, v83, 16, v82
    buffer_store_dwordx2 v[24:25], v30, s[32:35], s62 offen sc1
    s_add_u32 s62, s62, s63
    s_mov_b64 exec, s[70:71]
    v_cmpx_le_u32 vcc, 2, v87
    v_mov_b32 v62, s69
    v_perm_b32 v121, v62, s68, v4
    v_perm_b32 v122, v62, s68, v3
    v_and_b32 v121, v121, v20
    v_and_b32 v122, v122, v19
    v_msad_u8 v120, v68, v121, 0
    v_lshlrev_b32 v120, 8, v120
    v_msad_u8 v120, v63, v122, v120
    v_and_b32 v120, v120, v59

    v_ffbl_b32 v120, v120
    v_max_i32 v84, v84, v120
    s_mov_b64 exec, -1
    v_lshl_add_u32 v59, -1, v84, v59

    v_lshl_add_u32 v61, v84, 1, v31
    ds_read_u16 v80, v61 offset:24
    s_setprio 0
    v_ffbl_b32 v84, v59
    v_perm_b32 v60, v75, v74, v84
    v_and_or_b32 v60, v60, s66, v85

    v_cmpx_ge_u32 vcc, 1, v84
    ds_add_u32 v60, v10
    s_not_b64 s[70:71], vcc
    s_mov_b64 exec, s[70:71]
    ds_add_rtn_u32 v87, v60, v10
    s_mov_b64 exec, -1

    ds_wrxchg_rtn_b32 v116, v86, v13

    s_waitcnt lgkmcnt(0)
    v_cmp_gt_u32 s[68:69], 2, v116

    s_mov_b64 exec, s[70:71]
    v_cmpx_le_u32 vcc, 2, v87
    v_mov_b32 v62, s69
    v_perm_b32 v121, v62, s68, v4
    v_perm_b32 v122, v62, s68, v3
    v_and_b32 v121, v121, v20
    v_and_b32 v122, v122, v19
    v_msad_u8 v120, v68, v121, 0
    v_lshlrev_b32 v120, 8, v120
    v_msad_u8 v120, v63, v122, v120
    v_and_b32 v120, v120, v59

    v_ffbl_b32 v120, v120
    v_max_i32 v84, v84, v120
    s_mov_b64 exec, -1
    v_lshl_add_u32 v59, -1, v84, v59

    v_lshl_add_u32 v61, v84, 1, v31
    ds_read_u16 v81, v61 offset:24
    s_setprio 1

    s_cmp_ge_u32 s57, 800
    s_cbranch_scc1 standalone__deep_cross_pnn__recsys_kernel_norl
    s_waitcnt vmcnt(0)

    s_lshl_b32 s39, 1, s2
    s_cmp_eq_u32 s64, 0
    s_cselect_b32 s39, s39, 0

    s_lshr_b32 s38, s2, 5
    v_mov_b32 v60, s39
    s_lshl_b32 s38, s38, 4
    s_and_b64 exec, s[4:5], 1
    buffer_atomic_or v60, v13, s[52:55], s38 offen offset:128
    s_mov_b64 exec, -1

    v_perm_b32 v88, v132, v128, s84
    v_perm_b32 v89, v140, v136, s84
    v_perm_b32 v90, v148, v144, s84
    v_perm_b32 v91, v156, v152, s84
    v_perm_b32 v92, v132, v128, s85
    v_perm_b32 v93, v140, v136, s85
    v_perm_b32 v94, v148, v144, s85
    v_perm_b32 v95, v156, v152, s85
    v_perm_b32 v96, v133, v129, s84
    v_perm_b32 v97, v141, v137, s84
    v_perm_b32 v98, v149, v145, s84
    v_perm_b32 v99, v157, v153, s84
    v_perm_b32 v100, v133, v129, s85
    v_perm_b32 v101, v141, v137, s85
    v_perm_b32 v102, v149, v145, s85
    v_perm_b32 v103, v157, v153, s85
    ds_write_b128 v36, v[88:91]
    ds_write_b128 v37, v[92:95]
    ds_write_b128 v38, v[96:99]
    ds_write_b128 v39, v[100:103]
    ds_read_b128 v[192:195], v15 offset:0
    ds_read_b128 v[196:199], v15 offset:1024
    ds_read_b128 v[200:203], v15 offset:2048
    ds_read_b128 v[204:207], v15 offset:3072
    s_waitcnt lgkmcnt(4)
    v_perm_b32 v88, v164, v160, s84
    v_perm_b32 v89, v172, v168, s84
    v_perm_b32 v90, v180, v176, s84
    v_perm_b32 v91, v188, v184, s84
    v_perm_b32 v92, v164, v160, s85
    v_perm_b32 v93, v172, v168, s85
    v_perm_b32 v94, v180, v176, s85
    v_perm_b32 v95, v188, v184, s85
    v_perm_b32 v96, v165, v161, s84
    v_perm_b32 v97, v173, v169, s84
    v_perm_b32 v98, v181, v177, s84
    v_perm_b32 v99, v189, v185, s84
    v_perm_b32 v100, v165, v161, s85
    v_perm_b32 v101, v173, v169, s85
    v_perm_b32 v102, v181, v177, s85
    v_perm_b32 v103, v189, v185, s85
    ds_write_b128 v36, v[88:91]
    ds_write_b128 v37, v[92:95]
    ds_write_b128 v38, v[96:99]
    ds_write_b128 v39, v[100:103]
    ds_read_b128 v[208:211], v15 offset:0
    ds_read_b128 v[212:215], v15 offset:1024
    ds_read_b128 v[216:219], v15 offset:2048
    ds_read_b128 v[220:223], v15 offset:3072
    s_waitcnt lgkmcnt(4)
    v_perm_b32 v88, v134, v130, s84
    v_perm_b32 v89, v142, v138, s84
    v_perm_b32 v90, v150, v146, s84
    v_perm_b32 v91, v158, v154, s84
    v_perm_b32 v92, v134, v130, s85
    v_perm_b32 v93, v142, v138, s85
    v_perm_b32 v94, v150, v146, s85
    v_perm_b32 v95, v158, v154, s85
    v_perm_b32 v96, v135, v131, s84
    v_perm_b32 v97, v143, v139, s84
    v_perm_b32 v98, v151, v147, s84
    v_perm_b32 v99, v159, v155, s84
    v_perm_b32 v100, v135, v131, s85
    v_perm_b32 v101, v143, v139, s85
    v_perm_b32 v102, v151, v147, s85
    v_perm_b32 v103, v159, v155, s85
    ds_write_b128 v36, v[88:91]
    ds_write_b128 v37, v[92:95]
    ds_write_b128 v38, v[96:99]
    ds_write_b128 v39, v[100:103]
    ds_read_b128 v[224:227], v15 offset:0
    ds_read_b128 v[228:231], v15 offset:1024
    ds_read_b128 v[232:235], v15 offset:2048
    ds_read_b128 v[236:239], v15 offset:3072
    s_waitcnt lgkmcnt(4)
    v_perm_b32 v88, v166, v162, s84
    v_perm_b32 v89, v174, v170, s84
    v_perm_b32 v90, v182, v178, s84
    v_perm_b32 v91, v190, v186, s84
    v_perm_b32 v92, v166, v162, s85
    v_perm_b32 v93, v174, v170, s85
    v_perm_b32 v94, v182, v178, s85
    v_perm_b32 v95, v190, v186, s85
    v_perm_b32 v96, v167, v163, s84
    v_perm_b32 v97, v175, v171, s84
    v_perm_b32 v98, v183, v179, s84
    v_perm_b32 v99, v191, v187, s84
    v_perm_b32 v100, v167, v163, s85
    v_perm_b32 v101, v175, v171, s85
    v_perm_b32 v102, v183, v179, s85
    v_perm_b32 v103, v191, v187, s85
    ds_write_b128 v36, v[88:91]
    ds_write_b128 v37, v[92:95]
    ds_write_b128 v38, v[96:99]
    ds_write_b128 v39, v[100:103]
    ds_read_b128 v[240:243], v15 offset:0
    ds_read_b128 v[244:247], v15 offset:1024
    ds_read_b128 v[248:251], v15 offset:2048
    ds_read_b128 v[252:255], v15 offset:3072
    ds_write_b64 v31, v[44:45] offset:24
    ds_write_b64 v31, v[46:47] offset:32
    ds_write_b64 v31, v[48:49] offset:40
    ds_write_b64 v31, v[50:51] offset:48
    ds_write_b64 v31, v[52:53] offset:56
    ds_write_b64 v31, v[54:55] offset:64
    s_waitcnt lgkmcnt(6)
standalone__deep_cross_pnn__recsys_kernel_norl:
standalone__deep_cross_pnn__recsys_kernel_rld:
    v_ffbl_b32 v84, v59
    v_perm_b32 v60, v75, v74, v84
    v_and_or_b32 v60, v60, s66, v85

    v_cmpx_ge_u32 vcc, 2, v84
    ds_add_u32 v60, v10
    s_not_b64 s[70:71], vcc
    s_mov_b64 exec, s[70:71]
    ds_add_rtn_u32 v87, v60, v10
    s_mov_b64 exec, -1

    ds_wrxchg_rtn_b32 v116, v86, v13
    s_add_u32 s83, s82, 0
    buffer_store_dwordx4 v[192:195], v14, s[32:35], s83 offen sc1
    s_add_u32 s83, s82, 64
    buffer_store_dwordx4 v[208:211], v14, s[32:35], s83 offen sc1

    s_waitcnt lgkmcnt(0)
    v_cmp_gt_u32 s[68:69], 2, v116

    s_mov_b64 exec, s[70:71]
    v_cmpx_le_u32 vcc, 2, v87
    v_mov_b32 v62, s69
    v_perm_b32 v121, v62, s68, v4
    v_perm_b32 v122, v62, s68, v3
    v_and_b32 v121, v121, v20
    v_and_b32 v122, v122, v19
    v_msad_u8 v120, v68, v121, 0
    v_lshlrev_b32 v120, 8, v120
    v_msad_u8 v120, v63, v122, v120
    v_and_b32 v120, v120, v59

    v_ffbl_b32 v120, v120
    v_max_i32 v84, v84, v120
    s_mov_b64 exec, -1
    v_lshl_add_u32 v59, -1, v84, v59

    v_lshl_add_u32 v61, v84, 1, v31
    ds_read_u16 v82, v61 offset:24
    s_setprio 0
    v_ffbl_b32 v84, v59
    v_perm_b32 v60, v75, v74, v84
    v_and_or_b32 v60, v60, s66, v85

    v_cmpx_ge_u32 vcc, 3, v84
    ds_add_u32 v60, v10
    s_not_b64 s[70:71], vcc
    s_mov_b64 exec, s[70:71]
    ds_add_rtn_u32 v87, v60, v10
    s_mov_b64 exec, -1

    ds_wrxchg_rtn_b32 v116, v86, v13
    s_add_u32 s83, s82, 3284992
    buffer_store_dwordx4 v[196:199], v14, s[32:35], s83 offen sc1
    s_add_u32 s83, s82, 3285056
    buffer_store_dwordx4 v[212:215], v14, s[32:35], s83 offen sc1

    s_waitcnt lgkmcnt(0)
    v_cmp_gt_u32 s[68:69], 2, v116

    s_mov_b64 exec, s[70:71]
    v_cmpx_le_u32 vcc, 2, v87
    v_mov_b32 v62, s69
    v_perm_b32 v121, v62, s68, v4
    v_and_b32 v121, v121, v20
    v_msad_u8 v120, v68, v121, 0
    v_and_b32_sdwa v120, v120, v59 dst_sel:BYTE_1 dst_unused:UNUSED_PAD src0_sel:DWORD src1_sel:BYTE_1
    s_nop 0

    v_ffbl_b32 v120, v120
    v_max_i32 v84, v84, v120
    s_mov_b64 exec, -1
    v_lshl_add_u32 v59, -1, v84, v59

    v_lshl_add_u32 v61, v84, 1, v31
    ds_read_u16 v83, v61 offset:24
    v_lshrrev_b32 v59, 4, v59
    v_add_u32 v63, v58, v20
    s_setprio 1
    v_ffbl_b32 v84, v59
    v_perm_b32 v60, v76, v75, v84
    v_and_or_b32 v60, v60, s66, v85

    v_cmpx_ge_u32 vcc, 0, v84
    ds_add_u32 v60, v10
    s_not_b64 s[70:71], vcc
    s_mov_b64 exec, s[70:71]
    ds_add_rtn_u32 v87, v60, v10
    s_mov_b64 exec, -1

    ds_wrxchg_rtn_b32 v116, v86, v13
    s_add_u32 s83, s82, 6569984
    buffer_store_dwordx4 v[200:203], v14, s[32:35], s83 offen sc1
    s_add_u32 s83, s82, 6570048
    buffer_store_dwordx4 v[216:219], v14, s[32:35], s83 offen sc1

    s_waitcnt lgkmcnt(0)
    v_cmp_gt_u32 s[68:69], 2, v116

    v_lshl_or_b32 v24, v81, 16, v80
    v_lshl_or_b32 v25, v83, 16, v82
    buffer_store_dwordx2 v[24:25], v30, s[32:35], s62 offen sc1
    s_add_u32 s62, s62, s63
    s_mov_b64 exec, s[70:71]
    v_cmpx_le_u32 vcc, 2, v87
    v_mov_b32 v62, s69
    v_perm_b32 v121, v62, s68, v5
    v_perm_b32 v122, v62, s68, v4
    v_and_b32 v121, v121, v21
    v_and_b32 v122, v122, v20
    v_msad_u8 v120, v69, v121, 0
    v_lshlrev_b32 v120, 8, v120
    v_msad_u8 v120, v63, v122, v120
    v_and_b32 v120, v120, v59

    v_ffbl_b32 v120, v120
    v_max_i32 v84, v84, v120
    s_mov_b64 exec, -1
    v_lshl_add_u32 v59, -1, v84, v59

    v_lshl_add_u32 v61, v84, 1, v31
    ds_read_u16 v80, v61 offset:32
    s_setprio 0
    v_ffbl_b32 v84, v59
    v_perm_b32 v60, v76, v75, v84
    v_and_or_b32 v60, v60, s66, v85

    v_cmpx_ge_u32 vcc, 1, v84
    ds_add_u32 v60, v10
    s_not_b64 s[70:71], vcc
    s_mov_b64 exec, s[70:71]
    ds_add_rtn_u32 v87, v60, v10
    s_mov_b64 exec, -1

    ds_wrxchg_rtn_b32 v116, v86, v13
    s_add_u32 s83, s82, 9854976
    buffer_store_dwordx4 v[204:207], v14, s[32:35], s83 offen sc1
    s_add_u32 s83, s82, 9855040
    buffer_store_dwordx4 v[220:223], v14, s[32:35], s83 offen sc1

    s_waitcnt lgkmcnt(0)
    v_cmp_gt_u32 s[68:69], 2, v116

    s_mov_b64 exec, s[70:71]
    v_cmpx_le_u32 vcc, 2, v87
    v_mov_b32 v62, s69
    v_perm_b32 v121, v62, s68, v5
    v_perm_b32 v122, v62, s68, v4
    v_and_b32 v121, v121, v21
    v_and_b32 v122, v122, v20
    v_msad_u8 v120, v69, v121, 0
    v_lshlrev_b32 v120, 8, v120
    v_msad_u8 v120, v63, v122, v120
    v_and_b32 v120, v120, v59

    v_ffbl_b32 v120, v120
    v_max_i32 v84, v84, v120
    s_mov_b64 exec, -1
    v_lshl_add_u32 v59, -1, v84, v59

    v_lshl_add_u32 v61, v84, 1, v31
    ds_read_u16 v81, v61 offset:32
    s_setprio 1
    v_ffbl_b32 v84, v59
    v_perm_b32 v60, v76, v75, v84
    v_and_or_b32 v60, v60, s66, v85

    v_cmpx_ge_u32 vcc, 2, v84
    ds_add_u32 v60, v10
    s_not_b64 s[70:71], vcc
    s_mov_b64 exec, s[70:71]
    ds_add_rtn_u32 v87, v60, v10
    s_mov_b64 exec, -1

    ds_wrxchg_rtn_b32 v116, v86, v13
    s_add_u32 s83, s82, 102656
    buffer_store_dwordx4 v[224:227], v14, s[32:35], s83 offen sc1
    s_add_u32 s83, s82, 102720
    buffer_store_dwordx4 v[240:243], v14, s[32:35], s83 offen sc1

    s_waitcnt lgkmcnt(0)
    v_cmp_gt_u32 s[68:69], 2, v116

    s_mov_b64 exec, s[70:71]
    v_cmpx_le_u32 vcc, 2, v87
    v_mov_b32 v62, s69
    v_perm_b32 v121, v62, s68, v5
    v_perm_b32 v122, v62, s68, v4
    v_and_b32 v121, v121, v21
    v_and_b32 v122, v122, v20
    v_msad_u8 v120, v69, v121, 0
    v_lshlrev_b32 v120, 8, v120
    v_msad_u8 v120, v63, v122, v120
    v_and_b32 v120, v120, v59

    v_ffbl_b32 v120, v120
    v_max_i32 v84, v84, v120
    s_mov_b64 exec, -1
    v_lshl_add_u32 v59, -1, v84, v59

    v_lshl_add_u32 v61, v84, 1, v31
    ds_read_u16 v82, v61 offset:32
    s_setprio 0
    v_ffbl_b32 v84, v59
    v_perm_b32 v60, v76, v75, v84
    v_and_or_b32 v60, v60, s66, v85

    v_cmpx_ge_u32 vcc, 3, v84
    ds_add_u32 v60, v10
    s_not_b64 s[70:71], vcc
    s_mov_b64 exec, s[70:71]
    ds_add_rtn_u32 v87, v60, v10
    s_mov_b64 exec, -1

    ds_wrxchg_rtn_b32 v116, v86, v13
    s_add_u32 s83, s82, 3387648
    buffer_store_dwordx4 v[228:231], v14, s[32:35], s83 offen sc1
    s_add_u32 s83, s82, 3387712
    buffer_store_dwordx4 v[244:247], v14, s[32:35], s83 offen sc1

    s_waitcnt lgkmcnt(0)
    v_cmp_gt_u32 s[68:69], 2, v116

    s_mov_b64 exec, s[70:71]
    v_cmpx_le_u32 vcc, 2, v87
    v_mov_b32 v62, s69
    v_perm_b32 v121, v62, s68, v5
    v_and_b32 v121, v121, v21
    v_msad_u8 v120, v69, v121, 0
    v_and_b32_sdwa v120, v120, v59 dst_sel:BYTE_1 dst_unused:UNUSED_PAD src0_sel:DWORD src1_sel:BYTE_1
    s_nop 0

    v_ffbl_b32 v120, v120
    v_max_i32 v84, v84, v120
    s_mov_b64 exec, -1
    v_lshl_add_u32 v59, -1, v84, v59

    v_lshl_add_u32 v61, v84, 1, v31
    ds_read_u16 v83, v61 offset:32
    v_lshrrev_b32 v59, 4, v59
    v_add_u32 v63, v58, v21

    s_bitcmp0_b32 s59, 0
    s_cbranch_scc1 standalone__deep_cross_pnn__recsys_kernel_mg2
    v_mov_b32 v60, s46
    v_subrev_u32 v61, 512, v86

standalone__deep_cross_pnn__recsys_kernel_mg1:

    ds_read_b32 v12, v60
    ds_read_b32 v120, v61
    s_waitcnt lgkmcnt(0)
    v_readfirstlane_b32 s45, v12
    s_cmp_lg_u32 s45, 0
    s_cbranch_scc1 standalone__deep_cross_pnn__recsys_kernel_mg3
    s_sleep 2
    s_branch standalone__deep_cross_pnn__recsys_kernel_mg1

standalone__deep_cross_pnn__recsys_kernel_mg3:

    ds_write_b32 v60, v13
    s_mov_b32 s45, 0xff00
    v_lshl_or_b32 v120, v120, 8, v120
    v_and_or_b32 v59, v120, s45, v59

standalone__deep_cross_pnn__recsys_kernel_mg2:
    s_setprio 1
    v_ffbl_b32 v84, v59
    v_perm_b32 v60, v77, v76, v84
    v_and_or_b32 v60, v60, s66, v85

    v_cmpx_ge_u32 vcc, 0, v84
    ds_add_u32 v60, v10
    s_not_b64 s[70:71], vcc
    s_mov_b64 exec, s[70:71]
    ds_add_rtn_u32 v87, v60, v10
    s_mov_b64 exec, -1

    ds_wrxchg_rtn_b32 v116, v86, v13
    s_add_u32 s83, s82, 6672640
    buffer_store_dwordx4 v[232:235], v14, s[32:35], s83 offen sc1
    s_add_u32 s83, s82, 6672704
    buffer_store_dwordx4 v[248:251], v14, s[32:35], s83 offen sc1
    buffer_store_dwordx4 v[108:111], v9, s[12:15], s6 offen offset:0 sc1
    buffer_store_dwordx4 v[108:111], v9, s[12:15], s6 offen offset:1024 sc1

    s_waitcnt lgkmcnt(0)
    v_cmp_gt_u32 s[68:69], 2, v116

    v_lshl_or_b32 v24, v81, 16, v80
    v_lshl_or_b32 v25, v83, 16, v82
    buffer_store_dwordx2 v[24:25], v30, s[32:35], s62 offen sc1
    s_add_u32 s62, s62, s63
    s_mov_b64 exec, s[70:71]
    v_cmpx_le_u32 vcc, 2, v87
    v_mov_b32 v62, s69
    v_perm_b32 v121, v62, s68, v6
    v_perm_b32 v122, v62, s68, v5
    v_and_b32 v121, v121, v22
    v_and_b32 v122, v122, v21
    v_msad_u8 v120, v70, v121, 0
    v_lshlrev_b32 v120, 8, v120
    v_msad_u8 v120, v63, v122, v120
    v_and_b32 v120, v120, v59

    v_ffbl_b32 v120, v120
    v_max_i32 v84, v84, v120
    s_mov_b64 exec, -1
    v_lshl_add_u32 v59, -1, v84, v59

    v_lshl_add_u32 v61, v84, 1, v31
    ds_read_u16 v80, v61 offset:40
    s_setprio 0
    v_ffbl_b32 v84, v59
    v_perm_b32 v60, v77, v76, v84
    v_and_or_b32 v60, v60, s66, v85

    v_cmpx_ge_u32 vcc, 1, v84
    ds_add_u32 v60, v10
    s_not_b64 s[70:71], vcc
    s_mov_b64 exec, s[70:71]
    ds_add_rtn_u32 v87, v60, v10
    s_mov_b64 exec, -1

    ds_wrxchg_rtn_b32 v116, v86, v13
    s_add_u32 s83, s82, 9957632
    buffer_store_dwordx4 v[236:239], v14, s[32:35], s83 offen sc1
    s_add_u32 s83, s82, 9957696
    buffer_store_dwordx4 v[252:255], v14, s[32:35], s83 offen sc1
    buffer_store_dwordx4 v[108:111], v9, s[12:15], s6 offen offset:2048 sc1
    buffer_store_dwordx4 v[108:111], v9, s[12:15], s6 offen offset:3072 sc1

    s_waitcnt lgkmcnt(0)
    v_cmp_gt_u32 s[68:69], 2, v116

    s_mov_b64 exec, s[70:71]
    v_cmpx_le_u32 vcc, 2, v87
    v_mov_b32 v62, s69
    v_perm_b32 v121, v62, s68, v6
    v_perm_b32 v122, v62, s68, v5
    v_and_b32 v121, v121, v22
    v_and_b32 v122, v122, v21
    v_msad_u8 v120, v70, v121, 0
    v_lshlrev_b32 v120, 8, v120
    v_msad_u8 v120, v63, v122, v120
    v_and_b32 v120, v120, v59

    v_ffbl_b32 v120, v120
    v_max_i32 v84, v84, v120
    s_mov_b64 exec, -1
    v_lshl_add_u32 v59, -1, v84, v59

    v_lshl_add_u32 v61, v84, 1, v31
    ds_read_u16 v81, v61 offset:40
    s_setprio 1
    v_ffbl_b32 v84, v59
    v_perm_b32 v60, v77, v76, v84
    v_and_or_b32 v60, v60, s66, v85

    v_cmpx_ge_u32 vcc, 2, v84
    ds_add_u32 v60, v10
    s_not_b64 s[70:71], vcc
    s_mov_b64 exec, s[70:71]
    ds_add_rtn_u32 v87, v60, v10
    s_mov_b64 exec, -1

    ds_wrxchg_rtn_b32 v116, v86, v13
    buffer_store_dwordx4 v[108:111], v9, s[12:15], s7 offen offset:0 sc1
    buffer_store_dwordx4 v[108:111], v9, s[12:15], s7 offen offset:1024 sc1

    s_waitcnt lgkmcnt(0)
    v_cmp_gt_u32 s[68:69], 2, v116

    s_mov_b64 exec, s[70:71]
    v_cmpx_le_u32 vcc, 2, v87
    v_mov_b32 v62, s69
    v_perm_b32 v121, v62, s68, v6
    v_perm_b32 v122, v62, s68, v5
    v_and_b32 v121, v121, v22
    v_and_b32 v122, v122, v21
    v_msad_u8 v120, v70, v121, 0
    v_lshlrev_b32 v120, 8, v120
    v_msad_u8 v120, v63, v122, v120
    v_and_b32 v120, v120, v59

    v_ffbl_b32 v120, v120
    v_max_i32 v84, v84, v120
    s_mov_b64 exec, -1
    v_lshl_add_u32 v59, -1, v84, v59

    v_lshl_add_u32 v61, v84, 1, v31
    ds_read_u16 v82, v61 offset:40
    s_setprio 0
    v_ffbl_b32 v84, v59
    v_perm_b32 v60, v77, v76, v84
    v_and_or_b32 v60, v60, s66, v85

    v_cmpx_ge_u32 vcc, 3, v84
    ds_add_u32 v60, v10
    s_not_b64 s[70:71], vcc
    s_mov_b64 exec, s[70:71]
    ds_add_rtn_u32 v87, v60, v10
    s_mov_b64 exec, -1

    ds_wrxchg_rtn_b32 v116, v86, v13
    buffer_store_dwordx4 v[108:111], v9, s[12:15], s7 offen offset:2048 sc1
    buffer_store_dwordx4 v[108:111], v9, s[12:15], s7 offen offset:3072 sc1
    buffer_store_dwordx2 v[108:109], v30, s[12:15], s8 offen sc1
    s_mov_b64 exec, 0xff
    buffer_load_dword v104, v9, s[52:55], 0 offen offset:128 sc1
    s_mov_b64 exec, -1

    s_waitcnt lgkmcnt(0)
    v_cmp_gt_u32 s[68:69], 2, v116

    s_mov_b64 exec, s[70:71]
    v_cmpx_le_u32 vcc, 2, v87
    v_mov_b32 v62, s69
    v_perm_b32 v121, v62, s68, v6
    v_and_b32 v121, v121, v22
    v_msad_u8 v120, v70, v121, 0
    v_and_b32_sdwa v120, v120, v59 dst_sel:BYTE_1 dst_unused:UNUSED_PAD src0_sel:DWORD src1_sel:BYTE_1
    s_nop 0

    v_ffbl_b32 v120, v120
    v_max_i32 v84, v84, v120
    s_mov_b64 exec, -1
    v_lshl_add_u32 v59, -1, v84, v59

    v_lshl_add_u32 v61, v84, 1, v31
    ds_read_u16 v83, v61 offset:40

    s_bitcmp1_b32 s59, 0
    s_cbranch_scc1 standalone__deep_cross_pnn__recsys_kernel_sk6
    v_mov_b32 v60, s46
    ds_write_b32 v86, v59
    ds_write_b32 v60, v10
    s_branch standalone__deep_cross_pnn__recsys_kernel_sdone

standalone__deep_cross_pnn__recsys_kernel_sk6:
    v_lshrrev_b32 v59, 4, v59
    v_add_u32 v63, v58, v22
    s_setprio 1
    v_ffbl_b32 v84, v59
    v_perm_b32 v60, v78, v77, v84

    v_cmp_lt_u32 vcc, 7, v84
    v_alignbyte_b32 v61, v79, v79, v84
    s_nop 0
    v_cndmask_b32 v60, v60, v61, vcc

    v_and_or_b32 v60, v60, s66, v85
    ds_add_rtn_u32 v87, v60, v10
    ds_wrxchg_rtn_b32 v116, v86, v13

    s_waitcnt lgkmcnt(0)
    v_cmp_gt_u32 s[68:69], 2, v116

    v_lshl_or_b32 v24, v81, 16, v80
    v_lshl_or_b32 v25, v83, 16, v82
    buffer_store_dwordx2 v[24:25], v30, s[32:35], s62 offen sc1
    s_add_u32 s62, s62, s63
    s_nop 0
    v_cmpx_le_u32 vcc, 2, v87
    v_mov_b32 v62, s69
    v_perm_b32 v121, v62, s68, v7
    v_perm_b32 v122, v62, s68, v6
    v_perm_b32 v123, v62, s68, v5
    v_and_b32 v121, v121, v23
    v_and_b32 v122, v122, v22
    v_and_b32 v123, v123, v21
    v_msad_u8 v120, v71, v121, 0
    v_lshlrev_b32 v120, 8, v120
    v_msad_u8 v120, v63, v122, v120
    v_msad_u8 v120, v69, v123, v120
    v_and_b32 v120, v120, v59

    v_ffbl_b32 v120, v120
    v_max_i32 v84, v84, v120
    s_mov_b64 exec, -1
    v_lshl_add_u32 v59, -1, v84, v59

    v_lshl_add_u32 v61, v84, 1, v31
    ds_read_u16 v80, v61 offset:48
    s_setprio 0
    v_ffbl_b32 v84, v59
    v_perm_b32 v60, v78, v77, v84

    v_cmp_lt_u32 vcc, 7, v84
    v_alignbyte_b32 v61, v79, v79, v84
    s_nop 0
    v_cndmask_b32 v60, v60, v61, vcc

    v_and_or_b32 v60, v60, s66, v85
    ds_add_rtn_u32 v87, v60, v10
    ds_wrxchg_rtn_b32 v116, v86, v13

    s_waitcnt lgkmcnt(0)
    v_cmp_gt_u32 s[68:69], 2, v116

    s_nop 0
    v_cmpx_le_u32 vcc, 2, v87
    v_mov_b32 v62, s69
    v_perm_b32 v121, v62, s68, v7
    v_perm_b32 v122, v62, s68, v6
    v_perm_b32 v123, v62, s68, v5
    v_and_b32 v121, v121, v23
    v_and_b32 v122, v122, v22
    v_and_b32 v123, v123, v21
    v_msad_u8 v120, v71, v121, 0
    v_lshlrev_b32 v120, 8, v120
    v_msad_u8 v120, v63, v122, v120
    v_msad_u8 v120, v69, v123, v120
    v_and_b32 v120, v120, v59

    v_ffbl_b32 v120, v120
    v_max_i32 v84, v84, v120
    s_mov_b64 exec, -1
    v_lshl_add_u32 v59, -1, v84, v59

    v_lshl_add_u32 v61, v84, 1, v31
    ds_read_u16 v81, v61 offset:48
    s_setprio 1
    v_ffbl_b32 v84, v59
    v_perm_b32 v60, v78, v77, v84

    v_cmp_lt_u32 vcc, 7, v84
    v_alignbyte_b32 v61, v79, v79, v84
    s_nop 0
    v_cndmask_b32 v60, v60, v61, vcc

    v_and_or_b32 v60, v60, s66, v85
    ds_add_rtn_u32 v87, v60, v10
    ds_wrxchg_rtn_b32 v116, v86, v13

    s_waitcnt lgkmcnt(0)
    v_cmp_gt_u32 s[68:69], 2, v116

    s_nop 0
    v_cmpx_le_u32 vcc, 2, v87
    v_mov_b32 v62, s69
    v_perm_b32 v121, v62, s68, v7
    v_perm_b32 v122, v62, s68, v6
    v_perm_b32 v123, v62, s68, v5
    v_and_b32 v121, v121, v23
    v_and_b32 v122, v122, v22
    v_and_b32 v123, v123, v21
    v_msad_u8 v120, v71, v121, 0
    v_lshlrev_b32 v120, 8, v120
    v_msad_u8 v120, v63, v122, v120
    v_msad_u8 v120, v69, v123, v120
    v_and_b32 v120, v120, v59

    v_ffbl_b32 v120, v120
    v_max_i32 v84, v84, v120
    s_mov_b64 exec, -1
    v_lshl_add_u32 v59, -1, v84, v59

    v_lshl_add_u32 v61, v84, 1, v31
    ds_read_u16 v82, v61 offset:48
    v_ffbl_b32 v84, v59
    v_lshl_add_u32 v61, v84, 1, v31
    ds_read_u16 v83, v61 offset:48
standalone__deep_cross_pnn__recsys_kernel_sdone:
    s_waitcnt lgkmcnt(0)
    v_lshl_or_b32 v24, v81, 16, v80
    v_lshl_or_b32 v25, v83, 16, v82
    buffer_store_dwordx2 v[24:25], v30, s[32:35], s62 offen sc1
    s_add_u32 s62, s62, s63
standalone__deep_cross_pnn__recsys_kernel_udone:
    s_setprio 0

    s_waitcnt vmcnt(0)

    s_mov_b64 exec, 1
    ds_add_rtn_u32 v12, v11, v10 offset:20
    s_mov_b32 s49, 0
    s_waitcnt lgkmcnt(0)
    v_readfirstlane_b32 s48, v12
    s_and_b32 s48, s48, 3

    s_mov_b64 exec, 0xff
standalone__deep_cross_pnn__recsys_kernel_ec1:

    v_cmp_ne_u32 vcc, -1, v104
    s_cbranch_vccz standalone__deep_cross_pnn__recsys_kernel_tbl
    buffer_load_dword v104, v9, s[52:55], 0 offen offset:128 sc1
    s_add_u32 s49, s49, 1
    s_waitcnt vmcnt(0)
    s_cmp_lt_u32 s49, 12
    s_cbranch_scc1 standalone__deep_cross_pnn__recsys_kernel_ec1
    s_branch standalone__deep_cross_pnn__recsys_kernel_enx

standalone__deep_cross_pnn__recsys_kernel_hset:

    s_lshl_b32 s39, 1, s51
    s_lshr_b32 s38, s51, 5
    v_mov_b32 v1, s39
    s_lshl_b32 s38, s38, 4
    s_mov_b64 exec, 1
    buffer_atomic_or v1, v13, s[52:55], s38 offen offset:132
    s_mov_b64 exec, -1
    s_waitcnt vmcnt(0)
    s_branch standalone__deep_cross_pnn__recsys_kernel_slow

standalone__deep_cross_pnn__recsys_kernel_tbl:
    s_mov_b64 exec, -1
    s_mov_b32 s49, -1

    s_xor_b32 s44, s50, 1
    s_lshl_b32 s44, s44, 3
    s_add_u32 s44, s44, s56
    s_lshl_b32 s44, s44, 14
    s_add_u32 s44, s44, 15204352
    s_add_u32 s47, s44, 65536

    buffer_load_dwordx4 v[136:139], v9, s[12:15], s44 offen offset:0 sc1
    buffer_load_dwordx4 v[140:143], v9, s[12:15], s44 offen offset:1024 sc1
    buffer_load_dwordx4 v[152:155], v9, s[12:15], s44 offen offset:2048 sc1
    buffer_load_dwordx4 v[156:159], v9, s[12:15], s44 offen offset:3072 sc1
    s_add_u32 s44, s44, 4096
    buffer_load_dwordx4 v[168:171], v9, s[12:15], s44 offen offset:0 sc1
    buffer_load_dwordx4 v[172:175], v9, s[12:15], s44 offen offset:1024 sc1
    buffer_load_dwordx4 v[184:187], v9, s[12:15], s44 offen offset:2048 sc1
    buffer_load_dwordx4 v[188:191], v9, s[12:15], s44 offen offset:3072 sc1
    s_add_u32 s44, s44, 4096
    s_waitcnt vmcnt(7)
    buffer_load_dwordx4 v[200:203], v9, s[12:15], s44 offen offset:0 sc1
    s_waitcnt vmcnt(7)
    buffer_load_dwordx4 v[204:207], v9, s[12:15], s44 offen offset:1024 sc1
    s_waitcnt vmcnt(7)
    buffer_load_dwordx4 v[216:219], v9, s[12:15], s44 offen offset:2048 sc1
    s_waitcnt vmcnt(7)
    buffer_load_dwordx4 v[220:223], v9, s[12:15], s44 offen offset:3072 sc1
    s_add_u32 s44, s44, 4096
    s_waitcnt vmcnt(7)
    buffer_load_dwordx4 v[232:235], v9, s[12:15], s44 offen offset:0 sc1
    s_waitcnt vmcnt(7)
    buffer_load_dwordx4 v[236:239], v9, s[12:15], s44 offen offset:1024 sc1
    s_waitcnt vmcnt(7)
    buffer_load_dwordx4 v[248:251], v9, s[12:15], s44 offen offset:2048 sc1
    s_waitcnt vmcnt(7)
    buffer_load_dwordx4 v[252:255], v9, s[12:15], s44 offen offset:3072 sc1
    s_add_u32 s44, s44, 4096
    s_waitcnt vmcnt(7)
    buffer_load_dwordx4 v[88:91], v9, s[12:15], s47 offen offset:0 sc1
    s_waitcnt vmcnt(7)
    buffer_load_dwordx4 v[88:91], v9, s[12:15], s47 offen offset:1024 sc1
    s_waitcnt vmcnt(7)
    buffer_load_dwordx4 v[88:91], v9, s[12:15], s47 offen offset:2048 sc1
    s_waitcnt vmcnt(7)
    buffer_load_dwordx4 v[88:91], v9, s[12:15], s47 offen offset:3072 sc1
    s_add_u32 s47, s47, 4096
    s_waitcnt vmcnt(7)
    buffer_load_dwordx4 v[88:91], v9, s[12:15], s47 offen offset:0 sc1
    s_waitcnt vmcnt(7)
    buffer_load_dwordx4 v[88:91], v9, s[12:15], s47 offen offset:1024 sc1
    s_waitcnt vmcnt(7)
    buffer_load_dwordx4 v[88:91], v9, s[12:15], s47 offen offset:2048 sc1
    s_waitcnt vmcnt(7)
    buffer_load_dwordx4 v[88:91], v9, s[12:15], s47 offen offset:3072 sc1
    s_add_u32 s47, s47, 4096
    s_waitcnt vmcnt(7)
    buffer_load_dwordx4 v[88:91], v9, s[12:15], s47 offen offset:0 sc1
    s_waitcnt vmcnt(7)
    buffer_load_dwordx4 v[88:91], v9, s[12:15], s47 offen offset:1024 sc1
    s_waitcnt vmcnt(7)
    buffer_load_dwordx4 v[88:91], v9, s[12:15], s47 offen offset:2048 sc1
    s_waitcnt vmcnt(7)
    buffer_load_dwordx4 v[88:91], v9, s[12:15], s47 offen offset:3072 sc1
    s_add_u32 s47, s47, 4096
    s_waitcnt vmcnt(7)
    buffer_load_dwordx4 v[88:91], v9, s[12:15], s47 offen offset:0 sc1
    s_waitcnt vmcnt(7)
    buffer_load_dwordx4 v[88:91], v9, s[12:15], s47 offen offset:1024 sc1
    s_waitcnt vmcnt(7)
    buffer_load_dwordx4 v[88:91], v9, s[12:15], s47 offen offset:2048 sc1
    s_waitcnt vmcnt(7)
    buffer_load_dwordx4 v[88:91], v9, s[12:15], s47 offen offset:3072 sc1
    s_add_u32 s47, s47, 4096
standalone__deep_cross_pnn__recsys_kernel_enx:

    s_mov_b64 exec, -1
    s_mul_i32 s85, s56, 18432
    v_and_b32 v25, 15, v8
    v_lshrrev_b32 v26, 4, v8
    v_mul_u32_u24 v24, 144, v25
    v_lshl_add_u32 v24, v26, 4, v24
    v_add_u32 v24, s85, v24

    s_lshr_b32 s79, s2, 1
    s_mul_i32 s77, s79, 102656
    s_lshl_b32 s85, s50, 11
    s_xor_b32 s78, s85, 2048
    s_add_u32 s78, s78, s77
    s_add_u32 s77, s77, s85
    s_and_b32 s79, s2, 1
    s_mul_i32 s79, s79, 1638400
    s_add_u32 s79, s79, 16777216
    s_lshl_b32 s85, s3, 13
    s_add_u32 s79, s79, s85
    s_xor_b32 s85, s3, 4
    s_lshl_b32 s85, s85, 10
    s_lshl_b32 s80, s24, 16
    s_and_b32 s81, s24, 0xffff0000
    s_lshl_b32 s82, s25, 16
    s_and_b32 s83, s25, 0xffff0000
    ds_read_b128 v[128:131], v24 offset:0
    ds_read_b128 v[132:135], v24 offset:64
    v_lshlrev_b32 v69, 4, v8
    v_lshlrev_b32 v70, 13, v26
    v_lshl_add_u32 v70, v25, 3, v70
    v_add_u32 v70, s85, v70
    ds_read_b128 v[144:147], v24 offset:2304
    ds_read_b128 v[148:151], v24 offset:2368
    v_lshrrev_b32 v28, 3, v8
    v_xor_b32 v28, v28, v26
    v_and_b32 v28, 1, v28
    v_bfe_u32 v29, v8, 2, 1
    ds_read_b128 v[160:163], v24 offset:4608
    ds_read_b128 v[164:167], v24 offset:4672
    v_lshl_or_b32 v28, v28, 1, v29
    v_mov_b32 v30, 0x3f80
    v_cmp_eq_u32 vcc, 0, v28
    v_cmp_eq_u32 s[68:69], 1, v28
    ds_read_b128 v[176:179], v24 offset:6912
    ds_read_b128 v[180:183], v24 offset:6976
    v_and_b32 v29, 3, v8
    v_mul_u32_u24 v68, 0x5555, v29
    v_cndmask_b32 v64, 0, v30, vcc
    v_cndmask_b32 v65, 0, v30, vcc
    ds_read_b128 v[192:195], v24 offset:9216
    ds_read_b128 v[196:199], v24 offset:9280
    v_cndmask_b32 v66, 0, v30, s[68:69]
    v_cndmask_b32 v67, 0, v30, s[68:69]
    v_add_u32 v114, 144256, v69
    v_add_u32 v71, 0x10000, v70
    ds_read_b128 v[208:211], v24 offset:11520
    ds_read_b128 v[212:215], v24 offset:11584
    v_mov_b64 v[32:33], s[80:81]
    v_mov_b64 v[34:35], s[82:83]
    v_mov_b64 v[36:37], s[80:81]
    v_mov_b64 v[38:39], s[82:83]
    ds_read_b128 v[224:227], v24 offset:13824
    ds_read_b128 v[228:231], v24 offset:13888
    v_mov_b64 v[40:41], s[80:81]
    v_mov_b64 v[42:43], s[82:83]
    v_mov_b64 v[44:45], s[80:81]
    v_mov_b64 v[46:47], s[82:83]
    ds_read_b128 v[240:243], v24 offset:16128
    ds_read_b128 v[244:247], v24 offset:16192
    v_mov_b64 v[48:49], s[80:81]
    v_mov_b64 v[50:51], s[82:83]
    v_mov_b64 v[52:53], s[80:81]
    v_mov_b64 v[54:55], s[82:83]
    v_mov_b64 v[56:57], s[80:81]
    v_mov_b64 v[58:59], s[82:83]
    v_mov_b64 v[60:61], s[80:81]
    v_mov_b64 v[62:63], s[82:83]

    s_bitcmp1_b32 s56, 1
    s_cselect_b32 s84, s78, s77
    s_lshl_b32 s85, s56, 10
    s_add_u32 m0, s85, 144256
    s_and_b32 s85, s85, 1024
    s_add_u32 s84, s84, s85

    s_add_u32 s85, s84, 0
    buffer_load_dwordx4 v[88:91], v69, s[12:15], s85 offen sc1
    s_add_u32 s85, s84, 4096
    buffer_load_dwordx4 v[88:91], v69, s[12:15], s85 offen sc1
    s_add_u32 s85, s84, 8192
    buffer_load_dwordx4 v[88:91], v69, s[12:15], s85 offen sc1
    s_add_u32 s85, s84, 12288
    buffer_load_dwordx4 v[88:91], v69, s[12:15], s85 offen sc1

    s_cmp_lg_u32 s48, 0
    s_cbranch_scc1 standalone__deep_cross_pnn__recsys_kernel_wdec
    s_mov_b64 exec, -1
    v_lshlrev_b32 v0, 7, v8
    v_lshrrev_b32 v2, 5, v8
    v_lshlrev_b32 v2, 4, v2
    v_lshlrev_b32 v3, 2, v8
    s_mov_b32 s44, 14680064
    s_bfe_u32 s46, s2, 131072
    s_lshl_b32 s47, s46, 7
    s_add_u32 s47, s47, 14688256
    s_lshl_b32 s46, s46, 2
    s_mov_b32 s38, 3221225472

standalone__deep_cross_pnn__recsys_kernel_p0:

    ds_read_b32 v12, v11 offset:20
    s_waitcnt lgkmcnt(0)
    v_readfirstlane_b32 s45, v12
    s_and_b32 s45, s45, 3
    s_cbranch_scc0 standalone__deep_cross_pnn__recsys_kernel_p1s
    s_sleep 1
    s_branch standalone__deep_cross_pnn__recsys_kernel_p0

standalone__deep_cross_pnn__recsys_kernel_p1s:

    s_cmp_lg_u32 s64, 0
    s_cbranch_scc1 standalone__deep_cross_pnn__recsys_kernel_hset

    s_mov_b64 exec, 1
    s_cmp_lg_u32 s49, -1
    s_cbranch_scc1 standalone__deep_cross_pnn__recsys_kernel_nfp
    v_mov_b32 v1, 1
    buffer_atomic_add v1, v13, s[12:15], s47 offen sc0
    buffer_store_dword v10, v13, s[12:15], s9 offen sc1
    s_waitcnt vmcnt(1)
    v_cmpx_eq_u32 vcc, 63, v1
    buffer_store_dword v10, v13, s[52:55], s46 offen sc1
    s_mov_b64 exec, 0xf

standalone__deep_cross_pnn__recsys_kernel_p1:

    buffer_load_dword v1, v3, s[52:55], 0 offen sc1
    s_add_u32 s65, s65, 1
    s_waitcnt vmcnt(0)
    v_cmp_eq_u32 vcc, 0, v1
    s_cbranch_vccz standalone__deep_cross_pnn__recsys_kernel_dec
    s_sleep 4
    s_cmp_lt_u32 s65, 200
    s_cbranch_scc1 standalone__deep_cross_pnn__recsys_kernel_p1
    s_mov_b64 exec, 1

standalone__deep_cross_pnn__recsys_kernel_nfp:

    buffer_store_dword v10, v13, s[12:15], s9 offen sc1
    s_mov_b64 exec, -1

standalone__deep_cross_pnn__recsys_kernel_slow:
    buffer_load_dwordx2 v[16:17], v2, s[52:55], 0 offen offset:128 sc1
    buffer_load_dwordx2 v[18:19], v2, s[52:55], 0 offen offset:160 sc1
    buffer_load_dwordx2 v[20:21], v2, s[52:55], 0 offen offset:192 sc1
    buffer_load_dwordx2 v[22:23], v2, s[52:55], 0 offen offset:224 sc1

    s_waitcnt vmcnt(0)
    buffer_load_dwordx4 v[4:7], v0, s[12:15], s44 offen sc1
    s_add_u32 s65, s65, 1
    s_waitcnt vmcnt(0)

    v_bfe_u32 v16, v16, v8, 1
    v_bfe_u32 v17, v17, v8, 1
    v_and_b32 v4, v4, v16
    v_or_b32 v17, v17, v4

    v_bfe_u32 v18, v18, v8, 1
    v_bfe_u32 v19, v19, v8, 1
    v_and_b32 v5, v5, v18
    v_or_b32 v19, v19, v5

    v_bfe_u32 v20, v20, v8, 1
    v_bfe_u32 v21, v21, v8, 1
    v_and_b32 v6, v6, v20
    v_or_b32 v21, v21, v6

    v_bfe_u32 v22, v22, v8, 1
    v_bfe_u32 v23, v23, v8, 1
    v_and_b32 v7, v7, v22
    v_or_b32 v23, v23, v7

    v_min3_u32 v1, v4, v5, v6
    v_min_u32 v1, v1, v7
    v_cmp_eq_u32 vcc, 0, v1
    s_mov_b32 s38, 3221225472
    s_cbranch_vccz standalone__deep_cross_pnn__recsys_kernel_dec
    v_min3_u32 v1, v17, v19, v21
    v_min_u32 v1, v1, v23
    v_cmp_eq_u32 vcc, 0, v1
    s_mov_b32 s38, 2147483648
    s_cbranch_vccz standalone__deep_cross_pnn__recsys_kernel_dec
    s_cmp_lt_u32 s65, 200
    s_cbranch_scc1 standalone__deep_cross_pnn__recsys_kernel_slow

    v_cmp_eq_u32 vcc, 0, v17
    s_movk_i32 s38, 0
    s_cbranch_vccnz standalone__deep_cross_pnn__recsys_kernel_fnd
    v_cmp_eq_u32 vcc, 0, v19
    s_movk_i32 s38, 64
    s_cbranch_vccnz standalone__deep_cross_pnn__recsys_kernel_fnd
    v_cmp_eq_u32 vcc, 0, v21
    s_movk_i32 s38, 128
    s_cbranch_vccnz standalone__deep_cross_pnn__recsys_kernel_fnd
    v_cmp_eq_u32 vcc, 0, v23
    s_movk_i32 s38, 192
standalone__deep_cross_pnn__recsys_kernel_fnd:

    s_ff1_i32_b64 s39, vcc
    s_add_u32 s38, s38, s39
    s_andn2_b32 s39, s64, 255
    s_add_u32 s39, s39, 256
    s_or_b32 s38, s38, s39

standalone__deep_cross_pnn__recsys_kernel_dec:

    s_mov_b64 exec, 1
    v_mov_b32 v1, s38
    ds_write_b32 v11, v1 offset:24

standalone__deep_cross_pnn__recsys_kernel_wdec:

    s_mov_b64 exec, -1
    ds_read_b32 v12, v11 offset:24
    s_waitcnt lgkmcnt(0)
    v_readfirstlane_b32 s45, v12
    s_cmp_lg_u32 s45, s64
    s_cbranch_scc1 standalone__deep_cross_pnn__recsys_kernel_gotd
    s_sleep 2
    s_branch standalone__deep_cross_pnn__recsys_kernel_wdec

standalone__deep_cross_pnn__recsys_kernel_hlp:
    s_waitcnt vmcnt(0)
    s_branch standalone__deep_cross_pnn__recsys_kernel_unit
standalone__deep_cross_pnn__recsys_kernel_gotd:

    s_mov_b32 s64, s45
    s_and_b32 s51, s45, 255

    s_mov_b32 s65, 200
    s_bitcmp0_b32 s45, 31
    s_cbranch_scc1 standalone__deep_cross_pnn__recsys_kernel_hlp

    s_cmp_eq_u32 s49, -1
    s_cbranch_scc1 standalone__deep_cross_pnn__recsys_kernel_k2

    s_xor_b32 s44, s50, 1
    s_lshl_b32 s44, s44, 3
    s_add_u32 s44, s44, s56
    s_lshl_b32 s44, s44, 14
    s_add_u32 s44, s44, 15204352
    s_add_u32 s47, s44, 65536

    buffer_load_dwordx4 v[136:139], v9, s[12:15], s44 offen offset:0 sc1
    buffer_load_dwordx4 v[140:143], v9, s[12:15], s44 offen offset:1024 sc1
    buffer_load_dwordx4 v[152:155], v9, s[12:15], s44 offen offset:2048 sc1
    buffer_load_dwordx4 v[156:159], v9, s[12:15], s44 offen offset:3072 sc1
    s_add_u32 s44, s44, 4096
    buffer_load_dwordx4 v[168:171], v9, s[12:15], s44 offen offset:0 sc1
    buffer_load_dwordx4 v[172:175], v9, s[12:15], s44 offen offset:1024 sc1
    buffer_load_dwordx4 v[184:187], v9, s[12:15], s44 offen offset:2048 sc1
    buffer_load_dwordx4 v[188:191], v9, s[12:15], s44 offen offset:3072 sc1
    s_add_u32 s44, s44, 4096
    s_waitcnt vmcnt(7)
    buffer_load_dwordx4 v[200:203], v9, s[12:15], s44 offen offset:0 sc1
    s_waitcnt vmcnt(7)
    buffer_load_dwordx4 v[204:207], v9, s[12:15], s44 offen offset:1024 sc1
    s_waitcnt vmcnt(7)
    buffer_load_dwordx4 v[216:219], v9, s[12:15], s44 offen offset:2048 sc1
    s_waitcnt vmcnt(7)
    buffer_load_dwordx4 v[220:223], v9, s[12:15], s44 offen offset:3072 sc1
    s_add_u32 s44, s44, 4096
    s_waitcnt vmcnt(7)
    buffer_load_dwordx4 v[232:235], v9, s[12:15], s44 offen offset:0 sc1
    s_waitcnt vmcnt(7)
    buffer_load_dwordx4 v[236:239], v9, s[12:15], s44 offen offset:1024 sc1
    s_waitcnt vmcnt(7)
    buffer_load_dwordx4 v[248:251], v9, s[12:15], s44 offen offset:2048 sc1
    s_waitcnt vmcnt(7)
    buffer_load_dwordx4 v[252:255], v9, s[12:15], s44 offen offset:3072 sc1
    s_add_u32 s44, s44, 4096
    s_waitcnt vmcnt(7)
    buffer_load_dwordx4 v[88:91], v9, s[12:15], s47 offen offset:0 sc1
    s_waitcnt vmcnt(7)
    buffer_load_dwordx4 v[88:91], v9, s[12:15], s47 offen offset:1024 sc1
    s_waitcnt vmcnt(7)
    buffer_load_dwordx4 v[88:91], v9, s[12:15], s47 offen offset:2048 sc1
    s_waitcnt vmcnt(7)
    buffer_load_dwordx4 v[88:91], v9, s[12:15], s47 offen offset:3072 sc1
    s_add_u32 s47, s47, 4096
    s_waitcnt vmcnt(7)
    buffer_load_dwordx4 v[88:91], v9, s[12:15], s47 offen offset:0 sc1
    s_waitcnt vmcnt(7)
    buffer_load_dwordx4 v[88:91], v9, s[12:15], s47 offen offset:1024 sc1
    s_waitcnt vmcnt(7)
    buffer_load_dwordx4 v[88:91], v9, s[12:15], s47 offen offset:2048 sc1
    s_waitcnt vmcnt(7)
    buffer_load_dwordx4 v[88:91], v9, s[12:15], s47 offen offset:3072 sc1
    s_add_u32 s47, s47, 4096
    s_waitcnt vmcnt(7)
    buffer_load_dwordx4 v[88:91], v9, s[12:15], s47 offen offset:0 sc1
    s_waitcnt vmcnt(7)
    buffer_load_dwordx4 v[88:91], v9, s[12:15], s47 offen offset:1024 sc1
    s_waitcnt vmcnt(7)
    buffer_load_dwordx4 v[88:91], v9, s[12:15], s47 offen offset:2048 sc1
    s_waitcnt vmcnt(7)
    buffer_load_dwordx4 v[88:91], v9, s[12:15], s47 offen offset:3072 sc1
    s_add_u32 s47, s47, 4096
    s_waitcnt vmcnt(7)
    buffer_load_dwordx4 v[88:91], v9, s[12:15], s47 offen offset:0 sc1
    s_waitcnt vmcnt(7)
    buffer_load_dwordx4 v[88:91], v9, s[12:15], s47 offen offset:1024 sc1
    s_waitcnt vmcnt(7)
    buffer_load_dwordx4 v[88:91], v9, s[12:15], s47 offen offset:2048 sc1
    s_waitcnt vmcnt(7)
    buffer_load_dwordx4 v[88:91], v9, s[12:15], s47 offen offset:3072 sc1
    s_add_u32 s47, s47, 4096
standalone__deep_cross_pnn__recsys_kernel_k2:
    s_setprio 1
    buffer_load_dwordx4 v[0:3], v69, s[12:15], s77 offen offset:0 sc1
    buffer_load_dwordx4 v[4:7], v69, s[12:15], s77 offen offset:1024 sc1
    buffer_load_dwordx4 v[8:11], v69, s[12:15], s78 offen offset:0 sc1
    buffer_load_dwordx4 v[12:15], v69, s[12:15], s78 offen offset:1024 sc1
    buffer_load_dwordx4 v69, s[12:15], s84 offen sc1 lds
    s_add_u32 m0, m0, 4096
    s_add_u32 s84, s84, 4096
    buffer_load_dwordx4 v69, s[12:15], s84 offen sc1 lds
    s_add_u32 m0, m0, 4096
    s_add_u32 s84, s84, 4096
    buffer_load_dwordx4 v69, s[12:15], s84 offen sc1 lds
    s_add_u32 s44, s77, 4096
    s_add_u32 s45, s78, 4096
    buffer_load_dwordx4 v[16:19], v69, s[12:15], s44 offen offset:0 sc1
    buffer_load_dwordx4 v[20:23], v69, s[12:15], s44 offen offset:1024 sc1
    buffer_load_dwordx4 v[24:27], v69, s[12:15], s45 offen offset:0 sc1
    buffer_load_dwordx4 v[28:31], v69, s[12:15], s45 offen offset:1024 sc1
    s_barrier
    s_waitcnt vmcnt(7)
    v_mfma_f32_16x16x32_bf16 v[88:91], v[0:3], v[128:131], 0
    v_mfma_f32_16x16x32_bf16 v[92:95], v[0:3], v[144:147], 0
    s_add_u32 s21, s77, 12288
    v_mfma_f32_16x16x32_bf16 v[88:91], v[4:7], v[132:135], v[88:91]
    s_add_u32 s19, s78, 12288
    v_mfma_f32_16x16x32_bf16 v[92:95], v[4:7], v[148:151], v[92:95]
    s_mov_b32 s20, s79
    v_mfma_f32_16x16x32_bf16 v[88:91], v[8:11], v[136:139], v[88:91]
    s_lshr_b32 s33, s2, 1
    v_mfma_f32_16x16x32_bf16 v[92:95], v[8:11], v[152:155], v[92:95]
    s_and_b32 s34, s2, 1
    v_mfma_f32_16x16x32_bf16 v[88:91], v[12:15], v[140:143], v[88:91]
    s_load_dwordx4 s[56:59], s[0:1], 48
    v_mfma_f32_16x16x32_bf16 v[92:95], v[12:15], v[156:159], v[92:95]
    v_mfma_f32_16x16x32_bf16 v[96:99], v[0:3], v[160:163], 0
    v_mfma_f32_16x16x32_bf16 v[100:103], v[0:3], v[176:179], 0
    v_mfma_f32_16x16x32_bf16 v[96:99], v[4:7], v[164:167], v[96:99]
    v_cvt_pk_bf16_f32 v116, v88, v89
    v_mfma_f32_16x16x32_bf16 v[100:103], v[4:7], v[180:183], v[100:103]
    v_cvt_pk_bf16_f32 v117, v90, v91
    v_mfma_f32_16x16x32_bf16 v[96:99], v[8:11], v[168:171], v[96:99]
    v_mfma_f32_16x16x32_bf16 v[100:103], v[8:11], v[184:187], v[100:103]
    v_cvt_pk_bf16_f32 v118, v92, v93
    v_mfma_f32_16x16x32_bf16 v[96:99], v[12:15], v[172:175], v[96:99]
    v_cvt_pk_bf16_f32 v119, v94, v95
    v_mfma_f32_16x16x32_bf16 v[100:103], v[12:15], v[188:191], v[100:103]
    v_mfma_f32_16x16x32_bf16 v[104:107], v[0:3], v[192:195], 0
    v_mfma_f32_16x16x32_bf16 v[108:111], v[0:3], v[208:211], 0
    v_mfma_f32_16x16x32_bf16 v[104:107], v[4:7], v[196:199], v[104:107]
    v_cvt_pk_bf16_f32 v120, v96, v97
    v_mfma_f32_16x16x32_bf16 v[108:111], v[4:7], v[212:215], v[108:111]
    v_cvt_pk_bf16_f32 v121, v98, v99
    v_mfma_f32_16x16x32_bf16 v[104:107], v[8:11], v[200:203], v[104:107]
    v_mfma_f32_16x16x32_bf16 v[108:111], v[8:11], v[216:219], v[108:111]
    v_cvt_pk_bf16_f32 v122, v100, v101
    v_mfma_f32_16x16x32_bf16 v[104:107], v[12:15], v[204:207], v[104:107]
    v_cvt_pk_bf16_f32 v123, v102, v103
    v_mfma_f32_16x16x32_bf16 v[108:111], v[12:15], v[220:223], v[108:111]
    v_mfma_f32_16x16x32_bf16 v[88:91], v[0:3], v[224:227], 0
    v_mfma_f32_16x16x32_bf16 v[92:95], v[0:3], v[240:243], 0
    v_mfma_f32_16x16x32_bf16 v[88:91], v[4:7], v[228:231], v[88:91]
    v_cvt_pk_bf16_f32 v124, v104, v105
    v_mfma_f32_16x16x32_bf16 v[92:95], v[4:7], v[244:247], v[92:95]
    v_cvt_pk_bf16_f32 v125, v106, v107
    v_mfma_f32_16x16x32_bf16 v[88:91], v[8:11], v[232:235], v[88:91]
    v_mfma_f32_16x16x32_bf16 v[92:95], v[8:11], v[248:251], v[92:95]
    v_cvt_pk_bf16_f32 v126, v108, v109
    v_mfma_f32_16x16x32_bf16 v[88:91], v[12:15], v[236:239], v[88:91]
    v_cvt_pk_bf16_f32 v127, v110, v111
    v_mfma_f32_16x16x32_bf16 v[92:95], v[12:15], v[252:255], v[92:95]
    s_waitcnt vmcnt(0)
    v_mfma_f32_16x16x32_bf16 v[96:99], v[16:19], v[128:131], 0
    v_mfma_f32_16x16x32_bf16 v[100:103], v[16:19], v[144:147], 0
    v_mfma_f32_16x16x32_bf16 v[96:99], v[20:23], v[132:135], v[96:99]
    v_cvt_pk_bf16_f32 v72, v88, v89
    v_mfma_f32_16x16x32_bf16 v[100:103], v[20:23], v[148:151], v[100:103]
    v_cvt_pk_bf16_f32 v73, v90, v91
    s_waitcnt vmcnt(4)
    s_barrier
    v_mfma_f32_16x16x32_bf16 v[96:99], v[24:27], v[136:139], v[96:99]
    v_mfma_f32_16x16x32_bf16 v[100:103], v[24:27], v[152:155], v[100:103]
    v_cvt_pk_bf16_f32 v74, v92, v93
    v_mfma_f32_16x16x32_bf16 v[96:99], v[28:31], v[140:143], v[96:99]
    v_cvt_pk_bf16_f32 v75, v94, v95
    v_mfma_f32_16x16x32_bf16 v[100:103], v[28:31], v[156:159], v[100:103]
    v_mfma_f32_16x16x32_bf16 v[104:107], v[16:19], v[160:163], 0
    v_mfma_f32_16x16x32_bf16 v[108:111], v[16:19], v[176:179], 0
    v_mfma_f32_16x16x32_bf16 v[104:107], v[20:23], v[164:167], v[104:107]
    v_cvt_pk_bf16_f32 v76, v96, v97
    v_mfma_f32_16x16x32_bf16 v[108:111], v[20:23], v[180:183], v[108:111]
    v_cvt_pk_bf16_f32 v77, v98, v99
    v_mfma_f32_16x16x32_bf16 v[104:107], v[24:27], v[168:171], v[104:107]
    v_mfma_f32_16x16x32_bf16 v[108:111], v[24:27], v[184:187], v[108:111]
    v_cvt_pk_bf16_f32 v78, v100, v101
    v_mfma_f32_16x16x32_bf16 v[104:107], v[28:31], v[172:175], v[104:107]
    v_cvt_pk_bf16_f32 v79, v102, v103
    v_mfma_f32_16x16x32_bf16 v[108:111], v[28:31], v[188:191], v[108:111]
    v_mfma_f32_16x16x32_bf16 v[88:91], v[16:19], v[192:195], 0
    v_mfma_f32_16x16x32_bf16 v[92:95], v[16:19], v[208:211], 0
    v_mfma_f32_16x16x32_bf16 v[88:91], v[20:23], v[196:199], v[88:91]
    v_cvt_pk_bf16_f32 v80, v104, v105
    v_mfma_f32_16x16x32_bf16 v[92:95], v[20:23], v[212:215], v[92:95]
    v_cvt_pk_bf16_f32 v81, v106, v107
    v_mfma_f32_16x16x32_bf16 v[88:91], v[24:27], v[200:203], v[88:91]
    v_mfma_f32_16x16x32_bf16 v[92:95], v[24:27], v[216:219], v[92:95]
    v_cvt_pk_bf16_f32 v82, v108, v109
    v_mfma_f32_16x16x32_bf16 v[88:91], v[28:31], v[204:207], v[88:91]
    v_cvt_pk_bf16_f32 v83, v110, v111
    ds_write_b64 v70, v[116:117] offset:0
    v_mfma_f32_16x16x32_bf16 v[92:95], v[28:31], v[220:223], v[92:95]
    ds_read_b128 v[0:3], v114 offset:8192
    ds_read_b128 v[4:7], v114 offset:9216
    ds_read_b128 v[8:11], v114 offset:10240
    ds_read_b128 v[12:15], v114 offset:11264
    v_mfma_f32_16x16x32_bf16 v[96:99], v[16:19], v[224:227], 0
    ds_write_b64 v70, v[118:119] offset:128
    v_mfma_f32_16x16x32_bf16 v[100:103], v[16:19], v[240:243], 0
    v_mfma_f32_16x16x32_bf16 v[96:99], v[20:23], v[228:231], v[96:99]
    v_cvt_pk_bf16_f32 v88, v88, v89
    ds_write_b64 v70, v[120:121] offset:256
    v_mfma_f32_16x16x32_bf16 v[100:103], v[20:23], v[244:247], v[100:103]
    v_cvt_pk_bf16_f32 v89, v90, v91
    v_mfma_f32_16x16x32_bf16 v[96:99], v[24:27], v[232:235], v[96:99]
    ds_write_b64 v70, v[88:89] offset:33280
    ds_write_b64 v70, v[122:123] offset:384
    v_mfma_f32_16x16x32_bf16 v[100:103], v[24:27], v[248:251], v[100:103]
    v_cvt_pk_bf16_f32 v92, v92, v93
    v_mfma_f32_16x16x32_bf16 v[96:99], v[28:31], v[236:239], v[96:99]
    v_cvt_pk_bf16_f32 v93, v94, v95
    ds_write_b64 v70, v[124:125] offset:512
    v_mfma_f32_16x16x32_bf16 v[100:103], v[28:31], v[252:255], v[100:103]
    ds_write_b64 v70, v[92:93] offset:33408
    s_waitcnt lgkmcnt(6)
    v_mfma_f32_16x16x32_bf16 v[104:107], v[0:3], v[128:131], 0
    buffer_load_dwordx4 v[116:119], v69, s[12:15], s20 offen offset:0 sc1
    ds_write_b64 v70, v[126:127] offset:640
    v_mfma_f32_16x16x32_bf16 v[108:111], v[0:3], v[144:147], 0
    v_mfma_f32_16x16x32_bf16 v[104:107], v[4:7], v[132:135], v[104:107]
    v_cvt_pk_bf16_f32 v96, v96, v97
    ds_write_b64 v70, v[72:73] offset:768
    v_mfma_f32_16x16x32_bf16 v[108:111], v[4:7], v[148:151], v[108:111]
    v_cvt_pk_bf16_f32 v97, v98, v99
    v_mfma_f32_16x16x32_bf16 v[104:107], v[8:11], v[136:139], v[104:107]
    ds_write_b64 v70, v[96:97] offset:33536
    buffer_load_dwordx4 v[120:123], v69, s[12:15], s20 offen offset:1024 sc1
    v_mfma_f32_16x16x32_bf16 v[108:111], v[8:11], v[152:155], v[108:111]
    v_cvt_pk_bf16_f32 v100, v100, v101
    ds_write_b64 v70, v[74:75] offset:896
    v_mfma_f32_16x16x32_bf16 v[104:107], v[12:15], v[140:143], v[104:107]
    v_cvt_pk_bf16_f32 v101, v102, v103
    v_mov_b64 v[16:17], s[80:81]
    v_mfma_f32_16x16x32_bf16 v[108:111], v[12:15], v[156:159], v[108:111]
    ds_write_b64 v70, v[100:101] offset:33664
    v_mov_b64 v[18:19], s[82:83]
    v_mfma_f32_16x16x32_bf16 v[88:91], v[0:3], v[160:163], 0
    v_mov_b64 v[20:21], s[80:81]
    v_mov_b64 v[22:23], s[82:83]
    v_mfma_f32_16x16x32_bf16 v[92:95], v[0:3], v[176:179], 0
    v_mov_b64 v[24:25], s[80:81]
    v_mov_b64 v[26:27], s[82:83]
    v_mfma_f32_16x16x32_bf16 v[88:91], v[4:7], v[164:167], v[88:91]
    v_cvt_pk_bf16_f32 v104, v104, v105
    v_mov_b64 v[28:29], s[80:81]
    v_mfma_f32_16x16x32_bf16 v[92:95], v[4:7], v[180:183], v[92:95]
    v_cvt_pk_bf16_f32 v105, v106, v107
    v_mov_b64 v[30:31], s[82:83]
    v_mfma_f32_16x16x32_bf16 v[88:91], v[8:11], v[168:171], v[88:91]
    ds_write_b64 v71, v[104:105] offset:0
    ds_write_b64 v70, v[76:77] offset:32768
    v_mfma_f32_16x16x32_bf16 v[92:95], v[8:11], v[184:187], v[92:95]
    v_cvt_pk_bf16_f32 v108, v108, v109
    buffer_load_dwordx4 v[124:127], v69, s[12:15], s20 offen offset:2048 sc1
    v_mfma_f32_16x16x32_bf16 v[88:91], v[12:15], v[172:175], v[88:91]
    v_cvt_pk_bf16_f32 v109, v110, v111
    ds_write_b64 v70, v[78:79] offset:32896
    v_mfma_f32_16x16x32_bf16 v[92:95], v[12:15], v[188:191], v[92:95]
    ds_write_b64 v71, v[108:109] offset:128
    ds_write_b64 v70, v[80:81] offset:33024
    v_mfma_f32_16x16x32_bf16 v[96:99], v[0:3], v[192:195], 0
    buffer_load_dwordx4 v[72:75], v69, s[12:15], s21 offen offset:0 sc1
    ds_write_b64 v70, v[82:83] offset:33152
    v_mfma_f32_16x16x32_bf16 v[100:103], v[0:3], v[208:211], 0
    buffer_load_dwordx4 v[76:79], v69, s[12:15], s21 offen offset:1024 sc1
    v_mfma_f32_16x16x32_bf16 v[96:99], v[4:7], v[196:199], v[96:99]
    v_cvt_pk_bf16_f32 v88, v88, v89
    v_mfma_f32_16x16x32_bf16 v[100:103], v[4:7], v[212:215], v[100:103]
    v_cvt_pk_bf16_f32 v89, v90, v91
    v_mfma_f32_16x16x32_bf16 v[96:99], v[8:11], v[200:203], v[96:99]
    ds_write_b64 v71, v[88:89] offset:256
    buffer_load_dwordx4 v[80:83], v69, s[12:15], s19 offen offset:0 sc1
    v_mfma_f32_16x16x32_bf16 v[100:103], v[8:11], v[216:219], v[100:103]
    v_cvt_pk_bf16_f32 v92, v92, v93
    v_mfma_f32_16x16x32_bf16 v[96:99], v[12:15], v[204:207], v[96:99]
    v_cvt_pk_bf16_f32 v93, v94, v95
    v_mfma_f32_16x16x32_bf16 v[100:103], v[12:15], v[220:223], v[100:103]
    ds_write_b64 v71, v[92:93] offset:384
    v_mfma_f32_16x16x32_bf16 v[104:107], v[0:3], v[224:227], 0
    buffer_load_dwordx4 v[84:87], v69, s[12:15], s19 offen offset:1024 sc1
    s_add_u32 s21, s21, 4096
    s_add_u32 s19, s19, 4096
    v_mfma_f32_16x16x32_bf16 v[108:111], v[0:3], v[240:243], 0
    v_mfma_f32_16x16x32_bf16 v[104:107], v[4:7], v[228:231], v[104:107]
    v_cvt_pk_bf16_f32 v96, v96, v97
    v_mfma_f32_16x16x32_bf16 v[108:111], v[4:7], v[244:247], v[108:111]
    v_cvt_pk_bf16_f32 v97, v98, v99
    v_mfma_f32_16x16x32_bf16 v[104:107], v[8:11], v[232:235], v[104:107]
    ds_write_b64 v71, v[96:97] offset:512
    v_mfma_f32_16x16x32_bf16 v[108:111], v[8:11], v[248:251], v[108:111]
    v_cvt_pk_bf16_f32 v100, v100, v101
    v_mov_b64 v[0:1], s[80:81]
    v_mfma_f32_16x16x32_bf16 v[104:107], v[12:15], v[236:239], v[104:107]
    v_cvt_pk_bf16_f32 v101, v102, v103
    v_mov_b64 v[2:3], s[82:83]
    v_mfma_f32_16x16x32_bf16 v[108:111], v[12:15], v[252:255], v[108:111]
    ds_write_b64 v71, v[100:101] offset:640
    v_mov_b64 v[4:5], s[80:81]
    s_nop 1
    v_mov_b64 v[6:7], s[82:83]
    v_mov_b64 v[8:9], s[80:81]
    v_mov_b64 v[10:11], s[82:83]
    v_mov_b64 v[12:13], s[80:81]
    v_mov_b64 v[14:15], s[82:83]
    s_nop 4
    v_cvt_pk_bf16_f32 v104, v104, v105
    v_cvt_pk_bf16_f32 v105, v106, v107
    ds_write_b64 v71, v[104:105] offset:768
    v_cvt_pk_bf16_f32 v108, v108, v109
    v_cvt_pk_bf16_f32 v109, v110, v111
    ds_write_b64 v71, v[108:109] offset:896
    v_add_u32 v70, 0x18000, v70
    s_branch standalone__deep_cross_pnn__recsys_kernel_k2j
standalone__deep_cross_pnn__recsys_kernel_k2m:
    s_barrier

    s_setprio 0
    s_waitcnt vmcnt(0)

    buffer_load_dwordx4 v[136:139], v254, s[12:15], s44 offen offset:0 sc1
    ds_read_b128 v[128:131], v95 offset:0
    ds_read_b128 v[132:135], v95 offset:64
    ds_read_b128 v[144:147], v95 offset:2304
    ds_read_b128 v[148:151], v95 offset:2368
    v_fma_f32 v85, v188, v64, v240
    v_mov_b32 v84, v239
    v_mov_b32 v86, v241
    v_mov_b32 v113, v243
    v_mov_b32 v112, v94
    v_add_u32 v114, 144256, v254
    v_fmac_f32 v85, v189, v65
    v_fmac_f32 v85, v190, v66
    v_fmac_f32 v85, v191, v67
    v_fmac_f32 v85, v192, v68
    buffer_load_dwordx4 v[140:143], v254, s[12:15], s44 offen offset:1024 sc1
    ds_read_b128 v[160:163], v95 offset:4608
    ds_read_b128 v[164:167], v95 offset:4672
    ds_read_b128 v[176:179], v95 offset:6912
    ds_read_b128 v[180:183], v95 offset:6976
    v_fmac_f32 v85, v193, v69
    v_fmac_f32 v85, v194, v70
    v_fmac_f32 v85, v195, v71
    v_fmac_f32 v85, v196, v72
    v_fmac_f32 v85, v197, v73
    buffer_load_dwordx4 v[152:155], v254, s[12:15], s44 offen offset:2048 sc1
    ds_read_b128 v[208:211], v95 offset:11520
    ds_read_b128 v[212:215], v95 offset:11584
    ds_read_b128 v[224:227], v95 offset:13824
    ds_read_b128 v[228:231], v95 offset:13888
    v_fmac_f32 v85, v198, v74
    v_fmac_f32 v85, v199, v75
    v_fmac_f32 v85, v200, v76
    v_fmac_f32 v85, v201, v77
    v_fmac_f32 v85, v202, v78
    buffer_load_dwordx4 v[156:159], v254, s[12:15], s44 offen offset:3072 sc1
    s_add_u32 s44, s44, 4096
    ds_read_b128 v[240:243], v95 offset:16128
    ds_read_b128 v[244:247], v95 offset:16192
    ds_read_b128 v[192:195], v95 offset:9216
    ds_read_b128 v[196:199], v95 offset:9280
    v_fmac_f32 v85, v203, v79
    v_fmac_f32 v85, v204, v80
    v_fmac_f32 v85, v205, v81
    v_fmac_f32 v85, v206, v82
    v_fmac_f32 v85, v207, v83
    buffer_load_dwordx4 v[168:171], v254, s[12:15], s44 offen offset:0 sc1
    v_and_b32 v49, 15, v255
    v_lshrrev_b32 v50, 4, v255
    v_lshlrev_b32 v69, 4, v255
    v_lshlrev_b32 v70, 13, v50
    buffer_load_dwordx4 v[172:175], v254, s[12:15], s44 offen offset:1024 sc1
    v_lshl_add_u32 v70, v49, 3, v70
    v_add_u32 v70, s85, v70
    v_add_u32 v71, 0x10000, v70
    s_waitcnt lgkmcnt(0)
    s_barrier
    s_setprio 2
    ds_read_b128 v[0:3], v114 offset:0
    ds_read_b128 v[4:7], v114 offset:1024
    ds_read_b128 v[8:11], v114 offset:2048
    ds_read_b128 v[12:15], v114 offset:3072
    s_add_u32 s21, s77, 12288
    s_add_u32 s19, s78, 12288
    s_mov_b32 s20, s79
    s_lshr_b32 s33, s2, 1
    s_and_b32 s34, s2, 1
    v_lshrrev_b32 v52, 3, v255
    v_xor_b32 v52, v52, v50
    v_and_b32 v52, 1, v52
    v_bfe_u32 v53, v255, 2, 1
    v_lshl_or_b32 v52, v52, 1, v53
    v_mov_b32 v54, 0x3f80
    s_waitcnt lgkmcnt(0)
    v_mfma_f32_16x16x32_bf16 v[88:91], v[0:3], v[128:131], 0
    buffer_load_dwordx4 v[184:187], v69, s[12:15], s44 offen offset:2048 sc1
    v_cmp_eq_u32 vcc, 0, v52
    ds_read_b128 v[16:19], v114 offset:4096
    ds_read_b128 v[20:23], v114 offset:5120
    ds_read_b128 v[24:27], v114 offset:6144
    ds_read_b128 v[28:31], v114 offset:7168
    v_mfma_f32_16x16x32_bf16 v[92:95], v[0:3], v[144:147], 0
    v_permlane32_swap_b32 v84, v85
    v_mfma_f32_16x16x32_bf16 v[88:91], v[4:7], v[132:135], v[88:91]
    v_cmp_eq_u32 s[68:69], 1, v52
    v_mfma_f32_16x16x32_bf16 v[92:95], v[4:7], v[148:151], v[92:95]
    v_add_f32 v87, v84, v85
    buffer_load_dwordx4 v[188:191], v69, s[12:15], s44 offen offset:3072 sc1
    s_add_u32 s44, s44, 4096
    s_waitcnt vmcnt(4)
    v_mfma_f32_16x16x32_bf16 v[88:91], v[8:11], v[136:139], v[88:91]
    v_and_b32 v53, 3, v255
    v_mfma_f32_16x16x32_bf16 v[92:95], v[8:11], v[152:155], v[92:95]
    v_permlane16_swap_b32 v86, v87
    v_mfma_f32_16x16x32_bf16 v[88:91], v[12:15], v[140:143], v[88:91]
    buffer_load_dwordx4 v[200:203], v69, s[12:15], s44 offen offset:0 sc1
    v_mul_u32_u24 v68, 0x5555, v53
    ds_read_b128 v[32:35], v114 offset:8192
    ds_read_b128 v[36:39], v114 offset:9216
    ds_read_b128 v[40:43], v114 offset:10240
    ds_read_b128 v[44:47], v114 offset:11264
    v_mfma_f32_16x16x32_bf16 v[92:95], v[12:15], v[156:159], v[92:95]
    v_add_f32 v86, v86, v87
    s_waitcnt lgkmcnt(4)
    v_mfma_f32_16x16x32_bf16 v[96:99], v[16:19], v[128:131], 0
    v_cndmask_b32 v64, 0, v54, vcc
    v_mfma_f32_16x16x32_bf16 v[100:103], v[16:19], v[144:147], 0
    v_add_f32_dpp v86, v86, v86 row_ror:8 row_mask:0xf bank_mask:0xf
    buffer_load_dwordx4 v[204:207], v69, s[12:15], s44 offen offset:1024 sc1
    v_mfma_f32_16x16x32_bf16 v[96:99], v[20:23], v[132:135], v[96:99]
    v_cvt_pk_bf16_f32 v88, v88, v89
    v_cndmask_b32 v65, 0, v54, vcc
    v_mfma_f32_16x16x32_bf16 v[100:103], v[20:23], v[148:151], v[100:103]
    v_cvt_pk_bf16_f32 v89, v90, v91
    v_add_f32_dpp v86, v86, v86 row_ror:4 row_mask:0xf bank_mask:0xf
    v_mfma_f32_16x16x32_bf16 v[96:99], v[24:27], v[136:139], v[96:99]
    ds_write_b64 v70, v[88:89] offset:0
    buffer_load_dwordx4 v[216:219], v69, s[12:15], s44 offen offset:2048 sc1
    v_mfma_f32_16x16x32_bf16 v[100:103], v[24:27], v[152:155], v[100:103]
    v_cvt_pk_bf16_f32 v92, v92, v93
    v_cndmask_b32 v66, 0, v54, s[68:69]
    v_mfma_f32_16x16x32_bf16 v[96:99], v[28:31], v[140:143], v[96:99]
    v_cvt_pk_bf16_f32 v93, v94, v95
    v_add_f32_dpp v86, v86, v86 row_ror:2 row_mask:0xf bank_mask:0xf
    v_mfma_f32_16x16x32_bf16 v[100:103], v[28:31], v[156:159], v[100:103]
    ds_write_b64 v70, v[92:93] offset:128
    v_cndmask_b32 v67, 0, v54, s[68:69]
    s_waitcnt lgkmcnt(2)
    v_mfma_f32_16x16x32_bf16 v[104:107], v[32:35], v[128:131], 0
    v_add_f32_dpp v86, v86, v86 row_ror:1 row_mask:0xf bank_mask:0xf
    buffer_load_dwordx4 v[220:223], v69, s[12:15], s44 offen offset:3072 sc1
    s_add_u32 s44, s44, 4096
    v_mfma_f32_16x16x32_bf16 v[108:111], v[32:35], v[144:147], 0
    v_cndmask_b32 v113, v113, v86, s[70:71]
    v_mfma_f32_16x16x32_bf16 v[104:107], v[36:39], v[132:135], v[104:107]
    v_cvt_pk_bf16_f32 v96, v96, v97
    buffer_load_dwordx4 v[232:235], v69, s[12:15], s44 offen offset:0 sc1
    v_mfma_f32_16x16x32_bf16 v[108:111], v[36:39], v[148:151], v[108:111]
    v_cvt_pk_bf16_f32 v97, v98, v99
    v_mfma_f32_16x16x32_bf16 v[104:107], v[40:43], v[136:139], v[104:107]
    ds_write_b64 v70, v[96:97] offset:32768
    v_mfma_f32_16x16x32_bf16 v[108:111], v[40:43], v[152:155], v[108:111]
    v_cvt_pk_bf16_f32 v100, v100, v101
    buffer_load_dwordx4 v[236:239], v69, s[12:15], s44 offen offset:1024 sc1
    v_mfma_f32_16x16x32_bf16 v[104:107], v[44:47], v[140:143], v[104:107]
    v_cvt_pk_bf16_f32 v101, v102, v103
    s_mov_b64 exec, s[46:47]
    buffer_store_dword v113, v112, s[12:15], s76 offen sc1
    s_mov_b64 exec, -1
    v_mfma_f32_16x16x32_bf16 v[108:111], v[44:47], v[156:159], v[108:111]
    ds_write_b64 v70, v[100:101] offset:32896
    v_mov_b64 v[48:49], s[80:81]
    v_mfma_f32_16x16x32_bf16 v[88:91], v[0:3], v[160:163], 0
    buffer_load_dwordx4 v[248:251], v69, s[12:15], s44 offen offset:2048 sc1
    v_mov_b64 v[50:51], s[82:83]
    v_mfma_f32_16x16x32_bf16 v[92:95], v[0:3], v[176:179], 0
    v_mov_b64 v[52:53], s[80:81]
    v_mfma_f32_16x16x32_bf16 v[88:91], v[4:7], v[164:167], v[88:91]
    v_cvt_pk_bf16_f32 v104, v104, v105
    v_mov_b64 v[54:55], s[82:83]
    v_mfma_f32_16x16x32_bf16 v[92:95], v[4:7], v[180:183], v[92:95]
    v_cvt_pk_bf16_f32 v105, v106, v107
    buffer_load_dwordx4 v[252:255], v69, s[12:15], s44 offen offset:3072 sc1
    s_add_u32 s44, s44, 4096
    s_waitcnt vmcnt(9)
    v_mfma_f32_16x16x32_bf16 v[88:91], v[8:11], v[168:171], v[88:91]
    ds_write_b64 v71, v[104:105] offset:0
    v_mov_b64 v[56:57], s[80:81]
    v_mfma_f32_16x16x32_bf16 v[92:95], v[8:11], v[184:187], v[92:95]
    v_cvt_pk_bf16_f32 v108, v108, v109
    v_mov_b64 v[58:59], s[82:83]
    v_mfma_f32_16x16x32_bf16 v[88:91], v[12:15], v[172:175], v[88:91]
    v_cvt_pk_bf16_f32 v109, v110, v111
    v_mov_b64 v[60:61], s[80:81]
    v_mfma_f32_16x16x32_bf16 v[92:95], v[12:15], v[188:191], v[92:95]
    ds_write_b64 v71, v[108:109] offset:128
    buffer_load_dwordx4 v[116:119], v69, s[12:15], s20 offen offset:0 sc1
    v_mfma_f32_16x16x32_bf16 v[96:99], v[16:19], v[160:163], 0
    v_mov_b64 v[62:63], s[82:83]
    v_mfma_f32_16x16x32_bf16 v[100:103], v[16:19], v[176:179], 0
    buffer_load_dwordx4 v[120:123], v69, s[12:15], s20 offen offset:1024 sc1
    v_mfma_f32_16x16x32_bf16 v[96:99], v[20:23], v[164:167], v[96:99]
    v_cvt_pk_bf16_f32 v88, v88, v89
    v_mfma_f32_16x16x32_bf16 v[100:103], v[20:23], v[180:183], v[100:103]
    v_cvt_pk_bf16_f32 v89, v90, v91
    v_mfma_f32_16x16x32_bf16 v[96:99], v[24:27], v[168:171], v[96:99]
    ds_write_b64 v70, v[88:89] offset:256
    buffer_load_dwordx4 v[124:127], v69, s[12:15], s20 offen offset:2048 sc1
    v_mfma_f32_16x16x32_bf16 v[100:103], v[24:27], v[184:187], v[100:103]
    v_cvt_pk_bf16_f32 v92, v92, v93
    v_mfma_f32_16x16x32_bf16 v[96:99], v[28:31], v[172:175], v[96:99]
    v_cvt_pk_bf16_f32 v93, v94, v95
    v_mfma_f32_16x16x32_bf16 v[100:103], v[28:31], v[188:191], v[100:103]
    ds_write_b64 v70, v[92:93] offset:384
    buffer_load_dwordx4 v[72:75], v69, s[12:15], s21 offen offset:0 sc1
    v_mfma_f32_16x16x32_bf16 v[104:107], v[32:35], v[160:163], 0
    v_mfma_f32_16x16x32_bf16 v[108:111], v[32:35], v[176:179], 0
    s_load_dwordx4 s[56:59], s[0:1], 48
    v_mfma_f32_16x16x32_bf16 v[104:107], v[36:39], v[164:167], v[104:107]
    v_cvt_pk_bf16_f32 v96, v96, v97
    buffer_load_dwordx4 v[76:79], v69, s[12:15], s21 offen offset:1024 sc1
    v_mfma_f32_16x16x32_bf16 v[108:111], v[36:39], v[180:183], v[108:111]
    v_cvt_pk_bf16_f32 v97, v98, v99
    v_mfma_f32_16x16x32_bf16 v[104:107], v[40:43], v[168:171], v[104:107]
    ds_write_b64 v70, v[96:97] offset:33024
    v_mfma_f32_16x16x32_bf16 v[108:111], v[40:43], v[184:187], v[108:111]
    v_cvt_pk_bf16_f32 v100, v100, v101
    buffer_load_dwordx4 v[80:83], v69, s[12:15], s19 offen offset:0 sc1
    v_mfma_f32_16x16x32_bf16 v[104:107], v[44:47], v[172:175], v[104:107]
    v_cvt_pk_bf16_f32 v101, v102, v103
    v_mfma_f32_16x16x32_bf16 v[108:111], v[44:47], v[188:191], v[108:111]
    ds_write_b64 v70, v[100:101] offset:33152
    v_mfma_f32_16x16x32_bf16 v[88:91], v[0:3], v[192:195], 0
    buffer_load_dwordx4 v[84:87], v69, s[12:15], s19 offen offset:1024 sc1
    s_add_u32 s21, s21, 4096
    s_add_u32 s19, s19, 4096
    v_mfma_f32_16x16x32_bf16 v[92:95], v[0:3], v[208:211], 0
    v_mfma_f32_16x16x32_bf16 v[88:91], v[4:7], v[196:199], v[88:91]
    v_cvt_pk_bf16_f32 v104, v104, v105
    v_mfma_f32_16x16x32_bf16 v[92:95], v[4:7], v[212:215], v[92:95]
    v_cvt_pk_bf16_f32 v105, v106, v107
    s_waitcnt vmcnt(12)
    v_mfma_f32_16x16x32_bf16 v[88:91], v[8:11], v[200:203], v[88:91]
    ds_write_b64 v71, v[104:105] offset:256
    v_mfma_f32_16x16x32_bf16 v[92:95], v[8:11], v[216:219], v[92:95]
    v_cvt_pk_bf16_f32 v108, v108, v109
    v_mfma_f32_16x16x32_bf16 v[88:91], v[12:15], v[204:207], v[88:91]
    v_cvt_pk_bf16_f32 v109, v110, v111
    v_mfma_f32_16x16x32_bf16 v[92:95], v[12:15], v[220:223], v[92:95]
    ds_write_b64 v71, v[108:109] offset:384
    v_mfma_f32_16x16x32_bf16 v[96:99], v[16:19], v[192:195], 0
    v_mfma_f32_16x16x32_bf16 v[100:103], v[16:19], v[208:211], 0
    v_mfma_f32_16x16x32_bf16 v[96:99], v[20:23], v[196:199], v[96:99]
    v_cvt_pk_bf16_f32 v88, v88, v89
    v_mfma_f32_16x16x32_bf16 v[100:103], v[20:23], v[212:215], v[100:103]
    v_cvt_pk_bf16_f32 v89, v90, v91
    v_mfma_f32_16x16x32_bf16 v[96:99], v[24:27], v[200:203], v[96:99]
    ds_write_b64 v70, v[88:89] offset:512
    v_mfma_f32_16x16x32_bf16 v[100:103], v[24:27], v[216:219], v[100:103]
    v_cvt_pk_bf16_f32 v92, v92, v93
    v_mfma_f32_16x16x32_bf16 v[96:99], v[28:31], v[204:207], v[96:99]
    v_cvt_pk_bf16_f32 v93, v94, v95
    v_mfma_f32_16x16x32_bf16 v[100:103], v[28:31], v[220:223], v[100:103]
    ds_write_b64 v70, v[92:93] offset:640
    v_mfma_f32_16x16x32_bf16 v[104:107], v[32:35], v[192:195], 0
    v_mfma_f32_16x16x32_bf16 v[108:111], v[32:35], v[208:211], 0
    v_mfma_f32_16x16x32_bf16 v[104:107], v[36:39], v[196:199], v[104:107]
    v_cvt_pk_bf16_f32 v96, v96, v97
    v_mfma_f32_16x16x32_bf16 v[108:111], v[36:39], v[212:215], v[108:111]
    v_cvt_pk_bf16_f32 v97, v98, v99
    v_mfma_f32_16x16x32_bf16 v[104:107], v[40:43], v[200:203], v[104:107]
    ds_write_b64 v70, v[96:97] offset:33280
    v_mfma_f32_16x16x32_bf16 v[108:111], v[40:43], v[216:219], v[108:111]
    v_cvt_pk_bf16_f32 v100, v100, v101
    v_mfma_f32_16x16x32_bf16 v[104:107], v[44:47], v[204:207], v[104:107]
    v_cvt_pk_bf16_f32 v101, v102, v103
    v_mfma_f32_16x16x32_bf16 v[108:111], v[44:47], v[220:223], v[108:111]
    ds_write_b64 v70, v[100:101] offset:33408
    v_mfma_f32_16x16x32_bf16 v[88:91], v[0:3], v[224:227], 0
    v_mfma_f32_16x16x32_bf16 v[92:95], v[0:3], v[240:243], 0
    v_mfma_f32_16x16x32_bf16 v[88:91], v[4:7], v[228:231], v[88:91]
    v_cvt_pk_bf16_f32 v104, v104, v105
    v_mfma_f32_16x16x32_bf16 v[92:95], v[4:7], v[244:247], v[92:95]
    v_cvt_pk_bf16_f32 v105, v106, v107
    s_waitcnt vmcnt(7)
    v_mfma_f32_16x16x32_bf16 v[88:91], v[8:11], v[232:235], v[88:91]
    ds_write_b64 v71, v[104:105] offset:512
    v_mfma_f32_16x16x32_bf16 v[92:95], v[8:11], v[248:251], v[92:95]
    v_cvt_pk_bf16_f32 v108, v108, v109
    v_mov_b64 v[0:1], s[80:81]
    v_mfma_f32_16x16x32_bf16 v[88:91], v[12:15], v[236:239], v[88:91]
    v_cvt_pk_bf16_f32 v109, v110, v111
    v_mov_b64 v[2:3], s[82:83]
    v_mfma_f32_16x16x32_bf16 v[92:95], v[12:15], v[252:255], v[92:95]
    ds_write_b64 v71, v[108:109] offset:640
    v_mov_b64 v[4:5], s[80:81]
    v_mfma_f32_16x16x32_bf16 v[96:99], v[16:19], v[224:227], 0
    v_mov_b64 v[6:7], s[82:83]
    v_mfma_f32_16x16x32_bf16 v[100:103], v[16:19], v[240:243], 0
    v_mov_b64 v[8:9], s[80:81]
    v_mov_b64 v[10:11], s[82:83]
    v_mfma_f32_16x16x32_bf16 v[96:99], v[20:23], v[228:231], v[96:99]
    v_cvt_pk_bf16_f32 v88, v88, v89
    v_mfma_f32_16x16x32_bf16 v[100:103], v[20:23], v[244:247], v[100:103]
    v_cvt_pk_bf16_f32 v89, v90, v91
    v_mov_b64 v[12:13], s[80:81]
    v_mfma_f32_16x16x32_bf16 v[96:99], v[24:27], v[232:235], v[96:99]
    ds_write_b64 v70, v[88:89] offset:768
    v_mov_b64 v[14:15], s[82:83]
    v_mfma_f32_16x16x32_bf16 v[100:103], v[24:27], v[248:251], v[100:103]
    v_cvt_pk_bf16_f32 v92, v92, v93
    v_mov_b64 v[16:17], s[80:81]
    v_mfma_f32_16x16x32_bf16 v[96:99], v[28:31], v[236:239], v[96:99]
    v_cvt_pk_bf16_f32 v93, v94, v95
    v_mov_b64 v[18:19], s[82:83]
    v_mfma_f32_16x16x32_bf16 v[100:103], v[28:31], v[252:255], v[100:103]
    ds_write_b64 v70, v[92:93] offset:896
    v_mov_b64 v[20:21], s[80:81]
    v_mfma_f32_16x16x32_bf16 v[104:107], v[32:35], v[224:227], 0
    v_mov_b64 v[22:23], s[82:83]
    v_mfma_f32_16x16x32_bf16 v[108:111], v[32:35], v[240:243], 0
    v_mov_b64 v[24:25], s[80:81]
    v_mov_b64 v[26:27], s[82:83]
    v_mfma_f32_16x16x32_bf16 v[104:107], v[36:39], v[228:231], v[104:107]
    v_cvt_pk_bf16_f32 v96, v96, v97
    v_mfma_f32_16x16x32_bf16 v[108:111], v[36:39], v[244:247], v[108:111]
    v_cvt_pk_bf16_f32 v97, v98, v99
    v_mov_b64 v[28:29], s[80:81]
    v_mfma_f32_16x16x32_bf16 v[104:107], v[40:43], v[232:235], v[104:107]
    ds_write_b64 v70, v[96:97] offset:33536
    v_mov_b64 v[30:31], s[82:83]
    v_mfma_f32_16x16x32_bf16 v[108:111], v[40:43], v[248:251], v[108:111]
    v_cvt_pk_bf16_f32 v100, v100, v101
    v_mov_b64 v[32:33], s[80:81]
    v_mfma_f32_16x16x32_bf16 v[104:107], v[44:47], v[236:239], v[104:107]
    v_cvt_pk_bf16_f32 v101, v102, v103
    v_mov_b64 v[34:35], s[82:83]
    v_mfma_f32_16x16x32_bf16 v[108:111], v[44:47], v[252:255], v[108:111]
    ds_write_b64 v70, v[100:101] offset:33664
    v_mov_b64 v[36:37], s[80:81]
    s_nop 1
    v_mov_b64 v[38:39], s[82:83]
    v_mov_b64 v[40:41], s[80:81]
    v_mov_b64 v[42:43], s[82:83]
    v_mov_b64 v[44:45], s[80:81]
    v_mov_b64 v[46:47], s[82:83]
    s_nop 4
    v_cvt_pk_bf16_f32 v104, v104, v105
    v_cvt_pk_bf16_f32 v105, v106, v107
    ds_write_b64 v71, v[104:105] offset:768
    v_cvt_pk_bf16_f32 v108, v108, v109
    v_cvt_pk_bf16_f32 v109, v110, v111
    ds_write_b64 v71, v[108:109] offset:896
    v_add_u32 v70, 0x18000, v70
standalone__deep_cross_pnn__recsys_kernel_k2j:

    s_mov_b32 s22, 0
    s_mov_b32 s32, 0x8000
    s_mov_b32 s23, 3
    s_waitcnt vmcnt(0) lgkmcnt(0)
    s_barrier

    v_lshlrev_b32_sdwa v88, 3, v116 dst_sel:DWORD dst_unused:UNUSED_PAD src0_sel:DWORD src1_sel:WORD_0
    v_lshlrev_b32_sdwa v90, 3, v116 dst_sel:DWORD dst_unused:UNUSED_PAD src0_sel:DWORD src1_sel:WORD_1
    v_lshlrev_b32_sdwa v92, 3, v117 dst_sel:DWORD dst_unused:UNUSED_PAD src0_sel:DWORD src1_sel:WORD_0
    v_lshlrev_b32_sdwa v94, 3, v117 dst_sel:DWORD dst_unused:UNUSED_PAD src0_sel:DWORD src1_sel:WORD_1
    ds_read_b64 v[88:89], v88
    ds_read_b64 v[90:91], v90
    ds_read_b64 v[92:93], v92
    ds_read_b64 v[94:95], v94
    v_lshlrev_b32_sdwa v96, 3, v118 dst_sel:DWORD dst_unused:UNUSED_PAD src0_sel:DWORD src1_sel:WORD_0
    v_lshlrev_b32_sdwa v98, 3, v118 dst_sel:DWORD dst_unused:UNUSED_PAD src0_sel:DWORD src1_sel:WORD_1
    v_lshlrev_b32_sdwa v100, 3, v119 dst_sel:DWORD dst_unused:UNUSED_PAD src0_sel:DWORD src1_sel:WORD_0
    v_lshlrev_b32_sdwa v102, 3, v119 dst_sel:DWORD dst_unused:UNUSED_PAD src0_sel:DWORD src1_sel:WORD_1
    ds_read_b64 v[96:97], v96
    ds_read_b64 v[98:99], v98
    ds_read_b64 v[100:101], v100
    ds_read_b64 v[102:103], v102
    buffer_load_dwordx4 v[116:119], v69, s[12:15], s20 offen offset:3072 sc1
    s_add_u32 s20, s20, 4096
standalone__deep_cross_pnn__recsys_kernel_gloop:
    s_setprio 3
    s_waitcnt vmcnt(6)
    v_lshlrev_b32_sdwa v104, 3, v120 dst_sel:DWORD dst_unused:UNUSED_PAD src0_sel:DWORD src1_sel:WORD_0
    v_lshlrev_b32_sdwa v106, 3, v120 dst_sel:DWORD dst_unused:UNUSED_PAD src0_sel:DWORD src1_sel:WORD_1
    ds_read_b64 v[104:105], v104
    ds_read_b64 v[106:107], v106
    v_lshlrev_b32_sdwa v108, 3, v121 dst_sel:DWORD dst_unused:UNUSED_PAD src0_sel:DWORD src1_sel:WORD_0
    v_lshlrev_b32_sdwa v110, 3, v121 dst_sel:DWORD dst_unused:UNUSED_PAD src0_sel:DWORD src1_sel:WORD_1
    ds_read_b64 v[108:109], v108
    ds_read_b64 v[110:111], v110
    s_waitcnt lgkmcnt(8)
    v_smfmac_f32_16x16x64_bf16 v[0:3], v[64:67], v[88:95], v68
    s_waitcnt vmcnt(5)
    v_mfma_f32_16x16x32_bf16 v[112:115], v[72:75], v[128:131], 0
    v_lshlrev_b32_sdwa v88, 3, v122 dst_sel:DWORD dst_unused:UNUSED_PAD src0_sel:DWORD src1_sel:WORD_0
    v_lshlrev_b32_sdwa v90, 3, v122 dst_sel:DWORD dst_unused:UNUSED_PAD src0_sel:DWORD src1_sel:WORD_1
    ds_read_b64 v[88:89], v88
    ds_read_b64 v[90:91], v90
    s_waitcnt vmcnt(4)
    v_mfma_f32_16x16x32_bf16 v[112:115], v[76:79], v[132:135], v[112:115]
    v_lshlrev_b32_sdwa v92, 3, v123 dst_sel:DWORD dst_unused:UNUSED_PAD src0_sel:DWORD src1_sel:WORD_0
    v_lshlrev_b32_sdwa v94, 3, v123 dst_sel:DWORD dst_unused:UNUSED_PAD src0_sel:DWORD src1_sel:WORD_1
    ds_read_b64 v[92:93], v92
    ds_read_b64 v[94:95], v94
    buffer_load_dwordx4 v[120:123], v69, s[12:15], s20 offen offset:0 sc1
    s_waitcnt lgkmcnt(8)
    v_smfmac_f32_16x16x64_bf16 v[4:7], v[64:67], v[96:103], v68
    s_waitcnt vmcnt(4)
    v_mfma_f32_16x16x32_bf16 v[112:115], v[80:83], v[136:139], v[112:115]
    s_waitcnt vmcnt(2)
    v_lshlrev_b32_sdwa v96, 3, v124 dst_sel:DWORD dst_unused:UNUSED_PAD src0_sel:DWORD src1_sel:WORD_0
    v_lshlrev_b32_sdwa v98, 3, v124 dst_sel:DWORD dst_unused:UNUSED_PAD src0_sel:DWORD src1_sel:WORD_1
    ds_read_b64 v[96:97], v96
    ds_read_b64 v[98:99], v98
    s_waitcnt vmcnt(3)
    v_mfma_f32_16x16x32_bf16 v[112:115], v[84:87], v[140:143], v[112:115]
    v_lshlrev_b32_sdwa v100, 3, v125 dst_sel:DWORD dst_unused:UNUSED_PAD src0_sel:DWORD src1_sel:WORD_0
    v_lshlrev_b32_sdwa v102, 3, v125 dst_sel:DWORD dst_unused:UNUSED_PAD src0_sel:DWORD src1_sel:WORD_1
    ds_read_b64 v[100:101], v100
    ds_read_b64 v[102:103], v102
    s_waitcnt lgkmcnt(8)
    v_smfmac_f32_16x16x64_bf16 v[8:11], v[64:67], v[104:111], v68
    s_nop 1
    v_cvt_pk_bf16_f32 v112, v112, v113
    v_cvt_pk_bf16_f32 v113, v114, v115
    ds_write_b64 v70, v[112:113] offset:0
    v_mfma_f32_16x16x32_bf16 v[112:115], v[72:75], v[144:147], 0
    v_mfma_f32_16x16x32_bf16 v[112:115], v[76:79], v[148:151], v[112:115]
    v_lshlrev_b32_sdwa v104, 3, v126 dst_sel:DWORD dst_unused:UNUSED_PAD src0_sel:DWORD src1_sel:WORD_0
    v_lshlrev_b32_sdwa v106, 3, v126 dst_sel:DWORD dst_unused:UNUSED_PAD src0_sel:DWORD src1_sel:WORD_1
    ds_read_b64 v[104:105], v104
    ds_read_b64 v[106:107], v106
    v_mfma_f32_16x16x32_bf16 v[112:115], v[80:83], v[152:155], v[112:115]
    v_mfma_f32_16x16x32_bf16 v[112:115], v[84:87], v[156:159], v[112:115]
    v_lshlrev_b32_sdwa v108, 3, v127 dst_sel:DWORD dst_unused:UNUSED_PAD src0_sel:DWORD src1_sel:WORD_0
    v_lshlrev_b32_sdwa v110, 3, v127 dst_sel:DWORD dst_unused:UNUSED_PAD src0_sel:DWORD src1_sel:WORD_1
    ds_read_b64 v[108:109], v108
    ds_read_b64 v[110:111], v110
    buffer_load_dwordx4 v[124:127], v69, s[12:15], s20 offen offset:1024 sc1
    s_waitcnt lgkmcnt(9)
    v_smfmac_f32_16x16x64_bf16 v[12:15], v[64:67], v[88:95], v68
    s_nop 0
    v_cvt_pk_bf16_f32 v112, v112, v113
    v_cvt_pk_bf16_f32 v113, v114, v115
    ds_write_b64 v70, v[112:113] offset:128
    v_mfma_f32_16x16x32_bf16 v[112:115], v[72:75], v[160:163], 0
    s_waitcnt vmcnt(2)
    v_lshlrev_b32_sdwa v88, 3, v116 dst_sel:DWORD dst_unused:UNUSED_PAD src0_sel:DWORD src1_sel:WORD_0
    v_lshlrev_b32_sdwa v90, 3, v116 dst_sel:DWORD dst_unused:UNUSED_PAD src0_sel:DWORD src1_sel:WORD_1
    ds_read_b64 v[88:89], v88
    ds_read_b64 v[90:91], v90
    v_mfma_f32_16x16x32_bf16 v[112:115], v[76:79], v[164:167], v[112:115]
    v_lshlrev_b32_sdwa v92, 3, v117 dst_sel:DWORD dst_unused:UNUSED_PAD src0_sel:DWORD src1_sel:WORD_0
    v_lshlrev_b32_sdwa v94, 3, v117 dst_sel:DWORD dst_unused:UNUSED_PAD src0_sel:DWORD src1_sel:WORD_1
    ds_read_b64 v[92:93], v92
    ds_read_b64 v[94:95], v94
    s_waitcnt lgkmcnt(10)
    v_smfmac_f32_16x16x64_bf16 v[16:19], v[64:67], v[96:103], v68
    v_mfma_f32_16x16x32_bf16 v[112:115], v[80:83], v[168:171], v[112:115]
    v_lshlrev_b32_sdwa v96, 3, v118 dst_sel:DWORD dst_unused:UNUSED_PAD src0_sel:DWORD src1_sel:WORD_0
    v_lshlrev_b32_sdwa v98, 3, v118 dst_sel:DWORD dst_unused:UNUSED_PAD src0_sel:DWORD src1_sel:WORD_1
    ds_read_b64 v[96:97], v96
    ds_read_b64 v[98:99], v98
    v_mfma_f32_16x16x32_bf16 v[112:115], v[84:87], v[172:175], v[112:115]
    v_lshlrev_b32_sdwa v100, 3, v119 dst_sel:DWORD dst_unused:UNUSED_PAD src0_sel:DWORD src1_sel:WORD_0
    v_lshlrev_b32_sdwa v102, 3, v119 dst_sel:DWORD dst_unused:UNUSED_PAD src0_sel:DWORD src1_sel:WORD_1
    ds_read_b64 v[100:101], v100
    ds_read_b64 v[102:103], v102
    buffer_load_dwordx4 v[116:119], v69, s[12:15], s20 offen offset:2048 sc1
    s_waitcnt lgkmcnt(9)
    v_smfmac_f32_16x16x64_bf16 v[20:23], v[64:67], v[104:111], v68
    s_nop 0
    v_cvt_pk_bf16_f32 v112, v112, v113
    v_cvt_pk_bf16_f32 v113, v114, v115
    ds_write_b64 v70, v[112:113] offset:256
    v_mfma_f32_16x16x32_bf16 v[112:115], v[72:75], v[176:179], 0
    v_mfma_f32_16x16x32_bf16 v[112:115], v[76:79], v[180:183], v[112:115]
    s_waitcnt vmcnt(2)
    v_lshlrev_b32_sdwa v104, 3, v120 dst_sel:DWORD dst_unused:UNUSED_PAD src0_sel:DWORD src1_sel:WORD_0
    v_lshlrev_b32_sdwa v106, 3, v120 dst_sel:DWORD dst_unused:UNUSED_PAD src0_sel:DWORD src1_sel:WORD_1
    ds_read_b64 v[104:105], v104
    ds_read_b64 v[106:107], v106
    v_mfma_f32_16x16x32_bf16 v[112:115], v[80:83], v[184:187], v[112:115]
    v_mfma_f32_16x16x32_bf16 v[112:115], v[84:87], v[188:191], v[112:115]
    v_lshlrev_b32_sdwa v108, 3, v121 dst_sel:DWORD dst_unused:UNUSED_PAD src0_sel:DWORD src1_sel:WORD_0
    v_lshlrev_b32_sdwa v110, 3, v121 dst_sel:DWORD dst_unused:UNUSED_PAD src0_sel:DWORD src1_sel:WORD_1
    ds_read_b64 v[108:109], v108
    ds_read_b64 v[110:111], v110
    s_waitcnt lgkmcnt(9)
    v_smfmac_f32_16x16x64_bf16 v[24:27], v[64:67], v[88:95], v68
    s_nop 1
    v_cvt_pk_bf16_f32 v112, v112, v113
    v_cvt_pk_bf16_f32 v113, v114, v115
    ds_write_b64 v70, v[112:113] offset:384
    v_mfma_f32_16x16x32_bf16 v[112:115], v[72:75], v[192:195], 0
    v_lshlrev_b32_sdwa v88, 3, v122 dst_sel:DWORD dst_unused:UNUSED_PAD src0_sel:DWORD src1_sel:WORD_0
    v_lshlrev_b32_sdwa v90, 3, v122 dst_sel:DWORD dst_unused:UNUSED_PAD src0_sel:DWORD src1_sel:WORD_1
    ds_read_b64 v[88:89], v88
    ds_read_b64 v[90:91], v90
    v_mfma_f32_16x16x32_bf16 v[112:115], v[76:79], v[196:199], v[112:115]
    v_lshlrev_b32_sdwa v92, 3, v123 dst_sel:DWORD dst_unused:UNUSED_PAD src0_sel:DWORD src1_sel:WORD_0
    v_lshlrev_b32_sdwa v94, 3, v123 dst_sel:DWORD dst_unused:UNUSED_PAD src0_sel:DWORD src1_sel:WORD_1
    ds_read_b64 v[92:93], v92
    ds_read_b64 v[94:95], v94
    buffer_load_dwordx4 v[120:123], v69, s[12:15], s20 offen offset:3072 sc1
    s_add_u32 s20, s20, 61440
    s_waitcnt lgkmcnt(10)
    v_smfmac_f32_16x16x64_bf16 v[28:31], v[64:67], v[96:103], v68
    s_setprio 2
    v_mfma_f32_16x16x32_bf16 v[112:115], v[80:83], v[200:203], v[112:115]
    s_waitcnt vmcnt(2)
    v_lshlrev_b32_sdwa v96, 3, v124 dst_sel:DWORD dst_unused:UNUSED_PAD src0_sel:DWORD src1_sel:WORD_0
    v_lshlrev_b32_sdwa v98, 3, v124 dst_sel:DWORD dst_unused:UNUSED_PAD src0_sel:DWORD src1_sel:WORD_1
    ds_read_b64 v[96:97], v96
    ds_read_b64 v[98:99], v98
    v_mfma_f32_16x16x32_bf16 v[112:115], v[84:87], v[204:207], v[112:115]
    v_lshlrev_b32_sdwa v100, 3, v125 dst_sel:DWORD dst_unused:UNUSED_PAD src0_sel:DWORD src1_sel:WORD_0
    v_lshlrev_b32_sdwa v102, 3, v125 dst_sel:DWORD dst_unused:UNUSED_PAD src0_sel:DWORD src1_sel:WORD_1
    ds_read_b64 v[100:101], v100
    ds_read_b64 v[102:103], v102
    s_waitcnt lgkmcnt(9)
    v_smfmac_f32_16x16x64_bf16 v[32:35], v[64:67], v[104:111], v68
    s_nop 1
    v_cvt_pk_bf16_f32 v112, v112, v113
    v_cvt_pk_bf16_f32 v113, v114, v115
    ds_write_b64 v70, v[112:113] offset:512
    v_mfma_f32_16x16x32_bf16 v[112:115], v[72:75], v[208:211], 0
    v_lshlrev_b32_sdwa v104, 3, v126 dst_sel:DWORD dst_unused:UNUSED_PAD src0_sel:DWORD src1_sel:WORD_0
    v_lshlrev_b32_sdwa v106, 3, v126 dst_sel:DWORD dst_unused:UNUSED_PAD src0_sel:DWORD src1_sel:WORD_1
    ds_read_b64 v[104:105], v104
    ds_read_b64 v[106:107], v106
    v_mfma_f32_16x16x32_bf16 v[112:115], v[76:79], v[212:215], v[112:115]
    v_lshlrev_b32_sdwa v108, 3, v127 dst_sel:DWORD dst_unused:UNUSED_PAD src0_sel:DWORD src1_sel:WORD_0
    v_lshlrev_b32_sdwa v110, 3, v127 dst_sel:DWORD dst_unused:UNUSED_PAD src0_sel:DWORD src1_sel:WORD_1
    ds_read_b64 v[108:109], v108
    ds_read_b64 v[110:111], v110
    buffer_load_dwordx4 v[124:127], v69, s[12:15], s20 offen offset:0 sc1
    s_waitcnt lgkmcnt(9)
    v_smfmac_f32_16x16x64_bf16 v[36:39], v[64:67], v[88:95], v68
    v_mfma_f32_16x16x32_bf16 v[112:115], v[80:83], v[216:219], v[112:115]
    s_waitcnt vmcnt(2)
    v_lshlrev_b32_sdwa v88, 3, v116 dst_sel:DWORD dst_unused:UNUSED_PAD src0_sel:DWORD src1_sel:WORD_0
    v_lshlrev_b32_sdwa v90, 3, v116 dst_sel:DWORD dst_unused:UNUSED_PAD src0_sel:DWORD src1_sel:WORD_1
    ds_read_b64 v[88:89], v88
    ds_read_b64 v[90:91], v90
    v_mfma_f32_16x16x32_bf16 v[112:115], v[84:87], v[220:223], v[112:115]
    v_lshlrev_b32_sdwa v92, 3, v117 dst_sel:DWORD dst_unused:UNUSED_PAD src0_sel:DWORD src1_sel:WORD_0
    v_lshlrev_b32_sdwa v94, 3, v117 dst_sel:DWORD dst_unused:UNUSED_PAD src0_sel:DWORD src1_sel:WORD_1
    ds_read_b64 v[92:93], v92
    ds_read_b64 v[94:95], v94
    s_waitcnt lgkmcnt(9)
    v_smfmac_f32_16x16x64_bf16 v[40:43], v[64:67], v[96:103], v68
    s_nop 1
    v_cvt_pk_bf16_f32 v112, v112, v113
    v_cvt_pk_bf16_f32 v113, v114, v115
    ds_write_b64 v70, v[112:113] offset:640
    v_mfma_f32_16x16x32_bf16 v[112:115], v[72:75], v[224:227], 0
    v_mfma_f32_16x16x32_bf16 v[112:115], v[76:79], v[228:231], v[112:115]
    v_lshlrev_b32_sdwa v96, 3, v118 dst_sel:DWORD dst_unused:UNUSED_PAD src0_sel:DWORD src1_sel:WORD_0
    v_lshlrev_b32_sdwa v98, 3, v118 dst_sel:DWORD dst_unused:UNUSED_PAD src0_sel:DWORD src1_sel:WORD_1
    ds_read_b64 v[96:97], v96
    ds_read_b64 v[98:99], v98
    v_mfma_f32_16x16x32_bf16 v[112:115], v[80:83], v[232:235], v[112:115]
    v_mfma_f32_16x16x32_bf16 v[112:115], v[84:87], v[236:239], v[112:115]
    v_lshlrev_b32_sdwa v100, 3, v119 dst_sel:DWORD dst_unused:UNUSED_PAD src0_sel:DWORD src1_sel:WORD_0
    v_lshlrev_b32_sdwa v102, 3, v119 dst_sel:DWORD dst_unused:UNUSED_PAD src0_sel:DWORD src1_sel:WORD_1
    ds_read_b64 v[100:101], v100
    ds_read_b64 v[102:103], v102
    buffer_load_dwordx4 v[116:119], v69, s[12:15], s20 offen offset:1024 sc1
    s_waitcnt lgkmcnt(9)
    v_smfmac_f32_16x16x64_bf16 v[44:47], v[64:67], v[104:111], v68
    s_nop 0
    v_cvt_pk_bf16_f32 v112, v112, v113
    v_cvt_pk_bf16_f32 v113, v114, v115
    ds_write_b64 v70, v[112:113] offset:768
    s_setprio 1
    v_mfma_f32_16x16x32_bf16 v[112:115], v[72:75], v[240:243], 0
    buffer_load_dwordx4 v[72:75], v69, s[12:15], s21 offen offset:0 sc1
    s_waitcnt vmcnt(3)
    v_lshlrev_b32_sdwa v104, 3, v120 dst_sel:DWORD dst_unused:UNUSED_PAD src0_sel:DWORD src1_sel:WORD_0
    v_lshlrev_b32_sdwa v106, 3, v120 dst_sel:DWORD dst_unused:UNUSED_PAD src0_sel:DWORD src1_sel:WORD_1
    ds_read_b64 v[104:105], v104
    ds_read_b64 v[106:107], v106
    v_mfma_f32_16x16x32_bf16 v[112:115], v[76:79], v[244:247], v[112:115]
    buffer_load_dwordx4 v[76:79], v69, s[12:15], s21 offen offset:1024 sc1
    v_lshlrev_b32_sdwa v108, 3, v121 dst_sel:DWORD dst_unused:UNUSED_PAD src0_sel:DWORD src1_sel:WORD_0
    v_lshlrev_b32_sdwa v110, 3, v121 dst_sel:DWORD dst_unused:UNUSED_PAD src0_sel:DWORD src1_sel:WORD_1
    ds_read_b64 v[108:109], v108
    ds_read_b64 v[110:111], v110
    s_waitcnt lgkmcnt(10)
    v_smfmac_f32_16x16x64_bf16 v[48:51], v[64:67], v[88:95], v68
    v_mfma_f32_16x16x32_bf16 v[112:115], v[80:83], v[248:251], v[112:115]
    buffer_load_dwordx4 v[80:83], v69, s[12:15], s19 offen offset:0 sc1
    v_lshlrev_b32_sdwa v88, 3, v122 dst_sel:DWORD dst_unused:UNUSED_PAD src0_sel:DWORD src1_sel:WORD_0
    v_lshlrev_b32_sdwa v90, 3, v122 dst_sel:DWORD dst_unused:UNUSED_PAD src0_sel:DWORD src1_sel:WORD_1
    ds_read_b64 v[88:89], v88
    ds_read_b64 v[90:91], v90
    v_mfma_f32_16x16x32_bf16 v[112:115], v[84:87], v[252:255], v[112:115]
    buffer_load_dwordx4 v[84:87], v69, s[12:15], s19 offen offset:1024 sc1
    s_add_u32 s21, s21, 4096
    s_add_u32 s19, s19, 4096
    v_lshlrev_b32_sdwa v92, 3, v123 dst_sel:DWORD dst_unused:UNUSED_PAD src0_sel:DWORD src1_sel:WORD_0
    v_lshlrev_b32_sdwa v94, 3, v123 dst_sel:DWORD dst_unused:UNUSED_PAD src0_sel:DWORD src1_sel:WORD_1
    ds_read_b64 v[92:93], v92
    ds_read_b64 v[94:95], v94
    buffer_load_dwordx4 v[120:123], v69, s[12:15], s20 offen offset:2048 sc1
    s_waitcnt lgkmcnt(9)
    v_smfmac_f32_16x16x64_bf16 v[52:55], v[64:67], v[96:103], v68
    v_cvt_pk_bf16_f32 v112, v112, v113
    v_cvt_pk_bf16_f32 v113, v114, v115
    ds_write_b64 v70, v[112:113] offset:896
    s_add_u32 s23, s23, 1
    s_cmp_eq_u32 s23, 5
    s_cselect_b32 s35, 4294836224, s32
    s_cselect_b32 s23, 0, s23
    v_add_u32 v70, s35, v70
    s_waitcnt vmcnt(6)
    v_lshlrev_b32_sdwa v96, 3, v124 dst_sel:DWORD dst_unused:UNUSED_PAD src0_sel:DWORD src1_sel:WORD_0
    v_lshlrev_b32_sdwa v98, 3, v124 dst_sel:DWORD dst_unused:UNUSED_PAD src0_sel:DWORD src1_sel:WORD_1
    ds_read_b64 v[96:97], v96
    ds_read_b64 v[98:99], v98
    v_lshlrev_b32_sdwa v100, 3, v125 dst_sel:DWORD dst_unused:UNUSED_PAD src0_sel:DWORD src1_sel:WORD_0
    v_lshlrev_b32_sdwa v102, 3, v125 dst_sel:DWORD dst_unused:UNUSED_PAD src0_sel:DWORD src1_sel:WORD_1
    ds_read_b64 v[100:101], v100
    ds_read_b64 v[102:103], v102
    s_waitcnt lgkmcnt(9)
    v_smfmac_f32_16x16x64_bf16 v[56:59], v[64:67], v[104:111], v68
    s_setprio 0
    v_lshlrev_b32_sdwa v104, 3, v126 dst_sel:DWORD dst_unused:UNUSED_PAD src0_sel:DWORD src1_sel:WORD_0
    v_lshlrev_b32_sdwa v106, 3, v126 dst_sel:DWORD dst_unused:UNUSED_PAD src0_sel:DWORD src1_sel:WORD_1
    ds_read_b64 v[104:105], v104
    ds_read_b64 v[106:107], v106
    v_lshlrev_b32_sdwa v108, 3, v127 dst_sel:DWORD dst_unused:UNUSED_PAD src0_sel:DWORD src1_sel:WORD_0
    v_lshlrev_b32_sdwa v110, 3, v127 dst_sel:DWORD dst_unused:UNUSED_PAD src0_sel:DWORD src1_sel:WORD_1
    ds_read_b64 v[108:109], v108
    ds_read_b64 v[110:111], v110
    buffer_load_dwordx4 v[124:127], v69, s[12:15], s20 offen offset:3072 sc1
    s_add_u32 s20, s20, 4096
    s_waitcnt lgkmcnt(9)
    v_smfmac_f32_16x16x64_bf16 v[60:63], v[64:67], v[88:95], v68
    s_waitcnt lgkmcnt(8)
    s_barrier

    s_cmp_eq_u32 s22, 7
    s_cbranch_scc1 standalone__deep_cross_pnn__recsys_kernel_fin

    s_setprio 3
    s_waitcnt vmcnt(6)
    v_lshlrev_b32_sdwa v88, 3, v116 dst_sel:DWORD dst_unused:UNUSED_PAD src0_sel:DWORD src1_sel:WORD_0
    v_lshlrev_b32_sdwa v90, 3, v116 dst_sel:DWORD dst_unused:UNUSED_PAD src0_sel:DWORD src1_sel:WORD_1
    ds_read_b64 v[88:89], v88
    ds_read_b64 v[90:91], v90
    v_lshlrev_b32_sdwa v92, 3, v117 dst_sel:DWORD dst_unused:UNUSED_PAD src0_sel:DWORD src1_sel:WORD_0
    v_lshlrev_b32_sdwa v94, 3, v117 dst_sel:DWORD dst_unused:UNUSED_PAD src0_sel:DWORD src1_sel:WORD_1
    ds_read_b64 v[92:93], v92
    ds_read_b64 v[94:95], v94
    s_waitcnt lgkmcnt(8)
    v_smfmac_f32_16x16x64_bf16 v[0:3], v[64:67], v[96:103], v68
    s_waitcnt vmcnt(5)
    v_mfma_f32_16x16x32_bf16 v[112:115], v[72:75], v[128:131], 0
    v_lshlrev_b32_sdwa v96, 3, v118 dst_sel:DWORD dst_unused:UNUSED_PAD src0_sel:DWORD src1_sel:WORD_0
    v_lshlrev_b32_sdwa v98, 3, v118 dst_sel:DWORD dst_unused:UNUSED_PAD src0_sel:DWORD src1_sel:WORD_1
    ds_read_b64 v[96:97], v96
    ds_read_b64 v[98:99], v98
    s_waitcnt vmcnt(4)
    v_mfma_f32_16x16x32_bf16 v[112:115], v[76:79], v[132:135], v[112:115]
    v_lshlrev_b32_sdwa v100, 3, v119 dst_sel:DWORD dst_unused:UNUSED_PAD src0_sel:DWORD src1_sel:WORD_0
    v_lshlrev_b32_sdwa v102, 3, v119 dst_sel:DWORD dst_unused:UNUSED_PAD src0_sel:DWORD src1_sel:WORD_1
    ds_read_b64 v[100:101], v100
    ds_read_b64 v[102:103], v102
    buffer_load_dwordx4 v[116:119], v69, s[12:15], s20 offen offset:0 sc1
    s_waitcnt lgkmcnt(8)
    v_smfmac_f32_16x16x64_bf16 v[4:7], v[64:67], v[104:111], v68
    s_waitcnt vmcnt(4)
    v_mfma_f32_16x16x32_bf16 v[112:115], v[80:83], v[136:139], v[112:115]
    s_waitcnt vmcnt(2)
    v_lshlrev_b32_sdwa v104, 3, v120 dst_sel:DWORD dst_unused:UNUSED_PAD src0_sel:DWORD src1_sel:WORD_0
    v_lshlrev_b32_sdwa v106, 3, v120 dst_sel:DWORD dst_unused:UNUSED_PAD src0_sel:DWORD src1_sel:WORD_1
    ds_read_b64 v[104:105], v104
    ds_read_b64 v[106:107], v106
    s_waitcnt vmcnt(3)
    v_mfma_f32_16x16x32_bf16 v[112:115], v[84:87], v[140:143], v[112:115]
    v_lshlrev_b32_sdwa v108, 3, v121 dst_sel:DWORD dst_unused:UNUSED_PAD src0_sel:DWORD src1_sel:WORD_0
    v_lshlrev_b32_sdwa v110, 3, v121 dst_sel:DWORD dst_unused:UNUSED_PAD src0_sel:DWORD src1_sel:WORD_1
    ds_read_b64 v[108:109], v108
    ds_read_b64 v[110:111], v110
    s_waitcnt lgkmcnt(8)
    v_smfmac_f32_16x16x64_bf16 v[8:11], v[64:67], v[88:95], v68
    s_nop 1
    v_cvt_pk_bf16_f32 v112, v112, v113
    v_cvt_pk_bf16_f32 v113, v114, v115
    ds_write_b64 v70, v[112:113] offset:0
    v_mfma_f32_16x16x32_bf16 v[112:115], v[72:75], v[144:147], 0
    v_mfma_f32_16x16x32_bf16 v[112:115], v[76:79], v[148:151], v[112:115]
    v_lshlrev_b32_sdwa v88, 3, v122 dst_sel:DWORD dst_unused:UNUSED_PAD src0_sel:DWORD src1_sel:WORD_0
    v_lshlrev_b32_sdwa v90, 3, v122 dst_sel:DWORD dst_unused:UNUSED_PAD src0_sel:DWORD src1_sel:WORD_1
    ds_read_b64 v[88:89], v88
    ds_read_b64 v[90:91], v90
    v_mfma_f32_16x16x32_bf16 v[112:115], v[80:83], v[152:155], v[112:115]
    v_mfma_f32_16x16x32_bf16 v[112:115], v[84:87], v[156:159], v[112:115]
    v_lshlrev_b32_sdwa v92, 3, v123 dst_sel:DWORD dst_unused:UNUSED_PAD src0_sel:DWORD src1_sel:WORD_0
    v_lshlrev_b32_sdwa v94, 3, v123 dst_sel:DWORD dst_unused:UNUSED_PAD src0_sel:DWORD src1_sel:WORD_1
    ds_read_b64 v[92:93], v92
    ds_read_b64 v[94:95], v94
    buffer_load_dwordx4 v[120:123], v69, s[12:15], s20 offen offset:1024 sc1
    s_waitcnt lgkmcnt(9)
    v_smfmac_f32_16x16x64_bf16 v[12:15], v[64:67], v[96:103], v68
    s_nop 0
    v_cvt_pk_bf16_f32 v112, v112, v113
    v_cvt_pk_bf16_f32 v113, v114, v115
    ds_write_b64 v70, v[112:113] offset:128
    v_mfma_f32_16x16x32_bf16 v[112:115], v[72:75], v[160:163], 0
    s_waitcnt vmcnt(2)
    v_lshlrev_b32_sdwa v96, 3, v124 dst_sel:DWORD dst_unused:UNUSED_PAD src0_sel:DWORD src1_sel:WORD_0
    v_lshlrev_b32_sdwa v98, 3, v124 dst_sel:DWORD dst_unused:UNUSED_PAD src0_sel:DWORD src1_sel:WORD_1
    ds_read_b64 v[96:97], v96
    ds_read_b64 v[98:99], v98
    v_mfma_f32_16x16x32_bf16 v[112:115], v[76:79], v[164:167], v[112:115]
    v_lshlrev_b32_sdwa v100, 3, v125 dst_sel:DWORD dst_unused:UNUSED_PAD src0_sel:DWORD src1_sel:WORD_0
    v_lshlrev_b32_sdwa v102, 3, v125 dst_sel:DWORD dst_unused:UNUSED_PAD src0_sel:DWORD src1_sel:WORD_1
    ds_read_b64 v[100:101], v100
    ds_read_b64 v[102:103], v102
    s_waitcnt lgkmcnt(10)
    v_smfmac_f32_16x16x64_bf16 v[16:19], v[64:67], v[104:111], v68
    v_mfma_f32_16x16x32_bf16 v[112:115], v[80:83], v[168:171], v[112:115]
    v_lshlrev_b32_sdwa v104, 3, v126 dst_sel:DWORD dst_unused:UNUSED_PAD src0_sel:DWORD src1_sel:WORD_0
    v_lshlrev_b32_sdwa v106, 3, v126 dst_sel:DWORD dst_unused:UNUSED_PAD src0_sel:DWORD src1_sel:WORD_1
    ds_read_b64 v[104:105], v104
    ds_read_b64 v[106:107], v106
    v_mfma_f32_16x16x32_bf16 v[112:115], v[84:87], v[172:175], v[112:115]
    v_lshlrev_b32_sdwa v108, 3, v127 dst_sel:DWORD dst_unused:UNUSED_PAD src0_sel:DWORD src1_sel:WORD_0
    v_lshlrev_b32_sdwa v110, 3, v127 dst_sel:DWORD dst_unused:UNUSED_PAD src0_sel:DWORD src1_sel:WORD_1
    ds_read_b64 v[108:109], v108
    ds_read_b64 v[110:111], v110
    buffer_load_dwordx4 v[124:127], v69, s[12:15], s20 offen offset:2048 sc1
    s_waitcnt lgkmcnt(9)
    v_smfmac_f32_16x16x64_bf16 v[20:23], v[64:67], v[88:95], v68
    s_nop 0
    v_cvt_pk_bf16_f32 v112, v112, v113
    v_cvt_pk_bf16_f32 v113, v114, v115
    ds_write_b64 v70, v[112:113] offset:256
    v_mfma_f32_16x16x32_bf16 v[112:115], v[72:75], v[176:179], 0
    v_mfma_f32_16x16x32_bf16 v[112:115], v[76:79], v[180:183], v[112:115]
    s_waitcnt vmcnt(2)
    v_lshlrev_b32_sdwa v88, 3, v116 dst_sel:DWORD dst_unused:UNUSED_PAD src0_sel:DWORD src1_sel:WORD_0
    v_lshlrev_b32_sdwa v90, 3, v116 dst_sel:DWORD dst_unused:UNUSED_PAD src0_sel:DWORD src1_sel:WORD_1
    ds_read_b64 v[88:89], v88
    ds_read_b64 v[90:91], v90
    v_mfma_f32_16x16x32_bf16 v[112:115], v[80:83], v[184:187], v[112:115]
    v_mfma_f32_16x16x32_bf16 v[112:115], v[84:87], v[188:191], v[112:115]
    v_lshlrev_b32_sdwa v92, 3, v117 dst_sel:DWORD dst_unused:UNUSED_PAD src0_sel:DWORD src1_sel:WORD_0
    v_lshlrev_b32_sdwa v94, 3, v117 dst_sel:DWORD dst_unused:UNUSED_PAD src0_sel:DWORD src1_sel:WORD_1
    ds_read_b64 v[92:93], v92
    ds_read_b64 v[94:95], v94
    s_waitcnt lgkmcnt(9)
    v_smfmac_f32_16x16x64_bf16 v[24:27], v[64:67], v[96:103], v68
    s_nop 1
    v_cvt_pk_bf16_f32 v112, v112, v113
    v_cvt_pk_bf16_f32 v113, v114, v115
    ds_write_b64 v70, v[112:113] offset:384
    v_mfma_f32_16x16x32_bf16 v[112:115], v[72:75], v[192:195], 0
    v_lshlrev_b32_sdwa v96, 3, v118 dst_sel:DWORD dst_unused:UNUSED_PAD src0_sel:DWORD src1_sel:WORD_0
    v_lshlrev_b32_sdwa v98, 3, v118 dst_sel:DWORD dst_unused:UNUSED_PAD src0_sel:DWORD src1_sel:WORD_1
    ds_read_b64 v[96:97], v96
    ds_read_b64 v[98:99], v98
    v_mfma_f32_16x16x32_bf16 v[112:115], v[76:79], v[196:199], v[112:115]
    v_lshlrev_b32_sdwa v100, 3, v119 dst_sel:DWORD dst_unused:UNUSED_PAD src0_sel:DWORD src1_sel:WORD_0
    v_lshlrev_b32_sdwa v102, 3, v119 dst_sel:DWORD dst_unused:UNUSED_PAD src0_sel:DWORD src1_sel:WORD_1
    ds_read_b64 v[100:101], v100
    ds_read_b64 v[102:103], v102
    buffer_load_dwordx4 v[116:119], v69, s[12:15], s20 offen offset:3072 sc1
    s_add_u32 s20, s20, 61440
    s_waitcnt lgkmcnt(10)
    v_smfmac_f32_16x16x64_bf16 v[28:31], v[64:67], v[104:111], v68
    s_setprio 2
    v_mfma_f32_16x16x32_bf16 v[112:115], v[80:83], v[200:203], v[112:115]
    s_waitcnt vmcnt(2)
    v_lshlrev_b32_sdwa v104, 3, v120 dst_sel:DWORD dst_unused:UNUSED_PAD src0_sel:DWORD src1_sel:WORD_0
    v_lshlrev_b32_sdwa v106, 3, v120 dst_sel:DWORD dst_unused:UNUSED_PAD src0_sel:DWORD src1_sel:WORD_1
    ds_read_b64 v[104:105], v104
    ds_read_b64 v[106:107], v106
    v_mfma_f32_16x16x32_bf16 v[112:115], v[84:87], v[204:207], v[112:115]
    v_lshlrev_b32_sdwa v108, 3, v121 dst_sel:DWORD dst_unused:UNUSED_PAD src0_sel:DWORD src1_sel:WORD_0
    v_lshlrev_b32_sdwa v110, 3, v121 dst_sel:DWORD dst_unused:UNUSED_PAD src0_sel:DWORD src1_sel:WORD_1
    ds_read_b64 v[108:109], v108
    ds_read_b64 v[110:111], v110
    s_waitcnt lgkmcnt(9)
    v_smfmac_f32_16x16x64_bf16 v[32:35], v[64:67], v[88:95], v68
    s_nop 1
    v_cvt_pk_bf16_f32 v112, v112, v113
    v_cvt_pk_bf16_f32 v113, v114, v115
    ds_write_b64 v70, v[112:113] offset:512
    v_mfma_f32_16x16x32_bf16 v[112:115], v[72:75], v[208:211], 0
    v_lshlrev_b32_sdwa v88, 3, v122 dst_sel:DWORD dst_unused:UNUSED_PAD src0_sel:DWORD src1_sel:WORD_0
    v_lshlrev_b32_sdwa v90, 3, v122 dst_sel:DWORD dst_unused:UNUSED_PAD src0_sel:DWORD src1_sel:WORD_1
    ds_read_b64 v[88:89], v88
    ds_read_b64 v[90:91], v90
    v_mfma_f32_16x16x32_bf16 v[112:115], v[76:79], v[212:215], v[112:115]
    v_lshlrev_b32_sdwa v92, 3, v123 dst_sel:DWORD dst_unused:UNUSED_PAD src0_sel:DWORD src1_sel:WORD_0
    v_lshlrev_b32_sdwa v94, 3, v123 dst_sel:DWORD dst_unused:UNUSED_PAD src0_sel:DWORD src1_sel:WORD_1
    ds_read_b64 v[92:93], v92
    ds_read_b64 v[94:95], v94
    buffer_load_dwordx4 v[120:123], v69, s[12:15], s20 offen offset:0 sc1
    s_waitcnt lgkmcnt(9)
    v_smfmac_f32_16x16x64_bf16 v[36:39], v[64:67], v[96:103], v68
    v_mfma_f32_16x16x32_bf16 v[112:115], v[80:83], v[216:219], v[112:115]
    s_waitcnt vmcnt(2)
    v_lshlrev_b32_sdwa v96, 3, v124 dst_sel:DWORD dst_unused:UNUSED_PAD src0_sel:DWORD src1_sel:WORD_0
    v_lshlrev_b32_sdwa v98, 3, v124 dst_sel:DWORD dst_unused:UNUSED_PAD src0_sel:DWORD src1_sel:WORD_1
    ds_read_b64 v[96:97], v96
    ds_read_b64 v[98:99], v98
    v_mfma_f32_16x16x32_bf16 v[112:115], v[84:87], v[220:223], v[112:115]
    v_lshlrev_b32_sdwa v100, 3, v125 dst_sel:DWORD dst_unused:UNUSED_PAD src0_sel:DWORD src1_sel:WORD_0
    v_lshlrev_b32_sdwa v102, 3, v125 dst_sel:DWORD dst_unused:UNUSED_PAD src0_sel:DWORD src1_sel:WORD_1
    ds_read_b64 v[100:101], v100
    ds_read_b64 v[102:103], v102
    s_waitcnt lgkmcnt(9)
    v_smfmac_f32_16x16x64_bf16 v[40:43], v[64:67], v[104:111], v68
    s_nop 1
    v_cvt_pk_bf16_f32 v112, v112, v113
    v_cvt_pk_bf16_f32 v113, v114, v115
    ds_write_b64 v70, v[112:113] offset:640
    v_mfma_f32_16x16x32_bf16 v[112:115], v[72:75], v[224:227], 0
    v_mfma_f32_16x16x32_bf16 v[112:115], v[76:79], v[228:231], v[112:115]
    v_lshlrev_b32_sdwa v104, 3, v126 dst_sel:DWORD dst_unused:UNUSED_PAD src0_sel:DWORD src1_sel:WORD_0
    v_lshlrev_b32_sdwa v106, 3, v126 dst_sel:DWORD dst_unused:UNUSED_PAD src0_sel:DWORD src1_sel:WORD_1
    ds_read_b64 v[104:105], v104
    ds_read_b64 v[106:107], v106
    v_mfma_f32_16x16x32_bf16 v[112:115], v[80:83], v[232:235], v[112:115]
    v_mfma_f32_16x16x32_bf16 v[112:115], v[84:87], v[236:239], v[112:115]
    v_lshlrev_b32_sdwa v108, 3, v127 dst_sel:DWORD dst_unused:UNUSED_PAD src0_sel:DWORD src1_sel:WORD_0
    v_lshlrev_b32_sdwa v110, 3, v127 dst_sel:DWORD dst_unused:UNUSED_PAD src0_sel:DWORD src1_sel:WORD_1
    ds_read_b64 v[108:109], v108
    ds_read_b64 v[110:111], v110
    buffer_load_dwordx4 v[124:127], v69, s[12:15], s20 offen offset:1024 sc1
    s_waitcnt lgkmcnt(9)
    v_smfmac_f32_16x16x64_bf16 v[44:47], v[64:67], v[88:95], v68
    s_nop 0
    v_cvt_pk_bf16_f32 v112, v112, v113
    v_cvt_pk_bf16_f32 v113, v114, v115
    ds_write_b64 v70, v[112:113] offset:768
    s_setprio 1
    v_mfma_f32_16x16x32_bf16 v[112:115], v[72:75], v[240:243], 0
    buffer_load_dwordx4 v[72:75], v69, s[12:15], s21 offen offset:0 sc1
    s_waitcnt vmcnt(3)
    v_lshlrev_b32_sdwa v88, 3, v116 dst_sel:DWORD dst_unused:UNUSED_PAD src0_sel:DWORD src1_sel:WORD_0
    v_lshlrev_b32_sdwa v90, 3, v116 dst_sel:DWORD dst_unused:UNUSED_PAD src0_sel:DWORD src1_sel:WORD_1
    ds_read_b64 v[88:89], v88
    ds_read_b64 v[90:91], v90
    v_mfma_f32_16x16x32_bf16 v[112:115], v[76:79], v[244:247], v[112:115]
    buffer_load_dwordx4 v[76:79], v69, s[12:15], s21 offen offset:1024 sc1
    v_lshlrev_b32_sdwa v92, 3, v117 dst_sel:DWORD dst_unused:UNUSED_PAD src0_sel:DWORD src1_sel:WORD_0
    v_lshlrev_b32_sdwa v94, 3, v117 dst_sel:DWORD dst_unused:UNUSED_PAD src0_sel:DWORD src1_sel:WORD_1
    ds_read_b64 v[92:93], v92
    ds_read_b64 v[94:95], v94
    s_waitcnt lgkmcnt(10)
    v_smfmac_f32_16x16x64_bf16 v[48:51], v[64:67], v[96:103], v68
    v_mfma_f32_16x16x32_bf16 v[112:115], v[80:83], v[248:251], v[112:115]
    buffer_load_dwordx4 v[80:83], v69, s[12:15], s19 offen offset:0 sc1
    v_lshlrev_b32_sdwa v96, 3, v118 dst_sel:DWORD dst_unused:UNUSED_PAD src0_sel:DWORD src1_sel:WORD_0
    v_lshlrev_b32_sdwa v98, 3, v118 dst_sel:DWORD dst_unused:UNUSED_PAD src0_sel:DWORD src1_sel:WORD_1
    ds_read_b64 v[96:97], v96
    ds_read_b64 v[98:99], v98
    v_mfma_f32_16x16x32_bf16 v[112:115], v[84:87], v[252:255], v[112:115]
    buffer_load_dwordx4 v[84:87], v69, s[12:15], s19 offen offset:1024 sc1
    s_add_u32 s21, s21, 4096
    s_add_u32 s19, s19, 4096
    v_lshlrev_b32_sdwa v100, 3, v119 dst_sel:DWORD dst_unused:UNUSED_PAD src0_sel:DWORD src1_sel:WORD_0
    v_lshlrev_b32_sdwa v102, 3, v119 dst_sel:DWORD dst_unused:UNUSED_PAD src0_sel:DWORD src1_sel:WORD_1
    ds_read_b64 v[100:101], v100
    ds_read_b64 v[102:103], v102
    buffer_load_dwordx4 v[116:119], v69, s[12:15], s20 offen offset:2048 sc1
    s_waitcnt lgkmcnt(9)
    v_smfmac_f32_16x16x64_bf16 v[52:55], v[64:67], v[104:111], v68
    v_cvt_pk_bf16_f32 v112, v112, v113
    v_cvt_pk_bf16_f32 v113, v114, v115
    ds_write_b64 v70, v[112:113] offset:896
    s_add_u32 s23, s23, 1
    s_cmp_eq_u32 s23, 5
    s_cselect_b32 s35, 4294836224, s32
    s_cselect_b32 s23, 0, s23
    v_add_u32 v70, s35, v70
    s_waitcnt vmcnt(6)
    v_lshlrev_b32_sdwa v104, 3, v120 dst_sel:DWORD dst_unused:UNUSED_PAD src0_sel:DWORD src1_sel:WORD_0
    v_lshlrev_b32_sdwa v106, 3, v120 dst_sel:DWORD dst_unused:UNUSED_PAD src0_sel:DWORD src1_sel:WORD_1
    ds_read_b64 v[104:105], v104
    ds_read_b64 v[106:107], v106
    v_lshlrev_b32_sdwa v108, 3, v121 dst_sel:DWORD dst_unused:UNUSED_PAD src0_sel:DWORD src1_sel:WORD_0
    v_lshlrev_b32_sdwa v110, 3, v121 dst_sel:DWORD dst_unused:UNUSED_PAD src0_sel:DWORD src1_sel:WORD_1
    ds_read_b64 v[108:109], v108
    ds_read_b64 v[110:111], v110
    s_waitcnt lgkmcnt(9)
    v_smfmac_f32_16x16x64_bf16 v[56:59], v[64:67], v[88:95], v68
    s_setprio 0
    v_lshlrev_b32_sdwa v88, 3, v122 dst_sel:DWORD dst_unused:UNUSED_PAD src0_sel:DWORD src1_sel:WORD_0
    v_lshlrev_b32_sdwa v90, 3, v122 dst_sel:DWORD dst_unused:UNUSED_PAD src0_sel:DWORD src1_sel:WORD_1
    ds_read_b64 v[88:89], v88
    ds_read_b64 v[90:91], v90
    v_lshlrev_b32_sdwa v92, 3, v123 dst_sel:DWORD dst_unused:UNUSED_PAD src0_sel:DWORD src1_sel:WORD_0
    v_lshlrev_b32_sdwa v94, 3, v123 dst_sel:DWORD dst_unused:UNUSED_PAD src0_sel:DWORD src1_sel:WORD_1
    ds_read_b64 v[92:93], v92
    ds_read_b64 v[94:95], v94
    buffer_load_dwordx4 v[120:123], v69, s[12:15], s20 offen offset:3072 sc1
    s_add_u32 s20, s20, 4096
    s_waitcnt lgkmcnt(9)
    v_smfmac_f32_16x16x64_bf16 v[60:63], v[64:67], v[96:103], v68
    s_waitcnt lgkmcnt(8)
    s_barrier
    s_setprio 3
    s_waitcnt vmcnt(6)
    v_lshlrev_b32_sdwa v96, 3, v124 dst_sel:DWORD dst_unused:UNUSED_PAD src0_sel:DWORD src1_sel:WORD_0
    v_lshlrev_b32_sdwa v98, 3, v124 dst_sel:DWORD dst_unused:UNUSED_PAD src0_sel:DWORD src1_sel:WORD_1
    ds_read_b64 v[96:97], v96
    ds_read_b64 v[98:99], v98
    v_lshlrev_b32_sdwa v100, 3, v125 dst_sel:DWORD dst_unused:UNUSED_PAD src0_sel:DWORD src1_sel:WORD_0
    v_lshlrev_b32_sdwa v102, 3, v125 dst_sel:DWORD dst_unused:UNUSED_PAD src0_sel:DWORD src1_sel:WORD_1
    ds_read_b64 v[100:101], v100
    ds_read_b64 v[102:103], v102
    s_waitcnt lgkmcnt(8)
    v_smfmac_f32_16x16x64_bf16 v[0:3], v[64:67], v[104:111], v68
    s_waitcnt vmcnt(5)
    v_mfma_f32_16x16x32_bf16 v[112:115], v[72:75], v[128:131], 0
    v_lshlrev_b32_sdwa v104, 3, v126 dst_sel:DWORD dst_unused:UNUSED_PAD src0_sel:DWORD src1_sel:WORD_0
    v_lshlrev_b32_sdwa v106, 3, v126 dst_sel:DWORD dst_unused:UNUSED_PAD src0_sel:DWORD src1_sel:WORD_1
    ds_read_b64 v[104:105], v104
    ds_read_b64 v[106:107], v106
    s_waitcnt vmcnt(4)
    v_mfma_f32_16x16x32_bf16 v[112:115], v[76:79], v[132:135], v[112:115]
    v_lshlrev_b32_sdwa v108, 3, v127 dst_sel:DWORD dst_unused:UNUSED_PAD src0_sel:DWORD src1_sel:WORD_0
    v_lshlrev_b32_sdwa v110, 3, v127 dst_sel:DWORD dst_unused:UNUSED_PAD src0_sel:DWORD src1_sel:WORD_1
    ds_read_b64 v[108:109], v108
    ds_read_b64 v[110:111], v110
    buffer_load_dwordx4 v[124:127], v69, s[12:15], s20 offen offset:0 sc1
    s_waitcnt lgkmcnt(8)
    v_smfmac_f32_16x16x64_bf16 v[4:7], v[64:67], v[88:95], v68
    s_waitcnt vmcnt(4)
    v_mfma_f32_16x16x32_bf16 v[112:115], v[80:83], v[136:139], v[112:115]
    s_waitcnt vmcnt(2)
    v_lshlrev_b32_sdwa v88, 3, v116 dst_sel:DWORD dst_unused:UNUSED_PAD src0_sel:DWORD src1_sel:WORD_0
    v_lshlrev_b32_sdwa v90, 3, v116 dst_sel:DWORD dst_unused:UNUSED_PAD src0_sel:DWORD src1_sel:WORD_1
    ds_read_b64 v[88:89], v88
    ds_read_b64 v[90:91], v90
    s_waitcnt vmcnt(3)
    v_mfma_f32_16x16x32_bf16 v[112:115], v[84:87], v[140:143], v[112:115]
    v_lshlrev_b32_sdwa v92, 3, v117 dst_sel:DWORD dst_unused:UNUSED_PAD src0_sel:DWORD src1_sel:WORD_0
    v_lshlrev_b32_sdwa v94, 3, v117 dst_sel:DWORD dst_unused:UNUSED_PAD src0_sel:DWORD src1_sel:WORD_1
    ds_read_b64 v[92:93], v92
    ds_read_b64 v[94:95], v94
    s_waitcnt lgkmcnt(8)
    v_smfmac_f32_16x16x64_bf16 v[8:11], v[64:67], v[96:103], v68
    s_nop 1
    v_cvt_pk_bf16_f32 v112, v112, v113
    v_cvt_pk_bf16_f32 v113, v114, v115
    ds_write_b64 v70, v[112:113] offset:0
    v_mfma_f32_16x16x32_bf16 v[112:115], v[72:75], v[144:147], 0
    v_mfma_f32_16x16x32_bf16 v[112:115], v[76:79], v[148:151], v[112:115]
    v_lshlrev_b32_sdwa v96, 3, v118 dst_sel:DWORD dst_unused:UNUSED_PAD src0_sel:DWORD src1_sel:WORD_0
    v_lshlrev_b32_sdwa v98, 3, v118 dst_sel:DWORD dst_unused:UNUSED_PAD src0_sel:DWORD src1_sel:WORD_1
    ds_read_b64 v[96:97], v96
    ds_read_b64 v[98:99], v98
    v_mfma_f32_16x16x32_bf16 v[112:115], v[80:83], v[152:155], v[112:115]
    v_mfma_f32_16x16x32_bf16 v[112:115], v[84:87], v[156:159], v[112:115]
    v_lshlrev_b32_sdwa v100, 3, v119 dst_sel:DWORD dst_unused:UNUSED_PAD src0_sel:DWORD src1_sel:WORD_0
    v_lshlrev_b32_sdwa v102, 3, v119 dst_sel:DWORD dst_unused:UNUSED_PAD src0_sel:DWORD src1_sel:WORD_1
    ds_read_b64 v[100:101], v100
    ds_read_b64 v[102:103], v102
    buffer_load_dwordx4 v[116:119], v69, s[12:15], s20 offen offset:1024 sc1
    s_waitcnt lgkmcnt(9)
    v_smfmac_f32_16x16x64_bf16 v[12:15], v[64:67], v[104:111], v68
    s_nop 0
    v_cvt_pk_bf16_f32 v112, v112, v113
    v_cvt_pk_bf16_f32 v113, v114, v115
    ds_write_b64 v70, v[112:113] offset:128
    v_mfma_f32_16x16x32_bf16 v[112:115], v[72:75], v[160:163], 0
    s_waitcnt vmcnt(2)
    v_lshlrev_b32_sdwa v104, 3, v120 dst_sel:DWORD dst_unused:UNUSED_PAD src0_sel:DWORD src1_sel:WORD_0
    v_lshlrev_b32_sdwa v106, 3, v120 dst_sel:DWORD dst_unused:UNUSED_PAD src0_sel:DWORD src1_sel:WORD_1
    ds_read_b64 v[104:105], v104
    ds_read_b64 v[106:107], v106
    v_mfma_f32_16x16x32_bf16 v[112:115], v[76:79], v[164:167], v[112:115]
    v_lshlrev_b32_sdwa v108, 3, v121 dst_sel:DWORD dst_unused:UNUSED_PAD src0_sel:DWORD src1_sel:WORD_0
    v_lshlrev_b32_sdwa v110, 3, v121 dst_sel:DWORD dst_unused:UNUSED_PAD src0_sel:DWORD src1_sel:WORD_1
    ds_read_b64 v[108:109], v108
    ds_read_b64 v[110:111], v110
    s_waitcnt lgkmcnt(10)
    v_smfmac_f32_16x16x64_bf16 v[16:19], v[64:67], v[88:95], v68
    v_mfma_f32_16x16x32_bf16 v[112:115], v[80:83], v[168:171], v[112:115]
    v_lshlrev_b32_sdwa v88, 3, v122 dst_sel:DWORD dst_unused:UNUSED_PAD src0_sel:DWORD src1_sel:WORD_0
    v_lshlrev_b32_sdwa v90, 3, v122 dst_sel:DWORD dst_unused:UNUSED_PAD src0_sel:DWORD src1_sel:WORD_1
    ds_read_b64 v[88:89], v88
    ds_read_b64 v[90:91], v90
    v_mfma_f32_16x16x32_bf16 v[112:115], v[84:87], v[172:175], v[112:115]
    v_lshlrev_b32_sdwa v92, 3, v123 dst_sel:DWORD dst_unused:UNUSED_PAD src0_sel:DWORD src1_sel:WORD_0
    v_lshlrev_b32_sdwa v94, 3, v123 dst_sel:DWORD dst_unused:UNUSED_PAD src0_sel:DWORD src1_sel:WORD_1
    ds_read_b64 v[92:93], v92
    ds_read_b64 v[94:95], v94
    buffer_load_dwordx4 v[120:123], v69, s[12:15], s20 offen offset:2048 sc1
    s_waitcnt lgkmcnt(9)
    v_smfmac_f32_16x16x64_bf16 v[20:23], v[64:67], v[96:103], v68
    s_nop 0
    v_cvt_pk_bf16_f32 v112, v112, v113
    v_cvt_pk_bf16_f32 v113, v114, v115
    ds_write_b64 v70, v[112:113] offset:256
    v_mfma_f32_16x16x32_bf16 v[112:115], v[72:75], v[176:179], 0
    v_mfma_f32_16x16x32_bf16 v[112:115], v[76:79], v[180:183], v[112:115]
    s_waitcnt vmcnt(2)
    v_lshlrev_b32_sdwa v96, 3, v124 dst_sel:DWORD dst_unused:UNUSED_PAD src0_sel:DWORD src1_sel:WORD_0
    v_lshlrev_b32_sdwa v98, 3, v124 dst_sel:DWORD dst_unused:UNUSED_PAD src0_sel:DWORD src1_sel:WORD_1
    ds_read_b64 v[96:97], v96
    ds_read_b64 v[98:99], v98
    v_mfma_f32_16x16x32_bf16 v[112:115], v[80:83], v[184:187], v[112:115]
    v_mfma_f32_16x16x32_bf16 v[112:115], v[84:87], v[188:191], v[112:115]
    v_lshlrev_b32_sdwa v100, 3, v125 dst_sel:DWORD dst_unused:UNUSED_PAD src0_sel:DWORD src1_sel:WORD_0
    v_lshlrev_b32_sdwa v102, 3, v125 dst_sel:DWORD dst_unused:UNUSED_PAD src0_sel:DWORD src1_sel:WORD_1
    ds_read_b64 v[100:101], v100
    ds_read_b64 v[102:103], v102
    s_waitcnt lgkmcnt(9)
    v_smfmac_f32_16x16x64_bf16 v[24:27], v[64:67], v[104:111], v68
    s_nop 1
    v_cvt_pk_bf16_f32 v112, v112, v113
    v_cvt_pk_bf16_f32 v113, v114, v115
    ds_write_b64 v70, v[112:113] offset:384
    v_mfma_f32_16x16x32_bf16 v[112:115], v[72:75], v[192:195], 0
    v_lshlrev_b32_sdwa v104, 3, v126 dst_sel:DWORD dst_unused:UNUSED_PAD src0_sel:DWORD src1_sel:WORD_0
    v_lshlrev_b32_sdwa v106, 3, v126 dst_sel:DWORD dst_unused:UNUSED_PAD src0_sel:DWORD src1_sel:WORD_1
    ds_read_b64 v[104:105], v104
    ds_read_b64 v[106:107], v106
    v_mfma_f32_16x16x32_bf16 v[112:115], v[76:79], v[196:199], v[112:115]
    v_lshlrev_b32_sdwa v108, 3, v127 dst_sel:DWORD dst_unused:UNUSED_PAD src0_sel:DWORD src1_sel:WORD_0
    v_lshlrev_b32_sdwa v110, 3, v127 dst_sel:DWORD dst_unused:UNUSED_PAD src0_sel:DWORD src1_sel:WORD_1
    ds_read_b64 v[108:109], v108
    ds_read_b64 v[110:111], v110
    buffer_load_dwordx4 v[124:127], v69, s[12:15], s20 offen offset:3072 sc1
    s_add_u32 s20, s20, 61440
    s_waitcnt lgkmcnt(10)
    v_smfmac_f32_16x16x64_bf16 v[28:31], v[64:67], v[88:95], v68
    s_setprio 2
    v_mfma_f32_16x16x32_bf16 v[112:115], v[80:83], v[200:203], v[112:115]
    s_waitcnt vmcnt(2)
    v_lshlrev_b32_sdwa v88, 3, v116 dst_sel:DWORD dst_unused:UNUSED_PAD src0_sel:DWORD src1_sel:WORD_0
    v_lshlrev_b32_sdwa v90, 3, v116 dst_sel:DWORD dst_unused:UNUSED_PAD src0_sel:DWORD src1_sel:WORD_1
    ds_read_b64 v[88:89], v88
    ds_read_b64 v[90:91], v90
    v_mfma_f32_16x16x32_bf16 v[112:115], v[84:87], v[204:207], v[112:115]
    v_lshlrev_b32_sdwa v92, 3, v117 dst_sel:DWORD dst_unused:UNUSED_PAD src0_sel:DWORD src1_sel:WORD_0
    v_lshlrev_b32_sdwa v94, 3, v117 dst_sel:DWORD dst_unused:UNUSED_PAD src0_sel:DWORD src1_sel:WORD_1
    ds_read_b64 v[92:93], v92
    ds_read_b64 v[94:95], v94
    s_waitcnt lgkmcnt(9)
    v_smfmac_f32_16x16x64_bf16 v[32:35], v[64:67], v[96:103], v68
    s_nop 1
    v_cvt_pk_bf16_f32 v112, v112, v113
    v_cvt_pk_bf16_f32 v113, v114, v115
    ds_write_b64 v70, v[112:113] offset:512
    v_mfma_f32_16x16x32_bf16 v[112:115], v[72:75], v[208:211], 0
    v_lshlrev_b32_sdwa v96, 3, v118 dst_sel:DWORD dst_unused:UNUSED_PAD src0_sel:DWORD src1_sel:WORD_0
    v_lshlrev_b32_sdwa v98, 3, v118 dst_sel:DWORD dst_unused:UNUSED_PAD src0_sel:DWORD src1_sel:WORD_1
    ds_read_b64 v[96:97], v96
    ds_read_b64 v[98:99], v98
    v_mfma_f32_16x16x32_bf16 v[112:115], v[76:79], v[212:215], v[112:115]
    v_lshlrev_b32_sdwa v100, 3, v119 dst_sel:DWORD dst_unused:UNUSED_PAD src0_sel:DWORD src1_sel:WORD_0
    v_lshlrev_b32_sdwa v102, 3, v119 dst_sel:DWORD dst_unused:UNUSED_PAD src0_sel:DWORD src1_sel:WORD_1
    ds_read_b64 v[100:101], v100
    ds_read_b64 v[102:103], v102
    buffer_load_dwordx4 v[116:119], v69, s[12:15], s20 offen offset:0 sc1
    s_waitcnt lgkmcnt(9)
    v_smfmac_f32_16x16x64_bf16 v[36:39], v[64:67], v[104:111], v68
    v_mfma_f32_16x16x32_bf16 v[112:115], v[80:83], v[216:219], v[112:115]
    s_waitcnt vmcnt(2)
    v_lshlrev_b32_sdwa v104, 3, v120 dst_sel:DWORD dst_unused:UNUSED_PAD src0_sel:DWORD src1_sel:WORD_0
    v_lshlrev_b32_sdwa v106, 3, v120 dst_sel:DWORD dst_unused:UNUSED_PAD src0_sel:DWORD src1_sel:WORD_1
    ds_read_b64 v[104:105], v104
    ds_read_b64 v[106:107], v106
    v_mfma_f32_16x16x32_bf16 v[112:115], v[84:87], v[220:223], v[112:115]
    v_lshlrev_b32_sdwa v108, 3, v121 dst_sel:DWORD dst_unused:UNUSED_PAD src0_sel:DWORD src1_sel:WORD_0
    v_lshlrev_b32_sdwa v110, 3, v121 dst_sel:DWORD dst_unused:UNUSED_PAD src0_sel:DWORD src1_sel:WORD_1
    ds_read_b64 v[108:109], v108
    ds_read_b64 v[110:111], v110
    s_waitcnt lgkmcnt(9)
    v_smfmac_f32_16x16x64_bf16 v[40:43], v[64:67], v[88:95], v68
    s_nop 1
    v_cvt_pk_bf16_f32 v112, v112, v113
    v_cvt_pk_bf16_f32 v113, v114, v115
    ds_write_b64 v70, v[112:113] offset:640
    v_mfma_f32_16x16x32_bf16 v[112:115], v[72:75], v[224:227], 0
    v_mfma_f32_16x16x32_bf16 v[112:115], v[76:79], v[228:231], v[112:115]
    v_lshlrev_b32_sdwa v88, 3, v122 dst_sel:DWORD dst_unused:UNUSED_PAD src0_sel:DWORD src1_sel:WORD_0
    v_lshlrev_b32_sdwa v90, 3, v122 dst_sel:DWORD dst_unused:UNUSED_PAD src0_sel:DWORD src1_sel:WORD_1
    ds_read_b64 v[88:89], v88
    ds_read_b64 v[90:91], v90
    v_mfma_f32_16x16x32_bf16 v[112:115], v[80:83], v[232:235], v[112:115]
    v_mfma_f32_16x16x32_bf16 v[112:115], v[84:87], v[236:239], v[112:115]
    v_lshlrev_b32_sdwa v92, 3, v123 dst_sel:DWORD dst_unused:UNUSED_PAD src0_sel:DWORD src1_sel:WORD_0
    v_lshlrev_b32_sdwa v94, 3, v123 dst_sel:DWORD dst_unused:UNUSED_PAD src0_sel:DWORD src1_sel:WORD_1
    ds_read_b64 v[92:93], v92
    ds_read_b64 v[94:95], v94
    buffer_load_dwordx4 v[120:123], v69, s[12:15], s20 offen offset:1024 sc1
    s_waitcnt lgkmcnt(9)
    v_smfmac_f32_16x16x64_bf16 v[44:47], v[64:67], v[96:103], v68
    s_nop 0
    v_cvt_pk_bf16_f32 v112, v112, v113
    v_cvt_pk_bf16_f32 v113, v114, v115
    ds_write_b64 v70, v[112:113] offset:768
    s_setprio 1
    v_mfma_f32_16x16x32_bf16 v[112:115], v[72:75], v[240:243], 0
    buffer_load_dwordx4 v[72:75], v69, s[12:15], s21 offen offset:0 sc1
    s_waitcnt vmcnt(3)
    v_lshlrev_b32_sdwa v96, 3, v124 dst_sel:DWORD dst_unused:UNUSED_PAD src0_sel:DWORD src1_sel:WORD_0
    v_lshlrev_b32_sdwa v98, 3, v124 dst_sel:DWORD dst_unused:UNUSED_PAD src0_sel:DWORD src1_sel:WORD_1
    ds_read_b64 v[96:97], v96
    ds_read_b64 v[98:99], v98
    v_mfma_f32_16x16x32_bf16 v[112:115], v[76:79], v[244:247], v[112:115]
    buffer_load_dwordx4 v[76:79], v69, s[12:15], s21 offen offset:1024 sc1
    v_lshlrev_b32_sdwa v100, 3, v125 dst_sel:DWORD dst_unused:UNUSED_PAD src0_sel:DWORD src1_sel:WORD_0
    v_lshlrev_b32_sdwa v102, 3, v125 dst_sel:DWORD dst_unused:UNUSED_PAD src0_sel:DWORD src1_sel:WORD_1
    ds_read_b64 v[100:101], v100
    ds_read_b64 v[102:103], v102
    s_waitcnt lgkmcnt(10)
    v_smfmac_f32_16x16x64_bf16 v[48:51], v[64:67], v[104:111], v68
    v_mfma_f32_16x16x32_bf16 v[112:115], v[80:83], v[248:251], v[112:115]
    buffer_load_dwordx4 v[80:83], v69, s[12:15], s19 offen offset:0 sc1
    v_lshlrev_b32_sdwa v104, 3, v126 dst_sel:DWORD dst_unused:UNUSED_PAD src0_sel:DWORD src1_sel:WORD_0
    v_lshlrev_b32_sdwa v106, 3, v126 dst_sel:DWORD dst_unused:UNUSED_PAD src0_sel:DWORD src1_sel:WORD_1
    ds_read_b64 v[104:105], v104
    ds_read_b64 v[106:107], v106
    v_mfma_f32_16x16x32_bf16 v[112:115], v[84:87], v[252:255], v[112:115]
    buffer_load_dwordx4 v[84:87], v69, s[12:15], s19 offen offset:1024 sc1
    s_add_u32 s21, s21, 4096
    s_add_u32 s19, s19, 4096
    v_lshlrev_b32_sdwa v108, 3, v127 dst_sel:DWORD dst_unused:UNUSED_PAD src0_sel:DWORD src1_sel:WORD_0
    v_lshlrev_b32_sdwa v110, 3, v127 dst_sel:DWORD dst_unused:UNUSED_PAD src0_sel:DWORD src1_sel:WORD_1
    ds_read_b64 v[108:109], v108
    ds_read_b64 v[110:111], v110
    buffer_load_dwordx4 v[124:127], v69, s[12:15], s20 offen offset:2048 sc1
    s_waitcnt lgkmcnt(9)
    v_smfmac_f32_16x16x64_bf16 v[52:55], v[64:67], v[88:95], v68
    v_cvt_pk_bf16_f32 v112, v112, v113
    v_cvt_pk_bf16_f32 v113, v114, v115
    ds_write_b64 v70, v[112:113] offset:896
    s_add_u32 s23, s23, 1
    s_cmp_eq_u32 s23, 5
    s_cselect_b32 s35, 4294836224, s32
    s_cselect_b32 s23, 0, s23
    v_add_u32 v70, s35, v70
    s_waitcnt vmcnt(6)
    v_lshlrev_b32_sdwa v88, 3, v116 dst_sel:DWORD dst_unused:UNUSED_PAD src0_sel:DWORD src1_sel:WORD_0
    v_lshlrev_b32_sdwa v90, 3, v116 dst_sel:DWORD dst_unused:UNUSED_PAD src0_sel:DWORD src1_sel:WORD_1
    ds_read_b64 v[88:89], v88
    ds_read_b64 v[90:91], v90
    v_lshlrev_b32_sdwa v92, 3, v117 dst_sel:DWORD dst_unused:UNUSED_PAD src0_sel:DWORD src1_sel:WORD_0
    v_lshlrev_b32_sdwa v94, 3, v117 dst_sel:DWORD dst_unused:UNUSED_PAD src0_sel:DWORD src1_sel:WORD_1
    ds_read_b64 v[92:93], v92
    ds_read_b64 v[94:95], v94
    s_waitcnt lgkmcnt(9)
    v_smfmac_f32_16x16x64_bf16 v[56:59], v[64:67], v[96:103], v68
    s_setprio 0
    v_lshlrev_b32_sdwa v96, 3, v118 dst_sel:DWORD dst_unused:UNUSED_PAD src0_sel:DWORD src1_sel:WORD_0
    v_lshlrev_b32_sdwa v98, 3, v118 dst_sel:DWORD dst_unused:UNUSED_PAD src0_sel:DWORD src1_sel:WORD_1
    ds_read_b64 v[96:97], v96
    ds_read_b64 v[98:99], v98
    v_lshlrev_b32_sdwa v100, 3, v119 dst_sel:DWORD dst_unused:UNUSED_PAD src0_sel:DWORD src1_sel:WORD_0
    v_lshlrev_b32_sdwa v102, 3, v119 dst_sel:DWORD dst_unused:UNUSED_PAD src0_sel:DWORD src1_sel:WORD_1
    ds_read_b64 v[100:101], v100
    ds_read_b64 v[102:103], v102
    buffer_load_dwordx4 v[116:119], v69, s[12:15], s20 offen offset:3072 sc1
    s_add_u32 s20, s20, 4096
    s_waitcnt lgkmcnt(9)
    v_smfmac_f32_16x16x64_bf16 v[60:63], v[64:67], v[104:111], v68
    s_waitcnt lgkmcnt(8)
    s_barrier

    s_add_u32 s22, s22, 1
    s_branch standalone__deep_cross_pnn__recsys_kernel_gloop

standalone__deep_cross_pnn__recsys_kernel_fin:

    s_add_u32 s40, s20, 61440
    s_add_u32 s41, s20, 65536
    s_add_u32 s44, s20, 126976
    s_add_u32 s45, s20, 131072

    s_lshl_b32 s28, s26, 16
    s_and_b32 s29, s26, 0xffff0000
    s_lshl_b32 s30, s27, 16
    s_and_b32 s31, s27, 0xffff0000
    s_lshl_b32 s35, s33, 16
    s_lshl_b32 s42, s34, 15
    s_add_u32 s35, s35, s42
    s_lshl_b32 s42, s3, 12
    s_add_u32 s35, s35, s42
    s_add_u32 s35, s35, 20971520

    s_setprio 3
    v_mov_b32 v128, 0xbdd2d3e8
    v_mov_b32 v129, 0xbdd2d3e8
    v_mov_b32 v130, 0xc0135761
    v_mov_b32 v131, 0xc0135761
    v_mov_b32 v132, 1.0
    v_mov_b32 v133, 1.0
    v_mov_b32 v134, s28
    v_mov_b32 v135, s29
    s_waitcnt vmcnt(6)
    v_lshlrev_b32_sdwa v88, 3, v116 dst_sel:DWORD dst_unused:UNUSED_PAD src0_sel:DWORD src1_sel:WORD_0
    v_lshlrev_b32_sdwa v90, 3, v116 dst_sel:DWORD dst_unused:UNUSED_PAD src0_sel:DWORD src1_sel:WORD_1
    ds_read_b64 v[88:89], v88
    ds_read_b64 v[90:91], v90
    v_lshlrev_b32_sdwa v92, 3, v117 dst_sel:DWORD dst_unused:UNUSED_PAD src0_sel:DWORD src1_sel:WORD_0
    v_lshlrev_b32_sdwa v94, 3, v117 dst_sel:DWORD dst_unused:UNUSED_PAD src0_sel:DWORD src1_sel:WORD_1
    ds_read_b64 v[92:93], v92
    ds_read_b64 v[94:95], v94
    s_waitcnt lgkmcnt(8)
    v_smfmac_f32_16x16x64_bf16 v[0:3], v[64:67], v[96:103], v68
    v_mov_b32 v136, s30
    v_mov_b32 v137, s31
    v_lshrrev_b32 v70, 2, v69
    v_and_b32 v71, 128, v70
    v_add_u32 v70, v70, v71
    v_rcp_f32 v134, v134
    v_rcp_f32 v135, v135
    v_rcp_f32 v136, v136
    v_lshlrev_b32_sdwa v96, 3, v118 dst_sel:DWORD dst_unused:UNUSED_PAD src0_sel:DWORD src1_sel:WORD_0
    v_lshlrev_b32_sdwa v98, 3, v118 dst_sel:DWORD dst_unused:UNUSED_PAD src0_sel:DWORD src1_sel:WORD_1
    ds_read_b64 v[96:97], v96
    ds_read_b64 v[98:99], v98
    v_lshlrev_b32_sdwa v100, 3, v119 dst_sel:DWORD dst_unused:UNUSED_PAD src0_sel:DWORD src1_sel:WORD_0
    v_lshlrev_b32_sdwa v102, 3, v119 dst_sel:DWORD dst_unused:UNUSED_PAD src0_sel:DWORD src1_sel:WORD_1
    ds_read_b64 v[100:101], v100
    ds_read_b64 v[102:103], v102
    buffer_load_dwordx4 v[116:119], v69, s[12:15], s40 offen offset:0 sc1
    s_waitcnt lgkmcnt(8)
    v_smfmac_f32_16x16x64_bf16 v[4:7], v[64:67], v[104:111], v68
    v_rcp_f32 v137, v137
    v_mov_b32 v132, 0x7f7fffff
    v_mov_b32 v133, 0xff7fffff
    v_med3_f32 v134, v134, v132, v133
    v_med3_f32 v135, v135, v132, v133
    v_med3_f32 v136, v136, v132, v133
    v_med3_f32 v137, v137, v132, v133
    s_waitcnt vmcnt(2)
    v_lshlrev_b32_sdwa v104, 3, v120 dst_sel:DWORD dst_unused:UNUSED_PAD src0_sel:DWORD src1_sel:WORD_0
    v_lshlrev_b32_sdwa v106, 3, v120 dst_sel:DWORD dst_unused:UNUSED_PAD src0_sel:DWORD src1_sel:WORD_1
    ds_read_b64 v[104:105], v104
    ds_read_b64 v[106:107], v106
    v_lshlrev_b32_sdwa v108, 3, v121 dst_sel:DWORD dst_unused:UNUSED_PAD src0_sel:DWORD src1_sel:WORD_0
    v_lshlrev_b32_sdwa v110, 3, v121 dst_sel:DWORD dst_unused:UNUSED_PAD src0_sel:DWORD src1_sel:WORD_1
    ds_read_b64 v[108:109], v108
    ds_read_b64 v[110:111], v110
    s_waitcnt lgkmcnt(8)
    v_smfmac_f32_16x16x64_bf16 v[8:11], v[64:67], v[88:95], v68
    v_lshlrev_b32_sdwa v88, 3, v122 dst_sel:DWORD dst_unused:UNUSED_PAD src0_sel:DWORD src1_sel:WORD_0
    v_lshlrev_b32_sdwa v90, 3, v122 dst_sel:DWORD dst_unused:UNUSED_PAD src0_sel:DWORD src1_sel:WORD_1
    ds_read_b64 v[88:89], v88
    ds_read_b64 v[90:91], v90
    v_lshlrev_b32_sdwa v92, 3, v123 dst_sel:DWORD dst_unused:UNUSED_PAD src0_sel:DWORD src1_sel:WORD_0
    v_lshlrev_b32_sdwa v94, 3, v123 dst_sel:DWORD dst_unused:UNUSED_PAD src0_sel:DWORD src1_sel:WORD_1
    ds_read_b64 v[92:93], v92
    ds_read_b64 v[94:95], v94
    buffer_load_dwordx4 v[120:123], v69, s[12:15], s44 offen offset:0 sc1
    s_waitcnt lgkmcnt(8)
    v_smfmac_f32_16x16x64_bf16 v[12:15], v[64:67], v[96:103], v68
    s_waitcnt vmcnt(2)
    v_lshlrev_b32_sdwa v96, 3, v124 dst_sel:DWORD dst_unused:UNUSED_PAD src0_sel:DWORD src1_sel:WORD_0
    v_lshlrev_b32_sdwa v98, 3, v124 dst_sel:DWORD dst_unused:UNUSED_PAD src0_sel:DWORD src1_sel:WORD_1
    ds_read_b64 v[96:97], v96
    ds_read_b64 v[98:99], v98
    v_lshlrev_b32_sdwa v100, 3, v125 dst_sel:DWORD dst_unused:UNUSED_PAD src0_sel:DWORD src1_sel:WORD_0
    v_lshlrev_b32_sdwa v102, 3, v125 dst_sel:DWORD dst_unused:UNUSED_PAD src0_sel:DWORD src1_sel:WORD_1
    ds_read_b64 v[100:101], v100
    ds_read_b64 v[102:103], v102
    s_waitcnt lgkmcnt(8)
    v_smfmac_f32_16x16x64_bf16 v[16:19], v[64:67], v[104:111], v68
    v_lshlrev_b32_sdwa v104, 3, v126 dst_sel:DWORD dst_unused:UNUSED_PAD src0_sel:DWORD src1_sel:WORD_0
    v_lshlrev_b32_sdwa v106, 3, v126 dst_sel:DWORD dst_unused:UNUSED_PAD src0_sel:DWORD src1_sel:WORD_1
    ds_read_b64 v[104:105], v104
    ds_read_b64 v[106:107], v106
    v_lshlrev_b32_sdwa v108, 3, v127 dst_sel:DWORD dst_unused:UNUSED_PAD src0_sel:DWORD src1_sel:WORD_0
    v_lshlrev_b32_sdwa v110, 3, v127 dst_sel:DWORD dst_unused:UNUSED_PAD src0_sel:DWORD src1_sel:WORD_1
    ds_read_b64 v[108:109], v108
    ds_read_b64 v[110:111], v110
    buffer_load_dwordx4 v[124:127], v69, s[12:15], s40 offen offset:1024 sc1
    s_waitcnt lgkmcnt(8)
    v_smfmac_f32_16x16x64_bf16 v[20:23], v[64:67], v[88:95], v68
    s_waitcnt vmcnt(2)
    v_lshlrev_b32_sdwa v88, 3, v116 dst_sel:DWORD dst_unused:UNUSED_PAD src0_sel:DWORD src1_sel:WORD_0
    v_lshlrev_b32_sdwa v90, 3, v116 dst_sel:DWORD dst_unused:UNUSED_PAD src0_sel:DWORD src1_sel:WORD_1
    ds_read_b64 v[88:89], v88
    ds_read_b64 v[90:91], v90
    v_lshlrev_b32_sdwa v92, 3, v117 dst_sel:DWORD dst_unused:UNUSED_PAD src0_sel:DWORD src1_sel:WORD_0
    v_lshlrev_b32_sdwa v94, 3, v117 dst_sel:DWORD dst_unused:UNUSED_PAD src0_sel:DWORD src1_sel:WORD_1
    ds_read_b64 v[92:93], v92
    ds_read_b64 v[94:95], v94
    s_waitcnt lgkmcnt(8)
    v_smfmac_f32_16x16x64_bf16 v[24:27], v[64:67], v[96:103], v68
    v_lshlrev_b32_sdwa v96, 3, v118 dst_sel:DWORD dst_unused:UNUSED_PAD src0_sel:DWORD src1_sel:WORD_0
    v_lshlrev_b32_sdwa v98, 3, v118 dst_sel:DWORD dst_unused:UNUSED_PAD src0_sel:DWORD src1_sel:WORD_1
    ds_read_b64 v[96:97], v96
    ds_read_b64 v[98:99], v98
    v_lshlrev_b32_sdwa v100, 3, v119 dst_sel:DWORD dst_unused:UNUSED_PAD src0_sel:DWORD src1_sel:WORD_0
    v_lshlrev_b32_sdwa v102, 3, v119 dst_sel:DWORD dst_unused:UNUSED_PAD src0_sel:DWORD src1_sel:WORD_1
    ds_read_b64 v[100:101], v100
    ds_read_b64 v[102:103], v102
    buffer_load_dwordx4 v[116:119], v69, s[12:15], s44 offen offset:1024 sc1
    s_waitcnt lgkmcnt(8)
    v_smfmac_f32_16x16x64_bf16 v[28:31], v[64:67], v[104:111], v68
    s_waitcnt vmcnt(2)
    v_lshlrev_b32_sdwa v104, 3, v120 dst_sel:DWORD dst_unused:UNUSED_PAD src0_sel:DWORD src1_sel:WORD_0
    v_lshlrev_b32_sdwa v106, 3, v120 dst_sel:DWORD dst_unused:UNUSED_PAD src0_sel:DWORD src1_sel:WORD_1
    ds_read_b64 v[104:105], v104
    ds_read_b64 v[106:107], v106
    v_lshlrev_b32_sdwa v108, 3, v121 dst_sel:DWORD dst_unused:UNUSED_PAD src0_sel:DWORD src1_sel:WORD_0
    v_lshlrev_b32_sdwa v110, 3, v121 dst_sel:DWORD dst_unused:UNUSED_PAD src0_sel:DWORD src1_sel:WORD_1
    ds_read_b64 v[108:109], v108
    ds_read_b64 v[110:111], v110
    s_waitcnt lgkmcnt(8)
    v_smfmac_f32_16x16x64_bf16 v[0:3], v[64:67], v[88:95], v68
    v_lshlrev_b32_sdwa v88, 3, v122 dst_sel:DWORD dst_unused:UNUSED_PAD src0_sel:DWORD src1_sel:WORD_0
    v_lshlrev_b32_sdwa v90, 3, v122 dst_sel:DWORD dst_unused:UNUSED_PAD src0_sel:DWORD src1_sel:WORD_1
    ds_read_b64 v[88:89], v88
    ds_read_b64 v[90:91], v90
    v_lshlrev_b32_sdwa v92, 3, v123 dst_sel:DWORD dst_unused:UNUSED_PAD src0_sel:DWORD src1_sel:WORD_0
    v_lshlrev_b32_sdwa v94, 3, v123 dst_sel:DWORD dst_unused:UNUSED_PAD src0_sel:DWORD src1_sel:WORD_1
    ds_read_b64 v[92:93], v92
    ds_read_b64 v[94:95], v94
    buffer_load_dwordx4 v[120:123], v69, s[12:15], s40 offen offset:2048 sc1
    s_waitcnt lgkmcnt(8)
    v_smfmac_f32_16x16x64_bf16 v[4:7], v[64:67], v[96:103], v68
    s_waitcnt vmcnt(2)
    v_lshlrev_b32_sdwa v96, 3, v124 dst_sel:DWORD dst_unused:UNUSED_PAD src0_sel:DWORD src1_sel:WORD_0
    v_lshlrev_b32_sdwa v98, 3, v124 dst_sel:DWORD dst_unused:UNUSED_PAD src0_sel:DWORD src1_sel:WORD_1
    ds_read_b64 v[96:97], v96
    ds_read_b64 v[98:99], v98
    v_lshlrev_b32_sdwa v100, 3, v125 dst_sel:DWORD dst_unused:UNUSED_PAD src0_sel:DWORD src1_sel:WORD_0
    v_lshlrev_b32_sdwa v102, 3, v125 dst_sel:DWORD dst_unused:UNUSED_PAD src0_sel:DWORD src1_sel:WORD_1
    ds_read_b64 v[100:101], v100
    ds_read_b64 v[102:103], v102
    s_waitcnt lgkmcnt(8)
    v_smfmac_f32_16x16x64_bf16 v[0:3], v[64:67], v[104:111], v68
    v_lshlrev_b32_sdwa v104, 3, v126 dst_sel:DWORD dst_unused:UNUSED_PAD src0_sel:DWORD src1_sel:WORD_0
    v_lshlrev_b32_sdwa v106, 3, v126 dst_sel:DWORD dst_unused:UNUSED_PAD src0_sel:DWORD src1_sel:WORD_1
    ds_read_b64 v[104:105], v104
    ds_read_b64 v[106:107], v106
    v_lshlrev_b32_sdwa v108, 3, v127 dst_sel:DWORD dst_unused:UNUSED_PAD src0_sel:DWORD src1_sel:WORD_0
    v_lshlrev_b32_sdwa v110, 3, v127 dst_sel:DWORD dst_unused:UNUSED_PAD src0_sel:DWORD src1_sel:WORD_1
    ds_read_b64 v[108:109], v108
    ds_read_b64 v[110:111], v110
    buffer_load_dwordx4 v[124:127], v69, s[12:15], s44 offen offset:2048 sc1
    s_waitcnt lgkmcnt(8)
    v_smfmac_f32_16x16x64_bf16 v[4:7], v[64:67], v[88:95], v68
    s_waitcnt vmcnt(2)
    v_lshlrev_b32_sdwa v88, 3, v116 dst_sel:DWORD dst_unused:UNUSED_PAD src0_sel:DWORD src1_sel:WORD_0
    v_lshlrev_b32_sdwa v90, 3, v116 dst_sel:DWORD dst_unused:UNUSED_PAD src0_sel:DWORD src1_sel:WORD_1
    ds_read_b64 v[88:89], v88
    ds_read_b64 v[90:91], v90
    v_lshlrev_b32_sdwa v92, 3, v117 dst_sel:DWORD dst_unused:UNUSED_PAD src0_sel:DWORD src1_sel:WORD_0
    v_lshlrev_b32_sdwa v94, 3, v117 dst_sel:DWORD dst_unused:UNUSED_PAD src0_sel:DWORD src1_sel:WORD_1
    ds_read_b64 v[92:93], v92
    ds_read_b64 v[94:95], v94
    s_waitcnt lgkmcnt(8)
    v_smfmac_f32_16x16x64_bf16 v[8:11], v[64:67], v[96:103], v68
    v_pk_mul_f32 v[140:141], v[0:1], v[0:1]
    v_pk_mul_f32 v[142:143], v[2:3], v[2:3]
    v_pk_fma_f32 v[140:141], v[140:141], v[128:129], v[130:131]
    v_pk_fma_f32 v[142:143], v[142:143], v[128:129], v[130:131]
    v_pk_mul_f32 v[140:141], v[140:141], v[0:1]
    v_pk_mul_f32 v[142:143], v[142:143], v[2:3]
    v_exp_f32 v140, v140
    v_pk_mul_f32 v[146:147], v[4:5], v[4:5]
    v_lshlrev_b32_sdwa v96, 3, v118 dst_sel:DWORD dst_unused:UNUSED_PAD src0_sel:DWORD src1_sel:WORD_0
    v_lshlrev_b32_sdwa v98, 3, v118 dst_sel:DWORD dst_unused:UNUSED_PAD src0_sel:DWORD src1_sel:WORD_1
    ds_read_b64 v[96:97], v96
    ds_read_b64 v[98:99], v98
    v_lshlrev_b32_sdwa v100, 3, v119 dst_sel:DWORD dst_unused:UNUSED_PAD src0_sel:DWORD src1_sel:WORD_0
    v_lshlrev_b32_sdwa v102, 3, v119 dst_sel:DWORD dst_unused:UNUSED_PAD src0_sel:DWORD src1_sel:WORD_1
    ds_read_b64 v[100:101], v100
    ds_read_b64 v[102:103], v102
    buffer_load_dwordx4 v[116:119], v69, s[12:15], s40 offen offset:3072 sc1
    s_waitcnt lgkmcnt(8)
    v_smfmac_f32_16x16x64_bf16 v[12:15], v[64:67], v[104:111], v68
    v_exp_f32 v141, v141
    v_pk_fma_f32 v[146:147], v[146:147], v[128:129], v[130:131]
    v_pk_mul_f32 v[148:149], v[6:7], v[6:7]
    v_exp_f32 v142, v142
    v_pk_fma_f32 v[140:141], v[140:141], v[134:135], v[134:135]
    v_pk_mul_f32 v[146:147], v[146:147], v[4:5]
    v_rcp_f32 v140, v140
    v_pk_fma_f32 v[148:149], v[148:149], v[128:129], v[130:131]
    s_waitcnt vmcnt(2)
    v_lshlrev_b32_sdwa v104, 3, v120 dst_sel:DWORD dst_unused:UNUSED_PAD src0_sel:DWORD src1_sel:WORD_0
    v_lshlrev_b32_sdwa v106, 3, v120 dst_sel:DWORD dst_unused:UNUSED_PAD src0_sel:DWORD src1_sel:WORD_1
    ds_read_b64 v[104:105], v104
    ds_read_b64 v[106:107], v106
    v_lshlrev_b32_sdwa v108, 3, v121 dst_sel:DWORD dst_unused:UNUSED_PAD src0_sel:DWORD src1_sel:WORD_0
    v_lshlrev_b32_sdwa v110, 3, v121 dst_sel:DWORD dst_unused:UNUSED_PAD src0_sel:DWORD src1_sel:WORD_1
    ds_read_b64 v[108:109], v108
    ds_read_b64 v[110:111], v110
    s_waitcnt lgkmcnt(8)
    v_smfmac_f32_16x16x64_bf16 v[8:11], v[64:67], v[88:95], v68
    v_rcp_f32 v141, v141
    v_pk_mul_f32 v[148:149], v[148:149], v[6:7]
    v_exp_f32 v143, v143
    v_pk_mul_f32 v[144:145], v[0:1], v[140:141]
    v_exp_f32 v146, v146
    v_pk_fma_f32 v[142:143], v[142:143], v[136:137], v[136:137]
    v_exp_f32 v147, v147
    v_rcp_f32 v142, v142
    v_lshlrev_b32_sdwa v88, 3, v122 dst_sel:DWORD dst_unused:UNUSED_PAD src0_sel:DWORD src1_sel:WORD_0
    v_lshlrev_b32_sdwa v90, 3, v122 dst_sel:DWORD dst_unused:UNUSED_PAD src0_sel:DWORD src1_sel:WORD_1
    ds_read_b64 v[88:89], v88
    ds_read_b64 v[90:91], v90
    v_lshlrev_b32_sdwa v92, 3, v123 dst_sel:DWORD dst_unused:UNUSED_PAD src0_sel:DWORD src1_sel:WORD_0
    v_lshlrev_b32_sdwa v94, 3, v123 dst_sel:DWORD dst_unused:UNUSED_PAD src0_sel:DWORD src1_sel:WORD_1
    ds_read_b64 v[92:93], v92
    ds_read_b64 v[94:95], v94
    buffer_load_dwordx4 v[120:123], v69, s[12:15], s44 offen offset:3072 sc1
    s_waitcnt lgkmcnt(8)
    v_smfmac_f32_16x16x64_bf16 v[12:15], v[64:67], v[96:103], v68
    v_rcp_f32 v143, v143
    v_pk_fma_f32 v[146:147], v[146:147], v[134:135], v[134:135]
    v_pk_mul_f32 v[152:153], v[8:9], v[8:9]
    v_rcp_f32 v146, v146
    v_pk_fma_f32 v[144:145], v[2:3], v[142:143], v[144:145]
    v_pk_fma_f32 v[152:153], v[152:153], v[128:129], v[130:131]
    v_rcp_f32 v147, v147
    v_add_f32 v144, v144, v145
    s_waitcnt vmcnt(2)
    v_lshlrev_b32_sdwa v96, 3, v124 dst_sel:DWORD dst_unused:UNUSED_PAD src0_sel:DWORD src1_sel:WORD_0
    v_lshlrev_b32_sdwa v98, 3, v124 dst_sel:DWORD dst_unused:UNUSED_PAD src0_sel:DWORD src1_sel:WORD_1
    ds_read_b64 v[96:97], v96
    ds_read_b64 v[98:99], v98
    v_lshlrev_b32_sdwa v100, 3, v125 dst_sel:DWORD dst_unused:UNUSED_PAD src0_sel:DWORD src1_sel:WORD_0
    v_lshlrev_b32_sdwa v102, 3, v125 dst_sel:DWORD dst_unused:UNUSED_PAD src0_sel:DWORD src1_sel:WORD_1
    ds_read_b64 v[100:101], v100
    ds_read_b64 v[102:103], v102
    s_waitcnt lgkmcnt(8)
    v_smfmac_f32_16x16x64_bf16 v[16:19], v[64:67], v[104:111], v68
    v_exp_f32 v148, v148
    buffer_store_dword v144, v70, s[12:15], s35 offen offset:0 sc1
    v_pk_mul_f32 v[150:151], v[4:5], v[146:147]
    v_exp_f32 v149, v149
    v_pk_mul_f32 v[152:153], v[152:153], v[8:9]
    v_pk_mul_f32 v[154:155], v[10:11], v[10:11]
    v_exp_f32 v152, v152
    v_pk_fma_f32 v[148:149], v[148:149], v[136:137], v[136:137]
    v_lshlrev_b32_sdwa v104, 3, v126 dst_sel:DWORD dst_unused:UNUSED_PAD src0_sel:DWORD src1_sel:WORD_0
    v_lshlrev_b32_sdwa v106, 3, v126 dst_sel:DWORD dst_unused:UNUSED_PAD src0_sel:DWORD src1_sel:WORD_1
    ds_read_b64 v[104:105], v104
    ds_read_b64 v[106:107], v106
    v_lshlrev_b32_sdwa v108, 3, v127 dst_sel:DWORD dst_unused:UNUSED_PAD src0_sel:DWORD src1_sel:WORD_0
    v_lshlrev_b32_sdwa v110, 3, v127 dst_sel:DWORD dst_unused:UNUSED_PAD src0_sel:DWORD src1_sel:WORD_1
    ds_read_b64 v[108:109], v108
    ds_read_b64 v[110:111], v110
    buffer_load_dwordx4 v[124:127], v69, s[12:15], s20 offen offset:0 sc1
    s_waitcnt lgkmcnt(8)
    v_smfmac_f32_16x16x64_bf16 v[20:23], v[64:67], v[88:95], v68
    v_rcp_f32 v148, v148
    v_pk_fma_f32 v[154:155], v[154:155], v[128:129], v[130:131]
    v_pk_mul_f32 v[158:159], v[12:13], v[12:13]
    v_rcp_f32 v149, v149
    v_pk_mul_f32 v[154:155], v[154:155], v[10:11]
    v_pk_fma_f32 v[158:159], v[158:159], v[128:129], v[130:131]
    v_exp_f32 v153, v153
    v_pk_fma_f32 v[150:151], v[6:7], v[148:149], v[150:151]
    s_waitcnt vmcnt(3)
    v_lshlrev_b32_sdwa v88, 3, v116 dst_sel:DWORD dst_unused:UNUSED_PAD src0_sel:DWORD src1_sel:WORD_0
    v_lshlrev_b32_sdwa v90, 3, v116 dst_sel:DWORD dst_unused:UNUSED_PAD src0_sel:DWORD src1_sel:WORD_1
    ds_read_b64 v[88:89], v88
    ds_read_b64 v[90:91], v90
    v_lshlrev_b32_sdwa v92, 3, v117 dst_sel:DWORD dst_unused:UNUSED_PAD src0_sel:DWORD src1_sel:WORD_0
    v_lshlrev_b32_sdwa v94, 3, v117 dst_sel:DWORD dst_unused:UNUSED_PAD src0_sel:DWORD src1_sel:WORD_1
    ds_read_b64 v[92:93], v92
    ds_read_b64 v[94:95], v94
    s_waitcnt lgkmcnt(8)
    v_smfmac_f32_16x16x64_bf16 v[16:19], v[64:67], v[96:103], v68
    v_exp_f32 v154, v154
    v_add_f32 v150, v150, v151
    v_pk_fma_f32 v[152:153], v[152:153], v[134:135], v[134:135]
    v_exp_f32 v155, v155
    buffer_store_dword v150, v70, s[12:15], s35 offen offset:128 sc1
    v_pk_mul_f32 v[158:159], v[158:159], v[12:13]
    v_rcp_f32 v152, v152
    v_pk_fma_f32 v[154:155], v[154:155], v[136:137], v[136:137]
    v_lshlrev_b32_sdwa v96, 3, v118 dst_sel:DWORD dst_unused:UNUSED_PAD src0_sel:DWORD src1_sel:WORD_0
    v_lshlrev_b32_sdwa v98, 3, v118 dst_sel:DWORD dst_unused:UNUSED_PAD src0_sel:DWORD src1_sel:WORD_1
    ds_read_b64 v[96:97], v96
    ds_read_b64 v[98:99], v98
    v_lshlrev_b32_sdwa v100, 3, v119 dst_sel:DWORD dst_unused:UNUSED_PAD src0_sel:DWORD src1_sel:WORD_0
    v_lshlrev_b32_sdwa v102, 3, v119 dst_sel:DWORD dst_unused:UNUSED_PAD src0_sel:DWORD src1_sel:WORD_1
    ds_read_b64 v[100:101], v100
    ds_read_b64 v[102:103], v102
    buffer_load_dwordx4 v[116:119], v69, s[12:15], s41 offen offset:0 sc1
    s_waitcnt lgkmcnt(8)
    v_smfmac_f32_16x16x64_bf16 v[20:23], v[64:67], v[104:111], v68
    v_rcp_f32 v153, v153
    v_pk_mul_f32 v[160:161], v[14:15], v[14:15]
    v_pk_mul_f32 v[164:165], v[16:17], v[16:17]
    v_rcp_f32 v154, v154
    v_pk_mul_f32 v[156:157], v[8:9], v[152:153]
    v_pk_fma_f32 v[160:161], v[160:161], v[128:129], v[130:131]
    v_rcp_f32 v155, v155
    v_pk_mul_f32 v[160:161], v[160:161], v[14:15]
    s_waitcnt vmcnt(4)
    v_lshlrev_b32_sdwa v104, 3, v120 dst_sel:DWORD dst_unused:UNUSED_PAD src0_sel:DWORD src1_sel:WORD_0
    v_lshlrev_b32_sdwa v106, 3, v120 dst_sel:DWORD dst_unused:UNUSED_PAD src0_sel:DWORD src1_sel:WORD_1
    ds_read_b64 v[104:105], v104
    ds_read_b64 v[106:107], v106
    v_lshlrev_b32_sdwa v108, 3, v121 dst_sel:DWORD dst_unused:UNUSED_PAD src0_sel:DWORD src1_sel:WORD_0
    v_lshlrev_b32_sdwa v110, 3, v121 dst_sel:DWORD dst_unused:UNUSED_PAD src0_sel:DWORD src1_sel:WORD_1
    ds_read_b64 v[108:109], v108
    ds_read_b64 v[110:111], v110
    s_waitcnt lgkmcnt(8)
    v_smfmac_f32_16x16x64_bf16 v[24:27], v[64:67], v[88:95], v68
    v_exp_f32 v158, v158
    v_pk_fma_f32 v[156:157], v[10:11], v[154:155], v[156:157]
    v_pk_fma_f32 v[164:165], v[164:165], v[128:129], v[130:131]
    v_exp_f32 v159, v159
    v_add_f32 v156, v156, v157
    v_pk_mul_f32 v[164:165], v[164:165], v[16:17]
    v_exp_f32 v160, v160
    buffer_store_dword v156, v70, s[12:15], s35 offen offset:512 sc1
    v_lshlrev_b32_sdwa v88, 3, v122 dst_sel:DWORD dst_unused:UNUSED_PAD src0_sel:DWORD src1_sel:WORD_0
    v_lshlrev_b32_sdwa v90, 3, v122 dst_sel:DWORD dst_unused:UNUSED_PAD src0_sel:DWORD src1_sel:WORD_1
    ds_read_b64 v[88:89], v88
    ds_read_b64 v[90:91], v90
    v_lshlrev_b32_sdwa v92, 3, v123 dst_sel:DWORD dst_unused:UNUSED_PAD src0_sel:DWORD src1_sel:WORD_0
    v_lshlrev_b32_sdwa v94, 3, v123 dst_sel:DWORD dst_unused:UNUSED_PAD src0_sel:DWORD src1_sel:WORD_1
    ds_read_b64 v[92:93], v92
    ds_read_b64 v[94:95], v94
    buffer_load_dwordx4 v[120:123], v69, s[12:15], s45 offen offset:0 sc1
    s_waitcnt lgkmcnt(8)
    v_smfmac_f32_16x16x64_bf16 v[28:31], v[64:67], v[96:103], v68
    v_exp_f32 v161, v161
    v_pk_fma_f32 v[158:159], v[158:159], v[134:135], v[134:135]
    v_pk_mul_f32 v[166:167], v[18:19], v[18:19]
    v_rcp_f32 v158, v158
    v_pk_fma_f32 v[160:161], v[160:161], v[136:137], v[136:137]
    v_pk_fma_f32 v[166:167], v[166:167], v[128:129], v[130:131]
    v_rcp_f32 v159, v159
    v_pk_mul_f32 v[166:167], v[166:167], v[18:19]
    s_waitcnt vmcnt(4)
    v_lshlrev_b32_sdwa v96, 3, v124 dst_sel:DWORD dst_unused:UNUSED_PAD src0_sel:DWORD src1_sel:WORD_0
    v_lshlrev_b32_sdwa v98, 3, v124 dst_sel:DWORD dst_unused:UNUSED_PAD src0_sel:DWORD src1_sel:WORD_1
    ds_read_b64 v[96:97], v96
    ds_read_b64 v[98:99], v98
    v_lshlrev_b32_sdwa v100, 3, v125 dst_sel:DWORD dst_unused:UNUSED_PAD src0_sel:DWORD src1_sel:WORD_0
    v_lshlrev_b32_sdwa v102, 3, v125 dst_sel:DWORD dst_unused:UNUSED_PAD src0_sel:DWORD src1_sel:WORD_1
    ds_read_b64 v[100:101], v100
    ds_read_b64 v[102:103], v102
    s_waitcnt lgkmcnt(8)
    v_smfmac_f32_16x16x64_bf16 v[24:27], v[64:67], v[104:111], v68
    v_rcp_f32 v160, v160
    v_pk_mul_f32 v[162:163], v[12:13], v[158:159]
    v_pk_mul_f32 v[170:171], v[20:21], v[20:21]
    v_rcp_f32 v161, v161
    v_pk_fma_f32 v[170:171], v[170:171], v[128:129], v[130:131]
    v_pk_mul_f32 v[172:173], v[22:23], v[22:23]
    v_exp_f32 v164, v164
    v_pk_fma_f32 v[162:163], v[14:15], v[160:161], v[162:163]
    v_lshlrev_b32_sdwa v104, 3, v126 dst_sel:DWORD dst_unused:UNUSED_PAD src0_sel:DWORD src1_sel:WORD_0
    v_lshlrev_b32_sdwa v106, 3, v126 dst_sel:DWORD dst_unused:UNUSED_PAD src0_sel:DWORD src1_sel:WORD_1
    ds_read_b64 v[104:105], v104
    ds_read_b64 v[106:107], v106
    v_lshlrev_b32_sdwa v108, 3, v127 dst_sel:DWORD dst_unused:UNUSED_PAD src0_sel:DWORD src1_sel:WORD_0
    v_lshlrev_b32_sdwa v110, 3, v127 dst_sel:DWORD dst_unused:UNUSED_PAD src0_sel:DWORD src1_sel:WORD_1
    ds_read_b64 v[108:109], v108
    ds_read_b64 v[110:111], v110
    buffer_load_dwordx4 v[124:127], v69, s[12:15], s20 offen offset:1024 sc1
    s_waitcnt lgkmcnt(8)
    v_smfmac_f32_16x16x64_bf16 v[28:31], v[64:67], v[88:95], v68
    s_setprio 2
    v_exp_f32 v165, v165
    v_add_f32 v162, v162, v163
    v_pk_mul_f32 v[170:171], v[170:171], v[20:21]
    v_exp_f32 v166, v166
    buffer_store_dword v162, v70, s[12:15], s35 offen offset:640 sc1
    v_pk_fma_f32 v[164:165], v[164:165], v[134:135], v[134:135]
    v_exp_f32 v167, v167
    v_pk_fma_f32 v[172:173], v[172:173], v[128:129], v[130:131]
    s_waitcnt vmcnt(4)
    v_lshlrev_b32_sdwa v88, 3, v116 dst_sel:DWORD dst_unused:UNUSED_PAD src0_sel:DWORD src1_sel:WORD_0
    v_lshlrev_b32_sdwa v90, 3, v116 dst_sel:DWORD dst_unused:UNUSED_PAD src0_sel:DWORD src1_sel:WORD_1
    ds_read_b64 v[88:89], v88
    ds_read_b64 v[90:91], v90
    v_lshlrev_b32_sdwa v92, 3, v117 dst_sel:DWORD dst_unused:UNUSED_PAD src0_sel:DWORD src1_sel:WORD_0
    v_lshlrev_b32_sdwa v94, 3, v117 dst_sel:DWORD dst_unused:UNUSED_PAD src0_sel:DWORD src1_sel:WORD_1
    ds_read_b64 v[92:93], v92
    ds_read_b64 v[94:95], v94
    s_waitcnt lgkmcnt(8)
    v_smfmac_f32_16x16x64_bf16 v[32:35], v[64:67], v[96:103], v68
    v_rcp_f32 v164, v164
    v_pk_fma_f32 v[166:167], v[166:167], v[136:137], v[136:137]
    v_pk_mul_f32 v[172:173], v[172:173], v[22:23]
    v_rcp_f32 v165, v165
    v_pk_mul_f32 v[140:141], v[24:25], v[24:25]
    v_pk_mul_f32 v[142:143], v[26:27], v[26:27]
    v_rcp_f32 v166, v166
    v_pk_mul_f32 v[168:169], v[16:17], v[164:165]
    v_lshlrev_b32_sdwa v96, 3, v118 dst_sel:DWORD dst_unused:UNUSED_PAD src0_sel:DWORD src1_sel:WORD_0
    v_lshlrev_b32_sdwa v98, 3, v118 dst_sel:DWORD dst_unused:UNUSED_PAD src0_sel:DWORD src1_sel:WORD_1
    ds_read_b64 v[96:97], v96
    ds_read_b64 v[98:99], v98
    v_lshlrev_b32_sdwa v100, 3, v119 dst_sel:DWORD dst_unused:UNUSED_PAD src0_sel:DWORD src1_sel:WORD_0
    v_lshlrev_b32_sdwa v102, 3, v119 dst_sel:DWORD dst_unused:UNUSED_PAD src0_sel:DWORD src1_sel:WORD_1
    ds_read_b64 v[100:101], v100
    ds_read_b64 v[102:103], v102
    buffer_load_dwordx4 v[116:119], v69, s[12:15], s41 offen offset:1024 sc1
    s_waitcnt lgkmcnt(8)
    v_smfmac_f32_16x16x64_bf16 v[36:39], v[64:67], v[104:111], v68
    v_rcp_f32 v167, v167
    v_pk_fma_f32 v[140:141], v[140:141], v[128:129], v[130:131]
    v_pk_fma_f32 v[142:143], v[142:143], v[128:129], v[130:131]
    v_exp_f32 v170, v170
    v_pk_fma_f32 v[168:169], v[18:19], v[166:167], v[168:169]
    v_pk_mul_f32 v[140:141], v[140:141], v[24:25]
    v_exp_f32 v171, v171
    v_add_f32 v168, v168, v169
    s_waitcnt vmcnt(3)
    v_lshlrev_b32_sdwa v104, 3, v120 dst_sel:DWORD dst_unused:UNUSED_PAD src0_sel:DWORD src1_sel:WORD_0
    v_lshlrev_b32_sdwa v106, 3, v120 dst_sel:DWORD dst_unused:UNUSED_PAD src0_sel:DWORD src1_sel:WORD_1
    ds_read_b64 v[104:105], v104
    ds_read_b64 v[106:107], v106
    v_lshlrev_b32_sdwa v108, 3, v121 dst_sel:DWORD dst_unused:UNUSED_PAD src0_sel:DWORD src1_sel:WORD_0
    v_lshlrev_b32_sdwa v110, 3, v121 dst_sel:DWORD dst_unused:UNUSED_PAD src0_sel:DWORD src1_sel:WORD_1
    ds_read_b64 v[108:109], v108
    ds_read_b64 v[110:111], v110
    s_waitcnt lgkmcnt(8)
    v_smfmac_f32_16x16x64_bf16 v[32:35], v[64:67], v[88:95], v68
    v_exp_f32 v172, v172
    buffer_store_dword v168, v70, s[12:15], s35 offen offset:1024 sc1
    v_pk_fma_f32 v[170:171], v[170:171], v[134:135], v[134:135]
    v_exp_f32 v173, v173
    v_pk_mul_f32 v[142:143], v[142:143], v[26:27]
    v_pk_mul_f32 v[146:147], v[28:29], v[28:29]
    v_rcp_f32 v170, v170
    v_pk_fma_f32 v[172:173], v[172:173], v[136:137], v[136:137]
    v_lshlrev_b32_sdwa v88, 3, v122 dst_sel:DWORD dst_unused:UNUSED_PAD src0_sel:DWORD src1_sel:WORD_0
    v_lshlrev_b32_sdwa v90, 3, v122 dst_sel:DWORD dst_unused:UNUSED_PAD src0_sel:DWORD src1_sel:WORD_1
    ds_read_b64 v[88:89], v88
    ds_read_b64 v[90:91], v90
    v_lshlrev_b32_sdwa v92, 3, v123 dst_sel:DWORD dst_unused:UNUSED_PAD src0_sel:DWORD src1_sel:WORD_0
    v_lshlrev_b32_sdwa v94, 3, v123 dst_sel:DWORD dst_unused:UNUSED_PAD src0_sel:DWORD src1_sel:WORD_1
    ds_read_b64 v[92:93], v92
    ds_read_b64 v[94:95], v94
    buffer_load_dwordx4 v[120:123], v69, s[12:15], s45 offen offset:1024 sc1
    s_waitcnt lgkmcnt(8)
    v_smfmac_f32_16x16x64_bf16 v[36:39], v[64:67], v[96:103], v68
    v_rcp_f32 v171, v171
    v_pk_fma_f32 v[146:147], v[146:147], v[128:129], v[130:131]
    v_pk_mul_f32 v[148:149], v[30:31], v[30:31]
    v_rcp_f32 v172, v172
    v_pk_mul_f32 v[174:175], v[20:21], v[170:171]
    v_pk_mul_f32 v[146:147], v[146:147], v[28:29]
    v_rcp_f32 v173, v173
    v_pk_fma_f32 v[148:149], v[148:149], v[128:129], v[130:131]
    s_waitcnt vmcnt(4)
    v_lshlrev_b32_sdwa v96, 3, v124 dst_sel:DWORD dst_unused:UNUSED_PAD src0_sel:DWORD src1_sel:WORD_0
    v_lshlrev_b32_sdwa v98, 3, v124 dst_sel:DWORD dst_unused:UNUSED_PAD src0_sel:DWORD src1_sel:WORD_1
    ds_read_b64 v[96:97], v96
    ds_read_b64 v[98:99], v98
    v_lshlrev_b32_sdwa v100, 3, v125 dst_sel:DWORD dst_unused:UNUSED_PAD src0_sel:DWORD src1_sel:WORD_0
    v_lshlrev_b32_sdwa v102, 3, v125 dst_sel:DWORD dst_unused:UNUSED_PAD src0_sel:DWORD src1_sel:WORD_1
    ds_read_b64 v[100:101], v100
    ds_read_b64 v[102:103], v102
    s_waitcnt lgkmcnt(8)
    v_smfmac_f32_16x16x64_bf16 v[32:35], v[64:67], v[104:111], v68
    v_exp_f32 v140, v140
    v_pk_fma_f32 v[174:175], v[22:23], v[172:173], v[174:175]
    v_pk_mul_f32 v[148:149], v[148:149], v[30:31]
    v_exp_f32 v141, v141
    v_add_f32 v174, v174, v175
    v_exp_f32 v142, v142
    buffer_store_dword v174, v70, s[12:15], s35 offen offset:1152 sc1
    v_pk_fma_f32 v[140:141], v[140:141], v[134:135], v[134:135]
    v_lshlrev_b32_sdwa v104, 3, v126 dst_sel:DWORD dst_unused:UNUSED_PAD src0_sel:DWORD src1_sel:WORD_0
    v_lshlrev_b32_sdwa v106, 3, v126 dst_sel:DWORD dst_unused:UNUSED_PAD src0_sel:DWORD src1_sel:WORD_1
    ds_read_b64 v[104:105], v104
    ds_read_b64 v[106:107], v106
    v_lshlrev_b32_sdwa v108, 3, v127 dst_sel:DWORD dst_unused:UNUSED_PAD src0_sel:DWORD src1_sel:WORD_0
    v_lshlrev_b32_sdwa v110, 3, v127 dst_sel:DWORD dst_unused:UNUSED_PAD src0_sel:DWORD src1_sel:WORD_1
    ds_read_b64 v[108:109], v108
    ds_read_b64 v[110:111], v110
    buffer_load_dwordx4 v[124:127], v69, s[12:15], s20 offen offset:2048 sc1
    s_waitcnt lgkmcnt(8)
    v_smfmac_f32_16x16x64_bf16 v[36:39], v[64:67], v[88:95], v68
    v_rcp_f32 v140, v140
    v_pk_mul_f32 v[152:153], v[32:33], v[32:33]
    v_pk_mul_f32 v[154:155], v[34:35], v[34:35]
    v_rcp_f32 v141, v141
    v_pk_fma_f32 v[152:153], v[152:153], v[128:129], v[130:131]
    v_pk_fma_f32 v[154:155], v[154:155], v[128:129], v[130:131]
    v_exp_f32 v143, v143
    v_pk_mul_f32 v[144:145], v[24:25], v[140:141]
    s_waitcnt vmcnt(4)
    v_lshlrev_b32_sdwa v88, 3, v116 dst_sel:DWORD dst_unused:UNUSED_PAD src0_sel:DWORD src1_sel:WORD_0
    v_lshlrev_b32_sdwa v90, 3, v116 dst_sel:DWORD dst_unused:UNUSED_PAD src0_sel:DWORD src1_sel:WORD_1
    ds_read_b64 v[88:89], v88
    ds_read_b64 v[90:91], v90
    v_lshlrev_b32_sdwa v92, 3, v117 dst_sel:DWORD dst_unused:UNUSED_PAD src0_sel:DWORD src1_sel:WORD_0
    v_lshlrev_b32_sdwa v94, 3, v117 dst_sel:DWORD dst_unused:UNUSED_PAD src0_sel:DWORD src1_sel:WORD_1
    ds_read_b64 v[92:93], v92
    ds_read_b64 v[94:95], v94
    s_waitcnt lgkmcnt(8)
    v_smfmac_f32_16x16x64_bf16 v[40:43], v[64:67], v[96:103], v68
    v_exp_f32 v146, v146
    v_pk_fma_f32 v[142:143], v[142:143], v[136:137], v[136:137]
    v_pk_mul_f32 v[152:153], v[152:153], v[32:33]
    v_rcp_f32 v142, v142
    v_pk_mul_f32 v[154:155], v[154:155], v[34:35]
    v_pk_mul_f32 v[158:159], v[36:37], v[36:37]
    v_rcp_f32 v143, v143
    v_pk_fma_f32 v[158:159], v[158:159], v[128:129], v[130:131]
    v_lshlrev_b32_sdwa v96, 3, v118 dst_sel:DWORD dst_unused:UNUSED_PAD src0_sel:DWORD src1_sel:WORD_0
    v_lshlrev_b32_sdwa v98, 3, v118 dst_sel:DWORD dst_unused:UNUSED_PAD src0_sel:DWORD src1_sel:WORD_1
    ds_read_b64 v[96:97], v96
    ds_read_b64 v[98:99], v98
    v_lshlrev_b32_sdwa v100, 3, v119 dst_sel:DWORD dst_unused:UNUSED_PAD src0_sel:DWORD src1_sel:WORD_0
    v_lshlrev_b32_sdwa v102, 3, v119 dst_sel:DWORD dst_unused:UNUSED_PAD src0_sel:DWORD src1_sel:WORD_1
    ds_read_b64 v[100:101], v100
    ds_read_b64 v[102:103], v102
    buffer_load_dwordx4 v[116:119], v69, s[12:15], s41 offen offset:2048 sc1
    s_waitcnt lgkmcnt(8)
    v_smfmac_f32_16x16x64_bf16 v[44:47], v[64:67], v[104:111], v68
    v_exp_f32 v147, v147
    v_pk_fma_f32 v[144:145], v[26:27], v[142:143], v[144:145]
    v_pk_mul_f32 v[158:159], v[158:159], v[36:37]
    v_exp_f32 v148, v148
    v_add_f32 v144, v144, v145
    v_pk_fma_f32 v[146:147], v[146:147], v[134:135], v[134:135]
    v_exp_f32 v149, v149
    buffer_store_dword v144, v70, s[12:15], s35 offen offset:1536 sc1
    s_waitcnt vmcnt(4)
    v_lshlrev_b32_sdwa v104, 3, v120 dst_sel:DWORD dst_unused:UNUSED_PAD src0_sel:DWORD src1_sel:WORD_0
    v_lshlrev_b32_sdwa v106, 3, v120 dst_sel:DWORD dst_unused:UNUSED_PAD src0_sel:DWORD src1_sel:WORD_1
    ds_read_b64 v[104:105], v104
    ds_read_b64 v[106:107], v106
    v_lshlrev_b32_sdwa v108, 3, v121 dst_sel:DWORD dst_unused:UNUSED_PAD src0_sel:DWORD src1_sel:WORD_0
    v_lshlrev_b32_sdwa v110, 3, v121 dst_sel:DWORD dst_unused:UNUSED_PAD src0_sel:DWORD src1_sel:WORD_1
    ds_read_b64 v[108:109], v108
    ds_read_b64 v[110:111], v110
    s_waitcnt lgkmcnt(8)
    v_smfmac_f32_16x16x64_bf16 v[40:43], v[64:67], v[88:95], v68
    v_rcp_f32 v146, v146
    v_pk_fma_f32 v[148:149], v[148:149], v[136:137], v[136:137]
    v_pk_mul_f32 v[160:161], v[38:39], v[38:39]
    v_rcp_f32 v147, v147
    v_pk_fma_f32 v[160:161], v[160:161], v[128:129], v[130:131]
    v_rcp_f32 v148, v148
    v_pk_mul_f32 v[150:151], v[28:29], v[146:147]
    v_pk_mul_f32 v[160:161], v[160:161], v[38:39]
    v_lshlrev_b32_sdwa v88, 3, v122 dst_sel:DWORD dst_unused:UNUSED_PAD src0_sel:DWORD src1_sel:WORD_0
    v_lshlrev_b32_sdwa v90, 3, v122 dst_sel:DWORD dst_unused:UNUSED_PAD src0_sel:DWORD src1_sel:WORD_1
    ds_read_b64 v[88:89], v88
    ds_read_b64 v[90:91], v90
    v_lshlrev_b32_sdwa v92, 3, v123 dst_sel:DWORD dst_unused:UNUSED_PAD src0_sel:DWORD src1_sel:WORD_0
    v_lshlrev_b32_sdwa v94, 3, v123 dst_sel:DWORD dst_unused:UNUSED_PAD src0_sel:DWORD src1_sel:WORD_1
    ds_read_b64 v[92:93], v92
    ds_read_b64 v[94:95], v94
    buffer_load_dwordx4 v[120:123], v69, s[12:15], s45 offen offset:2048 sc1
    s_waitcnt lgkmcnt(8)
    v_smfmac_f32_16x16x64_bf16 v[44:47], v[64:67], v[96:103], v68
    v_rcp_f32 v149, v149
    v_exp_f32 v152, v152
    v_exp_f32 v153, v153
    v_pk_fma_f32 v[150:151], v[30:31], v[148:149], v[150:151]
    v_exp_f32 v154, v154
    v_add_f32 v150, v150, v151
    v_pk_fma_f32 v[152:153], v[152:153], v[134:135], v[134:135]
    v_exp_f32 v155, v155
    s_waitcnt vmcnt(3)
    v_lshlrev_b32_sdwa v96, 3, v124 dst_sel:DWORD dst_unused:UNUSED_PAD src0_sel:DWORD src1_sel:WORD_0
    v_lshlrev_b32_sdwa v98, 3, v124 dst_sel:DWORD dst_unused:UNUSED_PAD src0_sel:DWORD src1_sel:WORD_1
    ds_read_b64 v[96:97], v96
    ds_read_b64 v[98:99], v98
    v_lshlrev_b32_sdwa v100, 3, v125 dst_sel:DWORD dst_unused:UNUSED_PAD src0_sel:DWORD src1_sel:WORD_0
    v_lshlrev_b32_sdwa v102, 3, v125 dst_sel:DWORD dst_unused:UNUSED_PAD src0_sel:DWORD src1_sel:WORD_1
    ds_read_b64 v[100:101], v100
    ds_read_b64 v[102:103], v102
    s_waitcnt lgkmcnt(8)
    v_smfmac_f32_16x16x64_bf16 v[40:43], v[64:67], v[104:111], v68
    v_rcp_f32 v152, v152
    buffer_store_dword v150, v70, s[12:15], s35 offen offset:1664 sc1
    v_pk_fma_f32 v[154:155], v[154:155], v[136:137], v[136:137]
    v_rcp_f32 v153, v153
    v_rcp_f32 v154, v154
    v_rcp_f32 v155, v155
    v_pk_mul_f32 v[156:157], v[32:33], v[152:153]
    v_exp_f32 v158, v158
    v_lshlrev_b32_sdwa v104, 3, v126 dst_sel:DWORD dst_unused:UNUSED_PAD src0_sel:DWORD src1_sel:WORD_0
    v_lshlrev_b32_sdwa v106, 3, v126 dst_sel:DWORD dst_unused:UNUSED_PAD src0_sel:DWORD src1_sel:WORD_1
    ds_read_b64 v[104:105], v104
    ds_read_b64 v[106:107], v106
    v_lshlrev_b32_sdwa v108, 3, v127 dst_sel:DWORD dst_unused:UNUSED_PAD src0_sel:DWORD src1_sel:WORD_0
    v_lshlrev_b32_sdwa v110, 3, v127 dst_sel:DWORD dst_unused:UNUSED_PAD src0_sel:DWORD src1_sel:WORD_1
    ds_read_b64 v[108:109], v108
    ds_read_b64 v[110:111], v110
    buffer_load_dwordx4 v[124:127], v69, s[12:15], s20 offen offset:3072 sc1
    s_waitcnt lgkmcnt(8)
    v_smfmac_f32_16x16x64_bf16 v[44:47], v[64:67], v[88:95], v68
    v_exp_f32 v159, v159
    v_pk_fma_f32 v[156:157], v[34:35], v[154:155], v[156:157]
    v_pk_mul_f32 v[164:165], v[40:41], v[40:41]
    v_exp_f32 v160, v160
    v_add_f32 v156, v156, v157
    v_pk_fma_f32 v[158:159], v[158:159], v[134:135], v[134:135]
    v_exp_f32 v161, v161
    buffer_store_dword v156, v70, s[12:15], s35 offen offset:2048 sc1
    s_waitcnt vmcnt(5)
    v_lshlrev_b32_sdwa v88, 3, v116 dst_sel:DWORD dst_unused:UNUSED_PAD src0_sel:DWORD src1_sel:WORD_0
    v_lshlrev_b32_sdwa v90, 3, v116 dst_sel:DWORD dst_unused:UNUSED_PAD src0_sel:DWORD src1_sel:WORD_1
    ds_read_b64 v[88:89], v88
    ds_read_b64 v[90:91], v90
    v_lshlrev_b32_sdwa v92, 3, v117 dst_sel:DWORD dst_unused:UNUSED_PAD src0_sel:DWORD src1_sel:WORD_0
    v_lshlrev_b32_sdwa v94, 3, v117 dst_sel:DWORD dst_unused:UNUSED_PAD src0_sel:DWORD src1_sel:WORD_1
    ds_read_b64 v[92:93], v92
    ds_read_b64 v[94:95], v94
    s_waitcnt lgkmcnt(8)
    v_smfmac_f32_16x16x64_bf16 v[48:51], v[64:67], v[96:103], v68
    v_rcp_f32 v158, v158
    v_pk_fma_f32 v[160:161], v[160:161], v[136:137], v[136:137]
    v_pk_fma_f32 v[164:165], v[164:165], v[128:129], v[130:131]
    v_rcp_f32 v159, v159
    v_pk_mul_f32 v[164:165], v[164:165], v[40:41]
    v_pk_mul_f32 v[166:167], v[42:43], v[42:43]
    v_rcp_f32 v160, v160
    v_pk_mul_f32 v[162:163], v[36:37], v[158:159]
    v_lshlrev_b32_sdwa v96, 3, v118 dst_sel:DWORD dst_unused:UNUSED_PAD src0_sel:DWORD src1_sel:WORD_0
    v_lshlrev_b32_sdwa v98, 3, v118 dst_sel:DWORD dst_unused:UNUSED_PAD src0_sel:DWORD src1_sel:WORD_1
    ds_read_b64 v[96:97], v96
    ds_read_b64 v[98:99], v98
    v_lshlrev_b32_sdwa v100, 3, v119 dst_sel:DWORD dst_unused:UNUSED_PAD src0_sel:DWORD src1_sel:WORD_0
    v_lshlrev_b32_sdwa v102, 3, v119 dst_sel:DWORD dst_unused:UNUSED_PAD src0_sel:DWORD src1_sel:WORD_1
    ds_read_b64 v[100:101], v100
    ds_read_b64 v[102:103], v102
    buffer_load_dwordx4 v[116:119], v69, s[12:15], s41 offen offset:3072 sc1
    s_waitcnt lgkmcnt(8)
    v_smfmac_f32_16x16x64_bf16 v[52:55], v[64:67], v[104:111], v68
    s_setprio 1
    v_rcp_f32 v161, v161
    v_pk_fma_f32 v[166:167], v[166:167], v[128:129], v[130:131]
    v_pk_mul_f32 v[170:171], v[44:45], v[44:45]
    v_exp_f32 v164, v164
    v_pk_fma_f32 v[162:163], v[38:39], v[160:161], v[162:163]
    v_pk_mul_f32 v[166:167], v[166:167], v[42:43]
    v_exp_f32 v165, v165
    v_add_f32 v162, v162, v163
    s_waitcnt vmcnt(4)
    v_lshlrev_b32_sdwa v104, 3, v120 dst_sel:DWORD dst_unused:UNUSED_PAD src0_sel:DWORD src1_sel:WORD_0
    v_lshlrev_b32_sdwa v106, 3, v120 dst_sel:DWORD dst_unused:UNUSED_PAD src0_sel:DWORD src1_sel:WORD_1
    ds_read_b64 v[104:105], v104
    ds_read_b64 v[106:107], v106
    v_lshlrev_b32_sdwa v108, 3, v121 dst_sel:DWORD dst_unused:UNUSED_PAD src0_sel:DWORD src1_sel:WORD_0
    v_lshlrev_b32_sdwa v110, 3, v121 dst_sel:DWORD dst_unused:UNUSED_PAD src0_sel:DWORD src1_sel:WORD_1
    ds_read_b64 v[108:109], v108
    ds_read_b64 v[110:111], v110
    s_waitcnt lgkmcnt(8)
    v_smfmac_f32_16x16x64_bf16 v[48:51], v[64:67], v[88:95], v68
    v_exp_f32 v166, v166
    buffer_store_dword v162, v70, s[12:15], s35 offen offset:2176 sc1
    v_pk_fma_f32 v[164:165], v[164:165], v[134:135], v[134:135]
    v_exp_f32 v167, v167
    v_pk_fma_f32 v[170:171], v[170:171], v[128:129], v[130:131]
    v_pk_mul_f32 v[172:173], v[46:47], v[46:47]
    v_rcp_f32 v164, v164
    v_pk_fma_f32 v[166:167], v[166:167], v[136:137], v[136:137]
    v_lshlrev_b32_sdwa v88, 3, v122 dst_sel:DWORD dst_unused:UNUSED_PAD src0_sel:DWORD src1_sel:WORD_0
    v_lshlrev_b32_sdwa v90, 3, v122 dst_sel:DWORD dst_unused:UNUSED_PAD src0_sel:DWORD src1_sel:WORD_1
    ds_read_b64 v[88:89], v88
    ds_read_b64 v[90:91], v90
    v_lshlrev_b32_sdwa v92, 3, v123 dst_sel:DWORD dst_unused:UNUSED_PAD src0_sel:DWORD src1_sel:WORD_0
    v_lshlrev_b32_sdwa v94, 3, v123 dst_sel:DWORD dst_unused:UNUSED_PAD src0_sel:DWORD src1_sel:WORD_1
    ds_read_b64 v[92:93], v92
    ds_read_b64 v[94:95], v94
    buffer_load_dwordx4 v[120:123], v69, s[12:15], s45 offen offset:3072 sc1
    s_waitcnt lgkmcnt(8)
    v_smfmac_f32_16x16x64_bf16 v[52:55], v[64:67], v[96:103], v68
    v_rcp_f32 v165, v165
    v_pk_mul_f32 v[170:171], v[170:171], v[44:45]
    v_pk_fma_f32 v[172:173], v[172:173], v[128:129], v[130:131]
    v_rcp_f32 v166, v166
    v_pk_mul_f32 v[168:169], v[40:41], v[164:165]
    v_pk_mul_f32 v[172:173], v[172:173], v[46:47]
    v_rcp_f32 v167, v167
    v_exp_f32 v170, v170
    s_waitcnt vmcnt(4)
    v_lshlrev_b32_sdwa v96, 3, v124 dst_sel:DWORD dst_unused:UNUSED_PAD src0_sel:DWORD src1_sel:WORD_0
    v_lshlrev_b32_sdwa v98, 3, v124 dst_sel:DWORD dst_unused:UNUSED_PAD src0_sel:DWORD src1_sel:WORD_1
    ds_read_b64 v[96:97], v96
    ds_read_b64 v[98:99], v98
    v_lshlrev_b32_sdwa v100, 3, v125 dst_sel:DWORD dst_unused:UNUSED_PAD src0_sel:DWORD src1_sel:WORD_0
    v_lshlrev_b32_sdwa v102, 3, v125 dst_sel:DWORD dst_unused:UNUSED_PAD src0_sel:DWORD src1_sel:WORD_1
    ds_read_b64 v[100:101], v100
    ds_read_b64 v[102:103], v102
    s_waitcnt lgkmcnt(8)
    v_smfmac_f32_16x16x64_bf16 v[48:51], v[64:67], v[104:111], v68
    v_exp_f32 v171, v171
    v_pk_fma_f32 v[168:169], v[42:43], v[166:167], v[168:169]
    v_exp_f32 v172, v172
    v_add_f32 v168, v168, v169
    v_pk_fma_f32 v[170:171], v[170:171], v[134:135], v[134:135]
    v_exp_f32 v173, v173
    buffer_store_dword v168, v70, s[12:15], s35 offen offset:2560 sc1
    v_rcp_f32 v170, v170
    v_lshlrev_b32_sdwa v104, 3, v126 dst_sel:DWORD dst_unused:UNUSED_PAD src0_sel:DWORD src1_sel:WORD_0
    v_lshlrev_b32_sdwa v106, 3, v126 dst_sel:DWORD dst_unused:UNUSED_PAD src0_sel:DWORD src1_sel:WORD_1
    ds_read_b64 v[104:105], v104
    ds_read_b64 v[106:107], v106
    v_lshlrev_b32_sdwa v108, 3, v127 dst_sel:DWORD dst_unused:UNUSED_PAD src0_sel:DWORD src1_sel:WORD_0
    v_lshlrev_b32_sdwa v110, 3, v127 dst_sel:DWORD dst_unused:UNUSED_PAD src0_sel:DWORD src1_sel:WORD_1
    ds_read_b64 v[108:109], v108
    ds_read_b64 v[110:111], v110
    s_waitcnt lgkmcnt(8)
    v_smfmac_f32_16x16x64_bf16 v[52:55], v[64:67], v[88:95], v68
    v_rcp_f32 v171, v171
    v_pk_fma_f32 v[172:173], v[172:173], v[136:137], v[136:137]
    v_pk_mul_f32 v[140:141], v[48:49], v[48:49]
    v_rcp_f32 v172, v172
    v_pk_mul_f32 v[174:175], v[44:45], v[170:171]
    v_pk_fma_f32 v[140:141], v[140:141], v[128:129], v[130:131]
    v_rcp_f32 v173, v173
    v_pk_mul_f32 v[140:141], v[140:141], v[48:49]
    s_waitcnt vmcnt(3)
    v_lshlrev_b32_sdwa v88, 3, v116 dst_sel:DWORD dst_unused:UNUSED_PAD src0_sel:DWORD src1_sel:WORD_0
    v_lshlrev_b32_sdwa v90, 3, v116 dst_sel:DWORD dst_unused:UNUSED_PAD src0_sel:DWORD src1_sel:WORD_1
    ds_read_b64 v[88:89], v88
    ds_read_b64 v[90:91], v90
    v_lshlrev_b32_sdwa v92, 3, v117 dst_sel:DWORD dst_unused:UNUSED_PAD src0_sel:DWORD src1_sel:WORD_0
    v_lshlrev_b32_sdwa v94, 3, v117 dst_sel:DWORD dst_unused:UNUSED_PAD src0_sel:DWORD src1_sel:WORD_1
    ds_read_b64 v[92:93], v92
    ds_read_b64 v[94:95], v94
    s_waitcnt lgkmcnt(8)
    v_smfmac_f32_16x16x64_bf16 v[56:59], v[64:67], v[96:103], v68
    v_exp_f32 v140, v140
    v_pk_fma_f32 v[174:175], v[46:47], v[172:173], v[174:175]
    v_pk_mul_f32 v[142:143], v[50:51], v[50:51]
    v_exp_f32 v141, v141
    v_add_f32 v174, v174, v175
    v_pk_fma_f32 v[142:143], v[142:143], v[128:129], v[130:131]
    buffer_store_dword v174, v70, s[12:15], s35 offen offset:2688 sc1
    v_pk_fma_f32 v[140:141], v[140:141], v[134:135], v[134:135]
    v_lshlrev_b32_sdwa v96, 3, v118 dst_sel:DWORD dst_unused:UNUSED_PAD src0_sel:DWORD src1_sel:WORD_0
    v_lshlrev_b32_sdwa v98, 3, v118 dst_sel:DWORD dst_unused:UNUSED_PAD src0_sel:DWORD src1_sel:WORD_1
    ds_read_b64 v[96:97], v96
    ds_read_b64 v[98:99], v98
    v_lshlrev_b32_sdwa v100, 3, v119 dst_sel:DWORD dst_unused:UNUSED_PAD src0_sel:DWORD src1_sel:WORD_0
    v_lshlrev_b32_sdwa v102, 3, v119 dst_sel:DWORD dst_unused:UNUSED_PAD src0_sel:DWORD src1_sel:WORD_1
    ds_read_b64 v[100:101], v100
    ds_read_b64 v[102:103], v102
    s_waitcnt lgkmcnt(8)
    v_smfmac_f32_16x16x64_bf16 v[60:63], v[64:67], v[104:111], v68
    v_rcp_f32 v140, v140
    v_pk_mul_f32 v[142:143], v[142:143], v[50:51]
    v_pk_mul_f32 v[146:147], v[52:53], v[52:53]
    v_rcp_f32 v141, v141
    v_pk_fma_f32 v[146:147], v[146:147], v[128:129], v[130:131]
    v_pk_mul_f32 v[148:149], v[54:55], v[54:55]
    v_exp_f32 v142, v142
    v_pk_mul_f32 v[144:145], v[48:49], v[140:141]
    s_waitcnt vmcnt(2)
    v_lshlrev_b32_sdwa v104, 3, v120 dst_sel:DWORD dst_unused:UNUSED_PAD src0_sel:DWORD src1_sel:WORD_0
    v_lshlrev_b32_sdwa v106, 3, v120 dst_sel:DWORD dst_unused:UNUSED_PAD src0_sel:DWORD src1_sel:WORD_1
    ds_read_b64 v[104:105], v104
    ds_read_b64 v[106:107], v106
    v_lshlrev_b32_sdwa v108, 3, v121 dst_sel:DWORD dst_unused:UNUSED_PAD src0_sel:DWORD src1_sel:WORD_0
    v_lshlrev_b32_sdwa v110, 3, v121 dst_sel:DWORD dst_unused:UNUSED_PAD src0_sel:DWORD src1_sel:WORD_1
    ds_read_b64 v[108:109], v108
    ds_read_b64 v[110:111], v110
    s_waitcnt lgkmcnt(8)
    v_smfmac_f32_16x16x64_bf16 v[56:59], v[64:67], v[88:95], v68
    v_exp_f32 v143, v143
    v_pk_mul_f32 v[146:147], v[146:147], v[52:53]
    v_pk_fma_f32 v[148:149], v[148:149], v[128:129], v[130:131]
    v_exp_f32 v146, v146
    v_pk_fma_f32 v[142:143], v[142:143], v[136:137], v[136:137]
    v_pk_mul_f32 v[148:149], v[148:149], v[54:55]
    v_rcp_f32 v142, v142
    v_rcp_f32 v143, v143
    v_lshlrev_b32_sdwa v88, 3, v122 dst_sel:DWORD dst_unused:UNUSED_PAD src0_sel:DWORD src1_sel:WORD_0
    v_lshlrev_b32_sdwa v90, 3, v122 dst_sel:DWORD dst_unused:UNUSED_PAD src0_sel:DWORD src1_sel:WORD_1
    ds_read_b64 v[88:89], v88
    ds_read_b64 v[90:91], v90
    v_lshlrev_b32_sdwa v92, 3, v123 dst_sel:DWORD dst_unused:UNUSED_PAD src0_sel:DWORD src1_sel:WORD_0
    v_lshlrev_b32_sdwa v94, 3, v123 dst_sel:DWORD dst_unused:UNUSED_PAD src0_sel:DWORD src1_sel:WORD_1
    ds_read_b64 v[92:93], v92
    ds_read_b64 v[94:95], v94
    s_waitcnt lgkmcnt(8)
    v_smfmac_f32_16x16x64_bf16 v[60:63], v[64:67], v[96:103], v68
    s_setprio 0
    v_exp_f32 v147, v147
    v_pk_fma_f32 v[144:145], v[50:51], v[142:143], v[144:145]
    v_exp_f32 v148, v148
    v_add_f32 v144, v144, v145
    v_pk_fma_f32 v[146:147], v[146:147], v[134:135], v[134:135]
    v_exp_f32 v149, v149
    buffer_store_dword v144, v70, s[12:15], s35 offen offset:3072 sc1
    v_rcp_f32 v146, v146
    s_waitcnt lgkmcnt(4)
    v_smfmac_f32_16x16x64_bf16 v[56:59], v[64:67], v[104:111], v68
    v_rcp_f32 v147, v147
    v_pk_fma_f32 v[148:149], v[148:149], v[136:137], v[136:137]
    s_waitcnt lgkmcnt(0)
    v_smfmac_f32_16x16x64_bf16 v[60:63], v[64:67], v[88:95], v68
    v_rcp_f32 v148, v148
    v_pk_mul_f32 v[150:151], v[52:53], v[146:147]
    v_rcp_f32 v149, v149
    s_nop 0
    s_nop 0
    v_pk_fma_f32 v[150:151], v[54:55], v[148:149], v[150:151]
    s_nop 0
    v_add_f32 v150, v150, v151
    v_pk_mul_f32 v[152:153], v[56:57], v[56:57]
    buffer_store_dword v150, v70, s[12:15], s35 offen offset:3200 sc1
    v_pk_fma_f32 v[152:153], v[152:153], v[128:129], v[130:131]
    v_pk_mul_f32 v[154:155], v[58:59], v[58:59]
    v_pk_mul_f32 v[152:153], v[152:153], v[56:57]
    v_pk_fma_f32 v[154:155], v[154:155], v[128:129], v[130:131]
    v_exp_f32 v152, v152
    v_pk_mul_f32 v[154:155], v[154:155], v[58:59]
    v_pk_mul_f32 v[158:159], v[60:61], v[60:61]
    v_exp_f32 v153, v153
    v_pk_fma_f32 v[158:159], v[158:159], v[128:129], v[130:131]
    v_pk_mul_f32 v[160:161], v[62:63], v[62:63]
    v_exp_f32 v154, v154
    v_pk_fma_f32 v[152:153], v[152:153], v[134:135], v[134:135]
    v_pk_mul_f32 v[158:159], v[158:159], v[60:61]
    v_rcp_f32 v152, v152
    v_pk_fma_f32 v[160:161], v[160:161], v[128:129], v[130:131]
    v_rcp_f32 v153, v153
    v_pk_mul_f32 v[160:161], v[160:161], v[62:63]
    v_exp_f32 v155, v155
    v_pk_mul_f32 v[156:157], v[56:57], v[152:153]
    v_exp_f32 v158, v158
    v_pk_fma_f32 v[154:155], v[154:155], v[136:137], v[136:137]
    v_exp_f32 v159, v159
    v_rcp_f32 v154, v154
    v_rcp_f32 v155, v155
    v_pk_fma_f32 v[158:159], v[158:159], v[134:135], v[134:135]
    v_exp_f32 v160, v160
    v_pk_fma_f32 v[156:157], v[58:59], v[154:155], v[156:157]
    v_rcp_f32 v158, v158
    v_add_f32 v156, v156, v157
    v_rcp_f32 v159, v159
    buffer_store_dword v156, v70, s[12:15], s35 offen offset:3584 sc1
    v_exp_f32 v161, v161
    v_pk_mul_f32 v[162:163], v[60:61], v[158:159]
    s_nop 0
    v_pk_fma_f32 v[160:161], v[160:161], v[136:137], v[136:137]
    s_nop 0
    v_rcp_f32 v160, v160
    v_rcp_f32 v161, v161
    s_nop 0
    s_nop 0
    v_pk_fma_f32 v[162:163], v[62:63], v[160:161], v[162:163]
    s_nop 0
    v_add_f32 v162, v162, v163
    s_nop 0
    buffer_store_dword v162, v70, s[12:15], s35 offen offset:3712 sc1

    v_and_b32 v193, 0xf0, v69
    v_lshrrev_b32 v197, 8, v69
    v_lshl_or_b32 v192, v197, 16, v193
    v_lshrrev_b32 v198, 1, v197
    v_and_b32 v197, 1, v197
    v_lshl_or_b32 v193, v198, 2, v193
    v_lshl_or_b32 v193, v197, 3, v193
    v_mov_b32 v196, 0
    s_mov_b32 s65, 0

    s_lshl_b32 s68, s2, 8
    s_add_u32 s66, s68, 29360128
    s_add_u32 s67, s66, 65536
    s_add_u32 s60, s68, 20971520
    s_lshr_b32 s68, s68, 1

    s_lshl_b32 s61, s3, 20
    s_add_u32 s60, s60, s61

    s_add_u32 s61, s60, 262144
    s_add_u32 s62, s60, 524288
    s_add_u32 s63, s60, 786432

    s_mov_b32 s76, s56
    s_and_b32 s77, s57, 0xffff
    s_mov_b32 s78, 2
    s_mov_b32 s79, 0x00020000
    s_mov_b32 s72, s58
    s_and_b32 s73, s59, 0xffff
    s_mov_b32 s74, 32768
    s_mov_b32 s75, 0x00020000
    s_mov_b64 s[20:21], -1
    s_mov_b64 s[22:23], -1
    s_mov_b64 s[24:25], -1
    s_mov_b64 s[26:27], -1
    s_mov_b64 s[28:29], -1

    v_mov_b32 v216, -1
    buffer_load_short_d16_hi v196, v196, s[76:79], 0 offen
    s_bitcmp1_b32 s64, 30
    s_cbranch_scc0 standalone__deep_cross_pnn__recsys_kernel_rd

standalone__deep_cross_pnn__recsys_kernel_rp:
    s_mov_b64 exec, s[20:21]
    buffer_load_dwordx4 v[176:179], v192, s[12:15], s60 offen sc1
    s_mov_b64 exec, s[22:23]
    buffer_load_dwordx4 v[180:183], v192, s[12:15], s61 offen sc1
    s_mov_b64 exec, s[24:25]
    buffer_load_dwordx4 v[184:187], v192, s[12:15], s62 offen sc1
    s_mov_b64 exec, s[26:27]
    buffer_load_dwordx4 v[188:191], v192, s[12:15], s63 offen sc1
    s_mov_b64 exec, s[28:29]
    buffer_load_dword v194, v193, s[12:15], s66 offen sc1
    buffer_load_dword v195, v193, s[12:15], s67 offen sc1
    s_mov_b64 exec, -1
    s_waitcnt vmcnt(4)
    v_add_f32 v216, v176, v180
    v_add_f32 v217, v177, v181
    v_add_f32 v218, v178, v182
    v_add_f32 v219, v179, v183
    s_waitcnt vmcnt(2)
    v_add_f32 v220, v184, v188
    v_add_f32 v221, v185, v189
    v_add_f32 v222, v186, v190
    v_add_f32 v223, v187, v191
    v_add_f32 v216, v216, v220
    v_add_f32 v217, v217, v221
    v_add_f32 v218, v218, v222
    v_add_f32 v219, v219, v223

    s_nop 0
    v_permlane32_swap_b32 v216, v217
    v_permlane32_swap_b32 v218, v219
    v_add_f32 v216, v216, v217
    v_add_f32 v218, v218, v219
    s_nop 1
    v_permlane16_swap_b32 v216, v218
    s_nop 0
    v_add_f32 v216, v216, v218

    s_waitcnt vmcnt(0)
    v_add_f32 v201, v194, v195
    s_add_u32 s65, s65, 1
    v_add_f32 v197, v201, v216
    v_cmp_u_f32 vcc, v197, v197
    s_cbranch_vccz standalone__deep_cross_pnn__recsys_kernel_rd

    v_cmp_u_f32 s[20:21], v176, v177
    v_cmp_u_f32 vcc, v178, v179
    s_or_b64 s[20:21], s[20:21], vcc

    v_cmp_u_f32 s[22:23], v180, v181
    v_cmp_u_f32 vcc, v182, v183
    s_or_b64 s[22:23], s[22:23], vcc

    v_cmp_u_f32 s[24:25], v184, v185
    v_cmp_u_f32 vcc, v186, v187
    s_or_b64 s[24:25], s[24:25], vcc

    v_cmp_u_f32 s[26:27], v188, v189
    v_cmp_u_f32 vcc, v190, v191
    s_or_b64 s[26:27], s[26:27], vcc

    v_cmp_u_f32 s[28:29], v194, v195

    s_cmp_lt_u32 s65, 300
    s_cbranch_scc1 standalone__deep_cross_pnn__recsys_kernel_rp
    v_mov_b32 v216, -1

standalone__deep_cross_pnn__recsys_kernel_rd:

    v_lshrrev_b32 v197, 2, v69
    s_lshl_b32 s69, s3, 8
    v_add_u32 v198, s69, v197
    ds_write_b32 v198, v216
    v_mov_b32 v199, 0
    s_waitcnt vmcnt(0) lgkmcnt(0)

    s_barrier
    s_cmp_eq_u32 s3, 1
    s_cbranch_scc1 standalone__deep_cross_pnn__recsys_kernel_rc
    s_cmp_lg_u32 s3, 0
    s_cbranch_scc1 standalone__deep_cross_pnn__recsys_kernel_end

    ds_read_b32 v208, v197 offset:0
    ds_read_b32 v209, v197 offset:256
    ds_read_b32 v210, v197 offset:512
    ds_read_b32 v211, v197 offset:768
    ds_read_b32 v212, v197 offset:1024
    ds_read_b32 v213, v197 offset:1280
    ds_read_b32 v214, v197 offset:1536
    ds_read_b32 v215, v197 offset:1792
    s_waitcnt lgkmcnt(6)
    v_add_f32 v200, v208, v209
    s_waitcnt lgkmcnt(5)
    v_add_f32 v200, v200, v210
    s_waitcnt lgkmcnt(4)
    v_add_f32 v200, v200, v211
    s_waitcnt lgkmcnt(3)
    v_add_f32 v200, v200, v212
    s_waitcnt lgkmcnt(2)
    v_add_f32 v200, v200, v213
    s_waitcnt lgkmcnt(1)
    v_add_f32 v200, v200, v214
    s_waitcnt lgkmcnt(0)
    v_add_f32 v200, v200, v215

    v_cmp_u_f32 vcc, v200, v200
    s_cbranch_vccnz standalone__deep_cross_pnn__recsys_kernel_rf

    v_cvt_pk_bf16_f32 v197, v200, v201
    v_lshlrev_b32 v198, 16, v197
    v_and_b32 v197, 0xffff0000, v197
    v_add_f32 v198, v198, v196
    v_cvt_pk_bf16_f32 v198, v198, v198
    v_lshlrev_b32 v198, 16, v198
    v_add_f32 v198, v198, v197
    v_cvt_pk_bf16_f32 v198, v198, v198
    v_lshrrev_b32 v197, 1, v193
    buffer_store_short v198, v197, s[72:75], s68 offen

    s_endpgm
standalone__deep_cross_pnn__recsys_kernel_rf:

    s_lshr_b32 s69, s2, 5
    s_lshl_b32 s69, s69, 4
    s_lshl_b32 s70, 1, s2
    v_mov_b32 v198, s70
    s_mov_b64 exec, 1
    buffer_atomic_or v198, v199, s[52:55], s69 offen offset:136 sc0
    s_waitcnt vmcnt(0)

standalone__deep_cross_pnn__recsys_kernel_rc:

    s_mov_b64 exec, 0xff
    buffer_load_dwordx4 v[176:179], v69, s[52:55], 0 offen offset:128 sc1
    s_waitcnt vmcnt(0)
    v_cmp_ne_u32 vcc, 0, v178
    s_cbranch_vccz standalone__deep_cross_pnn__recsys_kernel_end
    v_cmp_ne_u32 vcc, -1, v176
    s_cbranch_vccnz standalone__deep_cross_pnn__recsys_kernel_end
    v_mov_b32 v199, v178
    s_mov_b64 exec, -1
    v_lshlrev_b32 v198, 3, v69
    s_mov_b32 s69, 14680064
    buffer_load_dwordx4 v[176:179], v198, s[12:15], s69 offen sc1
    s_waitcnt vmcnt(0)
    v_min3_u32 v198, v176, v177, v178
    v_min_u32 v198, v198, v179
    v_cmp_eq_u32 vcc, 0, v198
    s_cbranch_vccnz standalone__deep_cross_pnn__recsys_kernel_end

standalone__deep_cross_pnn__recsys_kernel_rn:

    v_cmp_ne_u32 vcc, 0, v199
    s_cbranch_vccz standalone__deep_cross_pnn__recsys_kernel_end
    s_ff1_i32_b64 s69, vcc
    s_mov_b32 m0, s69
    s_nop 3
    v_readlane_b32 s70, v199, s69
    s_ff1_i32_b32 s71, s70
    s_bitset0_b32 s70, s71
    s_nop 3
    v_writelane_b32 v199, s70, m0
    s_lshl_b32 s69, s69, 5
    s_add_u32 s69, s69, s71

    s_lshl_b32 s68, s69, 8
    s_add_u32 s66, s68, 29360128
    s_add_u32 s67, s66, 65536
    s_add_u32 s60, s68, 20971520
    s_lshr_b32 s68, s68, 1

    s_add_u32 s61, s60, 262144
    s_add_u32 s62, s60, 524288
    s_add_u32 s63, s60, 786432

    buffer_load_dword v194, v193, s[12:15], s66 offen sc1
    buffer_load_dword v195, v193, s[12:15], s67 offen sc1
    s_mov_b32 s65, 0
standalone__deep_cross_pnn__recsys_kernel_rw:
    buffer_load_dwordx4 v[176:179], v192, s[12:15], s60 offen sc1
    buffer_load_dwordx4 v[180:183], v192, s[12:15], s61 offen sc1
    buffer_load_dwordx4 v[184:187], v192, s[12:15], s62 offen sc1
    buffer_load_dwordx4 v[188:191], v192, s[12:15], s63 offen sc1
    s_waitcnt vmcnt(2)
    v_add_f32 v216, v176, v180
    v_add_f32 v217, v177, v181
    v_add_f32 v218, v178, v182
    v_add_f32 v219, v179, v183
    s_waitcnt vmcnt(0)
    v_add_f32 v220, v184, v188
    v_add_f32 v221, v185, v189
    v_add_f32 v222, v186, v190
    v_add_f32 v223, v187, v191
    v_add_f32 v216, v216, v220
    v_add_f32 v217, v217, v221
    v_add_f32 v218, v218, v222
    v_add_f32 v219, v219, v223

    s_nop 0
    v_permlane32_swap_b32 v216, v217
    v_permlane32_swap_b32 v218, v219
    v_add_f32 v216, v216, v217
    v_add_f32 v218, v218, v219
    s_nop 1
    v_permlane16_swap_b32 v216, v218
    s_nop 0
    v_add_f32 v216, v216, v218

    s_mov_b32 s70, 0xff800001
    s_mov_b64 s[20:21], 0
    v_cmp_eq_u32 vcc, s70, v194
    s_or_b64 s[20:21], s[20:21], vcc
    v_cmp_eq_u32 vcc, s70, v195
    s_or_b64 s[20:21], s[20:21], vcc
    v_cmp_eq_u32 vcc, s70, v176
    s_or_b64 s[20:21], s[20:21], vcc
    v_cmp_eq_u32 vcc, s70, v177
    s_or_b64 s[20:21], s[20:21], vcc
    v_cmp_eq_u32 vcc, s70, v178
    s_or_b64 s[20:21], s[20:21], vcc
    v_cmp_eq_u32 vcc, s70, v179
    s_or_b64 s[20:21], s[20:21], vcc
    v_cmp_eq_u32 vcc, s70, v180
    s_or_b64 s[20:21], s[20:21], vcc
    v_cmp_eq_u32 vcc, s70, v181
    s_or_b64 s[20:21], s[20:21], vcc
    v_cmp_eq_u32 vcc, s70, v182
    s_or_b64 s[20:21], s[20:21], vcc
    v_cmp_eq_u32 vcc, s70, v183
    s_or_b64 s[20:21], s[20:21], vcc
    v_cmp_eq_u32 vcc, s70, v184
    s_or_b64 s[20:21], s[20:21], vcc
    v_cmp_eq_u32 vcc, s70, v185
    s_or_b64 s[20:21], s[20:21], vcc
    v_cmp_eq_u32 vcc, s70, v186
    s_or_b64 s[20:21], s[20:21], vcc
    v_cmp_eq_u32 vcc, s70, v187
    s_or_b64 s[20:21], s[20:21], vcc
    v_cmp_eq_u32 vcc, s70, v188
    s_or_b64 s[20:21], s[20:21], vcc
    v_cmp_eq_u32 vcc, s70, v189
    s_or_b64 s[20:21], s[20:21], vcc
    v_cmp_eq_u32 vcc, s70, v190
    s_or_b64 s[20:21], s[20:21], vcc
    v_cmp_eq_u32 vcc, s70, v191
    s_or_b64 s[20:21], s[20:21], vcc

    s_cbranch_scc1 standalone__deep_cross_pnn__recsys_kernel_end
    s_cmp_eq_u32 s65, 0
    s_cselect_b64 vcc, -1, 0
    v_add_f32 v200, v200, v216
    v_cndmask_b32 v200, v200, v216, vcc
    s_add_u32 s60, s60, 1048576
    s_add_u32 s61, s61, 1048576
    s_add_u32 s62, s62, 1048576
    s_add_u32 s63, s63, 1048576
    s_add_u32 s65, s65, 1
    s_cmp_lt_u32 s65, 8
    s_cbranch_scc1 standalone__deep_cross_pnn__recsys_kernel_rw
    v_add_f32 v201, v194, v195

    v_cvt_pk_bf16_f32 v197, v200, v201
    v_lshlrev_b32 v198, 16, v197
    v_and_b32 v197, 0xffff0000, v197
    v_add_f32 v198, v198, v196
    v_cvt_pk_bf16_f32 v198, v198, v198
    v_lshlrev_b32 v198, 16, v198
    v_add_f32 v198, v198, v197
    v_cvt_pk_bf16_f32 v198, v198, v198
    v_lshrrev_b32 v197, 1, v193
    buffer_store_short v198, v197, s[72:75], s68 offen

    s_nop 1
    s_branch standalone__deep_cross_pnn__recsys_kernel_rn
standalone__deep_cross_pnn__recsys_kernel_end:
    s_endpgm
.section .rodata,"a"
.p2align 6
.amdhsa_kernel standalone__deep_cross_pnn__recsys_kernel
  .amdhsa_next_free_vgpr 256
  .amdhsa_next_free_sgpr 102
  .amdhsa_accum_offset 256
  .amdhsa_group_segment_fixed_size 0
  .amdhsa_kernarg_size 80
  .amdhsa_user_sgpr_count 2
  .amdhsa_user_sgpr_kernarg_segment_ptr 1
  .amdhsa_system_sgpr_workgroup_id_x 1
.end_amdhsa_kernel
```

```asm
; @launch grid=(256,1,1) block=(512,1,1) lds=163840
.amdgcn_target "amdgcn-amd-amdhsa--gfx950"
.text
.globl standalone__deep_cross_pnn__recsys_kernel
.p2align 8
.type standalone__deep_cross_pnn__recsys_kernel,@function
standalone__deep_cross_pnn__recsys_kernel:

    s_cmp_ge_u32 s2, 256
    s_cbranch_scc1 standalone__deep_cross_pnn__recsys_kernel_end
    s_load_dwordx8 s[4:11], s[0:1], 0
    s_load_dwordx2 s[12:13], s[0:1], 72
    s_load_dwordx2 s[52:53], s[0:1], 64
    s_load_dwordx4 s[60:63], s[0:1], 32
    v_lshrrev_b32 v1, 6, v0
    v_and_b32 v255, 63, v0
    s_bfe_u32 s36, s2, 0x10003
    v_readfirstlane_b32 s3, v1
    s_lshr_b32 s37, s2, 4
    s_lshl_b32 s37, s37, 3
    s_and_b32 s38, s2, 7
    s_or_b32 s37, s37, s38
    v_lshlrev_b32 v254, 4, v255
    v_mov_b32 v252, 163712
    v_mov_b32 v253, 1
    v_mov_b32 v40, 0
    v_cmp_gt_u32 vcc, 8, v0
    v_lshl_add_u32 v41, v0, 2, v252
    s_and_saveexec_b64 s[46:47], vcc
    ds_write_b32 v41, v40
    s_mov_b64 exec, s[46:47]
    v_mul_u32_u24 v6, 57, v255
    v_lshrrev_b32 v6, 9, v6
    v_mul_u32_u24 v5, 9, v6
    v_sub_u32 v5, v255, v5
    v_cmp_gt_u32 s[40:41], 8, v5
    v_lshlrev_b32 v5, 4, v5
    v_lshl_add_u32 v83, v6, 8, v5
    s_and_b32 s56, s3, 3
    s_mul_i32 s42, s56, 1792
    s_mul_i32 s43, s56, 1008
    s_lshl_b32 s38, s36, 7
    s_add_u32 s42, s42, s38
    s_bitset0_b32 s41, 31
    s_waitcnt lgkmcnt(0)

    s_mov_b32 s16, s4
    s_and_b32 s17, s5, 0xffff
    s_mov_b32 s18, 6553600
    s_mov_b32 s19, 0x00020000
    s_mov_b32 s20, s6
    s_and_b32 s21, s7, 0xffff
    s_mov_b32 s22, 256000
    s_mov_b32 s23, 0x00020000
    s_mov_b32 s24, s8
    s_and_b32 s25, s9, 0xffff
    s_mov_b32 s26, 20000
    s_mov_b32 s27, 0x00020000
    s_mov_b32 s28, s10
    s_and_b32 s29, s11, 0xffff
    s_mov_b32 s30, 13107200
    s_mov_b32 s31, 0x00020000
    s_mov_b32 s32, s12
    s_and_b32 s33, s13, 0xffff
    s_mov_b32 s34, 268435456
    s_mov_b32 s35, 0x00020000
    s_mov_b32 s12, s12
    s_and_b32 s13, s13, 0xffff
    s_mov_b32 s14, 268435456
    s_mov_b32 s15, 0x00020000
    s_mov_b32 s52, s52
    s_and_b32 s53, s53, 0xffff
    s_mov_b32 s54, 256
    s_mov_b32 s55, 0x00020000

    s_mov_b32 s50, s36
    s_lshr_b32 s44, s2, 1
    s_lshl_b32 s44, s44, 3

    s_cmp_ge_u32 s3, 4
    s_cbranch_scc1 standalone__deep_cross_pnn__recsys_kernel_aux

    s_setprio 3
    s_lshl_b32 s38, s3, 10
    s_add_u32 m0, s38, 144144
    v_and_b32 v5, 15, v255

    buffer_load_dwordx4 v254, s[24:27], s38 offen lds
    s_add_u32 m0, m0, 4096
    s_add_u32 s38, s38, 4096
    buffer_load_dwordx4 v254, s[24:27], s38 offen lds
    s_add_u32 m0, m0, 4096
    s_add_u32 s38, s38, 4096
    buffer_load_dwordx4 v254, s[24:27], s38 offen lds
    s_add_u32 m0, m0, 4096
    s_add_u32 s38, s38, 4096
    buffer_load_dwordx4 v254, s[24:27], s38 offen lds
    s_add_u32 m0, m0, 4096
    s_add_u32 s38, s38, 4096
    s_cmp_eq_u32 s3, 3
    s_cselect_b32 s45, 1024, 0
    s_sub_u32 m0, m0, s45
    s_sub_u32 s38, s38, s45
    buffer_load_dwordx4 v254, s[24:27], s38 offen lds

    v_lshrrev_b32 v6, 4, v255
    v_and_b32 v8, 3, v255
    v_bfe_u32 v7, v255, 2, 2
    v_mul_u32_u24 v245, 24, v5
    s_movk_i32 s45, 400
    v_lshlrev_b32 v246, 2, v7
    v_mad_u32_u24 v246, v8, s45, v246
    s_lshl_b32 s72, s37, 7
    s_lshl_b32 s73, s3, 5
    s_add_u32 s72, s72, s73
    s_mul_i32 s74, s72, 400
    s_add_u32 s58, s74, 12800
    s_mov_b32 s18, s58
    v_mul_u32_u24 v184, 12, v5
    s_movk_i32 s45, 200
    v_mad_u32_u24 v185, v6, s45, v184
    v_lshlrev_b32 v186, 1, v7
    v_mad_u32_u24 v186, v6, s45, v186
    v_mov_b32 v90, 0
    s_movk_i32 s45, 19200

    buffer_load_dwordx3 v[188:190], v185, s[24:27], s45 offen
    buffer_load_short_d16_hi v90, v186, s[24:27], s45 offen offset:192
    buffer_load_dwordx4 v[192:195], v245, s[16:19], s74 offen
    buffer_load_dwordx2 v[196:197], v245, s[16:19], s74 offen offset:16
    buffer_load_dword v198, v246, s[16:19], s74 offen offset:384
    buffer_load_dwordx4 v[218:221], v245, s[16:19], s74 offen offset:400
    buffer_load_dwordx2 v[222:223], v245, s[16:19], s74 offen offset:416
    buffer_load_dwordx4 v[224:227], v245, s[16:19], s74 offen offset:800
    buffer_load_dwordx2 v[228:229], v245, s[16:19], s74 offen offset:816
    buffer_load_dwordx4 v[230:233], v245, s[16:19], s74 offen offset:1200
    buffer_load_dwordx2 v[234:235], v245, s[16:19], s74 offen offset:1216
    buffer_load_dwordx4 v[212:215], v245, s[16:19], s74 offen offset:1600
    buffer_load_dwordx2 v[216:217], v245, s[16:19], s74 offen offset:1616
    buffer_load_dword v236, v246, s[16:19], s74 offen offset:1984
    s_load_dwordx2 s[24:25], s[60:61], s44
    s_load_dwordx2 s[26:27], s[62:63], s44

    v_add_u32 v40, -1, v5
    v_cmp_gt_u32 s[46:47], 8, v40
    s_lshl_b32 s76, s36, 14
    s_add_u32 s76, s76, s72
    s_lshl_b32 s76, s76, 2
    s_add_u32 s76, s76, 29360128
    v_lshlrev_b32 v40, 4, v40
    v_lshrrev_b32 v41, 5, v255
    v_lshl_add_u32 v40, v41, 2, v40
    v_bfe_u32 v41, v255, 4, 1
    v_lshl_add_u32 v94, v41, 3, v40
    s_add_u32 s45, s3, 4
    s_mul_i32 s44, s45, 18432
    v_mul_u32_u24 v95, 144, v5
    v_lshl_add_u32 v95, v6, 4, v95
    v_add_u32 v95, s44, v95
    s_xor_b32 s44, s36, 1
    s_lshl_b32 s44, s44, 3
    s_add_u32 s44, s44, s45
    s_lshl_b32 s44, s44, 14
    s_add_u32 s44, s44, 15204352
    s_mov_b32 s64, 0x40000000
    v_add_u32 v184, 144144, v184
    s_movk_i32 s45, 4800
    v_mad_u32_u24 v184, v6, s45, v184
    v_mul_u32_u24 v186, 1200, v5
    v_add_u32 v186, 144144, v186
    v_mad_u32_u24 v185, v6, 48, v186
    v_lshl_add_u32 v186, v6, 1, v186
    v_and_b32 v244, 48, v255
    s_movk_i32 s57, 144
    v_cmp_eq_u32 s[60:61], 0, v8
    v_cmp_eq_u32 s[62:63], 1, v8
    v_cmp_eq_u32 s[66:67], 2, v8
    v_cmp_eq_u32 s[68:69], 3, v8
    s_mov_b32 s70, 0x00010001
    s_mov_b32 s71, 0x00010001

    s_lshr_b32 s79, s2, 1
    s_mul_i32 s77, s79, 102656
    s_lshl_b32 s85, s50, 11
    s_xor_b32 s78, s85, 2048
    s_add_u32 s78, s78, s77
    s_add_u32 s77, s77, s85
    s_and_b32 s79, s2, 1
    s_mul_i32 s79, s79, 1638400
    s_add_u32 s79, s79, 16777216
    s_lshl_b32 s85, s3, 13
    s_add_u32 s79, s79, s85
    s_xor_b32 s85, s3, 4
    s_lshl_b32 s85, s85, 10
    v_mov_b32 v0, 0
    v_mov_b32 v1, 0
    v_mov_b32 v2, 0
    v_mov_b32 v3, 0
    v_mov_b32 v4, 0
    v_mov_b32 v5, 0
    v_mov_b32 v6, 0
    v_mov_b32 v7, 0
    v_mov_b32 v8, 0
    v_mov_b32 v9, 0
    v_mov_b32 v10, 0
    v_mov_b32 v11, 0
    v_mov_b32 v12, 0
    v_mov_b32 v13, 0
    v_mov_b32 v14, 0
    v_mov_b32 v15, 0
    v_mov_b32 v16, 0
    v_mov_b32 v17, 0
    v_mov_b32 v18, 0
    v_mov_b32 v19, 0
    v_mov_b32 v20, 0
    v_mov_b32 v21, 0
    v_mov_b32 v22, 0
    v_mov_b32 v23, 0
    v_mov_b32 v24, 0
    v_mov_b32 v25, 0
    v_mov_b32 v26, 0
    v_mov_b32 v27, 0
    v_mov_b32 v28, 0
    v_mov_b32 v29, 0
    v_mov_b32 v30, 0
    v_mov_b32 v31, 0
    v_mov_b32 v32, 0
    v_mov_b32 v33, 0
    v_mov_b32 v34, 0
    v_mov_b32 v35, 0
    v_mov_b32 v36, 0
    v_mov_b32 v37, 0
    v_mov_b32 v38, 0
    v_mov_b32 v39, 0
    v_mov_b32 v40, 0
    v_mov_b32 v41, 0
    v_mov_b32 v42, 0
    v_mov_b32 v43, 0
    v_mov_b32 v44, 0
    v_mov_b32 v45, 0
    v_mov_b32 v46, 0
    v_mov_b32 v47, 0
    v_mov_b32 v48, 0
    v_mov_b32 v49, 0
    v_mov_b32 v50, 0
    v_mov_b32 v51, 0
    v_mov_b32 v52, 0
    v_mov_b32 v53, 0
    v_mov_b32 v54, 0
    v_mov_b32 v55, 0
    v_mov_b32 v56, 0
    v_mov_b32 v57, 0
    v_mov_b32 v58, 0
    v_mov_b32 v59, 0
    v_mov_b32 v60, 0
    v_mov_b32 v61, 0
    v_mov_b32 v62, 0
    v_mov_b32 v63, 0
    v_mov_b32 v64, 0
    v_mov_b32 v65, 0
    v_mov_b32 v66, 0
    v_mov_b32 v67, 0
    v_mov_b32 v68, 0
    v_mov_b32 v69, 0
    v_mov_b32 v70, 0
    v_mov_b32 v71, 0
    v_mov_b32 v72, 0
    v_mov_b32 v73, 0
    v_mov_b32 v74, 0
    v_mov_b32 v75, 0
    v_mov_b32 v76, 0
    v_mov_b32 v77, 0
    v_mov_b32 v78, 0
    v_mov_b32 v79, 0
    v_mov_b32 v80, 0
    v_mov_b32 v81, 0
    v_mov_b32 v82, 0
    v_mov_b32 v83, 0
    v_mov_b32 v84, 0
    v_mov_b32 v85, 0
    v_mov_b32 v86, 0
    v_mov_b32 v87, 0
    v_mov_b32 v88, 0
    v_mov_b32 v89, 0
    s_waitcnt vmcnt(14)
    s_barrier
    ds_read_b64 v[96:97], v185 offset:200
    ds_read_b64 v[98:99], v185 offset:208
    ds_read_b64 v[100:101], v185 offset:224
    ds_read_b64 v[102:103], v185 offset:232
    ds_read_b64 v[104:105], v185 offset:400
    ds_read_b64 v[106:107], v185 offset:408
    ds_read_b64 v[108:109], v185 offset:424
    ds_read_b64 v[110:111], v185 offset:432
    ds_read_b64 v[112:113], v185 offset:600
    ds_read_b64 v[114:115], v185 offset:608
    ds_read_b64 v[116:117], v185 offset:616
    ds_read_b64 v[118:119], v185 offset:624
    ds_read_b64 v[120:121], v185 offset:632
    ds_read_b64 v[122:123], v185 offset:640
    ds_read_b64 v[124:125], v185 offset:800
    ds_read_b64 v[126:127], v185 offset:808
    ds_read_b64 v[128:129], v185 offset:816
    ds_read_b64 v[130:131], v185 offset:824
    ds_read_b64 v[132:133], v185 offset:832
    ds_read_b64 v[134:135], v185 offset:840
    ds_read_b64 v[136:137], v185 offset:1000
    ds_read_b64 v[138:139], v185 offset:1008
    ds_read_b64 v[140:141], v185 offset:1016
    ds_read_b64 v[142:143], v185 offset:1024
    ds_read_b64 v[144:145], v185 offset:1032
    ds_read_b64 v[146:147], v185 offset:1040
    ds_read_u16_d16_hi v84, v186 offset:192
    ds_read_u16_d16_hi v85, v186 offset:392
    ds_read_u16_d16_hi v86, v186 offset:592
    ds_read_u16_d16_hi v87, v186 offset:792
    ds_read_u16_d16_hi v88, v186 offset:992
    ds_read_u16_d16_hi v89, v186 offset:1192
    ds_read_u16_d16_hi v4, v184 offset:2
    ds_read_u16_d16_hi v5, v184 offset:1202
    ds_read_u16_d16_hi v6, v184 offset:2402
    ds_read_u16_d16_hi v7, v184 offset:3602
    ds_read_u16_d16_hi v8, v184 offset:4
    ds_read_u16_d16_hi v9, v184 offset:1204
    ds_read_u16_d16_hi v10, v184 offset:2404
    ds_read_u16_d16_hi v11, v184 offset:3604
    ds_read_u16_d16_hi v12, v184 offset:6
    ds_read_u16_d16_hi v13, v184 offset:1206
    ds_read_u16_d16_hi v14, v184 offset:2406
    ds_read_u16_d16_hi v15, v184 offset:3606
    ds_read_u16_d16_hi v16, v184 offset:8
    ds_read_u16_d16_hi v17, v184 offset:1208
    ds_read_u16_d16_hi v18, v184 offset:2408
    ds_read_u16_d16_hi v19, v184 offset:3608
    ds_read_u16_d16_hi v20, v184 offset:10
    ds_read_u16_d16_hi v21, v184 offset:1210
    ds_read_u16_d16_hi v22, v184 offset:2410
    ds_read_u16_d16_hi v23, v184 offset:3610
    ds_read_u16_d16_hi v28, v184 offset:204
    ds_read_u16_d16_hi v29, v184 offset:1404
    ds_read_u16_d16_hi v30, v184 offset:2604
    ds_read_u16_d16_hi v31, v184 offset:3804
    ds_read_u16_d16_hi v32, v184 offset:206
    ds_read_u16_d16_hi v33, v184 offset:1406
    ds_read_u16_d16_hi v34, v184 offset:2606
    ds_read_u16_d16_hi v35, v184 offset:3806
    ds_read_u16_d16_hi v36, v184 offset:208
    ds_read_u16_d16_hi v37, v184 offset:1408
    ds_read_u16_d16_hi v38, v184 offset:2608
    ds_read_u16_d16_hi v39, v184 offset:3808
    ds_read_u16_d16_hi v40, v184 offset:210
    ds_read_u16_d16_hi v41, v184 offset:1410
    ds_read_u16_d16_hi v42, v184 offset:2610
    ds_read_u16_d16_hi v43, v184 offset:3810
    ds_read_u16_d16_hi v48, v184 offset:406
    ds_read_u16_d16_hi v49, v184 offset:1606
    ds_read_u16_d16_hi v50, v184 offset:2806
    ds_read_u16_d16_hi v51, v184 offset:4006
    ds_read_u16_d16_hi v52, v184 offset:408
    ds_read_u16_d16_hi v53, v184 offset:1608
    ds_read_u16_d16_hi v54, v184 offset:2808
    ds_read_u16_d16_hi v55, v184 offset:4008
    ds_read_u16_d16_hi v56, v184 offset:410
    ds_read_u16_d16_hi v57, v184 offset:1610
    ds_read_u16_d16_hi v58, v184 offset:2810
    ds_read_u16_d16_hi v59, v184 offset:4010
    ds_read_u16_d16_hi v64, v184 offset:608
    ds_read_u16_d16_hi v65, v184 offset:1808
    ds_read_u16_d16_hi v66, v184 offset:3008
    ds_read_u16_d16_hi v67, v184 offset:4208
    ds_read_u16_d16_hi v68, v184 offset:610
    ds_read_u16_d16_hi v69, v184 offset:1810
    ds_read_u16_d16_hi v70, v184 offset:3010
    ds_read_u16_d16_hi v71, v184 offset:4210
    ds_read_u16_d16_hi v76, v184 offset:810
    ds_read_u16_d16_hi v77, v184 offset:2010
    ds_read_u16_d16_hi v78, v184 offset:3210
    ds_read_u16_d16_hi v79, v184 offset:4410
    ds_read_u16_d16_hi v0, v184 offset:0
    ds_read_u16_d16_hi v1, v184 offset:1200
    ds_read_u16_d16_hi v2, v184 offset:2400
    ds_read_u16_d16_hi v3, v184 offset:3600
    ds_read_u16_d16_hi v24, v184 offset:202
    ds_read_u16_d16_hi v25, v184 offset:1402
    ds_read_u16_d16_hi v26, v184 offset:2602
    ds_read_u16_d16_hi v27, v184 offset:3802
    ds_read_u16_d16_hi v44, v184 offset:404
    ds_read_u16_d16_hi v45, v184 offset:1604
    ds_read_u16_d16_hi v46, v184 offset:2804
    ds_read_u16_d16_hi v47, v184 offset:4004
    ds_read_u16_d16_hi v60, v184 offset:606
    ds_read_u16_d16_hi v61, v184 offset:1806
    ds_read_u16_d16_hi v62, v184 offset:3006
    ds_read_u16_d16_hi v63, v184 offset:4206
    ds_read_u16_d16_hi v72, v184 offset:808
    ds_read_u16_d16_hi v73, v184 offset:2008
    ds_read_u16_d16_hi v74, v184 offset:3208
    ds_read_u16_d16_hi v75, v184 offset:4408
    ds_read_u16_d16_hi v80, v184 offset:1010
    ds_read_u16_d16_hi v81, v184 offset:2210
    ds_read_u16_d16_hi v82, v184 offset:3410
    ds_read_u16_d16_hi v83, v184 offset:4610
    s_waitcnt vmcnt(9) lgkmcnt(15)
    v_lshlrev_b32 v200, 16, v96
    v_add_f32 v4, v4, v200
    v_lshlrev_b32 v201, 16, v99
    v_add_f32 v5, v5, v201
    v_lshlrev_b32 v200, 16, v100
    v_add_f32 v6, v6, v200
    v_lshlrev_b32 v201, 16, v103
    v_add_f32 v7, v7, v201
    v_lshlrev_b32 v200, 16, v104
    v_add_f32 v8, v8, v200
    v_lshlrev_b32 v201, 16, v107
    v_add_f32 v9, v9, v201
    v_lshlrev_b32 v200, 16, v108
    v_add_f32 v10, v10, v200
    v_lshlrev_b32 v201, 16, v111
    v_add_f32 v11, v11, v201
    v_lshlrev_b32 v200, 16, v112
    v_add_f32 v12, v12, v200
    v_lshlrev_b32 v201, 16, v115
    v_add_f32 v13, v13, v201
    v_lshlrev_b32 v200, 16, v118
    v_add_f32 v14, v14, v200
    v_lshlrev_b32 v201, 16, v121
    v_add_f32 v15, v15, v201
    v_lshlrev_b32 v200, 16, v124
    v_add_f32 v16, v16, v200
    v_lshlrev_b32 v201, 16, v127
    v_add_f32 v17, v17, v201
    v_lshlrev_b32 v200, 16, v130
    v_add_f32 v18, v18, v200
    v_lshlrev_b32 v201, 16, v133
    v_add_f32 v19, v19, v201
    v_lshlrev_b32 v200, 16, v136
    v_add_f32 v20, v20, v200
    v_lshlrev_b32 v201, 16, v139
    v_add_f32 v21, v21, v201
    v_lshlrev_b32 v200, 16, v142
    v_add_f32 v22, v22, v200
    v_lshlrev_b32 v201, 16, v145
    v_add_f32 v23, v23, v201
    v_and_b32 v200, 0xffff0000, v104
    v_add_f32 v28, v28, v200
    v_and_b32 v201, 0xffff0000, v107
    v_add_f32 v29, v29, v201
    v_and_b32 v200, 0xffff0000, v108
    v_add_f32 v30, v30, v200
    v_and_b32 v201, 0xffff0000, v111
    v_add_f32 v31, v31, v201
    v_and_b32 v200, 0xffff0000, v112
    v_add_f32 v32, v32, v200
    v_and_b32 v201, 0xffff0000, v115
    v_add_f32 v33, v33, v201
    v_and_b32 v200, 0xffff0000, v118
    v_add_f32 v34, v34, v200
    v_and_b32 v201, 0xffff0000, v121
    v_add_f32 v35, v35, v201
    v_and_b32 v200, 0xffff0000, v124
    v_add_f32 v36, v36, v200
    v_and_b32 v201, 0xffff0000, v127
    v_add_f32 v37, v37, v201
    v_and_b32 v200, 0xffff0000, v130
    v_add_f32 v38, v38, v200
    v_and_b32 v201, 0xffff0000, v133
    v_add_f32 v39, v39, v201
    v_and_b32 v200, 0xffff0000, v136
    v_add_f32 v40, v40, v200
    v_and_b32 v201, 0xffff0000, v139
    v_add_f32 v41, v41, v201
    v_and_b32 v200, 0xffff0000, v142
    v_add_f32 v42, v42, v200
    v_and_b32 v201, 0xffff0000, v145
    v_add_f32 v43, v43, v201
    v_lshlrev_b32 v200, 16, v113
    v_add_f32 v48, v48, v200
    v_lshlrev_b32 v201, 16, v116
    v_add_f32 v49, v49, v201
    v_lshlrev_b32 v200, 16, v119
    v_add_f32 v50, v50, v200
    v_lshlrev_b32 v201, 16, v122
    v_add_f32 v51, v51, v201
    v_lshlrev_b32 v200, 16, v125
    v_add_f32 v52, v52, v200
    v_lshlrev_b32 v201, 16, v128
    v_add_f32 v53, v53, v201
    v_lshlrev_b32 v200, 16, v131
    v_add_f32 v54, v54, v200
    v_lshlrev_b32 v201, 16, v134
    v_add_f32 v55, v55, v201
    v_lshlrev_b32 v200, 16, v137
    v_add_f32 v56, v56, v200
    v_lshlrev_b32 v201, 16, v140
    v_add_f32 v57, v57, v201
    v_lshlrev_b32 v200, 16, v143
    v_add_f32 v58, v58, v200
    v_lshlrev_b32 v201, 16, v146
    v_add_f32 v59, v59, v201
    v_and_b32 v200, 0xffff0000, v125
    v_add_f32 v64, v64, v200
    v_and_b32 v201, 0xffff0000, v128
    v_add_f32 v65, v65, v201
    v_and_b32 v200, 0xffff0000, v131
    v_add_f32 v66, v66, v200
    v_and_b32 v201, 0xffff0000, v134
    v_add_f32 v67, v67, v201
    v_and_b32 v200, 0xffff0000, v137
    v_add_f32 v68, v68, v200
    v_and_b32 v201, 0xffff0000, v140
    v_add_f32 v69, v69, v201
    v_and_b32 v200, 0xffff0000, v143
    v_add_f32 v70, v70, v200
    v_and_b32 v201, 0xffff0000, v146
    v_add_f32 v71, v71, v201
    v_lshlrev_b32 v200, 16, v138
    v_add_f32 v76, v76, v200
    v_lshlrev_b32 v201, 16, v141
    v_add_f32 v77, v77, v201
    v_lshlrev_b32 v200, 16, v144
    v_add_f32 v78, v78, v200
    v_lshlrev_b32 v201, 16, v147
    v_add_f32 v79, v79, v201
    v_lshlrev_b32 v200, 16, v188
    v_add_f32 v84, v84, v200
    v_and_b32 v201, 0xffff0000, v188
    v_add_f32 v85, v85, v201
    v_lshlrev_b32 v200, 16, v189
    v_add_f32 v86, v86, v200
    v_and_b32 v201, 0xffff0000, v189
    v_add_f32 v87, v87, v201
    v_lshlrev_b32 v200, 16, v190
    v_add_f32 v88, v88, v200
    v_and_b32 v201, 0xffff0000, v190
    v_add_f32 v89, v89, v201
    v_mad_u32_u24 v192, v192, s57, v244
    v_mad_u32_u24 v193, v193, s57, v244
    v_mad_u32_u24 v194, v194, s57, v244
    v_mad_u32_u24 v195, v195, s57, v244
    v_mad_u32_u24 v196, v196, s57, v244
    v_mad_u32_u24 v197, v197, s57, v244
    v_mad_u32_u24 v198, v198, s57, v244
    v_cndmask_b32 v93, 0, v90, s[68:69]
    v_cndmask_b32 v92, 0, v90, s[66:67]
    v_cndmask_b32 v91, 0, v90, s[62:63]
    v_cndmask_b32 v90, 0, v90, s[60:61]
    s_waitcnt lgkmcnt(0)
    s_lshl_b32 s80, s24, 16
    s_and_b32 s81, s24, 0xffff0000
    s_lshl_b32 s82, s25, 16
    s_and_b32 s83, s25, 0xffff0000
    s_barrier
    s_setprio 0
    ds_read_b128 v[96:99], v192 offset:0
    ds_read_b128 v[100:103], v192 offset:64
    ds_read_b128 v[104:107], v193 offset:0
    ds_read_b128 v[108:111], v193 offset:64
    ds_read_b128 v[112:115], v194 offset:0
    ds_read_b128 v[116:119], v194 offset:64
    ds_read_b128 v[128:131], v195 offset:0
    ds_read_b128 v[132:135], v195 offset:64
    ds_read_b128 v[144:147], v196 offset:0
    ds_read_b128 v[148:151], v196 offset:64
    ds_read_b128 v[160:163], v197 offset:0
    ds_read_b128 v[164:167], v197 offset:64
    ds_read_b128 v[176:179], v198 offset:0
    ds_read_b128 v[180:183], v198 offset:64
    s_waitcnt vmcnt(7) lgkmcnt(0)
standalone__deep_cross_pnn__recsys_kernel_loop:
    v_mfma_f32_16x16x32_bf16 v[184:187], v[96:99], v[96:99], 0
    v_fmac_f32 v240, v188, v64
    v_fmac_f32 v240, v189, v65
    v_mfma_f32_16x16x32_bf16 v[184:187], v[100:103], v[100:103], v[184:187]
    v_fmac_f32 v240, v190, v66
    v_fmac_f32 v240, v191, v67
    v_mfma_f32_16x16x32_bf16 v[188:191], v[96:99], v[104:107], 0
    v_fmac_f32 v240, v192, v68
    v_fmac_f32 v240, v193, v69
    v_fmac_f32 v240, v194, v70
    v_fmac_f32 v240, v195, v71
    v_mad_u32_u24 v220, v220, s57, v244
    v_mfma_f32_16x16x32_bf16 v[188:191], v[100:103], v[108:111], v[188:191]
    ds_read_b128 v[120:123], v220 offset:0
    ds_read_b128 v[124:127], v220 offset:64
    v_mfma_f32_16x16x32_bf16 v[192:195], v[96:99], v[112:115], 0
    v_fmac_f32 v240, v196, v72
    v_fmac_f32 v240, v197, v73
    v_mfma_f32_16x16x32_bf16 v[192:195], v[100:103], v[116:119], v[192:195]
    v_fmac_f32 v240, v198, v74
    v_fmac_f32 v240, v199, v75
    v_mfma_f32_16x16x32_bf16 v[196:199], v[176:179], v[96:99], 0
    v_fmac_f32 v240, v200, v76
    v_fmac_f32 v240, v201, v77
    v_mfma_f32_16x16x32_bf16 v[196:199], v[180:183], v[100:103], v[196:199]
    v_fmac_f32 v240, v202, v78
    v_fmac_f32 v240, v203, v79
    v_mad_u32_u24 v221, v221, s57, v244
    v_mfma_f32_16x16x32_bf16 v[200:203], v[96:99], v[128:131], 0
    ds_read_b128 v[136:139], v221 offset:0
    ds_read_b128 v[140:143], v221 offset:64
    v_mfma_f32_16x16x32_bf16 v[200:203], v[100:103], v[132:135], v[200:203]
    v_fmac_f32 v240, v204, v80
    v_fmac_f32 v240, v205, v81
    v_fmac_f32 v240, v206, v82
    v_fmac_f32 v240, v207, v83
    v_mfma_f32_16x16x32_bf16 v[204:207], v[96:99], v[144:147], 0
    v_mad_u32_u24 v218, v218, s57, v244
    v_mul_f32 v237, v184, v0
    v_mfma_f32_16x16x32_bf16 v[204:207], v[100:103], v[148:151], v[204:207]
    v_fmac_f32 v237, v185, v1
    v_fmac_f32 v237, v186, v2
    v_mfma_f32_16x16x32_bf16 v[208:211], v[96:99], v[160:163], 0
    v_fmac_f32 v237, v187, v3
    v_fmac_f32 v237, v188, v4
    v_mfma_f32_16x16x32_bf16 v[208:211], v[100:103], v[164:167], v[208:211]
    ds_read_b128 v[96:99], v218 offset:0
    ds_read_b128 v[100:103], v218 offset:64
    v_mfma_f32_16x16x32_bf16 v[184:187], v[104:107], v[104:107], 0
    v_fmac_f32 v237, v189, v5
    v_fmac_f32 v237, v190, v6
    v_mfma_f32_16x16x32_bf16 v[184:187], v[108:111], v[108:111], v[184:187]
    v_fmac_f32 v237, v191, v7
    v_fmac_f32 v237, v192, v8
    v_mfma_f32_16x16x32_bf16 v[188:191], v[104:107], v[112:115], 0
    v_fmac_f32 v237, v193, v9
    v_fmac_f32 v237, v194, v10
    v_mfma_f32_16x16x32_bf16 v[188:191], v[108:111], v[116:119], v[188:191]
    v_fmac_f32 v237, v195, v11
    v_mad_u32_u24 v222, v222, s57, v244
    v_mfma_f32_16x16x32_bf16 v[192:195], v[176:179], v[104:107], 0
    v_fmac_f32 v237, v196, v84
    v_fmac_f32 v237, v200, v12
    v_mfma_f32_16x16x32_bf16 v[192:195], v[180:183], v[108:111], v[192:195]
    ds_read_b128 v[152:155], v222 offset:0
    ds_read_b128 v[156:159], v222 offset:64
    v_mfma_f32_16x16x32_bf16 v[196:199], v[104:107], v[128:131], 0
    v_fmac_f32 v237, v201, v13
    v_fmac_f32 v237, v202, v14
    v_mfma_f32_16x16x32_bf16 v[196:199], v[108:111], v[132:135], v[196:199]
    v_fmac_f32 v237, v203, v15
    v_fmac_f32 v237, v204, v16
    v_mfma_f32_16x16x32_bf16 v[200:203], v[104:107], v[144:147], 0
    v_fmac_f32 v237, v205, v17
    v_fmac_f32 v237, v206, v18
    v_mfma_f32_16x16x32_bf16 v[200:203], v[108:111], v[148:151], v[200:203]
    v_fmac_f32 v237, v207, v19
    v_mad_u32_u24 v219, v219, s57, v244
    v_mfma_f32_16x16x32_bf16 v[204:207], v[104:107], v[160:163], 0
    v_fmac_f32 v237, v208, v20
    v_fmac_f32 v237, v209, v21
    v_fmac_f32 v237, v210, v22
    v_fmac_f32 v237, v211, v23
    v_mfma_f32_16x16x32_bf16 v[204:207], v[108:111], v[164:167], v[204:207]
    ds_read_b128 v[104:107], v219 offset:0
    ds_read_b128 v[108:111], v219 offset:64
    v_mfma_f32_16x16x32_bf16 v[208:211], v[112:115], v[112:115], 0
    v_fmac_f32 v237, v184, v24
    v_fmac_f32 v237, v185, v25
    v_mfma_f32_16x16x32_bf16 v[208:211], v[116:119], v[116:119], v[208:211]
    v_fmac_f32 v237, v186, v26
    v_fmac_f32 v237, v187, v27
    v_mfma_f32_16x16x32_bf16 v[184:187], v[176:179], v[112:115], 0
    v_fmac_f32 v237, v188, v28
    v_fmac_f32 v237, v189, v29
    v_mfma_f32_16x16x32_bf16 v[184:187], v[180:183], v[116:119], v[184:187]
    v_fmac_f32 v237, v190, v30
    v_fmac_f32 v237, v191, v31
    v_mfma_f32_16x16x32_bf16 v[188:191], v[112:115], v[128:131], 0
    v_permlane32_swap_b32 v239, v240
    v_mad_u32_u24 v223, v223, s57, v244
    v_fmac_f32 v237, v192, v85
    v_mfma_f32_16x16x32_bf16 v[188:191], v[116:119], v[132:135], v[188:191]
    ds_read_b128 v[168:171], v223 offset:0
    ds_read_b128 v[172:175], v223 offset:64
    v_mfma_f32_16x16x32_bf16 v[192:195], v[112:115], v[144:147], 0
    v_add_f32 v242, v239, v240
    v_fmac_f32 v237, v196, v32
    v_fmac_f32 v237, v197, v33
    v_fmac_f32 v237, v198, v34
    v_fmac_f32 v237, v199, v35
    v_mfma_f32_16x16x32_bf16 v[192:195], v[116:119], v[148:151], v[192:195]
    buffer_load_dwordx4 v[218:221], v245, s[16:19], s74 offen offset:2000
    buffer_load_dwordx2 v[222:223], v245, s[16:19], s74 offen offset:2016
    v_mfma_f32_16x16x32_bf16 v[196:199], v[176:179], v[128:131], 0
    v_permlane16_swap_b32 v241, v242
    v_mfma_f32_16x16x32_bf16 v[196:199], v[180:183], v[132:135], v[196:199]
    v_fmac_f32 v237, v200, v36
    v_fmac_f32 v237, v201, v37
    v_fmac_f32 v237, v202, v38
    v_fmac_f32 v237, v203, v39
    v_mfma_f32_16x16x32_bf16 v[200:203], v[112:115], v[160:163], 0
    v_add_f32 v241, v241, v242
    v_fmac_f32 v237, v204, v40
    v_mfma_f32_16x16x32_bf16 v[200:203], v[116:119], v[164:167], v[200:203]
    v_fmac_f32 v237, v205, v41
    v_fmac_f32 v237, v206, v42
    v_fmac_f32 v237, v207, v43
    v_mfma_f32_16x16x32_bf16 v[204:207], v[128:131], v[128:131], 0
    v_add_f32_dpp v241, v241, v241 row_ror:8 row_mask:0xf bank_mask:0xf
    v_fmac_f32 v237, v208, v44
    v_mfma_f32_16x16x32_bf16 v[204:207], v[132:135], v[132:135], v[204:207]
    v_fmac_f32 v237, v209, v45
    v_fmac_f32 v237, v210, v46
    v_fmac_f32 v237, v211, v47
    v_mfma_f32_16x16x32_bf16 v[208:211], v[176:179], v[144:147], 0
    v_add_f32_dpp v241, v241, v241 row_ror:4 row_mask:0xf bank_mask:0xf
    v_fmac_f32 v237, v184, v86
    v_mfma_f32_16x16x32_bf16 v[208:211], v[180:183], v[148:151], v[208:211]
    v_fmac_f32 v237, v188, v48
    v_fmac_f32 v237, v189, v49
    v_mfma_f32_16x16x32_bf16 v[184:187], v[128:131], v[144:147], 0
    v_add_f32_dpp v241, v241, v241 row_ror:2 row_mask:0xf bank_mask:0xf
    v_fmac_f32 v237, v190, v50
    v_mfma_f32_16x16x32_bf16 v[184:187], v[132:135], v[148:151], v[184:187]
    v_fmac_f32 v237, v191, v51
    v_fmac_f32 v237, v192, v52
    v_mfma_f32_16x16x32_bf16 v[188:191], v[128:131], v[160:163], 0
    v_add_f32_dpp v241, v241, v241 row_ror:1 row_mask:0xf bank_mask:0xf
    v_fmac_f32 v237, v193, v53
    v_mfma_f32_16x16x32_bf16 v[188:191], v[132:135], v[164:167], v[188:191]
    v_fmac_f32 v237, v194, v54
    v_fmac_f32 v237, v195, v55
    v_mfma_f32_16x16x32_bf16 v[192:195], v[176:179], v[160:163], 0
    v_cndmask_b32 v243, v243, v241, s[70:71]
    v_fmac_f32 v237, v196, v87
    v_mfma_f32_16x16x32_bf16 v[192:195], v[180:183], v[164:167], v[192:195]
    s_lshl_b64 s[70:71], s[70:71], 1
    v_fmac_f32 v237, v200, v56
    v_mfma_f32_16x16x32_bf16 v[196:199], v[144:147], v[144:147], 0
    v_fmac_f32 v237, v201, v57
    v_fmac_f32 v237, v202, v58
    v_mfma_f32_16x16x32_bf16 v[196:199], v[148:151], v[148:151], v[196:199]
    v_fmac_f32 v237, v203, v59
    v_fmac_f32 v237, v204, v60
    v_mfma_f32_16x16x32_bf16 v[200:203], v[144:147], v[160:163], 0
    v_fmac_f32 v237, v205, v61
    v_fmac_f32 v237, v206, v62
    v_mfma_f32_16x16x32_bf16 v[200:203], v[148:151], v[164:167], v[200:203]
    v_fmac_f32 v237, v207, v63
    v_fmac_f32 v237, v208, v88
    v_mfma_f32_16x16x32_bf16 v[204:207], v[160:163], v[160:163], 0
    v_fmac_f32 v237, v184, v64
    v_fmac_f32 v237, v185, v65
    v_mfma_f32_16x16x32_bf16 v[204:207], v[164:167], v[164:167], v[204:207]
    v_fmac_f32 v237, v186, v66
    s_waitcnt vmcnt(7) lgkmcnt(0)
    v_mfma_f32_16x16x32_bf16 v[208:211], v[96:99], v[96:99], 0
    v_fmac_f32 v237, v187, v67
    v_mad_u32_u24 v226, v226, s57, v244
    v_mfma_f32_16x16x32_bf16 v[208:211], v[100:103], v[100:103], v[208:211]
    v_fmac_f32 v237, v188, v68
    v_fmac_f32 v237, v189, v69
    v_mfma_f32_16x16x32_bf16 v[184:187], v[96:99], v[104:107], 0
    v_fmac_f32 v237, v190, v70
    v_fmac_f32 v237, v191, v71
    v_mfma_f32_16x16x32_bf16 v[184:187], v[100:103], v[108:111], v[184:187]
    ds_read_b128 v[112:115], v226 offset:0
    ds_read_b128 v[116:119], v226 offset:64
    v_mfma_f32_16x16x32_bf16 v[188:191], v[96:99], v[120:123], 0
    v_fmac_f32 v237, v192, v89
    v_mad_u32_u24 v227, v227, s57, v244
    v_mfma_f32_16x16x32_bf16 v[188:191], v[100:103], v[124:127], v[188:191]
    v_fmac_f32 v237, v196, v72
    v_fmac_f32 v237, v197, v73
    v_mfma_f32_16x16x32_bf16 v[192:195], v[176:179], v[96:99], 0
    v_fmac_f32 v237, v198, v74
    v_fmac_f32 v237, v199, v75
    v_mfma_f32_16x16x32_bf16 v[192:195], v[180:183], v[100:103], v[192:195]
    v_fmac_f32 v237, v200, v76
    v_fmac_f32 v237, v201, v77
    v_mfma_f32_16x16x32_bf16 v[196:199], v[96:99], v[136:139], 0
    ds_read_b128 v[128:131], v227 offset:0
    ds_read_b128 v[132:135], v227 offset:64
    v_mfma_f32_16x16x32_bf16 v[196:199], v[100:103], v[140:143], v[196:199]
    v_fmac_f32 v237, v202, v78
    v_fmac_f32 v237, v203, v79
    v_mfma_f32_16x16x32_bf16 v[200:203], v[96:99], v[152:155], 0
    v_fmac_f32 v237, v204, v80
    v_fmac_f32 v237, v205, v81
    v_mfma_f32_16x16x32_bf16 v[200:203], v[100:103], v[156:159], v[200:203]
    v_fmac_f32 v237, v206, v82
    v_fmac_f32 v237, v207, v83
    v_mfma_f32_16x16x32_bf16 v[204:207], v[96:99], v[168:171], 0
    v_mad_u32_u24 v224, v224, s57, v244
    v_mul_f32 v238, v208, v0
    v_fmac_f32 v238, v209, v1
    v_fmac_f32 v238, v210, v2
    v_fmac_f32 v238, v211, v3
    v_mfma_f32_16x16x32_bf16 v[204:207], v[100:103], v[172:175], v[204:207]
    ds_read_b128 v[96:99], v224 offset:0
    ds_read_b128 v[100:103], v224 offset:64
    v_mfma_f32_16x16x32_bf16 v[208:211], v[104:107], v[104:107], 0
    v_fmac_f32 v238, v184, v4
    v_fmac_f32 v238, v185, v5
    v_mfma_f32_16x16x32_bf16 v[208:211], v[108:111], v[108:111], v[208:211]
    v_fmac_f32 v238, v186, v6
    v_fmac_f32 v238, v187, v7
    v_mfma_f32_16x16x32_bf16 v[184:187], v[104:107], v[120:123], 0
    v_fmac_f32 v238, v188, v8
    v_fmac_f32 v238, v189, v9
    v_mfma_f32_16x16x32_bf16 v[184:187], v[108:111], v[124:127], v[184:187]
    v_fmac_f32 v238, v190, v10
    v_fmac_f32 v238, v191, v11
    v_mfma_f32_16x16x32_bf16 v[188:191], v[176:179], v[104:107], 0
    v_mad_u32_u24 v228, v228, s57, v244
    v_fmac_f32 v238, v193, v84
    v_mfma_f32_16x16x32_bf16 v[188:191], v[180:183], v[108:111], v[188:191]
    ds_read_b128 v[144:147], v228 offset:0
    ds_read_b128 v[148:151], v228 offset:64
    v_mfma_f32_16x16x32_bf16 v[192:195], v[104:107], v[136:139], 0
    v_fmac_f32 v238, v196, v12
    v_fmac_f32 v238, v197, v13
    v_mfma_f32_16x16x32_bf16 v[192:195], v[108:111], v[140:143], v[192:195]
    v_fmac_f32 v238, v198, v14
    v_fmac_f32 v238, v199, v15
    v_mfma_f32_16x16x32_bf16 v[196:199], v[104:107], v[152:155], 0
    v_fmac_f32 v238, v200, v16
    v_fmac_f32 v238, v201, v17
    v_mfma_f32_16x16x32_bf16 v[196:199], v[108:111], v[156:159], v[196:199]
    v_fmac_f32 v238, v202, v18
    v_fmac_f32 v238, v203, v19
    v_mfma_f32_16x16x32_bf16 v[200:203], v[104:107], v[168:171], 0
    v_mad_u32_u24 v225, v225, s57, v244
    v_fmac_f32 v238, v204, v20
    v_fmac_f32 v238, v205, v21
    v_fmac_f32 v238, v206, v22
    v_fmac_f32 v238, v207, v23
    v_mfma_f32_16x16x32_bf16 v[200:203], v[108:111], v[172:175], v[200:203]
    ds_read_b128 v[104:107], v225 offset:0
    ds_read_b128 v[108:111], v225 offset:64
    v_mfma_f32_16x16x32_bf16 v[204:207], v[120:123], v[120:123], 0
    v_fmac_f32 v238, v208, v24
    v_fmac_f32 v238, v209, v25
    v_mfma_f32_16x16x32_bf16 v[204:207], v[124:127], v[124:127], v[204:207]
    v_fmac_f32 v238, v210, v26
    v_fmac_f32 v238, v211, v27
    v_fmac_f32 v238, v184, v28
    v_fmac_f32 v238, v185, v29
    v_fmac_f32 v238, v186, v30
    v_fmac_f32 v238, v187, v31
    v_mfma_f32_16x16x32_bf16 v[184:187], v[176:179], v[120:123], 0
    v_fmac_f32 v238, v189, v85
    v_mad_u32_u24 v229, v229, s57, v244
    v_mfma_f32_16x16x32_bf16 v[184:187], v[180:183], v[124:127], v[184:187]
    v_fmac_f32 v238, v192, v32
    v_fmac_f32 v238, v193, v33
    v_mfma_f32_16x16x32_bf16 v[188:191], v[120:123], v[136:139], 0
    v_fmac_f32 v238, v194, v34
    v_fmac_f32 v238, v195, v35
    v_mfma_f32_16x16x32_bf16 v[188:191], v[124:127], v[140:143], v[188:191]
    ds_read_b128 v[160:163], v229 offset:0
    ds_read_b128 v[164:167], v229 offset:64
    v_mfma_f32_16x16x32_bf16 v[192:195], v[120:123], v[152:155], 0
    v_fmac_f32 v238, v196, v36
    v_fmac_f32 v238, v197, v37
    v_fmac_f32 v238, v198, v38
    v_fmac_f32 v238, v199, v39
    v_mfma_f32_16x16x32_bf16 v[192:195], v[124:127], v[156:159], v[192:195]
    buffer_load_dwordx4 v[224:227], v245, s[16:19], s74 offen offset:2400
    buffer_load_dwordx2 v[228:229], v245, s[16:19], s74 offen offset:2416
    v_mfma_f32_16x16x32_bf16 v[196:199], v[176:179], v[136:139], 0
    v_fmac_f32 v238, v200, v40
    v_fmac_f32 v238, v201, v41
    v_mfma_f32_16x16x32_bf16 v[196:199], v[180:183], v[140:143], v[196:199]
    v_fmac_f32 v238, v202, v42
    v_fmac_f32 v238, v203, v43
    v_mfma_f32_16x16x32_bf16 v[200:203], v[120:123], v[168:171], 0
    v_fmac_f32 v238, v204, v44
    v_fmac_f32 v238, v205, v45
    v_mfma_f32_16x16x32_bf16 v[200:203], v[124:127], v[172:175], v[200:203]
    v_fmac_f32 v238, v206, v46
    v_fmac_f32 v238, v207, v47
    v_mfma_f32_16x16x32_bf16 v[204:207], v[136:139], v[136:139], 0
    v_fmac_f32 v238, v185, v86
    v_fmac_f32 v238, v188, v48
    v_mfma_f32_16x16x32_bf16 v[204:207], v[140:143], v[140:143], v[204:207]
    v_fmac_f32 v238, v189, v49
    v_fmac_f32 v238, v190, v50
    v_mfma_f32_16x16x32_bf16 v[208:211], v[176:179], v[176:179], 0
    v_fmac_f32 v238, v191, v51
    v_fmac_f32 v238, v192, v52
    v_mfma_f32_16x16x32_bf16 v[208:211], v[180:183], v[180:183], v[208:211]
    v_fmac_f32 v238, v193, v53
    v_fmac_f32 v238, v194, v54
    v_mfma_f32_16x16x32_bf16 v[184:187], v[176:179], v[152:155], 0
    v_fmac_f32 v238, v195, v55
    v_fmac_f32 v238, v197, v87
    v_mfma_f32_16x16x32_bf16 v[184:187], v[180:183], v[156:159], v[184:187]
    v_fmac_f32 v238, v200, v56
    v_fmac_f32 v238, v201, v57
    v_mfma_f32_16x16x32_bf16 v[188:191], v[136:139], v[152:155], 0
    v_fmac_f32 v238, v202, v58
    v_fmac_f32 v238, v203, v59
    v_mfma_f32_16x16x32_bf16 v[188:191], v[140:143], v[156:159], v[188:191]
    v_fmac_f32 v238, v204, v60
    v_fmac_f32 v238, v205, v61
    v_mfma_f32_16x16x32_bf16 v[192:195], v[136:139], v[168:171], 0
    v_fmac_f32 v238, v206, v62
    v_fmac_f32 v238, v207, v63
    v_mfma_f32_16x16x32_bf16 v[192:195], v[140:143], v[172:175], v[192:195]
    v_fmac_f32 v237, v208, v90
    v_fmac_f32 v238, v209, v91
    v_mfma_f32_16x16x32_bf16 v[196:199], v[176:179], v[168:171], 0
    v_mul_f32 v239, v210, v92
    v_mul_f32 v240, v211, v93
    v_mfma_f32_16x16x32_bf16 v[196:199], v[180:183], v[172:175], v[196:199]
    v_fmac_f32 v238, v185, v88
    v_fmac_f32 v238, v188, v64
    v_mfma_f32_16x16x32_bf16 v[200:203], v[152:155], v[152:155], 0
    v_fmac_f32 v238, v189, v65
    v_fmac_f32 v238, v190, v66
    v_mfma_f32_16x16x32_bf16 v[200:203], v[156:159], v[156:159], v[200:203]
    v_fmac_f32 v238, v191, v67
    v_fmac_f32 v238, v192, v68
    v_mfma_f32_16x16x32_bf16 v[204:207], v[152:155], v[168:171], 0
    v_fmac_f32 v238, v193, v69
    v_fmac_f32 v238, v194, v70
    v_mfma_f32_16x16x32_bf16 v[204:207], v[156:159], v[172:175], v[204:207]
    v_fmac_f32 v238, v195, v71
    v_fmac_f32 v238, v197, v89
    v_mfma_f32_16x16x32_bf16 v[208:211], v[168:171], v[168:171], 0
    v_fmac_f32 v238, v200, v72
    v_fmac_f32 v238, v201, v73
    v_mfma_f32_16x16x32_bf16 v[208:211], v[172:175], v[172:175], v[208:211]
    v_fmac_f32 v238, v202, v74
    s_waitcnt vmcnt(7) lgkmcnt(0)
    v_mfma_f32_16x16x32_bf16 v[184:187], v[96:99], v[96:99], 0
    v_mad_u32_u24 v232, v232, s57, v244
    v_mad_u32_u24 v233, v233, s57, v244
    v_mfma_f32_16x16x32_bf16 v[184:187], v[100:103], v[100:103], v[184:187]
    v_fmac_f32 v238, v203, v75
    v_fmac_f32 v238, v204, v76
    v_mfma_f32_16x16x32_bf16 v[188:191], v[96:99], v[104:107], 0
    v_fmac_f32 v238, v205, v77
    v_fmac_f32 v238, v206, v78
    v_mfma_f32_16x16x32_bf16 v[188:191], v[100:103], v[108:111], v[188:191]
    ds_read_b128 v[120:123], v232 offset:0
    ds_read_b128 v[124:127], v232 offset:64
    v_mfma_f32_16x16x32_bf16 v[192:195], v[96:99], v[112:115], 0
    v_fmac_f32 v238, v207, v79
    v_fmac_f32 v238, v208, v80
    v_mfma_f32_16x16x32_bf16 v[192:195], v[100:103], v[116:119], v[192:195]
    v_fmac_f32 v238, v209, v81
    v_fmac_f32 v238, v210, v82
    v_mfma_f32_16x16x32_bf16 v[196:199], v[176:179], v[96:99], 0
    v_fmac_f32 v238, v211, v83
    v_mad_u32_u24 v230, v230, s57, v244
    v_mfma_f32_16x16x32_bf16 v[196:199], v[180:183], v[100:103], v[196:199]
    v_fmac_f32 v239, v184, v0
    v_fmac_f32 v239, v185, v1
    v_mfma_f32_16x16x32_bf16 v[200:203], v[96:99], v[128:131], 0
    ds_read_b128 v[136:139], v233 offset:0
    ds_read_b128 v[140:143], v233 offset:64
    v_mfma_f32_16x16x32_bf16 v[200:203], v[100:103], v[132:135], v[200:203]
    v_fmac_f32 v239, v186, v2
    v_fmac_f32 v239, v187, v3
    v_mfma_f32_16x16x32_bf16 v[204:207], v[96:99], v[144:147], 0
    v_fmac_f32 v239, v188, v4
    v_fmac_f32 v239, v189, v5
    v_mfma_f32_16x16x32_bf16 v[204:207], v[100:103], v[148:151], v[204:207]
    v_fmac_f32 v239, v190, v6
    v_fmac_f32 v239, v191, v7
    v_mfma_f32_16x16x32_bf16 v[208:211], v[96:99], v[160:163], 0
    v_fmac_f32 v239, v192, v8
    v_fmac_f32 v239, v193, v9
    v_mfma_f32_16x16x32_bf16 v[208:211], v[100:103], v[164:167], v[208:211]
    ds_read_b128 v[96:99], v230 offset:0
    ds_read_b128 v[100:103], v230 offset:64
    v_mfma_f32_16x16x32_bf16 v[184:187], v[104:107], v[104:107], 0
    v_fmac_f32 v239, v194, v10
    v_fmac_f32 v239, v195, v11
    v_mfma_f32_16x16x32_bf16 v[184:187], v[108:111], v[108:111], v[184:187]
    v_mad_u32_u24 v234, v234, s57, v244
    v_fmac_f32 v239, v198, v84
    v_mfma_f32_16x16x32_bf16 v[188:191], v[104:107], v[112:115], 0
    v_fmac_f32 v239, v200, v12
    v_fmac_f32 v239, v201, v13
    v_mfma_f32_16x16x32_bf16 v[188:191], v[108:111], v[116:119], v[188:191]
    v_fmac_f32 v239, v202, v14
    v_fmac_f32 v239, v203, v15
    v_mfma_f32_16x16x32_bf16 v[192:195], v[176:179], v[104:107], 0
    v_fmac_f32 v239, v204, v16
    v_fmac_f32 v239, v205, v17
    v_mfma_f32_16x16x32_bf16 v[192:195], v[180:183], v[108:111], v[192:195]
    ds_read_b128 v[152:155], v234 offset:0
    ds_read_b128 v[156:159], v234 offset:64
    v_mfma_f32_16x16x32_bf16 v[196:199], v[104:107], v[128:131], 0
    v_fmac_f32 v239, v206, v18
    v_fmac_f32 v239, v207, v19
    v_mfma_f32_16x16x32_bf16 v[196:199], v[108:111], v[132:135], v[196:199]
    v_mad_u32_u24 v231, v231, s57, v244
    v_fmac_f32 v239, v208, v20
    v_mfma_f32_16x16x32_bf16 v[200:203], v[104:107], v[144:147], 0
    v_fmac_f32 v239, v209, v21
    v_fmac_f32 v239, v210, v22
    v_mfma_f32_16x16x32_bf16 v[200:203], v[108:111], v[148:151], v[200:203]
    v_fmac_f32 v239, v211, v23
    v_fmac_f32 v239, v184, v24
    v_mfma_f32_16x16x32_bf16 v[204:207], v[104:107], v[160:163], 0
    v_fmac_f32 v239, v185, v25
    v_fmac_f32 v239, v186, v26
    v_mfma_f32_16x16x32_bf16 v[204:207], v[108:111], v[164:167], v[204:207]
    ds_read_b128 v[104:107], v231 offset:0
    ds_read_b128 v[108:111], v231 offset:64
    v_mfma_f32_16x16x32_bf16 v[208:211], v[112:115], v[112:115], 0
    v_fmac_f32 v239, v187, v27
    v_fmac_f32 v239, v188, v28
    v_mfma_f32_16x16x32_bf16 v[208:211], v[116:119], v[116:119], v[208:211]
    v_fmac_f32 v239, v189, v29
    v_fmac_f32 v239, v190, v30
    v_mfma_f32_16x16x32_bf16 v[184:187], v[176:179], v[112:115], 0
    v_fmac_f32 v239, v191, v31
    v_mad_u32_u24 v235, v235, s57, v244
    v_mfma_f32_16x16x32_bf16 v[184:187], v[180:183], v[116:119], v[184:187]
    v_fmac_f32 v239, v194, v85
    v_fmac_f32 v239, v196, v32
    v_mfma_f32_16x16x32_bf16 v[188:191], v[112:115], v[128:131], 0
    v_fmac_f32 v239, v197, v33
    v_fmac_f32 v239, v198, v34
    v_mfma_f32_16x16x32_bf16 v[188:191], v[116:119], v[132:135], v[188:191]
    ds_read_b128 v[168:171], v235 offset:0
    ds_read_b128 v[172:175], v235 offset:64
    v_mfma_f32_16x16x32_bf16 v[192:195], v[112:115], v[144:147], 0
    v_fmac_f32 v239, v199, v35
    v_fmac_f32 v239, v200, v36
    v_mfma_f32_16x16x32_bf16 v[192:195], v[116:119], v[148:151], v[192:195]
    buffer_load_dwordx4 v[230:233], v245, s[16:19], s74 offen offset:2800
    buffer_load_dwordx2 v[234:235], v245, s[16:19], s74 offen offset:2816
    v_mfma_f32_16x16x32_bf16 v[196:199], v[176:179], v[128:131], 0
    v_fmac_f32 v239, v201, v37
    v_fmac_f32 v239, v202, v38
    v_mfma_f32_16x16x32_bf16 v[196:199], v[180:183], v[132:135], v[196:199]
    v_fmac_f32 v239, v203, v39
    v_fmac_f32 v239, v204, v40
    v_mfma_f32_16x16x32_bf16 v[200:203], v[112:115], v[160:163], 0
    v_fmac_f32 v239, v205, v41
    v_fmac_f32 v239, v206, v42
    v_mfma_f32_16x16x32_bf16 v[200:203], v[116:119], v[164:167], v[200:203]
    v_fmac_f32 v239, v207, v43
    v_fmac_f32 v239, v208, v44
    v_mfma_f32_16x16x32_bf16 v[204:207], v[128:131], v[128:131], 0
    v_fmac_f32 v239, v209, v45
    v_fmac_f32 v239, v210, v46
    v_mfma_f32_16x16x32_bf16 v[204:207], v[132:135], v[132:135], v[204:207]
    v_fmac_f32 v239, v211, v47
    v_fmac_f32 v239, v186, v86
    v_mfma_f32_16x16x32_bf16 v[184:187], v[176:179], v[144:147], 0
    v_fmac_f32 v239, v188, v48
    v_fmac_f32 v239, v189, v49
    v_mfma_f32_16x16x32_bf16 v[184:187], v[180:183], v[148:151], v[184:187]
    v_fmac_f32 v239, v190, v50
    v_fmac_f32 v239, v191, v51
    v_mfma_f32_16x16x32_bf16 v[188:191], v[128:131], v[144:147], 0
    v_fmac_f32 v239, v192, v52
    v_fmac_f32 v239, v193, v53
    v_mfma_f32_16x16x32_bf16 v[188:191], v[132:135], v[148:151], v[188:191]
    v_fmac_f32 v239, v194, v54
    v_fmac_f32 v239, v195, v55
    v_mfma_f32_16x16x32_bf16 v[192:195], v[128:131], v[160:163], 0
    v_fmac_f32 v239, v198, v87
    v_fmac_f32 v239, v200, v56
    v_mfma_f32_16x16x32_bf16 v[192:195], v[132:135], v[164:167], v[192:195]
    v_fmac_f32 v239, v201, v57
    v_fmac_f32 v239, v202, v58
    v_mfma_f32_16x16x32_bf16 v[196:199], v[176:179], v[160:163], 0
    v_fmac_f32 v239, v203, v59
    v_fmac_f32 v239, v204, v60
    v_mfma_f32_16x16x32_bf16 v[196:199], v[180:183], v[164:167], v[196:199]
    v_fmac_f32 v239, v205, v61
    v_fmac_f32 v239, v206, v62
    v_mfma_f32_16x16x32_bf16 v[200:203], v[144:147], v[144:147], 0
    v_fmac_f32 v239, v207, v63
    v_fmac_f32 v239, v186, v88
    v_mfma_f32_16x16x32_bf16 v[200:203], v[148:151], v[148:151], v[200:203]
    v_fmac_f32 v239, v188, v64
    v_fmac_f32 v239, v189, v65
    v_mfma_f32_16x16x32_bf16 v[204:207], v[144:147], v[160:163], 0
    v_fmac_f32 v239, v190, v66
    v_fmac_f32 v239, v191, v67
    v_mfma_f32_16x16x32_bf16 v[204:207], v[148:151], v[164:167], v[204:207]
    v_fmac_f32 v239, v192, v68
    v_fmac_f32 v239, v193, v69
    v_mfma_f32_16x16x32_bf16 v[208:211], v[160:163], v[160:163], 0
    v_fmac_f32 v239, v194, v70
    v_fmac_f32 v239, v195, v71
    v_mfma_f32_16x16x32_bf16 v[208:211], v[164:167], v[164:167], v[208:211]
    v_fmac_f32 v239, v198, v89
    s_waitcnt vmcnt(6) lgkmcnt(0)
    v_mfma_f32_16x16x32_bf16 v[184:187], v[96:99], v[96:99], 0
    v_mad_u32_u24 v214, v214, s57, v244
    v_mad_u32_u24 v215, v215, s57, v244
    v_mfma_f32_16x16x32_bf16 v[184:187], v[100:103], v[100:103], v[184:187]
    v_fmac_f32 v239, v200, v72
    v_fmac_f32 v239, v201, v73
    v_mfma_f32_16x16x32_bf16 v[188:191], v[96:99], v[104:107], 0
    v_fmac_f32 v239, v202, v74
    v_fmac_f32 v239, v203, v75
    v_mfma_f32_16x16x32_bf16 v[188:191], v[100:103], v[108:111], v[188:191]
    ds_read_b128 v[112:115], v214 offset:0
    ds_read_b128 v[116:119], v214 offset:64
    v_mfma_f32_16x16x32_bf16 v[192:195], v[176:179], v[120:123], 0
    v_fmac_f32 v239, v204, v76
    v_fmac_f32 v239, v205, v77
    v_mfma_f32_16x16x32_bf16 v[192:195], v[180:183], v[124:127], v[192:195]
    v_fmac_f32 v239, v206, v78
    v_fmac_f32 v239, v207, v79
    v_mfma_f32_16x16x32_bf16 v[196:199], v[96:99], v[120:123], 0
    v_fmac_f32 v239, v208, v80
    v_fmac_f32 v239, v209, v81
    v_mfma_f32_16x16x32_bf16 v[196:199], v[100:103], v[124:127], v[196:199]
    v_fmac_f32 v239, v210, v82
    v_fmac_f32 v239, v211, v83
    v_mfma_f32_16x16x32_bf16 v[200:203], v[176:179], v[96:99], 0
    ds_read_b128 v[128:131], v215 offset:0
    ds_read_b128 v[132:135], v215 offset:64
    v_mfma_f32_16x16x32_bf16 v[200:203], v[180:183], v[100:103], v[200:203]
    v_fmac_f32 v240, v184, v0
    v_fmac_f32 v240, v185, v1
    v_mfma_f32_16x16x32_bf16 v[204:207], v[96:99], v[136:139], 0
    v_fmac_f32 v240, v186, v2
    v_fmac_f32 v240, v187, v3
    v_mfma_f32_16x16x32_bf16 v[204:207], v[100:103], v[140:143], v[204:207]
    v_fmac_f32 v240, v188, v4
    v_fmac_f32 v240, v189, v5
    v_mfma_f32_16x16x32_bf16 v[208:211], v[176:179], v[136:139], 0
    v_fmac_f32 v240, v190, v6
    v_fmac_f32 v240, v191, v7
    v_mfma_f32_16x16x32_bf16 v[208:211], v[180:183], v[140:143], v[208:211]
    v_mad_u32_u24 v212, v212, s57, v244
    v_fmac_f32 v240, v195, v86
    v_mfma_f32_16x16x32_bf16 v[184:187], v[96:99], v[152:155], 0
    v_mad_u32_u24 v216, v216, s57, v244
    v_fmac_f32 v240, v196, v8
    v_mfma_f32_16x16x32_bf16 v[184:187], v[100:103], v[156:159], v[184:187]
    v_fmac_f32 v240, v197, v9
    v_fmac_f32 v240, v198, v10
    v_mfma_f32_16x16x32_bf16 v[188:191], v[96:99], v[168:171], 0
    v_fmac_f32 v240, v199, v11
    v_fmac_f32 v240, v203, v84
    v_mfma_f32_16x16x32_bf16 v[188:191], v[100:103], v[172:175], v[188:191]
    ds_read_b128 v[96:99], v212 offset:0
    ds_read_b128 v[100:103], v212 offset:64
    v_mfma_f32_16x16x32_bf16 v[192:195], v[104:107], v[104:107], 0
    v_fmac_f32 v240, v204, v12
    v_fmac_f32 v240, v205, v13
    v_mfma_f32_16x16x32_bf16 v[192:195], v[108:111], v[108:111], v[192:195]
    ds_read_b128 v[144:147], v216 offset:0
    ds_read_b128 v[148:151], v216 offset:64
    v_mfma_f32_16x16x32_bf16 v[196:199], v[104:107], v[120:123], 0
    v_fmac_f32 v240, v206, v14
    v_fmac_f32 v240, v207, v15
    v_mfma_f32_16x16x32_bf16 v[196:199], v[108:111], v[124:127], v[196:199]
    v_fmac_f32 v240, v211, v87
    v_fmac_f32 v240, v184, v16
    v_mfma_f32_16x16x32_bf16 v[200:203], v[176:179], v[152:155], 0
    v_fmac_f32 v240, v185, v17
    v_fmac_f32 v240, v186, v18
    v_mfma_f32_16x16x32_bf16 v[200:203], v[180:183], v[156:159], v[200:203]
    v_fmac_f32 v240, v187, v19
    v_fmac_f32 v240, v188, v20
    v_mfma_f32_16x16x32_bf16 v[204:207], v[176:179], v[104:107], 0
    v_fmac_f32 v240, v189, v21
    v_fmac_f32 v240, v190, v22
    v_mfma_f32_16x16x32_bf16 v[204:207], v[180:183], v[108:111], v[204:207]
    v_fmac_f32 v240, v191, v23
    v_mad_u32_u24 v217, v217, s57, v244
    v_mfma_f32_16x16x32_bf16 v[208:211], v[104:107], v[136:139], 0
    v_mad_u32_u24 v236, v236, s57, v244
    v_mad_u32_u24 v213, v213, s57, v244
    v_mfma_f32_16x16x32_bf16 v[208:211], v[108:111], v[140:143], v[208:211]
    v_fmac_f32 v240, v192, v24
    v_fmac_f32 v240, v193, v25
    v_mfma_f32_16x16x32_bf16 v[184:187], v[104:107], v[152:155], 0
    v_fmac_f32 v240, v194, v26
    v_fmac_f32 v240, v195, v27
    v_mfma_f32_16x16x32_bf16 v[184:187], v[108:111], v[156:159], v[184:187]
    v_fmac_f32 v240, v196, v28
    v_fmac_f32 v240, v197, v29
    v_mfma_f32_16x16x32_bf16 v[188:191], v[176:179], v[168:171], 0
    v_fmac_f32 v240, v198, v30
    v_fmac_f32 v240, v199, v31
    v_mfma_f32_16x16x32_bf16 v[188:191], v[180:183], v[172:175], v[188:191]
    ds_read_b128 v[160:163], v217 offset:0
    ds_read_b128 v[164:167], v217 offset:64
    v_mfma_f32_16x16x32_bf16 v[192:195], v[104:107], v[168:171], 0
    ds_read_b128 v[176:179], v236 offset:0
    ds_read_b128 v[180:183], v236 offset:64
    v_mfma_f32_16x16x32_bf16 v[192:195], v[108:111], v[172:175], v[192:195]
    ds_read_b128 v[104:107], v213 offset:0
    ds_read_b128 v[108:111], v213 offset:64
    v_mfma_f32_16x16x32_bf16 v[196:199], v[120:123], v[120:123], 0
    v_fmac_f32 v240, v203, v88
    v_fmac_f32 v240, v207, v85
    v_mfma_f32_16x16x32_bf16 v[196:199], v[124:127], v[124:127], v[196:199]
    buffer_load_dwordx4 v[212:215], v245, s[16:19], s74 offen offset:3200
    buffer_load_dwordx2 v[216:217], v245, s[16:19], s74 offen offset:3216
    buffer_load_dword v236, v246, s[16:19], s74 offen offset:3584
    v_mfma_f32_16x16x32_bf16 v[200:203], v[120:123], v[136:139], 0
    v_fmac_f32 v240, v208, v32
    v_fmac_f32 v240, v209, v33
    v_mfma_f32_16x16x32_bf16 v[200:203], v[124:127], v[140:143], v[200:203]
    v_fmac_f32 v240, v210, v34
    v_fmac_f32 v240, v211, v35
    v_mfma_f32_16x16x32_bf16 v[204:207], v[120:123], v[152:155], 0
    v_fmac_f32 v240, v184, v36
    v_fmac_f32 v240, v185, v37
    v_mfma_f32_16x16x32_bf16 v[204:207], v[124:127], v[156:159], v[204:207]
    v_fmac_f32 v240, v186, v38
    v_fmac_f32 v240, v187, v39
    v_mfma_f32_16x16x32_bf16 v[208:211], v[120:123], v[168:171], 0
    v_fmac_f32 v240, v191, v89
    v_fmac_f32 v240, v192, v40
    v_mfma_f32_16x16x32_bf16 v[208:211], v[124:127], v[172:175], v[208:211]
    v_fmac_f32 v240, v193, v41
    v_fmac_f32 v240, v194, v42
    v_mfma_f32_16x16x32_bf16 v[184:187], v[136:139], v[136:139], 0
    v_fmac_f32 v240, v195, v43
    v_permlane32_swap_b32 v237, v238
    v_mfma_f32_16x16x32_bf16 v[184:187], v[140:143], v[140:143], v[184:187]
    s_add_u32 s74, s74, 1600
    v_fmac_f32 v240, v196, v44
    v_mfma_f32_16x16x32_bf16 v[188:191], v[136:139], v[152:155], 0
    v_fmac_f32 v240, v197, v45
    v_fmac_f32 v240, v198, v46
    v_mfma_f32_16x16x32_bf16 v[188:191], v[140:143], v[156:159], v[188:191]
    v_fmac_f32 v240, v199, v47
    v_add_f32 v241, v237, v238
    v_mfma_f32_16x16x32_bf16 v[192:195], v[136:139], v[168:171], 0
    s_cmp_lt_u32 s74, s58
    v_fmac_f32 v240, v200, v48
    v_mfma_f32_16x16x32_bf16 v[192:195], v[140:143], v[172:175], v[192:195]
    v_fmac_f32 v240, v201, v49
    v_fmac_f32 v240, v202, v50
    v_mfma_f32_16x16x32_bf16 v[196:199], v[152:155], v[152:155], 0
    v_fmac_f32 v240, v203, v51
    v_fmac_f32 v240, v204, v52
    v_mfma_f32_16x16x32_bf16 v[196:199], v[156:159], v[156:159], v[196:199]
    v_fmac_f32 v240, v205, v53
    v_fmac_f32 v240, v206, v54
    v_mfma_f32_16x16x32_bf16 v[200:203], v[152:155], v[168:171], 0
    v_fmac_f32 v240, v207, v55
    v_fmac_f32 v240, v208, v56
    v_mfma_f32_16x16x32_bf16 v[200:203], v[156:159], v[172:175], v[200:203]
    v_fmac_f32 v240, v209, v57
    v_fmac_f32 v240, v210, v58
    v_mfma_f32_16x16x32_bf16 v[204:207], v[168:171], v[168:171], 0
    v_fmac_f32 v240, v211, v59
    v_fmac_f32 v240, v184, v60
    v_mfma_f32_16x16x32_bf16 v[204:207], v[172:175], v[172:175], v[204:207]
    v_fmac_f32 v240, v185, v61
    v_fmac_f32 v240, v186, v62
    v_fmac_f32 v240, v187, v63
    s_waitcnt vmcnt(7) lgkmcnt(0)
    s_cbranch_scc1 standalone__deep_cross_pnn__recsys_kernel_loop
    s_branch standalone__deep_cross_pnn__recsys_kernel_k2m
standalone__deep_cross_pnn__recsys_kernel_aux:

    s_setprio 0
    s_load_dwordx2 s[24:25], s[60:61], s44
    s_load_dwordx2 s[26:27], s[62:63], s44
    v_mov_b32 v8, v255
    v_mov_b32 v9, v254
    v_mov_b32 v10, v253
    v_mov_b32 v11, v252
    s_mov_b32 s51, s2
    s_mov_b32 s64, 0
    s_mov_b32 s65, 0

    v_mov_b32 v35, v83
    s_lshr_b32 s72, s2, 3
    s_mul_i32 s72, s72, 36
    s_lshr_b32 s72, s72, 5
    s_lshl_b32 s75, s36, 7
    s_add_u32 s75, s75, 254464
    s_mov_b32 s76, 143136
    s_lshl_b32 s6, s2, 15
    s_lshl_b32 s7, s56, 13
    s_add_u32 s6, s6, s7
    s_add_u32 s6, s6, 20971520
    s_add_u32 s7, s6, 4096
    s_lshl_b32 s8, s36, 7
    s_add_u32 s8, s8, s37
    s_lshl_b32 s8, s8, 9
    s_add_u32 s8, s8, 29360128
    s_and_b32 s9, s2, 63
    s_lshl_b32 s9, s9, 5
    s_lshr_b32 s10, s2, 6
    s_add_u32 s9, s9, s10
    s_lshl_b32 s9, s9, 2
    s_add_u32 s9, s9, 14680064
    v_mov_b32 v112, 0

standalone__deep_cross_pnn__recsys_kernel_unit:

    s_bfe_u32 s36, s51, 0x10003

    s_lshr_b32 s38, s51, 4
    s_and_b32 s39, s51, 7
    s_sub_u32 s57, 2, s36
    s_lshl_b32 s57, s39, s57
    s_lshl_b32 s37, s36, 5
    s_add_u32 s57, s57, s37
    s_add_u32 s57, s57, s56
    s_mul_i32 s37, s38, 48
    s_add_u32 s37, s37, s57
    s_lshl_b32 s38, s38, 1
    s_lshr_b32 s39, s39, 2
    s_add_u32 s38, s38, s39
    s_add_u32 s38, s38, 768
    s_and_b32 s57, s57, 7
    s_cmp_eq_u32 s57, 2
    s_cselect_b32 s38, s38, 1000
    s_lshl_b32 s39, s36, 1
    s_and_b32 s39, s39, s56
    s_cselect_b32 s57, s38, s37

    s_lshr_b32 s37, s51, 4
    s_lshl_b32 s37, s37, 3
    s_and_b32 s38, s51, 7
    s_or_b32 s37, s37, s38
    s_and_b32 s58, s56, 1
    s_lshl_b32 s59, s37, 1
    s_add_u32 s58, s58, s59
    s_lshr_b32 s59, s56, 1
    s_xor_b32 s60, s36, 1
    s_mul_i32 s46, s60, 13
    s_lshl_b32 s60, s60, 1
    s_add_u32 s59, s59, s60
    s_add_u32 s61, s46, 6
    s_add_u32 s60, s46, 12
    s_bitcmp1_b32 s59, 0
    s_cselect_b32 s46, s60, s46
    s_cselect_b32 s63, -1, 1
    s_cselect_b32 s61, 24, s61
    v_lshrrev_b32 v1, 3, v8
    v_and_b32 v2, 7, v8
    v_mul_i32_i24 v7, s63, v2
    v_add_u32 v7, s46, v7
    v_cmp_ge_u32 s[48:49], s61, v7
    s_mul_i32 s60, s58, 25600
    s_movk_i32 s61, 400
    s_lshl_b32 s63, s63, 16
    v_mul_u32_u24 v0, s61, v1
    v_lshl_add_u32 v0, v7, 4, v0
    v_and_b32 v5, 15, v8
    v_and_b32 v6, 48, v8
    v_lshl_add_u32 v56, v5, 8, v6
    s_lshr_b32 s44, s37, 1
    s_lshl_b32 s44, s44, 12
    s_lshl_b32 s38, s36, 1
    s_and_b32 s39, s37, 1
    s_add_u32 s38, s38, s39
    s_lshl_b32 s38, s38, 6
    s_add_u32 s44, s44, s38
    s_lshl_b32 s47, s36, 7
    s_add_u32 s47, s47, s37
    s_lshl_b32 s47, s47, 10
    s_add_u32 s47, s47, 15204352

    s_cmp_eq_u32 s56, 0
    s_cselect_b64 s[4:5], -1, 0
    s_cmp_lg_u32 s64, 0
    s_cbranch_scc1 standalone__deep_cross_pnn__recsys_kernel_nd1
    s_mov_b64 exec, s[40:41]

    s_mul_i32 s73, s72, 4032
    s_mul_i32 s74, s72, 7168
    s_add_u32 s73, s73, s43
    s_add_u32 s74, s74, s42
    s_min_u32 m0, s73, s76
    s_min_u32 s74, s74, s75
    s_add_u32 s72, s72, 1

    buffer_load_dwordx4 v35, s[20:23], s74 offen lds
    s_cmp_eq_u32 s72, 36
    s_cselect_b32 s72, 0, s72

    s_mul_i32 s73, s72, 4032
    s_mul_i32 s74, s72, 7168
    s_add_u32 s73, s73, s43
    s_add_u32 s74, s74, s42
    s_min_u32 m0, s73, s76
    s_min_u32 s74, s74, s75
    s_add_u32 s72, s72, 1

    buffer_load_dwordx4 v35, s[20:23], s74 offen lds
    s_cmp_eq_u32 s72, 36
    s_cselect_b32 s72, 0, s72

    s_mul_i32 s73, s72, 4032
    s_mul_i32 s74, s72, 7168
    s_add_u32 s73, s73, s43
    s_add_u32 s74, s74, s42
    s_min_u32 m0, s73, s76
    s_min_u32 s74, s74, s75
    s_add_u32 s72, s72, 1

    buffer_load_dwordx4 v35, s[20:23], s74 offen lds
    s_cmp_eq_u32 s72, 36
    s_cselect_b32 s72, 0, s72

    s_mul_i32 s73, s72, 4032
    s_mul_i32 s74, s72, 7168
    s_add_u32 s73, s73, s43
    s_add_u32 s74, s74, s42
    s_min_u32 m0, s73, s76
    s_min_u32 s74, s74, s75
    s_add_u32 s72, s72, 1

    buffer_load_dwordx4 v35, s[20:23], s74 offen lds
    s_cmp_eq_u32 s72, 36
    s_cselect_b32 s72, 0, s72

    s_mul_i32 s73, s72, 4032
    s_mul_i32 s74, s72, 7168
    s_add_u32 s73, s73, s43
    s_add_u32 s74, s74, s42
    s_min_u32 m0, s73, s76
    s_min_u32 s74, s74, s75
    s_add_u32 s72, s72, 1

    buffer_load_dwordx4 v35, s[20:23], s74 offen lds
    s_cmp_eq_u32 s72, 36
    s_cselect_b32 s72, 0, s72

    s_mul_i32 s73, s72, 4032
    s_mul_i32 s74, s72, 7168
    s_add_u32 s73, s73, s43
    s_add_u32 s74, s74, s42
    s_min_u32 m0, s73, s76
    s_min_u32 s74, s74, s75
    s_add_u32 s72, s72, 1

    buffer_load_dwordx4 v35, s[20:23], s74 offen lds
    s_cmp_eq_u32 s72, 36
    s_cselect_b32 s72, 0, s72

    s_mul_i32 s73, s72, 4032
    s_mul_i32 s74, s72, 7168
    s_add_u32 s73, s73, s43
    s_add_u32 s74, s74, s42
    s_min_u32 m0, s73, s76
    s_min_u32 s74, s74, s75
    s_add_u32 s72, s72, 1

    buffer_load_dwordx4 v35, s[20:23], s74 offen lds
    s_cmp_eq_u32 s72, 36
    s_cselect_b32 s72, 0, s72

    s_mul_i32 s73, s72, 4032
    s_mul_i32 s74, s72, 7168
    s_add_u32 s73, s73, s43
    s_add_u32 s74, s74, s42
    s_min_u32 m0, s73, s76
    s_min_u32 s74, s74, s75
    s_add_u32 s72, s72, 1

    buffer_load_dwordx4 v35, s[20:23], s74 offen lds
    s_cmp_eq_u32 s72, 36
    s_cselect_b32 s72, 0, s72

    s_mul_i32 s73, s72, 4032
    s_mul_i32 s74, s72, 7168
    s_add_u32 s73, s73, s43
    s_add_u32 s74, s74, s42
    s_min_u32 m0, s73, s76
    s_min_u32 s74, s74, s75
    s_add_u32 s72, s72, 1
    s_barrier

    buffer_load_dwordx4 v35, s[20:23], s74 offen lds
    s_cmp_eq_u32 s72, 36
    s_cselect_b32 s72, 0, s72

    s_mul_i32 s73, s72, 4032
    s_mul_i32 s74, s72, 7168
    s_add_u32 s73, s73, s43
    s_add_u32 s74, s74, s42
    s_min_u32 m0, s73, s76
    s_min_u32 s74, s74, s75
    s_add_u32 s72, s72, 1

    buffer_load_dwordx4 v35, s[20:23], s74 offen lds
    s_cmp_eq_u32 s72, 36
    s_cselect_b32 s72, 0, s72

    s_mul_i32 s73, s72, 4032
    s_mul_i32 s74, s72, 7168
    s_add_u32 s73, s73, s43
    s_add_u32 s74, s74, s42
    s_min_u32 m0, s73, s76
    s_min_u32 s74, s74, s75
    s_add_u32 s72, s72, 1

    buffer_load_dwordx4 v35, s[20:23], s74 offen lds
    s_cmp_eq_u32 s72, 36
    s_cselect_b32 s72, 0, s72

    s_mul_i32 s73, s72, 4032
    s_mul_i32 s74, s72, 7168
    s_add_u32 s73, s73, s43
    s_add_u32 s74, s74, s42
    s_min_u32 m0, s73, s76
    s_min_u32 s74, s74, s75
    s_add_u32 s72, s72, 1

    buffer_load_dwordx4 v35, s[20:23], s74 offen lds
    s_cmp_eq_u32 s72, 36
    s_cselect_b32 s72, 0, s72

    s_mov_b64 exec, -1
standalone__deep_cross_pnn__recsys_kernel_nd1:

    s_lshr_b32 s78, s57, 5
    s_bfe_u32 s79, s57, 0x20003
    s_bfe_u32 s80, s57, 0x20001
    s_and_b32 s81, s57, 1
    s_lshl_b32 s77, s78, 2
    s_lshl_b32 s83, s81, 1
    s_add_u32 s77, s77, s83
    s_lshl_b32 s77, s77, 7
    s_lshl_b32 s83, s79, 5
    s_add_u32 s77, s77, s83
    s_lshl_b32 s83, s80, 3
    s_add_u32 s77, s77, s83
    s_lshl_b32 s77, s77, 10
    s_lshl_b32 s82, s78, 12
    s_lshl_b32 s83, s79, 10
    s_add_u32 s82, s82, s83
    s_lshl_b32 s83, s80, 8
    s_add_u32 s82, s82, s83
    s_lshl_b32 s83, s81, 7
    s_add_u32 s82, s82, s83
    s_mov_b32 s84, 205312
    v_lshrrev_b32 v3, 2, v8
    v_and_b32 v4, 3, v8
    v_mul_lo_u32 v14, v3, s84
    v_lshl_add_u32 v14, v4, 4, v14
    s_cmp_ge_u32 s57, 800
    s_cselect_b32 s83, 0x40000000, 0
    v_or_b32 v14, s83, v14
    s_mul_i32 s61, s56, 4608
    s_add_u32 s61, s61, 144256
    v_and_b32 v3, 3, v3
    v_lshlrev_b32 v36, 6, v8
    v_lshl_add_u32 v36, v3, 4, v36
    v_add_u32 v36, s61, v36
    v_xor_b32 v37, 16, v36
    v_xor_b32 v38, 32, v36
    v_xor_b32 v39, 48, v36
    v_and_b32 v3, 48, v8
    v_xor_b32 v15, v3, v9
    v_add_u32 v15, s61, v15
    s_mov_b32 s84, 0x05040100
    s_mov_b32 s85, 0x07060302

    s_cmp_lg_u32 s64, 0
    s_cbranch_scc1 standalone__deep_cross_pnn__recsys_kernel_nd2
    s_mov_b64 exec, s[40:41]

    s_mul_i32 s73, s72, 4032
    s_mul_i32 s74, s72, 7168
    s_add_u32 s73, s73, s43
    s_add_u32 s74, s74, s42
    s_min_u32 m0, s73, s76
    s_min_u32 s74, s74, s75
    s_add_u32 s72, s72, 1

    buffer_load_dwordx4 v35, s[20:23], s74 offen lds
    s_cmp_eq_u32 s72, 36
    s_cselect_b32 s72, 0, s72

    s_mul_i32 s73, s72, 4032
    s_mul_i32 s74, s72, 7168
    s_add_u32 s73, s73, s43
    s_add_u32 s74, s74, s42
    s_min_u32 m0, s73, s76
    s_min_u32 s74, s74, s75
    s_add_u32 s72, s72, 1

    buffer_load_dwordx4 v35, s[20:23], s74 offen lds
    s_cmp_eq_u32 s72, 36
    s_cselect_b32 s72, 0, s72

    s_mul_i32 s73, s72, 4032
    s_mul_i32 s74, s72, 7168
    s_add_u32 s73, s73, s43
    s_add_u32 s74, s74, s42
    s_min_u32 m0, s73, s76
    s_min_u32 s74, s74, s75
    s_add_u32 s72, s72, 1

    buffer_load_dwordx4 v35, s[20:23], s74 offen lds
    s_cmp_eq_u32 s72, 36
    s_cselect_b32 s72, 0, s72

    s_mul_i32 s73, s72, 4032
    s_mul_i32 s74, s72, 7168
    s_add_u32 s73, s73, s43
    s_add_u32 s74, s74, s42
    s_min_u32 m0, s73, s76
    s_min_u32 s74, s74, s75
    s_add_u32 s72, s72, 1

    buffer_load_dwordx4 v35, s[20:23], s74 offen lds
    s_cmp_eq_u32 s72, 36
    s_cselect_b32 s72, 0, s72

    s_mul_i32 s73, s72, 4032
    s_mul_i32 s74, s72, 7168
    s_add_u32 s73, s73, s43
    s_add_u32 s74, s74, s42
    s_min_u32 m0, s73, s76
    s_min_u32 s74, s74, s75
    s_add_u32 s72, s72, 1

    buffer_load_dwordx4 v35, s[20:23], s74 offen lds
    s_cmp_eq_u32 s72, 36
    s_cselect_b32 s72, 0, s72

    s_mul_i32 s73, s72, 4032
    s_mul_i32 s74, s72, 7168
    s_add_u32 s73, s73, s43
    s_add_u32 s74, s74, s42
    s_min_u32 m0, s73, s76
    s_min_u32 s74, s74, s75
    s_add_u32 s72, s72, 1

    buffer_load_dwordx4 v35, s[20:23], s74 offen lds
    s_cmp_eq_u32 s72, 36
    s_cselect_b32 s72, 0, s72

    s_mul_i32 s73, s72, 4032
    s_mul_i32 s74, s72, 7168
    s_add_u32 s73, s73, s43
    s_add_u32 s74, s74, s42
    s_min_u32 m0, s73, s76
    s_min_u32 s74, s74, s75
    s_add_u32 s72, s72, 1

    buffer_load_dwordx4 v35, s[20:23], s74 offen lds
    s_cmp_eq_u32 s72, 36
    s_cselect_b32 s72, 0, s72

    s_mul_i32 s73, s72, 4032
    s_mul_i32 s74, s72, 7168
    s_add_u32 s73, s73, s43
    s_add_u32 s74, s74, s42
    s_min_u32 m0, s73, s76
    s_min_u32 s74, s74, s75
    s_add_u32 s72, s72, 1

    buffer_load_dwordx4 v35, s[20:23], s74 offen lds
    s_cmp_eq_u32 s72, 36
    s_cselect_b32 s72, 0, s72

    s_mul_i32 s73, s72, 4032
    s_mul_i32 s74, s72, 7168
    s_add_u32 s73, s73, s43
    s_add_u32 s74, s74, s42
    s_min_u32 m0, s73, s76
    s_min_u32 s74, s74, s75
    s_add_u32 s72, s72, 1

    buffer_load_dwordx4 v35, s[20:23], s74 offen lds
    s_cmp_eq_u32 s72, 36
    s_cselect_b32 s72, 0, s72

    s_mul_i32 s73, s72, 4032
    s_mul_i32 s74, s72, 7168
    s_add_u32 s73, s73, s43
    s_add_u32 s74, s74, s42
    s_min_u32 m0, s73, s76
    s_min_u32 s74, s74, s75
    s_add_u32 s72, s72, 1

    buffer_load_dwordx4 v35, s[20:23], s74 offen lds
    s_cmp_eq_u32 s72, 36
    s_cselect_b32 s72, 0, s72

    s_mul_i32 s73, s72, 4032
    s_mul_i32 s74, s72, 7168
    s_add_u32 s73, s73, s43
    s_add_u32 s74, s74, s42
    s_min_u32 m0, s73, s76
    s_min_u32 s74, s74, s75
    s_add_u32 s72, s72, 1

    buffer_load_dwordx4 v35, s[20:23], s74 offen lds
    s_cmp_eq_u32 s72, 36
    s_cselect_b32 s72, 0, s72

    s_mul_i32 s73, s72, 4032
    s_mul_i32 s74, s72, 7168
    s_add_u32 s73, s73, s43
    s_add_u32 s74, s74, s42
    s_min_u32 m0, s73, s76
    s_min_u32 s74, s74, s75
    s_add_u32 s72, s72, 1

    buffer_load_dwordx4 v35, s[20:23], s74 offen lds
    s_cmp_eq_u32 s72, 36
    s_cselect_b32 s72, 0, s72

    s_mul_i32 s73, s72, 4032
    s_mul_i32 s74, s72, 7168
    s_add_u32 s73, s73, s43
    s_add_u32 s74, s74, s42
    s_min_u32 m0, s73, s76
    s_min_u32 s74, s74, s75
    s_add_u32 s72, s72, 1

    buffer_load_dwordx4 v35, s[20:23], s74 offen lds
    s_cmp_eq_u32 s72, 36
    s_cselect_b32 s72, 0, s72

    s_mul_i32 s73, s72, 4032
    s_mul_i32 s74, s72, 7168
    s_add_u32 s73, s73, s43
    s_add_u32 s74, s74, s42
    s_min_u32 m0, s73, s76
    s_min_u32 s74, s74, s75
    s_add_u32 s72, s72, 1

    buffer_load_dwordx4 v35, s[20:23], s74 offen lds
    s_cmp_eq_u32 s72, 36
    s_cselect_b32 s72, 0, s72

    s_mul_i32 s73, s72, 4032
    s_mul_i32 s74, s72, 7168
    s_add_u32 s73, s73, s43
    s_add_u32 s74, s74, s42
    s_min_u32 m0, s73, s76
    s_min_u32 s74, s74, s75
    s_add_u32 s72, s72, 1

    buffer_load_dwordx4 v35, s[20:23], s74 offen lds
    s_cmp_eq_u32 s72, 36
    s_cselect_b32 s72, 0, s72

    s_mul_i32 s73, s72, 4032
    s_mul_i32 s74, s72, 7168
    s_add_u32 s73, s73, s43
    s_add_u32 s74, s74, s42
    s_min_u32 m0, s73, s76
    s_min_u32 s74, s74, s75
    s_add_u32 s72, s72, 1

    buffer_load_dwordx4 v35, s[20:23], s74 offen lds
    s_cmp_eq_u32 s72, 36
    s_cselect_b32 s72, 0, s72

    s_mul_i32 s73, s72, 4032
    s_mul_i32 s74, s72, 7168
    s_add_u32 s73, s73, s43
    s_add_u32 s74, s74, s42
    s_min_u32 m0, s73, s76
    s_min_u32 s74, s74, s75
    s_add_u32 s72, s72, 1

    buffer_load_dwordx4 v35, s[20:23], s74 offen lds
    s_cmp_eq_u32 s72, 36
    s_cselect_b32 s72, 0, s72

    s_mul_i32 s73, s72, 4032
    s_mul_i32 s74, s72, 7168
    s_add_u32 s73, s73, s43
    s_add_u32 s74, s74, s42
    s_min_u32 m0, s73, s76
    s_min_u32 s74, s74, s75
    s_add_u32 s72, s72, 1

    buffer_load_dwordx4 v35, s[20:23], s74 offen lds
    s_cmp_eq_u32 s72, 36
    s_cselect_b32 s72, 0, s72

    s_mul_i32 s73, s72, 4032
    s_mul_i32 s74, s72, 7168
    s_add_u32 s73, s73, s43
    s_add_u32 s74, s74, s42
    s_min_u32 m0, s73, s76
    s_min_u32 s74, s74, s75
    s_add_u32 s72, s72, 1

    buffer_load_dwordx4 v35, s[20:23], s74 offen lds
    s_cmp_eq_u32 s72, 36
    s_cselect_b32 s72, 0, s72

    s_mul_i32 s73, s72, 4032
    s_mul_i32 s74, s72, 7168
    s_add_u32 s73, s73, s43
    s_add_u32 s74, s74, s42
    s_min_u32 m0, s73, s76
    s_min_u32 s74, s74, s75
    s_add_u32 s72, s72, 1

    buffer_load_dwordx4 v35, s[20:23], s74 offen lds
    s_cmp_eq_u32 s72, 36
    s_cselect_b32 s72, 0, s72

    s_mul_i32 s73, s72, 4032
    s_mul_i32 s74, s72, 7168
    s_add_u32 s73, s73, s43
    s_add_u32 s74, s74, s42
    s_min_u32 m0, s73, s76
    s_min_u32 s74, s74, s75
    s_add_u32 s72, s72, 1

    buffer_load_dwordx4 v35, s[20:23], s74 offen lds
    s_cmp_eq_u32 s72, 36
    s_cselect_b32 s72, 0, s72

    s_mul_i32 s73, s72, 4032
    s_mul_i32 s74, s72, 7168
    s_add_u32 s73, s73, s43
    s_add_u32 s74, s74, s42
    s_min_u32 m0, s73, s76
    s_min_u32 s74, s74, s75
    s_add_u32 s72, s72, 1

    buffer_load_dwordx4 v35, s[20:23], s74 offen lds
    s_cmp_eq_u32 s72, 36
    s_cselect_b32 s72, 0, s72

    s_mul_i32 s73, s72, 4032
    s_mul_i32 s74, s72, 7168
    s_add_u32 s73, s73, s43
    s_add_u32 s74, s74, s42
    s_min_u32 m0, s73, s76
    s_min_u32 s74, s74, s75
    s_add_u32 s72, s72, 1

    buffer_load_dwordx4 v35, s[20:23], s74 offen lds
    s_cmp_eq_u32 s72, 36
    s_cselect_b32 s72, 0, s72

    s_mul_i32 s73, s72, 4032
    s_mul_i32 s74, s72, 7168
    s_add_u32 s73, s73, s43
    s_add_u32 s74, s74, s42
    s_min_u32 m0, s73, s76
    s_min_u32 s74, s74, s75
    s_add_u32 s72, s72, 1

    buffer_load_dwordx4 v35, s[20:23], s74 offen lds
    s_cmp_eq_u32 s72, 36
    s_cselect_b32 s72, 0, s72

    s_mov_b64 exec, -1
standalone__deep_cross_pnn__recsys_kernel_nd2:

    s_cmp_lg_u32 s64, 0
    s_cbranch_scc1 standalone__deep_cross_pnn__recsys_kernel_nsig
    s_waitcnt vmcnt(0)
    s_barrier

standalone__deep_cross_pnn__recsys_kernel_nsig:
    s_mov_b64 exec, s[48:49]
    buffer_load_dwordx4 v[224:227], v0, s[16:19], s60 offen
    s_add_u32 s60, s60, 3200
    buffer_load_dwordx4 v[228:231], v0, s[16:19], s60 offen
    s_add_u32 s60, s60, 3200
    buffer_load_dwordx4 v[232:235], v0, s[16:19], s60 offen
    s_add_u32 s60, s60, 3200
    buffer_load_dwordx4 v[236:239], v0, s[16:19], s60 offen
    s_add_u32 s60, s60, 3200
    buffer_load_dwordx4 v[240:243], v0, s[16:19], s60 offen
    s_add_u32 s60, s60, 3200
    buffer_load_dwordx4 v[244:247], v0, s[16:19], s60 offen
    s_add_u32 s60, s60, 3200
    buffer_load_dwordx4 v[248:251], v0, s[16:19], s60 offen
    s_add_u32 s60, s60, 3200
    buffer_load_dwordx4 v[252:255], v0, s[16:19], s60 offen
    s_add_u32 s60, s60, 3200
    s_mov_b64 exec, -1
    s_setprio 1

    s_lshl_b32 s61, s56, 8
    s_add_u32 s61, s61, 162688
    v_lshlrev_b32 v86, 2, v8
    v_add_u32 v86, s61, v86
    v_and_b32 v85, 0xffffff80, v86
    v_lshrrev_b32 v27, 5, v8
    v_mul_u32_u24 v27, 0x40404, v27
    v_lshl_or_b32 v27, v27, 8, v27
    s_mul_i32 s61, s56, 4608
    s_add_u32 s61, s61, 144256
    v_mul_u32_u24 v31, 72, v8
    v_add3_u32 v31, s61, v31, -8
    v_mul_u32_u24 v34, 72, v1
    v_lshl_add_u32 v34, v2, 3, v34
    v_add_u32 v34, s61, v34
    v_mul_u32_u24 v3, 52, v7
    v_lshrrev_b32 v3, 8, v3
    v_mad_i32_i24 v2, v3, -5, v7
    v_mov_b32 v13, 0
    v_mul_u32_u24 v2, 0x10001, v2
    v_lshlrev_b32 v2, 12, v2
    v_add_u32 v32, 67108864, v2
    v_add_u32 v33, 201328640, v2
    s_cmp_eq_u32 s59, 3
    s_cselect_b32 s61, 0x0fffff00, -16
    s_cmp_eq_u32 s59, 1
    s_cselect_b32 s61, 0x0ffffff0, s61
    v_mov_b32 v59, s61
    s_lshr_b32 s62, s58, 7
    s_mul_i32 s62, s62, 25
    s_min_u32 s46, s46, 24
    s_add_u32 s62, s62, s46
    s_lshl_b32 s62, s62, 3
    s_bfe_u32 s61, s58, 0x30004
    s_add_u32 s62, s62, s61
    s_lshl_b32 s62, s62, 13
    s_bfe_u32 s61, s58, 0x30001
    s_lshl_b32 s61, s61, 10
    s_add_u32 s62, s62, s61
    s_and_b32 s61, s58, 1
    s_lshl_b32 s46, s61, 2
    s_add_u32 s46, s46, 163712
    s_lshl_b32 s61, s61, 9
    s_add_u32 s62, s62, s61
    s_add_u32 s62, s62, 16777216
    v_and_b32 v30, 31, v8
    v_lshrrev_b32 v3, 5, v8
    v_lshlrev_b32 v30, 4, v30
    v_lshl_add_u32 v30, v3, 3, v30
    s_movk_i32 s66, 0x7c
    s_mov_b32 s67, 0x03030303
    s_mov_b32 s75, 0x06040200
    v_mov_b32 v57, 0x08040201
    v_mov_b32 v58, 0x80402010
    v_mov_b32 v108, 0xff800001
    v_mov_b32 v109, 0xff800001
    v_mov_b32 v110, 0xff800001
    v_mov_b32 v111, 0xff800001
    s_mov_b64 exec, s[48:49]

    s_waitcnt vmcnt(7)
    v_lshl_or_b32 v224, v225, 16, v224
    v_lshl_or_b32 v225, v227, 16, v226
    v_add_u32 v224, v32, v224
    v_add_u32 v225, v33, v225
    ds_write_b64 v34, v[224:225] offset:0

    s_waitcnt vmcnt(6)
    v_lshl_or_b32 v228, v229, 16, v228
    v_lshl_or_b32 v229, v231, 16, v230
    v_add_u32 v228, v32, v228
    v_add_u32 v229, v33, v229
    ds_write_b64 v34, v[228:229] offset:576

    s_waitcnt vmcnt(5)
    v_lshl_or_b32 v232, v233, 16, v232
    v_lshl_or_b32 v233, v235, 16, v234
    v_add_u32 v232, v32, v232
    v_add_u32 v233, v33, v233
    ds_write_b64 v34, v[232:233] offset:1152

    s_waitcnt vmcnt(4)
    v_lshl_or_b32 v236, v237, 16, v236
    v_lshl_or_b32 v237, v239, 16, v238
    v_add_u32 v236, v32, v236
    v_add_u32 v237, v33, v237
    ds_write_b64 v34, v[236:237] offset:1728

    s_waitcnt vmcnt(3)
    v_lshl_or_b32 v240, v241, 16, v240
    v_lshl_or_b32 v241, v243, 16, v242
    v_add_u32 v240, v32, v240
    v_add_u32 v241, v33, v241
    ds_write_b64 v34, v[240:241] offset:2304

    s_waitcnt vmcnt(2)
    v_lshl_or_b32 v244, v245, 16, v244
    v_lshl_or_b32 v245, v247, 16, v246
    v_add_u32 v244, v32, v244
    v_add_u32 v245, v33, v245
    ds_write_b64 v34, v[244:245] offset:2880

    s_waitcnt vmcnt(1)
    v_lshl_or_b32 v248, v249, 16, v248
    v_lshl_or_b32 v249, v251, 16, v250
    v_add_u32 v248, v32, v248
    v_add_u32 v249, v33, v249
    ds_write_b64 v34, v[248:249] offset:3456

    s_waitcnt vmcnt(0)
    v_lshl_or_b32 v252, v253, 16, v252
    v_lshl_or_b32 v253, v255, 16, v254
    v_add_u32 v252, v32, v252
    v_add_u32 v253, v33, v253
    ds_write_b64 v34, v[252:253] offset:4032

    s_mov_b64 exec, -1
    ds_read_b64 v[40:41], v31 offset:8
    ds_read_b64 v[42:43], v31 offset:16
    ds_read_b64 v[44:45], v31 offset:24
    ds_read_b64 v[46:47], v31 offset:32
    ds_read_b64 v[48:49], v31 offset:40
    ds_read_b64 v[50:51], v31 offset:48
    ds_read_b64 v[52:53], v31 offset:56
    ds_read_b64 v[54:55], v31 offset:64

    s_waitcnt lgkmcnt(7)
    v_perm_b32 v60, v41, v40, s75
    v_lshlrev_b32 v72, 2, v60

    v_lshrrev_b32 v61, 3, v60
    v_and_b32 v60, 0x07070707, v60
    v_and_or_b32 v0, v61, s67, v27
    v_perm_b32 v16, v58, v57, v60
    v_add_u32 v64, v57, v16

    s_waitcnt lgkmcnt(6)
    v_perm_b32 v60, v43, v42, s75
    v_lshlrev_b32 v73, 2, v60

    v_lshrrev_b32 v61, 3, v60
    v_and_b32 v60, 0x07070707, v60
    v_and_or_b32 v1, v61, s67, v27
    v_perm_b32 v17, v58, v57, v60
    v_add_u32 v65, v57, v17

    s_waitcnt lgkmcnt(5)
    v_perm_b32 v60, v45, v44, s75
    v_lshlrev_b32 v74, 2, v60

    v_lshrrev_b32 v61, 3, v60
    v_and_b32 v60, 0x07070707, v60
    v_and_or_b32 v2, v61, s67, v27
    v_perm_b32 v18, v58, v57, v60
    v_add_u32 v66, v57, v18

    s_waitcnt lgkmcnt(4)
    v_perm_b32 v60, v47, v46, s75
    v_lshlrev_b32 v75, 2, v60

    v_lshrrev_b32 v61, 3, v60
    v_and_b32 v60, 0x07070707, v60
    v_and_or_b32 v3, v61, s67, v27
    v_perm_b32 v19, v58, v57, v60
    v_add_u32 v67, v57, v19

    s_waitcnt lgkmcnt(3)
    v_perm_b32 v60, v49, v48, s75
    v_lshlrev_b32 v76, 2, v60

    v_lshrrev_b32 v61, 3, v60
    v_and_b32 v60, 0x07070707, v60
    v_and_or_b32 v4, v61, s67, v27
    v_perm_b32 v20, v58, v57, v60
    v_add_u32 v68, v57, v20

    s_waitcnt lgkmcnt(2)
    v_perm_b32 v60, v51, v50, s75
    v_lshlrev_b32 v77, 2, v60

    v_lshrrev_b32 v61, 3, v60
    v_and_b32 v60, 0x07070707, v60
    v_and_or_b32 v5, v61, s67, v27
    v_perm_b32 v21, v58, v57, v60
    v_add_u32 v69, v57, v21

    s_waitcnt lgkmcnt(1)
    v_perm_b32 v60, v53, v52, s75
    v_lshlrev_b32 v78, 2, v60

    v_lshrrev_b32 v61, 3, v60
    v_and_b32 v60, 0x07070707, v60
    v_and_or_b32 v6, v61, s67, v27
    v_perm_b32 v22, v58, v57, v60
    v_add_u32 v70, v57, v22

    s_waitcnt lgkmcnt(0)
    v_perm_b32 v60, v55, v54, s75
    v_lshlrev_b32 v79, 2, v60

    v_lshrrev_b32 v61, 3, v60
    v_and_b32 v60, 0x07070707, v60
    v_and_or_b32 v7, v61, s67, v27
    v_perm_b32 v23, v58, v57, v60
    v_add_u32 v71, v57, v23

    ds_write_b32 v86, v13
    s_cmp_eq_u32 s59, 3
    s_cbranch_scc1 standalone__deep_cross_pnn__recsys_kernel_sk1
    v_add_u32 v63, v58, v16
    v_ffbl_b32 v84, v59
    v_perm_b32 v60, v72, v72, v84
    v_and_or_b32 v60, v60, s66, v85
    ds_add_rtn_u32 v87, v60, v10
    ds_wrxchg_rtn_b32 v116, v86, v13

    s_waitcnt lgkmcnt(0)
    v_cmp_gt_u32 s[68:69], 2, v116

    s_nop 0
    v_cmpx_le_u32 vcc, 2, v87
    v_mov_b32 v62, s69
    v_perm_b32 v121, v62, s68, v1
    v_perm_b32 v122, v62, s68, v0
    v_and_b32 v121, v121, v17
    v_and_b32 v122, v122, v16
    v_msad_u8 v120, v65, v121, 0
    v_lshlrev_b32 v120, 8, v120
    v_msad_u8 v120, v63, v122, v120
    v_and_b32 v120, v120, v59

    v_ffbl_b32 v120, v120
    v_max_i32 v84, v84, v120
    s_mov_b64 exec, -1
    v_lshl_add_u32 v59, -1, v84, v59

    v_lshl_add_u32 v61, v84, 1, v31
    ds_read_u16 v80, v61 offset:0
    s_setprio 0
    v_ffbl_b32 v84, v59
    v_perm_b32 v60, v72, v72, v84
    v_and_or_b32 v60, v60, s66, v85
    ds_add_rtn_u32 v87, v60, v10
    ds_wrxchg_rtn_b32 v116, v86, v13

    s_waitcnt lgkmcnt(0)
    v_cmp_gt_u32 s[68:69], 2, v116

    s_nop 0
    v_cmpx_le_u32 vcc, 2, v87
    v_mov_b32 v62, s69
    v_perm_b32 v121, v62, s68, v1
    v_perm_b32 v122, v62, s68, v0
    v_and_b32 v121, v121, v17
    v_and_b32 v122, v122, v16
    v_msad_u8 v120, v65, v121, 0
    v_lshlrev_b32 v120, 8, v120
    v_msad_u8 v120, v63, v122, v120
    v_and_b32 v120, v120, v59

    v_ffbl_b32 v120, v120
    v_max_i32 v84, v84, v120
    s_mov_b64 exec, -1
    v_lshl_add_u32 v59, -1, v84, v59

    v_lshl_add_u32 v61, v84, 1, v31
    ds_read_u16 v81, v61 offset:0
    s_setprio 1
    v_ffbl_b32 v84, v59
    v_perm_b32 v60, v72, v72, v84
    v_and_or_b32 v60, v60, s66, v85
    ds_add_rtn_u32 v87, v60, v10
    ds_wrxchg_rtn_b32 v116, v86, v13

    s_waitcnt lgkmcnt(0)
    v_cmp_gt_u32 s[68:69], 2, v116

    s_nop 0
    v_cmpx_le_u32 vcc, 2, v87
    v_mov_b32 v62, s69
    v_perm_b32 v121, v62, s68, v1
    v_perm_b32 v122, v62, s68, v0
    v_and_b32 v121, v121, v17
    v_and_b32 v122, v122, v16
    v_msad_u8 v120, v65, v121, 0
    v_lshlrev_b32 v120, 8, v120
    v_msad_u8 v120, v63, v122, v120
    v_and_b32 v120, v120, v59

    v_ffbl_b32 v120, v120
    v_max_i32 v84, v84, v120
    s_mov_b64 exec, -1
    v_lshl_add_u32 v59, -1, v84, v59

    v_lshl_add_u32 v61, v84, 1, v31
    ds_read_u16 v82, v61 offset:0
    s_setprio 0
    v_ffbl_b32 v84, v59
    v_perm_b32 v60, v72, v72, v84
    v_and_or_b32 v60, v60, s66, v85
    ds_add_rtn_u32 v87, v60, v10
    ds_wrxchg_rtn_b32 v116, v86, v13

    s_waitcnt lgkmcnt(0)
    v_cmp_gt_u32 s[68:69], 2, v116

    s_nop 0
    v_cmpx_le_u32 vcc, 2, v87
    v_mov_b32 v62, s69
    v_perm_b32 v121, v62, s68, v1
    v_and_b32 v121, v121, v17
    v_msad_u8 v120, v65, v121, 0
    v_and_b32_sdwa v120, v120, v59 dst_sel:BYTE_1 dst_unused:UNUSED_PAD src0_sel:DWORD src1_sel:BYTE_1
    s_nop 0

    v_ffbl_b32 v120, v120
    v_max_i32 v84, v84, v120
    s_mov_b64 exec, -1
    v_lshl_add_u32 v59, -1, v84, v59

    v_lshl_add_u32 v61, v84, 1, v31
    ds_read_u16 v83, v61 offset:0
standalone__deep_cross_pnn__recsys_kernel_sk1:
    v_lshrrev_b32 v59, 4, v59
    v_add_u32 v63, v58, v17
    s_setprio 1
    v_ffbl_b32 v84, v59
    v_perm_b32 v60, v73, v72, v84
    v_and_or_b32 v60, v60, s66, v85

    v_cmpx_ge_u32 vcc, 0, v84
    ds_add_u32 v60, v10
    s_not_b64 s[70:71], vcc
    s_mov_b64 exec, s[70:71]
    ds_add_rtn_u32 v87, v60, v10
    s_mov_b64 exec, -1

    ds_wrxchg_rtn_b32 v116, v86, v13
    v_lshlrev_b32 v104, 13, v8
    s_cmp_eq_u32 s64, 0
    s_cselect_b32 s45, s4, 0
    s_and_b32 exec_lo, s45, 3
    s_mov_b32 exec_hi, 0
    buffer_store_dword v13, v104, s[12:15], s9 offen sc1
    s_mov_b64 exec, -1
    buffer_load_dwordx4 v[128:131], v9, s[28:31], s77 offen offset:0
    buffer_load_dwordx4 v[132:135], v9, s[28:31], s77 offen offset:1024

    s_waitcnt lgkmcnt(0)
    v_cmp_gt_u32 s[68:69], 2, v116

    s_cmp_eq_u32 s59, 3
    s_cbranch_scc1 standalone__deep_cross_pnn__recsys_kernel_nf1
    v_lshl_or_b32 v24, v81, 16, v80
    v_lshl_or_b32 v25, v83, 16, v82
    buffer_store_dwordx2 v[24:25], v30, s[32:35], s62 offen sc1
    s_add_u32 s62, s62, s63
standalone__deep_cross_pnn__recsys_kernel_nf1:
    s_mov_b64 exec, s[70:71]
    v_cmpx_le_u32 vcc, 2, v87
    v_mov_b32 v62, s69
    v_perm_b32 v121, v62, s68, v2
    v_perm_b32 v122, v62, s68, v1
    v_and_b32 v121, v121, v18
    v_and_b32 v122, v122, v17
    v_msad_u8 v120, v66, v121, 0
    v_lshlrev_b32 v120, 8, v120
    v_msad_u8 v120, v63, v122, v120
    v_and_b32 v120, v120, v59

    v_ffbl_b32 v120, v120
    v_max_i32 v84, v84, v120
    s_mov_b64 exec, -1
    v_lshl_add_u32 v59, -1, v84, v59

    v_lshl_add_u32 v61, v84, 1, v31
    ds_read_u16 v80, v61 offset:8
    s_setprio 0
    v_ffbl_b32 v84, v59
    v_perm_b32 v60, v73, v72, v84
    v_and_or_b32 v60, v60, s66, v85

    v_cmpx_ge_u32 vcc, 1, v84
    ds_add_u32 v60, v10
    s_not_b64 s[70:71], vcc
    s_mov_b64 exec, s[70:71]
    ds_add_rtn_u32 v87, v60, v10
    s_mov_b64 exec, -1

    ds_wrxchg_rtn_b32 v116, v86, v13
    s_mov_b64 exec, s[4:5]
    buffer_load_dwordx4 v[104:107], v56, s[20:23], s44 offen
    s_mov_b64 exec, -1
    buffer_load_dwordx4 v[136:139], v9, s[28:31], s77 offen offset:2048
    buffer_load_dwordx4 v[140:143], v9, s[28:31], s77 offen offset:3072
    s_add_u32 s77, s77, 4096

    s_waitcnt lgkmcnt(0)
    v_cmp_gt_u32 s[68:69], 2, v116

    s_mov_b64 exec, s[70:71]
    v_cmpx_le_u32 vcc, 2, v87
    v_mov_b32 v62, s69
    v_perm_b32 v121, v62, s68, v2
    v_perm_b32 v122, v62, s68, v1
    v_and_b32 v121, v121, v18
    v_and_b32 v122, v122, v17
    v_msad_u8 v120, v66, v121, 0
    v_lshlrev_b32 v120, 8, v120
    v_msad_u8 v120, v63, v122, v120
    v_and_b32 v120, v120, v59

    v_ffbl_b32 v120, v120
    v_max_i32 v84, v84, v120
    s_mov_b64 exec, -1
    v_lshl_add_u32 v59, -1, v84, v59

    v_lshl_add_u32 v61, v84, 1, v31
    ds_read_u16 v81, v61 offset:8
    s_setprio 1
    v_ffbl_b32 v84, v59
    v_perm_b32 v60, v73, v72, v84
    v_and_or_b32 v60, v60, s66, v85

    v_cmpx_ge_u32 vcc, 2, v84
    ds_add_u32 v60, v10
    s_not_b64 s[70:71], vcc
    s_mov_b64 exec, s[70:71]
    ds_add_rtn_u32 v87, v60, v10
    s_mov_b64 exec, -1

    ds_wrxchg_rtn_b32 v116, v86, v13
    buffer_load_dwordx4 v[144:147], v9, s[28:31], s77 offen offset:0
    buffer_load_dwordx4 v[148:151], v9, s[28:31], s77 offen offset:1024

    s_waitcnt lgkmcnt(0)
    v_cmp_gt_u32 s[68:69], 2, v116

    s_mov_b64 exec, s[70:71]
    v_cmpx_le_u32 vcc, 2, v87
    v_mov_b32 v62, s69
    v_perm_b32 v121, v62, s68, v2
    v_perm_b32 v122, v62, s68, v1
    v_and_b32 v121, v121, v18
    v_and_b32 v122, v122, v17
    v_msad_u8 v120, v66, v121, 0
    v_lshlrev_b32 v120, 8, v120
    v_msad_u8 v120, v63, v122, v120
    v_and_b32 v120, v120, v59

    v_ffbl_b32 v120, v120
    v_max_i32 v84, v84, v120
    s_mov_b64 exec, -1
    v_lshl_add_u32 v59, -1, v84, v59

    v_lshl_add_u32 v61, v84, 1, v31
    ds_read_u16 v82, v61 offset:8
    s_setprio 0
    v_ffbl_b32 v84, v59
    v_perm_b32 v60, v73, v72, v84
    v_and_or_b32 v60, v60, s66, v85

    v_cmpx_ge_u32 vcc, 3, v84
    ds_add_u32 v60, v10
    s_not_b64 s[70:71], vcc
    s_mov_b64 exec, s[70:71]
    ds_add_rtn_u32 v87, v60, v10
    s_mov_b64 exec, -1

    ds_wrxchg_rtn_b32 v116, v86, v13
    buffer_load_dwordx4 v[152:155], v9, s[28:31], s77 offen offset:2048
    buffer_load_dwordx4 v[156:159], v9, s[28:31], s77 offen offset:3072
    s_add_u32 s77, s77, 126976

    s_waitcnt lgkmcnt(0)
    v_cmp_gt_u32 s[68:69], 2, v116

    s_mov_b64 exec, s[70:71]
    v_cmpx_le_u32 vcc, 2, v87
    v_mov_b32 v62, s69
    v_perm_b32 v121, v62, s68, v2
    v_and_b32 v121, v121, v18
    v_msad_u8 v120, v66, v121, 0
    v_and_b32_sdwa v120, v120, v59 dst_sel:BYTE_1 dst_unused:UNUSED_PAD src0_sel:DWORD src1_sel:BYTE_1
    s_nop 0

    v_ffbl_b32 v120, v120
    v_max_i32 v84, v84, v120
    s_mov_b64 exec, -1
    v_lshl_add_u32 v59, -1, v84, v59

    v_lshl_add_u32 v61, v84, 1, v31
    ds_read_u16 v83, v61 offset:8
    v_lshrrev_b32 v59, 4, v59
    v_add_u32 v63, v58, v18
    s_setprio 1
    v_ffbl_b32 v84, v59
    v_perm_b32 v60, v74, v73, v84
    v_and_or_b32 v60, v60, s66, v85

    v_cmpx_ge_u32 vcc, 0, v84
    ds_add_u32 v60, v10
    s_not_b64 s[70:71], vcc
    s_mov_b64 exec, s[70:71]
    ds_add_rtn_u32 v87, v60, v10
    s_mov_b64 exec, -1

    ds_wrxchg_rtn_b32 v116, v86, v13
    buffer_load_dwordx4 v[160:163], v9, s[28:31], s77 offen offset:0
    buffer_load_dwordx4 v[164:167], v9, s[28:31], s77 offen offset:1024

    s_waitcnt lgkmcnt(0)
    v_cmp_gt_u32 s[68:69], 2, v116

    v_lshl_or_b32 v24, v81, 16, v80
    v_lshl_or_b32 v25, v83, 16, v82
    buffer_store_dwordx2 v[24:25], v30, s[32:35], s62 offen sc1
    s_add_u32 s62, s62, s63
    s_mov_b64 exec, s[70:71]
    v_cmpx_le_u32 vcc, 2, v87
    v_mov_b32 v62, s69
    v_perm_b32 v121, v62, s68, v3
    v_perm_b32 v122, v62, s68, v2
    v_and_b32 v121, v121, v19
    v_and_b32 v122, v122, v18
    v_msad_u8 v120, v67, v121, 0
    v_lshlrev_b32 v120, 8, v120
    v_msad_u8 v120, v63, v122, v120
    v_and_b32 v120, v120, v59

    v_ffbl_b32 v120, v120
    v_max_i32 v84, v84, v120
    s_mov_b64 exec, -1
    v_lshl_add_u32 v59, -1, v84, v59

    v_lshl_add_u32 v61, v84, 1, v31
    ds_read_u16 v80, v61 offset:16
    s_setprio 0
    v_ffbl_b32 v84, v59
    v_perm_b32 v60, v74, v73, v84
    v_and_or_b32 v60, v60, s66, v85

    v_cmpx_ge_u32 vcc, 1, v84
    ds_add_u32 v60, v10
    s_not_b64 s[70:71], vcc
    s_mov_b64 exec, s[70:71]
    ds_add_rtn_u32 v87, v60, v10
    s_mov_b64 exec, -1

    ds_wrxchg_rtn_b32 v116, v86, v13
    buffer_load_dwordx4 v[168:171], v9, s[28:31], s77 offen offset:2048
    buffer_load_dwordx4 v[172:175], v9, s[28:31], s77 offen offset:3072
    s_add_u32 s77, s77, 4096

    s_waitcnt lgkmcnt(0)
    v_cmp_gt_u32 s[68:69], 2, v116

    s_mov_b64 exec, s[70:71]
    v_cmpx_le_u32 vcc, 2, v87
    v_mov_b32 v62, s69
    v_perm_b32 v121, v62, s68, v3
    v_perm_b32 v122, v62, s68, v2
    v_and_b32 v121, v121, v19
    v_and_b32 v122, v122, v18
    v_msad_u8 v120, v67, v121, 0
    v_lshlrev_b32 v120, 8, v120
    v_msad_u8 v120, v63, v122, v120
    v_and_b32 v120, v120, v59

    v_ffbl_b32 v120, v120
    v_max_i32 v84, v84, v120
    s_mov_b64 exec, -1
    v_lshl_add_u32 v59, -1, v84, v59

    v_lshl_add_u32 v61, v84, 1, v31
    ds_read_u16 v81, v61 offset:16
    s_setprio 1
    v_ffbl_b32 v84, v59
    v_perm_b32 v60, v74, v73, v84
    v_and_or_b32 v60, v60, s66, v85

    v_cmpx_ge_u32 vcc, 2, v84
    ds_add_u32 v60, v10
    s_not_b64 s[70:71], vcc
    s_mov_b64 exec, s[70:71]
    ds_add_rtn_u32 v87, v60, v10
    s_mov_b64 exec, -1

    ds_wrxchg_rtn_b32 v116, v86, v13
    s_waitcnt vmcnt(11)
    s_mov_b64 exec, s[4:5]
    buffer_store_dwordx4 v[104:107], v9, s[32:35], s47 offen sc1
    s_mov_b64 exec, -1
    buffer_load_dwordx4 v[176:179], v9, s[28:31], s77 offen offset:0
    buffer_load_dwordx4 v[180:183], v9, s[28:31], s77 offen offset:1024

    s_waitcnt lgkmcnt(0)
    v_cmp_gt_u32 s[68:69], 2, v116

    s_mov_b64 exec, s[70:71]
    v_cmpx_le_u32 vcc, 2, v87
    v_mov_b32 v62, s69
    v_perm_b32 v121, v62, s68, v3
    v_perm_b32 v122, v62, s68, v2
    v_and_b32 v121, v121, v19
    v_and_b32 v122, v122, v18
    v_msad_u8 v120, v67, v121, 0
    v_lshlrev_b32 v120, 8, v120
    v_msad_u8 v120, v63, v122, v120
    v_and_b32 v120, v120, v59

    v_ffbl_b32 v120, v120
    v_max_i32 v84, v84, v120
    s_mov_b64 exec, -1
    v_lshl_add_u32 v59, -1, v84, v59

    v_lshl_add_u32 v61, v84, 1, v31
    ds_read_u16 v82, v61 offset:16
    s_setprio 0
    v_ffbl_b32 v84, v59
    v_perm_b32 v60, v74, v73, v84
    v_and_or_b32 v60, v60, s66, v85

    v_cmpx_ge_u32 vcc, 3, v84
    ds_add_u32 v60, v10
    s_not_b64 s[70:71], vcc
    s_mov_b64 exec, s[70:71]
    ds_add_rtn_u32 v87, v60, v10
    s_mov_b64 exec, -1

    ds_wrxchg_rtn_b32 v116, v86, v13
    buffer_load_dwordx4 v[184:187], v9, s[28:31], s77 offen offset:2048
    buffer_load_dwordx4 v[188:191], v9, s[28:31], s77 offen offset:3072

    s_waitcnt lgkmcnt(0)
    v_cmp_gt_u32 s[68:69], 2, v116

    s_mov_b64 exec, s[70:71]
    v_cmpx_le_u32 vcc, 2, v87
    v_mov_b32 v62, s69
    v_perm_b32 v121, v62, s68, v3
    v_and_b32 v121, v121, v19
    v_msad_u8 v120, v67, v121, 0
    v_and_b32_sdwa v120, v120, v59 dst_sel:BYTE_1 dst_unused:UNUSED_PAD src0_sel:DWORD src1_sel:BYTE_1
    s_nop 0

    v_ffbl_b32 v120, v120
    v_max_i32 v84, v84, v120
    s_mov_b64 exec, -1
    v_lshl_add_u32 v59, -1, v84, v59

    v_lshl_add_u32 v61, v84, 1, v31
    ds_read_u16 v83, v61 offset:16
    v_lshrrev_b32 v59, 4, v59
    v_add_u32 v63, v58, v19
    s_setprio 1
    v_ffbl_b32 v84, v59
    v_perm_b32 v60, v75, v74, v84
    v_and_or_b32 v60, v60, s66, v85

    v_cmpx_ge_u32 vcc, 0, v84
    ds_add_u32 v60, v10
    s_not_b64 s[70:71], vcc
    s_mov_b64 exec, s[70:71]
    ds_add_rtn_u32 v87, v60, v10
    s_mov_b64 exec, -1

    ds_wrxchg_rtn_b32 v116, v86, v13

    s_waitcnt lgkmcnt(0)
    v_cmp_gt_u32 s[68:69], 2, v116

    v_lshl_or_b32 v24, v81, 16, v80
    v_lshl_or_b32 v25, v83, 16, v82
    buffer_store_dwordx2 v[24:25], v30, s[32:35], s62 offen sc1
    s_add_u32 s62, s62, s63
    s_mov_b64 exec, s[70:71]
    v_cmpx_le_u32 vcc, 2, v87
    v_mov_b32 v62, s69
    v_perm_b32 v121, v62, s68, v4
    v_perm_b32 v122, v62, s68, v3
    v_and_b32 v121, v121, v20
    v_and_b32 v122, v122, v19
    v_msad_u8 v120, v68, v121, 0
    v_lshlrev_b32 v120, 8, v120
    v_msad_u8 v120, v63, v122, v120
    v_and_b32 v120, v120, v59

    v_ffbl_b32 v120, v120
    v_max_i32 v84, v84, v120
    s_mov_b64 exec, -1
    v_lshl_add_u32 v59, -1, v84, v59

    v_lshl_add_u32 v61, v84, 1, v31
    ds_read_u16 v80, v61 offset:24
    s_setprio 0
    v_ffbl_b32 v84, v59
    v_perm_b32 v60, v75, v74, v84
    v_and_or_b32 v60, v60, s66, v85

    v_cmpx_ge_u32 vcc, 1, v84
    ds_add_u32 v60, v10
    s_not_b64 s[70:71], vcc
    s_mov_b64 exec, s[70:71]
    ds_add_rtn_u32 v87, v60, v10
    s_mov_b64 exec, -1

    ds_wrxchg_rtn_b32 v116, v86, v13

    s_waitcnt lgkmcnt(0)
    v_cmp_gt_u32 s[68:69], 2, v116

    s_mov_b64 exec, s[70:71]
    v_cmpx_le_u32 vcc, 2, v87
    v_mov_b32 v62, s69
    v_perm_b32 v121, v62, s68, v4
    v_perm_b32 v122, v62, s68, v3
    v_and_b32 v121, v121, v20
    v_and_b32 v122, v122, v19
    v_msad_u8 v120, v68, v121, 0
    v_lshlrev_b32 v120, 8, v120
    v_msad_u8 v120, v63, v122, v120
    v_and_b32 v120, v120, v59

    v_ffbl_b32 v120, v120
    v_max_i32 v84, v84, v120
    s_mov_b64 exec, -1
    v_lshl_add_u32 v59, -1, v84, v59

    v_lshl_add_u32 v61, v84, 1, v31
    ds_read_u16 v81, v61 offset:24
    s_setprio 1

    s_cmp_ge_u32 s57, 800
    s_cbranch_scc1 standalone__deep_cross_pnn__recsys_kernel_norl
    s_waitcnt vmcnt(0)

    s_lshl_b32 s39, 1, s2
    s_cmp_eq_u32 s64, 0
    s_cselect_b32 s39, s39, 0

    s_lshr_b32 s38, s2, 5
    v_mov_b32 v60, s39
    s_lshl_b32 s38, s38, 4
    s_and_b64 exec, s[4:5], 1
    buffer_atomic_or v60, v13, s[52:55], s38 offen offset:128
    s_mov_b64 exec, -1

    v_perm_b32 v88, v132, v128, s84
    v_perm_b32 v89, v140, v136, s84
    v_perm_b32 v90, v148, v144, s84
    v_perm_b32 v91, v156, v152, s84
    v_perm_b32 v92, v132, v128, s85
    v_perm_b32 v93, v140, v136, s85
    v_perm_b32 v94, v148, v144, s85
    v_perm_b32 v95, v156, v152, s85
    v_perm_b32 v96, v133, v129, s84
    v_perm_b32 v97, v141, v137, s84
    v_perm_b32 v98, v149, v145, s84
    v_perm_b32 v99, v157, v153, s84
    v_perm_b32 v100, v133, v129, s85
    v_perm_b32 v101, v141, v137, s85
    v_perm_b32 v102, v149, v145, s85
    v_perm_b32 v103, v157, v153, s85
    ds_write_b128 v36, v[88:91]
    ds_write_b128 v37, v[92:95]
    ds_write_b128 v38, v[96:99]
    ds_write_b128 v39, v[100:103]
    ds_read_b128 v[192:195], v15 offset:0
    ds_read_b128 v[196:199], v15 offset:1024
    ds_read_b128 v[200:203], v15 offset:2048
    ds_read_b128 v[204:207], v15 offset:3072
    s_waitcnt lgkmcnt(4)
    v_perm_b32 v88, v164, v160, s84
    v_perm_b32 v89, v172, v168, s84
    v_perm_b32 v90, v180, v176, s84
    v_perm_b32 v91, v188, v184, s84
    v_perm_b32 v92, v164, v160, s85
    v_perm_b32 v93, v172, v168, s85
    v_perm_b32 v94, v180, v176, s85
    v_perm_b32 v95, v188, v184, s85
    v_perm_b32 v96, v165, v161, s84
    v_perm_b32 v97, v173, v169, s84
    v_perm_b32 v98, v181, v177, s84
    v_perm_b32 v99, v189, v185, s84
    v_perm_b32 v100, v165, v161, s85
    v_perm_b32 v101, v173, v169, s85
    v_perm_b32 v102, v181, v177, s85
    v_perm_b32 v103, v189, v185, s85
    ds_write_b128 v36, v[88:91]
    ds_write_b128 v37, v[92:95]
    ds_write_b128 v38, v[96:99]
    ds_write_b128 v39, v[100:103]
    ds_read_b128 v[208:211], v15 offset:0
    ds_read_b128 v[212:215], v15 offset:1024
    ds_read_b128 v[216:219], v15 offset:2048
    ds_read_b128 v[220:223], v15 offset:3072
    s_waitcnt lgkmcnt(4)
    v_perm_b32 v88, v134, v130, s84
    v_perm_b32 v89, v142, v138, s84
    v_perm_b32 v90, v150, v146, s84
    v_perm_b32 v91, v158, v154, s84
    v_perm_b32 v92, v134, v130, s85
    v_perm_b32 v93, v142, v138, s85
    v_perm_b32 v94, v150, v146, s85
    v_perm_b32 v95, v158, v154, s85
    v_perm_b32 v96, v135, v131, s84
    v_perm_b32 v97, v143, v139, s84
    v_perm_b32 v98, v151, v147, s84
    v_perm_b32 v99, v159, v155, s84
    v_perm_b32 v100, v135, v131, s85
    v_perm_b32 v101, v143, v139, s85
    v_perm_b32 v102, v151, v147, s85
    v_perm_b32 v103, v159, v155, s85
    ds_write_b128 v36, v[88:91]
    ds_write_b128 v37, v[92:95]
    ds_write_b128 v38, v[96:99]
    ds_write_b128 v39, v[100:103]
    ds_read_b128 v[224:227], v15 offset:0
    ds_read_b128 v[228:231], v15 offset:1024
    ds_read_b128 v[232:235], v15 offset:2048
    ds_read_b128 v[236:239], v15 offset:3072
    s_waitcnt lgkmcnt(4)
    v_perm_b32 v88, v166, v162, s84
    v_perm_b32 v89, v174, v170, s84
    v_perm_b32 v90, v182, v178, s84
    v_perm_b32 v91, v190, v186, s84
    v_perm_b32 v92, v166, v162, s85
    v_perm_b32 v93, v174, v170, s85
    v_perm_b32 v94, v182, v178, s85
    v_perm_b32 v95, v190, v186, s85
    v_perm_b32 v96, v167, v163, s84
    v_perm_b32 v97, v175, v171, s84
    v_perm_b32 v98, v183, v179, s84
    v_perm_b32 v99, v191, v187, s84
    v_perm_b32 v100, v167, v163, s85
    v_perm_b32 v101, v175, v171, s85
    v_perm_b32 v102, v183, v179, s85
    v_perm_b32 v103, v191, v187, s85
    ds_write_b128 v36, v[88:91]
    ds_write_b128 v37, v[92:95]
    ds_write_b128 v38, v[96:99]
    ds_write_b128 v39, v[100:103]
    ds_read_b128 v[240:243], v15 offset:0
    ds_read_b128 v[244:247], v15 offset:1024
    ds_read_b128 v[248:251], v15 offset:2048
    ds_read_b128 v[252:255], v15 offset:3072
    ds_write_b64 v31, v[44:45] offset:24
    ds_write_b64 v31, v[46:47] offset:32
    ds_write_b64 v31, v[48:49] offset:40
    ds_write_b64 v31, v[50:51] offset:48
    ds_write_b64 v31, v[52:53] offset:56
    ds_write_b64 v31, v[54:55] offset:64
    s_waitcnt lgkmcnt(6)
standalone__deep_cross_pnn__recsys_kernel_norl:
standalone__deep_cross_pnn__recsys_kernel_rld:
    v_ffbl_b32 v84, v59
    v_perm_b32 v60, v75, v74, v84
    v_and_or_b32 v60, v60, s66, v85

    v_cmpx_ge_u32 vcc, 2, v84
    ds_add_u32 v60, v10
    s_not_b64 s[70:71], vcc
    s_mov_b64 exec, s[70:71]
    ds_add_rtn_u32 v87, v60, v10
    s_mov_b64 exec, -1

    ds_wrxchg_rtn_b32 v116, v86, v13
    s_add_u32 s83, s82, 0
    buffer_store_dwordx4 v[192:195], v14, s[32:35], s83 offen sc1
    s_add_u32 s83, s82, 64
    buffer_store_dwordx4 v[208:211], v14, s[32:35], s83 offen sc1

    s_waitcnt lgkmcnt(0)
    v_cmp_gt_u32 s[68:69], 2, v116

    s_mov_b64 exec, s[70:71]
    v_cmpx_le_u32 vcc, 2, v87
    v_mov_b32 v62, s69
    v_perm_b32 v121, v62, s68, v4
    v_perm_b32 v122, v62, s68, v3
    v_and_b32 v121, v121, v20
    v_and_b32 v122, v122, v19
    v_msad_u8 v120, v68, v121, 0
    v_lshlrev_b32 v120, 8, v120
    v_msad_u8 v120, v63, v122, v120
    v_and_b32 v120, v120, v59

    v_ffbl_b32 v120, v120
    v_max_i32 v84, v84, v120
    s_mov_b64 exec, -1
    v_lshl_add_u32 v59, -1, v84, v59

    v_lshl_add_u32 v61, v84, 1, v31
    ds_read_u16 v82, v61 offset:24
    s_setprio 0
    v_ffbl_b32 v84, v59
    v_perm_b32 v60, v75, v74, v84
    v_and_or_b32 v60, v60, s66, v85

    v_cmpx_ge_u32 vcc, 3, v84
    ds_add_u32 v60, v10
    s_not_b64 s[70:71], vcc
    s_mov_b64 exec, s[70:71]
    ds_add_rtn_u32 v87, v60, v10
    s_mov_b64 exec, -1

    ds_wrxchg_rtn_b32 v116, v86, v13
    s_add_u32 s83, s82, 3284992
    buffer_store_dwordx4 v[196:199], v14, s[32:35], s83 offen sc1
    s_add_u32 s83, s82, 3285056
    buffer_store_dwordx4 v[212:215], v14, s[32:35], s83 offen sc1

    s_waitcnt lgkmcnt(0)
    v_cmp_gt_u32 s[68:69], 2, v116

    s_mov_b64 exec, s[70:71]
    v_cmpx_le_u32 vcc, 2, v87
    v_mov_b32 v62, s69
    v_perm_b32 v121, v62, s68, v4
    v_and_b32 v121, v121, v20
    v_msad_u8 v120, v68, v121, 0
    v_and_b32_sdwa v120, v120, v59 dst_sel:BYTE_1 dst_unused:UNUSED_PAD src0_sel:DWORD src1_sel:BYTE_1
    s_nop 0

    v_ffbl_b32 v120, v120
    v_max_i32 v84, v84, v120
    s_mov_b64 exec, -1
    v_lshl_add_u32 v59, -1, v84, v59

    v_lshl_add_u32 v61, v84, 1, v31
    ds_read_u16 v83, v61 offset:24
    v_lshrrev_b32 v59, 4, v59
    v_add_u32 v63, v58, v20
    s_setprio 1
    v_ffbl_b32 v84, v59
    v_perm_b32 v60, v76, v75, v84
    v_and_or_b32 v60, v60, s66, v85

    v_cmpx_ge_u32 vcc, 0, v84
    ds_add_u32 v60, v10
    s_not_b64 s[70:71], vcc
    s_mov_b64 exec, s[70:71]
    ds_add_rtn_u32 v87, v60, v10
    s_mov_b64 exec, -1

    ds_wrxchg_rtn_b32 v116, v86, v13
    s_add_u32 s83, s82, 6569984
    buffer_store_dwordx4 v[200:203], v14, s[32:35], s83 offen sc1
    s_add_u32 s83, s82, 6570048
    buffer_store_dwordx4 v[216:219], v14, s[32:35], s83 offen sc1

    s_waitcnt lgkmcnt(0)
    v_cmp_gt_u32 s[68:69], 2, v116

    v_lshl_or_b32 v24, v81, 16, v80
    v_lshl_or_b32 v25, v83, 16, v82
    buffer_store_dwordx2 v[24:25], v30, s[32:35], s62 offen sc1
    s_add_u32 s62, s62, s63
    s_mov_b64 exec, s[70:71]
    v_cmpx_le_u32 vcc, 2, v87
    v_mov_b32 v62, s69
    v_perm_b32 v121, v62, s68, v5
    v_perm_b32 v122, v62, s68, v4
    v_and_b32 v121, v121, v21
    v_and_b32 v122, v122, v20
    v_msad_u8 v120, v69, v121, 0
    v_lshlrev_b32 v120, 8, v120
    v_msad_u8 v120, v63, v122, v120
    v_and_b32 v120, v120, v59

    v_ffbl_b32 v120, v120
    v_max_i32 v84, v84, v120
    s_mov_b64 exec, -1
    v_lshl_add_u32 v59, -1, v84, v59

    v_lshl_add_u32 v61, v84, 1, v31
    ds_read_u16 v80, v61 offset:32
    s_setprio 0
    v_ffbl_b32 v84, v59
    v_perm_b32 v60, v76, v75, v84
    v_and_or_b32 v60, v60, s66, v85

    v_cmpx_ge_u32 vcc, 1, v84
    ds_add_u32 v60, v10
    s_not_b64 s[70:71], vcc
    s_mov_b64 exec, s[70:71]
    ds_add_rtn_u32 v87, v60, v10
    s_mov_b64 exec, -1

    ds_wrxchg_rtn_b32 v116, v86, v13
    s_add_u32 s83, s82, 9854976
    buffer_store_dwordx4 v[204:207], v14, s[32:35], s83 offen sc1
    s_add_u32 s83, s82, 9855040
    buffer_store_dwordx4 v[220:223], v14, s[32:35], s83 offen sc1

    s_waitcnt lgkmcnt(0)
    v_cmp_gt_u32 s[68:69], 2, v116

    s_mov_b64 exec, s[70:71]
    v_cmpx_le_u32 vcc, 2, v87
    v_mov_b32 v62, s69
    v_perm_b32 v121, v62, s68, v5
    v_perm_b32 v122, v62, s68, v4
    v_and_b32 v121, v121, v21
    v_and_b32 v122, v122, v20
    v_msad_u8 v120, v69, v121, 0
    v_lshlrev_b32 v120, 8, v120
    v_msad_u8 v120, v63, v122, v120
    v_and_b32 v120, v120, v59

    v_ffbl_b32 v120, v120
    v_max_i32 v84, v84, v120
    s_mov_b64 exec, -1
    v_lshl_add_u32 v59, -1, v84, v59

    v_lshl_add_u32 v61, v84, 1, v31
    ds_read_u16 v81, v61 offset:32
    s_setprio 1
    v_ffbl_b32 v84, v59
    v_perm_b32 v60, v76, v75, v84
    v_and_or_b32 v60, v60, s66, v85

    v_cmpx_ge_u32 vcc, 2, v84
    ds_add_u32 v60, v10
    s_not_b64 s[70:71], vcc
    s_mov_b64 exec, s[70:71]
    ds_add_rtn_u32 v87, v60, v10
    s_mov_b64 exec, -1

    ds_wrxchg_rtn_b32 v116, v86, v13
    s_add_u32 s83, s82, 102656
    buffer_store_dwordx4 v[224:227], v14, s[32:35], s83 offen sc1
    s_add_u32 s83, s82, 102720
    buffer_store_dwordx4 v[240:243], v14, s[32:35], s83 offen sc1

    s_waitcnt lgkmcnt(0)
    v_cmp_gt_u32 s[68:69], 2, v116

    s_mov_b64 exec, s[70:71]
    v_cmpx_le_u32 vcc, 2, v87
    v_mov_b32 v62, s69
    v_perm_b32 v121, v62, s68, v5
    v_perm_b32 v122, v62, s68, v4
    v_and_b32 v121, v121, v21
    v_and_b32 v122, v122, v20
    v_msad_u8 v120, v69, v121, 0
    v_lshlrev_b32 v120, 8, v120
    v_msad_u8 v120, v63, v122, v120
    v_and_b32 v120, v120, v59

    v_ffbl_b32 v120, v120
    v_max_i32 v84, v84, v120
    s_mov_b64 exec, -1
    v_lshl_add_u32 v59, -1, v84, v59

    v_lshl_add_u32 v61, v84, 1, v31
    ds_read_u16 v82, v61 offset:32
    s_setprio 0
    v_ffbl_b32 v84, v59
    v_perm_b32 v60, v76, v75, v84
    v_and_or_b32 v60, v60, s66, v85

    v_cmpx_ge_u32 vcc, 3, v84
    ds_add_u32 v60, v10
    s_not_b64 s[70:71], vcc
    s_mov_b64 exec, s[70:71]
    ds_add_rtn_u32 v87, v60, v10
    s_mov_b64 exec, -1

    ds_wrxchg_rtn_b32 v116, v86, v13
    s_add_u32 s83, s82, 3387648
    buffer_store_dwordx4 v[228:231], v14, s[32:35], s83 offen sc1
    s_add_u32 s83, s82, 3387712
    buffer_store_dwordx4 v[244:247], v14, s[32:35], s83 offen sc1

    s_waitcnt lgkmcnt(0)
    v_cmp_gt_u32 s[68:69], 2, v116

    s_mov_b64 exec, s[70:71]
    v_cmpx_le_u32 vcc, 2, v87
    v_mov_b32 v62, s69
    v_perm_b32 v121, v62, s68, v5
    v_and_b32 v121, v121, v21
    v_msad_u8 v120, v69, v121, 0
    v_and_b32_sdwa v120, v120, v59 dst_sel:BYTE_1 dst_unused:UNUSED_PAD src0_sel:DWORD src1_sel:BYTE_1
    s_nop 0

    v_ffbl_b32 v120, v120
    v_max_i32 v84, v84, v120
    s_mov_b64 exec, -1
    v_lshl_add_u32 v59, -1, v84, v59

    v_lshl_add_u32 v61, v84, 1, v31
    ds_read_u16 v83, v61 offset:32
    v_lshrrev_b32 v59, 4, v59
    v_add_u32 v63, v58, v21

    s_bitcmp0_b32 s59, 0
    s_cbranch_scc1 standalone__deep_cross_pnn__recsys_kernel_mg2
    v_mov_b32 v60, s46
    v_subrev_u32 v61, 512, v86

standalone__deep_cross_pnn__recsys_kernel_mg1:

    ds_read_b32 v12, v60
    ds_read_b32 v120, v61
    s_waitcnt lgkmcnt(0)
    v_readfirstlane_b32 s45, v12
    s_cmp_lg_u32 s45, 0
    s_cbranch_scc1 standalone__deep_cross_pnn__recsys_kernel_mg3
    s_sleep 2
    s_branch standalone__deep_cross_pnn__recsys_kernel_mg1

standalone__deep_cross_pnn__recsys_kernel_mg3:

    ds_write_b32 v60, v13
    s_mov_b32 s45, 0xff00
    v_lshl_or_b32 v120, v120, 8, v120
    v_and_or_b32 v59, v120, s45, v59

standalone__deep_cross_pnn__recsys_kernel_mg2:
    s_setprio 1
    v_ffbl_b32 v84, v59
    v_perm_b32 v60, v77, v76, v84
    v_and_or_b32 v60, v60, s66, v85

    v_cmpx_ge_u32 vcc, 0, v84
    ds_add_u32 v60, v10
    s_not_b64 s[70:71], vcc
    s_mov_b64 exec, s[70:71]
    ds_add_rtn_u32 v87, v60, v10
    s_mov_b64 exec, -1

    ds_wrxchg_rtn_b32 v116, v86, v13
    s_add_u32 s83, s82, 6672640
    buffer_store_dwordx4 v[232:235], v14, s[32:35], s83 offen sc1
    s_add_u32 s83, s82, 6672704
    buffer_store_dwordx4 v[248:251], v14, s[32:35], s83 offen sc1
    buffer_store_dwordx4 v[108:111], v9, s[12:15], s6 offen offset:0 sc1
    buffer_store_dwordx4 v[108:111], v9, s[12:15], s6 offen offset:1024 sc1

    s_waitcnt lgkmcnt(0)
    v_cmp_gt_u32 s[68:69], 2, v116

    v_lshl_or_b32 v24, v81, 16, v80
    v_lshl_or_b32 v25, v83, 16, v82
    buffer_store_dwordx2 v[24:25], v30, s[32:35], s62 offen sc1
    s_add_u32 s62, s62, s63
    s_mov_b64 exec, s[70:71]
    v_cmpx_le_u32 vcc, 2, v87
    v_mov_b32 v62, s69
    v_perm_b32 v121, v62, s68, v6
    v_perm_b32 v122, v62, s68, v5
    v_and_b32 v121, v121, v22
    v_and_b32 v122, v122, v21
    v_msad_u8 v120, v70, v121, 0
    v_lshlrev_b32 v120, 8, v120
    v_msad_u8 v120, v63, v122, v120
    v_and_b32 v120, v120, v59

    v_ffbl_b32 v120, v120
    v_max_i32 v84, v84, v120
    s_mov_b64 exec, -1
    v_lshl_add_u32 v59, -1, v84, v59

    v_lshl_add_u32 v61, v84, 1, v31
    ds_read_u16 v80, v61 offset:40
    s_setprio 0
    v_ffbl_b32 v84, v59
    v_perm_b32 v60, v77, v76, v84
    v_and_or_b32 v60, v60, s66, v85

    v_cmpx_ge_u32 vcc, 1, v84
    ds_add_u32 v60, v10
    s_not_b64 s[70:71], vcc
    s_mov_b64 exec, s[70:71]
    ds_add_rtn_u32 v87, v60, v10
    s_mov_b64 exec, -1

    ds_wrxchg_rtn_b32 v116, v86, v13
    s_add_u32 s83, s82, 9957632
    buffer_store_dwordx4 v[236:239], v14, s[32:35], s83 offen sc1
    s_add_u32 s83, s82, 9957696
    buffer_store_dwordx4 v[252:255], v14, s[32:35], s83 offen sc1
    buffer_store_dwordx4 v[108:111], v9, s[12:15], s6 offen offset:2048 sc1
    buffer_store_dwordx4 v[108:111], v9, s[12:15], s6 offen offset:3072 sc1

    s_waitcnt lgkmcnt(0)
    v_cmp_gt_u32 s[68:69], 2, v116

    s_mov_b64 exec, s[70:71]
    v_cmpx_le_u32 vcc, 2, v87
    v_mov_b32 v62, s69
    v_perm_b32 v121, v62, s68, v6
    v_perm_b32 v122, v62, s68, v5
    v_and_b32 v121, v121, v22
    v_and_b32 v122, v122, v21
    v_msad_u8 v120, v70, v121, 0
    v_lshlrev_b32 v120, 8, v120
    v_msad_u8 v120, v63, v122, v120
    v_and_b32 v120, v120, v59

    v_ffbl_b32 v120, v120
    v_max_i32 v84, v84, v120
    s_mov_b64 exec, -1
    v_lshl_add_u32 v59, -1, v84, v59

    v_lshl_add_u32 v61, v84, 1, v31
    ds_read_u16 v81, v61 offset:40
    s_setprio 1
    v_ffbl_b32 v84, v59
    v_perm_b32 v60, v77, v76, v84
    v_and_or_b32 v60, v60, s66, v85

    v_cmpx_ge_u32 vcc, 2, v84
    ds_add_u32 v60, v10
    s_not_b64 s[70:71], vcc
    s_mov_b64 exec, s[70:71]
    ds_add_rtn_u32 v87, v60, v10
    s_mov_b64 exec, -1

    ds_wrxchg_rtn_b32 v116, v86, v13
    buffer_store_dwordx4 v[108:111], v9, s[12:15], s7 offen offset:0 sc1
    buffer_store_dwordx4 v[108:111], v9, s[12:15], s7 offen offset:1024 sc1

    s_waitcnt lgkmcnt(0)
    v_cmp_gt_u32 s[68:69], 2, v116

    s_mov_b64 exec, s[70:71]
    v_cmpx_le_u32 vcc, 2, v87
    v_mov_b32 v62, s69
    v_perm_b32 v121, v62, s68, v6
    v_perm_b32 v122, v62, s68, v5
    v_and_b32 v121, v121, v22
    v_and_b32 v122, v122, v21
    v_msad_u8 v120, v70, v121, 0
    v_lshlrev_b32 v120, 8, v120
    v_msad_u8 v120, v63, v122, v120
    v_and_b32 v120, v120, v59

    v_ffbl_b32 v120, v120
    v_max_i32 v84, v84, v120
    s_mov_b64 exec, -1
    v_lshl_add_u32 v59, -1, v84, v59

    v_lshl_add_u32 v61, v84, 1, v31
    ds_read_u16 v82, v61 offset:40
    s_setprio 0
    v_ffbl_b32 v84, v59
    v_perm_b32 v60, v77, v76, v84
    v_and_or_b32 v60, v60, s66, v85

    v_cmpx_ge_u32 vcc, 3, v84
    ds_add_u32 v60, v10
    s_not_b64 s[70:71], vcc
    s_mov_b64 exec, s[70:71]
    ds_add_rtn_u32 v87, v60, v10
    s_mov_b64 exec, -1

    ds_wrxchg_rtn_b32 v116, v86, v13
    buffer_store_dwordx4 v[108:111], v9, s[12:15], s7 offen offset:2048 sc1
    buffer_store_dwordx4 v[108:111], v9, s[12:15], s7 offen offset:3072 sc1
    buffer_store_dwordx2 v[108:109], v30, s[12:15], s8 offen sc1
    s_mov_b64 exec, 0xff
    buffer_load_dword v104, v9, s[52:55], 0 offen offset:128 sc1
    s_mov_b64 exec, -1

    s_waitcnt lgkmcnt(0)
    v_cmp_gt_u32 s[68:69], 2, v116

    s_mov_b64 exec, s[70:71]
    v_cmpx_le_u32 vcc, 2, v87
    v_mov_b32 v62, s69
    v_perm_b32 v121, v62, s68, v6
    v_and_b32 v121, v121, v22
    v_msad_u8 v120, v70, v121, 0
    v_and_b32_sdwa v120, v120, v59 dst_sel:BYTE_1 dst_unused:UNUSED_PAD src0_sel:DWORD src1_sel:BYTE_1
    s_nop 0

    v_ffbl_b32 v120, v120
    v_max_i32 v84, v84, v120
    s_mov_b64 exec, -1
    v_lshl_add_u32 v59, -1, v84, v59

    v_lshl_add_u32 v61, v84, 1, v31
    ds_read_u16 v83, v61 offset:40

    s_bitcmp1_b32 s59, 0
    s_cbranch_scc1 standalone__deep_cross_pnn__recsys_kernel_sk6
    v_mov_b32 v60, s46
    ds_write_b32 v86, v59
    ds_write_b32 v60, v10
    s_branch standalone__deep_cross_pnn__recsys_kernel_sdone

standalone__deep_cross_pnn__recsys_kernel_sk6:
    v_lshrrev_b32 v59, 4, v59
    v_add_u32 v63, v58, v22
    s_setprio 1
    v_ffbl_b32 v84, v59
    v_perm_b32 v60, v78, v77, v84

    v_cmp_lt_u32 vcc, 7, v84
    v_alignbyte_b32 v61, v79, v79, v84
    s_nop 0
    v_cndmask_b32 v60, v60, v61, vcc

    v_and_or_b32 v60, v60, s66, v85
    ds_add_rtn_u32 v87, v60, v10
    ds_wrxchg_rtn_b32 v116, v86, v13

    s_waitcnt lgkmcnt(0)
    v_cmp_gt_u32 s[68:69], 2, v116

    v_lshl_or_b32 v24, v81, 16, v80
    v_lshl_or_b32 v25, v83, 16, v82
    buffer_store_dwordx2 v[24:25], v30, s[32:35], s62 offen sc1
    s_add_u32 s62, s62, s63
    s_nop 0
    v_cmpx_le_u32 vcc, 2, v87
    v_mov_b32 v62, s69
    v_perm_b32 v121, v62, s68, v7
    v_perm_b32 v122, v62, s68, v6
    v_perm_b32 v123, v62, s68, v5
    v_and_b32 v121, v121, v23
    v_and_b32 v122, v122, v22
    v_and_b32 v123, v123, v21
    v_msad_u8 v120, v71, v121, 0
    v_lshlrev_b32 v120, 8, v120
    v_msad_u8 v120, v63, v122, v120
    v_msad_u8 v120, v69, v123, v120
    v_and_b32 v120, v120, v59

    v_ffbl_b32 v120, v120
    v_max_i32 v84, v84, v120
    s_mov_b64 exec, -1
    v_lshl_add_u32 v59, -1, v84, v59

    v_lshl_add_u32 v61, v84, 1, v31
    ds_read_u16 v80, v61 offset:48
    s_setprio 0
    v_ffbl_b32 v84, v59
    v_perm_b32 v60, v78, v77, v84

    v_cmp_lt_u32 vcc, 7, v84
    v_alignbyte_b32 v61, v79, v79, v84
    s_nop 0
    v_cndmask_b32 v60, v60, v61, vcc

    v_and_or_b32 v60, v60, s66, v85
    ds_add_rtn_u32 v87, v60, v10
    ds_wrxchg_rtn_b32 v116, v86, v13

    s_waitcnt lgkmcnt(0)
    v_cmp_gt_u32 s[68:69], 2, v116

    s_nop 0
    v_cmpx_le_u32 vcc, 2, v87
    v_mov_b32 v62, s69
    v_perm_b32 v121, v62, s68, v7
    v_perm_b32 v122, v62, s68, v6
    v_perm_b32 v123, v62, s68, v5
    v_and_b32 v121, v121, v23
    v_and_b32 v122, v122, v22
    v_and_b32 v123, v123, v21
    v_msad_u8 v120, v71, v121, 0
    v_lshlrev_b32 v120, 8, v120
    v_msad_u8 v120, v63, v122, v120
    v_msad_u8 v120, v69, v123, v120
    v_and_b32 v120, v120, v59

    v_ffbl_b32 v120, v120
    v_max_i32 v84, v84, v120
    s_mov_b64 exec, -1
    v_lshl_add_u32 v59, -1, v84, v59

    v_lshl_add_u32 v61, v84, 1, v31
    ds_read_u16 v81, v61 offset:48
    s_setprio 1
    v_ffbl_b32 v84, v59
    v_perm_b32 v60, v78, v77, v84

    v_cmp_lt_u32 vcc, 7, v84
    v_alignbyte_b32 v61, v79, v79, v84
    s_nop 0
    v_cndmask_b32 v60, v60, v61, vcc

    v_and_or_b32 v60, v60, s66, v85
    ds_add_rtn_u32 v87, v60, v10
    ds_wrxchg_rtn_b32 v116, v86, v13

    s_waitcnt lgkmcnt(0)
    v_cmp_gt_u32 s[68:69], 2, v116

    s_nop 0
    v_cmpx_le_u32 vcc, 2, v87
    v_mov_b32 v62, s69
    v_perm_b32 v121, v62, s68, v7
    v_perm_b32 v122, v62, s68, v6
    v_perm_b32 v123, v62, s68, v5
    v_and_b32 v121, v121, v23
    v_and_b32 v122, v122, v22
    v_and_b32 v123, v123, v21
    v_msad_u8 v120, v71, v121, 0
    v_lshlrev_b32 v120, 8, v120
    v_msad_u8 v120, v63, v122, v120
    v_msad_u8 v120, v69, v123, v120
    v_and_b32 v120, v120, v59

    v_ffbl_b32 v120, v120
    v_max_i32 v84, v84, v120
    s_mov_b64 exec, -1
    v_lshl_add_u32 v59, -1, v84, v59

    v_lshl_add_u32 v61, v84, 1, v31
    ds_read_u16 v82, v61 offset:48
    v_ffbl_b32 v84, v59
    v_lshl_add_u32 v61, v84, 1, v31
    ds_read_u16 v83, v61 offset:48
standalone__deep_cross_pnn__recsys_kernel_sdone:
    s_waitcnt lgkmcnt(0)
    v_lshl_or_b32 v24, v81, 16, v80
    v_lshl_or_b32 v25, v83, 16, v82
    buffer_store_dwordx2 v[24:25], v30, s[32:35], s62 offen sc1
    s_add_u32 s62, s62, s63
standalone__deep_cross_pnn__recsys_kernel_udone:
    s_setprio 0

    s_waitcnt vmcnt(0)

    s_mov_b64 exec, 1
    ds_add_rtn_u32 v12, v11, v10 offset:20
    s_mov_b32 s49, 0
    s_waitcnt lgkmcnt(0)
    v_readfirstlane_b32 s48, v12
    s_and_b32 s48, s48, 3

    s_mov_b64 exec, 0xff
standalone__deep_cross_pnn__recsys_kernel_ec1:

    v_cmp_ne_u32 vcc, -1, v104
    s_cbranch_vccz standalone__deep_cross_pnn__recsys_kernel_tbl
    buffer_load_dword v104, v9, s[52:55], 0 offen offset:128 sc1
    s_add_u32 s49, s49, 1
    s_waitcnt vmcnt(0)
    s_cmp_lt_u32 s49, 12
    s_cbranch_scc1 standalone__deep_cross_pnn__recsys_kernel_ec1
    s_branch standalone__deep_cross_pnn__recsys_kernel_enx

standalone__deep_cross_pnn__recsys_kernel_hset:

    s_lshl_b32 s39, 1, s51
    s_lshr_b32 s38, s51, 5
    v_mov_b32 v1, s39
    s_lshl_b32 s38, s38, 4
    s_mov_b64 exec, 1
    buffer_atomic_or v1, v13, s[52:55], s38 offen offset:132
    s_mov_b64 exec, -1
    s_waitcnt vmcnt(0)
    s_branch standalone__deep_cross_pnn__recsys_kernel_slow

standalone__deep_cross_pnn__recsys_kernel_tbl:
    s_mov_b64 exec, -1
    s_mov_b32 s49, -1

    s_xor_b32 s44, s50, 1
    s_lshl_b32 s44, s44, 3
    s_add_u32 s44, s44, s56
    s_lshl_b32 s44, s44, 14
    s_add_u32 s44, s44, 15204352
    s_add_u32 s47, s44, 65536

    buffer_load_dwordx4 v[136:139], v9, s[12:15], s44 offen offset:0 sc1
    buffer_load_dwordx4 v[140:143], v9, s[12:15], s44 offen offset:1024 sc1
    buffer_load_dwordx4 v[152:155], v9, s[12:15], s44 offen offset:2048 sc1
    buffer_load_dwordx4 v[156:159], v9, s[12:15], s44 offen offset:3072 sc1
    s_add_u32 s44, s44, 4096
    buffer_load_dwordx4 v[168:171], v9, s[12:15], s44 offen offset:0 sc1
    buffer_load_dwordx4 v[172:175], v9, s[12:15], s44 offen offset:1024 sc1
    buffer_load_dwordx4 v[184:187], v9, s[12:15], s44 offen offset:2048 sc1
    buffer_load_dwordx4 v[188:191], v9, s[12:15], s44 offen offset:3072 sc1
    s_add_u32 s44, s44, 4096
    s_waitcnt vmcnt(7)
    buffer_load_dwordx4 v[200:203], v9, s[12:15], s44 offen offset:0 sc1
    s_waitcnt vmcnt(7)
    buffer_load_dwordx4 v[204:207], v9, s[12:15], s44 offen offset:1024 sc1
    s_waitcnt vmcnt(7)
    buffer_load_dwordx4 v[216:219], v9, s[12:15], s44 offen offset:2048 sc1
    s_waitcnt vmcnt(7)
    buffer_load_dwordx4 v[220:223], v9, s[12:15], s44 offen offset:3072 sc1
    s_add_u32 s44, s44, 4096
    s_waitcnt vmcnt(7)
    buffer_load_dwordx4 v[232:235], v9, s[12:15], s44 offen offset:0 sc1
    s_waitcnt vmcnt(7)
    buffer_load_dwordx4 v[236:239], v9, s[12:15], s44 offen offset:1024 sc1
    s_waitcnt vmcnt(7)
    buffer_load_dwordx4 v[248:251], v9, s[12:15], s44 offen offset:2048 sc1
    s_waitcnt vmcnt(7)
    buffer_load_dwordx4 v[252:255], v9, s[12:15], s44 offen offset:3072 sc1
    s_add_u32 s44, s44, 4096
    s_waitcnt vmcnt(7)
    buffer_load_dwordx4 v[88:91], v9, s[12:15], s47 offen offset:0 sc1
    s_waitcnt vmcnt(7)
    buffer_load_dwordx4 v[88:91], v9, s[12:15], s47 offen offset:1024 sc1
    s_waitcnt vmcnt(7)
    buffer_load_dwordx4 v[88:91], v9, s[12:15], s47 offen offset:2048 sc1
    s_waitcnt vmcnt(7)
    buffer_load_dwordx4 v[88:91], v9, s[12:15], s47 offen offset:3072 sc1
    s_add_u32 s47, s47, 4096
    s_waitcnt vmcnt(7)
    buffer_load_dwordx4 v[88:91], v9, s[12:15], s47 offen offset:0 sc1
    s_waitcnt vmcnt(7)
    buffer_load_dwordx4 v[88:91], v9, s[12:15], s47 offen offset:1024 sc1
    s_waitcnt vmcnt(7)
    buffer_load_dwordx4 v[88:91], v9, s[12:15], s47 offen offset:2048 sc1
    s_waitcnt vmcnt(7)
    buffer_load_dwordx4 v[88:91], v9, s[12:15], s47 offen offset:3072 sc1
    s_add_u32 s47, s47, 4096
    s_waitcnt vmcnt(7)
    buffer_load_dwordx4 v[88:91], v9, s[12:15], s47 offen offset:0 sc1
    s_waitcnt vmcnt(7)
    buffer_load_dwordx4 v[88:91], v9, s[12:15], s47 offen offset:1024 sc1
    s_waitcnt vmcnt(7)
    buffer_load_dwordx4 v[88:91], v9, s[12:15], s47 offen offset:2048 sc1
    s_waitcnt vmcnt(7)
    buffer_load_dwordx4 v[88:91], v9, s[12:15], s47 offen offset:3072 sc1
    s_add_u32 s47, s47, 4096
    s_waitcnt vmcnt(7)
    buffer_load_dwordx4 v[88:91], v9, s[12:15], s47 offen offset:0 sc1
    s_waitcnt vmcnt(7)
    buffer_load_dwordx4 v[88:91], v9, s[12:15], s47 offen offset:1024 sc1
    s_waitcnt vmcnt(7)
    buffer_load_dwordx4 v[88:91], v9, s[12:15], s47 offen offset:2048 sc1
    s_waitcnt vmcnt(7)
    buffer_load_dwordx4 v[88:91], v9, s[12:15], s47 offen offset:3072 sc1
    s_add_u32 s47, s47, 4096
standalone__deep_cross_pnn__recsys_kernel_enx:

    s_mov_b64 exec, -1
    s_mul_i32 s85, s56, 18432
    v_and_b32 v25, 15, v8
    v_lshrrev_b32 v26, 4, v8
    v_mul_u32_u24 v24, 144, v25
    v_lshl_add_u32 v24, v26, 4, v24
    v_add_u32 v24, s85, v24

    s_lshr_b32 s79, s2, 1
    s_mul_i32 s77, s79, 102656
    s_lshl_b32 s85, s50, 11
    s_xor_b32 s78, s85, 2048
    s_add_u32 s78, s78, s77
    s_add_u32 s77, s77, s85
    s_and_b32 s79, s2, 1
    s_mul_i32 s79, s79, 1638400
    s_add_u32 s79, s79, 16777216
    s_lshl_b32 s85, s3, 13
    s_add_u32 s79, s79, s85
    s_xor_b32 s85, s3, 4
    s_lshl_b32 s85, s85, 10
    s_lshl_b32 s80, s24, 16
    s_and_b32 s81, s24, 0xffff0000
    s_lshl_b32 s82, s25, 16
    s_and_b32 s83, s25, 0xffff0000
    ds_read_b128 v[128:131], v24 offset:0
    ds_read_b128 v[132:135], v24 offset:64
    v_lshlrev_b32 v69, 4, v8
    v_lshlrev_b32 v70, 13, v26
    v_lshl_add_u32 v70, v25, 3, v70
    v_add_u32 v70, s85, v70
    ds_read_b128 v[144:147], v24 offset:2304
    ds_read_b128 v[148:151], v24 offset:2368
    v_lshrrev_b32 v28, 3, v8
    v_xor_b32 v28, v28, v26
    v_and_b32 v28, 1, v28
    v_bfe_u32 v29, v8, 2, 1
    ds_read_b128 v[160:163], v24 offset:4608
    ds_read_b128 v[164:167], v24 offset:4672
    v_lshl_or_b32 v28, v28, 1, v29
    v_mov_b32 v30, 0x3f80
    v_cmp_eq_u32 vcc, 0, v28
    v_cmp_eq_u32 s[68:69], 1, v28
    ds_read_b128 v[176:179], v24 offset:6912
    ds_read_b128 v[180:183], v24 offset:6976
    v_and_b32 v29, 3, v8
    v_mul_u32_u24 v68, 0x5555, v29
    v_cndmask_b32 v64, 0, v30, vcc
    v_cndmask_b32 v65, 0, v30, vcc
    ds_read_b128 v[192:195], v24 offset:9216
    ds_read_b128 v[196:199], v24 offset:9280
    v_cndmask_b32 v66, 0, v30, s[68:69]
    v_cndmask_b32 v67, 0, v30, s[68:69]
    v_add_u32 v114, 144256, v69
    v_add_u32 v71, 0x10000, v70
    ds_read_b128 v[208:211], v24 offset:11520
    ds_read_b128 v[212:215], v24 offset:11584
    v_mov_b64 v[32:33], s[80:81]
    v_mov_b64 v[34:35], s[82:83]
    v_mov_b64 v[36:37], s[80:81]
    v_mov_b64 v[38:39], s[82:83]
    ds_read_b128 v[224:227], v24 offset:13824
    ds_read_b128 v[228:231], v24 offset:13888
    v_mov_b64 v[40:41], s[80:81]
    v_mov_b64 v[42:43], s[82:83]
    v_mov_b64 v[44:45], s[80:81]
    v_mov_b64 v[46:47], s[82:83]
    ds_read_b128 v[240:243], v24 offset:16128
    ds_read_b128 v[244:247], v24 offset:16192
    v_mov_b64 v[48:49], s[80:81]
    v_mov_b64 v[50:51], s[82:83]
    v_mov_b64 v[52:53], s[80:81]
    v_mov_b64 v[54:55], s[82:83]
    v_mov_b64 v[56:57], s[80:81]
    v_mov_b64 v[58:59], s[82:83]
    v_mov_b64 v[60:61], s[80:81]
    v_mov_b64 v[62:63], s[82:83]

    s_bitcmp1_b32 s56, 1
    s_cselect_b32 s84, s78, s77
    s_lshl_b32 s85, s56, 10
    s_add_u32 m0, s85, 144256
    s_and_b32 s85, s85, 1024
    s_add_u32 s84, s84, s85

    s_add_u32 s85, s84, 0
    buffer_load_dwordx4 v[88:91], v69, s[12:15], s85 offen sc1
    s_add_u32 s85, s84, 4096
    buffer_load_dwordx4 v[88:91], v69, s[12:15], s85 offen sc1
    s_add_u32 s85, s84, 8192
    buffer_load_dwordx4 v[88:91], v69, s[12:15], s85 offen sc1
    s_add_u32 s85, s84, 12288
    buffer_load_dwordx4 v[88:91], v69, s[12:15], s85 offen sc1

    s_cmp_lg_u32 s48, 0
    s_cbranch_scc1 standalone__deep_cross_pnn__recsys_kernel_wdec
    s_mov_b64 exec, -1
    v_lshlrev_b32 v0, 7, v8
    v_lshrrev_b32 v2, 5, v8
    v_lshlrev_b32 v2, 4, v2
    v_lshlrev_b32 v3, 2, v8
    s_mov_b32 s44, 14680064
    s_bfe_u32 s46, s2, 131072
    s_lshl_b32 s47, s46, 7
    s_add_u32 s47, s47, 14688256
    s_lshl_b32 s46, s46, 2
    s_mov_b32 s38, 3221225472

standalone__deep_cross_pnn__recsys_kernel_p0:

    ds_read_b32 v12, v11 offset:20
    s_waitcnt lgkmcnt(0)
    v_readfirstlane_b32 s45, v12
    s_and_b32 s45, s45, 3
    s_cbranch_scc0 standalone__deep_cross_pnn__recsys_kernel_p1s
    s_sleep 1
    s_branch standalone__deep_cross_pnn__recsys_kernel_p0

standalone__deep_cross_pnn__recsys_kernel_p1s:

    s_cmp_lg_u32 s64, 0
    s_cbranch_scc1 standalone__deep_cross_pnn__recsys_kernel_hset

    s_mov_b64 exec, 1
    s_cmp_lg_u32 s49, -1
    s_cbranch_scc1 standalone__deep_cross_pnn__recsys_kernel_nfp
    v_mov_b32 v1, 1
    buffer_atomic_add v1, v13, s[12:15], s47 offen sc0
    buffer_store_dword v10, v13, s[12:15], s9 offen sc1
    s_waitcnt vmcnt(1)
    v_cmpx_eq_u32 vcc, 63, v1
    buffer_store_dword v10, v13, s[52:55], s46 offen sc1
    s_mov_b64 exec, 0xf

standalone__deep_cross_pnn__recsys_kernel_p1:

    buffer_load_dword v1, v3, s[52:55], 0 offen sc1
    s_add_u32 s65, s65, 1
    s_waitcnt vmcnt(0)
    v_cmp_eq_u32 vcc, 0, v1
    s_cbranch_vccz standalone__deep_cross_pnn__recsys_kernel_dec
    s_sleep 4
    s_cmp_lt_u32 s65, 200
    s_cbranch_scc1 standalone__deep_cross_pnn__recsys_kernel_p1
    s_mov_b64 exec, 1

standalone__deep_cross_pnn__recsys_kernel_nfp:

    buffer_store_dword v10, v13, s[12:15], s9 offen sc1
    s_mov_b64 exec, -1

standalone__deep_cross_pnn__recsys_kernel_slow:
    buffer_load_dwordx2 v[16:17], v2, s[52:55], 0 offen offset:128 sc1
    buffer_load_dwordx2 v[18:19], v2, s[52:55], 0 offen offset:160 sc1
    buffer_load_dwordx2 v[20:21], v2, s[52:55], 0 offen offset:192 sc1
    buffer_load_dwordx2 v[22:23], v2, s[52:55], 0 offen offset:224 sc1

    s_waitcnt vmcnt(0)
    buffer_load_dwordx4 v[4:7], v0, s[12:15], s44 offen sc1
    s_add_u32 s65, s65, 1
    s_waitcnt vmcnt(0)

    v_bfe_u32 v16, v16, v8, 1
    v_bfe_u32 v17, v17, v8, 1
    v_and_b32 v4, v4, v16
    v_or_b32 v17, v17, v4

    v_bfe_u32 v18, v18, v8, 1
    v_bfe_u32 v19, v19, v8, 1
    v_and_b32 v5, v5, v18
    v_or_b32 v19, v19, v5

    v_bfe_u32 v20, v20, v8, 1
    v_bfe_u32 v21, v21, v8, 1
    v_and_b32 v6, v6, v20
    v_or_b32 v21, v21, v6

    v_bfe_u32 v22, v22, v8, 1
    v_bfe_u32 v23, v23, v8, 1
    v_and_b32 v7, v7, v22
    v_or_b32 v23, v23, v7

    v_min3_u32 v1, v4, v5, v6
    v_min_u32 v1, v1, v7
    v_cmp_eq_u32 vcc, 0, v1
    s_mov_b32 s38, 3221225472
    s_cbranch_vccz standalone__deep_cross_pnn__recsys_kernel_dec
    v_min3_u32 v1, v17, v19, v21
    v_min_u32 v1, v1, v23
    v_cmp_eq_u32 vcc, 0, v1
    s_mov_b32 s38, 2147483648
    s_cbranch_vccz standalone__deep_cross_pnn__recsys_kernel_dec
    s_cmp_lt_u32 s65, 200
    s_cbranch_scc1 standalone__deep_cross_pnn__recsys_kernel_slow

    v_cmp_eq_u32 vcc, 0, v17
    s_movk_i32 s38, 0
    s_cbranch_vccnz standalone__deep_cross_pnn__recsys_kernel_fnd
    v_cmp_eq_u32 vcc, 0, v19
    s_movk_i32 s38, 64
    s_cbranch_vccnz standalone__deep_cross_pnn__recsys_kernel_fnd
    v_cmp_eq_u32 vcc, 0, v21
    s_movk_i32 s38, 128
    s_cbranch_vccnz standalone__deep_cross_pnn__recsys_kernel_fnd
    v_cmp_eq_u32 vcc, 0, v23
    s_movk_i32 s38, 192
standalone__deep_cross_pnn__recsys_kernel_fnd:

    s_ff1_i32_b64 s39, vcc
    s_add_u32 s38, s38, s39
    s_andn2_b32 s39, s64, 255
    s_add_u32 s39, s39, 256
    s_or_b32 s38, s38, s39

standalone__deep_cross_pnn__recsys_kernel_dec:

    s_mov_b64 exec, 1
    v_mov_b32 v1, s38
    ds_write_b32 v11, v1 offset:24

standalone__deep_cross_pnn__recsys_kernel_wdec:

    s_mov_b64 exec, -1
    ds_read_b32 v12, v11 offset:24
    s_waitcnt lgkmcnt(0)
    v_readfirstlane_b32 s45, v12
    s_cmp_lg_u32 s45, s64
    s_cbranch_scc1 standalone__deep_cross_pnn__recsys_kernel_gotd
    s_sleep 2
    s_branch standalone__deep_cross_pnn__recsys_kernel_wdec

standalone__deep_cross_pnn__recsys_kernel_hlp:
    s_waitcnt vmcnt(0)
    s_branch standalone__deep_cross_pnn__recsys_kernel_unit
standalone__deep_cross_pnn__recsys_kernel_gotd:

    s_mov_b32 s64, s45
    s_and_b32 s51, s45, 255

    s_mov_b32 s65, 200
    s_bitcmp0_b32 s45, 31
    s_cbranch_scc1 standalone__deep_cross_pnn__recsys_kernel_hlp

    s_cmp_eq_u32 s49, -1
    s_cbranch_scc1 standalone__deep_cross_pnn__recsys_kernel_k2

    s_xor_b32 s44, s50, 1
    s_lshl_b32 s44, s44, 3
    s_add_u32 s44, s44, s56
    s_lshl_b32 s44, s44, 14
    s_add_u32 s44, s44, 15204352
    s_add_u32 s47, s44, 65536

    buffer_load_dwordx4 v[136:139], v9, s[12:15], s44 offen offset:0 sc1
    buffer_load_dwordx4 v[140:143], v9, s[12:15], s44 offen offset:1024 sc1
    buffer_load_dwordx4 v[152:155], v9, s[12:15], s44 offen offset:2048 sc1
    buffer_load_dwordx4 v[156:159], v9, s[12:15], s44 offen offset:3072 sc1
    s_add_u32 s44, s44, 4096
    buffer_load_dwordx4 v[168:171], v9, s[12:15], s44 offen offset:0 sc1
    buffer_load_dwordx4 v[172:175], v9, s[12:15], s44 offen offset:1024 sc1
    buffer_load_dwordx4 v[184:187], v9, s[12:15], s44 offen offset:2048 sc1
    buffer_load_dwordx4 v[188:191], v9, s[12:15], s44 offen offset:3072 sc1
    s_add_u32 s44, s44, 4096
    s_waitcnt vmcnt(7)
    buffer_load_dwordx4 v[200:203], v9, s[12:15], s44 offen offset:0 sc1
    s_waitcnt vmcnt(7)
    buffer_load_dwordx4 v[204:207], v9, s[12:15], s44 offen offset:1024 sc1
    s_waitcnt vmcnt(7)
    buffer_load_dwordx4 v[216:219], v9, s[12:15], s44 offen offset:2048 sc1
    s_waitcnt vmcnt(7)
    buffer_load_dwordx4 v[220:223], v9, s[12:15], s44 offen offset:3072 sc1
    s_add_u32 s44, s44, 4096
    s_waitcnt vmcnt(7)
    buffer_load_dwordx4 v[232:235], v9, s[12:15], s44 offen offset:0 sc1
    s_waitcnt vmcnt(7)
    buffer_load_dwordx4 v[236:239], v9, s[12:15], s44 offen offset:1024 sc1
    s_waitcnt vmcnt(7)
    buffer_load_dwordx4 v[248:251], v9, s[12:15], s44 offen offset:2048 sc1
    s_waitcnt vmcnt(7)
    buffer_load_dwordx4 v[252:255], v9, s[12:15], s44 offen offset:3072 sc1
    s_add_u32 s44, s44, 4096
    s_waitcnt vmcnt(7)
    buffer_load_dwordx4 v[88:91], v9, s[12:15], s47 offen offset:0 sc1
    s_waitcnt vmcnt(7)
    buffer_load_dwordx4 v[88:91], v9, s[12:15], s47 offen offset:1024 sc1
    s_waitcnt vmcnt(7)
    buffer_load_dwordx4 v[88:91], v9, s[12:15], s47 offen offset:2048 sc1
    s_waitcnt vmcnt(7)
    buffer_load_dwordx4 v[88:91], v9, s[12:15], s47 offen offset:3072 sc1
    s_add_u32 s47, s47, 4096
    s_waitcnt vmcnt(7)
    buffer_load_dwordx4 v[88:91], v9, s[12:15], s47 offen offset:0 sc1
    s_waitcnt vmcnt(7)
    buffer_load_dwordx4 v[88:91], v9, s[12:15], s47 offen offset:1024 sc1
    s_waitcnt vmcnt(7)
    buffer_load_dwordx4 v[88:91], v9, s[12:15], s47 offen offset:2048 sc1
    s_waitcnt vmcnt(7)
    buffer_load_dwordx4 v[88:91], v9, s[12:15], s47 offen offset:3072 sc1
    s_add_u32 s47, s47, 4096
    s_waitcnt vmcnt(7)
    buffer_load_dwordx4 v[88:91], v9, s[12:15], s47 offen offset:0 sc1
    s_waitcnt vmcnt(7)
    buffer_load_dwordx4 v[88:91], v9, s[12:15], s47 offen offset:1024 sc1
    s_waitcnt vmcnt(7)
    buffer_load_dwordx4 v[88:91], v9, s[12:15], s47 offen offset:2048 sc1
    s_waitcnt vmcnt(7)
    buffer_load_dwordx4 v[88:91], v9, s[12:15], s47 offen offset:3072 sc1
    s_add_u32 s47, s47, 4096
    s_waitcnt vmcnt(7)
    buffer_load_dwordx4 v[88:91], v9, s[12:15], s47 offen offset:0 sc1
    s_waitcnt vmcnt(7)
    buffer_load_dwordx4 v[88:91], v9, s[12:15], s47 offen offset:1024 sc1
    s_waitcnt vmcnt(7)
    buffer_load_dwordx4 v[88:91], v9, s[12:15], s47 offen offset:2048 sc1
    s_waitcnt vmcnt(7)
    buffer_load_dwordx4 v[88:91], v9, s[12:15], s47 offen offset:3072 sc1
    s_add_u32 s47, s47, 4096
standalone__deep_cross_pnn__recsys_kernel_k2:
    s_setprio 1
    buffer_load_dwordx4 v[0:3], v69, s[12:15], s77 offen offset:0 sc1
    buffer_load_dwordx4 v[4:7], v69, s[12:15], s77 offen offset:1024 sc1
    buffer_load_dwordx4 v[8:11], v69, s[12:15], s78 offen offset:0 sc1
    buffer_load_dwordx4 v[12:15], v69, s[12:15], s78 offen offset:1024 sc1
    buffer_load_dwordx4 v69, s[12:15], s84 offen sc1 lds
    s_add_u32 m0, m0, 4096
    s_add_u32 s84, s84, 4096
    buffer_load_dwordx4 v69, s[12:15], s84 offen sc1 lds
    s_add_u32 m0, m0, 4096
    s_add_u32 s84, s84, 4096
    buffer_load_dwordx4 v69, s[12:15], s84 offen sc1 lds
    s_add_u32 s44, s77, 4096
    s_add_u32 s45, s78, 4096
    buffer_load_dwordx4 v[16:19], v69, s[12:15], s44 offen offset:0 sc1
    buffer_load_dwordx4 v[20:23], v69, s[12:15], s44 offen offset:1024 sc1
    buffer_load_dwordx4 v[24:27], v69, s[12:15], s45 offen offset:0 sc1
    buffer_load_dwordx4 v[28:31], v69, s[12:15], s45 offen offset:1024 sc1
    s_barrier
    s_waitcnt vmcnt(7)
    v_mfma_f32_16x16x32_bf16 v[88:91], v[0:3], v[128:131], 0
    v_mfma_f32_16x16x32_bf16 v[92:95], v[0:3], v[144:147], 0
    s_add_u32 s21, s77, 12288
    v_mfma_f32_16x16x32_bf16 v[88:91], v[4:7], v[132:135], v[88:91]
    s_add_u32 s19, s78, 12288
    v_mfma_f32_16x16x32_bf16 v[92:95], v[4:7], v[148:151], v[92:95]
    s_mov_b32 s20, s79
    v_mfma_f32_16x16x32_bf16 v[88:91], v[8:11], v[136:139], v[88:91]
    s_lshr_b32 s33, s2, 1
    v_mfma_f32_16x16x32_bf16 v[92:95], v[8:11], v[152:155], v[92:95]
    s_and_b32 s34, s2, 1
    v_mfma_f32_16x16x32_bf16 v[88:91], v[12:15], v[140:143], v[88:91]
    s_load_dwordx4 s[56:59], s[0:1], 48
    v_mfma_f32_16x16x32_bf16 v[92:95], v[12:15], v[156:159], v[92:95]
    v_mfma_f32_16x16x32_bf16 v[96:99], v[0:3], v[160:163], 0
    v_mfma_f32_16x16x32_bf16 v[100:103], v[0:3], v[176:179], 0
    v_mfma_f32_16x16x32_bf16 v[96:99], v[4:7], v[164:167], v[96:99]
    v_cvt_pk_bf16_f32 v116, v88, v89
    v_mfma_f32_16x16x32_bf16 v[100:103], v[4:7], v[180:183], v[100:103]
    v_cvt_pk_bf16_f32 v117, v90, v91
    v_mfma_f32_16x16x32_bf16 v[96:99], v[8:11], v[168:171], v[96:99]
    v_mfma_f32_16x16x32_bf16 v[100:103], v[8:11], v[184:187], v[100:103]
    v_cvt_pk_bf16_f32 v118, v92, v93
    v_mfma_f32_16x16x32_bf16 v[96:99], v[12:15], v[172:175], v[96:99]
    v_cvt_pk_bf16_f32 v119, v94, v95
    v_mfma_f32_16x16x32_bf16 v[100:103], v[12:15], v[188:191], v[100:103]
    v_mfma_f32_16x16x32_bf16 v[104:107], v[0:3], v[192:195], 0
    v_mfma_f32_16x16x32_bf16 v[108:111], v[0:3], v[208:211], 0
    v_mfma_f32_16x16x32_bf16 v[104:107], v[4:7], v[196:199], v[104:107]
    v_cvt_pk_bf16_f32 v120, v96, v97
    v_mfma_f32_16x16x32_bf16 v[108:111], v[4:7], v[212:215], v[108:111]
    v_cvt_pk_bf16_f32 v121, v98, v99
    v_mfma_f32_16x16x32_bf16 v[104:107], v[8:11], v[200:203], v[104:107]
    v_mfma_f32_16x16x32_bf16 v[108:111], v[8:11], v[216:219], v[108:111]
    v_cvt_pk_bf16_f32 v122, v100, v101
    v_mfma_f32_16x16x32_bf16 v[104:107], v[12:15], v[204:207], v[104:107]
    v_cvt_pk_bf16_f32 v123, v102, v103
    v_mfma_f32_16x16x32_bf16 v[108:111], v[12:15], v[220:223], v[108:111]
    v_mfma_f32_16x16x32_bf16 v[88:91], v[0:3], v[224:227], 0
    v_mfma_f32_16x16x32_bf16 v[92:95], v[0:3], v[240:243], 0
    v_mfma_f32_16x16x32_bf16 v[88:91], v[4:7], v[228:231], v[88:91]
    v_cvt_pk_bf16_f32 v124, v104, v105
    v_mfma_f32_16x16x32_bf16 v[92:95], v[4:7], v[244:247], v[92:95]
    v_cvt_pk_bf16_f32 v125, v106, v107
    v_mfma_f32_16x16x32_bf16 v[88:91], v[8:11], v[232:235], v[88:91]
    v_mfma_f32_16x16x32_bf16 v[92:95], v[8:11], v[248:251], v[92:95]
    v_cvt_pk_bf16_f32 v126, v108, v109
    v_mfma_f32_16x16x32_bf16 v[88:91], v[12:15], v[236:239], v[88:91]
    v_cvt_pk_bf16_f32 v127, v110, v111
    v_mfma_f32_16x16x32_bf16 v[92:95], v[12:15], v[252:255], v[92:95]
    s_waitcnt vmcnt(0)
    v_mfma_f32_16x16x32_bf16 v[96:99], v[16:19], v[128:131], 0
    v_mfma_f32_16x16x32_bf16 v[100:103], v[16:19], v[144:147], 0
    v_mfma_f32_16x16x32_bf16 v[96:99], v[20:23], v[132:135], v[96:99]
    v_cvt_pk_bf16_f32 v72, v88, v89
    v_mfma_f32_16x16x32_bf16 v[100:103], v[20:23], v[148:151], v[100:103]
    v_cvt_pk_bf16_f32 v73, v90, v91
    s_waitcnt vmcnt(4)
    s_barrier
    v_mfma_f32_16x16x32_bf16 v[96:99], v[24:27], v[136:139], v[96:99]
    v_mfma_f32_16x16x32_bf16 v[100:103], v[24:27], v[152:155], v[100:103]
    v_cvt_pk_bf16_f32 v74, v92, v93
    v_mfma_f32_16x16x32_bf16 v[96:99], v[28:31], v[140:143], v[96:99]
    v_cvt_pk_bf16_f32 v75, v94, v95
    v_mfma_f32_16x16x32_bf16 v[100:103], v[28:31], v[156:159], v[100:103]
    v_mfma_f32_16x16x32_bf16 v[104:107], v[16:19], v[160:163], 0
    v_mfma_f32_16x16x32_bf16 v[108:111], v[16:19], v[176:179], 0
    v_mfma_f32_16x16x32_bf16 v[104:107], v[20:23], v[164:167], v[104:107]
    v_cvt_pk_bf16_f32 v76, v96, v97
    v_mfma_f32_16x16x32_bf16 v[108:111], v[20:23], v[180:183], v[108:111]
    v_cvt_pk_bf16_f32 v77, v98, v99
    v_mfma_f32_16x16x32_bf16 v[104:107], v[24:27], v[168:171], v[104:107]
    v_mfma_f32_16x16x32_bf16 v[108:111], v[24:27], v[184:187], v[108:111]
    v_cvt_pk_bf16_f32 v78, v100, v101
    v_mfma_f32_16x16x32_bf16 v[104:107], v[28:31], v[172:175], v[104:107]
    v_cvt_pk_bf16_f32 v79, v102, v103
    v_mfma_f32_16x16x32_bf16 v[108:111], v[28:31], v[188:191], v[108:111]
    v_mfma_f32_16x16x32_bf16 v[88:91], v[16:19], v[192:195], 0
    v_mfma_f32_16x16x32_bf16 v[92:95], v[16:19], v[208:211], 0
    v_mfma_f32_16x16x32_bf16 v[88:91], v[20:23], v[196:199], v[88:91]
    v_cvt_pk_bf16_f32 v80, v104, v105
    v_mfma_f32_16x16x32_bf16 v[92:95], v[20:23], v[212:215], v[92:95]
    v_cvt_pk_bf16_f32 v81, v106, v107
    v_mfma_f32_16x16x32_bf16 v[88:91], v[24:27], v[200:203], v[88:91]
    v_mfma_f32_16x16x32_bf16 v[92:95], v[24:27], v[216:219], v[92:95]
    v_cvt_pk_bf16_f32 v82, v108, v109
    v_mfma_f32_16x16x32_bf16 v[88:91], v[28:31], v[204:207], v[88:91]
    v_cvt_pk_bf16_f32 v83, v110, v111
    ds_write_b64 v70, v[116:117] offset:0
    v_mfma_f32_16x16x32_bf16 v[92:95], v[28:31], v[220:223], v[92:95]
    ds_read_b128 v[0:3], v114 offset:8192
    ds_read_b128 v[4:7], v114 offset:9216
    ds_read_b128 v[8:11], v114 offset:10240
    ds_read_b128 v[12:15], v114 offset:11264
    v_mfma_f32_16x16x32_bf16 v[96:99], v[16:19], v[224:227], 0
    ds_write_b64 v70, v[118:119] offset:128
    v_mfma_f32_16x16x32_bf16 v[100:103], v[16:19], v[240:243], 0
    v_mfma_f32_16x16x32_bf16 v[96:99], v[20:23], v[228:231], v[96:99]
    v_cvt_pk_bf16_f32 v88, v88, v89
    ds_write_b64 v70, v[120:121] offset:256
    v_mfma_f32_16x16x32_bf16 v[100:103], v[20:23], v[244:247], v[100:103]
    v_cvt_pk_bf16_f32 v89, v90, v91
    v_mfma_f32_16x16x32_bf16 v[96:99], v[24:27], v[232:235], v[96:99]
    ds_write_b64 v70, v[88:89] offset:33280
    ds_write_b64 v70, v[122:123] offset:384
    v_mfma_f32_16x16x32_bf16 v[100:103], v[24:27], v[248:251], v[100:103]
    v_cvt_pk_bf16_f32 v92, v92, v93
    v_mfma_f32_16x16x32_bf16 v[96:99], v[28:31], v[236:239], v[96:99]
    v_cvt_pk_bf16_f32 v93, v94, v95
    ds_write_b64 v70, v[124:125] offset:512
    v_mfma_f32_16x16x32_bf16 v[100:103], v[28:31], v[252:255], v[100:103]
    ds_write_b64 v70, v[92:93] offset:33408
    s_waitcnt lgkmcnt(6)
    v_mfma_f32_16x16x32_bf16 v[104:107], v[0:3], v[128:131], 0
    buffer_load_dwordx4 v[116:119], v69, s[12:15], s20 offen offset:0 sc1
    ds_write_b64 v70, v[126:127] offset:640
    v_mfma_f32_16x16x32_bf16 v[108:111], v[0:3], v[144:147], 0
    v_mfma_f32_16x16x32_bf16 v[104:107], v[4:7], v[132:135], v[104:107]
    v_cvt_pk_bf16_f32 v96, v96, v97
    ds_write_b64 v70, v[72:73] offset:768
    v_mfma_f32_16x16x32_bf16 v[108:111], v[4:7], v[148:151], v[108:111]
    v_cvt_pk_bf16_f32 v97, v98, v99
    v_mfma_f32_16x16x32_bf16 v[104:107], v[8:11], v[136:139], v[104:107]
    ds_write_b64 v70, v[96:97] offset:33536
    buffer_load_dwordx4 v[120:123], v69, s[12:15], s20 offen offset:1024 sc1
    v_mfma_f32_16x16x32_bf16 v[108:111], v[8:11], v[152:155], v[108:111]
    v_cvt_pk_bf16_f32 v100, v100, v101
    ds_write_b64 v70, v[74:75] offset:896
    v_mfma_f32_16x16x32_bf16 v[104:107], v[12:15], v[140:143], v[104:107]
    v_cvt_pk_bf16_f32 v101, v102, v103
    v_mov_b64 v[16:17], s[80:81]
    v_mfma_f32_16x16x32_bf16 v[108:111], v[12:15], v[156:159], v[108:111]
    ds_write_b64 v70, v[100:101] offset:33664
    v_mov_b64 v[18:19], s[82:83]
    v_mfma_f32_16x16x32_bf16 v[88:91], v[0:3], v[160:163], 0
    v_mov_b64 v[20:21], s[80:81]
    v_mov_b64 v[22:23], s[82:83]
    v_mfma_f32_16x16x32_bf16 v[92:95], v[0:3], v[176:179], 0
    v_mov_b64 v[24:25], s[80:81]
    v_mov_b64 v[26:27], s[82:83]
    v_mfma_f32_16x16x32_bf16 v[88:91], v[4:7], v[164:167], v[88:91]
    v_cvt_pk_bf16_f32 v104, v104, v105
    v_mov_b64 v[28:29], s[80:81]
    v_mfma_f32_16x16x32_bf16 v[92:95], v[4:7], v[180:183], v[92:95]
    v_cvt_pk_bf16_f32 v105, v106, v107
    v_mov_b64 v[30:31], s[82:83]
    v_mfma_f32_16x16x32_bf16 v[88:91], v[8:11], v[168:171], v[88:91]
    ds_write_b64 v71, v[104:105] offset:0
    ds_write_b64 v70, v[76:77] offset:32768
    v_mfma_f32_16x16x32_bf16 v[92:95], v[8:11], v[184:187], v[92:95]
    v_cvt_pk_bf16_f32 v108, v108, v109
    buffer_load_dwordx4 v[124:127], v69, s[12:15], s20 offen offset:2048 sc1
    v_mfma_f32_16x16x32_bf16 v[88:91], v[12:15], v[172:175], v[88:91]
    v_cvt_pk_bf16_f32 v109, v110, v111
    ds_write_b64 v70, v[78:79] offset:32896
    v_mfma_f32_16x16x32_bf16 v[92:95], v[12:15], v[188:191], v[92:95]
    ds_write_b64 v71, v[108:109] offset:128
    ds_write_b64 v70, v[80:81] offset:33024
    v_mfma_f32_16x16x32_bf16 v[96:99], v[0:3], v[192:195], 0
    buffer_load_dwordx4 v[72:75], v69, s[12:15], s21 offen offset:0 sc1
    ds_write_b64 v70, v[82:83] offset:33152
    v_mfma_f32_16x16x32_bf16 v[100:103], v[0:3], v[208:211], 0
    buffer_load_dwordx4 v[76:79], v69, s[12:15], s21 offen offset:1024 sc1
    v_mfma_f32_16x16x32_bf16 v[96:99], v[4:7], v[196:199], v[96:99]
    v_cvt_pk_bf16_f32 v88, v88, v89
    v_mfma_f32_16x16x32_bf16 v[100:103], v[4:7], v[212:215], v[100:103]
    v_cvt_pk_bf16_f32 v89, v90, v91
    v_mfma_f32_16x16x32_bf16 v[96:99], v[8:11], v[200:203], v[96:99]
    ds_write_b64 v71, v[88:89] offset:256
    buffer_load_dwordx4 v[80:83], v69, s[12:15], s19 offen offset:0 sc1
    v_mfma_f32_16x16x32_bf16 v[100:103], v[8:11], v[216:219], v[100:103]
    v_cvt_pk_bf16_f32 v92, v92, v93
    v_mfma_f32_16x16x32_bf16 v[96:99], v[12:15], v[204:207], v[96:99]
    v_cvt_pk_bf16_f32 v93, v94, v95
    v_mfma_f32_16x16x32_bf16 v[100:103], v[12:15], v[220:223], v[100:103]
    ds_write_b64 v71, v[92:93] offset:384
    v_mfma_f32_16x16x32_bf16 v[104:107], v[0:3], v[224:227], 0
    buffer_load_dwordx4 v[84:87], v69, s[12:15], s19 offen offset:1024 sc1
    s_add_u32 s21, s21, 4096
    s_add_u32 s19, s19, 4096
    v_mfma_f32_16x16x32_bf16 v[108:111], v[0:3], v[240:243], 0
    v_mfma_f32_16x16x32_bf16 v[104:107], v[4:7], v[228:231], v[104:107]
    v_cvt_pk_bf16_f32 v96, v96, v97
    v_mfma_f32_16x16x32_bf16 v[108:111], v[4:7], v[244:247], v[108:111]
    v_cvt_pk_bf16_f32 v97, v98, v99
    v_mfma_f32_16x16x32_bf16 v[104:107], v[8:11], v[232:235], v[104:107]
    ds_write_b64 v71, v[96:97] offset:512
    v_mfma_f32_16x16x32_bf16 v[108:111], v[8:11], v[248:251], v[108:111]
    v_cvt_pk_bf16_f32 v100, v100, v101
    v_mov_b64 v[0:1], s[80:81]
    v_mfma_f32_16x16x32_bf16 v[104:107], v[12:15], v[236:239], v[104:107]
    v_cvt_pk_bf16_f32 v101, v102, v103
    v_mov_b64 v[2:3], s[82:83]
    v_mfma_f32_16x16x32_bf16 v[108:111], v[12:15], v[252:255], v[108:111]
    ds_write_b64 v71, v[100:101] offset:640
    v_mov_b64 v[4:5], s[80:81]
    s_nop 1
    v_mov_b64 v[6:7], s[82:83]
    v_mov_b64 v[8:9], s[80:81]
    v_mov_b64 v[10:11], s[82:83]
    v_mov_b64 v[12:13], s[80:81]
    v_mov_b64 v[14:15], s[82:83]
    s_nop 4
    v_cvt_pk_bf16_f32 v104, v104, v105
    v_cvt_pk_bf16_f32 v105, v106, v107
    ds_write_b64 v71, v[104:105] offset:768
    v_cvt_pk_bf16_f32 v108, v108, v109
    v_cvt_pk_bf16_f32 v109, v110, v111
    ds_write_b64 v71, v[108:109] offset:896
    v_add_u32 v70, 0x18000, v70
    s_branch standalone__deep_cross_pnn__recsys_kernel_k2j
standalone__deep_cross_pnn__recsys_kernel_k2m:
    s_barrier

    s_setprio 0
    s_waitcnt vmcnt(0)

    buffer_load_dwordx4 v[136:139], v254, s[12:15], s44 offen offset:0 sc1
    ds_read_b128 v[128:131], v95 offset:0
    ds_read_b128 v[132:135], v95 offset:64
    ds_read_b128 v[144:147], v95 offset:2304
    ds_read_b128 v[148:151], v95 offset:2368
    v_fma_f32 v85, v188, v64, v240
    v_mov_b32 v84, v239
    v_mov_b32 v86, v241
    v_mov_b32 v113, v243
    v_mov_b32 v112, v94
    v_add_u32 v114, 144256, v254
    v_fmac_f32 v85, v189, v65
    v_fmac_f32 v85, v190, v66
    v_fmac_f32 v85, v191, v67
    v_fmac_f32 v85, v192, v68
    buffer_load_dwordx4 v[140:143], v254, s[12:15], s44 offen offset:1024 sc1
    ds_read_b128 v[160:163], v95 offset:4608
    ds_read_b128 v[164:167], v95 offset:4672
    ds_read_b128 v[176:179], v95 offset:6912
    ds_read_b128 v[180:183], v95 offset:6976
    v_fmac_f32 v85, v193, v69
    v_fmac_f32 v85, v194, v70
    v_fmac_f32 v85, v195, v71
    v_fmac_f32 v85, v196, v72
    v_fmac_f32 v85, v197, v73
    buffer_load_dwordx4 v[152:155], v254, s[12:15], s44 offen offset:2048 sc1
    ds_read_b128 v[208:211], v95 offset:11520
    ds_read_b128 v[212:215], v95 offset:11584
    ds_read_b128 v[224:227], v95 offset:13824
    ds_read_b128 v[228:231], v95 offset:13888
    v_fmac_f32 v85, v198, v74
    v_fmac_f32 v85, v199, v75
    v_fmac_f32 v85, v200, v76
    v_fmac_f32 v85, v201, v77
    v_fmac_f32 v85, v202, v78
    buffer_load_dwordx4 v[156:159], v254, s[12:15], s44 offen offset:3072 sc1
    s_add_u32 s44, s44, 4096
    ds_read_b128 v[240:243], v95 offset:16128
    ds_read_b128 v[244:247], v95 offset:16192
    ds_read_b128 v[192:195], v95 offset:9216
    ds_read_b128 v[196:199], v95 offset:9280
    v_fmac_f32 v85, v203, v79
    v_fmac_f32 v85, v204, v80
    v_fmac_f32 v85, v205, v81
    v_fmac_f32 v85, v206, v82
    v_fmac_f32 v85, v207, v83
    buffer_load_dwordx4 v[168:171], v254, s[12:15], s44 offen offset:0 sc1
    v_and_b32 v49, 15, v255
    v_lshrrev_b32 v50, 4, v255
    v_lshlrev_b32 v69, 4, v255
    v_lshlrev_b32 v70, 13, v50
    buffer_load_dwordx4 v[172:175], v254, s[12:15], s44 offen offset:1024 sc1
    v_lshl_add_u32 v70, v49, 3, v70
    v_add_u32 v70, s85, v70
    v_add_u32 v71, 0x10000, v70
    s_waitcnt lgkmcnt(0)
    s_barrier
    s_setprio 2
    ds_read_b128 v[0:3], v114 offset:0
    ds_read_b128 v[4:7], v114 offset:1024
    ds_read_b128 v[8:11], v114 offset:2048
    ds_read_b128 v[12:15], v114 offset:3072
    s_add_u32 s21, s77, 12288
    s_add_u32 s19, s78, 12288
    s_mov_b32 s20, s79
    s_lshr_b32 s33, s2, 1
    s_and_b32 s34, s2, 1
    v_lshrrev_b32 v52, 3, v255
    v_xor_b32 v52, v52, v50
    v_and_b32 v52, 1, v52
    v_bfe_u32 v53, v255, 2, 1
    v_lshl_or_b32 v52, v52, 1, v53
    v_mov_b32 v54, 0x3f80
    s_waitcnt lgkmcnt(0)
    v_mfma_f32_16x16x32_bf16 v[88:91], v[0:3], v[128:131], 0
    buffer_load_dwordx4 v[184:187], v69, s[12:15], s44 offen offset:2048 sc1
    v_cmp_eq_u32 vcc, 0, v52
    ds_read_b128 v[16:19], v114 offset:4096
    ds_read_b128 v[20:23], v114 offset:5120
    ds_read_b128 v[24:27], v114 offset:6144
    ds_read_b128 v[28:31], v114 offset:7168
    v_mfma_f32_16x16x32_bf16 v[92:95], v[0:3], v[144:147], 0
    v_permlane32_swap_b32 v84, v85
    v_mfma_f32_16x16x32_bf16 v[88:91], v[4:7], v[132:135], v[88:91]
    v_cmp_eq_u32 s[68:69], 1, v52
    v_mfma_f32_16x16x32_bf16 v[92:95], v[4:7], v[148:151], v[92:95]
    v_add_f32 v87, v84, v85
    buffer_load_dwordx4 v[188:191], v69, s[12:15], s44 offen offset:3072 sc1
    s_add_u32 s44, s44, 4096
    s_waitcnt vmcnt(4)
    v_mfma_f32_16x16x32_bf16 v[88:91], v[8:11], v[136:139], v[88:91]
    v_and_b32 v53, 3, v255
    v_mfma_f32_16x16x32_bf16 v[92:95], v[8:11], v[152:155], v[92:95]
    v_permlane16_swap_b32 v86, v87
    v_mfma_f32_16x16x32_bf16 v[88:91], v[12:15], v[140:143], v[88:91]
    buffer_load_dwordx4 v[200:203], v69, s[12:15], s44 offen offset:0 sc1
    v_mul_u32_u24 v68, 0x5555, v53
    ds_read_b128 v[32:35], v114 offset:8192
    ds_read_b128 v[36:39], v114 offset:9216
    ds_read_b128 v[40:43], v114 offset:10240
    ds_read_b128 v[44:47], v114 offset:11264
    v_mfma_f32_16x16x32_bf16 v[92:95], v[12:15], v[156:159], v[92:95]
    v_add_f32 v86, v86, v87
    s_waitcnt lgkmcnt(4)
    v_mfma_f32_16x16x32_bf16 v[96:99], v[16:19], v[128:131], 0
    v_cndmask_b32 v64, 0, v54, vcc
    v_mfma_f32_16x16x32_bf16 v[100:103], v[16:19], v[144:147], 0
    v_add_f32_dpp v86, v86, v86 row_ror:8 row_mask:0xf bank_mask:0xf
    buffer_load_dwordx4 v[204:207], v69, s[12:15], s44 offen offset:1024 sc1
    v_mfma_f32_16x16x32_bf16 v[96:99], v[20:23], v[132:135], v[96:99]
    v_cvt_pk_bf16_f32 v88, v88, v89
    v_cndmask_b32 v65, 0, v54, vcc
    v_mfma_f32_16x16x32_bf16 v[100:103], v[20:23], v[148:151], v[100:103]
    v_cvt_pk_bf16_f32 v89, v90, v91
    v_add_f32_dpp v86, v86, v86 row_ror:4 row_mask:0xf bank_mask:0xf
    v_mfma_f32_16x16x32_bf16 v[96:99], v[24:27], v[136:139], v[96:99]
    ds_write_b64 v70, v[88:89] offset:0
    buffer_load_dwordx4 v[216:219], v69, s[12:15], s44 offen offset:2048 sc1
    v_mfma_f32_16x16x32_bf16 v[100:103], v[24:27], v[152:155], v[100:103]
    v_cvt_pk_bf16_f32 v92, v92, v93
    v_cndmask_b32 v66, 0, v54, s[68:69]
    v_mfma_f32_16x16x32_bf16 v[96:99], v[28:31], v[140:143], v[96:99]
    v_cvt_pk_bf16_f32 v93, v94, v95
    v_add_f32_dpp v86, v86, v86 row_ror:2 row_mask:0xf bank_mask:0xf
    v_mfma_f32_16x16x32_bf16 v[100:103], v[28:31], v[156:159], v[100:103]
    ds_write_b64 v70, v[92:93] offset:128
    v_cndmask_b32 v67, 0, v54, s[68:69]
    s_waitcnt lgkmcnt(2)
    v_mfma_f32_16x16x32_bf16 v[104:107], v[32:35], v[128:131], 0
    v_add_f32_dpp v86, v86, v86 row_ror:1 row_mask:0xf bank_mask:0xf
    buffer_load_dwordx4 v[220:223], v69, s[12:15], s44 offen offset:3072 sc1
    s_add_u32 s44, s44, 4096
    v_mfma_f32_16x16x32_bf16 v[108:111], v[32:35], v[144:147], 0
    v_cndmask_b32 v113, v113, v86, s[70:71]
    v_mfma_f32_16x16x32_bf16 v[104:107], v[36:39], v[132:135], v[104:107]
    v_cvt_pk_bf16_f32 v96, v96, v97
    buffer_load_dwordx4 v[232:235], v69, s[12:15], s44 offen offset:0 sc1
    v_mfma_f32_16x16x32_bf16 v[108:111], v[36:39], v[148:151], v[108:111]
    v_cvt_pk_bf16_f32 v97, v98, v99
    v_mfma_f32_16x16x32_bf16 v[104:107], v[40:43], v[136:139], v[104:107]
    ds_write_b64 v70, v[96:97] offset:32768
    v_mfma_f32_16x16x32_bf16 v[108:111], v[40:43], v[152:155], v[108:111]
    v_cvt_pk_bf16_f32 v100, v100, v101
    buffer_load_dwordx4 v[236:239], v69, s[12:15], s44 offen offset:1024 sc1
    v_mfma_f32_16x16x32_bf16 v[104:107], v[44:47], v[140:143], v[104:107]
    v_cvt_pk_bf16_f32 v101, v102, v103
    s_mov_b64 exec, s[46:47]
    buffer_store_dword v113, v112, s[12:15], s76 offen sc1
    s_mov_b64 exec, -1
    v_mfma_f32_16x16x32_bf16 v[108:111], v[44:47], v[156:159], v[108:111]
    ds_write_b64 v70, v[100:101] offset:32896
    v_mov_b64 v[48:49], s[80:81]
    v_mfma_f32_16x16x32_bf16 v[88:91], v[0:3], v[160:163], 0
    buffer_load_dwordx4 v[248:251], v69, s[12:15], s44 offen offset:2048 sc1
    v_mov_b64 v[50:51], s[82:83]
    v_mfma_f32_16x16x32_bf16 v[92:95], v[0:3], v[176:179], 0
    v_mov_b64 v[52:53], s[80:81]
    v_mfma_f32_16x16x32_bf16 v[88:91], v[4:7], v[164:167], v[88:91]
    v_cvt_pk_bf16_f32 v104, v104, v105
    v_mov_b64 v[54:55], s[82:83]
    v_mfma_f32_16x16x32_bf16 v[92:95], v[4:7], v[180:183], v[92:95]
    v_cvt_pk_bf16_f32 v105, v106, v107
    buffer_load_dwordx4 v[252:255], v69, s[12:15], s44 offen offset:3072 sc1
    s_add_u32 s44, s44, 4096
    s_waitcnt vmcnt(9)
    v_mfma_f32_16x16x32_bf16 v[88:91], v[8:11], v[168:171], v[88:91]
    ds_write_b64 v71, v[104:105] offset:0
    v_mov_b64 v[56:57], s[80:81]
    v_mfma_f32_16x16x32_bf16 v[92:95], v[8:11], v[184:187], v[92:95]
    v_cvt_pk_bf16_f32 v108, v108, v109
    v_mov_b64 v[58:59], s[82:83]
    v_mfma_f32_16x16x32_bf16 v[88:91], v[12:15], v[172:175], v[88:91]
    v_cvt_pk_bf16_f32 v109, v110, v111
    v_mov_b64 v[60:61], s[80:81]
    v_mfma_f32_16x16x32_bf16 v[92:95], v[12:15], v[188:191], v[92:95]
    ds_write_b64 v71, v[108:109] offset:128
    buffer_load_dwordx4 v[116:119], v69, s[12:15], s20 offen offset:0 sc1
    v_mfma_f32_16x16x32_bf16 v[96:99], v[16:19], v[160:163], 0
    v_mov_b64 v[62:63], s[82:83]
    v_mfma_f32_16x16x32_bf16 v[100:103], v[16:19], v[176:179], 0
    buffer_load_dwordx4 v[120:123], v69, s[12:15], s20 offen offset:1024 sc1
    v_mfma_f32_16x16x32_bf16 v[96:99], v[20:23], v[164:167], v[96:99]
    v_cvt_pk_bf16_f32 v88, v88, v89
    v_mfma_f32_16x16x32_bf16 v[100:103], v[20:23], v[180:183], v[100:103]
    v_cvt_pk_bf16_f32 v89, v90, v91
    v_mfma_f32_16x16x32_bf16 v[96:99], v[24:27], v[168:171], v[96:99]
    ds_write_b64 v70, v[88:89] offset:256
    buffer_load_dwordx4 v[124:127], v69, s[12:15], s20 offen offset:2048 sc1
    v_mfma_f32_16x16x32_bf16 v[100:103], v[24:27], v[184:187], v[100:103]
    v_cvt_pk_bf16_f32 v92, v92, v93
    v_mfma_f32_16x16x32_bf16 v[96:99], v[28:31], v[172:175], v[96:99]
    v_cvt_pk_bf16_f32 v93, v94, v95
    v_mfma_f32_16x16x32_bf16 v[100:103], v[28:31], v[188:191], v[100:103]
    ds_write_b64 v70, v[92:93] offset:384
    buffer_load_dwordx4 v[72:75], v69, s[12:15], s21 offen offset:0 sc1
    v_mfma_f32_16x16x32_bf16 v[104:107], v[32:35], v[160:163], 0
    v_mfma_f32_16x16x32_bf16 v[108:111], v[32:35], v[176:179], 0
    s_load_dwordx4 s[56:59], s[0:1], 48
    v_mfma_f32_16x16x32_bf16 v[104:107], v[36:39], v[164:167], v[104:107]
    v_cvt_pk_bf16_f32 v96, v96, v97
    buffer_load_dwordx4 v[76:79], v69, s[12:15], s21 offen offset:1024 sc1
    v_mfma_f32_16x16x32_bf16 v[108:111], v[36:39], v[180:183], v[108:111]
    v_cvt_pk_bf16_f32 v97, v98, v99
    v_mfma_f32_16x16x32_bf16 v[104:107], v[40:43], v[168:171], v[104:107]
    ds_write_b64 v70, v[96:97] offset:33024
    v_mfma_f32_16x16x32_bf16 v[108:111], v[40:43], v[184:187], v[108:111]
    v_cvt_pk_bf16_f32 v100, v100, v101
    buffer_load_dwordx4 v[80:83], v69, s[12:15], s19 offen offset:0 sc1
    v_mfma_f32_16x16x32_bf16 v[104:107], v[44:47], v[172:175], v[104:107]
    v_cvt_pk_bf16_f32 v101, v102, v103
    v_mfma_f32_16x16x32_bf16 v[108:111], v[44:47], v[188:191], v[108:111]
    ds_write_b64 v70, v[100:101] offset:33152
    v_mfma_f32_16x16x32_bf16 v[88:91], v[0:3], v[192:195], 0
    buffer_load_dwordx4 v[84:87], v69, s[12:15], s19 offen offset:1024 sc1
    s_add_u32 s21, s21, 4096
    s_add_u32 s19, s19, 4096
    v_mfma_f32_16x16x32_bf16 v[92:95], v[0:3], v[208:211], 0
    v_mfma_f32_16x16x32_bf16 v[88:91], v[4:7], v[196:199], v[88:91]
    v_cvt_pk_bf16_f32 v104, v104, v105
    v_mfma_f32_16x16x32_bf16 v[92:95], v[4:7], v[212:215], v[92:95]
    v_cvt_pk_bf16_f32 v105, v106, v107
    s_waitcnt vmcnt(12)
    v_mfma_f32_16x16x32_bf16 v[88:91], v[8:11], v[200:203], v[88:91]
    ds_write_b64 v71, v[104:105] offset:256
    v_mfma_f32_16x16x32_bf16 v[92:95], v[8:11], v[216:219], v[92:95]
    v_cvt_pk_bf16_f32 v108, v108, v109
    v_mfma_f32_16x16x32_bf16 v[88:91], v[12:15], v[204:207], v[88:91]
    v_cvt_pk_bf16_f32 v109, v110, v111
    v_mfma_f32_16x16x32_bf16 v[92:95], v[12:15], v[220:223], v[92:95]
    ds_write_b64 v71, v[108:109] offset:384
    v_mfma_f32_16x16x32_bf16 v[96:99], v[16:19], v[192:195], 0
    v_mfma_f32_16x16x32_bf16 v[100:103], v[16:19], v[208:211], 0
    v_mfma_f32_16x16x32_bf16 v[96:99], v[20:23], v[196:199], v[96:99]
    v_cvt_pk_bf16_f32 v88, v88, v89
    v_mfma_f32_16x16x32_bf16 v[100:103], v[20:23], v[212:215], v[100:103]
    v_cvt_pk_bf16_f32 v89, v90, v91
    v_mfma_f32_16x16x32_bf16 v[96:99], v[24:27], v[200:203], v[96:99]
    ds_write_b64 v70, v[88:89] offset:512
    v_mfma_f32_16x16x32_bf16 v[100:103], v[24:27], v[216:219], v[100:103]
    v_cvt_pk_bf16_f32 v92, v92, v93
    v_mfma_f32_16x16x32_bf16 v[96:99], v[28:31], v[204:207], v[96:99]
    v_cvt_pk_bf16_f32 v93, v94, v95
    v_mfma_f32_16x16x32_bf16 v[100:103], v[28:31], v[220:223], v[100:103]
    ds_write_b64 v70, v[92:93] offset:640
    v_mfma_f32_16x16x32_bf16 v[104:107], v[32:35], v[192:195], 0
    v_mfma_f32_16x16x32_bf16 v[108:111], v[32:35], v[208:211], 0
    v_mfma_f32_16x16x32_bf16 v[104:107], v[36:39], v[196:199], v[104:107]
    v_cvt_pk_bf16_f32 v96, v96, v97
    v_mfma_f32_16x16x32_bf16 v[108:111], v[36:39], v[212:215], v[108:111]
    v_cvt_pk_bf16_f32 v97, v98, v99
    v_mfma_f32_16x16x32_bf16 v[104:107], v[40:43], v[200:203], v[104:107]
    ds_write_b64 v70, v[96:97] offset:33280
    v_mfma_f32_16x16x32_bf16 v[108:111], v[40:43], v[216:219], v[108:111]
    v_cvt_pk_bf16_f32 v100, v100, v101
    v_mfma_f32_16x16x32_bf16 v[104:107], v[44:47], v[204:207], v[104:107]
    v_cvt_pk_bf16_f32 v101, v102, v103
    v_mfma_f32_16x16x32_bf16 v[108:111], v[44:47], v[220:223], v[108:111]
    ds_write_b64 v70, v[100:101] offset:33408
    v_mfma_f32_16x16x32_bf16 v[88:91], v[0:3], v[224:227], 0
    v_mfma_f32_16x16x32_bf16 v[92:95], v[0:3], v[240:243], 0
    v_mfma_f32_16x16x32_bf16 v[88:91], v[4:7], v[228:231], v[88:91]
    v_cvt_pk_bf16_f32 v104, v104, v105
    v_mfma_f32_16x16x32_bf16 v[92:95], v[4:7], v[244:247], v[92:95]
    v_cvt_pk_bf16_f32 v105, v106, v107
    s_waitcnt vmcnt(7)
    v_mfma_f32_16x16x32_bf16 v[88:91], v[8:11], v[232:235], v[88:91]
    ds_write_b64 v71, v[104:105] offset:512
    v_mfma_f32_16x16x32_bf16 v[92:95], v[8:11], v[248:251], v[92:95]
    v_cvt_pk_bf16_f32 v108, v108, v109
    v_mov_b64 v[0:1], s[80:81]
    v_mfma_f32_16x16x32_bf16 v[88:91], v[12:15], v[236:239], v[88:91]
    v_cvt_pk_bf16_f32 v109, v110, v111
    v_mov_b64 v[2:3], s[82:83]
    v_mfma_f32_16x16x32_bf16 v[92:95], v[12:15], v[252:255], v[92:95]
    ds_write_b64 v71, v[108:109] offset:640
    v_mov_b64 v[4:5], s[80:81]
    v_mfma_f32_16x16x32_bf16 v[96:99], v[16:19], v[224:227], 0
    v_mov_b64 v[6:7], s[82:83]
    v_mfma_f32_16x16x32_bf16 v[100:103], v[16:19], v[240:243], 0
    v_mov_b64 v[8:9], s[80:81]
    v_mov_b64 v[10:11], s[82:83]
    v_mfma_f32_16x16x32_bf16 v[96:99], v[20:23], v[228:231], v[96:99]
    v_cvt_pk_bf16_f32 v88, v88, v89
    v_mfma_f32_16x16x32_bf16 v[100:103], v[20:23], v[244:247], v[100:103]
    v_cvt_pk_bf16_f32 v89, v90, v91
    v_mov_b64 v[12:13], s[80:81]
    v_mfma_f32_16x16x32_bf16 v[96:99], v[24:27], v[232:235], v[96:99]
    ds_write_b64 v70, v[88:89] offset:768
    v_mov_b64 v[14:15], s[82:83]
    v_mfma_f32_16x16x32_bf16 v[100:103], v[24:27], v[248:251], v[100:103]
    v_cvt_pk_bf16_f32 v92, v92, v93
    v_mov_b64 v[16:17], s[80:81]
    v_mfma_f32_16x16x32_bf16 v[96:99], v[28:31], v[236:239], v[96:99]
    v_cvt_pk_bf16_f32 v93, v94, v95
    v_mov_b64 v[18:19], s[82:83]
    v_mfma_f32_16x16x32_bf16 v[100:103], v[28:31], v[252:255], v[100:103]
    ds_write_b64 v70, v[92:93] offset:896
    v_mov_b64 v[20:21], s[80:81]
    v_mfma_f32_16x16x32_bf16 v[104:107], v[32:35], v[224:227], 0
    v_mov_b64 v[22:23], s[82:83]
    v_mfma_f32_16x16x32_bf16 v[108:111], v[32:35], v[240:243], 0
    v_mov_b64 v[24:25], s[80:81]
    v_mov_b64 v[26:27], s[82:83]
    v_mfma_f32_16x16x32_bf16 v[104:107], v[36:39], v[228:231], v[104:107]
    v_cvt_pk_bf16_f32 v96, v96, v97
    v_mfma_f32_16x16x32_bf16 v[108:111], v[36:39], v[244:247], v[108:111]
    v_cvt_pk_bf16_f32 v97, v98, v99
    v_mov_b64 v[28:29], s[80:81]
    v_mfma_f32_16x16x32_bf16 v[104:107], v[40:43], v[232:235], v[104:107]
    ds_write_b64 v70, v[96:97] offset:33536
    v_mov_b64 v[30:31], s[82:83]
    v_mfma_f32_16x16x32_bf16 v[108:111], v[40:43], v[248:251], v[108:111]
    v_cvt_pk_bf16_f32 v100, v100, v101
    v_mov_b64 v[32:33], s[80:81]
    v_mfma_f32_16x16x32_bf16 v[104:107], v[44:47], v[236:239], v[104:107]
    v_cvt_pk_bf16_f32 v101, v102, v103
    v_mov_b64 v[34:35], s[82:83]
    v_mfma_f32_16x16x32_bf16 v[108:111], v[44:47], v[252:255], v[108:111]
    ds_write_b64 v70, v[100:101] offset:33664
    v_mov_b64 v[36:37], s[80:81]
    s_nop 1
    v_mov_b64 v[38:39], s[82:83]
    v_mov_b64 v[40:41], s[80:81]
    v_mov_b64 v[42:43], s[82:83]
    v_mov_b64 v[44:45], s[80:81]
    v_mov_b64 v[46:47], s[82:83]
    s_nop 4
    v_cvt_pk_bf16_f32 v104, v104, v105
    v_cvt_pk_bf16_f32 v105, v106, v107
    ds_write_b64 v71, v[104:105] offset:768
    v_cvt_pk_bf16_f32 v108, v108, v109
    v_cvt_pk_bf16_f32 v109, v110, v111
    ds_write_b64 v71, v[108:109] offset:896
    v_add_u32 v70, 0x18000, v70
standalone__deep_cross_pnn__recsys_kernel_k2j:

    s_mov_b32 s22, 0
    s_mov_b32 s32, 0x8000
    s_mov_b32 s23, 3
    s_waitcnt vmcnt(0) lgkmcnt(0)
    s_barrier

    v_lshlrev_b32_sdwa v88, 3, v116 dst_sel:DWORD dst_unused:UNUSED_PAD src0_sel:DWORD src1_sel:WORD_0
    v_lshlrev_b32_sdwa v90, 3, v116 dst_sel:DWORD dst_unused:UNUSED_PAD src0_sel:DWORD src1_sel:WORD_1
    v_lshlrev_b32_sdwa v92, 3, v117 dst_sel:DWORD dst_unused:UNUSED_PAD src0_sel:DWORD src1_sel:WORD_0
    v_lshlrev_b32_sdwa v94, 3, v117 dst_sel:DWORD dst_unused:UNUSED_PAD src0_sel:DWORD src1_sel:WORD_1
    ds_read_b64 v[88:89], v88
    ds_read_b64 v[90:91], v90
    ds_read_b64 v[92:93], v92
    ds_read_b64 v[94:95], v94
    v_lshlrev_b32_sdwa v96, 3, v118 dst_sel:DWORD dst_unused:UNUSED_PAD src0_sel:DWORD src1_sel:WORD_0
    v_lshlrev_b32_sdwa v98, 3, v118 dst_sel:DWORD dst_unused:UNUSED_PAD src0_sel:DWORD src1_sel:WORD_1
    v_lshlrev_b32_sdwa v100, 3, v119 dst_sel:DWORD dst_unused:UNUSED_PAD src0_sel:DWORD src1_sel:WORD_0
    v_lshlrev_b32_sdwa v102, 3, v119 dst_sel:DWORD dst_unused:UNUSED_PAD src0_sel:DWORD src1_sel:WORD_1
    ds_read_b64 v[96:97], v96
    ds_read_b64 v[98:99], v98
    ds_read_b64 v[100:101], v100
    ds_read_b64 v[102:103], v102
    buffer_load_dwordx4 v[116:119], v69, s[12:15], s20 offen offset:3072 sc1
    s_add_u32 s20, s20, 4096
standalone__deep_cross_pnn__recsys_kernel_gloop:
    s_setprio 3
    s_waitcnt vmcnt(6)
    v_lshlrev_b32_sdwa v104, 3, v120 dst_sel:DWORD dst_unused:UNUSED_PAD src0_sel:DWORD src1_sel:WORD_0
    v_lshlrev_b32_sdwa v106, 3, v120 dst_sel:DWORD dst_unused:UNUSED_PAD src0_sel:DWORD src1_sel:WORD_1
    ds_read_b64 v[104:105], v104
    ds_read_b64 v[106:107], v106
    v_lshlrev_b32_sdwa v108, 3, v121 dst_sel:DWORD dst_unused:UNUSED_PAD src0_sel:DWORD src1_sel:WORD_0
    v_lshlrev_b32_sdwa v110, 3, v121 dst_sel:DWORD dst_unused:UNUSED_PAD src0_sel:DWORD src1_sel:WORD_1
    ds_read_b64 v[108:109], v108
    ds_read_b64 v[110:111], v110
    s_waitcnt lgkmcnt(8)
    v_smfmac_f32_16x16x64_bf16 v[0:3], v[64:67], v[88:95], v68
    s_waitcnt vmcnt(5)
    v_mfma_f32_16x16x32_bf16 v[112:115], v[72:75], v[128:131], 0
    v_lshlrev_b32_sdwa v88, 3, v122 dst_sel:DWORD dst_unused:UNUSED_PAD src0_sel:DWORD src1_sel:WORD_0
    v_lshlrev_b32_sdwa v90, 3, v122 dst_sel:DWORD dst_unused:UNUSED_PAD src0_sel:DWORD src1_sel:WORD_1
    ds_read_b64 v[88:89], v88
    ds_read_b64 v[90:91], v90
    s_waitcnt vmcnt(4)
    v_mfma_f32_16x16x32_bf16 v[112:115], v[76:79], v[132:135], v[112:115]
    v_lshlrev_b32_sdwa v92, 3, v123 dst_sel:DWORD dst_unused:UNUSED_PAD src0_sel:DWORD src1_sel:WORD_0
    v_lshlrev_b32_sdwa v94, 3, v123 dst_sel:DWORD dst_unused:UNUSED_PAD src0_sel:DWORD src1_sel:WORD_1
    ds_read_b64 v[92:93], v92
    ds_read_b64 v[94:95], v94
    buffer_load_dwordx4 v[120:123], v69, s[12:15], s20 offen offset:0 sc1
    s_waitcnt lgkmcnt(8)
    v_smfmac_f32_16x16x64_bf16 v[4:7], v[64:67], v[96:103], v68
    s_waitcnt vmcnt(4)
    v_mfma_f32_16x16x32_bf16 v[112:115], v[80:83], v[136:139], v[112:115]
    s_waitcnt vmcnt(2)
    v_lshlrev_b32_sdwa v96, 3, v124 dst_sel:DWORD dst_unused:UNUSED_PAD src0_sel:DWORD src1_sel:WORD_0
    v_lshlrev_b32_sdwa v98, 3, v124 dst_sel:DWORD dst_unused:UNUSED_PAD src0_sel:DWORD src1_sel:WORD_1
    ds_read_b64 v[96:97], v96
    ds_read_b64 v[98:99], v98
    s_waitcnt vmcnt(3)
    v_mfma_f32_16x16x32_bf16 v[112:115], v[84:87], v[140:143], v[112:115]
    v_lshlrev_b32_sdwa v100, 3, v125 dst_sel:DWORD dst_unused:UNUSED_PAD src0_sel:DWORD src1_sel:WORD_0
    v_lshlrev_b32_sdwa v102, 3, v125 dst_sel:DWORD dst_unused:UNUSED_PAD src0_sel:DWORD src1_sel:WORD_1
    ds_read_b64 v[100:101], v100
    ds_read_b64 v[102:103], v102
    s_waitcnt lgkmcnt(8)
    v_smfmac_f32_16x16x64_bf16 v[8:11], v[64:67], v[104:111], v68
    s_nop 1
    v_cvt_pk_bf16_f32 v112, v112, v113
    v_cvt_pk_bf16_f32 v113, v114, v115
    ds_write_b64 v70, v[112:113] offset:0
    v_mfma_f32_16x16x32_bf16 v[112:115], v[72:75], v[144:147], 0
    v_mfma_f32_16x16x32_bf16 v[112:115], v[76:79], v[148:151], v[112:115]
    v_lshlrev_b32_sdwa v104, 3, v126 dst_sel:DWORD dst_unused:UNUSED_PAD src0_sel:DWORD src1_sel:WORD_0
    v_lshlrev_b32_sdwa v106, 3, v126 dst_sel:DWORD dst_unused:UNUSED_PAD src0_sel:DWORD src1_sel:WORD_1
    ds_read_b64 v[104:105], v104
    ds_read_b64 v[106:107], v106
    v_mfma_f32_16x16x32_bf16 v[112:115], v[80:83], v[152:155], v[112:115]
    v_mfma_f32_16x16x32_bf16 v[112:115], v[84:87], v[156:159], v[112:115]
    v_lshlrev_b32_sdwa v108, 3, v127 dst_sel:DWORD dst_unused:UNUSED_PAD src0_sel:DWORD src1_sel:WORD_0
    v_lshlrev_b32_sdwa v110, 3, v127 dst_sel:DWORD dst_unused:UNUSED_PAD src0_sel:DWORD src1_sel:WORD_1
    ds_read_b64 v[108:109], v108
    ds_read_b64 v[110:111], v110
    buffer_load_dwordx4 v[124:127], v69, s[12:15], s20 offen offset:1024 sc1
    s_waitcnt lgkmcnt(9)
    v_smfmac_f32_16x16x64_bf16 v[12:15], v[64:67], v[88:95], v68
    s_nop 0
    v_cvt_pk_bf16_f32 v112, v112, v113
    v_cvt_pk_bf16_f32 v113, v114, v115
    ds_write_b64 v70, v[112:113] offset:128
    v_mfma_f32_16x16x32_bf16 v[112:115], v[72:75], v[160:163], 0
    s_waitcnt vmcnt(2)
    v_lshlrev_b32_sdwa v88, 3, v116 dst_sel:DWORD dst_unused:UNUSED_PAD src0_sel:DWORD src1_sel:WORD_0
    v_lshlrev_b32_sdwa v90, 3, v116 dst_sel:DWORD dst_unused:UNUSED_PAD src0_sel:DWORD src1_sel:WORD_1
    ds_read_b64 v[88:89], v88
    ds_read_b64 v[90:91], v90
    v_mfma_f32_16x16x32_bf16 v[112:115], v[76:79], v[164:167], v[112:115]
    v_lshlrev_b32_sdwa v92, 3, v117 dst_sel:DWORD dst_unused:UNUSED_PAD src0_sel:DWORD src1_sel:WORD_0
    v_lshlrev_b32_sdwa v94, 3, v117 dst_sel:DWORD dst_unused:UNUSED_PAD src0_sel:DWORD src1_sel:WORD_1
    ds_read_b64 v[92:93], v92
    ds_read_b64 v[94:95], v94
    s_waitcnt lgkmcnt(10)
    v_smfmac_f32_16x16x64_bf16 v[16:19], v[64:67], v[96:103], v68
    v_mfma_f32_16x16x32_bf16 v[112:115], v[80:83], v[168:171], v[112:115]
    v_lshlrev_b32_sdwa v96, 3, v118 dst_sel:DWORD dst_unused:UNUSED_PAD src0_sel:DWORD src1_sel:WORD_0
    v_lshlrev_b32_sdwa v98, 3, v118 dst_sel:DWORD dst_unused:UNUSED_PAD src0_sel:DWORD src1_sel:WORD_1
    ds_read_b64 v[96:97], v96
    ds_read_b64 v[98:99], v98
    v_mfma_f32_16x16x32_bf16 v[112:115], v[84:87], v[172:175], v[112:115]
    v_lshlrev_b32_sdwa v100, 3, v119 dst_sel:DWORD dst_unused:UNUSED_PAD src0_sel:DWORD src1_sel:WORD_0
    v_lshlrev_b32_sdwa v102, 3, v119 dst_sel:DWORD dst_unused:UNUSED_PAD src0_sel:DWORD src1_sel:WORD_1
    ds_read_b64 v[100:101], v100
    ds_read_b64 v[102:103], v102
    buffer_load_dwordx4 v[116:119], v69, s[12:15], s20 offen offset:2048 sc1
    s_waitcnt lgkmcnt(9)
    v_smfmac_f32_16x16x64_bf16 v[20:23], v[64:67], v[104:111], v68
    s_nop 0
    v_cvt_pk_bf16_f32 v112, v112, v113
    v_cvt_pk_bf16_f32 v113, v114, v115
    ds_write_b64 v70, v[112:113] offset:256
    v_mfma_f32_16x16x32_bf16 v[112:115], v[72:75], v[176:179], 0
    v_mfma_f32_16x16x32_bf16 v[112:115], v[76:79], v[180:183], v[112:115]
    s_waitcnt vmcnt(2)
    v_lshlrev_b32_sdwa v104, 3, v120 dst_sel:DWORD dst_unused:UNUSED_PAD src0_sel:DWORD src1_sel:WORD_0
    v_lshlrev_b32_sdwa v106, 3, v120 dst_sel:DWORD dst_unused:UNUSED_PAD src0_sel:DWORD src1_sel:WORD_1
    ds_read_b64 v[104:105], v104
    ds_read_b64 v[106:107], v106
    v_mfma_f32_16x16x32_bf16 v[112:115], v[80:83], v[184:187], v[112:115]
    v_mfma_f32_16x16x32_bf16 v[112:115], v[84:87], v[188:191], v[112:115]
    v_lshlrev_b32_sdwa v108, 3, v121 dst_sel:DWORD dst_unused:UNUSED_PAD src0_sel:DWORD src1_sel:WORD_0
    v_lshlrev_b32_sdwa v110, 3, v121 dst_sel:DWORD dst_unused:UNUSED_PAD src0_sel:DWORD src1_sel:WORD_1
    ds_read_b64 v[108:109], v108
    ds_read_b64 v[110:111], v110
    s_waitcnt lgkmcnt(9)
    v_smfmac_f32_16x16x64_bf16 v[24:27], v[64:67], v[88:95], v68
    s_nop 1
    v_cvt_pk_bf16_f32 v112, v112, v113
    v_cvt_pk_bf16_f32 v113, v114, v115
    ds_write_b64 v70, v[112:113] offset:384
    v_mfma_f32_16x16x32_bf16 v[112:115], v[72:75], v[192:195], 0
    v_lshlrev_b32_sdwa v88, 3, v122 dst_sel:DWORD dst_unused:UNUSED_PAD src0_sel:DWORD src1_sel:WORD_0
    v_lshlrev_b32_sdwa v90, 3, v122 dst_sel:DWORD dst_unused:UNUSED_PAD src0_sel:DWORD src1_sel:WORD_1
    ds_read_b64 v[88:89], v88
    ds_read_b64 v[90:91], v90
    v_mfma_f32_16x16x32_bf16 v[112:115], v[76:79], v[196:199], v[112:115]
    v_lshlrev_b32_sdwa v92, 3, v123 dst_sel:DWORD dst_unused:UNUSED_PAD src0_sel:DWORD src1_sel:WORD_0
    v_lshlrev_b32_sdwa v94, 3, v123 dst_sel:DWORD dst_unused:UNUSED_PAD src0_sel:DWORD src1_sel:WORD_1
    ds_read_b64 v[92:93], v92
    ds_read_b64 v[94:95], v94
    buffer_load_dwordx4 v[120:123], v69, s[12:15], s20 offen offset:3072 sc1
    s_add_u32 s20, s20, 61440
    s_waitcnt lgkmcnt(10)
    v_smfmac_f32_16x16x64_bf16 v[28:31], v[64:67], v[96:103], v68
    s_setprio 2
    v_mfma_f32_16x16x32_bf16 v[112:115], v[80:83], v[200:203], v[112:115]
    s_waitcnt vmcnt(2)
    v_lshlrev_b32_sdwa v96, 3, v124 dst_sel:DWORD dst_unused:UNUSED_PAD src0_sel:DWORD src1_sel:WORD_0
    v_lshlrev_b32_sdwa v98, 3, v124 dst_sel:DWORD dst_unused:UNUSED_PAD src0_sel:DWORD src1_sel:WORD_1
    ds_read_b64 v[96:97], v96
    ds_read_b64 v[98:99], v98
    v_mfma_f32_16x16x32_bf16 v[112:115], v[84:87], v[204:207], v[112:115]
    v_lshlrev_b32_sdwa v100, 3, v125 dst_sel:DWORD dst_unused:UNUSED_PAD src0_sel:DWORD src1_sel:WORD_0
    v_lshlrev_b32_sdwa v102, 3, v125 dst_sel:DWORD dst_unused:UNUSED_PAD src0_sel:DWORD src1_sel:WORD_1
    ds_read_b64 v[100:101], v100
    ds_read_b64 v[102:103], v102
    s_waitcnt lgkmcnt(9)
    v_smfmac_f32_16x16x64_bf16 v[32:35], v[64:67], v[104:111], v68
    s_nop 1
    v_cvt_pk_bf16_f32 v112, v112, v113
    v_cvt_pk_bf16_f32 v113, v114, v115
    ds_write_b64 v70, v[112:113] offset:512
    v_mfma_f32_16x16x32_bf16 v[112:115], v[72:75], v[208:211], 0
    v_lshlrev_b32_sdwa v104, 3, v126 dst_sel:DWORD dst_unused:UNUSED_PAD src0_sel:DWORD src1_sel:WORD_0
    v_lshlrev_b32_sdwa v106, 3, v126 dst_sel:DWORD dst_unused:UNUSED_PAD src0_sel:DWORD src1_sel:WORD_1
    ds_read_b64 v[104:105], v104
    ds_read_b64 v[106:107], v106
    v_mfma_f32_16x16x32_bf16 v[112:115], v[76:79], v[212:215], v[112:115]
    v_lshlrev_b32_sdwa v108, 3, v127 dst_sel:DWORD dst_unused:UNUSED_PAD src0_sel:DWORD src1_sel:WORD_0
    v_lshlrev_b32_sdwa v110, 3, v127 dst_sel:DWORD dst_unused:UNUSED_PAD src0_sel:DWORD src1_sel:WORD_1
    ds_read_b64 v[108:109], v108
    ds_read_b64 v[110:111], v110
    buffer_load_dwordx4 v[124:127], v69, s[12:15], s20 offen offset:0 sc1
    s_waitcnt lgkmcnt(9)
    v_smfmac_f32_16x16x64_bf16 v[36:39], v[64:67], v[88:95], v68
    v_mfma_f32_16x16x32_bf16 v[112:115], v[80:83], v[216:219], v[112:115]
    s_waitcnt vmcnt(2)
    v_lshlrev_b32_sdwa v88, 3, v116 dst_sel:DWORD dst_unused:UNUSED_PAD src0_sel:DWORD src1_sel:WORD_0
    v_lshlrev_b32_sdwa v90, 3, v116 dst_sel:DWORD dst_unused:UNUSED_PAD src0_sel:DWORD src1_sel:WORD_1
    ds_read_b64 v[88:89], v88
    ds_read_b64 v[90:91], v90
    v_mfma_f32_16x16x32_bf16 v[112:115], v[84:87], v[220:223], v[112:115]
    v_lshlrev_b32_sdwa v92, 3, v117 dst_sel:DWORD dst_unused:UNUSED_PAD src0_sel:DWORD src1_sel:WORD_0
    v_lshlrev_b32_sdwa v94, 3, v117 dst_sel:DWORD dst_unused:UNUSED_PAD src0_sel:DWORD src1_sel:WORD_1
    ds_read_b64 v[92:93], v92
    ds_read_b64 v[94:95], v94
    s_waitcnt lgkmcnt(9)
    v_smfmac_f32_16x16x64_bf16 v[40:43], v[64:67], v[96:103], v68
    s_nop 1
    v_cvt_pk_bf16_f32 v112, v112, v113
    v_cvt_pk_bf16_f32 v113, v114, v115
    ds_write_b64 v70, v[112:113] offset:640
    v_mfma_f32_16x16x32_bf16 v[112:115], v[72:75], v[224:227], 0
    v_mfma_f32_16x16x32_bf16 v[112:115], v[76:79], v[228:231], v[112:115]
    v_lshlrev_b32_sdwa v96, 3, v118 dst_sel:DWORD dst_unused:UNUSED_PAD src0_sel:DWORD src1_sel:WORD_0
    v_lshlrev_b32_sdwa v98, 3, v118 dst_sel:DWORD dst_unused:UNUSED_PAD src0_sel:DWORD src1_sel:WORD_1
    ds_read_b64 v[96:97], v96
    ds_read_b64 v[98:99], v98
    v_mfma_f32_16x16x32_bf16 v[112:115], v[80:83], v[232:235], v[112:115]
    v_mfma_f32_16x16x32_bf16 v[112:115], v[84:87], v[236:239], v[112:115]
    v_lshlrev_b32_sdwa v100, 3, v119 dst_sel:DWORD dst_unused:UNUSED_PAD src0_sel:DWORD src1_sel:WORD_0
    v_lshlrev_b32_sdwa v102, 3, v119 dst_sel:DWORD dst_unused:UNUSED_PAD src0_sel:DWORD src1_sel:WORD_1
    ds_read_b64 v[100:101], v100
    ds_read_b64 v[102:103], v102
    buffer_load_dwordx4 v[116:119], v69, s[12:15], s20 offen offset:1024 sc1
    s_waitcnt lgkmcnt(9)
    v_smfmac_f32_16x16x64_bf16 v[44:47], v[64:67], v[104:111], v68
    s_nop 0
    v_cvt_pk_bf16_f32 v112, v112, v113
    v_cvt_pk_bf16_f32 v113, v114, v115
    ds_write_b64 v70, v[112:113] offset:768
    s_setprio 1
    v_mfma_f32_16x16x32_bf16 v[112:115], v[72:75], v[240:243], 0
    buffer_load_dwordx4 v[72:75], v69, s[12:15], s21 offen offset:0
    s_waitcnt vmcnt(3)
    v_lshlrev_b32_sdwa v104, 3, v120 dst_sel:DWORD dst_unused:UNUSED_PAD src0_sel:DWORD src1_sel:WORD_0
    v_lshlrev_b32_sdwa v106, 3, v120 dst_sel:DWORD dst_unused:UNUSED_PAD src0_sel:DWORD src1_sel:WORD_1
    ds_read_b64 v[104:105], v104
    ds_read_b64 v[106:107], v106
    v_mfma_f32_16x16x32_bf16 v[112:115], v[76:79], v[244:247], v[112:115]
    buffer_load_dwordx4 v[76:79], v69, s[12:15], s21 offen offset:1024
    v_lshlrev_b32_sdwa v108, 3, v121 dst_sel:DWORD dst_unused:UNUSED_PAD src0_sel:DWORD src1_sel:WORD_0
    v_lshlrev_b32_sdwa v110, 3, v121 dst_sel:DWORD dst_unused:UNUSED_PAD src0_sel:DWORD src1_sel:WORD_1
    ds_read_b64 v[108:109], v108
    ds_read_b64 v[110:111], v110
    s_waitcnt lgkmcnt(10)
    v_smfmac_f32_16x16x64_bf16 v[48:51], v[64:67], v[88:95], v68
    v_mfma_f32_16x16x32_bf16 v[112:115], v[80:83], v[248:251], v[112:115]
    buffer_load_dwordx4 v[80:83], v69, s[12:15], s19 offen offset:0
    v_lshlrev_b32_sdwa v88, 3, v122 dst_sel:DWORD dst_unused:UNUSED_PAD src0_sel:DWORD src1_sel:WORD_0
    v_lshlrev_b32_sdwa v90, 3, v122 dst_sel:DWORD dst_unused:UNUSED_PAD src0_sel:DWORD src1_sel:WORD_1
    ds_read_b64 v[88:89], v88
    ds_read_b64 v[90:91], v90
    v_mfma_f32_16x16x32_bf16 v[112:115], v[84:87], v[252:255], v[112:115]
    buffer_load_dwordx4 v[84:87], v69, s[12:15], s19 offen offset:1024
    s_add_u32 s21, s21, 4096
    s_add_u32 s19, s19, 4096
    v_lshlrev_b32_sdwa v92, 3, v123 dst_sel:DWORD dst_unused:UNUSED_PAD src0_sel:DWORD src1_sel:WORD_0
    v_lshlrev_b32_sdwa v94, 3, v123 dst_sel:DWORD dst_unused:UNUSED_PAD src0_sel:DWORD src1_sel:WORD_1
    ds_read_b64 v[92:93], v92
    ds_read_b64 v[94:95], v94
    buffer_load_dwordx4 v[120:123], v69, s[12:15], s20 offen offset:2048 sc1
    s_waitcnt lgkmcnt(9)
    v_smfmac_f32_16x16x64_bf16 v[52:55], v[64:67], v[96:103], v68
    v_cvt_pk_bf16_f32 v112, v112, v113
    v_cvt_pk_bf16_f32 v113, v114, v115
    ds_write_b64 v70, v[112:113] offset:896
    s_add_u32 s23, s23, 1
    s_cmp_eq_u32 s23, 5
    s_cselect_b32 s35, 4294836224, s32
    s_cselect_b32 s23, 0, s23
    v_add_u32 v70, s35, v70
    s_waitcnt vmcnt(6)
    v_lshlrev_b32_sdwa v96, 3, v124 dst_sel:DWORD dst_unused:UNUSED_PAD src0_sel:DWORD src1_sel:WORD_0
    v_lshlrev_b32_sdwa v98, 3, v124 dst_sel:DWORD dst_unused:UNUSED_PAD src0_sel:DWORD src1_sel:WORD_1
    ds_read_b64 v[96:97], v96
    ds_read_b64 v[98:99], v98
    v_lshlrev_b32_sdwa v100, 3, v125 dst_sel:DWORD dst_unused:UNUSED_PAD src0_sel:DWORD src1_sel:WORD_0
    v_lshlrev_b32_sdwa v102, 3, v125 dst_sel:DWORD dst_unused:UNUSED_PAD src0_sel:DWORD src1_sel:WORD_1
    ds_read_b64 v[100:101], v100
    ds_read_b64 v[102:103], v102
    s_waitcnt lgkmcnt(9)
    v_smfmac_f32_16x16x64_bf16 v[56:59], v[64:67], v[104:111], v68
    s_setprio 0
    v_lshlrev_b32_sdwa v104, 3, v126 dst_sel:DWORD dst_unused:UNUSED_PAD src0_sel:DWORD src1_sel:WORD_0
    v_lshlrev_b32_sdwa v106, 3, v126 dst_sel:DWORD dst_unused:UNUSED_PAD src0_sel:DWORD src1_sel:WORD_1
    ds_read_b64 v[104:105], v104
    ds_read_b64 v[106:107], v106
    v_lshlrev_b32_sdwa v108, 3, v127 dst_sel:DWORD dst_unused:UNUSED_PAD src0_sel:DWORD src1_sel:WORD_0
    v_lshlrev_b32_sdwa v110, 3, v127 dst_sel:DWORD dst_unused:UNUSED_PAD src0_sel:DWORD src1_sel:WORD_1
    ds_read_b64 v[108:109], v108
    ds_read_b64 v[110:111], v110
    buffer_load_dwordx4 v[124:127], v69, s[12:15], s20 offen offset:3072 sc1
    s_add_u32 s20, s20, 4096
    s_waitcnt lgkmcnt(9)
    v_smfmac_f32_16x16x64_bf16 v[60:63], v[64:67], v[88:95], v68
    s_waitcnt lgkmcnt(8)
    s_barrier

    s_cmp_eq_u32 s22, 7
    s_cbranch_scc1 standalone__deep_cross_pnn__recsys_kernel_fin

    s_setprio 3
    s_waitcnt vmcnt(6)
    v_lshlrev_b32_sdwa v88, 3, v116 dst_sel:DWORD dst_unused:UNUSED_PAD src0_sel:DWORD src1_sel:WORD_0
    v_lshlrev_b32_sdwa v90, 3, v116 dst_sel:DWORD dst_unused:UNUSED_PAD src0_sel:DWORD src1_sel:WORD_1
    ds_read_b64 v[88:89], v88
    ds_read_b64 v[90:91], v90
    v_lshlrev_b32_sdwa v92, 3, v117 dst_sel:DWORD dst_unused:UNUSED_PAD src0_sel:DWORD src1_sel:WORD_0
    v_lshlrev_b32_sdwa v94, 3, v117 dst_sel:DWORD dst_unused:UNUSED_PAD src0_sel:DWORD src1_sel:WORD_1
    ds_read_b64 v[92:93], v92
    ds_read_b64 v[94:95], v94
    s_waitcnt lgkmcnt(8)
    v_smfmac_f32_16x16x64_bf16 v[0:3], v[64:67], v[96:103], v68
    s_waitcnt vmcnt(5)
    v_mfma_f32_16x16x32_bf16 v[112:115], v[72:75], v[128:131], 0
    v_lshlrev_b32_sdwa v96, 3, v118 dst_sel:DWORD dst_unused:UNUSED_PAD src0_sel:DWORD src1_sel:WORD_0
    v_lshlrev_b32_sdwa v98, 3, v118 dst_sel:DWORD dst_unused:UNUSED_PAD src0_sel:DWORD src1_sel:WORD_1
    ds_read_b64 v[96:97], v96
    ds_read_b64 v[98:99], v98
    s_waitcnt vmcnt(4)
    v_mfma_f32_16x16x32_bf16 v[112:115], v[76:79], v[132:135], v[112:115]
    v_lshlrev_b32_sdwa v100, 3, v119 dst_sel:DWORD dst_unused:UNUSED_PAD src0_sel:DWORD src1_sel:WORD_0
    v_lshlrev_b32_sdwa v102, 3, v119 dst_sel:DWORD dst_unused:UNUSED_PAD src0_sel:DWORD src1_sel:WORD_1
    ds_read_b64 v[100:101], v100
    ds_read_b64 v[102:103], v102
    buffer_load_dwordx4 v[116:119], v69, s[12:15], s20 offen offset:0 sc1
    s_waitcnt lgkmcnt(8)
    v_smfmac_f32_16x16x64_bf16 v[4:7], v[64:67], v[104:111], v68
    s_waitcnt vmcnt(4)
    v_mfma_f32_16x16x32_bf16 v[112:115], v[80:83], v[136:139], v[112:115]
    s_waitcnt vmcnt(2)
    v_lshlrev_b32_sdwa v104, 3, v120 dst_sel:DWORD dst_unused:UNUSED_PAD src0_sel:DWORD src1_sel:WORD_0
    v_lshlrev_b32_sdwa v106, 3, v120 dst_sel:DWORD dst_unused:UNUSED_PAD src0_sel:DWORD src1_sel:WORD_1
    ds_read_b64 v[104:105], v104
    ds_read_b64 v[106:107], v106
    s_waitcnt vmcnt(3)
    v_mfma_f32_16x16x32_bf16 v[112:115], v[84:87], v[140:143], v[112:115]
    v_lshlrev_b32_sdwa v108, 3, v121 dst_sel:DWORD dst_unused:UNUSED_PAD src0_sel:DWORD src1_sel:WORD_0
    v_lshlrev_b32_sdwa v110, 3, v121 dst_sel:DWORD dst_unused:UNUSED_PAD src0_sel:DWORD src1_sel:WORD_1
    ds_read_b64 v[108:109], v108
    ds_read_b64 v[110:111], v110
    s_waitcnt lgkmcnt(8)
    v_smfmac_f32_16x16x64_bf16 v[8:11], v[64:67], v[88:95], v68
    s_nop 1
    v_cvt_pk_bf16_f32 v112, v112, v113
    v_cvt_pk_bf16_f32 v113, v114, v115
    ds_write_b64 v70, v[112:113] offset:0
    v_mfma_f32_16x16x32_bf16 v[112:115], v[72:75], v[144:147], 0
    v_mfma_f32_16x16x32_bf16 v[112:115], v[76:79], v[148:151], v[112:115]
    v_lshlrev_b32_sdwa v88, 3, v122 dst_sel:DWORD dst_unused:UNUSED_PAD src0_sel:DWORD src1_sel:WORD_0
    v_lshlrev_b32_sdwa v90, 3, v122 dst_sel:DWORD dst_unused:UNUSED_PAD src0_sel:DWORD src1_sel:WORD_1
    ds_read_b64 v[88:89], v88
    ds_read_b64 v[90:91], v90
    v_mfma_f32_16x16x32_bf16 v[112:115], v[80:83], v[152:155], v[112:115]
    v_mfma_f32_16x16x32_bf16 v[112:115], v[84:87], v[156:159], v[112:115]
    v_lshlrev_b32_sdwa v92, 3, v123 dst_sel:DWORD dst_unused:UNUSED_PAD src0_sel:DWORD src1_sel:WORD_0
    v_lshlrev_b32_sdwa v94, 3, v123 dst_sel:DWORD dst_unused:UNUSED_PAD src0_sel:DWORD src1_sel:WORD_1
    ds_read_b64 v[92:93], v92
    ds_read_b64 v[94:95], v94
    buffer_load_dwordx4 v[120:123], v69, s[12:15], s20 offen offset:1024 sc1
    s_waitcnt lgkmcnt(9)
    v_smfmac_f32_16x16x64_bf16 v[12:15], v[64:67], v[96:103], v68
    s_nop 0
    v_cvt_pk_bf16_f32 v112, v112, v113
    v_cvt_pk_bf16_f32 v113, v114, v115
    ds_write_b64 v70, v[112:113] offset:128
    v_mfma_f32_16x16x32_bf16 v[112:115], v[72:75], v[160:163], 0
    s_waitcnt vmcnt(2)
    v_lshlrev_b32_sdwa v96, 3, v124 dst_sel:DWORD dst_unused:UNUSED_PAD src0_sel:DWORD src1_sel:WORD_0
    v_lshlrev_b32_sdwa v98, 3, v124 dst_sel:DWORD dst_unused:UNUSED_PAD src0_sel:DWORD src1_sel:WORD_1
    ds_read_b64 v[96:97], v96
    ds_read_b64 v[98:99], v98
    v_mfma_f32_16x16x32_bf16 v[112:115], v[76:79], v[164:167], v[112:115]
    v_lshlrev_b32_sdwa v100, 3, v125 dst_sel:DWORD dst_unused:UNUSED_PAD src0_sel:DWORD src1_sel:WORD_0
    v_lshlrev_b32_sdwa v102, 3, v125 dst_sel:DWORD dst_unused:UNUSED_PAD src0_sel:DWORD src1_sel:WORD_1
    ds_read_b64 v[100:101], v100
    ds_read_b64 v[102:103], v102
    s_waitcnt lgkmcnt(10)
    v_smfmac_f32_16x16x64_bf16 v[16:19], v[64:67], v[104:111], v68
    v_mfma_f32_16x16x32_bf16 v[112:115], v[80:83], v[168:171], v[112:115]
    v_lshlrev_b32_sdwa v104, 3, v126 dst_sel:DWORD dst_unused:UNUSED_PAD src0_sel:DWORD src1_sel:WORD_0
    v_lshlrev_b32_sdwa v106, 3, v126 dst_sel:DWORD dst_unused:UNUSED_PAD src0_sel:DWORD src1_sel:WORD_1
    ds_read_b64 v[104:105], v104
    ds_read_b64 v[106:107], v106
    v_mfma_f32_16x16x32_bf16 v[112:115], v[84:87], v[172:175], v[112:115]
    v_lshlrev_b32_sdwa v108, 3, v127 dst_sel:DWORD dst_unused:UNUSED_PAD src0_sel:DWORD src1_sel:WORD_0
    v_lshlrev_b32_sdwa v110, 3, v127 dst_sel:DWORD dst_unused:UNUSED_PAD src0_sel:DWORD src1_sel:WORD_1
    ds_read_b64 v[108:109], v108
    ds_read_b64 v[110:111], v110
    buffer_load_dwordx4 v[124:127], v69, s[12:15], s20 offen offset:2048 sc1
    s_waitcnt lgkmcnt(9)
    v_smfmac_f32_16x16x64_bf16 v[20:23], v[64:67], v[88:95], v68
    s_nop 0
    v_cvt_pk_bf16_f32 v112, v112, v113
    v_cvt_pk_bf16_f32 v113, v114, v115
    ds_write_b64 v70, v[112:113] offset:256
    v_mfma_f32_16x16x32_bf16 v[112:115], v[72:75], v[176:179], 0
    v_mfma_f32_16x16x32_bf16 v[112:115], v[76:79], v[180:183], v[112:115]
    s_waitcnt vmcnt(2)
    v_lshlrev_b32_sdwa v88, 3, v116 dst_sel:DWORD dst_unused:UNUSED_PAD src0_sel:DWORD src1_sel:WORD_0
    v_lshlrev_b32_sdwa v90, 3, v116 dst_sel:DWORD dst_unused:UNUSED_PAD src0_sel:DWORD src1_sel:WORD_1
    ds_read_b64 v[88:89], v88
    ds_read_b64 v[90:91], v90
    v_mfma_f32_16x16x32_bf16 v[112:115], v[80:83], v[184:187], v[112:115]
    v_mfma_f32_16x16x32_bf16 v[112:115], v[84:87], v[188:191], v[112:115]
    v_lshlrev_b32_sdwa v92, 3, v117 dst_sel:DWORD dst_unused:UNUSED_PAD src0_sel:DWORD src1_sel:WORD_0
    v_lshlrev_b32_sdwa v94, 3, v117 dst_sel:DWORD dst_unused:UNUSED_PAD src0_sel:DWORD src1_sel:WORD_1
    ds_read_b64 v[92:93], v92
    ds_read_b64 v[94:95], v94
    s_waitcnt lgkmcnt(9)
    v_smfmac_f32_16x16x64_bf16 v[24:27], v[64:67], v[96:103], v68
    s_nop 1
    v_cvt_pk_bf16_f32 v112, v112, v113
    v_cvt_pk_bf16_f32 v113, v114, v115
    ds_write_b64 v70, v[112:113] offset:384
    v_mfma_f32_16x16x32_bf16 v[112:115], v[72:75], v[192:195], 0
    v_lshlrev_b32_sdwa v96, 3, v118 dst_sel:DWORD dst_unused:UNUSED_PAD src0_sel:DWORD src1_sel:WORD_0
    v_lshlrev_b32_sdwa v98, 3, v118 dst_sel:DWORD dst_unused:UNUSED_PAD src0_sel:DWORD src1_sel:WORD_1
    ds_read_b64 v[96:97], v96
    ds_read_b64 v[98:99], v98
    v_mfma_f32_16x16x32_bf16 v[112:115], v[76:79], v[196:199], v[112:115]
    v_lshlrev_b32_sdwa v100, 3, v119 dst_sel:DWORD dst_unused:UNUSED_PAD src0_sel:DWORD src1_sel:WORD_0
    v_lshlrev_b32_sdwa v102, 3, v119 dst_sel:DWORD dst_unused:UNUSED_PAD src0_sel:DWORD src1_sel:WORD_1
    ds_read_b64 v[100:101], v100
    ds_read_b64 v[102:103], v102
    buffer_load_dwordx4 v[116:119], v69, s[12:15], s20 offen offset:3072 sc1
    s_add_u32 s20, s20, 61440
    s_waitcnt lgkmcnt(10)
    v_smfmac_f32_16x16x64_bf16 v[28:31], v[64:67], v[104:111], v68
    s_setprio 2
    v_mfma_f32_16x16x32_bf16 v[112:115], v[80:83], v[200:203], v[112:115]
    s_waitcnt vmcnt(2)
    v_lshlrev_b32_sdwa v104, 3, v120 dst_sel:DWORD dst_unused:UNUSED_PAD src0_sel:DWORD src1_sel:WORD_0
    v_lshlrev_b32_sdwa v106, 3, v120 dst_sel:DWORD dst_unused:UNUSED_PAD src0_sel:DWORD src1_sel:WORD_1
    ds_read_b64 v[104:105], v104
    ds_read_b64 v[106:107], v106
    v_mfma_f32_16x16x32_bf16 v[112:115], v[84:87], v[204:207], v[112:115]
    v_lshlrev_b32_sdwa v108, 3, v121 dst_sel:DWORD dst_unused:UNUSED_PAD src0_sel:DWORD src1_sel:WORD_0
    v_lshlrev_b32_sdwa v110, 3, v121 dst_sel:DWORD dst_unused:UNUSED_PAD src0_sel:DWORD src1_sel:WORD_1
    ds_read_b64 v[108:109], v108
    ds_read_b64 v[110:111], v110
    s_waitcnt lgkmcnt(9)
    v_smfmac_f32_16x16x64_bf16 v[32:35], v[64:67], v[88:95], v68
    s_nop 1
    v_cvt_pk_bf16_f32 v112, v112, v113
    v_cvt_pk_bf16_f32 v113, v114, v115
    ds_write_b64 v70, v[112:113] offset:512
    v_mfma_f32_16x16x32_bf16 v[112:115], v[72:75], v[208:211], 0
    v_lshlrev_b32_sdwa v88, 3, v122 dst_sel:DWORD dst_unused:UNUSED_PAD src0_sel:DWORD src1_sel:WORD_0
    v_lshlrev_b32_sdwa v90, 3, v122 dst_sel:DWORD dst_unused:UNUSED_PAD src0_sel:DWORD src1_sel:WORD_1
    ds_read_b64 v[88:89], v88
    ds_read_b64 v[90:91], v90
    v_mfma_f32_16x16x32_bf16 v[112:115], v[76:79], v[212:215], v[112:115]
    v_lshlrev_b32_sdwa v92, 3, v123 dst_sel:DWORD dst_unused:UNUSED_PAD src0_sel:DWORD src1_sel:WORD_0
    v_lshlrev_b32_sdwa v94, 3, v123 dst_sel:DWORD dst_unused:UNUSED_PAD src0_sel:DWORD src1_sel:WORD_1
    ds_read_b64 v[92:93], v92
    ds_read_b64 v[94:95], v94
    buffer_load_dwordx4 v[120:123], v69, s[12:15], s20 offen offset:0 sc1
    s_waitcnt lgkmcnt(9)
    v_smfmac_f32_16x16x64_bf16 v[36:39], v[64:67], v[96:103], v68
    v_mfma_f32_16x16x32_bf16 v[112:115], v[80:83], v[216:219], v[112:115]
    s_waitcnt vmcnt(2)
    v_lshlrev_b32_sdwa v96, 3, v124 dst_sel:DWORD dst_unused:UNUSED_PAD src0_sel:DWORD src1_sel:WORD_0
    v_lshlrev_b32_sdwa v98, 3, v124 dst_sel:DWORD dst_unused:UNUSED_PAD src0_sel:DWORD src1_sel:WORD_1
    ds_read_b64 v[96:97], v96
    ds_read_b64 v[98:99], v98
    v_mfma_f32_16x16x32_bf16 v[112:115], v[84:87], v[220:223], v[112:115]
    v_lshlrev_b32_sdwa v100, 3, v125 dst_sel:DWORD dst_unused:UNUSED_PAD src0_sel:DWORD src1_sel:WORD_0
    v_lshlrev_b32_sdwa v102, 3, v125 dst_sel:DWORD dst_unused:UNUSED_PAD src0_sel:DWORD src1_sel:WORD_1
    ds_read_b64 v[100:101], v100
    ds_read_b64 v[102:103], v102
    s_waitcnt lgkmcnt(9)
    v_smfmac_f32_16x16x64_bf16 v[40:43], v[64:67], v[104:111], v68
    s_nop 1
    v_cvt_pk_bf16_f32 v112, v112, v113
    v_cvt_pk_bf16_f32 v113, v114, v115
    ds_write_b64 v70, v[112:113] offset:640
    v_mfma_f32_16x16x32_bf16 v[112:115], v[72:75], v[224:227], 0
    v_mfma_f32_16x16x32_bf16 v[112:115], v[76:79], v[228:231], v[112:115]
    v_lshlrev_b32_sdwa v104, 3, v126 dst_sel:DWORD dst_unused:UNUSED_PAD src0_sel:DWORD src1_sel:WORD_0
    v_lshlrev_b32_sdwa v106, 3, v126 dst_sel:DWORD dst_unused:UNUSED_PAD src0_sel:DWORD src1_sel:WORD_1
    ds_read_b64 v[104:105], v104
    ds_read_b64 v[106:107], v106
    v_mfma_f32_16x16x32_bf16 v[112:115], v[80:83], v[232:235], v[112:115]
    v_mfma_f32_16x16x32_bf16 v[112:115], v[84:87], v[236:239], v[112:115]
    v_lshlrev_b32_sdwa v108, 3, v127 dst_sel:DWORD dst_unused:UNUSED_PAD src0_sel:DWORD src1_sel:WORD_0
    v_lshlrev_b32_sdwa v110, 3, v127 dst_sel:DWORD dst_unused:UNUSED_PAD src0_sel:DWORD src1_sel:WORD_1
    ds_read_b64 v[108:109], v108
    ds_read_b64 v[110:111], v110
    buffer_load_dwordx4 v[124:127], v69, s[12:15], s20 offen offset:1024 sc1
    s_waitcnt lgkmcnt(9)
    v_smfmac_f32_16x16x64_bf16 v[44:47], v[64:67], v[88:95], v68
    s_nop 0
    v_cvt_pk_bf16_f32 v112, v112, v113
    v_cvt_pk_bf16_f32 v113, v114, v115
    ds_write_b64 v70, v[112:113] offset:768
    s_setprio 1
    v_mfma_f32_16x16x32_bf16 v[112:115], v[72:75], v[240:243], 0
    buffer_load_dwordx4 v[72:75], v69, s[12:15], s21 offen offset:0
    s_waitcnt vmcnt(3)
    v_lshlrev_b32_sdwa v88, 3, v116 dst_sel:DWORD dst_unused:UNUSED_PAD src0_sel:DWORD src1_sel:WORD_0
    v_lshlrev_b32_sdwa v90, 3, v116 dst_sel:DWORD dst_unused:UNUSED_PAD src0_sel:DWORD src1_sel:WORD_1
    ds_read_b64 v[88:89], v88
    ds_read_b64 v[90:91], v90
    v_mfma_f32_16x16x32_bf16 v[112:115], v[76:79], v[244:247], v[112:115]
    buffer_load_dwordx4 v[76:79], v69, s[12:15], s21 offen offset:1024
    v_lshlrev_b32_sdwa v92, 3, v117 dst_sel:DWORD dst_unused:UNUSED_PAD src0_sel:DWORD src1_sel:WORD_0
    v_lshlrev_b32_sdwa v94, 3, v117 dst_sel:DWORD dst_unused:UNUSED_PAD src0_sel:DWORD src1_sel:WORD_1
    ds_read_b64 v[92:93], v92
    ds_read_b64 v[94:95], v94
    s_waitcnt lgkmcnt(10)
    v_smfmac_f32_16x16x64_bf16 v[48:51], v[64:67], v[96:103], v68
    v_mfma_f32_16x16x32_bf16 v[112:115], v[80:83], v[248:251], v[112:115]
    buffer_load_dwordx4 v[80:83], v69, s[12:15], s19 offen offset:0
    v_lshlrev_b32_sdwa v96, 3, v118 dst_sel:DWORD dst_unused:UNUSED_PAD src0_sel:DWORD src1_sel:WORD_0
    v_lshlrev_b32_sdwa v98, 3, v118 dst_sel:DWORD dst_unused:UNUSED_PAD src0_sel:DWORD src1_sel:WORD_1
    ds_read_b64 v[96:97], v96
    ds_read_b64 v[98:99], v98
    v_mfma_f32_16x16x32_bf16 v[112:115], v[84:87], v[252:255], v[112:115]
    buffer_load_dwordx4 v[84:87], v69, s[12:15], s19 offen offset:1024
    s_add_u32 s21, s21, 4096
    s_add_u32 s19, s19, 4096
    v_lshlrev_b32_sdwa v100, 3, v119 dst_sel:DWORD dst_unused:UNUSED_PAD src0_sel:DWORD src1_sel:WORD_0
    v_lshlrev_b32_sdwa v102, 3, v119 dst_sel:DWORD dst_unused:UNUSED_PAD src0_sel:DWORD src1_sel:WORD_1
    ds_read_b64 v[100:101], v100
    ds_read_b64 v[102:103], v102
    buffer_load_dwordx4 v[116:119], v69, s[12:15], s20 offen offset:2048 sc1
    s_waitcnt lgkmcnt(9)
    v_smfmac_f32_16x16x64_bf16 v[52:55], v[64:67], v[104:111], v68
    v_cvt_pk_bf16_f32 v112, v112, v113
    v_cvt_pk_bf16_f32 v113, v114, v115
    ds_write_b64 v70, v[112:113] offset:896
    s_add_u32 s23, s23, 1
    s_cmp_eq_u32 s23, 5
    s_cselect_b32 s35, 4294836224, s32
    s_cselect_b32 s23, 0, s23
    v_add_u32 v70, s35, v70
    s_waitcnt vmcnt(6)
    v_lshlrev_b32_sdwa v104, 3, v120 dst_sel:DWORD dst_unused:UNUSED_PAD src0_sel:DWORD src1_sel:WORD_0
    v_lshlrev_b32_sdwa v106, 3, v120 dst_sel:DWORD dst_unused:UNUSED_PAD src0_sel:DWORD src1_sel:WORD_1
    ds_read_b64 v[104:105], v104
    ds_read_b64 v[106:107], v106
    v_lshlrev_b32_sdwa v108, 3, v121 dst_sel:DWORD dst_unused:UNUSED_PAD src0_sel:DWORD src1_sel:WORD_0
    v_lshlrev_b32_sdwa v110, 3, v121 dst_sel:DWORD dst_unused:UNUSED_PAD src0_sel:DWORD src1_sel:WORD_1
    ds_read_b64 v[108:109], v108
    ds_read_b64 v[110:111], v110
    s_waitcnt lgkmcnt(9)
    v_smfmac_f32_16x16x64_bf16 v[56:59], v[64:67], v[88:95], v68
    s_setprio 0
    v_lshlrev_b32_sdwa v88, 3, v122 dst_sel:DWORD dst_unused:UNUSED_PAD src0_sel:DWORD src1_sel:WORD_0
    v_lshlrev_b32_sdwa v90, 3, v122 dst_sel:DWORD dst_unused:UNUSED_PAD src0_sel:DWORD src1_sel:WORD_1
    ds_read_b64 v[88:89], v88
    ds_read_b64 v[90:91], v90
    v_lshlrev_b32_sdwa v92, 3, v123 dst_sel:DWORD dst_unused:UNUSED_PAD src0_sel:DWORD src1_sel:WORD_0
    v_lshlrev_b32_sdwa v94, 3, v123 dst_sel:DWORD dst_unused:UNUSED_PAD src0_sel:DWORD src1_sel:WORD_1
    ds_read_b64 v[92:93], v92
    ds_read_b64 v[94:95], v94
    buffer_load_dwordx4 v[120:123], v69, s[12:15], s20 offen offset:3072 sc1
    s_add_u32 s20, s20, 4096
    s_waitcnt lgkmcnt(9)
    v_smfmac_f32_16x16x64_bf16 v[60:63], v[64:67], v[96:103], v68
    s_waitcnt lgkmcnt(8)
    s_barrier
    s_setprio 3
    s_waitcnt vmcnt(6)
    v_lshlrev_b32_sdwa v96, 3, v124 dst_sel:DWORD dst_unused:UNUSED_PAD src0_sel:DWORD src1_sel:WORD_0
    v_lshlrev_b32_sdwa v98, 3, v124 dst_sel:DWORD dst_unused:UNUSED_PAD src0_sel:DWORD src1_sel:WORD_1
    ds_read_b64 v[96:97], v96
    ds_read_b64 v[98:99], v98
    v_lshlrev_b32_sdwa v100, 3, v125 dst_sel:DWORD dst_unused:UNUSED_PAD src0_sel:DWORD src1_sel:WORD_0
    v_lshlrev_b32_sdwa v102, 3, v125 dst_sel:DWORD dst_unused:UNUSED_PAD src0_sel:DWORD src1_sel:WORD_1
    ds_read_b64 v[100:101], v100
    ds_read_b64 v[102:103], v102
    s_waitcnt lgkmcnt(8)
    v_smfmac_f32_16x16x64_bf16 v[0:3], v[64:67], v[104:111], v68
    s_waitcnt vmcnt(5)
    v_mfma_f32_16x16x32_bf16 v[112:115], v[72:75], v[128:131], 0
    v_lshlrev_b32_sdwa v104, 3, v126 dst_sel:DWORD dst_unused:UNUSED_PAD src0_sel:DWORD src1_sel:WORD_0
    v_lshlrev_b32_sdwa v106, 3, v126 dst_sel:DWORD dst_unused:UNUSED_PAD src0_sel:DWORD src1_sel:WORD_1
    ds_read_b64 v[104:105], v104
    ds_read_b64 v[106:107], v106
    s_waitcnt vmcnt(4)
    v_mfma_f32_16x16x32_bf16 v[112:115], v[76:79], v[132:135], v[112:115]
    v_lshlrev_b32_sdwa v108, 3, v127 dst_sel:DWORD dst_unused:UNUSED_PAD src0_sel:DWORD src1_sel:WORD_0
    v_lshlrev_b32_sdwa v110, 3, v127 dst_sel:DWORD dst_unused:UNUSED_PAD src0_sel:DWORD src1_sel:WORD_1
    ds_read_b64 v[108:109], v108
    ds_read_b64 v[110:111], v110
    buffer_load_dwordx4 v[124:127], v69, s[12:15], s20 offen offset:0 sc1
    s_waitcnt lgkmcnt(8)
    v_smfmac_f32_16x16x64_bf16 v[4:7], v[64:67], v[88:95], v68
    s_waitcnt vmcnt(4)
    v_mfma_f32_16x16x32_bf16 v[112:115], v[80:83], v[136:139], v[112:115]
    s_waitcnt vmcnt(2)
    v_lshlrev_b32_sdwa v88, 3, v116 dst_sel:DWORD dst_unused:UNUSED_PAD src0_sel:DWORD src1_sel:WORD_0
    v_lshlrev_b32_sdwa v90, 3, v116 dst_sel:DWORD dst_unused:UNUSED_PAD src0_sel:DWORD src1_sel:WORD_1
    ds_read_b64 v[88:89], v88
    ds_read_b64 v[90:91], v90
    s_waitcnt vmcnt(3)
    v_mfma_f32_16x16x32_bf16 v[112:115], v[84:87], v[140:143], v[112:115]
    v_lshlrev_b32_sdwa v92, 3, v117 dst_sel:DWORD dst_unused:UNUSED_PAD src0_sel:DWORD src1_sel:WORD_0
    v_lshlrev_b32_sdwa v94, 3, v117 dst_sel:DWORD dst_unused:UNUSED_PAD src0_sel:DWORD src1_sel:WORD_1
    ds_read_b64 v[92:93], v92
    ds_read_b64 v[94:95], v94
    s_waitcnt lgkmcnt(8)
    v_smfmac_f32_16x16x64_bf16 v[8:11], v[64:67], v[96:103], v68
    s_nop 1
    v_cvt_pk_bf16_f32 v112, v112, v113
    v_cvt_pk_bf16_f32 v113, v114, v115
    ds_write_b64 v70, v[112:113] offset:0
    v_mfma_f32_16x16x32_bf16 v[112:115], v[72:75], v[144:147], 0
    v_mfma_f32_16x16x32_bf16 v[112:115], v[76:79], v[148:151], v[112:115]
    v_lshlrev_b32_sdwa v96, 3, v118 dst_sel:DWORD dst_unused:UNUSED_PAD src0_sel:DWORD src1_sel:WORD_0
    v_lshlrev_b32_sdwa v98, 3, v118 dst_sel:DWORD dst_unused:UNUSED_PAD src0_sel:DWORD src1_sel:WORD_1
    ds_read_b64 v[96:97], v96
    ds_read_b64 v[98:99], v98
    v_mfma_f32_16x16x32_bf16 v[112:115], v[80:83], v[152:155], v[112:115]
    v_mfma_f32_16x16x32_bf16 v[112:115], v[84:87], v[156:159], v[112:115]
    v_lshlrev_b32_sdwa v100, 3, v119 dst_sel:DWORD dst_unused:UNUSED_PAD src0_sel:DWORD src1_sel:WORD_0
    v_lshlrev_b32_sdwa v102, 3, v119 dst_sel:DWORD dst_unused:UNUSED_PAD src0_sel:DWORD src1_sel:WORD_1
    ds_read_b64 v[100:101], v100
    ds_read_b64 v[102:103], v102
    buffer_load_dwordx4 v[116:119], v69, s[12:15], s20 offen offset:1024 sc1
    s_waitcnt lgkmcnt(9)
    v_smfmac_f32_16x16x64_bf16 v[12:15], v[64:67], v[104:111], v68
    s_nop 0
    v_cvt_pk_bf16_f32 v112, v112, v113
    v_cvt_pk_bf16_f32 v113, v114, v115
    ds_write_b64 v70, v[112:113] offset:128
    v_mfma_f32_16x16x32_bf16 v[112:115], v[72:75], v[160:163], 0
    s_waitcnt vmcnt(2)
    v_lshlrev_b32_sdwa v104, 3, v120 dst_sel:DWORD dst_unused:UNUSED_PAD src0_sel:DWORD src1_sel:WORD_0
    v_lshlrev_b32_sdwa v106, 3, v120 dst_sel:DWORD dst_unused:UNUSED_PAD src0_sel:DWORD src1_sel:WORD_1
    ds_read_b64 v[104:105], v104
    ds_read_b64 v[106:107], v106
    v_mfma_f32_16x16x32_bf16 v[112:115], v[76:79], v[164:167], v[112:115]
    v_lshlrev_b32_sdwa v108, 3, v121 dst_sel:DWORD dst_unused:UNUSED_PAD src0_sel:DWORD src1_sel:WORD_0
    v_lshlrev_b32_sdwa v110, 3, v121 dst_sel:DWORD dst_unused:UNUSED_PAD src0_sel:DWORD src1_sel:WORD_1
    ds_read_b64 v[108:109], v108
    ds_read_b64 v[110:111], v110
    s_waitcnt lgkmcnt(10)
    v_smfmac_f32_16x16x64_bf16 v[16:19], v[64:67], v[88:95], v68
    v_mfma_f32_16x16x32_bf16 v[112:115], v[80:83], v[168:171], v[112:115]
    v_lshlrev_b32_sdwa v88, 3, v122 dst_sel:DWORD dst_unused:UNUSED_PAD src0_sel:DWORD src1_sel:WORD_0
    v_lshlrev_b32_sdwa v90, 3, v122 dst_sel:DWORD dst_unused:UNUSED_PAD src0_sel:DWORD src1_sel:WORD_1
    ds_read_b64 v[88:89], v88
    ds_read_b64 v[90:91], v90
    v_mfma_f32_16x16x32_bf16 v[112:115], v[84:87], v[172:175], v[112:115]
    v_lshlrev_b32_sdwa v92, 3, v123 dst_sel:DWORD dst_unused:UNUSED_PAD src0_sel:DWORD src1_sel:WORD_0
    v_lshlrev_b32_sdwa v94, 3, v123 dst_sel:DWORD dst_unused:UNUSED_PAD src0_sel:DWORD src1_sel:WORD_1
    ds_read_b64 v[92:93], v92
    ds_read_b64 v[94:95], v94
    buffer_load_dwordx4 v[120:123], v69, s[12:15], s20 offen offset:2048 sc1
    s_waitcnt lgkmcnt(9)
    v_smfmac_f32_16x16x64_bf16 v[20:23], v[64:67], v[96:103], v68
    s_nop 0
    v_cvt_pk_bf16_f32 v112, v112, v113
    v_cvt_pk_bf16_f32 v113, v114, v115
    ds_write_b64 v70, v[112:113] offset:256
    v_mfma_f32_16x16x32_bf16 v[112:115], v[72:75], v[176:179], 0
    v_mfma_f32_16x16x32_bf16 v[112:115], v[76:79], v[180:183], v[112:115]
    s_waitcnt vmcnt(2)
    v_lshlrev_b32_sdwa v96, 3, v124 dst_sel:DWORD dst_unused:UNUSED_PAD src0_sel:DWORD src1_sel:WORD_0
    v_lshlrev_b32_sdwa v98, 3, v124 dst_sel:DWORD dst_unused:UNUSED_PAD src0_sel:DWORD src1_sel:WORD_1
    ds_read_b64 v[96:97], v96
    ds_read_b64 v[98:99], v98
    v_mfma_f32_16x16x32_bf16 v[112:115], v[80:83], v[184:187], v[112:115]
    v_mfma_f32_16x16x32_bf16 v[112:115], v[84:87], v[188:191], v[112:115]
    v_lshlrev_b32_sdwa v100, 3, v125 dst_sel:DWORD dst_unused:UNUSED_PAD src0_sel:DWORD src1_sel:WORD_0
    v_lshlrev_b32_sdwa v102, 3, v125 dst_sel:DWORD dst_unused:UNUSED_PAD src0_sel:DWORD src1_sel:WORD_1
    ds_read_b64 v[100:101], v100
    ds_read_b64 v[102:103], v102
    s_waitcnt lgkmcnt(9)
    v_smfmac_f32_16x16x64_bf16 v[24:27], v[64:67], v[104:111], v68
    s_nop 1
    v_cvt_pk_bf16_f32 v112, v112, v113
    v_cvt_pk_bf16_f32 v113, v114, v115
    ds_write_b64 v70, v[112:113] offset:384
    v_mfma_f32_16x16x32_bf16 v[112:115], v[72:75], v[192:195], 0
    v_lshlrev_b32_sdwa v104, 3, v126 dst_sel:DWORD dst_unused:UNUSED_PAD src0_sel:DWORD src1_sel:WORD_0
    v_lshlrev_b32_sdwa v106, 3, v126 dst_sel:DWORD dst_unused:UNUSED_PAD src0_sel:DWORD src1_sel:WORD_1
    ds_read_b64 v[104:105], v104
    ds_read_b64 v[106:107], v106
    v_mfma_f32_16x16x32_bf16 v[112:115], v[76:79], v[196:199], v[112:115]
    v_lshlrev_b32_sdwa v108, 3, v127 dst_sel:DWORD dst_unused:UNUSED_PAD src0_sel:DWORD src1_sel:WORD_0
    v_lshlrev_b32_sdwa v110, 3, v127 dst_sel:DWORD dst_unused:UNUSED_PAD src0_sel:DWORD src1_sel:WORD_1
    ds_read_b64 v[108:109], v108
    ds_read_b64 v[110:111], v110
    buffer_load_dwordx4 v[124:127], v69, s[12:15], s20 offen offset:3072 sc1
    s_add_u32 s20, s20, 61440
    s_waitcnt lgkmcnt(10)
    v_smfmac_f32_16x16x64_bf16 v[28:31], v[64:67], v[88:95], v68
    s_setprio 2
    v_mfma_f32_16x16x32_bf16 v[112:115], v[80:83], v[200:203], v[112:115]
    s_waitcnt vmcnt(2)
    v_lshlrev_b32_sdwa v88, 3, v116 dst_sel:DWORD dst_unused:UNUSED_PAD src0_sel:DWORD src1_sel:WORD_0
    v_lshlrev_b32_sdwa v90, 3, v116 dst_sel:DWORD dst_unused:UNUSED_PAD src0_sel:DWORD src1_sel:WORD_1
    ds_read_b64 v[88:89], v88
    ds_read_b64 v[90:91], v90
    v_mfma_f32_16x16x32_bf16 v[112:115], v[84:87], v[204:207], v[112:115]
    v_lshlrev_b32_sdwa v92, 3, v117 dst_sel:DWORD dst_unused:UNUSED_PAD src0_sel:DWORD src1_sel:WORD_0
    v_lshlrev_b32_sdwa v94, 3, v117 dst_sel:DWORD dst_unused:UNUSED_PAD src0_sel:DWORD src1_sel:WORD_1
    ds_read_b64 v[92:93], v92
    ds_read_b64 v[94:95], v94
    s_waitcnt lgkmcnt(9)
    v_smfmac_f32_16x16x64_bf16 v[32:35], v[64:67], v[96:103], v68
    s_nop 1
    v_cvt_pk_bf16_f32 v112, v112, v113
    v_cvt_pk_bf16_f32 v113, v114, v115
    ds_write_b64 v70, v[112:113] offset:512
    v_mfma_f32_16x16x32_bf16 v[112:115], v[72:75], v[208:211], 0
    v_lshlrev_b32_sdwa v96, 3, v118 dst_sel:DWORD dst_unused:UNUSED_PAD src0_sel:DWORD src1_sel:WORD_0
    v_lshlrev_b32_sdwa v98, 3, v118 dst_sel:DWORD dst_unused:UNUSED_PAD src0_sel:DWORD src1_sel:WORD_1
    ds_read_b64 v[96:97], v96
    ds_read_b64 v[98:99], v98
    v_mfma_f32_16x16x32_bf16 v[112:115], v[76:79], v[212:215], v[112:115]
    v_lshlrev_b32_sdwa v100, 3, v119 dst_sel:DWORD dst_unused:UNUSED_PAD src0_sel:DWORD src1_sel:WORD_0
    v_lshlrev_b32_sdwa v102, 3, v119 dst_sel:DWORD dst_unused:UNUSED_PAD src0_sel:DWORD src1_sel:WORD_1
    ds_read_b64 v[100:101], v100
    ds_read_b64 v[102:103], v102
    buffer_load_dwordx4 v[116:119], v69, s[12:15], s20 offen offset:0 sc1
    s_waitcnt lgkmcnt(9)
    v_smfmac_f32_16x16x64_bf16 v[36:39], v[64:67], v[104:111], v68
    v_mfma_f32_16x16x32_bf16 v[112:115], v[80:83], v[216:219], v[112:115]
    s_waitcnt vmcnt(2)
    v_lshlrev_b32_sdwa v104, 3, v120 dst_sel:DWORD dst_unused:UNUSED_PAD src0_sel:DWORD src1_sel:WORD_0
    v_lshlrev_b32_sdwa v106, 3, v120 dst_sel:DWORD dst_unused:UNUSED_PAD src0_sel:DWORD src1_sel:WORD_1
    ds_read_b64 v[104:105], v104
    ds_read_b64 v[106:107], v106
    v_mfma_f32_16x16x32_bf16 v[112:115], v[84:87], v[220:223], v[112:115]
    v_lshlrev_b32_sdwa v108, 3, v121 dst_sel:DWORD dst_unused:UNUSED_PAD src0_sel:DWORD src1_sel:WORD_0
    v_lshlrev_b32_sdwa v110, 3, v121 dst_sel:DWORD dst_unused:UNUSED_PAD src0_sel:DWORD src1_sel:WORD_1
    ds_read_b64 v[108:109], v108
    ds_read_b64 v[110:111], v110
    s_waitcnt lgkmcnt(9)
    v_smfmac_f32_16x16x64_bf16 v[40:43], v[64:67], v[88:95], v68
    s_nop 1
    v_cvt_pk_bf16_f32 v112, v112, v113
    v_cvt_pk_bf16_f32 v113, v114, v115
    ds_write_b64 v70, v[112:113] offset:640
    v_mfma_f32_16x16x32_bf16 v[112:115], v[72:75], v[224:227], 0
    v_mfma_f32_16x16x32_bf16 v[112:115], v[76:79], v[228:231], v[112:115]
    v_lshlrev_b32_sdwa v88, 3, v122 dst_sel:DWORD dst_unused:UNUSED_PAD src0_sel:DWORD src1_sel:WORD_0
    v_lshlrev_b32_sdwa v90, 3, v122 dst_sel:DWORD dst_unused:UNUSED_PAD src0_sel:DWORD src1_sel:WORD_1
    ds_read_b64 v[88:89], v88
    ds_read_b64 v[90:91], v90
    v_mfma_f32_16x16x32_bf16 v[112:115], v[80:83], v[232:235], v[112:115]
    v_mfma_f32_16x16x32_bf16 v[112:115], v[84:87], v[236:239], v[112:115]
    v_lshlrev_b32_sdwa v92, 3, v123 dst_sel:DWORD dst_unused:UNUSED_PAD src0_sel:DWORD src1_sel:WORD_0
    v_lshlrev_b32_sdwa v94, 3, v123 dst_sel:DWORD dst_unused:UNUSED_PAD src0_sel:DWORD src1_sel:WORD_1
    ds_read_b64 v[92:93], v92
    ds_read_b64 v[94:95], v94
    buffer_load_dwordx4 v[120:123], v69, s[12:15], s20 offen offset:1024 sc1
    s_waitcnt lgkmcnt(9)
    v_smfmac_f32_16x16x64_bf16 v[44:47], v[64:67], v[96:103], v68
    s_nop 0
    v_cvt_pk_bf16_f32 v112, v112, v113
    v_cvt_pk_bf16_f32 v113, v114, v115
    ds_write_b64 v70, v[112:113] offset:768
    s_setprio 1
    v_mfma_f32_16x16x32_bf16 v[112:115], v[72:75], v[240:243], 0
    buffer_load_dwordx4 v[72:75], v69, s[12:15], s21 offen offset:0
    s_waitcnt vmcnt(3)
    v_lshlrev_b32_sdwa v96, 3, v124 dst_sel:DWORD dst_unused:UNUSED_PAD src0_sel:DWORD src1_sel:WORD_0
    v_lshlrev_b32_sdwa v98, 3, v124 dst_sel:DWORD dst_unused:UNUSED_PAD src0_sel:DWORD src1_sel:WORD_1
    ds_read_b64 v[96:97], v96
    ds_read_b64 v[98:99], v98
    v_mfma_f32_16x16x32_bf16 v[112:115], v[76:79], v[244:247], v[112:115]
    buffer_load_dwordx4 v[76:79], v69, s[12:15], s21 offen offset:1024
    v_lshlrev_b32_sdwa v100, 3, v125 dst_sel:DWORD dst_unused:UNUSED_PAD src0_sel:DWORD src1_sel:WORD_0
    v_lshlrev_b32_sdwa v102, 3, v125 dst_sel:DWORD dst_unused:UNUSED_PAD src0_sel:DWORD src1_sel:WORD_1
    ds_read_b64 v[100:101], v100
    ds_read_b64 v[102:103], v102
    s_waitcnt lgkmcnt(10)
    v_smfmac_f32_16x16x64_bf16 v[48:51], v[64:67], v[104:111], v68
    v_mfma_f32_16x16x32_bf16 v[112:115], v[80:83], v[248:251], v[112:115]
    buffer_load_dwordx4 v[80:83], v69, s[12:15], s19 offen offset:0
    v_lshlrev_b32_sdwa v104, 3, v126 dst_sel:DWORD dst_unused:UNUSED_PAD src0_sel:DWORD src1_sel:WORD_0
    v_lshlrev_b32_sdwa v106, 3, v126 dst_sel:DWORD dst_unused:UNUSED_PAD src0_sel:DWORD src1_sel:WORD_1
    ds_read_b64 v[104:105], v104
    ds_read_b64 v[106:107], v106
    v_mfma_f32_16x16x32_bf16 v[112:115], v[84:87], v[252:255], v[112:115]
    buffer_load_dwordx4 v[84:87], v69, s[12:15], s19 offen offset:1024
    s_add_u32 s21, s21, 4096
    s_add_u32 s19, s19, 4096
    v_lshlrev_b32_sdwa v108, 3, v127 dst_sel:DWORD dst_unused:UNUSED_PAD src0_sel:DWORD src1_sel:WORD_0
    v_lshlrev_b32_sdwa v110, 3, v127 dst_sel:DWORD dst_unused:UNUSED_PAD src0_sel:DWORD src1_sel:WORD_1
    ds_read_b64 v[108:109], v108
    ds_read_b64 v[110:111], v110
    buffer_load_dwordx4 v[124:127], v69, s[12:15], s20 offen offset:2048 sc1
    s_waitcnt lgkmcnt(9)
    v_smfmac_f32_16x16x64_bf16 v[52:55], v[64:67], v[88:95], v68
    v_cvt_pk_bf16_f32 v112, v112, v113
    v_cvt_pk_bf16_f32 v113, v114, v115
    ds_write_b64 v70, v[112:113] offset:896
    s_add_u32 s23, s23, 1
    s_cmp_eq_u32 s23, 5
    s_cselect_b32 s35, 4294836224, s32
    s_cselect_b32 s23, 0, s23
    v_add_u32 v70, s35, v70
    s_waitcnt vmcnt(6)
    v_lshlrev_b32_sdwa v88, 3, v116 dst_sel:DWORD dst_unused:UNUSED_PAD src0_sel:DWORD src1_sel:WORD_0
    v_lshlrev_b32_sdwa v90, 3, v116 dst_sel:DWORD dst_unused:UNUSED_PAD src0_sel:DWORD src1_sel:WORD_1
    ds_read_b64 v[88:89], v88
    ds_read_b64 v[90:91], v90
    v_lshlrev_b32_sdwa v92, 3, v117 dst_sel:DWORD dst_unused:UNUSED_PAD src0_sel:DWORD src1_sel:WORD_0
    v_lshlrev_b32_sdwa v94, 3, v117 dst_sel:DWORD dst_unused:UNUSED_PAD src0_sel:DWORD src1_sel:WORD_1
    ds_read_b64 v[92:93], v92
    ds_read_b64 v[94:95], v94
    s_waitcnt lgkmcnt(9)
    v_smfmac_f32_16x16x64_bf16 v[56:59], v[64:67], v[96:103], v68
    s_setprio 0
    v_lshlrev_b32_sdwa v96, 3, v118 dst_sel:DWORD dst_unused:UNUSED_PAD src0_sel:DWORD src1_sel:WORD_0
    v_lshlrev_b32_sdwa v98, 3, v118 dst_sel:DWORD dst_unused:UNUSED_PAD src0_sel:DWORD src1_sel:WORD_1
    ds_read_b64 v[96:97], v96
    ds_read_b64 v[98:99], v98
    v_lshlrev_b32_sdwa v100, 3, v119 dst_sel:DWORD dst_unused:UNUSED_PAD src0_sel:DWORD src1_sel:WORD_0
    v_lshlrev_b32_sdwa v102, 3, v119 dst_sel:DWORD dst_unused:UNUSED_PAD src0_sel:DWORD src1_sel:WORD_1
    ds_read_b64 v[100:101], v100
    ds_read_b64 v[102:103], v102
    buffer_load_dwordx4 v[116:119], v69, s[12:15], s20 offen offset:3072 sc1
    s_add_u32 s20, s20, 4096
    s_waitcnt lgkmcnt(9)
    v_smfmac_f32_16x16x64_bf16 v[60:63], v[64:67], v[104:111], v68
    s_waitcnt lgkmcnt(8)
    s_barrier

    s_add_u32 s22, s22, 1
    s_branch standalone__deep_cross_pnn__recsys_kernel_gloop

standalone__deep_cross_pnn__recsys_kernel_fin:

    s_add_u32 s40, s20, 61440
    s_add_u32 s41, s20, 65536
    s_add_u32 s44, s20, 126976
    s_add_u32 s45, s20, 131072

    s_lshl_b32 s28, s26, 16
    s_and_b32 s29, s26, 0xffff0000
    s_lshl_b32 s30, s27, 16
    s_and_b32 s31, s27, 0xffff0000
    s_lshl_b32 s35, s33, 16
    s_lshl_b32 s42, s34, 15
    s_add_u32 s35, s35, s42
    s_lshl_b32 s42, s3, 12
    s_add_u32 s35, s35, s42
    s_add_u32 s35, s35, 20971520

    s_setprio 3
    v_mov_b32 v128, 0xbdd2d3e8
    v_mov_b32 v129, 0xbdd2d3e8
    v_mov_b32 v130, 0xc0135761
    v_mov_b32 v131, 0xc0135761
    v_mov_b32 v132, 1.0
    v_mov_b32 v133, 1.0
    v_mov_b32 v134, s28
    v_mov_b32 v135, s29
    s_waitcnt vmcnt(6)
    v_lshlrev_b32_sdwa v88, 3, v116 dst_sel:DWORD dst_unused:UNUSED_PAD src0_sel:DWORD src1_sel:WORD_0
    v_lshlrev_b32_sdwa v90, 3, v116 dst_sel:DWORD dst_unused:UNUSED_PAD src0_sel:DWORD src1_sel:WORD_1
    ds_read_b64 v[88:89], v88
    ds_read_b64 v[90:91], v90
    v_lshlrev_b32_sdwa v92, 3, v117 dst_sel:DWORD dst_unused:UNUSED_PAD src0_sel:DWORD src1_sel:WORD_0
    v_lshlrev_b32_sdwa v94, 3, v117 dst_sel:DWORD dst_unused:UNUSED_PAD src0_sel:DWORD src1_sel:WORD_1
    ds_read_b64 v[92:93], v92
    ds_read_b64 v[94:95], v94
    s_waitcnt lgkmcnt(8)
    v_smfmac_f32_16x16x64_bf16 v[0:3], v[64:67], v[96:103], v68
    v_mov_b32 v136, s30
    v_mov_b32 v137, s31
    v_lshrrev_b32 v70, 2, v69
    v_and_b32 v71, 128, v70
    v_add_u32 v70, v70, v71
    v_rcp_f32 v134, v134
    v_rcp_f32 v135, v135
    v_rcp_f32 v136, v136
    v_lshlrev_b32_sdwa v96, 3, v118 dst_sel:DWORD dst_unused:UNUSED_PAD src0_sel:DWORD src1_sel:WORD_0
    v_lshlrev_b32_sdwa v98, 3, v118 dst_sel:DWORD dst_unused:UNUSED_PAD src0_sel:DWORD src1_sel:WORD_1
    ds_read_b64 v[96:97], v96
    ds_read_b64 v[98:99], v98
    v_lshlrev_b32_sdwa v100, 3, v119 dst_sel:DWORD dst_unused:UNUSED_PAD src0_sel:DWORD src1_sel:WORD_0
    v_lshlrev_b32_sdwa v102, 3, v119 dst_sel:DWORD dst_unused:UNUSED_PAD src0_sel:DWORD src1_sel:WORD_1
    ds_read_b64 v[100:101], v100
    ds_read_b64 v[102:103], v102
    buffer_load_dwordx4 v[116:119], v69, s[12:15], s40 offen offset:0 sc1
    s_waitcnt lgkmcnt(8)
    v_smfmac_f32_16x16x64_bf16 v[4:7], v[64:67], v[104:111], v68
    v_rcp_f32 v137, v137
    v_mov_b32 v132, 0x7f7fffff
    v_mov_b32 v133, 0xff7fffff
    v_med3_f32 v134, v134, v132, v133
    v_med3_f32 v135, v135, v132, v133
    v_med3_f32 v136, v136, v132, v133
    v_med3_f32 v137, v137, v132, v133
    s_waitcnt vmcnt(2)
    v_lshlrev_b32_sdwa v104, 3, v120 dst_sel:DWORD dst_unused:UNUSED_PAD src0_sel:DWORD src1_sel:WORD_0
    v_lshlrev_b32_sdwa v106, 3, v120 dst_sel:DWORD dst_unused:UNUSED_PAD src0_sel:DWORD src1_sel:WORD_1
    ds_read_b64 v[104:105], v104
    ds_read_b64 v[106:107], v106
    v_lshlrev_b32_sdwa v108, 3, v121 dst_sel:DWORD dst_unused:UNUSED_PAD src0_sel:DWORD src1_sel:WORD_0
    v_lshlrev_b32_sdwa v110, 3, v121 dst_sel:DWORD dst_unused:UNUSED_PAD src0_sel:DWORD src1_sel:WORD_1
    ds_read_b64 v[108:109], v108
    ds_read_b64 v[110:111], v110
    s_waitcnt lgkmcnt(8)
    v_smfmac_f32_16x16x64_bf16 v[8:11], v[64:67], v[88:95], v68
    v_lshlrev_b32_sdwa v88, 3, v122 dst_sel:DWORD dst_unused:UNUSED_PAD src0_sel:DWORD src1_sel:WORD_0
    v_lshlrev_b32_sdwa v90, 3, v122 dst_sel:DWORD dst_unused:UNUSED_PAD src0_sel:DWORD src1_sel:WORD_1
    ds_read_b64 v[88:89], v88
    ds_read_b64 v[90:91], v90
    v_lshlrev_b32_sdwa v92, 3, v123 dst_sel:DWORD dst_unused:UNUSED_PAD src0_sel:DWORD src1_sel:WORD_0
    v_lshlrev_b32_sdwa v94, 3, v123 dst_sel:DWORD dst_unused:UNUSED_PAD src0_sel:DWORD src1_sel:WORD_1
    ds_read_b64 v[92:93], v92
    ds_read_b64 v[94:95], v94
    buffer_load_dwordx4 v[120:123], v69, s[12:15], s44 offen offset:0 sc1
    s_waitcnt lgkmcnt(8)
    v_smfmac_f32_16x16x64_bf16 v[12:15], v[64:67], v[96:103], v68
    s_waitcnt vmcnt(2)
    v_lshlrev_b32_sdwa v96, 3, v124 dst_sel:DWORD dst_unused:UNUSED_PAD src0_sel:DWORD src1_sel:WORD_0
    v_lshlrev_b32_sdwa v98, 3, v124 dst_sel:DWORD dst_unused:UNUSED_PAD src0_sel:DWORD src1_sel:WORD_1
    ds_read_b64 v[96:97], v96
    ds_read_b64 v[98:99], v98
    v_lshlrev_b32_sdwa v100, 3, v125 dst_sel:DWORD dst_unused:UNUSED_PAD src0_sel:DWORD src1_sel:WORD_0
    v_lshlrev_b32_sdwa v102, 3, v125 dst_sel:DWORD dst_unused:UNUSED_PAD src0_sel:DWORD src1_sel:WORD_1
    ds_read_b64 v[100:101], v100
    ds_read_b64 v[102:103], v102
    s_waitcnt lgkmcnt(8)
    v_smfmac_f32_16x16x64_bf16 v[16:19], v[64:67], v[104:111], v68
    v_lshlrev_b32_sdwa v104, 3, v126 dst_sel:DWORD dst_unused:UNUSED_PAD src0_sel:DWORD src1_sel:WORD_0
    v_lshlrev_b32_sdwa v106, 3, v126 dst_sel:DWORD dst_unused:UNUSED_PAD src0_sel:DWORD src1_sel:WORD_1
    ds_read_b64 v[104:105], v104
    ds_read_b64 v[106:107], v106
    v_lshlrev_b32_sdwa v108, 3, v127 dst_sel:DWORD dst_unused:UNUSED_PAD src0_sel:DWORD src1_sel:WORD_0
    v_lshlrev_b32_sdwa v110, 3, v127 dst_sel:DWORD dst_unused:UNUSED_PAD src0_sel:DWORD src1_sel:WORD_1
    ds_read_b64 v[108:109], v108
    ds_read_b64 v[110:111], v110
    buffer_load_dwordx4 v[124:127], v69, s[12:15], s40 offen offset:1024 sc1
    s_waitcnt lgkmcnt(8)
    v_smfmac_f32_16x16x64_bf16 v[20:23], v[64:67], v[88:95], v68
    s_waitcnt vmcnt(2)
    v_lshlrev_b32_sdwa v88, 3, v116 dst_sel:DWORD dst_unused:UNUSED_PAD src0_sel:DWORD src1_sel:WORD_0
    v_lshlrev_b32_sdwa v90, 3, v116 dst_sel:DWORD dst_unused:UNUSED_PAD src0_sel:DWORD src1_sel:WORD_1
    ds_read_b64 v[88:89], v88
    ds_read_b64 v[90:91], v90
    v_lshlrev_b32_sdwa v92, 3, v117 dst_sel:DWORD dst_unused:UNUSED_PAD src0_sel:DWORD src1_sel:WORD_0
    v_lshlrev_b32_sdwa v94, 3, v117 dst_sel:DWORD dst_unused:UNUSED_PAD src0_sel:DWORD src1_sel:WORD_1
    ds_read_b64 v[92:93], v92
    ds_read_b64 v[94:95], v94
    s_waitcnt lgkmcnt(8)
    v_smfmac_f32_16x16x64_bf16 v[24:27], v[64:67], v[96:103], v68
    v_lshlrev_b32_sdwa v96, 3, v118 dst_sel:DWORD dst_unused:UNUSED_PAD src0_sel:DWORD src1_sel:WORD_0
    v_lshlrev_b32_sdwa v98, 3, v118 dst_sel:DWORD dst_unused:UNUSED_PAD src0_sel:DWORD src1_sel:WORD_1
    ds_read_b64 v[96:97], v96
    ds_read_b64 v[98:99], v98
    v_lshlrev_b32_sdwa v100, 3, v119 dst_sel:DWORD dst_unused:UNUSED_PAD src0_sel:DWORD src1_sel:WORD_0
    v_lshlrev_b32_sdwa v102, 3, v119 dst_sel:DWORD dst_unused:UNUSED_PAD src0_sel:DWORD src1_sel:WORD_1
    ds_read_b64 v[100:101], v100
    ds_read_b64 v[102:103], v102
    buffer_load_dwordx4 v[116:119], v69, s[12:15], s44 offen offset:1024 sc1
    s_waitcnt lgkmcnt(8)
    v_smfmac_f32_16x16x64_bf16 v[28:31], v[64:67], v[104:111], v68
    s_waitcnt vmcnt(2)
    v_lshlrev_b32_sdwa v104, 3, v120 dst_sel:DWORD dst_unused:UNUSED_PAD src0_sel:DWORD src1_sel:WORD_0
    v_lshlrev_b32_sdwa v106, 3, v120 dst_sel:DWORD dst_unused:UNUSED_PAD src0_sel:DWORD src1_sel:WORD_1
    ds_read_b64 v[104:105], v104
    ds_read_b64 v[106:107], v106
    v_lshlrev_b32_sdwa v108, 3, v121 dst_sel:DWORD dst_unused:UNUSED_PAD src0_sel:DWORD src1_sel:WORD_0
    v_lshlrev_b32_sdwa v110, 3, v121 dst_sel:DWORD dst_unused:UNUSED_PAD src0_sel:DWORD src1_sel:WORD_1
    ds_read_b64 v[108:109], v108
    ds_read_b64 v[110:111], v110
    s_waitcnt lgkmcnt(8)
    v_smfmac_f32_16x16x64_bf16 v[0:3], v[64:67], v[88:95], v68
    v_lshlrev_b32_sdwa v88, 3, v122 dst_sel:DWORD dst_unused:UNUSED_PAD src0_sel:DWORD src1_sel:WORD_0
    v_lshlrev_b32_sdwa v90, 3, v122 dst_sel:DWORD dst_unused:UNUSED_PAD src0_sel:DWORD src1_sel:WORD_1
    ds_read_b64 v[88:89], v88
    ds_read_b64 v[90:91], v90
    v_lshlrev_b32_sdwa v92, 3, v123 dst_sel:DWORD dst_unused:UNUSED_PAD src0_sel:DWORD src1_sel:WORD_0
    v_lshlrev_b32_sdwa v94, 3, v123 dst_sel:DWORD dst_unused:UNUSED_PAD src0_sel:DWORD src1_sel:WORD_1
    ds_read_b64 v[92:93], v92
    ds_read_b64 v[94:95], v94
    buffer_load_dwordx4 v[120:123], v69, s[12:15], s40 offen offset:2048 sc1
    s_waitcnt lgkmcnt(8)
    v_smfmac_f32_16x16x64_bf16 v[4:7], v[64:67], v[96:103], v68
    s_waitcnt vmcnt(2)
    v_lshlrev_b32_sdwa v96, 3, v124 dst_sel:DWORD dst_unused:UNUSED_PAD src0_sel:DWORD src1_sel:WORD_0
    v_lshlrev_b32_sdwa v98, 3, v124 dst_sel:DWORD dst_unused:UNUSED_PAD src0_sel:DWORD src1_sel:WORD_1
    ds_read_b64 v[96:97], v96
    ds_read_b64 v[98:99], v98
    v_lshlrev_b32_sdwa v100, 3, v125 dst_sel:DWORD dst_unused:UNUSED_PAD src0_sel:DWORD src1_sel:WORD_0
    v_lshlrev_b32_sdwa v102, 3, v125 dst_sel:DWORD dst_unused:UNUSED_PAD src0_sel:DWORD src1_sel:WORD_1
    ds_read_b64 v[100:101], v100
    ds_read_b64 v[102:103], v102
    s_waitcnt lgkmcnt(8)
    v_smfmac_f32_16x16x64_bf16 v[0:3], v[64:67], v[104:111], v68
    v_lshlrev_b32_sdwa v104, 3, v126 dst_sel:DWORD dst_unused:UNUSED_PAD src0_sel:DWORD src1_sel:WORD_0
    v_lshlrev_b32_sdwa v106, 3, v126 dst_sel:DWORD dst_unused:UNUSED_PAD src0_sel:DWORD src1_sel:WORD_1
    ds_read_b64 v[104:105], v104
    ds_read_b64 v[106:107], v106
    v_lshlrev_b32_sdwa v108, 3, v127 dst_sel:DWORD dst_unused:UNUSED_PAD src0_sel:DWORD src1_sel:WORD_0
    v_lshlrev_b32_sdwa v110, 3, v127 dst_sel:DWORD dst_unused:UNUSED_PAD src0_sel:DWORD src1_sel:WORD_1
    ds_read_b64 v[108:109], v108
    ds_read_b64 v[110:111], v110
    buffer_load_dwordx4 v[124:127], v69, s[12:15], s44 offen offset:2048 sc1
    s_waitcnt lgkmcnt(8)
    v_smfmac_f32_16x16x64_bf16 v[4:7], v[64:67], v[88:95], v68
    s_waitcnt vmcnt(2)
    v_lshlrev_b32_sdwa v88, 3, v116 dst_sel:DWORD dst_unused:UNUSED_PAD src0_sel:DWORD src1_sel:WORD_0
    v_lshlrev_b32_sdwa v90, 3, v116 dst_sel:DWORD dst_unused:UNUSED_PAD src0_sel:DWORD src1_sel:WORD_1
    ds_read_b64 v[88:89], v88
    ds_read_b64 v[90:91], v90
    v_lshlrev_b32_sdwa v92, 3, v117 dst_sel:DWORD dst_unused:UNUSED_PAD src0_sel:DWORD src1_sel:WORD_0
    v_lshlrev_b32_sdwa v94, 3, v117 dst_sel:DWORD dst_unused:UNUSED_PAD src0_sel:DWORD src1_sel:WORD_1
    ds_read_b64 v[92:93], v92
    ds_read_b64 v[94:95], v94
    s_waitcnt lgkmcnt(8)
    v_smfmac_f32_16x16x64_bf16 v[8:11], v[64:67], v[96:103], v68
    v_pk_mul_f32 v[140:141], v[0:1], v[0:1]
    v_pk_mul_f32 v[142:143], v[2:3], v[2:3]
    v_pk_fma_f32 v[140:141], v[140:141], v[128:129], v[130:131]
    v_pk_fma_f32 v[142:143], v[142:143], v[128:129], v[130:131]
    v_pk_mul_f32 v[140:141], v[140:141], v[0:1]
    v_pk_mul_f32 v[142:143], v[142:143], v[2:3]
    v_exp_f32 v140, v140
    v_pk_mul_f32 v[146:147], v[4:5], v[4:5]
    v_lshlrev_b32_sdwa v96, 3, v118 dst_sel:DWORD dst_unused:UNUSED_PAD src0_sel:DWORD src1_sel:WORD_0
    v_lshlrev_b32_sdwa v98, 3, v118 dst_sel:DWORD dst_unused:UNUSED_PAD src0_sel:DWORD src1_sel:WORD_1
    ds_read_b64 v[96:97], v96
    ds_read_b64 v[98:99], v98
    v_lshlrev_b32_sdwa v100, 3, v119 dst_sel:DWORD dst_unused:UNUSED_PAD src0_sel:DWORD src1_sel:WORD_0
    v_lshlrev_b32_sdwa v102, 3, v119 dst_sel:DWORD dst_unused:UNUSED_PAD src0_sel:DWORD src1_sel:WORD_1
    ds_read_b64 v[100:101], v100
    ds_read_b64 v[102:103], v102
    buffer_load_dwordx4 v[116:119], v69, s[12:15], s40 offen offset:3072 sc1
    s_waitcnt lgkmcnt(8)
    v_smfmac_f32_16x16x64_bf16 v[12:15], v[64:67], v[104:111], v68
    v_exp_f32 v141, v141
    v_pk_fma_f32 v[146:147], v[146:147], v[128:129], v[130:131]
    v_pk_mul_f32 v[148:149], v[6:7], v[6:7]
    v_exp_f32 v142, v142
    v_pk_fma_f32 v[140:141], v[140:141], v[134:135], v[134:135]
    v_pk_mul_f32 v[146:147], v[146:147], v[4:5]
    v_rcp_f32 v140, v140
    v_pk_fma_f32 v[148:149], v[148:149], v[128:129], v[130:131]
    s_waitcnt vmcnt(2)
    v_lshlrev_b32_sdwa v104, 3, v120 dst_sel:DWORD dst_unused:UNUSED_PAD src0_sel:DWORD src1_sel:WORD_0
    v_lshlrev_b32_sdwa v106, 3, v120 dst_sel:DWORD dst_unused:UNUSED_PAD src0_sel:DWORD src1_sel:WORD_1
    ds_read_b64 v[104:105], v104
    ds_read_b64 v[106:107], v106
    v_lshlrev_b32_sdwa v108, 3, v121 dst_sel:DWORD dst_unused:UNUSED_PAD src0_sel:DWORD src1_sel:WORD_0
    v_lshlrev_b32_sdwa v110, 3, v121 dst_sel:DWORD dst_unused:UNUSED_PAD src0_sel:DWORD src1_sel:WORD_1
    ds_read_b64 v[108:109], v108
    ds_read_b64 v[110:111], v110
    s_waitcnt lgkmcnt(8)
    v_smfmac_f32_16x16x64_bf16 v[8:11], v[64:67], v[88:95], v68
    v_rcp_f32 v141, v141
    v_pk_mul_f32 v[148:149], v[148:149], v[6:7]
    v_exp_f32 v143, v143
    v_pk_mul_f32 v[144:145], v[0:1], v[140:141]
    v_exp_f32 v146, v146
    v_pk_fma_f32 v[142:143], v[142:143], v[136:137], v[136:137]
    v_exp_f32 v147, v147
    v_rcp_f32 v142, v142
    v_lshlrev_b32_sdwa v88, 3, v122 dst_sel:DWORD dst_unused:UNUSED_PAD src0_sel:DWORD src1_sel:WORD_0
    v_lshlrev_b32_sdwa v90, 3, v122 dst_sel:DWORD dst_unused:UNUSED_PAD src0_sel:DWORD src1_sel:WORD_1
    ds_read_b64 v[88:89], v88
    ds_read_b64 v[90:91], v90
    v_lshlrev_b32_sdwa v92, 3, v123 dst_sel:DWORD dst_unused:UNUSED_PAD src0_sel:DWORD src1_sel:WORD_0
    v_lshlrev_b32_sdwa v94, 3, v123 dst_sel:DWORD dst_unused:UNUSED_PAD src0_sel:DWORD src1_sel:WORD_1
    ds_read_b64 v[92:93], v92
    ds_read_b64 v[94:95], v94
    buffer_load_dwordx4 v[120:123], v69, s[12:15], s44 offen offset:3072 sc1
    s_waitcnt lgkmcnt(8)
    v_smfmac_f32_16x16x64_bf16 v[12:15], v[64:67], v[96:103], v68
    v_rcp_f32 v143, v143
    v_pk_fma_f32 v[146:147], v[146:147], v[134:135], v[134:135]
    v_pk_mul_f32 v[152:153], v[8:9], v[8:9]
    v_rcp_f32 v146, v146
    v_pk_fma_f32 v[144:145], v[2:3], v[142:143], v[144:145]
    v_pk_fma_f32 v[152:153], v[152:153], v[128:129], v[130:131]
    v_rcp_f32 v147, v147
    v_add_f32 v144, v144, v145
    s_waitcnt vmcnt(2)
    v_lshlrev_b32_sdwa v96, 3, v124 dst_sel:DWORD dst_unused:UNUSED_PAD src0_sel:DWORD src1_sel:WORD_0
    v_lshlrev_b32_sdwa v98, 3, v124 dst_sel:DWORD dst_unused:UNUSED_PAD src0_sel:DWORD src1_sel:WORD_1
    ds_read_b64 v[96:97], v96
    ds_read_b64 v[98:99], v98
    v_lshlrev_b32_sdwa v100, 3, v125 dst_sel:DWORD dst_unused:UNUSED_PAD src0_sel:DWORD src1_sel:WORD_0
    v_lshlrev_b32_sdwa v102, 3, v125 dst_sel:DWORD dst_unused:UNUSED_PAD src0_sel:DWORD src1_sel:WORD_1
    ds_read_b64 v[100:101], v100
    ds_read_b64 v[102:103], v102
    s_waitcnt lgkmcnt(8)
    v_smfmac_f32_16x16x64_bf16 v[16:19], v[64:67], v[104:111], v68
    v_exp_f32 v148, v148
    buffer_store_dword v144, v70, s[12:15], s35 offen offset:0 sc1
    v_pk_mul_f32 v[150:151], v[4:5], v[146:147]
    v_exp_f32 v149, v149
    v_pk_mul_f32 v[152:153], v[152:153], v[8:9]
    v_pk_mul_f32 v[154:155], v[10:11], v[10:11]
    v_exp_f32 v152, v152
    v_pk_fma_f32 v[148:149], v[148:149], v[136:137], v[136:137]
    v_lshlrev_b32_sdwa v104, 3, v126 dst_sel:DWORD dst_unused:UNUSED_PAD src0_sel:DWORD src1_sel:WORD_0
    v_lshlrev_b32_sdwa v106, 3, v126 dst_sel:DWORD dst_unused:UNUSED_PAD src0_sel:DWORD src1_sel:WORD_1
    ds_read_b64 v[104:105], v104
    ds_read_b64 v[106:107], v106
    v_lshlrev_b32_sdwa v108, 3, v127 dst_sel:DWORD dst_unused:UNUSED_PAD src0_sel:DWORD src1_sel:WORD_0
    v_lshlrev_b32_sdwa v110, 3, v127 dst_sel:DWORD dst_unused:UNUSED_PAD src0_sel:DWORD src1_sel:WORD_1
    ds_read_b64 v[108:109], v108
    ds_read_b64 v[110:111], v110
    buffer_load_dwordx4 v[124:127], v69, s[12:15], s20 offen offset:0 sc1
    s_waitcnt lgkmcnt(8)
    v_smfmac_f32_16x16x64_bf16 v[20:23], v[64:67], v[88:95], v68
    v_rcp_f32 v148, v148
    v_pk_fma_f32 v[154:155], v[154:155], v[128:129], v[130:131]
    v_pk_mul_f32 v[158:159], v[12:13], v[12:13]
    v_rcp_f32 v149, v149
    v_pk_mul_f32 v[154:155], v[154:155], v[10:11]
    v_pk_fma_f32 v[158:159], v[158:159], v[128:129], v[130:131]
    v_exp_f32 v153, v153
    v_pk_fma_f32 v[150:151], v[6:7], v[148:149], v[150:151]
    s_waitcnt vmcnt(3)
    v_lshlrev_b32_sdwa v88, 3, v116 dst_sel:DWORD dst_unused:UNUSED_PAD src0_sel:DWORD src1_sel:WORD_0
    v_lshlrev_b32_sdwa v90, 3, v116 dst_sel:DWORD dst_unused:UNUSED_PAD src0_sel:DWORD src1_sel:WORD_1
    ds_read_b64 v[88:89], v88
    ds_read_b64 v[90:91], v90
    v_lshlrev_b32_sdwa v92, 3, v117 dst_sel:DWORD dst_unused:UNUSED_PAD src0_sel:DWORD src1_sel:WORD_0
    v_lshlrev_b32_sdwa v94, 3, v117 dst_sel:DWORD dst_unused:UNUSED_PAD src0_sel:DWORD src1_sel:WORD_1
    ds_read_b64 v[92:93], v92
    ds_read_b64 v[94:95], v94
    s_waitcnt lgkmcnt(8)
    v_smfmac_f32_16x16x64_bf16 v[16:19], v[64:67], v[96:103], v68
    v_exp_f32 v154, v154
    v_add_f32 v150, v150, v151
    v_pk_fma_f32 v[152:153], v[152:153], v[134:135], v[134:135]
    v_exp_f32 v155, v155
    buffer_store_dword v150, v70, s[12:15], s35 offen offset:128 sc1
    v_pk_mul_f32 v[158:159], v[158:159], v[12:13]
    v_rcp_f32 v152, v152
    v_pk_fma_f32 v[154:155], v[154:155], v[136:137], v[136:137]
    v_lshlrev_b32_sdwa v96, 3, v118 dst_sel:DWORD dst_unused:UNUSED_PAD src0_sel:DWORD src1_sel:WORD_0
    v_lshlrev_b32_sdwa v98, 3, v118 dst_sel:DWORD dst_unused:UNUSED_PAD src0_sel:DWORD src1_sel:WORD_1
    ds_read_b64 v[96:97], v96
    ds_read_b64 v[98:99], v98
    v_lshlrev_b32_sdwa v100, 3, v119 dst_sel:DWORD dst_unused:UNUSED_PAD src0_sel:DWORD src1_sel:WORD_0
    v_lshlrev_b32_sdwa v102, 3, v119 dst_sel:DWORD dst_unused:UNUSED_PAD src0_sel:DWORD src1_sel:WORD_1
    ds_read_b64 v[100:101], v100
    ds_read_b64 v[102:103], v102
    buffer_load_dwordx4 v[116:119], v69, s[12:15], s41 offen offset:0 sc1
    s_waitcnt lgkmcnt(8)
    v_smfmac_f32_16x16x64_bf16 v[20:23], v[64:67], v[104:111], v68
    v_rcp_f32 v153, v153
    v_pk_mul_f32 v[160:161], v[14:15], v[14:15]
    v_pk_mul_f32 v[164:165], v[16:17], v[16:17]
    v_rcp_f32 v154, v154
    v_pk_mul_f32 v[156:157], v[8:9], v[152:153]
    v_pk_fma_f32 v[160:161], v[160:161], v[128:129], v[130:131]
    v_rcp_f32 v155, v155
    v_pk_mul_f32 v[160:161], v[160:161], v[14:15]
    s_waitcnt vmcnt(4)
    v_lshlrev_b32_sdwa v104, 3, v120 dst_sel:DWORD dst_unused:UNUSED_PAD src0_sel:DWORD src1_sel:WORD_0
    v_lshlrev_b32_sdwa v106, 3, v120 dst_sel:DWORD dst_unused:UNUSED_PAD src0_sel:DWORD src1_sel:WORD_1
    ds_read_b64 v[104:105], v104
    ds_read_b64 v[106:107], v106
    v_lshlrev_b32_sdwa v108, 3, v121 dst_sel:DWORD dst_unused:UNUSED_PAD src0_sel:DWORD src1_sel:WORD_0
    v_lshlrev_b32_sdwa v110, 3, v121 dst_sel:DWORD dst_unused:UNUSED_PAD src0_sel:DWORD src1_sel:WORD_1
    ds_read_b64 v[108:109], v108
    ds_read_b64 v[110:111], v110
    s_waitcnt lgkmcnt(8)
    v_smfmac_f32_16x16x64_bf16 v[24:27], v[64:67], v[88:95], v68
    v_exp_f32 v158, v158
    v_pk_fma_f32 v[156:157], v[10:11], v[154:155], v[156:157]
    v_pk_fma_f32 v[164:165], v[164:165], v[128:129], v[130:131]
    v_exp_f32 v159, v159
    v_add_f32 v156, v156, v157
    v_pk_mul_f32 v[164:165], v[164:165], v[16:17]
    v_exp_f32 v160, v160
    buffer_store_dword v156, v70, s[12:15], s35 offen offset:512 sc1
    v_lshlrev_b32_sdwa v88, 3, v122 dst_sel:DWORD dst_unused:UNUSED_PAD src0_sel:DWORD src1_sel:WORD_0
    v_lshlrev_b32_sdwa v90, 3, v122 dst_sel:DWORD dst_unused:UNUSED_PAD src0_sel:DWORD src1_sel:WORD_1
    ds_read_b64 v[88:89], v88
    ds_read_b64 v[90:91], v90
    v_lshlrev_b32_sdwa v92, 3, v123 dst_sel:DWORD dst_unused:UNUSED_PAD src0_sel:DWORD src1_sel:WORD_0
    v_lshlrev_b32_sdwa v94, 3, v123 dst_sel:DWORD dst_unused:UNUSED_PAD src0_sel:DWORD src1_sel:WORD_1
    ds_read_b64 v[92:93], v92
    ds_read_b64 v[94:95], v94
    buffer_load_dwordx4 v[120:123], v69, s[12:15], s45 offen offset:0 sc1
    s_waitcnt lgkmcnt(8)
    v_smfmac_f32_16x16x64_bf16 v[28:31], v[64:67], v[96:103], v68
    v_exp_f32 v161, v161
    v_pk_fma_f32 v[158:159], v[158:159], v[134:135], v[134:135]
    v_pk_mul_f32 v[166:167], v[18:19], v[18:19]
    v_rcp_f32 v158, v158
    v_pk_fma_f32 v[160:161], v[160:161], v[136:137], v[136:137]
    v_pk_fma_f32 v[166:167], v[166:167], v[128:129], v[130:131]
    v_rcp_f32 v159, v159
    v_pk_mul_f32 v[166:167], v[166:167], v[18:19]
    s_waitcnt vmcnt(4)
    v_lshlrev_b32_sdwa v96, 3, v124 dst_sel:DWORD dst_unused:UNUSED_PAD src0_sel:DWORD src1_sel:WORD_0
    v_lshlrev_b32_sdwa v98, 3, v124 dst_sel:DWORD dst_unused:UNUSED_PAD src0_sel:DWORD src1_sel:WORD_1
    ds_read_b64 v[96:97], v96
    ds_read_b64 v[98:99], v98
    v_lshlrev_b32_sdwa v100, 3, v125 dst_sel:DWORD dst_unused:UNUSED_PAD src0_sel:DWORD src1_sel:WORD_0
    v_lshlrev_b32_sdwa v102, 3, v125 dst_sel:DWORD dst_unused:UNUSED_PAD src0_sel:DWORD src1_sel:WORD_1
    ds_read_b64 v[100:101], v100
    ds_read_b64 v[102:103], v102
    s_waitcnt lgkmcnt(8)
    v_smfmac_f32_16x16x64_bf16 v[24:27], v[64:67], v[104:111], v68
    v_rcp_f32 v160, v160
    v_pk_mul_f32 v[162:163], v[12:13], v[158:159]
    v_pk_mul_f32 v[170:171], v[20:21], v[20:21]
    v_rcp_f32 v161, v161
    v_pk_fma_f32 v[170:171], v[170:171], v[128:129], v[130:131]
    v_pk_mul_f32 v[172:173], v[22:23], v[22:23]
    v_exp_f32 v164, v164
    v_pk_fma_f32 v[162:163], v[14:15], v[160:161], v[162:163]
    v_lshlrev_b32_sdwa v104, 3, v126 dst_sel:DWORD dst_unused:UNUSED_PAD src0_sel:DWORD src1_sel:WORD_0
    v_lshlrev_b32_sdwa v106, 3, v126 dst_sel:DWORD dst_unused:UNUSED_PAD src0_sel:DWORD src1_sel:WORD_1
    ds_read_b64 v[104:105], v104
    ds_read_b64 v[106:107], v106
    v_lshlrev_b32_sdwa v108, 3, v127 dst_sel:DWORD dst_unused:UNUSED_PAD src0_sel:DWORD src1_sel:WORD_0
    v_lshlrev_b32_sdwa v110, 3, v127 dst_sel:DWORD dst_unused:UNUSED_PAD src0_sel:DWORD src1_sel:WORD_1
    ds_read_b64 v[108:109], v108
    ds_read_b64 v[110:111], v110
    buffer_load_dwordx4 v[124:127], v69, s[12:15], s20 offen offset:1024 sc1
    s_waitcnt lgkmcnt(8)
    v_smfmac_f32_16x16x64_bf16 v[28:31], v[64:67], v[88:95], v68
    s_setprio 2
    v_exp_f32 v165, v165
    v_add_f32 v162, v162, v163
    v_pk_mul_f32 v[170:171], v[170:171], v[20:21]
    v_exp_f32 v166, v166
    buffer_store_dword v162, v70, s[12:15], s35 offen offset:640 sc1
    v_pk_fma_f32 v[164:165], v[164:165], v[134:135], v[134:135]
    v_exp_f32 v167, v167
    v_pk_fma_f32 v[172:173], v[172:173], v[128:129], v[130:131]
    s_waitcnt vmcnt(4)
    v_lshlrev_b32_sdwa v88, 3, v116 dst_sel:DWORD dst_unused:UNUSED_PAD src0_sel:DWORD src1_sel:WORD_0
    v_lshlrev_b32_sdwa v90, 3, v116 dst_sel:DWORD dst_unused:UNUSED_PAD src0_sel:DWORD src1_sel:WORD_1
    ds_read_b64 v[88:89], v88
    ds_read_b64 v[90:91], v90
    v_lshlrev_b32_sdwa v92, 3, v117 dst_sel:DWORD dst_unused:UNUSED_PAD src0_sel:DWORD src1_sel:WORD_0
    v_lshlrev_b32_sdwa v94, 3, v117 dst_sel:DWORD dst_unused:UNUSED_PAD src0_sel:DWORD src1_sel:WORD_1
    ds_read_b64 v[92:93], v92
    ds_read_b64 v[94:95], v94
    s_waitcnt lgkmcnt(8)
    v_smfmac_f32_16x16x64_bf16 v[32:35], v[64:67], v[96:103], v68
    v_rcp_f32 v164, v164
    v_pk_fma_f32 v[166:167], v[166:167], v[136:137], v[136:137]
    v_pk_mul_f32 v[172:173], v[172:173], v[22:23]
    v_rcp_f32 v165, v165
    v_pk_mul_f32 v[140:141], v[24:25], v[24:25]
    v_pk_mul_f32 v[142:143], v[26:27], v[26:27]
    v_rcp_f32 v166, v166
    v_pk_mul_f32 v[168:169], v[16:17], v[164:165]
    v_lshlrev_b32_sdwa v96, 3, v118 dst_sel:DWORD dst_unused:UNUSED_PAD src0_sel:DWORD src1_sel:WORD_0
    v_lshlrev_b32_sdwa v98, 3, v118 dst_sel:DWORD dst_unused:UNUSED_PAD src0_sel:DWORD src1_sel:WORD_1
    ds_read_b64 v[96:97], v96
    ds_read_b64 v[98:99], v98
    v_lshlrev_b32_sdwa v100, 3, v119 dst_sel:DWORD dst_unused:UNUSED_PAD src0_sel:DWORD src1_sel:WORD_0
    v_lshlrev_b32_sdwa v102, 3, v119 dst_sel:DWORD dst_unused:UNUSED_PAD src0_sel:DWORD src1_sel:WORD_1
    ds_read_b64 v[100:101], v100
    ds_read_b64 v[102:103], v102
    buffer_load_dwordx4 v[116:119], v69, s[12:15], s41 offen offset:1024 sc1
    s_waitcnt lgkmcnt(8)
    v_smfmac_f32_16x16x64_bf16 v[36:39], v[64:67], v[104:111], v68
    v_rcp_f32 v167, v167
    v_pk_fma_f32 v[140:141], v[140:141], v[128:129], v[130:131]
    v_pk_fma_f32 v[142:143], v[142:143], v[128:129], v[130:131]
    v_exp_f32 v170, v170
    v_pk_fma_f32 v[168:169], v[18:19], v[166:167], v[168:169]
    v_pk_mul_f32 v[140:141], v[140:141], v[24:25]
    v_exp_f32 v171, v171
    v_add_f32 v168, v168, v169
    s_waitcnt vmcnt(3)
    v_lshlrev_b32_sdwa v104, 3, v120 dst_sel:DWORD dst_unused:UNUSED_PAD src0_sel:DWORD src1_sel:WORD_0
    v_lshlrev_b32_sdwa v106, 3, v120 dst_sel:DWORD dst_unused:UNUSED_PAD src0_sel:DWORD src1_sel:WORD_1
    ds_read_b64 v[104:105], v104
    ds_read_b64 v[106:107], v106
    v_lshlrev_b32_sdwa v108, 3, v121 dst_sel:DWORD dst_unused:UNUSED_PAD src0_sel:DWORD src1_sel:WORD_0
    v_lshlrev_b32_sdwa v110, 3, v121 dst_sel:DWORD dst_unused:UNUSED_PAD src0_sel:DWORD src1_sel:WORD_1
    ds_read_b64 v[108:109], v108
    ds_read_b64 v[110:111], v110
    s_waitcnt lgkmcnt(8)
    v_smfmac_f32_16x16x64_bf16 v[32:35], v[64:67], v[88:95], v68
    v_exp_f32 v172, v172
    buffer_store_dword v168, v70, s[12:15], s35 offen offset:1024 sc1
    v_pk_fma_f32 v[170:171], v[170:171], v[134:135], v[134:135]
    v_exp_f32 v173, v173
    v_pk_mul_f32 v[142:143], v[142:143], v[26:27]
    v_pk_mul_f32 v[146:147], v[28:29], v[28:29]
    v_rcp_f32 v170, v170
    v_pk_fma_f32 v[172:173], v[172:173], v[136:137], v[136:137]
    v_lshlrev_b32_sdwa v88, 3, v122 dst_sel:DWORD dst_unused:UNUSED_PAD src0_sel:DWORD src1_sel:WORD_0
    v_lshlrev_b32_sdwa v90, 3, v122 dst_sel:DWORD dst_unused:UNUSED_PAD src0_sel:DWORD src1_sel:WORD_1
    ds_read_b64 v[88:89], v88
    ds_read_b64 v[90:91], v90
    v_lshlrev_b32_sdwa v92, 3, v123 dst_sel:DWORD dst_unused:UNUSED_PAD src0_sel:DWORD src1_sel:WORD_0
    v_lshlrev_b32_sdwa v94, 3, v123 dst_sel:DWORD dst_unused:UNUSED_PAD src0_sel:DWORD src1_sel:WORD_1
    ds_read_b64 v[92:93], v92
    ds_read_b64 v[94:95], v94
    buffer_load_dwordx4 v[120:123], v69, s[12:15], s45 offen offset:1024 sc1
    s_waitcnt lgkmcnt(8)
    v_smfmac_f32_16x16x64_bf16 v[36:39], v[64:67], v[96:103], v68
    v_rcp_f32 v171, v171
    v_pk_fma_f32 v[146:147], v[146:147], v[128:129], v[130:131]
    v_pk_mul_f32 v[148:149], v[30:31], v[30:31]
    v_rcp_f32 v172, v172
    v_pk_mul_f32 v[174:175], v[20:21], v[170:171]
    v_pk_mul_f32 v[146:147], v[146:147], v[28:29]
    v_rcp_f32 v173, v173
    v_pk_fma_f32 v[148:149], v[148:149], v[128:129], v[130:131]
    s_waitcnt vmcnt(4)
    v_lshlrev_b32_sdwa v96, 3, v124 dst_sel:DWORD dst_unused:UNUSED_PAD src0_sel:DWORD src1_sel:WORD_0
    v_lshlrev_b32_sdwa v98, 3, v124 dst_sel:DWORD dst_unused:UNUSED_PAD src0_sel:DWORD src1_sel:WORD_1
    ds_read_b64 v[96:97], v96
    ds_read_b64 v[98:99], v98
    v_lshlrev_b32_sdwa v100, 3, v125 dst_sel:DWORD dst_unused:UNUSED_PAD src0_sel:DWORD src1_sel:WORD_0
    v_lshlrev_b32_sdwa v102, 3, v125 dst_sel:DWORD dst_unused:UNUSED_PAD src0_sel:DWORD src1_sel:WORD_1
    ds_read_b64 v[100:101], v100
    ds_read_b64 v[102:103], v102
    s_waitcnt lgkmcnt(8)
    v_smfmac_f32_16x16x64_bf16 v[32:35], v[64:67], v[104:111], v68
    v_exp_f32 v140, v140
    v_pk_fma_f32 v[174:175], v[22:23], v[172:173], v[174:175]
    v_pk_mul_f32 v[148:149], v[148:149], v[30:31]
    v_exp_f32 v141, v141
    v_add_f32 v174, v174, v175
    v_exp_f32 v142, v142
    buffer_store_dword v174, v70, s[12:15], s35 offen offset:1152 sc1
    v_pk_fma_f32 v[140:141], v[140:141], v[134:135], v[134:135]
    v_lshlrev_b32_sdwa v104, 3, v126 dst_sel:DWORD dst_unused:UNUSED_PAD src0_sel:DWORD src1_sel:WORD_0
    v_lshlrev_b32_sdwa v106, 3, v126 dst_sel:DWORD dst_unused:UNUSED_PAD src0_sel:DWORD src1_sel:WORD_1
    ds_read_b64 v[104:105], v104
    ds_read_b64 v[106:107], v106
    v_lshlrev_b32_sdwa v108, 3, v127 dst_sel:DWORD dst_unused:UNUSED_PAD src0_sel:DWORD src1_sel:WORD_0
    v_lshlrev_b32_sdwa v110, 3, v127 dst_sel:DWORD dst_unused:UNUSED_PAD src0_sel:DWORD src1_sel:WORD_1
    ds_read_b64 v[108:109], v108
    ds_read_b64 v[110:111], v110
    buffer_load_dwordx4 v[124:127], v69, s[12:15], s20 offen offset:2048 sc1
    s_waitcnt lgkmcnt(8)
    v_smfmac_f32_16x16x64_bf16 v[36:39], v[64:67], v[88:95], v68
    v_rcp_f32 v140, v140
    v_pk_mul_f32 v[152:153], v[32:33], v[32:33]
    v_pk_mul_f32 v[154:155], v[34:35], v[34:35]
    v_rcp_f32 v141, v141
    v_pk_fma_f32 v[152:153], v[152:153], v[128:129], v[130:131]
    v_pk_fma_f32 v[154:155], v[154:155], v[128:129], v[130:131]
    v_exp_f32 v143, v143
    v_pk_mul_f32 v[144:145], v[24:25], v[140:141]
    s_waitcnt vmcnt(4)
    v_lshlrev_b32_sdwa v88, 3, v116 dst_sel:DWORD dst_unused:UNUSED_PAD src0_sel:DWORD src1_sel:WORD_0
    v_lshlrev_b32_sdwa v90, 3, v116 dst_sel:DWORD dst_unused:UNUSED_PAD src0_sel:DWORD src1_sel:WORD_1
    ds_read_b64 v[88:89], v88
    ds_read_b64 v[90:91], v90
    v_lshlrev_b32_sdwa v92, 3, v117 dst_sel:DWORD dst_unused:UNUSED_PAD src0_sel:DWORD src1_sel:WORD_0
    v_lshlrev_b32_sdwa v94, 3, v117 dst_sel:DWORD dst_unused:UNUSED_PAD src0_sel:DWORD src1_sel:WORD_1
    ds_read_b64 v[92:93], v92
    ds_read_b64 v[94:95], v94
    s_waitcnt lgkmcnt(8)
    v_smfmac_f32_16x16x64_bf16 v[40:43], v[64:67], v[96:103], v68
    v_exp_f32 v146, v146
    v_pk_fma_f32 v[142:143], v[142:143], v[136:137], v[136:137]
    v_pk_mul_f32 v[152:153], v[152:153], v[32:33]
    v_rcp_f32 v142, v142
    v_pk_mul_f32 v[154:155], v[154:155], v[34:35]
    v_pk_mul_f32 v[158:159], v[36:37], v[36:37]
    v_rcp_f32 v143, v143
    v_pk_fma_f32 v[158:159], v[158:159], v[128:129], v[130:131]
    v_lshlrev_b32_sdwa v96, 3, v118 dst_sel:DWORD dst_unused:UNUSED_PAD src0_sel:DWORD src1_sel:WORD_0
    v_lshlrev_b32_sdwa v98, 3, v118 dst_sel:DWORD dst_unused:UNUSED_PAD src0_sel:DWORD src1_sel:WORD_1
    ds_read_b64 v[96:97], v96
    ds_read_b64 v[98:99], v98
    v_lshlrev_b32_sdwa v100, 3, v119 dst_sel:DWORD dst_unused:UNUSED_PAD src0_sel:DWORD src1_sel:WORD_0
    v_lshlrev_b32_sdwa v102, 3, v119 dst_sel:DWORD dst_unused:UNUSED_PAD src0_sel:DWORD src1_sel:WORD_1
    ds_read_b64 v[100:101], v100
    ds_read_b64 v[102:103], v102
    buffer_load_dwordx4 v[116:119], v69, s[12:15], s41 offen offset:2048 sc1
    s_waitcnt lgkmcnt(8)
    v_smfmac_f32_16x16x64_bf16 v[44:47], v[64:67], v[104:111], v68
    v_exp_f32 v147, v147
    v_pk_fma_f32 v[144:145], v[26:27], v[142:143], v[144:145]
    v_pk_mul_f32 v[158:159], v[158:159], v[36:37]
    v_exp_f32 v148, v148
    v_add_f32 v144, v144, v145
    v_pk_fma_f32 v[146:147], v[146:147], v[134:135], v[134:135]
    v_exp_f32 v149, v149
    buffer_store_dword v144, v70, s[12:15], s35 offen offset:1536 sc1
    s_waitcnt vmcnt(4)
    v_lshlrev_b32_sdwa v104, 3, v120 dst_sel:DWORD dst_unused:UNUSED_PAD src0_sel:DWORD src1_sel:WORD_0
    v_lshlrev_b32_sdwa v106, 3, v120 dst_sel:DWORD dst_unused:UNUSED_PAD src0_sel:DWORD src1_sel:WORD_1
    ds_read_b64 v[104:105], v104
    ds_read_b64 v[106:107], v106
    v_lshlrev_b32_sdwa v108, 3, v121 dst_sel:DWORD dst_unused:UNUSED_PAD src0_sel:DWORD src1_sel:WORD_0
    v_lshlrev_b32_sdwa v110, 3, v121 dst_sel:DWORD dst_unused:UNUSED_PAD src0_sel:DWORD src1_sel:WORD_1
    ds_read_b64 v[108:109], v108
    ds_read_b64 v[110:111], v110
    s_waitcnt lgkmcnt(8)
    v_smfmac_f32_16x16x64_bf16 v[40:43], v[64:67], v[88:95], v68
    v_rcp_f32 v146, v146
    v_pk_fma_f32 v[148:149], v[148:149], v[136:137], v[136:137]
    v_pk_mul_f32 v[160:161], v[38:39], v[38:39]
    v_rcp_f32 v147, v147
    v_pk_fma_f32 v[160:161], v[160:161], v[128:129], v[130:131]
    v_rcp_f32 v148, v148
    v_pk_mul_f32 v[150:151], v[28:29], v[146:147]
    v_pk_mul_f32 v[160:161], v[160:161], v[38:39]
    v_lshlrev_b32_sdwa v88, 3, v122 dst_sel:DWORD dst_unused:UNUSED_PAD src0_sel:DWORD src1_sel:WORD_0
    v_lshlrev_b32_sdwa v90, 3, v122 dst_sel:DWORD dst_unused:UNUSED_PAD src0_sel:DWORD src1_sel:WORD_1
    ds_read_b64 v[88:89], v88
    ds_read_b64 v[90:91], v90
    v_lshlrev_b32_sdwa v92, 3, v123 dst_sel:DWORD dst_unused:UNUSED_PAD src0_sel:DWORD src1_sel:WORD_0
    v_lshlrev_b32_sdwa v94, 3, v123 dst_sel:DWORD dst_unused:UNUSED_PAD src0_sel:DWORD src1_sel:WORD_1
    ds_read_b64 v[92:93], v92
    ds_read_b64 v[94:95], v94
    buffer_load_dwordx4 v[120:123], v69, s[12:15], s45 offen offset:2048 sc1
    s_waitcnt lgkmcnt(8)
    v_smfmac_f32_16x16x64_bf16 v[44:47], v[64:67], v[96:103], v68
    v_rcp_f32 v149, v149
    v_exp_f32 v152, v152
    v_exp_f32 v153, v153
    v_pk_fma_f32 v[150:151], v[30:31], v[148:149], v[150:151]
    v_exp_f32 v154, v154
    v_add_f32 v150, v150, v151
    v_pk_fma_f32 v[152:153], v[152:153], v[134:135], v[134:135]
    v_exp_f32 v155, v155
    s_waitcnt vmcnt(3)
    v_lshlrev_b32_sdwa v96, 3, v124 dst_sel:DWORD dst_unused:UNUSED_PAD src0_sel:DWORD src1_sel:WORD_0
    v_lshlrev_b32_sdwa v98, 3, v124 dst_sel:DWORD dst_unused:UNUSED_PAD src0_sel:DWORD src1_sel:WORD_1
    ds_read_b64 v[96:97], v96
    ds_read_b64 v[98:99], v98
    v_lshlrev_b32_sdwa v100, 3, v125 dst_sel:DWORD dst_unused:UNUSED_PAD src0_sel:DWORD src1_sel:WORD_0
    v_lshlrev_b32_sdwa v102, 3, v125 dst_sel:DWORD dst_unused:UNUSED_PAD src0_sel:DWORD src1_sel:WORD_1
    ds_read_b64 v[100:101], v100
    ds_read_b64 v[102:103], v102
    s_waitcnt lgkmcnt(8)
    v_smfmac_f32_16x16x64_bf16 v[40:43], v[64:67], v[104:111], v68
    v_rcp_f32 v152, v152
    buffer_store_dword v150, v70, s[12:15], s35 offen offset:1664 sc1
    v_pk_fma_f32 v[154:155], v[154:155], v[136:137], v[136:137]
    v_rcp_f32 v153, v153
    v_rcp_f32 v154, v154
    v_rcp_f32 v155, v155
    v_pk_mul_f32 v[156:157], v[32:33], v[152:153]
    v_exp_f32 v158, v158
    v_lshlrev_b32_sdwa v104, 3, v126 dst_sel:DWORD dst_unused:UNUSED_PAD src0_sel:DWORD src1_sel:WORD_0
    v_lshlrev_b32_sdwa v106, 3, v126 dst_sel:DWORD dst_unused:UNUSED_PAD src0_sel:DWORD src1_sel:WORD_1
    ds_read_b64 v[104:105], v104
    ds_read_b64 v[106:107], v106
    v_lshlrev_b32_sdwa v108, 3, v127 dst_sel:DWORD dst_unused:UNUSED_PAD src0_sel:DWORD src1_sel:WORD_0
    v_lshlrev_b32_sdwa v110, 3, v127 dst_sel:DWORD dst_unused:UNUSED_PAD src0_sel:DWORD src1_sel:WORD_1
    ds_read_b64 v[108:109], v108
    ds_read_b64 v[110:111], v110
    buffer_load_dwordx4 v[124:127], v69, s[12:15], s20 offen offset:3072 sc1
    s_waitcnt lgkmcnt(8)
    v_smfmac_f32_16x16x64_bf16 v[44:47], v[64:67], v[88:95], v68
    v_exp_f32 v159, v159
    v_pk_fma_f32 v[156:157], v[34:35], v[154:155], v[156:157]
    v_pk_mul_f32 v[164:165], v[40:41], v[40:41]
    v_exp_f32 v160, v160
    v_add_f32 v156, v156, v157
    v_pk_fma_f32 v[158:159], v[158:159], v[134:135], v[134:135]
    v_exp_f32 v161, v161
    buffer_store_dword v156, v70, s[12:15], s35 offen offset:2048 sc1
    s_waitcnt vmcnt(5)
    v_lshlrev_b32_sdwa v88, 3, v116 dst_sel:DWORD dst_unused:UNUSED_PAD src0_sel:DWORD src1_sel:WORD_0
    v_lshlrev_b32_sdwa v90, 3, v116 dst_sel:DWORD dst_unused:UNUSED_PAD src0_sel:DWORD src1_sel:WORD_1
    ds_read_b64 v[88:89], v88
    ds_read_b64 v[90:91], v90
    v_lshlrev_b32_sdwa v92, 3, v117 dst_sel:DWORD dst_unused:UNUSED_PAD src0_sel:DWORD src1_sel:WORD_0
    v_lshlrev_b32_sdwa v94, 3, v117 dst_sel:DWORD dst_unused:UNUSED_PAD src0_sel:DWORD src1_sel:WORD_1
    ds_read_b64 v[92:93], v92
    ds_read_b64 v[94:95], v94
    s_waitcnt lgkmcnt(8)
    v_smfmac_f32_16x16x64_bf16 v[48:51], v[64:67], v[96:103], v68
    v_rcp_f32 v158, v158
    v_pk_fma_f32 v[160:161], v[160:161], v[136:137], v[136:137]
    v_pk_fma_f32 v[164:165], v[164:165], v[128:129], v[130:131]
    v_rcp_f32 v159, v159
    v_pk_mul_f32 v[164:165], v[164:165], v[40:41]
    v_pk_mul_f32 v[166:167], v[42:43], v[42:43]
    v_rcp_f32 v160, v160
    v_pk_mul_f32 v[162:163], v[36:37], v[158:159]
    v_lshlrev_b32_sdwa v96, 3, v118 dst_sel:DWORD dst_unused:UNUSED_PAD src0_sel:DWORD src1_sel:WORD_0
    v_lshlrev_b32_sdwa v98, 3, v118 dst_sel:DWORD dst_unused:UNUSED_PAD src0_sel:DWORD src1_sel:WORD_1
    ds_read_b64 v[96:97], v96
    ds_read_b64 v[98:99], v98
    v_lshlrev_b32_sdwa v100, 3, v119 dst_sel:DWORD dst_unused:UNUSED_PAD src0_sel:DWORD src1_sel:WORD_0
    v_lshlrev_b32_sdwa v102, 3, v119 dst_sel:DWORD dst_unused:UNUSED_PAD src0_sel:DWORD src1_sel:WORD_1
    ds_read_b64 v[100:101], v100
    ds_read_b64 v[102:103], v102
    buffer_load_dwordx4 v[116:119], v69, s[12:15], s41 offen offset:3072 sc1
    s_waitcnt lgkmcnt(8)
    v_smfmac_f32_16x16x64_bf16 v[52:55], v[64:67], v[104:111], v68
    s_setprio 1
    v_rcp_f32 v161, v161
    v_pk_fma_f32 v[166:167], v[166:167], v[128:129], v[130:131]
    v_pk_mul_f32 v[170:171], v[44:45], v[44:45]
    v_exp_f32 v164, v164
    v_pk_fma_f32 v[162:163], v[38:39], v[160:161], v[162:163]
    v_pk_mul_f32 v[166:167], v[166:167], v[42:43]
    v_exp_f32 v165, v165
    v_add_f32 v162, v162, v163
    s_waitcnt vmcnt(4)
    v_lshlrev_b32_sdwa v104, 3, v120 dst_sel:DWORD dst_unused:UNUSED_PAD src0_sel:DWORD src1_sel:WORD_0
    v_lshlrev_b32_sdwa v106, 3, v120 dst_sel:DWORD dst_unused:UNUSED_PAD src0_sel:DWORD src1_sel:WORD_1
    ds_read_b64 v[104:105], v104
    ds_read_b64 v[106:107], v106
    v_lshlrev_b32_sdwa v108, 3, v121 dst_sel:DWORD dst_unused:UNUSED_PAD src0_sel:DWORD src1_sel:WORD_0
    v_lshlrev_b32_sdwa v110, 3, v121 dst_sel:DWORD dst_unused:UNUSED_PAD src0_sel:DWORD src1_sel:WORD_1
    ds_read_b64 v[108:109], v108
    ds_read_b64 v[110:111], v110
    s_waitcnt lgkmcnt(8)
    v_smfmac_f32_16x16x64_bf16 v[48:51], v[64:67], v[88:95], v68
    v_exp_f32 v166, v166
    buffer_store_dword v162, v70, s[12:15], s35 offen offset:2176 sc1
    v_pk_fma_f32 v[164:165], v[164:165], v[134:135], v[134:135]
    v_exp_f32 v167, v167
    v_pk_fma_f32 v[170:171], v[170:171], v[128:129], v[130:131]
    v_pk_mul_f32 v[172:173], v[46:47], v[46:47]
    v_rcp_f32 v164, v164
    v_pk_fma_f32 v[166:167], v[166:167], v[136:137], v[136:137]
    v_lshlrev_b32_sdwa v88, 3, v122 dst_sel:DWORD dst_unused:UNUSED_PAD src0_sel:DWORD src1_sel:WORD_0
    v_lshlrev_b32_sdwa v90, 3, v122 dst_sel:DWORD dst_unused:UNUSED_PAD src0_sel:DWORD src1_sel:WORD_1
    ds_read_b64 v[88:89], v88
    ds_read_b64 v[90:91], v90
    v_lshlrev_b32_sdwa v92, 3, v123 dst_sel:DWORD dst_unused:UNUSED_PAD src0_sel:DWORD src1_sel:WORD_0
    v_lshlrev_b32_sdwa v94, 3, v123 dst_sel:DWORD dst_unused:UNUSED_PAD src0_sel:DWORD src1_sel:WORD_1
    ds_read_b64 v[92:93], v92
    ds_read_b64 v[94:95], v94
    buffer_load_dwordx4 v[120:123], v69, s[12:15], s45 offen offset:3072 sc1
    s_waitcnt lgkmcnt(8)
    v_smfmac_f32_16x16x64_bf16 v[52:55], v[64:67], v[96:103], v68
    v_rcp_f32 v165, v165
    v_pk_mul_f32 v[170:171], v[170:171], v[44:45]
    v_pk_fma_f32 v[172:173], v[172:173], v[128:129], v[130:131]
    v_rcp_f32 v166, v166
    v_pk_mul_f32 v[168:169], v[40:41], v[164:165]
    v_pk_mul_f32 v[172:173], v[172:173], v[46:47]
    v_rcp_f32 v167, v167
    v_exp_f32 v170, v170
    s_waitcnt vmcnt(4)
    v_lshlrev_b32_sdwa v96, 3, v124 dst_sel:DWORD dst_unused:UNUSED_PAD src0_sel:DWORD src1_sel:WORD_0
    v_lshlrev_b32_sdwa v98, 3, v124 dst_sel:DWORD dst_unused:UNUSED_PAD src0_sel:DWORD src1_sel:WORD_1
    ds_read_b64 v[96:97], v96
    ds_read_b64 v[98:99], v98
    v_lshlrev_b32_sdwa v100, 3, v125 dst_sel:DWORD dst_unused:UNUSED_PAD src0_sel:DWORD src1_sel:WORD_0
    v_lshlrev_b32_sdwa v102, 3, v125 dst_sel:DWORD dst_unused:UNUSED_PAD src0_sel:DWORD src1_sel:WORD_1
    ds_read_b64 v[100:101], v100
    ds_read_b64 v[102:103], v102
    s_waitcnt lgkmcnt(8)
    v_smfmac_f32_16x16x64_bf16 v[48:51], v[64:67], v[104:111], v68
    v_exp_f32 v171, v171
    v_pk_fma_f32 v[168:169], v[42:43], v[166:167], v[168:169]
    v_exp_f32 v172, v172
    v_add_f32 v168, v168, v169
    v_pk_fma_f32 v[170:171], v[170:171], v[134:135], v[134:135]
    v_exp_f32 v173, v173
    buffer_store_dword v168, v70, s[12:15], s35 offen offset:2560 sc1
    v_rcp_f32 v170, v170
    v_lshlrev_b32_sdwa v104, 3, v126 dst_sel:DWORD dst_unused:UNUSED_PAD src0_sel:DWORD src1_sel:WORD_0
    v_lshlrev_b32_sdwa v106, 3, v126 dst_sel:DWORD dst_unused:UNUSED_PAD src0_sel:DWORD src1_sel:WORD_1
    ds_read_b64 v[104:105], v104
    ds_read_b64 v[106:107], v106
    v_lshlrev_b32_sdwa v108, 3, v127 dst_sel:DWORD dst_unused:UNUSED_PAD src0_sel:DWORD src1_sel:WORD_0
    v_lshlrev_b32_sdwa v110, 3, v127 dst_sel:DWORD dst_unused:UNUSED_PAD src0_sel:DWORD src1_sel:WORD_1
    ds_read_b64 v[108:109], v108
    ds_read_b64 v[110:111], v110
    s_waitcnt lgkmcnt(8)
    v_smfmac_f32_16x16x64_bf16 v[52:55], v[64:67], v[88:95], v68
    v_rcp_f32 v171, v171
    v_pk_fma_f32 v[172:173], v[172:173], v[136:137], v[136:137]
    v_pk_mul_f32 v[140:141], v[48:49], v[48:49]
    v_rcp_f32 v172, v172
    v_pk_mul_f32 v[174:175], v[44:45], v[170:171]
    v_pk_fma_f32 v[140:141], v[140:141], v[128:129], v[130:131]
    v_rcp_f32 v173, v173
    v_pk_mul_f32 v[140:141], v[140:141], v[48:49]
    s_waitcnt vmcnt(3)
    v_lshlrev_b32_sdwa v88, 3, v116 dst_sel:DWORD dst_unused:UNUSED_PAD src0_sel:DWORD src1_sel:WORD_0
    v_lshlrev_b32_sdwa v90, 3, v116 dst_sel:DWORD dst_unused:UNUSED_PAD src0_sel:DWORD src1_sel:WORD_1
    ds_read_b64 v[88:89], v88
    ds_read_b64 v[90:91], v90
    v_lshlrev_b32_sdwa v92, 3, v117 dst_sel:DWORD dst_unused:UNUSED_PAD src0_sel:DWORD src1_sel:WORD_0
    v_lshlrev_b32_sdwa v94, 3, v117 dst_sel:DWORD dst_unused:UNUSED_PAD src0_sel:DWORD src1_sel:WORD_1
    ds_read_b64 v[92:93], v92
    ds_read_b64 v[94:95], v94
    s_waitcnt lgkmcnt(8)
    v_smfmac_f32_16x16x64_bf16 v[56:59], v[64:67], v[96:103], v68
    v_exp_f32 v140, v140
    v_pk_fma_f32 v[174:175], v[46:47], v[172:173], v[174:175]
    v_pk_mul_f32 v[142:143], v[50:51], v[50:51]
    v_exp_f32 v141, v141
    v_add_f32 v174, v174, v175
    v_pk_fma_f32 v[142:143], v[142:143], v[128:129], v[130:131]
    buffer_store_dword v174, v70, s[12:15], s35 offen offset:2688 sc1
    v_pk_fma_f32 v[140:141], v[140:141], v[134:135], v[134:135]
    v_lshlrev_b32_sdwa v96, 3, v118 dst_sel:DWORD dst_unused:UNUSED_PAD src0_sel:DWORD src1_sel:WORD_0
    v_lshlrev_b32_sdwa v98, 3, v118 dst_sel:DWORD dst_unused:UNUSED_PAD src0_sel:DWORD src1_sel:WORD_1
    ds_read_b64 v[96:97], v96
    ds_read_b64 v[98:99], v98
    v_lshlrev_b32_sdwa v100, 3, v119 dst_sel:DWORD dst_unused:UNUSED_PAD src0_sel:DWORD src1_sel:WORD_0
    v_lshlrev_b32_sdwa v102, 3, v119 dst_sel:DWORD dst_unused:UNUSED_PAD src0_sel:DWORD src1_sel:WORD_1
    ds_read_b64 v[100:101], v100
    ds_read_b64 v[102:103], v102
    s_waitcnt lgkmcnt(8)
    v_smfmac_f32_16x16x64_bf16 v[60:63], v[64:67], v[104:111], v68
    v_rcp_f32 v140, v140
    v_pk_mul_f32 v[142:143], v[142:143], v[50:51]
    v_pk_mul_f32 v[146:147], v[52:53], v[52:53]
    v_rcp_f32 v141, v141
    v_pk_fma_f32 v[146:147], v[146:147], v[128:129], v[130:131]
    v_pk_mul_f32 v[148:149], v[54:55], v[54:55]
    v_exp_f32 v142, v142
    v_pk_mul_f32 v[144:145], v[48:49], v[140:141]
    s_waitcnt vmcnt(2)
    v_lshlrev_b32_sdwa v104, 3, v120 dst_sel:DWORD dst_unused:UNUSED_PAD src0_sel:DWORD src1_sel:WORD_0
    v_lshlrev_b32_sdwa v106, 3, v120 dst_sel:DWORD dst_unused:UNUSED_PAD src0_sel:DWORD src1_sel:WORD_1
    ds_read_b64 v[104:105], v104
    ds_read_b64 v[106:107], v106
    v_lshlrev_b32_sdwa v108, 3, v121 dst_sel:DWORD dst_unused:UNUSED_PAD src0_sel:DWORD src1_sel:WORD_0
    v_lshlrev_b32_sdwa v110, 3, v121 dst_sel:DWORD dst_unused:UNUSED_PAD src0_sel:DWORD src1_sel:WORD_1
    ds_read_b64 v[108:109], v108
    ds_read_b64 v[110:111], v110
    s_waitcnt lgkmcnt(8)
    v_smfmac_f32_16x16x64_bf16 v[56:59], v[64:67], v[88:95], v68
    v_exp_f32 v143, v143
    v_pk_mul_f32 v[146:147], v[146:147], v[52:53]
    v_pk_fma_f32 v[148:149], v[148:149], v[128:129], v[130:131]
    v_exp_f32 v146, v146
    v_pk_fma_f32 v[142:143], v[142:143], v[136:137], v[136:137]
    v_pk_mul_f32 v[148:149], v[148:149], v[54:55]
    v_rcp_f32 v142, v142
    v_rcp_f32 v143, v143
    v_lshlrev_b32_sdwa v88, 3, v122 dst_sel:DWORD dst_unused:UNUSED_PAD src0_sel:DWORD src1_sel:WORD_0
    v_lshlrev_b32_sdwa v90, 3, v122 dst_sel:DWORD dst_unused:UNUSED_PAD src0_sel:DWORD src1_sel:WORD_1
    ds_read_b64 v[88:89], v88
    ds_read_b64 v[90:91], v90
    v_lshlrev_b32_sdwa v92, 3, v123 dst_sel:DWORD dst_unused:UNUSED_PAD src0_sel:DWORD src1_sel:WORD_0
    v_lshlrev_b32_sdwa v94, 3, v123 dst_sel:DWORD dst_unused:UNUSED_PAD src0_sel:DWORD src1_sel:WORD_1
    ds_read_b64 v[92:93], v92
    ds_read_b64 v[94:95], v94
    s_waitcnt lgkmcnt(8)
    v_smfmac_f32_16x16x64_bf16 v[60:63], v[64:67], v[96:103], v68
    s_setprio 0
    v_exp_f32 v147, v147
    v_pk_fma_f32 v[144:145], v[50:51], v[142:143], v[144:145]
    v_exp_f32 v148, v148
    v_add_f32 v144, v144, v145
    v_pk_fma_f32 v[146:147], v[146:147], v[134:135], v[134:135]
    v_exp_f32 v149, v149
    buffer_store_dword v144, v70, s[12:15], s35 offen offset:3072 sc1
    v_rcp_f32 v146, v146
    s_waitcnt lgkmcnt(4)
    v_smfmac_f32_16x16x64_bf16 v[56:59], v[64:67], v[104:111], v68
    v_rcp_f32 v147, v147
    v_pk_fma_f32 v[148:149], v[148:149], v[136:137], v[136:137]
    s_waitcnt lgkmcnt(0)
    v_smfmac_f32_16x16x64_bf16 v[60:63], v[64:67], v[88:95], v68
    v_rcp_f32 v148, v148
    v_pk_mul_f32 v[150:151], v[52:53], v[146:147]
    v_rcp_f32 v149, v149
    s_nop 0
    s_nop 0
    v_pk_fma_f32 v[150:151], v[54:55], v[148:149], v[150:151]
    s_nop 0
    v_add_f32 v150, v150, v151
    v_pk_mul_f32 v[152:153], v[56:57], v[56:57]
    buffer_store_dword v150, v70, s[12:15], s35 offen offset:3200 sc1
    v_pk_fma_f32 v[152:153], v[152:153], v[128:129], v[130:131]
    v_pk_mul_f32 v[154:155], v[58:59], v[58:59]
    v_pk_mul_f32 v[152:153], v[152:153], v[56:57]
    v_pk_fma_f32 v[154:155], v[154:155], v[128:129], v[130:131]
    v_exp_f32 v152, v152
    v_pk_mul_f32 v[154:155], v[154:155], v[58:59]
    v_pk_mul_f32 v[158:159], v[60:61], v[60:61]
    v_exp_f32 v153, v153
    v_pk_fma_f32 v[158:159], v[158:159], v[128:129], v[130:131]
    v_pk_mul_f32 v[160:161], v[62:63], v[62:63]
    v_exp_f32 v154, v154
    v_pk_fma_f32 v[152:153], v[152:153], v[134:135], v[134:135]
    v_pk_mul_f32 v[158:159], v[158:159], v[60:61]
    v_rcp_f32 v152, v152
    v_pk_fma_f32 v[160:161], v[160:161], v[128:129], v[130:131]
    v_rcp_f32 v153, v153
    v_pk_mul_f32 v[160:161], v[160:161], v[62:63]
    v_exp_f32 v155, v155
    v_pk_mul_f32 v[156:157], v[56:57], v[152:153]
    v_exp_f32 v158, v158
    v_pk_fma_f32 v[154:155], v[154:155], v[136:137], v[136:137]
    v_exp_f32 v159, v159
    v_rcp_f32 v154, v154
    v_rcp_f32 v155, v155
    v_pk_fma_f32 v[158:159], v[158:159], v[134:135], v[134:135]
    v_exp_f32 v160, v160
    v_pk_fma_f32 v[156:157], v[58:59], v[154:155], v[156:157]
    v_rcp_f32 v158, v158
    v_add_f32 v156, v156, v157
    v_rcp_f32 v159, v159
    buffer_store_dword v156, v70, s[12:15], s35 offen offset:3584 sc1
    v_exp_f32 v161, v161
    v_pk_mul_f32 v[162:163], v[60:61], v[158:159]
    s_nop 0
    v_pk_fma_f32 v[160:161], v[160:161], v[136:137], v[136:137]
    s_nop 0
    v_rcp_f32 v160, v160
    v_rcp_f32 v161, v161
    s_nop 0
    s_nop 0
    v_pk_fma_f32 v[162:163], v[62:63], v[160:161], v[162:163]
    s_nop 0
    v_add_f32 v162, v162, v163
    s_nop 0
    buffer_store_dword v162, v70, s[12:15], s35 offen offset:3712 sc1

    v_and_b32 v193, 0xf0, v69
    v_lshrrev_b32 v197, 8, v69
    v_lshl_or_b32 v192, v197, 16, v193
    v_lshrrev_b32 v198, 1, v197
    v_and_b32 v197, 1, v197
    v_lshl_or_b32 v193, v198, 2, v193
    v_lshl_or_b32 v193, v197, 3, v193
    v_mov_b32 v196, 0
    s_mov_b32 s65, 0

    s_lshl_b32 s68, s2, 8
    s_add_u32 s66, s68, 29360128
    s_add_u32 s67, s66, 65536
    s_add_u32 s60, s68, 20971520
    s_lshr_b32 s68, s68, 1

    s_lshl_b32 s61, s3, 20
    s_add_u32 s60, s60, s61

    s_add_u32 s61, s60, 262144
    s_add_u32 s62, s60, 524288
    s_add_u32 s63, s60, 786432

    s_mov_b32 s76, s56
    s_and_b32 s77, s57, 0xffff
    s_mov_b32 s78, 2
    s_mov_b32 s79, 0x00020000
    s_mov_b32 s72, s58
    s_and_b32 s73, s59, 0xffff
    s_mov_b32 s74, 32768
    s_mov_b32 s75, 0x00020000
    s_mov_b64 s[20:21], -1
    s_mov_b64 s[22:23], -1
    s_mov_b64 s[24:25], -1
    s_mov_b64 s[26:27], -1
    s_mov_b64 s[28:29], -1

    v_mov_b32 v216, -1
    buffer_load_short_d16_hi v196, v196, s[76:79], 0 offen
    s_bitcmp1_b32 s64, 30
    s_cbranch_scc0 standalone__deep_cross_pnn__recsys_kernel_rd

standalone__deep_cross_pnn__recsys_kernel_rp:
    s_mov_b64 exec, s[20:21]
    buffer_load_dwordx4 v[176:179], v192, s[12:15], s60 offen sc1
    s_mov_b64 exec, s[22:23]
    buffer_load_dwordx4 v[180:183], v192, s[12:15], s61 offen sc1
    s_mov_b64 exec, s[24:25]
    buffer_load_dwordx4 v[184:187], v192, s[12:15], s62 offen sc1
    s_mov_b64 exec, s[26:27]
    buffer_load_dwordx4 v[188:191], v192, s[12:15], s63 offen sc1
    s_mov_b64 exec, s[28:29]
    buffer_load_dword v194, v193, s[12:15], s66 offen sc1
    buffer_load_dword v195, v193, s[12:15], s67 offen sc1
    s_mov_b64 exec, -1
    s_waitcnt vmcnt(4)
    v_add_f32 v216, v176, v180
    v_add_f32 v217, v177, v181
    v_add_f32 v218, v178, v182
    v_add_f32 v219, v179, v183
    s_waitcnt vmcnt(2)
    v_add_f32 v220, v184, v188
    v_add_f32 v221, v185, v189
    v_add_f32 v222, v186, v190
    v_add_f32 v223, v187, v191
    v_add_f32 v216, v216, v220
    v_add_f32 v217, v217, v221
    v_add_f32 v218, v218, v222
    v_add_f32 v219, v219, v223

    s_nop 0
    v_permlane32_swap_b32 v216, v217
    v_permlane32_swap_b32 v218, v219
    v_add_f32 v216, v216, v217
    v_add_f32 v218, v218, v219
    s_nop 1
    v_permlane16_swap_b32 v216, v218
    s_nop 0
    v_add_f32 v216, v216, v218

    s_waitcnt vmcnt(0)
    v_add_f32 v201, v194, v195
    s_add_u32 s65, s65, 1
    v_add_f32 v197, v201, v216
    v_cmp_u_f32 vcc, v197, v197
    s_cbranch_vccz standalone__deep_cross_pnn__recsys_kernel_rd

    v_cmp_u_f32 s[20:21], v176, v177
    v_cmp_u_f32 vcc, v178, v179
    s_or_b64 s[20:21], s[20:21], vcc

    v_cmp_u_f32 s[22:23], v180, v181
    v_cmp_u_f32 vcc, v182, v183
    s_or_b64 s[22:23], s[22:23], vcc

    v_cmp_u_f32 s[24:25], v184, v185
    v_cmp_u_f32 vcc, v186, v187
    s_or_b64 s[24:25], s[24:25], vcc

    v_cmp_u_f32 s[26:27], v188, v189
    v_cmp_u_f32 vcc, v190, v191
    s_or_b64 s[26:27], s[26:27], vcc

    v_cmp_u_f32 s[28:29], v194, v195

    s_cmp_lt_u32 s65, 300
    s_cbranch_scc1 standalone__deep_cross_pnn__recsys_kernel_rp
    v_mov_b32 v216, -1

standalone__deep_cross_pnn__recsys_kernel_rd:

    v_lshrrev_b32 v197, 2, v69
    s_lshl_b32 s69, s3, 8
    v_add_u32 v198, s69, v197
    ds_write_b32 v198, v216
    v_mov_b32 v199, 0
    s_waitcnt vmcnt(0) lgkmcnt(0)

    s_barrier
    s_cmp_eq_u32 s3, 1
    s_cbranch_scc1 standalone__deep_cross_pnn__recsys_kernel_rc
    s_cmp_lg_u32 s3, 0
    s_cbranch_scc1 standalone__deep_cross_pnn__recsys_kernel_end

    ds_read_b32 v208, v197 offset:0
    ds_read_b32 v209, v197 offset:256
    ds_read_b32 v210, v197 offset:512
    ds_read_b32 v211, v197 offset:768
    ds_read_b32 v212, v197 offset:1024
    ds_read_b32 v213, v197 offset:1280
    ds_read_b32 v214, v197 offset:1536
    ds_read_b32 v215, v197 offset:1792
    s_waitcnt lgkmcnt(6)
    v_add_f32 v200, v208, v209
    s_waitcnt lgkmcnt(5)
    v_add_f32 v200, v200, v210
    s_waitcnt lgkmcnt(4)
    v_add_f32 v200, v200, v211
    s_waitcnt lgkmcnt(3)
    v_add_f32 v200, v200, v212
    s_waitcnt lgkmcnt(2)
    v_add_f32 v200, v200, v213
    s_waitcnt lgkmcnt(1)
    v_add_f32 v200, v200, v214
    s_waitcnt lgkmcnt(0)
    v_add_f32 v200, v200, v215

    v_cmp_u_f32 vcc, v200, v200
    s_cbranch_vccnz standalone__deep_cross_pnn__recsys_kernel_rf

    v_cvt_pk_bf16_f32 v197, v200, v201
    v_lshlrev_b32 v198, 16, v197
    v_and_b32 v197, 0xffff0000, v197
    v_add_f32 v198, v198, v196
    v_cvt_pk_bf16_f32 v198, v198, v198
    v_lshlrev_b32 v198, 16, v198
    v_add_f32 v198, v198, v197
    v_cvt_pk_bf16_f32 v198, v198, v198
    v_lshrrev_b32 v197, 1, v193
    buffer_store_short v198, v197, s[72:75], s68 offen

    s_endpgm
standalone__deep_cross_pnn__recsys_kernel_rf:

    s_lshr_b32 s69, s2, 5
    s_lshl_b32 s69, s69, 4
    s_lshl_b32 s70, 1, s2
    v_mov_b32 v198, s70
    s_mov_b64 exec, 1
    buffer_atomic_or v198, v199, s[52:55], s69 offen offset:136 sc0
    s_waitcnt vmcnt(0)

standalone__deep_cross_pnn__recsys_kernel_rc:

    s_mov_b64 exec, 0xff
    buffer_load_dwordx4 v[176:179], v69, s[52:55], 0 offen offset:128 sc1
    s_waitcnt vmcnt(0)
    v_cmp_ne_u32 vcc, 0, v178
    s_cbranch_vccz standalone__deep_cross_pnn__recsys_kernel_end
    v_cmp_ne_u32 vcc, -1, v176
    s_cbranch_vccnz standalone__deep_cross_pnn__recsys_kernel_end
    v_mov_b32 v199, v178
    s_mov_b64 exec, -1
    v_lshlrev_b32 v198, 3, v69
    s_mov_b32 s69, 14680064
    buffer_load_dwordx4 v[176:179], v198, s[12:15], s69 offen sc1
    s_waitcnt vmcnt(0)
    v_min3_u32 v198, v176, v177, v178
    v_min_u32 v198, v198, v179
    v_cmp_eq_u32 vcc, 0, v198
    s_cbranch_vccnz standalone__deep_cross_pnn__recsys_kernel_end

standalone__deep_cross_pnn__recsys_kernel_rn:

    v_cmp_ne_u32 vcc, 0, v199
    s_cbranch_vccz standalone__deep_cross_pnn__recsys_kernel_end
    s_ff1_i32_b64 s69, vcc
    s_mov_b32 m0, s69
    s_nop 3
    v_readlane_b32 s70, v199, s69
    s_ff1_i32_b32 s71, s70
    s_bitset0_b32 s70, s71
    s_nop 3
    v_writelane_b32 v199, s70, m0
    s_lshl_b32 s69, s69, 5
    s_add_u32 s69, s69, s71

    s_lshl_b32 s68, s69, 8
    s_add_u32 s66, s68, 29360128
    s_add_u32 s67, s66, 65536
    s_add_u32 s60, s68, 20971520
    s_lshr_b32 s68, s68, 1

    s_add_u32 s61, s60, 262144
    s_add_u32 s62, s60, 524288
    s_add_u32 s63, s60, 786432

    buffer_load_dword v194, v193, s[12:15], s66 offen sc1
    buffer_load_dword v195, v193, s[12:15], s67 offen sc1
    s_mov_b32 s65, 0
standalone__deep_cross_pnn__recsys_kernel_rw:
    buffer_load_dwordx4 v[176:179], v192, s[12:15], s60 offen sc1
    buffer_load_dwordx4 v[180:183], v192, s[12:15], s61 offen sc1
    buffer_load_dwordx4 v[184:187], v192, s[12:15], s62 offen sc1
    buffer_load_dwordx4 v[188:191], v192, s[12:15], s63 offen sc1
    s_waitcnt vmcnt(2)
    v_add_f32 v216, v176, v180
    v_add_f32 v217, v177, v181
    v_add_f32 v218, v178, v182
    v_add_f32 v219, v179, v183
    s_waitcnt vmcnt(0)
    v_add_f32 v220, v184, v188
    v_add_f32 v221, v185, v189
    v_add_f32 v222, v186, v190
    v_add_f32 v223, v187, v191
    v_add_f32 v216, v216, v220
    v_add_f32 v217, v217, v221
    v_add_f32 v218, v218, v222
    v_add_f32 v219, v219, v223

    s_nop 0
    v_permlane32_swap_b32 v216, v217
    v_permlane32_swap_b32 v218, v219
    v_add_f32 v216, v216, v217
    v_add_f32 v218, v218, v219
    s_nop 1
    v_permlane16_swap_b32 v216, v218
    s_nop 0
    v_add_f32 v216, v216, v218

    s_mov_b32 s70, 0xff800001
    s_mov_b64 s[20:21], 0
    v_cmp_eq_u32 vcc, s70, v194
    s_or_b64 s[20:21], s[20:21], vcc
    v_cmp_eq_u32 vcc, s70, v195
    s_or_b64 s[20:21], s[20:21], vcc
    v_cmp_eq_u32 vcc, s70, v176
    s_or_b64 s[20:21], s[20:21], vcc
    v_cmp_eq_u32 vcc, s70, v177
    s_or_b64 s[20:21], s[20:21], vcc
    v_cmp_eq_u32 vcc, s70, v178
    s_or_b64 s[20:21], s[20:21], vcc
    v_cmp_eq_u32 vcc, s70, v179
    s_or_b64 s[20:21], s[20:21], vcc
    v_cmp_eq_u32 vcc, s70, v180
    s_or_b64 s[20:21], s[20:21], vcc
    v_cmp_eq_u32 vcc, s70, v181
    s_or_b64 s[20:21], s[20:21], vcc
    v_cmp_eq_u32 vcc, s70, v182
    s_or_b64 s[20:21], s[20:21], vcc
    v_cmp_eq_u32 vcc, s70, v183
    s_or_b64 s[20:21], s[20:21], vcc
    v_cmp_eq_u32 vcc, s70, v184
    s_or_b64 s[20:21], s[20:21], vcc
    v_cmp_eq_u32 vcc, s70, v185
    s_or_b64 s[20:21], s[20:21], vcc
    v_cmp_eq_u32 vcc, s70, v186
    s_or_b64 s[20:21], s[20:21], vcc
    v_cmp_eq_u32 vcc, s70, v187
    s_or_b64 s[20:21], s[20:21], vcc
    v_cmp_eq_u32 vcc, s70, v188
    s_or_b64 s[20:21], s[20:21], vcc
    v_cmp_eq_u32 vcc, s70, v189
    s_or_b64 s[20:21], s[20:21], vcc
    v_cmp_eq_u32 vcc, s70, v190
    s_or_b64 s[20:21], s[20:21], vcc
    v_cmp_eq_u32 vcc, s70, v191
    s_or_b64 s[20:21], s[20:21], vcc

    s_cbranch_scc1 standalone__deep_cross_pnn__recsys_kernel_end
    s_cmp_eq_u32 s65, 0
    s_cselect_b64 vcc, -1, 0
    v_add_f32 v200, v200, v216
    v_cndmask_b32 v200, v200, v216, vcc
    s_add_u32 s60, s60, 1048576
    s_add_u32 s61, s61, 1048576
    s_add_u32 s62, s62, 1048576
    s_add_u32 s63, s63, 1048576
    s_add_u32 s65, s65, 1
    s_cmp_lt_u32 s65, 8
    s_cbranch_scc1 standalone__deep_cross_pnn__recsys_kernel_rw
    v_add_f32 v201, v194, v195

    v_cvt_pk_bf16_f32 v197, v200, v201
    v_lshlrev_b32 v198, 16, v197
    v_and_b32 v197, 0xffff0000, v197
    v_add_f32 v198, v198, v196
    v_cvt_pk_bf16_f32 v198, v198, v198
    v_lshlrev_b32 v198, 16, v198
    v_add_f32 v198, v198, v197
    v_cvt_pk_bf16_f32 v198, v198, v198
    v_lshrrev_b32 v197, 1, v193
    buffer_store_short v198, v197, s[72:75], s68 offen

    s_nop 1
    s_branch standalone__deep_cross_pnn__recsys_kernel_rn
standalone__deep_cross_pnn__recsys_kernel_end:
    s_endpgm
.section .rodata,"a"
.p2align 6
.amdhsa_kernel standalone__deep_cross_pnn__recsys_kernel
  .amdhsa_next_free_vgpr 256
  .amdhsa_next_free_sgpr 102
  .amdhsa_accum_offset 256
  .amdhsa_group_segment_fixed_size 0
  .amdhsa_kernarg_size 80
  .amdhsa_user_sgpr_count 2
  .amdhsa_user_sgpr_kernarg_segment_ptr 1
  .amdhsa_system_sgpr_workgroup_id_x 1
.end_amdhsa_kernel
```

```asm
; @launch grid=(256,1,1) block=(512,1,1) lds=163840
.amdgcn_target "amdgcn-amd-amdhsa--gfx950"
.text
.globl standalone__deep_cross_pnn__recsys_kernel
.p2align 8
.type standalone__deep_cross_pnn__recsys_kernel,@function
standalone__deep_cross_pnn__recsys_kernel:

    s_cmp_ge_u32 s2, 256
    s_cbranch_scc1 standalone__deep_cross_pnn__recsys_kernel_end
    s_load_dwordx8 s[4:11], s[0:1], 0
    s_load_dwordx2 s[12:13], s[0:1], 72
    s_load_dwordx2 s[52:53], s[0:1], 64
    s_load_dwordx4 s[60:63], s[0:1], 32
    v_lshrrev_b32 v1, 6, v0
    v_and_b32 v255, 63, v0
    s_bfe_u32 s36, s2, 0x10003
    v_readfirstlane_b32 s3, v1
    s_lshr_b32 s37, s2, 4
    s_lshl_b32 s37, s37, 3
    s_and_b32 s38, s2, 7
    s_or_b32 s37, s37, s38
    v_lshlrev_b32 v254, 4, v255
    v_mov_b32 v252, 163712
    v_mov_b32 v253, 1
    v_mov_b32 v40, 0
    v_cmp_gt_u32 vcc, 8, v0
    v_lshl_add_u32 v41, v0, 2, v252
    s_and_saveexec_b64 s[46:47], vcc
    ds_write_b32 v41, v40
    s_mov_b64 exec, s[46:47]
    v_mul_u32_u24 v6, 57, v255
    v_lshrrev_b32 v6, 9, v6
    v_mul_u32_u24 v5, 9, v6
    v_sub_u32 v5, v255, v5
    v_cmp_gt_u32 s[40:41], 8, v5
    v_lshlrev_b32 v5, 4, v5
    v_lshl_add_u32 v83, v6, 8, v5
    s_and_b32 s56, s3, 3
    s_mul_i32 s42, s56, 1792
    s_mul_i32 s43, s56, 1008
    s_lshl_b32 s38, s36, 7
    s_add_u32 s42, s42, s38
    s_bitset0_b32 s41, 31
    s_waitcnt lgkmcnt(0)

    s_mov_b32 s16, s4
    s_and_b32 s17, s5, 0xffff
    s_mov_b32 s18, 6553600
    s_mov_b32 s19, 0x00020000
    s_mov_b32 s20, s6
    s_and_b32 s21, s7, 0xffff
    s_mov_b32 s22, 256000
    s_mov_b32 s23, 0x00020000
    s_mov_b32 s24, s8
    s_and_b32 s25, s9, 0xffff
    s_mov_b32 s26, 20000
    s_mov_b32 s27, 0x00020000
    s_mov_b32 s28, s10
    s_and_b32 s29, s11, 0xffff
    s_mov_b32 s30, 13107200
    s_mov_b32 s31, 0x00020000
    s_mov_b32 s32, s12
    s_and_b32 s33, s13, 0xffff
    s_mov_b32 s34, 268435456
    s_mov_b32 s35, 0x00020000
    s_mov_b32 s12, s12
    s_and_b32 s13, s13, 0xffff
    s_mov_b32 s14, 268435456
    s_mov_b32 s15, 0x00020000
    s_mov_b32 s52, s52
    s_and_b32 s53, s53, 0xffff
    s_mov_b32 s54, 256
    s_mov_b32 s55, 0x00020000

    s_mov_b32 s50, s36
    s_lshr_b32 s44, s2, 4
    s_lshl_b32 s44, s44, 6
    s_and_b32 s45, s2, 12
    s_add_u32 s44, s44, s45
    s_add_u32 s60, s60, s44
    s_addc_u32 s61, s61, 0
    s_add_u32 s10, s62, s44
    s_addc_u32 s11, s63, 0

    s_cmp_ge_u32 s3, 4
    s_cbranch_scc1 standalone__deep_cross_pnn__recsys_kernel_aux

    s_setprio 3
    s_lshl_b32 s38, s3, 10
    s_add_u32 m0, s38, 144144
    v_and_b32 v5, 15, v255

    buffer_load_dwordx4 v254, s[24:27], s38 offen lds
    s_add_u32 m0, m0, 4096
    s_add_u32 s38, s38, 4096
    buffer_load_dwordx4 v254, s[24:27], s38 offen lds
    s_add_u32 m0, m0, 4096
    s_add_u32 s38, s38, 4096
    buffer_load_dwordx4 v254, s[24:27], s38 offen lds
    s_add_u32 m0, m0, 4096
    s_add_u32 s38, s38, 4096
    buffer_load_dwordx4 v254, s[24:27], s38 offen lds
    s_add_u32 m0, m0, 4096
    s_add_u32 s38, s38, 4096
    s_cmp_eq_u32 s3, 3
    s_cselect_b32 s45, 1024, 0
    s_sub_u32 m0, m0, s45
    s_sub_u32 s38, s38, s45
    buffer_load_dwordx4 v254, s[24:27], s38 offen lds

    v_lshrrev_b32 v6, 4, v255
    v_and_b32 v8, 3, v255
    v_bfe_u32 v7, v255, 2, 2
    v_mul_u32_u24 v245, 24, v5
    s_movk_i32 s45, 400
    v_lshlrev_b32 v246, 2, v7
    v_mad_u32_u24 v246, v8, s45, v246
    s_lshl_b32 s72, s37, 7
    s_lshl_b32 s73, s3, 5
    s_add_u32 s72, s72, s73
    s_mul_i32 s74, s72, 400
    s_add_u32 s58, s74, 12800
    s_mov_b32 s18, s58
    v_mul_u32_u24 v184, 12, v5
    s_movk_i32 s45, 200
    v_mad_u32_u24 v185, v6, s45, v184
    v_lshlrev_b32 v186, 1, v7
    v_mad_u32_u24 v186, v6, s45, v186
    v_mov_b32 v90, 0
    s_movk_i32 s45, 19200

    buffer_load_dwordx3 v[188:190], v185, s[24:27], s45 offen
    buffer_load_short_d16_hi v90, v186, s[24:27], s45 offen offset:192
    buffer_load_dwordx4 v[192:195], v245, s[16:19], s74 offen
    buffer_load_dwordx2 v[196:197], v245, s[16:19], s74 offen offset:16
    buffer_load_dword v198, v246, s[16:19], s74 offen offset:384
    buffer_load_dwordx4 v[218:221], v245, s[16:19], s74 offen offset:400
    buffer_load_dwordx2 v[222:223], v245, s[16:19], s74 offen offset:416
    buffer_load_dwordx4 v[224:227], v245, s[16:19], s74 offen offset:800
    buffer_load_dwordx2 v[228:229], v245, s[16:19], s74 offen offset:816
    buffer_load_dwordx4 v[230:233], v245, s[16:19], s74 offen offset:1200
    buffer_load_dwordx2 v[234:235], v245, s[16:19], s74 offen offset:1216
    buffer_load_dwordx4 v[212:215], v245, s[16:19], s74 offen offset:1600
    buffer_load_dwordx2 v[216:217], v245, s[16:19], s74 offen offset:1616
    buffer_load_dword v236, v246, s[16:19], s74 offen offset:1984
    s_load_dword s24, s[60:61], 0
    s_load_dword s25, s[60:61], 16
    s_load_dword s26, s[60:61], 32
    s_load_dword s27, s[60:61], 48
    s_load_dword s28, s[10:11], 0
    s_load_dword s29, s[10:11], 16
    s_load_dword s30, s[10:11], 32
    s_load_dword s31, s[10:11], 48

    v_add_u32 v40, -1, v5
    v_cmp_gt_u32 s[46:47], 8, v40
    s_lshl_b32 s76, s36, 14
    s_add_u32 s76, s76, s72
    s_lshl_b32 s76, s76, 2
    s_add_u32 s76, s76, 29360128
    v_lshlrev_b32 v40, 4, v40
    v_lshrrev_b32 v41, 5, v255
    v_lshl_add_u32 v40, v41, 2, v40
    v_bfe_u32 v41, v255, 4, 1
    v_lshl_add_u32 v94, v41, 3, v40
    s_add_u32 s45, s3, 4
    s_mul_i32 s44, s45, 18432
    v_mul_u32_u24 v95, 144, v5
    v_lshl_add_u32 v95, v6, 4, v95
    v_add_u32 v95, s44, v95
    s_xor_b32 s44, s36, 1
    s_lshl_b32 s44, s44, 3
    s_add_u32 s44, s44, s45
    s_lshl_b32 s44, s44, 14
    s_add_u32 s44, s44, 15204352
    s_mov_b32 s64, 0x40000000
    v_add_u32 v184, 144144, v184
    s_movk_i32 s45, 4800
    v_mad_u32_u24 v184, v6, s45, v184
    v_mul_u32_u24 v186, 1200, v5
    v_add_u32 v186, 144144, v186
    v_mad_u32_u24 v185, v6, 48, v186
    v_lshl_add_u32 v186, v6, 1, v186
    v_and_b32 v244, 48, v255
    s_movk_i32 s57, 144
    v_cmp_eq_u32 s[60:61], 0, v8
    v_cmp_eq_u32 s[62:63], 1, v8
    v_cmp_eq_u32 s[66:67], 2, v8
    v_cmp_eq_u32 s[68:69], 3, v8
    s_mov_b32 s70, 0x00010001
    s_mov_b32 s71, 0x00010001

    s_lshr_b32 s79, s2, 1
    s_mul_i32 s77, s79, 102656
    s_lshl_b32 s85, s50, 11
    s_xor_b32 s78, s85, 2048
    s_add_u32 s78, s78, s77
    s_add_u32 s77, s77, s85
    s_and_b32 s79, s2, 1
    s_mul_i32 s79, s79, 1638400
    s_add_u32 s79, s79, 16777216
    s_lshl_b32 s85, s3, 13
    s_add_u32 s79, s79, s85
    s_xor_b32 s85, s3, 4
    s_lshl_b32 s85, s85, 10
    v_mov_b32 v0, 0
    v_mov_b32 v1, 0
    v_mov_b32 v2, 0
    v_mov_b32 v3, 0
    v_mov_b32 v4, 0
    v_mov_b32 v5, 0
    v_mov_b32 v6, 0
    v_mov_b32 v7, 0
    v_mov_b32 v8, 0
    v_mov_b32 v9, 0
    v_mov_b32 v10, 0
    v_mov_b32 v11, 0
    v_mov_b32 v12, 0
    v_mov_b32 v13, 0
    v_mov_b32 v14, 0
    v_mov_b32 v15, 0
    v_mov_b32 v16, 0
    v_mov_b32 v17, 0
    v_mov_b32 v18, 0
    v_mov_b32 v19, 0
    v_mov_b32 v20, 0
    v_mov_b32 v21, 0
    v_mov_b32 v22, 0
    v_mov_b32 v23, 0
    v_mov_b32 v24, 0
    v_mov_b32 v25, 0
    v_mov_b32 v26, 0
    v_mov_b32 v27, 0
    v_mov_b32 v28, 0
    v_mov_b32 v29, 0
    v_mov_b32 v30, 0
    v_mov_b32 v31, 0
    v_mov_b32 v32, 0
    v_mov_b32 v33, 0
    v_mov_b32 v34, 0
    v_mov_b32 v35, 0
    v_mov_b32 v36, 0
    v_mov_b32 v37, 0
    v_mov_b32 v38, 0
    v_mov_b32 v39, 0
    v_mov_b32 v40, 0
    v_mov_b32 v41, 0
    v_mov_b32 v42, 0
    v_mov_b32 v43, 0
    v_mov_b32 v44, 0
    v_mov_b32 v45, 0
    v_mov_b32 v46, 0
    v_mov_b32 v47, 0
    v_mov_b32 v48, 0
    v_mov_b32 v49, 0
    v_mov_b32 v50, 0
    v_mov_b32 v51, 0
    v_mov_b32 v52, 0
    v_mov_b32 v53, 0
    v_mov_b32 v54, 0
    v_mov_b32 v55, 0
    v_mov_b32 v56, 0
    v_mov_b32 v57, 0
    v_mov_b32 v58, 0
    v_mov_b32 v59, 0
    v_mov_b32 v60, 0
    v_mov_b32 v61, 0
    v_mov_b32 v62, 0
    v_mov_b32 v63, 0
    v_mov_b32 v64, 0
    v_mov_b32 v65, 0
    v_mov_b32 v66, 0
    v_mov_b32 v67, 0
    v_mov_b32 v68, 0
    v_mov_b32 v69, 0
    v_mov_b32 v70, 0
    v_mov_b32 v71, 0
    v_mov_b32 v72, 0
    v_mov_b32 v73, 0
    v_mov_b32 v74, 0
    v_mov_b32 v75, 0
    v_mov_b32 v76, 0
    v_mov_b32 v77, 0
    v_mov_b32 v78, 0
    v_mov_b32 v79, 0
    v_mov_b32 v80, 0
    v_mov_b32 v81, 0
    v_mov_b32 v82, 0
    v_mov_b32 v83, 0
    v_mov_b32 v84, 0
    v_mov_b32 v85, 0
    v_mov_b32 v86, 0
    v_mov_b32 v87, 0
    v_mov_b32 v88, 0
    v_mov_b32 v89, 0
    s_waitcnt vmcnt(14)
    s_barrier
    ds_read_b64 v[96:97], v185 offset:200
    ds_read_b64 v[98:99], v185 offset:208
    ds_read_b64 v[100:101], v185 offset:224
    ds_read_b64 v[102:103], v185 offset:232
    ds_read_b64 v[104:105], v185 offset:400
    ds_read_b64 v[106:107], v185 offset:408
    ds_read_b64 v[108:109], v185 offset:424
    ds_read_b64 v[110:111], v185 offset:432
    ds_read_b64 v[112:113], v185 offset:600
    ds_read_b64 v[114:115], v185 offset:608
    ds_read_b64 v[116:117], v185 offset:616
    ds_read_b64 v[118:119], v185 offset:624
    ds_read_b64 v[120:121], v185 offset:632
    ds_read_b64 v[122:123], v185 offset:640
    ds_read_b64 v[124:125], v185 offset:800
    ds_read_b64 v[126:127], v185 offset:808
    ds_read_b64 v[128:129], v185 offset:816
    ds_read_b64 v[130:131], v185 offset:824
    ds_read_b64 v[132:133], v185 offset:832
    ds_read_b64 v[134:135], v185 offset:840
    ds_read_b64 v[136:137], v185 offset:1000
    ds_read_b64 v[138:139], v185 offset:1008
    ds_read_b64 v[140:141], v185 offset:1016
    ds_read_b64 v[142:143], v185 offset:1024
    ds_read_b64 v[144:145], v185 offset:1032
    ds_read_b64 v[146:147], v185 offset:1040
    ds_read_u16_d16_hi v84, v186 offset:192
    ds_read_u16_d16_hi v85, v186 offset:392
    ds_read_u16_d16_hi v86, v186 offset:592
    ds_read_u16_d16_hi v87, v186 offset:792
    ds_read_u16_d16_hi v88, v186 offset:992
    ds_read_u16_d16_hi v89, v186 offset:1192
    ds_read_u16_d16_hi v4, v184 offset:2
    ds_read_u16_d16_hi v5, v184 offset:1202
    ds_read_u16_d16_hi v6, v184 offset:2402
    ds_read_u16_d16_hi v7, v184 offset:3602
    ds_read_u16_d16_hi v8, v184 offset:4
    ds_read_u16_d16_hi v9, v184 offset:1204
    ds_read_u16_d16_hi v10, v184 offset:2404
    ds_read_u16_d16_hi v11, v184 offset:3604
    ds_read_u16_d16_hi v12, v184 offset:6
    ds_read_u16_d16_hi v13, v184 offset:1206
    ds_read_u16_d16_hi v14, v184 offset:2406
    ds_read_u16_d16_hi v15, v184 offset:3606
    ds_read_u16_d16_hi v16, v184 offset:8
    ds_read_u16_d16_hi v17, v184 offset:1208
    ds_read_u16_d16_hi v18, v184 offset:2408
    ds_read_u16_d16_hi v19, v184 offset:3608
    ds_read_u16_d16_hi v20, v184 offset:10
    ds_read_u16_d16_hi v21, v184 offset:1210
    ds_read_u16_d16_hi v22, v184 offset:2410
    ds_read_u16_d16_hi v23, v184 offset:3610
    ds_read_u16_d16_hi v28, v184 offset:204
    ds_read_u16_d16_hi v29, v184 offset:1404
    ds_read_u16_d16_hi v30, v184 offset:2604
    ds_read_u16_d16_hi v31, v184 offset:3804
    ds_read_u16_d16_hi v32, v184 offset:206
    ds_read_u16_d16_hi v33, v184 offset:1406
    ds_read_u16_d16_hi v34, v184 offset:2606
    ds_read_u16_d16_hi v35, v184 offset:3806
    ds_read_u16_d16_hi v36, v184 offset:208
    ds_read_u16_d16_hi v37, v184 offset:1408
    ds_read_u16_d16_hi v38, v184 offset:2608
    ds_read_u16_d16_hi v39, v184 offset:3808
    ds_read_u16_d16_hi v40, v184 offset:210
    ds_read_u16_d16_hi v41, v184 offset:1410
    ds_read_u16_d16_hi v42, v184 offset:2610
    ds_read_u16_d16_hi v43, v184 offset:3810
    ds_read_u16_d16_hi v48, v184 offset:406
    ds_read_u16_d16_hi v49, v184 offset:1606
    ds_read_u16_d16_hi v50, v184 offset:2806
    ds_read_u16_d16_hi v51, v184 offset:4006
    ds_read_u16_d16_hi v52, v184 offset:408
    ds_read_u16_d16_hi v53, v184 offset:1608
    ds_read_u16_d16_hi v54, v184 offset:2808
    ds_read_u16_d16_hi v55, v184 offset:4008
    ds_read_u16_d16_hi v56, v184 offset:410
    ds_read_u16_d16_hi v57, v184 offset:1610
    ds_read_u16_d16_hi v58, v184 offset:2810
    ds_read_u16_d16_hi v59, v184 offset:4010
    ds_read_u16_d16_hi v64, v184 offset:608
    ds_read_u16_d16_hi v65, v184 offset:1808
    ds_read_u16_d16_hi v66, v184 offset:3008
    ds_read_u16_d16_hi v67, v184 offset:4208
    ds_read_u16_d16_hi v68, v184 offset:610
    ds_read_u16_d16_hi v69, v184 offset:1810
    ds_read_u16_d16_hi v70, v184 offset:3010
    ds_read_u16_d16_hi v71, v184 offset:4210
    ds_read_u16_d16_hi v76, v184 offset:810
    ds_read_u16_d16_hi v77, v184 offset:2010
    ds_read_u16_d16_hi v78, v184 offset:3210
    ds_read_u16_d16_hi v79, v184 offset:4410
    ds_read_u16_d16_hi v0, v184 offset:0
    ds_read_u16_d16_hi v1, v184 offset:1200
    ds_read_u16_d16_hi v2, v184 offset:2400
    ds_read_u16_d16_hi v3, v184 offset:3600
    ds_read_u16_d16_hi v24, v184 offset:202
    ds_read_u16_d16_hi v25, v184 offset:1402
    ds_read_u16_d16_hi v26, v184 offset:2602
    ds_read_u16_d16_hi v27, v184 offset:3802
    ds_read_u16_d16_hi v44, v184 offset:404
    ds_read_u16_d16_hi v45, v184 offset:1604
    ds_read_u16_d16_hi v46, v184 offset:2804
    ds_read_u16_d16_hi v47, v184 offset:4004
    ds_read_u16_d16_hi v60, v184 offset:606
    ds_read_u16_d16_hi v61, v184 offset:1806
    ds_read_u16_d16_hi v62, v184 offset:3006
    ds_read_u16_d16_hi v63, v184 offset:4206
    ds_read_u16_d16_hi v72, v184 offset:808
    ds_read_u16_d16_hi v73, v184 offset:2008
    ds_read_u16_d16_hi v74, v184 offset:3208
    ds_read_u16_d16_hi v75, v184 offset:4408
    ds_read_u16_d16_hi v80, v184 offset:1010
    ds_read_u16_d16_hi v81, v184 offset:2210
    ds_read_u16_d16_hi v82, v184 offset:3410
    ds_read_u16_d16_hi v83, v184 offset:4610
    s_waitcnt vmcnt(9) lgkmcnt(15)
    v_lshlrev_b32 v200, 16, v96
    v_add_f32 v4, v4, v200
    v_lshlrev_b32 v201, 16, v99
    v_add_f32 v5, v5, v201
    v_lshlrev_b32 v200, 16, v100
    v_add_f32 v6, v6, v200
    v_lshlrev_b32 v201, 16, v103
    v_add_f32 v7, v7, v201
    v_lshlrev_b32 v200, 16, v104
    v_add_f32 v8, v8, v200
    v_lshlrev_b32 v201, 16, v107
    v_add_f32 v9, v9, v201
    v_lshlrev_b32 v200, 16, v108
    v_add_f32 v10, v10, v200
    v_lshlrev_b32 v201, 16, v111
    v_add_f32 v11, v11, v201
    v_lshlrev_b32 v200, 16, v112
    v_add_f32 v12, v12, v200
    v_lshlrev_b32 v201, 16, v115
    v_add_f32 v13, v13, v201
    v_lshlrev_b32 v200, 16, v118
    v_add_f32 v14, v14, v200
    v_lshlrev_b32 v201, 16, v121
    v_add_f32 v15, v15, v201
    v_lshlrev_b32 v200, 16, v124
    v_add_f32 v16, v16, v200
    v_lshlrev_b32 v201, 16, v127
    v_add_f32 v17, v17, v201
    v_lshlrev_b32 v200, 16, v130
    v_add_f32 v18, v18, v200
    v_lshlrev_b32 v201, 16, v133
    v_add_f32 v19, v19, v201
    v_lshlrev_b32 v200, 16, v136
    v_add_f32 v20, v20, v200
    v_lshlrev_b32 v201, 16, v139
    v_add_f32 v21, v21, v201
    v_lshlrev_b32 v200, 16, v142
    v_add_f32 v22, v22, v200
    v_lshlrev_b32 v201, 16, v145
    v_add_f32 v23, v23, v201
    v_and_b32 v200, 0xffff0000, v104
    v_add_f32 v28, v28, v200
    v_and_b32 v201, 0xffff0000, v107
    v_add_f32 v29, v29, v201
    v_and_b32 v200, 0xffff0000, v108
    v_add_f32 v30, v30, v200
    v_and_b32 v201, 0xffff0000, v111
    v_add_f32 v31, v31, v201
    v_and_b32 v200, 0xffff0000, v112
    v_add_f32 v32, v32, v200
    v_and_b32 v201, 0xffff0000, v115
    v_add_f32 v33, v33, v201
    v_and_b32 v200, 0xffff0000, v118
    v_add_f32 v34, v34, v200
    v_and_b32 v201, 0xffff0000, v121
    v_add_f32 v35, v35, v201
    v_and_b32 v200, 0xffff0000, v124
    v_add_f32 v36, v36, v200
    v_and_b32 v201, 0xffff0000, v127
    v_add_f32 v37, v37, v201
    v_and_b32 v200, 0xffff0000, v130
    v_add_f32 v38, v38, v200
    v_and_b32 v201, 0xffff0000, v133
    v_add_f32 v39, v39, v201
    v_and_b32 v200, 0xffff0000, v136
    v_add_f32 v40, v40, v200
    v_and_b32 v201, 0xffff0000, v139
    v_add_f32 v41, v41, v201
    v_and_b32 v200, 0xffff0000, v142
    v_add_f32 v42, v42, v200
    v_and_b32 v201, 0xffff0000, v145
    v_add_f32 v43, v43, v201
    v_lshlrev_b32 v200, 16, v113
    v_add_f32 v48, v48, v200
    v_lshlrev_b32 v201, 16, v116
    v_add_f32 v49, v49, v201
    v_lshlrev_b32 v200, 16, v119
    v_add_f32 v50, v50, v200
    v_lshlrev_b32 v201, 16, v122
    v_add_f32 v51, v51, v201
    v_lshlrev_b32 v200, 16, v125
    v_add_f32 v52, v52, v200
    v_lshlrev_b32 v201, 16, v128
    v_add_f32 v53, v53, v201
    v_lshlrev_b32 v200, 16, v131
    v_add_f32 v54, v54, v200
    v_lshlrev_b32 v201, 16, v134
    v_add_f32 v55, v55, v201
    v_lshlrev_b32 v200, 16, v137
    v_add_f32 v56, v56, v200
    v_lshlrev_b32 v201, 16, v140
    v_add_f32 v57, v57, v201
    v_lshlrev_b32 v200, 16, v143
    v_add_f32 v58, v58, v200
    v_lshlrev_b32 v201, 16, v146
    v_add_f32 v59, v59, v201
    v_and_b32 v200, 0xffff0000, v125
    v_add_f32 v64, v64, v200
    v_and_b32 v201, 0xffff0000, v128
    v_add_f32 v65, v65, v201
    v_and_b32 v200, 0xffff0000, v131
    v_add_f32 v66, v66, v200
    v_and_b32 v201, 0xffff0000, v134
    v_add_f32 v67, v67, v201
    v_and_b32 v200, 0xffff0000, v137
    v_add_f32 v68, v68, v200
    v_and_b32 v201, 0xffff0000, v140
    v_add_f32 v69, v69, v201
    v_and_b32 v200, 0xffff0000, v143
    v_add_f32 v70, v70, v200
    v_and_b32 v201, 0xffff0000, v146
    v_add_f32 v71, v71, v201
    v_lshlrev_b32 v200, 16, v138
    v_add_f32 v76, v76, v200
    v_lshlrev_b32 v201, 16, v141
    v_add_f32 v77, v77, v201
    v_lshlrev_b32 v200, 16, v144
    v_add_f32 v78, v78, v200
    v_lshlrev_b32 v201, 16, v147
    v_add_f32 v79, v79, v201
    v_lshlrev_b32 v200, 16, v188
    v_add_f32 v84, v84, v200
    v_and_b32 v201, 0xffff0000, v188
    v_add_f32 v85, v85, v201
    v_lshlrev_b32 v200, 16, v189
    v_add_f32 v86, v86, v200
    v_and_b32 v201, 0xffff0000, v189
    v_add_f32 v87, v87, v201
    v_lshlrev_b32 v200, 16, v190
    v_add_f32 v88, v88, v200
    v_and_b32 v201, 0xffff0000, v190
    v_add_f32 v89, v89, v201
    v_mad_u32_u24 v192, v192, s57, v244
    v_mad_u32_u24 v193, v193, s57, v244
    v_mad_u32_u24 v194, v194, s57, v244
    v_mad_u32_u24 v195, v195, s57, v244
    v_mad_u32_u24 v196, v196, s57, v244
    v_mad_u32_u24 v197, v197, s57, v244
    v_mad_u32_u24 v198, v198, s57, v244
    v_cndmask_b32 v93, 0, v90, s[68:69]
    v_cndmask_b32 v92, 0, v90, s[66:67]
    v_cndmask_b32 v91, 0, v90, s[62:63]
    v_cndmask_b32 v90, 0, v90, s[60:61]
    s_waitcnt lgkmcnt(0)
    s_bitcmp1_b32 s2, 1
    s_cselect_b32 s83, 0, 16
    s_lshl_b32 s80, s24, s83
    s_lshl_b32 s81, s25, s83
    s_lshl_b32 s82, s26, s83
    s_lshl_b32 s83, s27, s83
    s_and_b32 s80, s80, 0xffff0000
    s_and_b32 s81, s81, 0xffff0000
    s_and_b32 s82, s82, 0xffff0000
    s_and_b32 s83, s83, 0xffff0000
    s_barrier
    s_setprio 0
    ds_read_b128 v[96:99], v192 offset:0
    ds_read_b128 v[100:103], v192 offset:64
    ds_read_b128 v[104:107], v193 offset:0
    ds_read_b128 v[108:111], v193 offset:64
    ds_read_b128 v[112:115], v194 offset:0
    ds_read_b128 v[116:119], v194 offset:64
    ds_read_b128 v[128:131], v195 offset:0
    ds_read_b128 v[132:135], v195 offset:64
    ds_read_b128 v[144:147], v196 offset:0
    ds_read_b128 v[148:151], v196 offset:64
    ds_read_b128 v[160:163], v197 offset:0
    ds_read_b128 v[164:167], v197 offset:64
    ds_read_b128 v[176:179], v198 offset:0
    ds_read_b128 v[180:183], v198 offset:64
    s_waitcnt vmcnt(7) lgkmcnt(0)
standalone__deep_cross_pnn__recsys_kernel_loop:
    v_mfma_f32_16x16x32_bf16 v[184:187], v[96:99], v[96:99], 0
    v_fmac_f32 v240, v188, v64
    v_fmac_f32 v240, v189, v65
    v_mfma_f32_16x16x32_bf16 v[184:187], v[100:103], v[100:103], v[184:187]
    v_fmac_f32 v240, v190, v66
    v_fmac_f32 v240, v191, v67
    v_mfma_f32_16x16x32_bf16 v[188:191], v[96:99], v[104:107], 0
    v_fmac_f32 v240, v192, v68
    v_fmac_f32 v240, v193, v69
    v_fmac_f32 v240, v194, v70
    v_fmac_f32 v240, v195, v71
    v_mad_u32_u24 v220, v220, s57, v244
    v_mfma_f32_16x16x32_bf16 v[188:191], v[100:103], v[108:111], v[188:191]
    ds_read_b128 v[120:123], v220 offset:0
    ds_read_b128 v[124:127], v220 offset:64
    v_mfma_f32_16x16x32_bf16 v[192:195], v[96:99], v[112:115], 0
    v_fmac_f32 v240, v196, v72
    v_fmac_f32 v240, v197, v73
    v_mfma_f32_16x16x32_bf16 v[192:195], v[100:103], v[116:119], v[192:195]
    v_fmac_f32 v240, v198, v74
    v_fmac_f32 v240, v199, v75
    v_mfma_f32_16x16x32_bf16 v[196:199], v[176:179], v[96:99], 0
    v_fmac_f32 v240, v200, v76
    v_fmac_f32 v240, v201, v77
    v_mfma_f32_16x16x32_bf16 v[196:199], v[180:183], v[100:103], v[196:199]
    v_fmac_f32 v240, v202, v78
    v_fmac_f32 v240, v203, v79
    v_mad_u32_u24 v221, v221, s57, v244
    v_mfma_f32_16x16x32_bf16 v[200:203], v[96:99], v[128:131], 0
    ds_read_b128 v[136:139], v221 offset:0
    ds_read_b128 v[140:143], v221 offset:64
    v_mfma_f32_16x16x32_bf16 v[200:203], v[100:103], v[132:135], v[200:203]
    v_fmac_f32 v240, v204, v80
    v_fmac_f32 v240, v205, v81
    v_fmac_f32 v240, v206, v82
    v_fmac_f32 v240, v207, v83
    v_mfma_f32_16x16x32_bf16 v[204:207], v[96:99], v[144:147], 0
    v_mad_u32_u24 v218, v218, s57, v244
    v_mul_f32 v237, v184, v0
    v_mfma_f32_16x16x32_bf16 v[204:207], v[100:103], v[148:151], v[204:207]
    v_fmac_f32 v237, v185, v1
    v_fmac_f32 v237, v186, v2
    v_mfma_f32_16x16x32_bf16 v[208:211], v[96:99], v[160:163], 0
    v_fmac_f32 v237, v187, v3
    v_fmac_f32 v237, v188, v4
    v_mfma_f32_16x16x32_bf16 v[208:211], v[100:103], v[164:167], v[208:211]
    ds_read_b128 v[96:99], v218 offset:0
    ds_read_b128 v[100:103], v218 offset:64
    v_mfma_f32_16x16x32_bf16 v[184:187], v[104:107], v[104:107], 0
    v_fmac_f32 v237, v189, v5
    v_fmac_f32 v237, v190, v6
    v_mfma_f32_16x16x32_bf16 v[184:187], v[108:111], v[108:111], v[184:187]
    v_fmac_f32 v237, v191, v7
    v_fmac_f32 v237, v192, v8
    v_mfma_f32_16x16x32_bf16 v[188:191], v[104:107], v[112:115], 0
    v_fmac_f32 v237, v193, v9
    v_fmac_f32 v237, v194, v10
    v_mfma_f32_16x16x32_bf16 v[188:191], v[108:111], v[116:119], v[188:191]
    v_fmac_f32 v237, v195, v11
    v_mad_u32_u24 v222, v222, s57, v244
    v_mfma_f32_16x16x32_bf16 v[192:195], v[176:179], v[104:107], 0
    v_fmac_f32 v237, v196, v84
    v_fmac_f32 v237, v200, v12
    v_mfma_f32_16x16x32_bf16 v[192:195], v[180:183], v[108:111], v[192:195]
    ds_read_b128 v[152:155], v222 offset:0
    ds_read_b128 v[156:159], v222 offset:64
    v_mfma_f32_16x16x32_bf16 v[196:199], v[104:107], v[128:131], 0
    v_fmac_f32 v237, v201, v13
    v_fmac_f32 v237, v202, v14
    v_mfma_f32_16x16x32_bf16 v[196:199], v[108:111], v[132:135], v[196:199]
    v_fmac_f32 v237, v203, v15
    v_fmac_f32 v237, v204, v16
    v_mfma_f32_16x16x32_bf16 v[200:203], v[104:107], v[144:147], 0
    v_fmac_f32 v237, v205, v17
    v_fmac_f32 v237, v206, v18
    v_mfma_f32_16x16x32_bf16 v[200:203], v[108:111], v[148:151], v[200:203]
    v_fmac_f32 v237, v207, v19
    v_mad_u32_u24 v219, v219, s57, v244
    v_mfma_f32_16x16x32_bf16 v[204:207], v[104:107], v[160:163], 0
    v_fmac_f32 v237, v208, v20
    v_fmac_f32 v237, v209, v21
    v_fmac_f32 v237, v210, v22
    v_fmac_f32 v237, v211, v23
    v_mfma_f32_16x16x32_bf16 v[204:207], v[108:111], v[164:167], v[204:207]
    ds_read_b128 v[104:107], v219 offset:0
    ds_read_b128 v[108:111], v219 offset:64
    v_mfma_f32_16x16x32_bf16 v[208:211], v[112:115], v[112:115], 0
    v_fmac_f32 v237, v184, v24
    v_fmac_f32 v237, v185, v25
    v_mfma_f32_16x16x32_bf16 v[208:211], v[116:119], v[116:119], v[208:211]
    v_fmac_f32 v237, v186, v26
    v_fmac_f32 v237, v187, v27
    v_mfma_f32_16x16x32_bf16 v[184:187], v[176:179], v[112:115], 0
    v_fmac_f32 v237, v188, v28
    v_fmac_f32 v237, v189, v29
    v_mfma_f32_16x16x32_bf16 v[184:187], v[180:183], v[116:119], v[184:187]
    v_fmac_f32 v237, v190, v30
    v_fmac_f32 v237, v191, v31
    v_mfma_f32_16x16x32_bf16 v[188:191], v[112:115], v[128:131], 0
    v_permlane32_swap_b32 v239, v240
    v_mad_u32_u24 v223, v223, s57, v244
    v_fmac_f32 v237, v192, v85
    v_mfma_f32_16x16x32_bf16 v[188:191], v[116:119], v[132:135], v[188:191]
    ds_read_b128 v[168:171], v223 offset:0
    ds_read_b128 v[172:175], v223 offset:64
    v_mfma_f32_16x16x32_bf16 v[192:195], v[112:115], v[144:147], 0
    v_add_f32 v242, v239, v240
    v_fmac_f32 v237, v196, v32
    v_fmac_f32 v237, v197, v33
    v_fmac_f32 v237, v198, v34
    v_fmac_f32 v237, v199, v35
    v_mfma_f32_16x16x32_bf16 v[192:195], v[116:119], v[148:151], v[192:195]
    buffer_load_dwordx4 v[218:221], v245, s[16:19], s74 offen offset:2000
    buffer_load_dwordx2 v[222:223], v245, s[16:19], s74 offen offset:2016
    v_mfma_f32_16x16x32_bf16 v[196:199], v[176:179], v[128:131], 0
    v_permlane16_swap_b32 v241, v242
    v_mfma_f32_16x16x32_bf16 v[196:199], v[180:183], v[132:135], v[196:199]
    v_fmac_f32 v237, v200, v36
    v_fmac_f32 v237, v201, v37
    v_fmac_f32 v237, v202, v38
    v_fmac_f32 v237, v203, v39
    v_mfma_f32_16x16x32_bf16 v[200:203], v[112:115], v[160:163], 0
    v_add_f32 v241, v241, v242
    v_fmac_f32 v237, v204, v40
    v_mfma_f32_16x16x32_bf16 v[200:203], v[116:119], v[164:167], v[200:203]
    v_fmac_f32 v237, v205, v41
    v_fmac_f32 v237, v206, v42
    v_fmac_f32 v237, v207, v43
    v_mfma_f32_16x16x32_bf16 v[204:207], v[128:131], v[128:131], 0
    v_add_f32_dpp v241, v241, v241 row_ror:8 row_mask:0xf bank_mask:0xf
    v_fmac_f32 v237, v208, v44
    v_mfma_f32_16x16x32_bf16 v[204:207], v[132:135], v[132:135], v[204:207]
    v_fmac_f32 v237, v209, v45
    v_fmac_f32 v237, v210, v46
    v_fmac_f32 v237, v211, v47
    v_mfma_f32_16x16x32_bf16 v[208:211], v[176:179], v[144:147], 0
    v_add_f32_dpp v241, v241, v241 row_ror:4 row_mask:0xf bank_mask:0xf
    v_fmac_f32 v237, v184, v86
    v_mfma_f32_16x16x32_bf16 v[208:211], v[180:183], v[148:151], v[208:211]
    v_fmac_f32 v237, v188, v48
    v_fmac_f32 v237, v189, v49
    v_mfma_f32_16x16x32_bf16 v[184:187], v[128:131], v[144:147], 0
    v_add_f32_dpp v241, v241, v241 row_ror:2 row_mask:0xf bank_mask:0xf
    v_fmac_f32 v237, v190, v50
    v_mfma_f32_16x16x32_bf16 v[184:187], v[132:135], v[148:151], v[184:187]
    v_fmac_f32 v237, v191, v51
    v_fmac_f32 v237, v192, v52
    v_mfma_f32_16x16x32_bf16 v[188:191], v[128:131], v[160:163], 0
    v_add_f32_dpp v241, v241, v241 row_ror:1 row_mask:0xf bank_mask:0xf
    v_fmac_f32 v237, v193, v53
    v_mfma_f32_16x16x32_bf16 v[188:191], v[132:135], v[164:167], v[188:191]
    v_fmac_f32 v237, v194, v54
    v_fmac_f32 v237, v195, v55
    v_mfma_f32_16x16x32_bf16 v[192:195], v[176:179], v[160:163], 0
    v_cndmask_b32 v243, v243, v241, s[70:71]
    v_fmac_f32 v237, v196, v87
    v_mfma_f32_16x16x32_bf16 v[192:195], v[180:183], v[164:167], v[192:195]
    s_lshl_b64 s[70:71], s[70:71], 1
    v_fmac_f32 v237, v200, v56
    v_mfma_f32_16x16x32_bf16 v[196:199], v[144:147], v[144:147], 0
    v_fmac_f32 v237, v201, v57
    v_fmac_f32 v237, v202, v58
    v_mfma_f32_16x16x32_bf16 v[196:199], v[148:151], v[148:151], v[196:199]
    v_fmac_f32 v237, v203, v59
    v_fmac_f32 v237, v204, v60
    v_mfma_f32_16x16x32_bf16 v[200:203], v[144:147], v[160:163], 0
    v_fmac_f32 v237, v205, v61
    v_fmac_f32 v237, v206, v62
    v_mfma_f32_16x16x32_bf16 v[200:203], v[148:151], v[164:167], v[200:203]
    v_fmac_f32 v237, v207, v63
    v_fmac_f32 v237, v208, v88
    v_mfma_f32_16x16x32_bf16 v[204:207], v[160:163], v[160:163], 0
    v_fmac_f32 v237, v184, v64
    v_fmac_f32 v237, v185, v65
    v_mfma_f32_16x16x32_bf16 v[204:207], v[164:167], v[164:167], v[204:207]
    v_fmac_f32 v237, v186, v66
    s_waitcnt vmcnt(7) lgkmcnt(0)
    v_mfma_f32_16x16x32_bf16 v[208:211], v[96:99], v[96:99], 0
    v_fmac_f32 v237, v187, v67
    v_mad_u32_u24 v226, v226, s57, v244
    v_mfma_f32_16x16x32_bf16 v[208:211], v[100:103], v[100:103], v[208:211]
    v_fmac_f32 v237, v188, v68
    v_fmac_f32 v237, v189, v69
    v_mfma_f32_16x16x32_bf16 v[184:187], v[96:99], v[104:107], 0
    v_fmac_f32 v237, v190, v70
    v_fmac_f32 v237, v191, v71
    v_mfma_f32_16x16x32_bf16 v[184:187], v[100:103], v[108:111], v[184:187]
    ds_read_b128 v[112:115], v226 offset:0
    ds_read_b128 v[116:119], v226 offset:64
    v_mfma_f32_16x16x32_bf16 v[188:191], v[96:99], v[120:123], 0
    v_fmac_f32 v237, v192, v89
    v_mad_u32_u24 v227, v227, s57, v244
    v_mfma_f32_16x16x32_bf16 v[188:191], v[100:103], v[124:127], v[188:191]
    v_fmac_f32 v237, v196, v72
    v_fmac_f32 v237, v197, v73
    v_mfma_f32_16x16x32_bf16 v[192:195], v[176:179], v[96:99], 0
    v_fmac_f32 v237, v198, v74
    v_fmac_f32 v237, v199, v75
    v_mfma_f32_16x16x32_bf16 v[192:195], v[180:183], v[100:103], v[192:195]
    v_fmac_f32 v237, v200, v76
    v_fmac_f32 v237, v201, v77
    v_mfma_f32_16x16x32_bf16 v[196:199], v[96:99], v[136:139], 0
    ds_read_b128 v[128:131], v227 offset:0
    ds_read_b128 v[132:135], v227 offset:64
    v_mfma_f32_16x16x32_bf16 v[196:199], v[100:103], v[140:143], v[196:199]
    v_fmac_f32 v237, v202, v78
    v_fmac_f32 v237, v203, v79
    v_mfma_f32_16x16x32_bf16 v[200:203], v[96:99], v[152:155], 0
    v_fmac_f32 v237, v204, v80
    v_fmac_f32 v237, v205, v81
    v_mfma_f32_16x16x32_bf16 v[200:203], v[100:103], v[156:159], v[200:203]
    v_fmac_f32 v237, v206, v82
    v_fmac_f32 v237, v207, v83
    v_mfma_f32_16x16x32_bf16 v[204:207], v[96:99], v[168:171], 0
    v_mad_u32_u24 v224, v224, s57, v244
    v_mul_f32 v238, v208, v0
    v_fmac_f32 v238, v209, v1
    v_fmac_f32 v238, v210, v2
    v_fmac_f32 v238, v211, v3
    v_mfma_f32_16x16x32_bf16 v[204:207], v[100:103], v[172:175], v[204:207]
    ds_read_b128 v[96:99], v224 offset:0
    ds_read_b128 v[100:103], v224 offset:64
    v_mfma_f32_16x16x32_bf16 v[208:211], v[104:107], v[104:107], 0
    v_fmac_f32 v238, v184, v4
    v_fmac_f32 v238, v185, v5
    v_mfma_f32_16x16x32_bf16 v[208:211], v[108:111], v[108:111], v[208:211]
    v_fmac_f32 v238, v186, v6
    v_fmac_f32 v238, v187, v7
    v_mfma_f32_16x16x32_bf16 v[184:187], v[104:107], v[120:123], 0
    v_fmac_f32 v238, v188, v8
    v_fmac_f32 v238, v189, v9
    v_mfma_f32_16x16x32_bf16 v[184:187], v[108:111], v[124:127], v[184:187]
    v_fmac_f32 v238, v190, v10
    v_fmac_f32 v238, v191, v11
    v_mfma_f32_16x16x32_bf16 v[188:191], v[176:179], v[104:107], 0
    v_mad_u32_u24 v228, v228, s57, v244
    v_fmac_f32 v238, v193, v84
    v_mfma_f32_16x16x32_bf16 v[188:191], v[180:183], v[108:111], v[188:191]
    ds_read_b128 v[144:147], v228 offset:0
    ds_read_b128 v[148:151], v228 offset:64
    v_mfma_f32_16x16x32_bf16 v[192:195], v[104:107], v[136:139], 0
    v_fmac_f32 v238, v196, v12
    v_fmac_f32 v238, v197, v13
    v_mfma_f32_16x16x32_bf16 v[192:195], v[108:111], v[140:143], v[192:195]
    v_fmac_f32 v238, v198, v14
    v_fmac_f32 v238, v199, v15
    v_mfma_f32_16x16x32_bf16 v[196:199], v[104:107], v[152:155], 0
    v_fmac_f32 v238, v200, v16
    v_fmac_f32 v238, v201, v17
    v_mfma_f32_16x16x32_bf16 v[196:199], v[108:111], v[156:159], v[196:199]
    v_fmac_f32 v238, v202, v18
    v_fmac_f32 v238, v203, v19
    v_mfma_f32_16x16x32_bf16 v[200:203], v[104:107], v[168:171], 0
    v_mad_u32_u24 v225, v225, s57, v244
    v_fmac_f32 v238, v204, v20
    v_fmac_f32 v238, v205, v21
    v_fmac_f32 v238, v206, v22
    v_fmac_f32 v238, v207, v23
    v_mfma_f32_16x16x32_bf16 v[200:203], v[108:111], v[172:175], v[200:203]
    ds_read_b128 v[104:107], v225 offset:0
    ds_read_b128 v[108:111], v225 offset:64
    v_mfma_f32_16x16x32_bf16 v[204:207], v[120:123], v[120:123], 0
    v_fmac_f32 v238, v208, v24
    v_fmac_f32 v238, v209, v25
    v_mfma_f32_16x16x32_bf16 v[204:207], v[124:127], v[124:127], v[204:207]
    v_fmac_f32 v238, v210, v26
    v_fmac_f32 v238, v211, v27
    v_fmac_f32 v238, v184, v28
    v_fmac_f32 v238, v185, v29
    v_fmac_f32 v238, v186, v30
    v_fmac_f32 v238, v187, v31
    v_mfma_f32_16x16x32_bf16 v[184:187], v[176:179], v[120:123], 0
    v_fmac_f32 v238, v189, v85
    v_mad_u32_u24 v229, v229, s57, v244
    v_mfma_f32_16x16x32_bf16 v[184:187], v[180:183], v[124:127], v[184:187]
    v_fmac_f32 v238, v192, v32
    v_fmac_f32 v238, v193, v33
    v_mfma_f32_16x16x32_bf16 v[188:191], v[120:123], v[136:139], 0
    v_fmac_f32 v238, v194, v34
    v_fmac_f32 v238, v195, v35
    v_mfma_f32_16x16x32_bf16 v[188:191], v[124:127], v[140:143], v[188:191]
    ds_read_b128 v[160:163], v229 offset:0
    ds_read_b128 v[164:167], v229 offset:64
    v_mfma_f32_16x16x32_bf16 v[192:195], v[120:123], v[152:155], 0
    v_fmac_f32 v238, v196, v36
    v_fmac_f32 v238, v197, v37
    v_fmac_f32 v238, v198, v38
    v_fmac_f32 v238, v199, v39
    v_mfma_f32_16x16x32_bf16 v[192:195], v[124:127], v[156:159], v[192:195]
    buffer_load_dwordx4 v[224:227], v245, s[16:19], s74 offen offset:2400
    buffer_load_dwordx2 v[228:229], v245, s[16:19], s74 offen offset:2416
    v_mfma_f32_16x16x32_bf16 v[196:199], v[176:179], v[136:139], 0
    v_fmac_f32 v238, v200, v40
    v_fmac_f32 v238, v201, v41
    v_mfma_f32_16x16x32_bf16 v[196:199], v[180:183], v[140:143], v[196:199]
    v_fmac_f32 v238, v202, v42
    v_fmac_f32 v238, v203, v43
    v_mfma_f32_16x16x32_bf16 v[200:203], v[120:123], v[168:171], 0
    v_fmac_f32 v238, v204, v44
    v_fmac_f32 v238, v205, v45
    v_mfma_f32_16x16x32_bf16 v[200:203], v[124:127], v[172:175], v[200:203]
    v_fmac_f32 v238, v206, v46
    v_fmac_f32 v238, v207, v47
    v_mfma_f32_16x16x32_bf16 v[204:207], v[136:139], v[136:139], 0
    v_fmac_f32 v238, v185, v86
    v_fmac_f32 v238, v188, v48
    v_mfma_f32_16x16x32_bf16 v[204:207], v[140:143], v[140:143], v[204:207]
    v_fmac_f32 v238, v189, v49
    v_fmac_f32 v238, v190, v50
    v_mfma_f32_16x16x32_bf16 v[208:211], v[176:179], v[176:179], 0
    v_fmac_f32 v238, v191, v51
    v_fmac_f32 v238, v192, v52
    v_mfma_f32_16x16x32_bf16 v[208:211], v[180:183], v[180:183], v[208:211]
    v_fmac_f32 v238, v193, v53
    v_fmac_f32 v238, v194, v54
    v_mfma_f32_16x16x32_bf16 v[184:187], v[176:179], v[152:155], 0
    v_fmac_f32 v238, v195, v55
    v_fmac_f32 v238, v197, v87
    v_mfma_f32_16x16x32_bf16 v[184:187], v[180:183], v[156:159], v[184:187]
    v_fmac_f32 v238, v200, v56
    v_fmac_f32 v238, v201, v57
    v_mfma_f32_16x16x32_bf16 v[188:191], v[136:139], v[152:155], 0
    v_fmac_f32 v238, v202, v58
    v_fmac_f32 v238, v203, v59
    v_mfma_f32_16x16x32_bf16 v[188:191], v[140:143], v[156:159], v[188:191]
    v_fmac_f32 v238, v204, v60
    v_fmac_f32 v238, v205, v61
    v_mfma_f32_16x16x32_bf16 v[192:195], v[136:139], v[168:171], 0
    v_fmac_f32 v238, v206, v62
    v_fmac_f32 v238, v207, v63
    v_mfma_f32_16x16x32_bf16 v[192:195], v[140:143], v[172:175], v[192:195]
    v_fmac_f32 v237, v208, v90
    v_fmac_f32 v238, v209, v91
    v_mfma_f32_16x16x32_bf16 v[196:199], v[176:179], v[168:171], 0
    v_mul_f32 v239, v210, v92
    v_mul_f32 v240, v211, v93
    v_mfma_f32_16x16x32_bf16 v[196:199], v[180:183], v[172:175], v[196:199]
    v_fmac_f32 v238, v185, v88
    v_fmac_f32 v238, v188, v64
    v_mfma_f32_16x16x32_bf16 v[200:203], v[152:155], v[152:155], 0
    v_fmac_f32 v238, v189, v65
    v_fmac_f32 v238, v190, v66
    v_mfma_f32_16x16x32_bf16 v[200:203], v[156:159], v[156:159], v[200:203]
    v_fmac_f32 v238, v191, v67
    v_fmac_f32 v238, v192, v68
    v_mfma_f32_16x16x32_bf16 v[204:207], v[152:155], v[168:171], 0
    v_fmac_f32 v238, v193, v69
    v_fmac_f32 v238, v194, v70
    v_mfma_f32_16x16x32_bf16 v[204:207], v[156:159], v[172:175], v[204:207]
    v_fmac_f32 v238, v195, v71
    v_fmac_f32 v238, v197, v89
    v_mfma_f32_16x16x32_bf16 v[208:211], v[168:171], v[168:171], 0
    v_fmac_f32 v238, v200, v72
    v_fmac_f32 v238, v201, v73
    v_mfma_f32_16x16x32_bf16 v[208:211], v[172:175], v[172:175], v[208:211]
    v_fmac_f32 v238, v202, v74
    s_waitcnt vmcnt(7) lgkmcnt(0)
    v_mfma_f32_16x16x32_bf16 v[184:187], v[96:99], v[96:99], 0
    v_mad_u32_u24 v232, v232, s57, v244
    v_mad_u32_u24 v233, v233, s57, v244
    v_mfma_f32_16x16x32_bf16 v[184:187], v[100:103], v[100:103], v[184:187]
    v_fmac_f32 v238, v203, v75
    v_fmac_f32 v238, v204, v76
    v_mfma_f32_16x16x32_bf16 v[188:191], v[96:99], v[104:107], 0
    v_fmac_f32 v238, v205, v77
    v_fmac_f32 v238, v206, v78
    v_mfma_f32_16x16x32_bf16 v[188:191], v[100:103], v[108:111], v[188:191]
    ds_read_b128 v[120:123], v232 offset:0
    ds_read_b128 v[124:127], v232 offset:64
    v_mfma_f32_16x16x32_bf16 v[192:195], v[96:99], v[112:115], 0
    v_fmac_f32 v238, v207, v79
    v_fmac_f32 v238, v208, v80
    v_mfma_f32_16x16x32_bf16 v[192:195], v[100:103], v[116:119], v[192:195]
    v_fmac_f32 v238, v209, v81
    v_fmac_f32 v238, v210, v82
    v_mfma_f32_16x16x32_bf16 v[196:199], v[176:179], v[96:99], 0
    v_fmac_f32 v238, v211, v83
    v_mad_u32_u24 v230, v230, s57, v244
    v_mfma_f32_16x16x32_bf16 v[196:199], v[180:183], v[100:103], v[196:199]
    v_fmac_f32 v239, v184, v0
    v_fmac_f32 v239, v185, v1
    v_mfma_f32_16x16x32_bf16 v[200:203], v[96:99], v[128:131], 0
    ds_read_b128 v[136:139], v233 offset:0
    ds_read_b128 v[140:143], v233 offset:64
    v_mfma_f32_16x16x32_bf16 v[200:203], v[100:103], v[132:135], v[200:203]
    v_fmac_f32 v239, v186, v2
    v_fmac_f32 v239, v187, v3
    v_mfma_f32_16x16x32_bf16 v[204:207], v[96:99], v[144:147], 0
    v_fmac_f32 v239, v188, v4
    v_fmac_f32 v239, v189, v5
    v_mfma_f32_16x16x32_bf16 v[204:207], v[100:103], v[148:151], v[204:207]
    v_fmac_f32 v239, v190, v6
    v_fmac_f32 v239, v191, v7
    v_mfma_f32_16x16x32_bf16 v[208:211], v[96:99], v[160:163], 0
    v_fmac_f32 v239, v192, v8
    v_fmac_f32 v239, v193, v9
    v_mfma_f32_16x16x32_bf16 v[208:211], v[100:103], v[164:167], v[208:211]
    ds_read_b128 v[96:99], v230 offset:0
    ds_read_b128 v[100:103], v230 offset:64
    v_mfma_f32_16x16x32_bf16 v[184:187], v[104:107], v[104:107], 0
    v_fmac_f32 v239, v194, v10
    v_fmac_f32 v239, v195, v11
    v_mfma_f32_16x16x32_bf16 v[184:187], v[108:111], v[108:111], v[184:187]
    v_mad_u32_u24 v234, v234, s57, v244
    v_fmac_f32 v239, v198, v84
    v_mfma_f32_16x16x32_bf16 v[188:191], v[104:107], v[112:115], 0
    v_fmac_f32 v239, v200, v12
    v_fmac_f32 v239, v201, v13
    v_mfma_f32_16x16x32_bf16 v[188:191], v[108:111], v[116:119], v[188:191]
    v_fmac_f32 v239, v202, v14
    v_fmac_f32 v239, v203, v15
    v_mfma_f32_16x16x32_bf16 v[192:195], v[176:179], v[104:107], 0
    v_fmac_f32 v239, v204, v16
    v_fmac_f32 v239, v205, v17
    v_mfma_f32_16x16x32_bf16 v[192:195], v[180:183], v[108:111], v[192:195]
    ds_read_b128 v[152:155], v234 offset:0
    ds_read_b128 v[156:159], v234 offset:64
    v_mfma_f32_16x16x32_bf16 v[196:199], v[104:107], v[128:131], 0
    v_fmac_f32 v239, v206, v18
    v_fmac_f32 v239, v207, v19
    v_mfma_f32_16x16x32_bf16 v[196:199], v[108:111], v[132:135], v[196:199]
    v_mad_u32_u24 v231, v231, s57, v244
    v_fmac_f32 v239, v208, v20
    v_mfma_f32_16x16x32_bf16 v[200:203], v[104:107], v[144:147], 0
    v_fmac_f32 v239, v209, v21
    v_fmac_f32 v239, v210, v22
    v_mfma_f32_16x16x32_bf16 v[200:203], v[108:111], v[148:151], v[200:203]
    v_fmac_f32 v239, v211, v23
    v_fmac_f32 v239, v184, v24
    v_mfma_f32_16x16x32_bf16 v[204:207], v[104:107], v[160:163], 0
    v_fmac_f32 v239, v185, v25
    v_fmac_f32 v239, v186, v26
    v_mfma_f32_16x16x32_bf16 v[204:207], v[108:111], v[164:167], v[204:207]
    ds_read_b128 v[104:107], v231 offset:0
    ds_read_b128 v[108:111], v231 offset:64
    v_mfma_f32_16x16x32_bf16 v[208:211], v[112:115], v[112:115], 0
    v_fmac_f32 v239, v187, v27
    v_fmac_f32 v239, v188, v28
    v_mfma_f32_16x16x32_bf16 v[208:211], v[116:119], v[116:119], v[208:211]
    v_fmac_f32 v239, v189, v29
    v_fmac_f32 v239, v190, v30
    v_mfma_f32_16x16x32_bf16 v[184:187], v[176:179], v[112:115], 0
    v_fmac_f32 v239, v191, v31
    v_mad_u32_u24 v235, v235, s57, v244
    v_mfma_f32_16x16x32_bf16 v[184:187], v[180:183], v[116:119], v[184:187]
    v_fmac_f32 v239, v194, v85
    v_fmac_f32 v239, v196, v32
    v_mfma_f32_16x16x32_bf16 v[188:191], v[112:115], v[128:131], 0
    v_fmac_f32 v239, v197, v33
    v_fmac_f32 v239, v198, v34
    v_mfma_f32_16x16x32_bf16 v[188:191], v[116:119], v[132:135], v[188:191]
    ds_read_b128 v[168:171], v235 offset:0
    ds_read_b128 v[172:175], v235 offset:64
    v_mfma_f32_16x16x32_bf16 v[192:195], v[112:115], v[144:147], 0
    v_fmac_f32 v239, v199, v35
    v_fmac_f32 v239, v200, v36
    v_mfma_f32_16x16x32_bf16 v[192:195], v[116:119], v[148:151], v[192:195]
    buffer_load_dwordx4 v[230:233], v245, s[16:19], s74 offen offset:2800
    buffer_load_dwordx2 v[234:235], v245, s[16:19], s74 offen offset:2816
    v_mfma_f32_16x16x32_bf16 v[196:199], v[176:179], v[128:131], 0
    v_fmac_f32 v239, v201, v37
    v_fmac_f32 v239, v202, v38
    v_mfma_f32_16x16x32_bf16 v[196:199], v[180:183], v[132:135], v[196:199]
    v_fmac_f32 v239, v203, v39
    v_fmac_f32 v239, v204, v40
    v_mfma_f32_16x16x32_bf16 v[200:203], v[112:115], v[160:163], 0
    v_fmac_f32 v239, v205, v41
    v_fmac_f32 v239, v206, v42
    v_mfma_f32_16x16x32_bf16 v[200:203], v[116:119], v[164:167], v[200:203]
    v_fmac_f32 v239, v207, v43
    v_fmac_f32 v239, v208, v44
    v_mfma_f32_16x16x32_bf16 v[204:207], v[128:131], v[128:131], 0
    v_fmac_f32 v239, v209, v45
    v_fmac_f32 v239, v210, v46
    v_mfma_f32_16x16x32_bf16 v[204:207], v[132:135], v[132:135], v[204:207]
    v_fmac_f32 v239, v211, v47
    v_fmac_f32 v239, v186, v86
    v_mfma_f32_16x16x32_bf16 v[184:187], v[176:179], v[144:147], 0
    v_fmac_f32 v239, v188, v48
    v_fmac_f32 v239, v189, v49
    v_mfma_f32_16x16x32_bf16 v[184:187], v[180:183], v[148:151], v[184:187]
    v_fmac_f32 v239, v190, v50
    v_fmac_f32 v239, v191, v51
    v_mfma_f32_16x16x32_bf16 v[188:191], v[128:131], v[144:147], 0
    v_fmac_f32 v239, v192, v52
    v_fmac_f32 v239, v193, v53
    v_mfma_f32_16x16x32_bf16 v[188:191], v[132:135], v[148:151], v[188:191]
    v_fmac_f32 v239, v194, v54
    v_fmac_f32 v239, v195, v55
    v_mfma_f32_16x16x32_bf16 v[192:195], v[128:131], v[160:163], 0
    v_fmac_f32 v239, v198, v87
    v_fmac_f32 v239, v200, v56
    v_mfma_f32_16x16x32_bf16 v[192:195], v[132:135], v[164:167], v[192:195]
    v_fmac_f32 v239, v201, v57
    v_fmac_f32 v239, v202, v58
    v_mfma_f32_16x16x32_bf16 v[196:199], v[176:179], v[160:163], 0
    v_fmac_f32 v239, v203, v59
    v_fmac_f32 v239, v204, v60
    v_mfma_f32_16x16x32_bf16 v[196:199], v[180:183], v[164:167], v[196:199]
    v_fmac_f32 v239, v205, v61
    v_fmac_f32 v239, v206, v62
    v_mfma_f32_16x16x32_bf16 v[200:203], v[144:147], v[144:147], 0
    v_fmac_f32 v239, v207, v63
    v_fmac_f32 v239, v186, v88
    v_mfma_f32_16x16x32_bf16 v[200:203], v[148:151], v[148:151], v[200:203]
    v_fmac_f32 v239, v188, v64
    v_fmac_f32 v239, v189, v65
    v_mfma_f32_16x16x32_bf16 v[204:207], v[144:147], v[160:163], 0
    v_fmac_f32 v239, v190, v66
    v_fmac_f32 v239, v191, v67
    v_mfma_f32_16x16x32_bf16 v[204:207], v[148:151], v[164:167], v[204:207]
    v_fmac_f32 v239, v192, v68
    v_fmac_f32 v239, v193, v69
    v_mfma_f32_16x16x32_bf16 v[208:211], v[160:163], v[160:163], 0
    v_fmac_f32 v239, v194, v70
    v_fmac_f32 v239, v195, v71
    v_mfma_f32_16x16x32_bf16 v[208:211], v[164:167], v[164:167], v[208:211]
    v_fmac_f32 v239, v198, v89
    s_waitcnt vmcnt(6) lgkmcnt(0)
    v_mfma_f32_16x16x32_bf16 v[184:187], v[96:99], v[96:99], 0
    v_mad_u32_u24 v214, v214, s57, v244
    v_mad_u32_u24 v215, v215, s57, v244
    v_mfma_f32_16x16x32_bf16 v[184:187], v[100:103], v[100:103], v[184:187]
    v_fmac_f32 v239, v200, v72
    v_fmac_f32 v239, v201, v73
    v_mfma_f32_16x16x32_bf16 v[188:191], v[96:99], v[104:107], 0
    v_fmac_f32 v239, v202, v74
    v_fmac_f32 v239, v203, v75
    v_mfma_f32_16x16x32_bf16 v[188:191], v[100:103], v[108:111], v[188:191]
    ds_read_b128 v[112:115], v214 offset:0
    ds_read_b128 v[116:119], v214 offset:64
    v_mfma_f32_16x16x32_bf16 v[192:195], v[176:179], v[120:123], 0
    v_fmac_f32 v239, v204, v76
    v_fmac_f32 v239, v205, v77
    v_mfma_f32_16x16x32_bf16 v[192:195], v[180:183], v[124:127], v[192:195]
    v_fmac_f32 v239, v206, v78
    v_fmac_f32 v239, v207, v79
    v_mfma_f32_16x16x32_bf16 v[196:199], v[96:99], v[120:123], 0
    v_fmac_f32 v239, v208, v80
    v_fmac_f32 v239, v209, v81
    v_mfma_f32_16x16x32_bf16 v[196:199], v[100:103], v[124:127], v[196:199]
    v_fmac_f32 v239, v210, v82
    v_fmac_f32 v239, v211, v83
    v_mfma_f32_16x16x32_bf16 v[200:203], v[176:179], v[96:99], 0
    ds_read_b128 v[128:131], v215 offset:0
    ds_read_b128 v[132:135], v215 offset:64
    v_mfma_f32_16x16x32_bf16 v[200:203], v[180:183], v[100:103], v[200:203]
    v_fmac_f32 v240, v184, v0
    v_fmac_f32 v240, v185, v1
    v_mfma_f32_16x16x32_bf16 v[204:207], v[96:99], v[136:139], 0
    v_fmac_f32 v240, v186, v2
    v_fmac_f32 v240, v187, v3
    v_mfma_f32_16x16x32_bf16 v[204:207], v[100:103], v[140:143], v[204:207]
    v_fmac_f32 v240, v188, v4
    v_fmac_f32 v240, v189, v5
    v_mfma_f32_16x16x32_bf16 v[208:211], v[176:179], v[136:139], 0
    v_fmac_f32 v240, v190, v6
    v_fmac_f32 v240, v191, v7
    v_mfma_f32_16x16x32_bf16 v[208:211], v[180:183], v[140:143], v[208:211]
    v_mad_u32_u24 v212, v212, s57, v244
    v_fmac_f32 v240, v195, v86
    v_mfma_f32_16x16x32_bf16 v[184:187], v[96:99], v[152:155], 0
    v_mad_u32_u24 v216, v216, s57, v244
    v_fmac_f32 v240, v196, v8
    v_mfma_f32_16x16x32_bf16 v[184:187], v[100:103], v[156:159], v[184:187]
    v_fmac_f32 v240, v197, v9
    v_fmac_f32 v240, v198, v10
    v_mfma_f32_16x16x32_bf16 v[188:191], v[96:99], v[168:171], 0
    v_fmac_f32 v240, v199, v11
    v_fmac_f32 v240, v203, v84
    v_mfma_f32_16x16x32_bf16 v[188:191], v[100:103], v[172:175], v[188:191]
    ds_read_b128 v[96:99], v212 offset:0
    ds_read_b128 v[100:103], v212 offset:64
    v_mfma_f32_16x16x32_bf16 v[192:195], v[104:107], v[104:107], 0
    v_fmac_f32 v240, v204, v12
    v_fmac_f32 v240, v205, v13
    v_mfma_f32_16x16x32_bf16 v[192:195], v[108:111], v[108:111], v[192:195]
    ds_read_b128 v[144:147], v216 offset:0
    ds_read_b128 v[148:151], v216 offset:64
    v_mfma_f32_16x16x32_bf16 v[196:199], v[104:107], v[120:123], 0
    v_fmac_f32 v240, v206, v14
    v_fmac_f32 v240, v207, v15
    v_mfma_f32_16x16x32_bf16 v[196:199], v[108:111], v[124:127], v[196:199]
    v_fmac_f32 v240, v211, v87
    v_fmac_f32 v240, v184, v16
    v_mfma_f32_16x16x32_bf16 v[200:203], v[176:179], v[152:155], 0
    v_fmac_f32 v240, v185, v17
    v_fmac_f32 v240, v186, v18
    v_mfma_f32_16x16x32_bf16 v[200:203], v[180:183], v[156:159], v[200:203]
    v_fmac_f32 v240, v187, v19
    v_fmac_f32 v240, v188, v20
    v_mfma_f32_16x16x32_bf16 v[204:207], v[176:179], v[104:107], 0
    v_fmac_f32 v240, v189, v21
    v_fmac_f32 v240, v190, v22
    v_mfma_f32_16x16x32_bf16 v[204:207], v[180:183], v[108:111], v[204:207]
    v_fmac_f32 v240, v191, v23
    v_mad_u32_u24 v217, v217, s57, v244
    v_mfma_f32_16x16x32_bf16 v[208:211], v[104:107], v[136:139], 0
    v_mad_u32_u24 v236, v236, s57, v244
    v_mad_u32_u24 v213, v213, s57, v244
    v_mfma_f32_16x16x32_bf16 v[208:211], v[108:111], v[140:143], v[208:211]
    v_fmac_f32 v240, v192, v24
    v_fmac_f32 v240, v193, v25
    v_mfma_f32_16x16x32_bf16 v[184:187], v[104:107], v[152:155], 0
    v_fmac_f32 v240, v194, v26
    v_fmac_f32 v240, v195, v27
    v_mfma_f32_16x16x32_bf16 v[184:187], v[108:111], v[156:159], v[184:187]
    v_fmac_f32 v240, v196, v28
    v_fmac_f32 v240, v197, v29
    v_mfma_f32_16x16x32_bf16 v[188:191], v[176:179], v[168:171], 0
    v_fmac_f32 v240, v198, v30
    v_fmac_f32 v240, v199, v31
    v_mfma_f32_16x16x32_bf16 v[188:191], v[180:183], v[172:175], v[188:191]
    ds_read_b128 v[160:163], v217 offset:0
    ds_read_b128 v[164:167], v217 offset:64
    v_mfma_f32_16x16x32_bf16 v[192:195], v[104:107], v[168:171], 0
    ds_read_b128 v[176:179], v236 offset:0
    ds_read_b128 v[180:183], v236 offset:64
    v_mfma_f32_16x16x32_bf16 v[192:195], v[108:111], v[172:175], v[192:195]
    ds_read_b128 v[104:107], v213 offset:0
    ds_read_b128 v[108:111], v213 offset:64
    v_mfma_f32_16x16x32_bf16 v[196:199], v[120:123], v[120:123], 0
    v_fmac_f32 v240, v203, v88
    v_fmac_f32 v240, v207, v85
    v_mfma_f32_16x16x32_bf16 v[196:199], v[124:127], v[124:127], v[196:199]
    buffer_load_dwordx4 v[212:215], v245, s[16:19], s74 offen offset:3200
    buffer_load_dwordx2 v[216:217], v245, s[16:19], s74 offen offset:3216
    buffer_load_dword v236, v246, s[16:19], s74 offen offset:3584
    v_mfma_f32_16x16x32_bf16 v[200:203], v[120:123], v[136:139], 0
    v_fmac_f32 v240, v208, v32
    v_fmac_f32 v240, v209, v33
    v_mfma_f32_16x16x32_bf16 v[200:203], v[124:127], v[140:143], v[200:203]
    v_fmac_f32 v240, v210, v34
    v_fmac_f32 v240, v211, v35
    v_mfma_f32_16x16x32_bf16 v[204:207], v[120:123], v[152:155], 0
    v_fmac_f32 v240, v184, v36
    v_fmac_f32 v240, v185, v37
    v_mfma_f32_16x16x32_bf16 v[204:207], v[124:127], v[156:159], v[204:207]
    v_fmac_f32 v240, v186, v38
    v_fmac_f32 v240, v187, v39
    v_mfma_f32_16x16x32_bf16 v[208:211], v[120:123], v[168:171], 0
    v_fmac_f32 v240, v191, v89
    v_fmac_f32 v240, v192, v40
    v_mfma_f32_16x16x32_bf16 v[208:211], v[124:127], v[172:175], v[208:211]
    v_fmac_f32 v240, v193, v41
    v_fmac_f32 v240, v194, v42
    v_mfma_f32_16x16x32_bf16 v[184:187], v[136:139], v[136:139], 0
    v_fmac_f32 v240, v195, v43
    v_permlane32_swap_b32 v237, v238
    v_mfma_f32_16x16x32_bf16 v[184:187], v[140:143], v[140:143], v[184:187]
    s_add_u32 s74, s74, 1600
    v_fmac_f32 v240, v196, v44
    v_mfma_f32_16x16x32_bf16 v[188:191], v[136:139], v[152:155], 0
    v_fmac_f32 v240, v197, v45
    v_fmac_f32 v240, v198, v46
    v_mfma_f32_16x16x32_bf16 v[188:191], v[140:143], v[156:159], v[188:191]
    v_fmac_f32 v240, v199, v47
    v_add_f32 v241, v237, v238
    v_mfma_f32_16x16x32_bf16 v[192:195], v[136:139], v[168:171], 0
    s_cmp_lt_u32 s74, s58
    v_fmac_f32 v240, v200, v48
    v_mfma_f32_16x16x32_bf16 v[192:195], v[140:143], v[172:175], v[192:195]
    v_fmac_f32 v240, v201, v49
    v_fmac_f32 v240, v202, v50
    v_mfma_f32_16x16x32_bf16 v[196:199], v[152:155], v[152:155], 0
    v_fmac_f32 v240, v203, v51
    v_fmac_f32 v240, v204, v52
    v_mfma_f32_16x16x32_bf16 v[196:199], v[156:159], v[156:159], v[196:199]
    v_fmac_f32 v240, v205, v53
    v_fmac_f32 v240, v206, v54
    v_mfma_f32_16x16x32_bf16 v[200:203], v[152:155], v[168:171], 0
    v_fmac_f32 v240, v207, v55
    v_fmac_f32 v240, v208, v56
    v_mfma_f32_16x16x32_bf16 v[200:203], v[156:159], v[172:175], v[200:203]
    v_fmac_f32 v240, v209, v57
    v_fmac_f32 v240, v210, v58
    v_mfma_f32_16x16x32_bf16 v[204:207], v[168:171], v[168:171], 0
    v_fmac_f32 v240, v211, v59
    v_fmac_f32 v240, v184, v60
    v_mfma_f32_16x16x32_bf16 v[204:207], v[172:175], v[172:175], v[204:207]
    v_fmac_f32 v240, v185, v61
    v_fmac_f32 v240, v186, v62
    v_fmac_f32 v240, v187, v63
    s_waitcnt vmcnt(7) lgkmcnt(0)
    s_cbranch_scc1 standalone__deep_cross_pnn__recsys_kernel_loop
    s_branch standalone__deep_cross_pnn__recsys_kernel_k2m
standalone__deep_cross_pnn__recsys_kernel_aux:

    s_setprio 0
    s_load_dword s24, s[60:61], 0
    s_load_dword s25, s[60:61], 16
    s_load_dword s26, s[60:61], 32
    s_load_dword s27, s[60:61], 48
    v_mov_b32 v8, v255
    v_mov_b32 v9, v254
    v_mov_b32 v10, v253
    v_mov_b32 v11, v252
    s_mov_b32 s51, s2
    s_mov_b32 s64, 0
    s_mov_b32 s65, 0

    v_mov_b32 v35, v83
    s_lshr_b32 s72, s2, 3
    s_mul_i32 s72, s72, 36
    s_lshr_b32 s72, s72, 5
    s_lshl_b32 s75, s36, 7
    s_add_u32 s75, s75, 254464
    s_mov_b32 s76, 143136
    s_lshl_b32 s6, s2, 15
    s_lshl_b32 s7, s56, 13
    s_add_u32 s6, s6, s7
    s_add_u32 s6, s6, 20971520
    s_add_u32 s7, s6, 4096
    s_lshl_b32 s8, s36, 7
    s_add_u32 s8, s8, s37
    s_lshl_b32 s8, s8, 9
    s_add_u32 s8, s8, 29360128
    s_and_b32 s9, s2, 63
    s_lshl_b32 s9, s9, 5
    s_lshr_b32 s38, s2, 6
    s_add_u32 s9, s9, s38
    s_lshl_b32 s9, s9, 2
    s_add_u32 s9, s9, 14680064
    v_mov_b32 v112, 0

standalone__deep_cross_pnn__recsys_kernel_unit:

    s_bfe_u32 s36, s51, 0x10003

    s_lshr_b32 s38, s51, 4
    s_and_b32 s39, s51, 7
    s_sub_u32 s57, 2, s36
    s_lshl_b32 s57, s39, s57
    s_lshl_b32 s37, s36, 5
    s_add_u32 s57, s57, s37
    s_add_u32 s57, s57, s56
    s_mul_i32 s37, s38, 48
    s_add_u32 s37, s37, s57
    s_lshl_b32 s38, s38, 1
    s_lshr_b32 s39, s39, 2
    s_add_u32 s38, s38, s39
    s_add_u32 s38, s38, 768
    s_and_b32 s57, s57, 7
    s_cmp_eq_u32 s57, 2
    s_cselect_b32 s38, s38, 1000
    s_lshl_b32 s39, s36, 1
    s_and_b32 s39, s39, s56
    s_cselect_b32 s57, s38, s37

    s_lshr_b32 s37, s51, 4
    s_lshl_b32 s37, s37, 3
    s_and_b32 s38, s51, 7
    s_or_b32 s37, s37, s38
    s_and_b32 s58, s56, 1
    s_lshl_b32 s59, s37, 1
    s_add_u32 s58, s58, s59
    s_lshr_b32 s59, s56, 1
    s_xor_b32 s60, s36, 1
    s_mul_i32 s46, s60, 13
    s_lshl_b32 s60, s60, 1
    s_add_u32 s59, s59, s60
    s_add_u32 s61, s46, 6
    s_add_u32 s60, s46, 12
    s_bitcmp1_b32 s59, 0
    s_cselect_b32 s46, s60, s46
    s_cselect_b32 s63, -1, 1
    s_cselect_b32 s61, 24, s61
    v_lshrrev_b32 v1, 3, v8
    v_and_b32 v2, 7, v8
    v_mul_i32_i24 v7, s63, v2
    v_add_u32 v7, s46, v7
    v_cmp_ge_u32 s[48:49], s61, v7
    s_mul_i32 s60, s58, 25600
    s_movk_i32 s61, 400
    s_lshl_b32 s63, s63, 16
    v_mul_u32_u24 v0, s61, v1
    v_lshl_add_u32 v0, v7, 4, v0
    v_and_b32 v5, 15, v8
    v_and_b32 v6, 48, v8
    v_lshl_add_u32 v56, v5, 8, v6
    s_lshr_b32 s44, s37, 1
    s_lshl_b32 s44, s44, 12
    s_lshl_b32 s38, s36, 1
    s_and_b32 s39, s37, 1
    s_add_u32 s38, s38, s39
    s_lshl_b32 s38, s38, 6
    s_add_u32 s44, s44, s38
    s_lshl_b32 s47, s36, 7
    s_add_u32 s47, s47, s37
    s_lshl_b32 s47, s47, 10
    s_add_u32 s47, s47, 15204352

    s_cmp_eq_u32 s56, 0
    s_cselect_b64 s[4:5], -1, 0
    s_cmp_lg_u32 s64, 0
    s_cbranch_scc1 standalone__deep_cross_pnn__recsys_kernel_nd1
    s_mov_b64 exec, s[40:41]

    s_mul_i32 s73, s72, 4032
    s_mul_i32 s74, s72, 7168
    s_add_u32 s73, s73, s43
    s_add_u32 s74, s74, s42
    s_min_u32 m0, s73, s76
    s_min_u32 s74, s74, s75
    s_add_u32 s72, s72, 1

    buffer_load_dwordx4 v35, s[20:23], s74 offen lds
    s_cmp_eq_u32 s72, 36
    s_cselect_b32 s72, 0, s72

    s_mul_i32 s73, s72, 4032
    s_mul_i32 s74, s72, 7168
    s_add_u32 s73, s73, s43
    s_add_u32 s74, s74, s42
    s_min_u32 m0, s73, s76
    s_min_u32 s74, s74, s75
    s_add_u32 s72, s72, 1

    buffer_load_dwordx4 v35, s[20:23], s74 offen lds
    s_cmp_eq_u32 s72, 36
    s_cselect_b32 s72, 0, s72

    s_mul_i32 s73, s72, 4032
    s_mul_i32 s74, s72, 7168
    s_add_u32 s73, s73, s43
    s_add_u32 s74, s74, s42
    s_min_u32 m0, s73, s76
    s_min_u32 s74, s74, s75
    s_add_u32 s72, s72, 1

    buffer_load_dwordx4 v35, s[20:23], s74 offen lds
    s_cmp_eq_u32 s72, 36
    s_cselect_b32 s72, 0, s72

    s_mul_i32 s73, s72, 4032
    s_mul_i32 s74, s72, 7168
    s_add_u32 s73, s73, s43
    s_add_u32 s74, s74, s42
    s_min_u32 m0, s73, s76
    s_min_u32 s74, s74, s75
    s_add_u32 s72, s72, 1

    buffer_load_dwordx4 v35, s[20:23], s74 offen lds
    s_cmp_eq_u32 s72, 36
    s_cselect_b32 s72, 0, s72

    s_mul_i32 s73, s72, 4032
    s_mul_i32 s74, s72, 7168
    s_add_u32 s73, s73, s43
    s_add_u32 s74, s74, s42
    s_min_u32 m0, s73, s76
    s_min_u32 s74, s74, s75
    s_add_u32 s72, s72, 1

    buffer_load_dwordx4 v35, s[20:23], s74 offen lds
    s_cmp_eq_u32 s72, 36
    s_cselect_b32 s72, 0, s72

    s_mul_i32 s73, s72, 4032
    s_mul_i32 s74, s72, 7168
    s_add_u32 s73, s73, s43
    s_add_u32 s74, s74, s42
    s_min_u32 m0, s73, s76
    s_min_u32 s74, s74, s75
    s_add_u32 s72, s72, 1

    buffer_load_dwordx4 v35, s[20:23], s74 offen lds
    s_cmp_eq_u32 s72, 36
    s_cselect_b32 s72, 0, s72

    s_mul_i32 s73, s72, 4032
    s_mul_i32 s74, s72, 7168
    s_add_u32 s73, s73, s43
    s_add_u32 s74, s74, s42
    s_min_u32 m0, s73, s76
    s_min_u32 s74, s74, s75
    s_add_u32 s72, s72, 1

    buffer_load_dwordx4 v35, s[20:23], s74 offen lds
    s_cmp_eq_u32 s72, 36
    s_cselect_b32 s72, 0, s72

    s_mul_i32 s73, s72, 4032
    s_mul_i32 s74, s72, 7168
    s_add_u32 s73, s73, s43
    s_add_u32 s74, s74, s42
    s_min_u32 m0, s73, s76
    s_min_u32 s74, s74, s75
    s_add_u32 s72, s72, 1

    buffer_load_dwordx4 v35, s[20:23], s74 offen lds
    s_cmp_eq_u32 s72, 36
    s_cselect_b32 s72, 0, s72

    s_mul_i32 s73, s72, 4032
    s_mul_i32 s74, s72, 7168
    s_add_u32 s73, s73, s43
    s_add_u32 s74, s74, s42
    s_min_u32 m0, s73, s76
    s_min_u32 s74, s74, s75
    s_add_u32 s72, s72, 1
    s_barrier

    buffer_load_dwordx4 v35, s[20:23], s74 offen lds
    s_cmp_eq_u32 s72, 36
    s_cselect_b32 s72, 0, s72

    s_mul_i32 s73, s72, 4032
    s_mul_i32 s74, s72, 7168
    s_add_u32 s73, s73, s43
    s_add_u32 s74, s74, s42
    s_min_u32 m0, s73, s76
    s_min_u32 s74, s74, s75
    s_add_u32 s72, s72, 1

    buffer_load_dwordx4 v35, s[20:23], s74 offen lds
    s_cmp_eq_u32 s72, 36
    s_cselect_b32 s72, 0, s72

    s_mul_i32 s73, s72, 4032
    s_mul_i32 s74, s72, 7168
    s_add_u32 s73, s73, s43
    s_add_u32 s74, s74, s42
    s_min_u32 m0, s73, s76
    s_min_u32 s74, s74, s75
    s_add_u32 s72, s72, 1

    buffer_load_dwordx4 v35, s[20:23], s74 offen lds
    s_cmp_eq_u32 s72, 36
    s_cselect_b32 s72, 0, s72

    s_mul_i32 s73, s72, 4032
    s_mul_i32 s74, s72, 7168
    s_add_u32 s73, s73, s43
    s_add_u32 s74, s74, s42
    s_min_u32 m0, s73, s76
    s_min_u32 s74, s74, s75
    s_add_u32 s72, s72, 1

    buffer_load_dwordx4 v35, s[20:23], s74 offen lds
    s_cmp_eq_u32 s72, 36
    s_cselect_b32 s72, 0, s72

    s_mov_b64 exec, -1
standalone__deep_cross_pnn__recsys_kernel_nd1:

    s_lshr_b32 s78, s57, 5
    s_bfe_u32 s79, s57, 0x20003
    s_bfe_u32 s80, s57, 0x20001
    s_and_b32 s81, s57, 1
    s_lshl_b32 s77, s78, 2
    s_lshl_b32 s83, s81, 1
    s_add_u32 s77, s77, s83
    s_lshl_b32 s77, s77, 7
    s_lshl_b32 s83, s79, 5
    s_add_u32 s77, s77, s83
    s_lshl_b32 s83, s80, 3
    s_add_u32 s77, s77, s83
    s_lshl_b32 s77, s77, 10
    s_lshl_b32 s82, s78, 12
    s_lshl_b32 s83, s79, 10
    s_add_u32 s82, s82, s83
    s_lshl_b32 s83, s80, 8
    s_add_u32 s82, s82, s83
    s_lshl_b32 s83, s81, 7
    s_add_u32 s82, s82, s83
    s_mov_b32 s84, 821248
    v_mul_lo_u32 v14, v1, s84
    v_lshl_add_u32 v14, v2, 4, v14
    s_cmp_ge_u32 s57, 800
    s_cselect_b32 s83, 0x40000000, 0
    v_or_b32 v14, s83, v14
    v_and_b32 v3, 3, v8
    v_lshlrev_b32 v3, 4, v3
    v_lshl_or_b32 v3, v1, 6, v3
    v_and_b32 v4, 4, v8
    v_lshl_or_b32 v15, v4, 15, v3
    s_mov_b32 s84, 0x05040100
    s_mov_b32 s85, 0x07060302

    s_cmp_lg_u32 s64, 0
    s_cbranch_scc1 standalone__deep_cross_pnn__recsys_kernel_nd2
    s_mov_b64 exec, s[40:41]

    s_mul_i32 s73, s72, 4032
    s_mul_i32 s74, s72, 7168
    s_add_u32 s73, s73, s43
    s_add_u32 s74, s74, s42
    s_min_u32 m0, s73, s76
    s_min_u32 s74, s74, s75
    s_add_u32 s72, s72, 1

    buffer_load_dwordx4 v35, s[20:23], s74 offen lds
    s_cmp_eq_u32 s72, 36
    s_cselect_b32 s72, 0, s72

    s_mul_i32 s73, s72, 4032
    s_mul_i32 s74, s72, 7168
    s_add_u32 s73, s73, s43
    s_add_u32 s74, s74, s42
    s_min_u32 m0, s73, s76
    s_min_u32 s74, s74, s75
    s_add_u32 s72, s72, 1

    buffer_load_dwordx4 v35, s[20:23], s74 offen lds
    s_cmp_eq_u32 s72, 36
    s_cselect_b32 s72, 0, s72

    s_mul_i32 s73, s72, 4032
    s_mul_i32 s74, s72, 7168
    s_add_u32 s73, s73, s43
    s_add_u32 s74, s74, s42
    s_min_u32 m0, s73, s76
    s_min_u32 s74, s74, s75
    s_add_u32 s72, s72, 1

    buffer_load_dwordx4 v35, s[20:23], s74 offen lds
    s_cmp_eq_u32 s72, 36
    s_cselect_b32 s72, 0, s72

    s_mul_i32 s73, s72, 4032
    s_mul_i32 s74, s72, 7168
    s_add_u32 s73, s73, s43
    s_add_u32 s74, s74, s42
    s_min_u32 m0, s73, s76
    s_min_u32 s74, s74, s75
    s_add_u32 s72, s72, 1

    buffer_load_dwordx4 v35, s[20:23], s74 offen lds
    s_cmp_eq_u32 s72, 36
    s_cselect_b32 s72, 0, s72

    s_mul_i32 s73, s72, 4032
    s_mul_i32 s74, s72, 7168
    s_add_u32 s73, s73, s43
    s_add_u32 s74, s74, s42
    s_min_u32 m0, s73, s76
    s_min_u32 s74, s74, s75
    s_add_u32 s72, s72, 1

    buffer_load_dwordx4 v35, s[20:23], s74 offen lds
    s_cmp_eq_u32 s72, 36
    s_cselect_b32 s72, 0, s72

    s_mul_i32 s73, s72, 4032
    s_mul_i32 s74, s72, 7168
    s_add_u32 s73, s73, s43
    s_add_u32 s74, s74, s42
    s_min_u32 m0, s73, s76
    s_min_u32 s74, s74, s75
    s_add_u32 s72, s72, 1

    buffer_load_dwordx4 v35, s[20:23], s74 offen lds
    s_cmp_eq_u32 s72, 36
    s_cselect_b32 s72, 0, s72

    s_mul_i32 s73, s72, 4032
    s_mul_i32 s74, s72, 7168
    s_add_u32 s73, s73, s43
    s_add_u32 s74, s74, s42
    s_min_u32 m0, s73, s76
    s_min_u32 s74, s74, s75
    s_add_u32 s72, s72, 1

    buffer_load_dwordx4 v35, s[20:23], s74 offen lds
    s_cmp_eq_u32 s72, 36
    s_cselect_b32 s72, 0, s72

    s_mul_i32 s73, s72, 4032
    s_mul_i32 s74, s72, 7168
    s_add_u32 s73, s73, s43
    s_add_u32 s74, s74, s42
    s_min_u32 m0, s73, s76
    s_min_u32 s74, s74, s75
    s_add_u32 s72, s72, 1

    buffer_load_dwordx4 v35, s[20:23], s74 offen lds
    s_cmp_eq_u32 s72, 36
    s_cselect_b32 s72, 0, s72

    s_mul_i32 s73, s72, 4032
    s_mul_i32 s74, s72, 7168
    s_add_u32 s73, s73, s43
    s_add_u32 s74, s74, s42
    s_min_u32 m0, s73, s76
    s_min_u32 s74, s74, s75
    s_add_u32 s72, s72, 1

    buffer_load_dwordx4 v35, s[20:23], s74 offen lds
    s_cmp_eq_u32 s72, 36
    s_cselect_b32 s72, 0, s72

    s_mul_i32 s73, s72, 4032
    s_mul_i32 s74, s72, 7168
    s_add_u32 s73, s73, s43
    s_add_u32 s74, s74, s42
    s_min_u32 m0, s73, s76
    s_min_u32 s74, s74, s75
    s_add_u32 s72, s72, 1

    buffer_load_dwordx4 v35, s[20:23], s74 offen lds
    s_cmp_eq_u32 s72, 36
    s_cselect_b32 s72, 0, s72

    s_mul_i32 s73, s72, 4032
    s_mul_i32 s74, s72, 7168
    s_add_u32 s73, s73, s43
    s_add_u32 s74, s74, s42
    s_min_u32 m0, s73, s76
    s_min_u32 s74, s74, s75
    s_add_u32 s72, s72, 1

    buffer_load_dwordx4 v35, s[20:23], s74 offen lds
    s_cmp_eq_u32 s72, 36
    s_cselect_b32 s72, 0, s72

    s_mul_i32 s73, s72, 4032
    s_mul_i32 s74, s72, 7168
    s_add_u32 s73, s73, s43
    s_add_u32 s74, s74, s42
    s_min_u32 m0, s73, s76
    s_min_u32 s74, s74, s75
    s_add_u32 s72, s72, 1

    buffer_load_dwordx4 v35, s[20:23], s74 offen lds
    s_cmp_eq_u32 s72, 36
    s_cselect_b32 s72, 0, s72

    s_mul_i32 s73, s72, 4032
    s_mul_i32 s74, s72, 7168
    s_add_u32 s73, s73, s43
    s_add_u32 s74, s74, s42
    s_min_u32 m0, s73, s76
    s_min_u32 s74, s74, s75
    s_add_u32 s72, s72, 1

    buffer_load_dwordx4 v35, s[20:23], s74 offen lds
    s_cmp_eq_u32 s72, 36
    s_cselect_b32 s72, 0, s72

    s_mul_i32 s73, s72, 4032
    s_mul_i32 s74, s72, 7168
    s_add_u32 s73, s73, s43
    s_add_u32 s74, s74, s42
    s_min_u32 m0, s73, s76
    s_min_u32 s74, s74, s75
    s_add_u32 s72, s72, 1

    buffer_load_dwordx4 v35, s[20:23], s74 offen lds
    s_cmp_eq_u32 s72, 36
    s_cselect_b32 s72, 0, s72

    s_mul_i32 s73, s72, 4032
    s_mul_i32 s74, s72, 7168
    s_add_u32 s73, s73, s43
    s_add_u32 s74, s74, s42
    s_min_u32 m0, s73, s76
    s_min_u32 s74, s74, s75
    s_add_u32 s72, s72, 1

    buffer_load_dwordx4 v35, s[20:23], s74 offen lds
    s_cmp_eq_u32 s72, 36
    s_cselect_b32 s72, 0, s72

    s_mul_i32 s73, s72, 4032
    s_mul_i32 s74, s72, 7168
    s_add_u32 s73, s73, s43
    s_add_u32 s74, s74, s42
    s_min_u32 m0, s73, s76
    s_min_u32 s74, s74, s75
    s_add_u32 s72, s72, 1

    buffer_load_dwordx4 v35, s[20:23], s74 offen lds
    s_cmp_eq_u32 s72, 36
    s_cselect_b32 s72, 0, s72

    s_mul_i32 s73, s72, 4032
    s_mul_i32 s74, s72, 7168
    s_add_u32 s73, s73, s43
    s_add_u32 s74, s74, s42
    s_min_u32 m0, s73, s76
    s_min_u32 s74, s74, s75
    s_add_u32 s72, s72, 1

    buffer_load_dwordx4 v35, s[20:23], s74 offen lds
    s_cmp_eq_u32 s72, 36
    s_cselect_b32 s72, 0, s72

    s_mul_i32 s73, s72, 4032
    s_mul_i32 s74, s72, 7168
    s_add_u32 s73, s73, s43
    s_add_u32 s74, s74, s42
    s_min_u32 m0, s73, s76
    s_min_u32 s74, s74, s75
    s_add_u32 s72, s72, 1

    buffer_load_dwordx4 v35, s[20:23], s74 offen lds
    s_cmp_eq_u32 s72, 36
    s_cselect_b32 s72, 0, s72

    s_mul_i32 s73, s72, 4032
    s_mul_i32 s74, s72, 7168
    s_add_u32 s73, s73, s43
    s_add_u32 s74, s74, s42
    s_min_u32 m0, s73, s76
    s_min_u32 s74, s74, s75
    s_add_u32 s72, s72, 1

    buffer_load_dwordx4 v35, s[20:23], s74 offen lds
    s_cmp_eq_u32 s72, 36
    s_cselect_b32 s72, 0, s72

    s_mul_i32 s73, s72, 4032
    s_mul_i32 s74, s72, 7168
    s_add_u32 s73, s73, s43
    s_add_u32 s74, s74, s42
    s_min_u32 m0, s73, s76
    s_min_u32 s74, s74, s75
    s_add_u32 s72, s72, 1

    buffer_load_dwordx4 v35, s[20:23], s74 offen lds
    s_cmp_eq_u32 s72, 36
    s_cselect_b32 s72, 0, s72

    s_mul_i32 s73, s72, 4032
    s_mul_i32 s74, s72, 7168
    s_add_u32 s73, s73, s43
    s_add_u32 s74, s74, s42
    s_min_u32 m0, s73, s76
    s_min_u32 s74, s74, s75
    s_add_u32 s72, s72, 1

    buffer_load_dwordx4 v35, s[20:23], s74 offen lds
    s_cmp_eq_u32 s72, 36
    s_cselect_b32 s72, 0, s72

    s_mul_i32 s73, s72, 4032
    s_mul_i32 s74, s72, 7168
    s_add_u32 s73, s73, s43
    s_add_u32 s74, s74, s42
    s_min_u32 m0, s73, s76
    s_min_u32 s74, s74, s75
    s_add_u32 s72, s72, 1

    buffer_load_dwordx4 v35, s[20:23], s74 offen lds
    s_cmp_eq_u32 s72, 36
    s_cselect_b32 s72, 0, s72

    s_mul_i32 s73, s72, 4032
    s_mul_i32 s74, s72, 7168
    s_add_u32 s73, s73, s43
    s_add_u32 s74, s74, s42
    s_min_u32 m0, s73, s76
    s_min_u32 s74, s74, s75
    s_add_u32 s72, s72, 1

    buffer_load_dwordx4 v35, s[20:23], s74 offen lds
    s_cmp_eq_u32 s72, 36
    s_cselect_b32 s72, 0, s72

    s_mul_i32 s73, s72, 4032
    s_mul_i32 s74, s72, 7168
    s_add_u32 s73, s73, s43
    s_add_u32 s74, s74, s42
    s_min_u32 m0, s73, s76
    s_min_u32 s74, s74, s75
    s_add_u32 s72, s72, 1

    buffer_load_dwordx4 v35, s[20:23], s74 offen lds
    s_cmp_eq_u32 s72, 36
    s_cselect_b32 s72, 0, s72

    s_mov_b64 exec, -1
standalone__deep_cross_pnn__recsys_kernel_nd2:

    s_cmp_lg_u32 s64, 0
    s_cbranch_scc1 standalone__deep_cross_pnn__recsys_kernel_nsig
    s_waitcnt vmcnt(0)
    s_barrier

standalone__deep_cross_pnn__recsys_kernel_nsig:
    s_setprio 1
    s_mov_b64 exec, s[48:49]
    buffer_load_dwordx4 v[224:227], v0, s[16:19], s60 offen
    s_add_u32 s60, s60, 3200
    buffer_load_dwordx4 v[228:231], v0, s[16:19], s60 offen
    s_add_u32 s60, s60, 3200
    buffer_load_dwordx4 v[232:235], v0, s[16:19], s60 offen
    s_add_u32 s60, s60, 3200
    buffer_load_dwordx4 v[236:239], v0, s[16:19], s60 offen
    s_add_u32 s60, s60, 3200
    buffer_load_dwordx4 v[240:243], v0, s[16:19], s60 offen
    s_add_u32 s60, s60, 3200
    buffer_load_dwordx4 v[244:247], v0, s[16:19], s60 offen
    s_add_u32 s60, s60, 3200
    buffer_load_dwordx4 v[248:251], v0, s[16:19], s60 offen
    s_add_u32 s60, s60, 3200
    buffer_load_dwordx4 v[252:255], v0, s[16:19], s60 offen
    s_add_u32 s60, s60, 3200
    s_mov_b64 exec, -1

    s_lshl_b32 s61, s56, 8
    s_add_u32 s61, s61, 162688
    v_lshlrev_b32 v86, 2, v8
    v_add_u32 v86, s61, v86
    v_and_b32 v85, 0xffffff80, v86
    v_lshrrev_b32 v27, 5, v8
    v_mul_u32_u24 v27, 0x40404, v27
    v_lshl_or_b32 v27, v27, 8, v27
    s_mul_i32 s61, s56, 4608
    s_add_u32 s61, s61, 144256
    v_mul_u32_u24 v31, 72, v8
    v_add3_u32 v31, s61, v31, -8
    v_mul_u32_u24 v34, 72, v1
    v_lshl_add_u32 v34, v2, 3, v34
    v_add_u32 v34, s61, v34
    v_mul_u32_u24 v3, 52, v7
    v_lshrrev_b32 v3, 8, v3
    v_mad_i32_i24 v2, v3, -5, v7
    v_mov_b32 v13, 0
    v_mul_u32_u24 v2, 0x10001, v2
    v_lshlrev_b32 v2, 12, v2
    v_add_u32 v32, 67108864, v2
    v_add_u32 v33, 201328640, v2
    s_cmp_eq_u32 s59, 3
    s_cselect_b32 s61, 0x0fffff00, -16
    s_cmp_eq_u32 s59, 1
    s_cselect_b32 s61, 0x0ffffff0, s61
    v_mov_b32 v59, s61
    s_lshr_b32 s62, s58, 7
    s_mul_i32 s62, s62, 25
    s_min_u32 s46, s46, 24
    s_add_u32 s62, s62, s46
    s_lshl_b32 s62, s62, 3
    s_bfe_u32 s61, s58, 0x30004
    s_add_u32 s62, s62, s61
    s_lshl_b32 s62, s62, 13
    s_bfe_u32 s61, s58, 0x30001
    s_lshl_b32 s61, s61, 10
    s_add_u32 s62, s62, s61
    s_and_b32 s61, s58, 1
    s_lshl_b32 s46, s61, 2
    s_add_u32 s46, s46, 163712
    s_lshl_b32 s61, s61, 9
    s_add_u32 s62, s62, s61
    s_add_u32 s62, s62, 16777216
    v_and_b32 v30, 31, v8
    v_lshrrev_b32 v3, 5, v8
    v_lshlrev_b32 v30, 4, v30
    v_lshl_add_u32 v30, v3, 3, v30
    s_movk_i32 s66, 0x7c
    s_mov_b32 s67, 0x03030303
    s_mov_b32 s75, 0x06040200
    v_mov_b32 v57, 0x08040201
    v_mov_b32 v58, 0x80402010
    v_mov_b32 v108, 0xff800001
    v_mov_b32 v109, 0xff800001
    v_mov_b32 v110, 0xff800001
    v_mov_b32 v111, 0xff800001

    s_mov_b64 exec, s[48:49]

    s_waitcnt vmcnt(7)
    v_lshl_or_b32 v224, v225, 16, v224
    v_lshl_or_b32 v225, v227, 16, v226
    v_add_u32 v224, v32, v224
    v_add_u32 v225, v33, v225

    ds_write_b64 v34, v[224:225] offset:0

    s_waitcnt vmcnt(6)
    v_lshl_or_b32 v228, v229, 16, v228
    v_lshl_or_b32 v229, v231, 16, v230
    v_add_u32 v228, v32, v228
    v_add_u32 v229, v33, v229

    ds_write_b64 v34, v[228:229] offset:576

    s_waitcnt vmcnt(5)
    v_lshl_or_b32 v232, v233, 16, v232
    v_lshl_or_b32 v233, v235, 16, v234
    v_add_u32 v232, v32, v232
    v_add_u32 v233, v33, v233

    ds_write_b64 v34, v[232:233] offset:1152

    s_waitcnt vmcnt(4)
    v_lshl_or_b32 v236, v237, 16, v236
    v_lshl_or_b32 v237, v239, 16, v238
    v_add_u32 v236, v32, v236
    v_add_u32 v237, v33, v237

    ds_write_b64 v34, v[236:237] offset:1728

    s_waitcnt vmcnt(3)
    v_lshl_or_b32 v240, v241, 16, v240
    v_lshl_or_b32 v241, v243, 16, v242
    v_add_u32 v240, v32, v240
    v_add_u32 v241, v33, v241

    ds_write_b64 v34, v[240:241] offset:2304

    s_waitcnt vmcnt(2)
    v_lshl_or_b32 v244, v245, 16, v244
    v_lshl_or_b32 v245, v247, 16, v246
    v_add_u32 v244, v32, v244
    v_add_u32 v245, v33, v245

    ds_write_b64 v34, v[244:245] offset:2880

    s_waitcnt vmcnt(1)
    v_lshl_or_b32 v248, v249, 16, v248
    v_lshl_or_b32 v249, v251, 16, v250
    v_add_u32 v248, v32, v248
    v_add_u32 v249, v33, v249

    ds_write_b64 v34, v[248:249] offset:3456

    s_waitcnt vmcnt(0)
    v_lshl_or_b32 v252, v253, 16, v252
    v_lshl_or_b32 v253, v255, 16, v254
    v_add_u32 v252, v32, v252
    v_add_u32 v253, v33, v253

    ds_write_b64 v34, v[252:253] offset:4032
    s_mov_b64 exec, -1
    ds_read_b64 v[40:41], v31 offset:8
    ds_read_b64 v[42:43], v31 offset:16
    ds_read_b64 v[44:45], v31 offset:24
    ds_read_b64 v[46:47], v31 offset:32
    ds_read_b64 v[48:49], v31 offset:40
    ds_read_b64 v[50:51], v31 offset:48
    ds_read_b64 v[52:53], v31 offset:56
    ds_read_b64 v[54:55], v31 offset:64

    s_waitcnt lgkmcnt(7)
    v_perm_b32 v60, v41, v40, s75
    v_lshlrev_b32 v72, 2, v60

    v_lshrrev_b32 v61, 3, v60
    v_and_b32 v60, 0x07070707, v60
    v_and_or_b32 v0, v61, s67, v27
    v_perm_b32 v16, v58, v57, v60
    v_add_u32 v64, v57, v16

    s_waitcnt lgkmcnt(6)
    v_perm_b32 v60, v43, v42, s75
    v_lshlrev_b32 v73, 2, v60

    v_lshrrev_b32 v61, 3, v60
    v_and_b32 v60, 0x07070707, v60
    v_and_or_b32 v1, v61, s67, v27
    v_perm_b32 v17, v58, v57, v60
    v_add_u32 v65, v57, v17

    s_waitcnt lgkmcnt(5)
    v_perm_b32 v60, v45, v44, s75
    v_lshlrev_b32 v74, 2, v60

    v_lshrrev_b32 v61, 3, v60
    v_and_b32 v60, 0x07070707, v60
    v_and_or_b32 v2, v61, s67, v27
    v_perm_b32 v18, v58, v57, v60
    v_add_u32 v66, v57, v18

    s_waitcnt lgkmcnt(4)
    v_perm_b32 v60, v47, v46, s75
    v_lshlrev_b32 v75, 2, v60

    v_lshrrev_b32 v61, 3, v60
    v_and_b32 v60, 0x07070707, v60
    v_and_or_b32 v3, v61, s67, v27
    v_perm_b32 v19, v58, v57, v60
    v_add_u32 v67, v57, v19

    s_waitcnt lgkmcnt(3)
    v_perm_b32 v60, v49, v48, s75
    v_lshlrev_b32 v76, 2, v60

    v_lshrrev_b32 v61, 3, v60
    v_and_b32 v60, 0x07070707, v60
    v_and_or_b32 v4, v61, s67, v27
    v_perm_b32 v20, v58, v57, v60
    v_add_u32 v68, v57, v20

    s_waitcnt lgkmcnt(2)
    v_perm_b32 v60, v51, v50, s75
    v_lshlrev_b32 v77, 2, v60

    v_lshrrev_b32 v61, 3, v60
    v_and_b32 v60, 0x07070707, v60
    v_and_or_b32 v5, v61, s67, v27
    v_perm_b32 v21, v58, v57, v60
    v_add_u32 v69, v57, v21

    s_waitcnt lgkmcnt(1)
    v_perm_b32 v60, v53, v52, s75
    v_lshlrev_b32 v78, 2, v60

    v_lshrrev_b32 v61, 3, v60
    v_and_b32 v60, 0x07070707, v60
    v_and_or_b32 v6, v61, s67, v27
    v_perm_b32 v22, v58, v57, v60
    v_add_u32 v70, v57, v22

    s_waitcnt lgkmcnt(0)
    v_perm_b32 v60, v55, v54, s75
    v_lshlrev_b32 v79, 2, v60

    v_lshrrev_b32 v61, 3, v60
    v_and_b32 v60, 0x07070707, v60
    v_and_or_b32 v7, v61, s67, v27
    v_perm_b32 v23, v58, v57, v60
    v_add_u32 v71, v57, v23

    ds_write_b32 v86, v13
    s_cmp_eq_u32 s59, 3
    s_cbranch_scc1 standalone__deep_cross_pnn__recsys_kernel_sk1
    v_add_u32 v63, v58, v16
    v_ffbl_b32 v84, v59
    v_perm_b32 v60, v72, v72, v84
    v_and_or_b32 v60, v60, s66, v85
    ds_add_rtn_u32 v87, v60, v10
    ds_wrxchg_rtn_b32 v116, v86, v13

    s_waitcnt lgkmcnt(0)
    v_cmp_gt_u32 s[68:69], 2, v116

    s_nop 0
    v_cmpx_le_u32 vcc, 2, v87
    v_mov_b32 v62, s69
    v_perm_b32 v121, v62, s68, v1
    v_perm_b32 v122, v62, s68, v0
    v_and_b32 v121, v121, v17
    v_and_b32 v122, v122, v16
    v_msad_u8 v120, v65, v121, 0
    v_lshlrev_b32 v120, 8, v120
    v_msad_u8 v120, v63, v122, v120
    v_and_b32 v120, v120, v59

    v_ffbl_b32 v120, v120
    v_max_i32 v84, v84, v120
    s_mov_b64 exec, -1
    v_lshl_add_u32 v59, -1, v84, v59

    v_lshl_add_u32 v61, v84, 1, v31
    ds_read_u16 v80, v61 offset:0
    s_setprio 0
    v_ffbl_b32 v84, v59
    v_perm_b32 v60, v72, v72, v84
    v_and_or_b32 v60, v60, s66, v85
    ds_add_rtn_u32 v87, v60, v10
    ds_wrxchg_rtn_b32 v116, v86, v13

    s_waitcnt lgkmcnt(0)
    v_cmp_gt_u32 s[68:69], 2, v116

    s_nop 0
    v_cmpx_le_u32 vcc, 2, v87
    v_mov_b32 v62, s69
    v_perm_b32 v121, v62, s68, v1
    v_perm_b32 v122, v62, s68, v0
    v_and_b32 v121, v121, v17
    v_and_b32 v122, v122, v16
    v_msad_u8 v120, v65, v121, 0
    v_lshlrev_b32 v120, 8, v120
    v_msad_u8 v120, v63, v122, v120
    v_and_b32 v120, v120, v59

    v_ffbl_b32 v120, v120
    v_max_i32 v84, v84, v120
    s_mov_b64 exec, -1
    v_lshl_add_u32 v59, -1, v84, v59

    v_lshl_add_u32 v61, v84, 1, v31
    ds_read_u16 v81, v61 offset:0
    s_setprio 1
    v_ffbl_b32 v84, v59
    v_perm_b32 v60, v72, v72, v84
    v_and_or_b32 v60, v60, s66, v85
    ds_add_rtn_u32 v87, v60, v10
    ds_wrxchg_rtn_b32 v116, v86, v13

    s_waitcnt lgkmcnt(0)
    v_cmp_gt_u32 s[68:69], 2, v116

    s_nop 0
    v_cmpx_le_u32 vcc, 2, v87
    v_mov_b32 v62, s69
    v_perm_b32 v121, v62, s68, v1
    v_perm_b32 v122, v62, s68, v0
    v_and_b32 v121, v121, v17
    v_and_b32 v122, v122, v16
    v_msad_u8 v120, v65, v121, 0
    v_lshlrev_b32 v120, 8, v120
    v_msad_u8 v120, v63, v122, v120
    v_and_b32 v120, v120, v59

    v_ffbl_b32 v120, v120
    v_max_i32 v84, v84, v120
    s_mov_b64 exec, -1
    v_lshl_add_u32 v59, -1, v84, v59

    v_lshl_add_u32 v61, v84, 1, v31
    ds_read_u16 v82, v61 offset:0
    s_setprio 0
    v_ffbl_b32 v84, v59
    v_perm_b32 v60, v72, v72, v84
    v_and_or_b32 v60, v60, s66, v85
    ds_add_rtn_u32 v87, v60, v10
    ds_wrxchg_rtn_b32 v116, v86, v13

    s_waitcnt lgkmcnt(0)
    v_cmp_gt_u32 s[68:69], 2, v116

    s_nop 0
    v_cmpx_le_u32 vcc, 2, v87
    v_mov_b32 v62, s69
    v_perm_b32 v121, v62, s68, v1
    v_and_b32 v121, v121, v17
    v_msad_u8 v120, v65, v121, 0
    v_and_b32_sdwa v120, v120, v59 dst_sel:BYTE_1 dst_unused:UNUSED_PAD src0_sel:DWORD src1_sel:BYTE_1
    s_nop 0

    v_ffbl_b32 v120, v120
    v_max_i32 v84, v84, v120
    s_mov_b64 exec, -1
    v_lshl_add_u32 v59, -1, v84, v59

    v_lshl_add_u32 v61, v84, 1, v31
    ds_read_u16 v83, v61 offset:0
standalone__deep_cross_pnn__recsys_kernel_sk1:
    v_lshrrev_b32 v59, 4, v59
    v_add_u32 v63, v58, v17
    s_setprio 1
    v_ffbl_b32 v84, v59
    v_perm_b32 v60, v73, v72, v84
    v_and_or_b32 v60, v60, s66, v85

    v_cmpx_ge_u32 vcc, 0, v84
    ds_add_u32 v60, v10
    s_not_b64 s[70:71], vcc
    s_mov_b64 exec, s[70:71]
    ds_add_rtn_u32 v87, v60, v10
    s_mov_b64 exec, -1

    ds_wrxchg_rtn_b32 v116, v86, v13
    v_lshlrev_b32 v104, 13, v8
    s_cmp_eq_u32 s64, 0
    s_cselect_b32 s45, s4, 0
    s_and_b32 exec_lo, s45, 3
    s_mov_b32 exec_hi, 0
    buffer_store_dword v13, v104, s[12:15], s9 offen sc1
    s_mov_b64 exec, -1
    buffer_load_dwordx4 v[128:131], v15, s[28:31], s77 offen offset:0
    buffer_load_dwordx4 v[160:163], v15, s[28:31], s77 offen offset:512

    s_waitcnt lgkmcnt(0)
    v_cmp_gt_u32 s[68:69], 2, v116

    s_cmp_eq_u32 s59, 3
    s_cbranch_scc1 standalone__deep_cross_pnn__recsys_kernel_nf1
    v_lshl_or_b32 v24, v81, 16, v80
    v_lshl_or_b32 v25, v83, 16, v82
    buffer_store_dwordx2 v[24:25], v30, s[32:35], s62 offen sc1
    s_add_u32 s62, s62, s63
standalone__deep_cross_pnn__recsys_kernel_nf1:
    s_mov_b64 exec, s[70:71]
    v_cmpx_le_u32 vcc, 2, v87
    v_mov_b32 v62, s69
    v_perm_b32 v121, v62, s68, v2
    v_perm_b32 v122, v62, s68, v1
    v_and_b32 v121, v121, v18
    v_and_b32 v122, v122, v17
    v_msad_u8 v120, v66, v121, 0
    v_lshlrev_b32 v120, 8, v120
    v_msad_u8 v120, v63, v122, v120
    v_and_b32 v120, v120, v59

    v_ffbl_b32 v120, v120
    v_max_i32 v84, v84, v120
    s_mov_b64 exec, -1
    v_lshl_add_u32 v59, -1, v84, v59

    v_lshl_add_u32 v61, v84, 1, v31
    ds_read_u16 v80, v61 offset:8
    s_setprio 0
    v_ffbl_b32 v84, v59
    v_perm_b32 v60, v73, v72, v84
    v_and_or_b32 v60, v60, s66, v85

    v_cmpx_ge_u32 vcc, 1, v84
    ds_add_u32 v60, v10
    s_not_b64 s[70:71], vcc
    s_mov_b64 exec, s[70:71]
    ds_add_rtn_u32 v87, v60, v10
    s_mov_b64 exec, -1

    ds_wrxchg_rtn_b32 v116, v86, v13
    s_mov_b64 exec, s[4:5]
    buffer_load_dwordx4 v[104:107], v56, s[20:23], s44 offen
    s_mov_b64 exec, -1
    buffer_load_dwordx4 v[132:135], v15, s[28:31], s77 offen offset:1024
    buffer_load_dwordx4 v[164:167], v15, s[28:31], s77 offen offset:1536

    s_waitcnt lgkmcnt(0)
    v_cmp_gt_u32 s[68:69], 2, v116

    s_mov_b64 exec, s[70:71]
    v_cmpx_le_u32 vcc, 2, v87
    v_mov_b32 v62, s69
    v_perm_b32 v121, v62, s68, v2
    v_perm_b32 v122, v62, s68, v1
    v_and_b32 v121, v121, v18
    v_and_b32 v122, v122, v17
    v_msad_u8 v120, v66, v121, 0
    v_lshlrev_b32 v120, 8, v120
    v_msad_u8 v120, v63, v122, v120
    v_and_b32 v120, v120, v59

    v_ffbl_b32 v120, v120
    v_max_i32 v84, v84, v120
    s_mov_b64 exec, -1
    v_lshl_add_u32 v59, -1, v84, v59

    v_lshl_add_u32 v61, v84, 1, v31
    ds_read_u16 v81, v61 offset:8
    s_setprio 1
    v_ffbl_b32 v84, v59
    v_perm_b32 v60, v73, v72, v84
    v_and_or_b32 v60, v60, s66, v85

    v_cmpx_ge_u32 vcc, 2, v84
    ds_add_u32 v60, v10
    s_not_b64 s[70:71], vcc
    s_mov_b64 exec, s[70:71]
    ds_add_rtn_u32 v87, v60, v10
    s_mov_b64 exec, -1

    ds_wrxchg_rtn_b32 v116, v86, v13
    buffer_load_dwordx4 v[136:139], v15, s[28:31], s77 offen offset:2048
    buffer_load_dwordx4 v[168:171], v15, s[28:31], s77 offen offset:2560

    s_waitcnt lgkmcnt(0)
    v_cmp_gt_u32 s[68:69], 2, v116

    s_mov_b64 exec, s[70:71]
    v_cmpx_le_u32 vcc, 2, v87
    v_mov_b32 v62, s69
    v_perm_b32 v121, v62, s68, v2
    v_perm_b32 v122, v62, s68, v1
    v_and_b32 v121, v121, v18
    v_and_b32 v122, v122, v17
    v_msad_u8 v120, v66, v121, 0
    v_lshlrev_b32 v120, 8, v120
    v_msad_u8 v120, v63, v122, v120
    v_and_b32 v120, v120, v59

    v_ffbl_b32 v120, v120
    v_max_i32 v84, v84, v120
    s_mov_b64 exec, -1
    v_lshl_add_u32 v59, -1, v84, v59

    v_lshl_add_u32 v61, v84, 1, v31
    ds_read_u16 v82, v61 offset:8
    s_setprio 0
    v_ffbl_b32 v84, v59
    v_perm_b32 v60, v73, v72, v84
    v_and_or_b32 v60, v60, s66, v85

    v_cmpx_ge_u32 vcc, 3, v84
    ds_add_u32 v60, v10
    s_not_b64 s[70:71], vcc
    s_mov_b64 exec, s[70:71]
    ds_add_rtn_u32 v87, v60, v10
    s_mov_b64 exec, -1

    ds_wrxchg_rtn_b32 v116, v86, v13
    buffer_load_dwordx4 v[140:143], v15, s[28:31], s77 offen offset:3072
    buffer_load_dwordx4 v[172:175], v15, s[28:31], s77 offen offset:3584
    s_add_u32 s77, s77, 4096

    s_waitcnt lgkmcnt(0)
    v_cmp_gt_u32 s[68:69], 2, v116

    s_mov_b64 exec, s[70:71]
    v_cmpx_le_u32 vcc, 2, v87
    v_mov_b32 v62, s69
    v_perm_b32 v121, v62, s68, v2
    v_and_b32 v121, v121, v18
    v_msad_u8 v120, v66, v121, 0
    v_and_b32_sdwa v120, v120, v59 dst_sel:BYTE_1 dst_unused:UNUSED_PAD src0_sel:DWORD src1_sel:BYTE_1
    s_nop 0

    v_ffbl_b32 v120, v120
    v_max_i32 v84, v84, v120
    s_mov_b64 exec, -1
    v_lshl_add_u32 v59, -1, v84, v59

    v_lshl_add_u32 v61, v84, 1, v31
    ds_read_u16 v83, v61 offset:8
    v_lshrrev_b32 v59, 4, v59
    v_add_u32 v63, v58, v18
    s_setprio 1
    v_ffbl_b32 v84, v59
    v_perm_b32 v60, v74, v73, v84
    v_and_or_b32 v60, v60, s66, v85

    v_cmpx_ge_u32 vcc, 0, v84
    ds_add_u32 v60, v10
    s_not_b64 s[70:71], vcc
    s_mov_b64 exec, s[70:71]
    ds_add_rtn_u32 v87, v60, v10
    s_mov_b64 exec, -1

    ds_wrxchg_rtn_b32 v116, v86, v13
    buffer_load_dwordx4 v[144:147], v15, s[28:31], s77 offen offset:0
    buffer_load_dwordx4 v[176:179], v15, s[28:31], s77 offen offset:512

    s_waitcnt lgkmcnt(0)
    v_cmp_gt_u32 s[68:69], 2, v116

    v_lshl_or_b32 v24, v81, 16, v80
    v_lshl_or_b32 v25, v83, 16, v82
    buffer_store_dwordx2 v[24:25], v30, s[32:35], s62 offen sc1
    s_add_u32 s62, s62, s63
    s_mov_b64 exec, s[70:71]
    v_cmpx_le_u32 vcc, 2, v87
    v_mov_b32 v62, s69
    v_perm_b32 v121, v62, s68, v3
    v_perm_b32 v122, v62, s68, v2
    v_and_b32 v121, v121, v19
    v_and_b32 v122, v122, v18
    v_msad_u8 v120, v67, v121, 0
    v_lshlrev_b32 v120, 8, v120
    v_msad_u8 v120, v63, v122, v120
    v_and_b32 v120, v120, v59

    v_ffbl_b32 v120, v120
    v_max_i32 v84, v84, v120
    s_mov_b64 exec, -1
    v_lshl_add_u32 v59, -1, v84, v59

    v_lshl_add_u32 v61, v84, 1, v31
    ds_read_u16 v80, v61 offset:16
    s_setprio 0
    v_ffbl_b32 v84, v59
    v_perm_b32 v60, v74, v73, v84
    v_and_or_b32 v60, v60, s66, v85

    v_cmpx_ge_u32 vcc, 1, v84
    ds_add_u32 v60, v10
    s_not_b64 s[70:71], vcc
    s_mov_b64 exec, s[70:71]
    ds_add_rtn_u32 v87, v60, v10
    s_mov_b64 exec, -1

    ds_wrxchg_rtn_b32 v116, v86, v13
    buffer_load_dwordx4 v[148:151], v15, s[28:31], s77 offen offset:1024
    buffer_load_dwordx4 v[180:183], v15, s[28:31], s77 offen offset:1536

    s_waitcnt lgkmcnt(0)
    v_cmp_gt_u32 s[68:69], 2, v116

    s_mov_b64 exec, s[70:71]
    v_cmpx_le_u32 vcc, 2, v87
    v_mov_b32 v62, s69
    v_perm_b32 v121, v62, s68, v3
    v_perm_b32 v122, v62, s68, v2
    v_and_b32 v121, v121, v19
    v_and_b32 v122, v122, v18
    v_msad_u8 v120, v67, v121, 0
    v_lshlrev_b32 v120, 8, v120
    v_msad_u8 v120, v63, v122, v120
    v_and_b32 v120, v120, v59

    v_ffbl_b32 v120, v120
    v_max_i32 v84, v84, v120
    s_mov_b64 exec, -1
    v_lshl_add_u32 v59, -1, v84, v59

    v_lshl_add_u32 v61, v84, 1, v31
    ds_read_u16 v81, v61 offset:16
    s_setprio 1
    v_ffbl_b32 v84, v59
    v_perm_b32 v60, v74, v73, v84
    v_and_or_b32 v60, v60, s66, v85

    v_cmpx_ge_u32 vcc, 2, v84
    ds_add_u32 v60, v10
    s_not_b64 s[70:71], vcc
    s_mov_b64 exec, s[70:71]
    ds_add_rtn_u32 v87, v60, v10
    s_mov_b64 exec, -1

    ds_wrxchg_rtn_b32 v116, v86, v13
    s_waitcnt vmcnt(11)
    s_mov_b64 exec, s[4:5]
    buffer_store_dwordx4 v[104:107], v9, s[32:35], s47 offen sc1
    s_mov_b64 exec, -1
    buffer_load_dwordx4 v[152:155], v15, s[28:31], s77 offen offset:2048
    buffer_load_dwordx4 v[184:187], v15, s[28:31], s77 offen offset:2560

    s_waitcnt lgkmcnt(0)
    v_cmp_gt_u32 s[68:69], 2, v116

    s_mov_b64 exec, s[70:71]
    v_cmpx_le_u32 vcc, 2, v87
    v_mov_b32 v62, s69
    v_perm_b32 v121, v62, s68, v3
    v_perm_b32 v122, v62, s68, v2
    v_and_b32 v121, v121, v19
    v_and_b32 v122, v122, v18
    v_msad_u8 v120, v67, v121, 0
    v_lshlrev_b32 v120, 8, v120
    v_msad_u8 v120, v63, v122, v120
    v_and_b32 v120, v120, v59

    v_ffbl_b32 v120, v120
    v_max_i32 v84, v84, v120
    s_mov_b64 exec, -1
    v_lshl_add_u32 v59, -1, v84, v59

    v_lshl_add_u32 v61, v84, 1, v31
    ds_read_u16 v82, v61 offset:16
    s_setprio 0
    v_ffbl_b32 v84, v59
    v_perm_b32 v60, v74, v73, v84
    v_and_or_b32 v60, v60, s66, v85

    v_cmpx_ge_u32 vcc, 3, v84
    ds_add_u32 v60, v10
    s_not_b64 s[70:71], vcc
    s_mov_b64 exec, s[70:71]
    ds_add_rtn_u32 v87, v60, v10
    s_mov_b64 exec, -1

    ds_wrxchg_rtn_b32 v116, v86, v13
    buffer_load_dwordx4 v[156:159], v15, s[28:31], s77 offen offset:3072
    buffer_load_dwordx4 v[188:191], v15, s[28:31], s77 offen offset:3584

    s_waitcnt lgkmcnt(0)
    v_cmp_gt_u32 s[68:69], 2, v116

    s_mov_b64 exec, s[70:71]
    v_cmpx_le_u32 vcc, 2, v87
    v_mov_b32 v62, s69
    v_perm_b32 v121, v62, s68, v3
    v_and_b32 v121, v121, v19
    v_msad_u8 v120, v67, v121, 0
    v_and_b32_sdwa v120, v120, v59 dst_sel:BYTE_1 dst_unused:UNUSED_PAD src0_sel:DWORD src1_sel:BYTE_1
    s_nop 0

    v_ffbl_b32 v120, v120
    v_max_i32 v84, v84, v120
    s_mov_b64 exec, -1
    v_lshl_add_u32 v59, -1, v84, v59

    v_lshl_add_u32 v61, v84, 1, v31
    ds_read_u16 v83, v61 offset:16
    v_lshrrev_b32 v59, 4, v59
    v_add_u32 v63, v58, v19
    s_setprio 1
    v_ffbl_b32 v84, v59
    v_perm_b32 v60, v75, v74, v84
    v_and_or_b32 v60, v60, s66, v85

    v_cmpx_ge_u32 vcc, 0, v84
    ds_add_u32 v60, v10
    s_not_b64 s[70:71], vcc
    s_mov_b64 exec, s[70:71]
    ds_add_rtn_u32 v87, v60, v10
    s_mov_b64 exec, -1

    ds_wrxchg_rtn_b32 v116, v86, v13

    s_waitcnt lgkmcnt(0)
    v_cmp_gt_u32 s[68:69], 2, v116

    v_lshl_or_b32 v24, v81, 16, v80
    v_lshl_or_b32 v25, v83, 16, v82
    buffer_store_dwordx2 v[24:25], v30, s[32:35], s62 offen sc1
    s_add_u32 s62, s62, s63
    s_mov_b64 exec, s[70:71]
    v_cmpx_le_u32 vcc, 2, v87
    v_mov_b32 v62, s69
    v_perm_b32 v121, v62, s68, v4
    v_perm_b32 v122, v62, s68, v3
    v_and_b32 v121, v121, v20
    v_and_b32 v122, v122, v19
    v_msad_u8 v120, v68, v121, 0
    v_lshlrev_b32 v120, 8, v120
    v_msad_u8 v120, v63, v122, v120
    v_and_b32 v120, v120, v59

    v_ffbl_b32 v120, v120
    v_max_i32 v84, v84, v120
    s_mov_b64 exec, -1
    v_lshl_add_u32 v59, -1, v84, v59

    v_lshl_add_u32 v61, v84, 1, v31
    ds_read_u16 v80, v61 offset:24
    s_setprio 0
    v_ffbl_b32 v84, v59
    v_perm_b32 v60, v75, v74, v84
    v_and_or_b32 v60, v60, s66, v85

    v_cmpx_ge_u32 vcc, 1, v84
    ds_add_u32 v60, v10
    s_not_b64 s[70:71], vcc
    s_mov_b64 exec, s[70:71]
    ds_add_rtn_u32 v87, v60, v10
    s_mov_b64 exec, -1

    ds_wrxchg_rtn_b32 v116, v86, v13

    s_waitcnt lgkmcnt(0)
    v_cmp_gt_u32 s[68:69], 2, v116

    s_mov_b64 exec, s[70:71]
    v_cmpx_le_u32 vcc, 2, v87
    v_mov_b32 v62, s69
    v_perm_b32 v121, v62, s68, v4
    v_perm_b32 v122, v62, s68, v3
    v_and_b32 v121, v121, v20
    v_and_b32 v122, v122, v19
    v_msad_u8 v120, v68, v121, 0
    v_lshlrev_b32 v120, 8, v120
    v_msad_u8 v120, v63, v122, v120
    v_and_b32 v120, v120, v59

    v_ffbl_b32 v120, v120
    v_max_i32 v84, v84, v120
    s_mov_b64 exec, -1
    v_lshl_add_u32 v59, -1, v84, v59

    v_lshl_add_u32 v61, v84, 1, v31
    ds_read_u16 v81, v61 offset:24
    s_setprio 1

    s_cmp_ge_u32 s57, 800
    s_cbranch_scc1 standalone__deep_cross_pnn__recsys_kernel_norl
    s_waitcnt vmcnt(0)

    s_lshl_b32 s39, 1, s2
    s_cmp_eq_u32 s64, 0
    s_cselect_b32 s39, s39, 0

    s_lshr_b32 s38, s2, 5
    v_mov_b32 v60, s39
    s_lshl_b32 s38, s38, 4
    s_and_b64 exec, s[4:5], 1
    buffer_atomic_or v60, v13, s[52:55], s38 offen offset:128
    s_mov_b64 exec, -1

standalone__deep_cross_pnn__recsys_kernel_norl:
standalone__deep_cross_pnn__recsys_kernel_rld:
    v_ffbl_b32 v84, v59
    v_perm_b32 v60, v75, v74, v84
    v_and_or_b32 v60, v60, s66, v85

    v_cmpx_ge_u32 vcc, 2, v84
    ds_add_u32 v60, v10
    s_not_b64 s[70:71], vcc
    s_mov_b64 exec, s[70:71]
    ds_add_rtn_u32 v87, v60, v10
    s_mov_b64 exec, -1

    ds_wrxchg_rtn_b32 v116, v86, v13
    s_cmp_ge_u32 s57, 800
    s_cbranch_scc1 standalone__deep_cross_pnn__recsys_kernel_nr14
    v_perm_b32 v192, v132, v128, s84
    v_perm_b32 v193, v140, v136, s84
    v_perm_b32 v194, v148, v144, s84
    v_perm_b32 v195, v156, v152, s84
    s_add_u32 s83, s82, 0
    buffer_store_dwordx4 v[192:195], v14, s[32:35], s83 offen sc1
    v_perm_b32 v196, v132, v128, s85
    v_perm_b32 v197, v140, v136, s85
    v_perm_b32 v198, v148, v144, s85
    v_perm_b32 v199, v156, v152, s85
    s_add_u32 s83, s82, 102656
    buffer_store_dwordx4 v[196:199], v14, s[32:35], s83 offen sc1
standalone__deep_cross_pnn__recsys_kernel_nr14:

    s_waitcnt lgkmcnt(0)
    v_cmp_gt_u32 s[68:69], 2, v116

    s_mov_b64 exec, s[70:71]
    v_cmpx_le_u32 vcc, 2, v87
    v_mov_b32 v62, s69
    v_perm_b32 v121, v62, s68, v4
    v_perm_b32 v122, v62, s68, v3
    v_and_b32 v121, v121, v20
    v_and_b32 v122, v122, v19
    v_msad_u8 v120, v68, v121, 0
    v_lshlrev_b32 v120, 8, v120
    v_msad_u8 v120, v63, v122, v120
    v_and_b32 v120, v120, v59

    v_ffbl_b32 v120, v120
    v_max_i32 v84, v84, v120
    s_mov_b64 exec, -1
    v_lshl_add_u32 v59, -1, v84, v59

    v_lshl_add_u32 v61, v84, 1, v31
    ds_read_u16 v82, v61 offset:24
    s_setprio 0
    v_ffbl_b32 v84, v59
    v_perm_b32 v60, v75, v74, v84
    v_and_or_b32 v60, v60, s66, v85

    v_cmpx_ge_u32 vcc, 3, v84
    ds_add_u32 v60, v10
    s_not_b64 s[70:71], vcc
    s_mov_b64 exec, s[70:71]
    ds_add_rtn_u32 v87, v60, v10
    s_mov_b64 exec, -1

    ds_wrxchg_rtn_b32 v116, v86, v13
    s_cmp_ge_u32 s57, 800
    s_cbranch_scc1 standalone__deep_cross_pnn__recsys_kernel_nr15
    v_perm_b32 v200, v133, v129, s84
    v_perm_b32 v201, v141, v137, s84
    v_perm_b32 v202, v149, v145, s84
    v_perm_b32 v203, v157, v153, s84
    s_add_u32 s83, s82, 205312
    buffer_store_dwordx4 v[200:203], v14, s[32:35], s83 offen sc1
    v_perm_b32 v204, v133, v129, s85
    v_perm_b32 v205, v141, v137, s85
    v_perm_b32 v206, v149, v145, s85
    v_perm_b32 v207, v157, v153, s85
    s_add_u32 s83, s82, 307968
    buffer_store_dwordx4 v[204:207], v14, s[32:35], s83 offen sc1
standalone__deep_cross_pnn__recsys_kernel_nr15:

    s_waitcnt lgkmcnt(0)
    v_cmp_gt_u32 s[68:69], 2, v116

    s_mov_b64 exec, s[70:71]
    v_cmpx_le_u32 vcc, 2, v87
    v_mov_b32 v62, s69
    v_perm_b32 v121, v62, s68, v4
    v_and_b32 v121, v121, v20
    v_msad_u8 v120, v68, v121, 0
    v_and_b32_sdwa v120, v120, v59 dst_sel:BYTE_1 dst_unused:UNUSED_PAD src0_sel:DWORD src1_sel:BYTE_1
    s_nop 0

    v_ffbl_b32 v120, v120
    v_max_i32 v84, v84, v120
    s_mov_b64 exec, -1
    v_lshl_add_u32 v59, -1, v84, v59

    v_lshl_add_u32 v61, v84, 1, v31
    ds_read_u16 v83, v61 offset:24
    v_lshrrev_b32 v59, 4, v59
    v_add_u32 v63, v58, v20
    s_setprio 1
    v_ffbl_b32 v84, v59
    v_perm_b32 v60, v76, v75, v84
    v_and_or_b32 v60, v60, s66, v85

    v_cmpx_ge_u32 vcc, 0, v84
    ds_add_u32 v60, v10
    s_not_b64 s[70:71], vcc
    s_mov_b64 exec, s[70:71]
    ds_add_rtn_u32 v87, v60, v10
    s_mov_b64 exec, -1

    ds_wrxchg_rtn_b32 v116, v86, v13
    s_cmp_ge_u32 s57, 800
    s_cbranch_scc1 standalone__deep_cross_pnn__recsys_kernel_nr16
    v_perm_b32 v208, v134, v130, s84
    v_perm_b32 v209, v142, v138, s84
    v_perm_b32 v210, v150, v146, s84
    v_perm_b32 v211, v158, v154, s84
    s_add_u32 s83, s82, 410624
    buffer_store_dwordx4 v[208:211], v14, s[32:35], s83 offen sc1
    v_perm_b32 v212, v134, v130, s85
    v_perm_b32 v213, v142, v138, s85
    v_perm_b32 v214, v150, v146, s85
    v_perm_b32 v215, v158, v154, s85
    s_add_u32 s83, s82, 513280
    buffer_store_dwordx4 v[212:215], v14, s[32:35], s83 offen sc1
standalone__deep_cross_pnn__recsys_kernel_nr16:

    s_waitcnt lgkmcnt(0)
    v_cmp_gt_u32 s[68:69], 2, v116

    v_lshl_or_b32 v24, v81, 16, v80
    v_lshl_or_b32 v25, v83, 16, v82
    buffer_store_dwordx2 v[24:25], v30, s[32:35], s62 offen sc1
    s_add_u32 s62, s62, s63
    s_mov_b64 exec, s[70:71]
    v_cmpx_le_u32 vcc, 2, v87
    v_mov_b32 v62, s69
    v_perm_b32 v121, v62, s68, v5
    v_perm_b32 v122, v62, s68, v4
    v_and_b32 v121, v121, v21
    v_and_b32 v122, v122, v20
    v_msad_u8 v120, v69, v121, 0
    v_lshlrev_b32 v120, 8, v120
    v_msad_u8 v120, v63, v122, v120
    v_and_b32 v120, v120, v59

    v_ffbl_b32 v120, v120
    v_max_i32 v84, v84, v120
    s_mov_b64 exec, -1
    v_lshl_add_u32 v59, -1, v84, v59

    v_lshl_add_u32 v61, v84, 1, v31
    ds_read_u16 v80, v61 offset:32
    s_setprio 0
    v_ffbl_b32 v84, v59
    v_perm_b32 v60, v76, v75, v84
    v_and_or_b32 v60, v60, s66, v85

    v_cmpx_ge_u32 vcc, 1, v84
    ds_add_u32 v60, v10
    s_not_b64 s[70:71], vcc
    s_mov_b64 exec, s[70:71]
    ds_add_rtn_u32 v87, v60, v10
    s_mov_b64 exec, -1

    ds_wrxchg_rtn_b32 v116, v86, v13
    s_cmp_ge_u32 s57, 800
    s_cbranch_scc1 standalone__deep_cross_pnn__recsys_kernel_nr17
    v_perm_b32 v216, v135, v131, s84
    v_perm_b32 v217, v143, v139, s84
    v_perm_b32 v218, v151, v147, s84
    v_perm_b32 v219, v159, v155, s84
    s_add_u32 s83, s82, 615936
    buffer_store_dwordx4 v[216:219], v14, s[32:35], s83 offen sc1
    v_perm_b32 v220, v135, v131, s85
    v_perm_b32 v221, v143, v139, s85
    v_perm_b32 v222, v151, v147, s85
    v_perm_b32 v223, v159, v155, s85
    s_add_u32 s83, s82, 718592
    buffer_store_dwordx4 v[220:223], v14, s[32:35], s83 offen sc1
standalone__deep_cross_pnn__recsys_kernel_nr17:

    s_waitcnt lgkmcnt(0)
    v_cmp_gt_u32 s[68:69], 2, v116

    s_mov_b64 exec, s[70:71]
    v_cmpx_le_u32 vcc, 2, v87
    v_mov_b32 v62, s69
    v_perm_b32 v121, v62, s68, v5
    v_perm_b32 v122, v62, s68, v4
    v_and_b32 v121, v121, v21
    v_and_b32 v122, v122, v20
    v_msad_u8 v120, v69, v121, 0
    v_lshlrev_b32 v120, 8, v120
    v_msad_u8 v120, v63, v122, v120
    v_and_b32 v120, v120, v59

    v_ffbl_b32 v120, v120
    v_max_i32 v84, v84, v120
    s_mov_b64 exec, -1
    v_lshl_add_u32 v59, -1, v84, v59

    v_lshl_add_u32 v61, v84, 1, v31
    ds_read_u16 v81, v61 offset:32
    s_setprio 1
    v_ffbl_b32 v84, v59
    v_perm_b32 v60, v76, v75, v84
    v_and_or_b32 v60, v60, s66, v85

    v_cmpx_ge_u32 vcc, 2, v84
    ds_add_u32 v60, v10
    s_not_b64 s[70:71], vcc
    s_mov_b64 exec, s[70:71]
    ds_add_rtn_u32 v87, v60, v10
    s_mov_b64 exec, -1

    ds_wrxchg_rtn_b32 v116, v86, v13
    s_cmp_ge_u32 s57, 800
    s_cbranch_scc1 standalone__deep_cross_pnn__recsys_kernel_nr18
    v_perm_b32 v224, v164, v160, s84
    v_perm_b32 v225, v172, v168, s84
    v_perm_b32 v226, v180, v176, s84
    v_perm_b32 v227, v188, v184, s84
    s_add_u32 s83, s82, 6569984
    buffer_store_dwordx4 v[224:227], v14, s[32:35], s83 offen sc1
    v_perm_b32 v228, v164, v160, s85
    v_perm_b32 v229, v172, v168, s85
    v_perm_b32 v230, v180, v176, s85
    v_perm_b32 v231, v188, v184, s85
    s_add_u32 s83, s82, 6672640
    buffer_store_dwordx4 v[228:231], v14, s[32:35], s83 offen sc1
standalone__deep_cross_pnn__recsys_kernel_nr18:

    s_waitcnt lgkmcnt(0)
    v_cmp_gt_u32 s[68:69], 2, v116

    s_mov_b64 exec, s[70:71]
    v_cmpx_le_u32 vcc, 2, v87
    v_mov_b32 v62, s69
    v_perm_b32 v121, v62, s68, v5
    v_perm_b32 v122, v62, s68, v4
    v_and_b32 v121, v121, v21
    v_and_b32 v122, v122, v20
    v_msad_u8 v120, v69, v121, 0
    v_lshlrev_b32 v120, 8, v120
    v_msad_u8 v120, v63, v122, v120
    v_and_b32 v120, v120, v59

    v_ffbl_b32 v120, v120
    v_max_i32 v84, v84, v120
    s_mov_b64 exec, -1
    v_lshl_add_u32 v59, -1, v84, v59

    v_lshl_add_u32 v61, v84, 1, v31
    ds_read_u16 v82, v61 offset:32
    s_setprio 0
    v_ffbl_b32 v84, v59
    v_perm_b32 v60, v76, v75, v84
    v_and_or_b32 v60, v60, s66, v85

    v_cmpx_ge_u32 vcc, 3, v84
    ds_add_u32 v60, v10
    s_not_b64 s[70:71], vcc
    s_mov_b64 exec, s[70:71]
    ds_add_rtn_u32 v87, v60, v10
    s_mov_b64 exec, -1

    ds_wrxchg_rtn_b32 v116, v86, v13
    s_cmp_ge_u32 s57, 800
    s_cbranch_scc1 standalone__deep_cross_pnn__recsys_kernel_nr19
    v_perm_b32 v232, v165, v161, s84
    v_perm_b32 v233, v173, v169, s84
    v_perm_b32 v234, v181, v177, s84
    v_perm_b32 v235, v189, v185, s84
    s_add_u32 s83, s82, 6775296
    buffer_store_dwordx4 v[232:235], v14, s[32:35], s83 offen sc1
    v_perm_b32 v236, v165, v161, s85
    v_perm_b32 v237, v173, v169, s85
    v_perm_b32 v238, v181, v177, s85
    v_perm_b32 v239, v189, v185, s85
    s_add_u32 s83, s82, 6877952
    buffer_store_dwordx4 v[236:239], v14, s[32:35], s83 offen sc1
standalone__deep_cross_pnn__recsys_kernel_nr19:

    s_waitcnt lgkmcnt(0)
    v_cmp_gt_u32 s[68:69], 2, v116

    s_mov_b64 exec, s[70:71]
    v_cmpx_le_u32 vcc, 2, v87
    v_mov_b32 v62, s69
    v_perm_b32 v121, v62, s68, v5
    v_and_b32 v121, v121, v21
    v_msad_u8 v120, v69, v121, 0
    v_and_b32_sdwa v120, v120, v59 dst_sel:BYTE_1 dst_unused:UNUSED_PAD src0_sel:DWORD src1_sel:BYTE_1
    s_nop 0

    v_ffbl_b32 v120, v120
    v_max_i32 v84, v84, v120
    s_mov_b64 exec, -1
    v_lshl_add_u32 v59, -1, v84, v59

    v_lshl_add_u32 v61, v84, 1, v31
    ds_read_u16 v83, v61 offset:32
    v_lshrrev_b32 v59, 4, v59
    v_add_u32 v63, v58, v21

    s_bitcmp0_b32 s59, 0
    s_cbranch_scc1 standalone__deep_cross_pnn__recsys_kernel_mg2
    v_mov_b32 v60, s46
    v_subrev_u32 v61, 512, v86

standalone__deep_cross_pnn__recsys_kernel_mg1:

    ds_read_b32 v12, v60
    ds_read_b32 v120, v61
    s_waitcnt lgkmcnt(0)
    v_readfirstlane_b32 s45, v12
    s_cmp_lg_u32 s45, 0
    s_cbranch_scc1 standalone__deep_cross_pnn__recsys_kernel_mg3
    s_sleep 2
    s_branch standalone__deep_cross_pnn__recsys_kernel_mg1

standalone__deep_cross_pnn__recsys_kernel_mg3:

    ds_write_b32 v60, v13
    s_mov_b32 s45, 0xff00
    v_lshl_or_b32 v120, v120, 8, v120
    v_and_or_b32 v59, v120, s45, v59

standalone__deep_cross_pnn__recsys_kernel_mg2:
    s_setprio 1
    v_ffbl_b32 v84, v59
    v_perm_b32 v60, v77, v76, v84
    v_and_or_b32 v60, v60, s66, v85

    v_cmpx_ge_u32 vcc, 0, v84
    ds_add_u32 v60, v10
    s_not_b64 s[70:71], vcc
    s_mov_b64 exec, s[70:71]
    ds_add_rtn_u32 v87, v60, v10
    s_mov_b64 exec, -1

    ds_wrxchg_rtn_b32 v116, v86, v13
    s_cmp_ge_u32 s57, 800
    s_cbranch_scc1 standalone__deep_cross_pnn__recsys_kernel_nr20
    v_perm_b32 v240, v166, v162, s84
    v_perm_b32 v241, v174, v170, s84
    v_perm_b32 v242, v182, v178, s84
    v_perm_b32 v243, v190, v186, s84
    s_add_u32 s83, s82, 6980608
    buffer_store_dwordx4 v[240:243], v14, s[32:35], s83 offen sc1
    v_perm_b32 v244, v166, v162, s85
    v_perm_b32 v245, v174, v170, s85
    v_perm_b32 v246, v182, v178, s85
    v_perm_b32 v247, v190, v186, s85
    s_add_u32 s83, s82, 7083264
    buffer_store_dwordx4 v[244:247], v14, s[32:35], s83 offen sc1
standalone__deep_cross_pnn__recsys_kernel_nr20:
    buffer_store_dwordx4 v[108:111], v9, s[12:15], s6 offen offset:0 sc1
    buffer_store_dwordx4 v[108:111], v9, s[12:15], s6 offen offset:1024 sc1

    s_waitcnt lgkmcnt(0)
    v_cmp_gt_u32 s[68:69], 2, v116

    v_lshl_or_b32 v24, v81, 16, v80
    v_lshl_or_b32 v25, v83, 16, v82
    buffer_store_dwordx2 v[24:25], v30, s[32:35], s62 offen sc1
    s_add_u32 s62, s62, s63
    s_mov_b64 exec, s[70:71]
    v_cmpx_le_u32 vcc, 2, v87
    v_mov_b32 v62, s69
    v_perm_b32 v121, v62, s68, v6
    v_perm_b32 v122, v62, s68, v5
    v_and_b32 v121, v121, v22
    v_and_b32 v122, v122, v21
    v_msad_u8 v120, v70, v121, 0
    v_lshlrev_b32 v120, 8, v120
    v_msad_u8 v120, v63, v122, v120
    v_and_b32 v120, v120, v59

    v_ffbl_b32 v120, v120
    v_max_i32 v84, v84, v120
    s_mov_b64 exec, -1
    v_lshl_add_u32 v59, -1, v84, v59

    v_lshl_add_u32 v61, v84, 1, v31
    ds_read_u16 v80, v61 offset:40
    s_setprio 0
    v_ffbl_b32 v84, v59
    v_perm_b32 v60, v77, v76, v84
    v_and_or_b32 v60, v60, s66, v85

    v_cmpx_ge_u32 vcc, 1, v84
    ds_add_u32 v60, v10
    s_not_b64 s[70:71], vcc
    s_mov_b64 exec, s[70:71]
    ds_add_rtn_u32 v87, v60, v10
    s_mov_b64 exec, -1

    ds_wrxchg_rtn_b32 v116, v86, v13
    s_cmp_ge_u32 s57, 800
    s_cbranch_scc1 standalone__deep_cross_pnn__recsys_kernel_nr21
    v_perm_b32 v248, v167, v163, s84
    v_perm_b32 v249, v175, v171, s84
    v_perm_b32 v250, v183, v179, s84
    v_perm_b32 v251, v191, v187, s84
    s_add_u32 s83, s82, 7185920
    buffer_store_dwordx4 v[248:251], v14, s[32:35], s83 offen sc1
    v_perm_b32 v252, v167, v163, s85
    v_perm_b32 v253, v175, v171, s85
    v_perm_b32 v254, v183, v179, s85
    v_perm_b32 v255, v191, v187, s85
    s_add_u32 s83, s82, 7288576
    buffer_store_dwordx4 v[252:255], v14, s[32:35], s83 offen sc1
standalone__deep_cross_pnn__recsys_kernel_nr21:
    buffer_store_dwordx4 v[108:111], v9, s[12:15], s6 offen offset:2048 sc1
    buffer_store_dwordx4 v[108:111], v9, s[12:15], s6 offen offset:3072 sc1

    s_waitcnt lgkmcnt(0)
    v_cmp_gt_u32 s[68:69], 2, v116

    s_mov_b64 exec, s[70:71]
    v_cmpx_le_u32 vcc, 2, v87
    v_mov_b32 v62, s69
    v_perm_b32 v121, v62, s68, v6
    v_perm_b32 v122, v62, s68, v5
    v_and_b32 v121, v121, v22
    v_and_b32 v122, v122, v21
    v_msad_u8 v120, v70, v121, 0
    v_lshlrev_b32 v120, 8, v120
    v_msad_u8 v120, v63, v122, v120
    v_and_b32 v120, v120, v59

    v_ffbl_b32 v120, v120
    v_max_i32 v84, v84, v120
    s_mov_b64 exec, -1
    v_lshl_add_u32 v59, -1, v84, v59

    v_lshl_add_u32 v61, v84, 1, v31
    ds_read_u16 v81, v61 offset:40
    s_setprio 1
    v_ffbl_b32 v84, v59
    v_perm_b32 v60, v77, v76, v84
    v_and_or_b32 v60, v60, s66, v85

    v_cmpx_ge_u32 vcc, 2, v84
    ds_add_u32 v60, v10
    s_not_b64 s[70:71], vcc
    s_mov_b64 exec, s[70:71]
    ds_add_rtn_u32 v87, v60, v10
    s_mov_b64 exec, -1

    ds_wrxchg_rtn_b32 v116, v86, v13
    buffer_store_dwordx4 v[108:111], v9, s[12:15], s7 offen offset:0 sc1
    buffer_store_dwordx4 v[108:111], v9, s[12:15], s7 offen offset:1024 sc1

    s_waitcnt lgkmcnt(0)
    v_cmp_gt_u32 s[68:69], 2, v116

    s_mov_b64 exec, s[70:71]
    v_cmpx_le_u32 vcc, 2, v87
    v_mov_b32 v62, s69
    v_perm_b32 v121, v62, s68, v6
    v_perm_b32 v122, v62, s68, v5
    v_and_b32 v121, v121, v22
    v_and_b32 v122, v122, v21
    v_msad_u8 v120, v70, v121, 0
    v_lshlrev_b32 v120, 8, v120
    v_msad_u8 v120, v63, v122, v120
    v_and_b32 v120, v120, v59

    v_ffbl_b32 v120, v120
    v_max_i32 v84, v84, v120
    s_mov_b64 exec, -1
    v_lshl_add_u32 v59, -1, v84, v59

    v_lshl_add_u32 v61, v84, 1, v31
    ds_read_u16 v82, v61 offset:40
    s_setprio 0
    v_ffbl_b32 v84, v59
    v_perm_b32 v60, v77, v76, v84
    v_and_or_b32 v60, v60, s66, v85

    v_cmpx_ge_u32 vcc, 3, v84
    ds_add_u32 v60, v10
    s_not_b64 s[70:71], vcc
    s_mov_b64 exec, s[70:71]
    ds_add_rtn_u32 v87, v60, v10
    s_mov_b64 exec, -1

    ds_wrxchg_rtn_b32 v116, v86, v13
    buffer_store_dwordx4 v[108:111], v9, s[12:15], s7 offen offset:2048 sc1
    buffer_store_dwordx4 v[108:111], v9, s[12:15], s7 offen offset:3072 sc1
    buffer_store_dwordx2 v[108:109], v30, s[12:15], s8 offen sc1
    s_mov_b64 exec, 0xff
    buffer_load_dword v104, v9, s[52:55], 0 offen offset:128 sc1
    s_mov_b64 exec, -1

    s_waitcnt lgkmcnt(0)
    v_cmp_gt_u32 s[68:69], 2, v116

    s_mov_b64 exec, s[70:71]
    v_cmpx_le_u32 vcc, 2, v87
    v_mov_b32 v62, s69
    v_perm_b32 v121, v62, s68, v6
    v_and_b32 v121, v121, v22
    v_msad_u8 v120, v70, v121, 0
    v_and_b32_sdwa v120, v120, v59 dst_sel:BYTE_1 dst_unused:UNUSED_PAD src0_sel:DWORD src1_sel:BYTE_1
    s_nop 0

    v_ffbl_b32 v120, v120
    v_max_i32 v84, v84, v120
    s_mov_b64 exec, -1
    v_lshl_add_u32 v59, -1, v84, v59

    v_lshl_add_u32 v61, v84, 1, v31
    ds_read_u16 v83, v61 offset:40

    s_bitcmp1_b32 s59, 0
    s_cbranch_scc1 standalone__deep_cross_pnn__recsys_kernel_sk6
    v_mov_b32 v60, s46
    ds_write_b32 v86, v59
    ds_write_b32 v60, v10
    s_branch standalone__deep_cross_pnn__recsys_kernel_sdone

standalone__deep_cross_pnn__recsys_kernel_sk6:
    v_lshrrev_b32 v59, 4, v59
    v_add_u32 v63, v58, v22
    s_setprio 1
    v_ffbl_b32 v84, v59
    v_perm_b32 v60, v78, v77, v84

    v_cmp_lt_u32 vcc, 7, v84
    v_alignbyte_b32 v61, v79, v79, v84
    s_nop 0
    v_cndmask_b32 v60, v60, v61, vcc

    v_and_or_b32 v60, v60, s66, v85
    ds_add_rtn_u32 v87, v60, v10
    ds_wrxchg_rtn_b32 v116, v86, v13

    s_waitcnt lgkmcnt(0)
    v_cmp_gt_u32 s[68:69], 2, v116

    v_lshl_or_b32 v24, v81, 16, v80
    v_lshl_or_b32 v25, v83, 16, v82
    buffer_store_dwordx2 v[24:25], v30, s[32:35], s62 offen sc1
    s_add_u32 s62, s62, s63
    s_nop 0
    v_cmpx_le_u32 vcc, 2, v87
    v_mov_b32 v62, s69
    v_perm_b32 v121, v62, s68, v7
    v_perm_b32 v122, v62, s68, v6
    v_perm_b32 v123, v62, s68, v5
    v_and_b32 v121, v121, v23
    v_and_b32 v122, v122, v22
    v_and_b32 v123, v123, v21
    v_msad_u8 v120, v71, v121, 0
    v_lshlrev_b32 v120, 8, v120
    v_msad_u8 v120, v63, v122, v120
    v_msad_u8 v120, v69, v123, v120
    v_and_b32 v120, v120, v59

    v_ffbl_b32 v120, v120
    v_max_i32 v84, v84, v120
    s_mov_b64 exec, -1
    v_lshl_add_u32 v59, -1, v84, v59

    v_lshl_add_u32 v61, v84, 1, v31
    ds_read_u16 v80, v61 offset:48
    v_ffbl_b32 v84, v59
    v_perm_b32 v60, v78, v77, v84

    v_cmp_lt_u32 vcc, 7, v84
    v_alignbyte_b32 v61, v79, v79, v84
    s_nop 0
    v_cndmask_b32 v60, v60, v61, vcc

    v_and_or_b32 v60, v60, s66, v85
    ds_add_rtn_u32 v87, v60, v10
    ds_wrxchg_rtn_b32 v116, v86, v13

    s_waitcnt lgkmcnt(0)
    v_cmp_gt_u32 s[68:69], 2, v116

    s_nop 0
    v_cmpx_le_u32 vcc, 2, v87
    v_mov_b32 v62, s69
    v_perm_b32 v121, v62, s68, v7
    v_perm_b32 v122, v62, s68, v6
    v_perm_b32 v123, v62, s68, v5
    v_and_b32 v121, v121, v23
    v_and_b32 v122, v122, v22
    v_and_b32 v123, v123, v21
    v_msad_u8 v120, v71, v121, 0
    v_lshlrev_b32 v120, 8, v120
    v_msad_u8 v120, v63, v122, v120
    v_msad_u8 v120, v69, v123, v120
    v_and_b32 v120, v120, v59

    v_ffbl_b32 v120, v120
    v_max_i32 v84, v84, v120
    s_mov_b64 exec, -1
    v_lshl_add_u32 v59, -1, v84, v59

    v_lshl_add_u32 v61, v84, 1, v31
    ds_read_u16 v81, v61 offset:48
    v_ffbl_b32 v84, v59
    v_perm_b32 v60, v78, v77, v84

    v_cmp_lt_u32 vcc, 7, v84
    v_alignbyte_b32 v61, v79, v79, v84
    s_nop 0
    v_cndmask_b32 v60, v60, v61, vcc

    v_and_or_b32 v60, v60, s66, v85
    ds_add_rtn_u32 v87, v60, v10
    ds_wrxchg_rtn_b32 v116, v86, v13

    s_waitcnt lgkmcnt(0)
    v_cmp_gt_u32 s[68:69], 2, v116

    s_nop 0
    v_cmpx_le_u32 vcc, 2, v87
    v_mov_b32 v62, s69
    v_perm_b32 v121, v62, s68, v7
    v_perm_b32 v122, v62, s68, v6
    v_perm_b32 v123, v62, s68, v5
    v_and_b32 v121, v121, v23
    v_and_b32 v122, v122, v22
    v_and_b32 v123, v123, v21
    v_msad_u8 v120, v71, v121, 0
    v_lshlrev_b32 v120, 8, v120
    v_msad_u8 v120, v63, v122, v120
    v_msad_u8 v120, v69, v123, v120
    v_and_b32 v120, v120, v59

    v_ffbl_b32 v120, v120
    v_max_i32 v84, v84, v120
    s_mov_b64 exec, -1
    v_lshl_add_u32 v59, -1, v84, v59

    v_lshl_add_u32 v61, v84, 1, v31
    ds_read_u16 v82, v61 offset:48
    v_ffbl_b32 v84, v59
    v_lshl_add_u32 v61, v84, 1, v31
    ds_read_u16 v83, v61 offset:48
standalone__deep_cross_pnn__recsys_kernel_sdone:
    s_waitcnt lgkmcnt(0)
    v_lshl_or_b32 v24, v81, 16, v80
    v_lshl_or_b32 v25, v83, 16, v82
    buffer_store_dwordx2 v[24:25], v30, s[32:35], s62 offen sc1
    s_add_u32 s62, s62, s63
standalone__deep_cross_pnn__recsys_kernel_udone:
    s_setprio 0

    s_waitcnt vmcnt(0)

    s_mov_b64 exec, 1
    ds_add_rtn_u32 v12, v11, v10 offset:20
    s_mov_b32 s49, 0
    s_waitcnt lgkmcnt(0)
    v_readfirstlane_b32 s48, v12
    s_and_b32 s48, s48, 3

    s_mov_b64 exec, 0xff
standalone__deep_cross_pnn__recsys_kernel_ec1:

    v_cmp_ne_u32 vcc, -1, v104
    s_cbranch_vccz standalone__deep_cross_pnn__recsys_kernel_tbl
    buffer_load_dword v104, v9, s[52:55], 0 offen offset:128 sc1
    s_add_u32 s49, s49, 1
    s_waitcnt vmcnt(0)
    s_cmp_lt_u32 s49, 12
    s_cbranch_scc1 standalone__deep_cross_pnn__recsys_kernel_ec1
    s_branch standalone__deep_cross_pnn__recsys_kernel_enx

standalone__deep_cross_pnn__recsys_kernel_hset:

    s_lshl_b32 s39, 1, s51
    s_lshr_b32 s38, s51, 5
    v_mov_b32 v1, s39
    s_lshl_b32 s38, s38, 4
    s_mov_b64 exec, 1
    buffer_atomic_or v1, v13, s[52:55], s38 offen offset:132
    s_mov_b64 exec, -1
    s_waitcnt vmcnt(0)
    s_branch standalone__deep_cross_pnn__recsys_kernel_slow

standalone__deep_cross_pnn__recsys_kernel_tbl:
    s_mov_b64 exec, -1
    s_mov_b32 s49, -1

    s_xor_b32 s44, s50, 1
    s_lshl_b32 s44, s44, 3
    s_add_u32 s44, s44, s56
    s_lshl_b32 s44, s44, 14
    s_add_u32 s44, s44, 15204352
    s_add_u32 s47, s44, 65536

    buffer_load_dwordx4 v[136:139], v9, s[12:15], s44 offen offset:0 sc1
    buffer_load_dwordx4 v[140:143], v9, s[12:15], s44 offen offset:1024 sc1
    buffer_load_dwordx4 v[152:155], v9, s[12:15], s44 offen offset:2048 sc1
    buffer_load_dwordx4 v[156:159], v9, s[12:15], s44 offen offset:3072 sc1
    s_add_u32 s44, s44, 4096
    buffer_load_dwordx4 v[168:171], v9, s[12:15], s44 offen offset:0 sc1
    buffer_load_dwordx4 v[172:175], v9, s[12:15], s44 offen offset:1024 sc1
    buffer_load_dwordx4 v[184:187], v9, s[12:15], s44 offen offset:2048 sc1
    buffer_load_dwordx4 v[188:191], v9, s[12:15], s44 offen offset:3072 sc1
    s_add_u32 s44, s44, 4096
    s_waitcnt vmcnt(7)
    buffer_load_dwordx4 v[200:203], v9, s[12:15], s44 offen offset:0 sc1
    s_waitcnt vmcnt(7)
    buffer_load_dwordx4 v[204:207], v9, s[12:15], s44 offen offset:1024 sc1
    s_waitcnt vmcnt(7)
    buffer_load_dwordx4 v[216:219], v9, s[12:15], s44 offen offset:2048 sc1
    s_waitcnt vmcnt(7)
    buffer_load_dwordx4 v[220:223], v9, s[12:15], s44 offen offset:3072 sc1
    s_add_u32 s44, s44, 4096
    s_waitcnt vmcnt(7)
    buffer_load_dwordx4 v[232:235], v9, s[12:15], s44 offen offset:0 sc1
    s_waitcnt vmcnt(7)
    buffer_load_dwordx4 v[236:239], v9, s[12:15], s44 offen offset:1024 sc1
    s_waitcnt vmcnt(7)
    buffer_load_dwordx4 v[248:251], v9, s[12:15], s44 offen offset:2048 sc1
    s_waitcnt vmcnt(7)
    buffer_load_dwordx4 v[252:255], v9, s[12:15], s44 offen offset:3072 sc1
    s_add_u32 s44, s44, 4096
    s_waitcnt vmcnt(7)
    buffer_load_dwordx4 v[88:91], v9, s[12:15], s47 offen offset:0 sc1
    s_waitcnt vmcnt(7)
    buffer_load_dwordx4 v[88:91], v9, s[12:15], s47 offen offset:1024 sc1
    s_waitcnt vmcnt(7)
    buffer_load_dwordx4 v[88:91], v9, s[12:15], s47 offen offset:2048 sc1
    s_waitcnt vmcnt(7)
    buffer_load_dwordx4 v[88:91], v9, s[12:15], s47 offen offset:3072 sc1
    s_add_u32 s47, s47, 4096
    s_waitcnt vmcnt(7)
    buffer_load_dwordx4 v[88:91], v9, s[12:15], s47 offen offset:0 sc1
    s_waitcnt vmcnt(7)
    buffer_load_dwordx4 v[88:91], v9, s[12:15], s47 offen offset:1024 sc1
    s_waitcnt vmcnt(7)
    buffer_load_dwordx4 v[88:91], v9, s[12:15], s47 offen offset:2048 sc1
    s_waitcnt vmcnt(7)
    buffer_load_dwordx4 v[88:91], v9, s[12:15], s47 offen offset:3072 sc1
    s_add_u32 s47, s47, 4096
    s_waitcnt vmcnt(7)
    buffer_load_dwordx4 v[88:91], v9, s[12:15], s47 offen offset:0 sc1
    s_waitcnt vmcnt(7)
    buffer_load_dwordx4 v[88:91], v9, s[12:15], s47 offen offset:1024 sc1
    s_waitcnt vmcnt(7)
    buffer_load_dwordx4 v[88:91], v9, s[12:15], s47 offen offset:2048 sc1
    s_waitcnt vmcnt(7)
    buffer_load_dwordx4 v[88:91], v9, s[12:15], s47 offen offset:3072 sc1
    s_add_u32 s47, s47, 4096
    s_waitcnt vmcnt(7)
    buffer_load_dwordx4 v[88:91], v9, s[12:15], s47 offen offset:0 sc1
    s_waitcnt vmcnt(7)
    buffer_load_dwordx4 v[88:91], v9, s[12:15], s47 offen offset:1024 sc1
    s_waitcnt vmcnt(7)
    buffer_load_dwordx4 v[88:91], v9, s[12:15], s47 offen offset:2048 sc1
    s_waitcnt vmcnt(7)
    buffer_load_dwordx4 v[88:91], v9, s[12:15], s47 offen offset:3072 sc1
    s_add_u32 s47, s47, 4096
standalone__deep_cross_pnn__recsys_kernel_enx:

    s_mov_b64 exec, -1
    s_mul_i32 s85, s56, 18432
    v_and_b32 v25, 15, v8
    v_lshrrev_b32 v26, 4, v8
    v_mul_u32_u24 v24, 144, v25
    v_lshl_add_u32 v24, v26, 4, v24
    v_add_u32 v24, s85, v24

    s_lshr_b32 s79, s2, 1
    s_mul_i32 s77, s79, 102656
    s_lshl_b32 s85, s50, 11
    s_xor_b32 s78, s85, 2048
    s_add_u32 s78, s78, s77
    s_add_u32 s77, s77, s85
    s_and_b32 s79, s2, 1
    s_mul_i32 s79, s79, 1638400
    s_add_u32 s79, s79, 16777216
    s_lshl_b32 s85, s3, 13
    s_add_u32 s79, s79, s85
    s_xor_b32 s85, s3, 4
    s_lshl_b32 s85, s85, 10
    s_bitcmp1_b32 s2, 1
    s_cselect_b32 s83, 0, 16
    s_lshl_b32 s80, s24, s83
    s_lshl_b32 s81, s25, s83
    s_lshl_b32 s82, s26, s83
    s_lshl_b32 s83, s27, s83
    s_and_b32 s80, s80, 0xffff0000
    s_and_b32 s81, s81, 0xffff0000
    s_and_b32 s82, s82, 0xffff0000
    s_and_b32 s83, s83, 0xffff0000
    ds_read_b128 v[128:131], v24 offset:0
    ds_read_b128 v[132:135], v24 offset:64
    v_lshlrev_b32 v69, 4, v8
    v_lshlrev_b32 v70, 13, v26
    v_lshl_add_u32 v70, v25, 3, v70
    v_add_u32 v70, s85, v70
    ds_read_b128 v[144:147], v24 offset:2304
    ds_read_b128 v[148:151], v24 offset:2368
    v_lshrrev_b32 v28, 3, v8
    v_xor_b32 v28, v28, v26
    v_and_b32 v28, 1, v28
    v_bfe_u32 v29, v8, 2, 1
    ds_read_b128 v[160:163], v24 offset:4608
    ds_read_b128 v[164:167], v24 offset:4672
    v_lshl_or_b32 v28, v28, 1, v29
    v_mov_b32 v30, 0x3f80
    v_cmp_eq_u32 vcc, 0, v28
    v_cmp_eq_u32 s[68:69], 1, v28
    ds_read_b128 v[176:179], v24 offset:6912
    ds_read_b128 v[180:183], v24 offset:6976
    v_and_b32 v29, 3, v8
    v_mul_u32_u24 v68, 0x5555, v29
    v_cndmask_b32 v64, 0, v30, vcc
    v_cndmask_b32 v65, 0, v30, vcc
    ds_read_b128 v[192:195], v24 offset:9216
    ds_read_b128 v[196:199], v24 offset:9280
    v_cndmask_b32 v66, 0, v30, s[68:69]
    v_cndmask_b32 v67, 0, v30, s[68:69]
    v_add_u32 v114, 144256, v69
    v_add_u32 v71, 0x10000, v70
    ds_read_b128 v[208:211], v24 offset:11520
    ds_read_b128 v[212:215], v24 offset:11584
    v_mov_b64 v[32:33], s[80:81]
    v_mov_b64 v[34:35], s[82:83]
    v_mov_b64 v[36:37], s[80:81]
    v_mov_b64 v[38:39], s[82:83]
    ds_read_b128 v[224:227], v24 offset:13824
    ds_read_b128 v[228:231], v24 offset:13888
    v_mov_b64 v[40:41], s[80:81]
    v_mov_b64 v[42:43], s[82:83]
    v_mov_b64 v[44:45], s[80:81]
    v_mov_b64 v[46:47], s[82:83]
    ds_read_b128 v[240:243], v24 offset:16128
    ds_read_b128 v[244:247], v24 offset:16192
    v_mov_b64 v[48:49], s[80:81]
    v_mov_b64 v[50:51], s[82:83]
    v_mov_b64 v[52:53], s[80:81]
    v_mov_b64 v[54:55], s[82:83]
    v_mov_b64 v[56:57], s[80:81]
    v_mov_b64 v[58:59], s[82:83]
    v_mov_b64 v[60:61], s[80:81]
    v_mov_b64 v[62:63], s[82:83]

    s_bitcmp1_b32 s56, 1
    s_cselect_b32 s84, s78, s77
    s_lshl_b32 s85, s56, 10
    s_add_u32 m0, s85, 144256
    s_and_b32 s85, s85, 1024
    s_add_u32 s84, s84, s85

    s_add_u32 s85, s84, 0
    buffer_load_dwordx4 v[88:91], v69, s[12:15], s85 offen sc1
    s_add_u32 s85, s84, 4096
    buffer_load_dwordx4 v[88:91], v69, s[12:15], s85 offen sc1
    s_add_u32 s85, s84, 8192
    buffer_load_dwordx4 v[88:91], v69, s[12:15], s85 offen sc1
    s_add_u32 s85, s84, 12288
    buffer_load_dwordx4 v[88:91], v69, s[12:15], s85 offen sc1

    s_cmp_lg_u32 s48, 0
    s_cbranch_scc1 standalone__deep_cross_pnn__recsys_kernel_wdec
    s_mov_b64 exec, -1
    v_lshlrev_b32 v0, 7, v8
    v_lshrrev_b32 v2, 5, v8
    v_lshlrev_b32 v2, 4, v2
    v_lshlrev_b32 v3, 2, v8
    s_mov_b32 s44, 14680064
    s_bfe_u32 s46, s2, 131072
    s_lshl_b32 s47, s46, 7
    s_add_u32 s47, s47, 14688256
    s_lshl_b32 s46, s46, 2
    s_mov_b32 s38, 3221225472

standalone__deep_cross_pnn__recsys_kernel_p0:

    ds_read_b32 v12, v11 offset:20
    s_waitcnt lgkmcnt(0)
    v_readfirstlane_b32 s45, v12
    s_and_b32 s45, s45, 3
    s_cbranch_scc0 standalone__deep_cross_pnn__recsys_kernel_p1s
    s_sleep 1
    s_branch standalone__deep_cross_pnn__recsys_kernel_p0

standalone__deep_cross_pnn__recsys_kernel_p1s:

    s_cmp_lg_u32 s64, 0
    s_cbranch_scc1 standalone__deep_cross_pnn__recsys_kernel_hset

    s_mov_b64 exec, 1
    s_cmp_lg_u32 s49, -1
    s_cbranch_scc1 standalone__deep_cross_pnn__recsys_kernel_nfp
    v_mov_b32 v1, 1
    buffer_atomic_add v1, v13, s[12:15], s47 offen sc0
    buffer_store_dword v10, v13, s[12:15], s9 offen sc1
    s_waitcnt vmcnt(1)
    v_cmpx_eq_u32 vcc, 63, v1
    buffer_store_dword v10, v13, s[52:55], s46 offen sc1
    s_mov_b64 exec, 0xf

standalone__deep_cross_pnn__recsys_kernel_p1:

    buffer_load_dword v1, v3, s[52:55], 0 offen sc1
    s_add_u32 s65, s65, 1
    s_waitcnt vmcnt(0)
    v_cmp_eq_u32 vcc, 0, v1
    s_cbranch_vccz standalone__deep_cross_pnn__recsys_kernel_dec
    s_sleep 4
    s_cmp_lt_u32 s65, 200
    s_cbranch_scc1 standalone__deep_cross_pnn__recsys_kernel_p1
    s_mov_b64 exec, 1

standalone__deep_cross_pnn__recsys_kernel_nfp:

    buffer_store_dword v10, v13, s[12:15], s9 offen sc1
    s_mov_b64 exec, -1

standalone__deep_cross_pnn__recsys_kernel_slow:
    buffer_load_dwordx2 v[16:17], v2, s[52:55], 0 offen offset:128 sc1
    buffer_load_dwordx2 v[18:19], v2, s[52:55], 0 offen offset:160 sc1
    buffer_load_dwordx2 v[20:21], v2, s[52:55], 0 offen offset:192 sc1
    buffer_load_dwordx2 v[22:23], v2, s[52:55], 0 offen offset:224 sc1

    s_waitcnt vmcnt(0)
    buffer_load_dwordx4 v[4:7], v0, s[12:15], s44 offen sc1
    s_add_u32 s65, s65, 1
    s_waitcnt vmcnt(0)

    v_bfe_u32 v16, v16, v8, 1
    v_bfe_u32 v17, v17, v8, 1
    v_and_b32 v4, v4, v16
    v_or_b32 v17, v17, v4

    v_bfe_u32 v18, v18, v8, 1
    v_bfe_u32 v19, v19, v8, 1
    v_and_b32 v5, v5, v18
    v_or_b32 v19, v19, v5

    v_bfe_u32 v20, v20, v8, 1
    v_bfe_u32 v21, v21, v8, 1
    v_and_b32 v6, v6, v20
    v_or_b32 v21, v21, v6

    v_bfe_u32 v22, v22, v8, 1
    v_bfe_u32 v23, v23, v8, 1
    v_and_b32 v7, v7, v22
    v_or_b32 v23, v23, v7

    v_min3_u32 v1, v4, v5, v6
    v_min_u32 v1, v1, v7
    v_cmp_eq_u32 vcc, 0, v1
    s_mov_b32 s38, 3221225472
    s_cbranch_vccz standalone__deep_cross_pnn__recsys_kernel_dec
    v_min3_u32 v1, v17, v19, v21
    v_min_u32 v1, v1, v23
    v_cmp_eq_u32 vcc, 0, v1
    s_mov_b32 s38, 2147483648
    s_cbranch_vccz standalone__deep_cross_pnn__recsys_kernel_dec
    s_cmp_lt_u32 s65, 200
    s_cbranch_scc1 standalone__deep_cross_pnn__recsys_kernel_slow

    v_cmp_eq_u32 vcc, 0, v17
    s_movk_i32 s38, 0
    s_cbranch_vccnz standalone__deep_cross_pnn__recsys_kernel_fnd
    v_cmp_eq_u32 vcc, 0, v19
    s_movk_i32 s38, 64
    s_cbranch_vccnz standalone__deep_cross_pnn__recsys_kernel_fnd
    v_cmp_eq_u32 vcc, 0, v21
    s_movk_i32 s38, 128
    s_cbranch_vccnz standalone__deep_cross_pnn__recsys_kernel_fnd
    v_cmp_eq_u32 vcc, 0, v23
    s_movk_i32 s38, 192
standalone__deep_cross_pnn__recsys_kernel_fnd:

    s_ff1_i32_b64 s39, vcc
    s_add_u32 s38, s38, s39
    s_andn2_b32 s39, s64, 255
    s_add_u32 s39, s39, 256
    s_or_b32 s38, s38, s39

standalone__deep_cross_pnn__recsys_kernel_dec:

    s_mov_b64 exec, 1
    v_mov_b32 v1, s38
    ds_write_b32 v11, v1 offset:24

standalone__deep_cross_pnn__recsys_kernel_wdec:

    s_mov_b64 exec, -1
    ds_read_b32 v12, v11 offset:24
    s_waitcnt lgkmcnt(0)
    v_readfirstlane_b32 s45, v12
    s_cmp_lg_u32 s45, s64
    s_cbranch_scc1 standalone__deep_cross_pnn__recsys_kernel_gotd
    s_sleep 2
    s_branch standalone__deep_cross_pnn__recsys_kernel_wdec

standalone__deep_cross_pnn__recsys_kernel_hlp:
    s_waitcnt vmcnt(0)
    s_branch standalone__deep_cross_pnn__recsys_kernel_unit
standalone__deep_cross_pnn__recsys_kernel_gotd:

    s_mov_b32 s64, s45
    s_and_b32 s51, s45, 255

    s_mov_b32 s65, 200
    s_bitcmp0_b32 s45, 31
    s_cbranch_scc1 standalone__deep_cross_pnn__recsys_kernel_hlp

    s_cmp_eq_u32 s49, -1
    s_cbranch_scc1 standalone__deep_cross_pnn__recsys_kernel_k2

    s_xor_b32 s44, s50, 1
    s_lshl_b32 s44, s44, 3
    s_add_u32 s44, s44, s56
    s_lshl_b32 s44, s44, 14
    s_add_u32 s44, s44, 15204352
    s_add_u32 s47, s44, 65536

    buffer_load_dwordx4 v[136:139], v9, s[12:15], s44 offen offset:0 sc1
    buffer_load_dwordx4 v[140:143], v9, s[12:15], s44 offen offset:1024 sc1
    buffer_load_dwordx4 v[152:155], v9, s[12:15], s44 offen offset:2048 sc1
    buffer_load_dwordx4 v[156:159], v9, s[12:15], s44 offen offset:3072 sc1
    s_add_u32 s44, s44, 4096
    buffer_load_dwordx4 v[168:171], v9, s[12:15], s44 offen offset:0 sc1
    buffer_load_dwordx4 v[172:175], v9, s[12:15], s44 offen offset:1024 sc1
    buffer_load_dwordx4 v[184:187], v9, s[12:15], s44 offen offset:2048 sc1
    buffer_load_dwordx4 v[188:191], v9, s[12:15], s44 offen offset:3072 sc1
    s_add_u32 s44, s44, 4096
    s_waitcnt vmcnt(7)
    buffer_load_dwordx4 v[200:203], v9, s[12:15], s44 offen offset:0 sc1
    s_waitcnt vmcnt(7)
    buffer_load_dwordx4 v[204:207], v9, s[12:15], s44 offen offset:1024 sc1
    s_waitcnt vmcnt(7)
    buffer_load_dwordx4 v[216:219], v9, s[12:15], s44 offen offset:2048 sc1
    s_waitcnt vmcnt(7)
    buffer_load_dwordx4 v[220:223], v9, s[12:15], s44 offen offset:3072 sc1
    s_add_u32 s44, s44, 4096
    s_waitcnt vmcnt(7)
    buffer_load_dwordx4 v[232:235], v9, s[12:15], s44 offen offset:0 sc1
    s_waitcnt vmcnt(7)
    buffer_load_dwordx4 v[236:239], v9, s[12:15], s44 offen offset:1024 sc1
    s_waitcnt vmcnt(7)
    buffer_load_dwordx4 v[248:251], v9, s[12:15], s44 offen offset:2048 sc1
    s_waitcnt vmcnt(7)
    buffer_load_dwordx4 v[252:255], v9, s[12:15], s44 offen offset:3072 sc1
    s_add_u32 s44, s44, 4096
    s_waitcnt vmcnt(7)
    buffer_load_dwordx4 v[88:91], v9, s[12:15], s47 offen offset:0 sc1
    s_waitcnt vmcnt(7)
    buffer_load_dwordx4 v[88:91], v9, s[12:15], s47 offen offset:1024 sc1
    s_waitcnt vmcnt(7)
    buffer_load_dwordx4 v[88:91], v9, s[12:15], s47 offen offset:2048 sc1
    s_waitcnt vmcnt(7)
    buffer_load_dwordx4 v[88:91], v9, s[12:15], s47 offen offset:3072 sc1
    s_add_u32 s47, s47, 4096
    s_waitcnt vmcnt(7)
    buffer_load_dwordx4 v[88:91], v9, s[12:15], s47 offen offset:0 sc1
    s_waitcnt vmcnt(7)
    buffer_load_dwordx4 v[88:91], v9, s[12:15], s47 offen offset:1024 sc1
    s_waitcnt vmcnt(7)
    buffer_load_dwordx4 v[88:91], v9, s[12:15], s47 offen offset:2048 sc1
    s_waitcnt vmcnt(7)
    buffer_load_dwordx4 v[88:91], v9, s[12:15], s47 offen offset:3072 sc1
    s_add_u32 s47, s47, 4096
    s_waitcnt vmcnt(7)
    buffer_load_dwordx4 v[88:91], v9, s[12:15], s47 offen offset:0 sc1
    s_waitcnt vmcnt(7)
    buffer_load_dwordx4 v[88:91], v9, s[12:15], s47 offen offset:1024 sc1
    s_waitcnt vmcnt(7)
    buffer_load_dwordx4 v[88:91], v9, s[12:15], s47 offen offset:2048 sc1
    s_waitcnt vmcnt(7)
    buffer_load_dwordx4 v[88:91], v9, s[12:15], s47 offen offset:3072 sc1
    s_add_u32 s47, s47, 4096
    s_waitcnt vmcnt(7)
    buffer_load_dwordx4 v[88:91], v9, s[12:15], s47 offen offset:0 sc1
    s_waitcnt vmcnt(7)
    buffer_load_dwordx4 v[88:91], v9, s[12:15], s47 offen offset:1024 sc1
    s_waitcnt vmcnt(7)
    buffer_load_dwordx4 v[88:91], v9, s[12:15], s47 offen offset:2048 sc1
    s_waitcnt vmcnt(7)
    buffer_load_dwordx4 v[88:91], v9, s[12:15], s47 offen offset:3072 sc1
    s_add_u32 s47, s47, 4096
standalone__deep_cross_pnn__recsys_kernel_k2:
    s_setprio 1
    buffer_load_dwordx4 v[0:3], v69, s[12:15], s77 offen offset:0 sc1
    buffer_load_dwordx4 v[4:7], v69, s[12:15], s77 offen offset:1024 sc1
    buffer_load_dwordx4 v[8:11], v69, s[12:15], s78 offen offset:0 sc1
    buffer_load_dwordx4 v[12:15], v69, s[12:15], s78 offen offset:1024 sc1
    buffer_load_dwordx4 v69, s[12:15], s84 offen sc1 lds
    s_add_u32 m0, m0, 4096
    s_add_u32 s84, s84, 4096
    buffer_load_dwordx4 v69, s[12:15], s84 offen sc1 lds
    s_add_u32 m0, m0, 4096
    s_add_u32 s84, s84, 4096
    buffer_load_dwordx4 v69, s[12:15], s84 offen sc1 lds
    s_add_u32 s44, s77, 4096
    s_add_u32 s45, s78, 4096
    buffer_load_dwordx4 v[16:19], v69, s[12:15], s44 offen offset:0 sc1
    buffer_load_dwordx4 v[20:23], v69, s[12:15], s44 offen offset:1024 sc1
    buffer_load_dwordx4 v[24:27], v69, s[12:15], s45 offen offset:0 sc1
    buffer_load_dwordx4 v[28:31], v69, s[12:15], s45 offen offset:1024 sc1
    s_barrier
    s_waitcnt vmcnt(7)
    v_mfma_f32_16x16x32_bf16 v[88:91], v[0:3], v[128:131], 0
    v_mfma_f32_16x16x32_bf16 v[92:95], v[0:3], v[144:147], 0
    s_add_u32 s21, s77, 12288
    v_mfma_f32_16x16x32_bf16 v[88:91], v[4:7], v[132:135], v[88:91]
    s_add_u32 s19, s78, 12288
    v_mfma_f32_16x16x32_bf16 v[92:95], v[4:7], v[148:151], v[92:95]
    s_mov_b32 s20, s79
    v_mfma_f32_16x16x32_bf16 v[88:91], v[8:11], v[136:139], v[88:91]
    s_lshr_b32 s33, s2, 1
    v_mfma_f32_16x16x32_bf16 v[92:95], v[8:11], v[152:155], v[92:95]
    s_and_b32 s34, s2, 1
    v_mfma_f32_16x16x32_bf16 v[88:91], v[12:15], v[140:143], v[88:91]
    s_load_dwordx4 s[56:59], s[0:1], 48
    s_load_dword s28, s[10:11], 0
    s_load_dword s29, s[10:11], 16
    s_load_dword s30, s[10:11], 32
    s_load_dword s31, s[10:11], 48
    v_mfma_f32_16x16x32_bf16 v[92:95], v[12:15], v[156:159], v[92:95]
    v_mfma_f32_16x16x32_bf16 v[96:99], v[0:3], v[160:163], 0
    v_mfma_f32_16x16x32_bf16 v[100:103], v[0:3], v[176:179], 0
    v_mfma_f32_16x16x32_bf16 v[96:99], v[4:7], v[164:167], v[96:99]
    v_cvt_pk_bf16_f32 v116, v88, v89
    v_mfma_f32_16x16x32_bf16 v[100:103], v[4:7], v[180:183], v[100:103]
    v_cvt_pk_bf16_f32 v117, v90, v91
    v_mfma_f32_16x16x32_bf16 v[96:99], v[8:11], v[168:171], v[96:99]
    v_mfma_f32_16x16x32_bf16 v[100:103], v[8:11], v[184:187], v[100:103]
    v_cvt_pk_bf16_f32 v118, v92, v93
    v_mfma_f32_16x16x32_bf16 v[96:99], v[12:15], v[172:175], v[96:99]
    v_cvt_pk_bf16_f32 v119, v94, v95
    v_mfma_f32_16x16x32_bf16 v[100:103], v[12:15], v[188:191], v[100:103]
    v_mfma_f32_16x16x32_bf16 v[104:107], v[0:3], v[192:195], 0
    v_mfma_f32_16x16x32_bf16 v[108:111], v[0:3], v[208:211], 0
    v_mfma_f32_16x16x32_bf16 v[104:107], v[4:7], v[196:199], v[104:107]
    v_cvt_pk_bf16_f32 v120, v96, v97
    v_mfma_f32_16x16x32_bf16 v[108:111], v[4:7], v[212:215], v[108:111]
    v_cvt_pk_bf16_f32 v121, v98, v99
    v_mfma_f32_16x16x32_bf16 v[104:107], v[8:11], v[200:203], v[104:107]
    v_mfma_f32_16x16x32_bf16 v[108:111], v[8:11], v[216:219], v[108:111]
    v_cvt_pk_bf16_f32 v122, v100, v101
    v_mfma_f32_16x16x32_bf16 v[104:107], v[12:15], v[204:207], v[104:107]
    v_cvt_pk_bf16_f32 v123, v102, v103
    v_mfma_f32_16x16x32_bf16 v[108:111], v[12:15], v[220:223], v[108:111]
    v_mfma_f32_16x16x32_bf16 v[88:91], v[0:3], v[224:227], 0
    v_mfma_f32_16x16x32_bf16 v[92:95], v[0:3], v[240:243], 0
    v_mfma_f32_16x16x32_bf16 v[88:91], v[4:7], v[228:231], v[88:91]
    v_cvt_pk_bf16_f32 v124, v104, v105
    v_mfma_f32_16x16x32_bf16 v[92:95], v[4:7], v[244:247], v[92:95]
    v_cvt_pk_bf16_f32 v125, v106, v107
    v_mfma_f32_16x16x32_bf16 v[88:91], v[8:11], v[232:235], v[88:91]
    v_mfma_f32_16x16x32_bf16 v[92:95], v[8:11], v[248:251], v[92:95]
    v_cvt_pk_bf16_f32 v126, v108, v109
    v_mfma_f32_16x16x32_bf16 v[88:91], v[12:15], v[236:239], v[88:91]
    v_cvt_pk_bf16_f32 v127, v110, v111
    v_mfma_f32_16x16x32_bf16 v[92:95], v[12:15], v[252:255], v[92:95]
    s_waitcnt vmcnt(0)
    v_mfma_f32_16x16x32_bf16 v[96:99], v[16:19], v[128:131], 0
    v_mfma_f32_16x16x32_bf16 v[100:103], v[16:19], v[144:147], 0
    v_mfma_f32_16x16x32_bf16 v[96:99], v[20:23], v[132:135], v[96:99]
    v_cvt_pk_bf16_f32 v72, v88, v89
    v_mfma_f32_16x16x32_bf16 v[100:103], v[20:23], v[148:151], v[100:103]
    v_cvt_pk_bf16_f32 v73, v90, v91
    s_waitcnt vmcnt(4)
    s_barrier
    v_mfma_f32_16x16x32_bf16 v[96:99], v[24:27], v[136:139], v[96:99]
    v_mfma_f32_16x16x32_bf16 v[100:103], v[24:27], v[152:155], v[100:103]
    v_cvt_pk_bf16_f32 v74, v92, v93
    v_mfma_f32_16x16x32_bf16 v[96:99], v[28:31], v[140:143], v[96:99]
    v_cvt_pk_bf16_f32 v75, v94, v95
    v_mfma_f32_16x16x32_bf16 v[100:103], v[28:31], v[156:159], v[100:103]
    v_mfma_f32_16x16x32_bf16 v[104:107], v[16:19], v[160:163], 0
    v_mfma_f32_16x16x32_bf16 v[108:111], v[16:19], v[176:179], 0
    v_mfma_f32_16x16x32_bf16 v[104:107], v[20:23], v[164:167], v[104:107]
    v_cvt_pk_bf16_f32 v76, v96, v97
    v_mfma_f32_16x16x32_bf16 v[108:111], v[20:23], v[180:183], v[108:111]
    v_cvt_pk_bf16_f32 v77, v98, v99
    v_mfma_f32_16x16x32_bf16 v[104:107], v[24:27], v[168:171], v[104:107]
    v_mfma_f32_16x16x32_bf16 v[108:111], v[24:27], v[184:187], v[108:111]
    v_cvt_pk_bf16_f32 v78, v100, v101
    v_mfma_f32_16x16x32_bf16 v[104:107], v[28:31], v[172:175], v[104:107]
    v_cvt_pk_bf16_f32 v79, v102, v103
    v_mfma_f32_16x16x32_bf16 v[108:111], v[28:31], v[188:191], v[108:111]
    v_mfma_f32_16x16x32_bf16 v[88:91], v[16:19], v[192:195], 0
    v_mfma_f32_16x16x32_bf16 v[92:95], v[16:19], v[208:211], 0
    v_mfma_f32_16x16x32_bf16 v[88:91], v[20:23], v[196:199], v[88:91]
    v_cvt_pk_bf16_f32 v80, v104, v105
    v_mfma_f32_16x16x32_bf16 v[92:95], v[20:23], v[212:215], v[92:95]
    v_cvt_pk_bf16_f32 v81, v106, v107
    v_mfma_f32_16x16x32_bf16 v[88:91], v[24:27], v[200:203], v[88:91]
    v_mfma_f32_16x16x32_bf16 v[92:95], v[24:27], v[216:219], v[92:95]
    v_cvt_pk_bf16_f32 v82, v108, v109
    v_mfma_f32_16x16x32_bf16 v[88:91], v[28:31], v[204:207], v[88:91]
    v_cvt_pk_bf16_f32 v83, v110, v111
    ds_write_b64 v70, v[116:117] offset:0
    v_mfma_f32_16x16x32_bf16 v[92:95], v[28:31], v[220:223], v[92:95]
    ds_read_b128 v[0:3], v114 offset:8192
    ds_read_b128 v[4:7], v114 offset:9216
    ds_read_b128 v[8:11], v114 offset:10240
    ds_read_b128 v[12:15], v114 offset:11264
    v_mfma_f32_16x16x32_bf16 v[96:99], v[16:19], v[224:227], 0
    ds_write_b64 v70, v[118:119] offset:128
    v_mfma_f32_16x16x32_bf16 v[100:103], v[16:19], v[240:243], 0
    v_mfma_f32_16x16x32_bf16 v[96:99], v[20:23], v[228:231], v[96:99]
    v_cvt_pk_bf16_f32 v88, v88, v89
    ds_write_b64 v70, v[120:121] offset:256
    v_mfma_f32_16x16x32_bf16 v[100:103], v[20:23], v[244:247], v[100:103]
    v_cvt_pk_bf16_f32 v89, v90, v91
    v_mfma_f32_16x16x32_bf16 v[96:99], v[24:27], v[232:235], v[96:99]
    ds_write_b64 v70, v[88:89] offset:33280
    ds_write_b64 v70, v[122:123] offset:384
    v_mfma_f32_16x16x32_bf16 v[100:103], v[24:27], v[248:251], v[100:103]
    v_cvt_pk_bf16_f32 v92, v92, v93
    v_mfma_f32_16x16x32_bf16 v[96:99], v[28:31], v[236:239], v[96:99]
    v_cvt_pk_bf16_f32 v93, v94, v95
    ds_write_b64 v70, v[124:125] offset:512
    v_mfma_f32_16x16x32_bf16 v[100:103], v[28:31], v[252:255], v[100:103]
    ds_write_b64 v70, v[92:93] offset:33408
    s_waitcnt lgkmcnt(6)
    v_mfma_f32_16x16x32_bf16 v[104:107], v[0:3], v[128:131], 0
    buffer_load_dwordx4 v[116:119], v69, s[12:15], s20 offen offset:0 sc1
    ds_write_b64 v70, v[126:127] offset:640
    v_mfma_f32_16x16x32_bf16 v[108:111], v[0:3], v[144:147], 0
    v_mfma_f32_16x16x32_bf16 v[104:107], v[4:7], v[132:135], v[104:107]
    v_cvt_pk_bf16_f32 v96, v96, v97
    ds_write_b64 v70, v[72:73] offset:768
    v_mfma_f32_16x16x32_bf16 v[108:111], v[4:7], v[148:151], v[108:111]
    v_cvt_pk_bf16_f32 v97, v98, v99
    v_mfma_f32_16x16x32_bf16 v[104:107], v[8:11], v[136:139], v[104:107]
    ds_write_b64 v70, v[96:97] offset:33536
    buffer_load_dwordx4 v[120:123], v69, s[12:15], s20 offen offset:1024 sc1
    v_mfma_f32_16x16x32_bf16 v[108:111], v[8:11], v[152:155], v[108:111]
    v_cvt_pk_bf16_f32 v100, v100, v101
    ds_write_b64 v70, v[74:75] offset:896
    v_mfma_f32_16x16x32_bf16 v[104:107], v[12:15], v[140:143], v[104:107]
    v_cvt_pk_bf16_f32 v101, v102, v103
    v_mov_b64 v[16:17], s[80:81]
    v_mfma_f32_16x16x32_bf16 v[108:111], v[12:15], v[156:159], v[108:111]
    ds_write_b64 v70, v[100:101] offset:33664
    v_mov_b64 v[18:19], s[82:83]
    v_mfma_f32_16x16x32_bf16 v[88:91], v[0:3], v[160:163], 0
    v_mov_b64 v[20:21], s[80:81]
    v_mov_b64 v[22:23], s[82:83]
    v_mfma_f32_16x16x32_bf16 v[92:95], v[0:3], v[176:179], 0
    v_mov_b64 v[24:25], s[80:81]
    v_mov_b64 v[26:27], s[82:83]
    v_mfma_f32_16x16x32_bf16 v[88:91], v[4:7], v[164:167], v[88:91]
    v_cvt_pk_bf16_f32 v104, v104, v105
    v_mov_b64 v[28:29], s[80:81]
    v_mfma_f32_16x16x32_bf16 v[92:95], v[4:7], v[180:183], v[92:95]
    v_cvt_pk_bf16_f32 v105, v106, v107
    v_mov_b64 v[30:31], s[82:83]
    v_mfma_f32_16x16x32_bf16 v[88:91], v[8:11], v[168:171], v[88:91]
    ds_write_b64 v71, v[104:105] offset:0
    ds_write_b64 v70, v[76:77] offset:32768
    v_mfma_f32_16x16x32_bf16 v[92:95], v[8:11], v[184:187], v[92:95]
    v_cvt_pk_bf16_f32 v108, v108, v109
    buffer_load_dwordx4 v[124:127], v69, s[12:15], s20 offen offset:2048 sc1
    v_mfma_f32_16x16x32_bf16 v[88:91], v[12:15], v[172:175], v[88:91]
    v_cvt_pk_bf16_f32 v109, v110, v111
    ds_write_b64 v70, v[78:79] offset:32896
    v_mfma_f32_16x16x32_bf16 v[92:95], v[12:15], v[188:191], v[92:95]
    ds_write_b64 v71, v[108:109] offset:128
    ds_write_b64 v70, v[80:81] offset:33024
    v_mfma_f32_16x16x32_bf16 v[96:99], v[0:3], v[192:195], 0
    buffer_load_dwordx4 v[72:75], v69, s[12:15], s21 offen offset:0 sc1
    ds_write_b64 v70, v[82:83] offset:33152
    v_mfma_f32_16x16x32_bf16 v[100:103], v[0:3], v[208:211], 0
    buffer_load_dwordx4 v[76:79], v69, s[12:15], s21 offen offset:1024 sc1
    v_mfma_f32_16x16x32_bf16 v[96:99], v[4:7], v[196:199], v[96:99]
    v_cvt_pk_bf16_f32 v88, v88, v89
    v_mfma_f32_16x16x32_bf16 v[100:103], v[4:7], v[212:215], v[100:103]
    v_cvt_pk_bf16_f32 v89, v90, v91
    v_mfma_f32_16x16x32_bf16 v[96:99], v[8:11], v[200:203], v[96:99]
    ds_write_b64 v71, v[88:89] offset:256
    buffer_load_dwordx4 v[80:83], v69, s[12:15], s19 offen offset:0 sc1
    v_mfma_f32_16x16x32_bf16 v[100:103], v[8:11], v[216:219], v[100:103]
    v_cvt_pk_bf16_f32 v92, v92, v93
    v_mfma_f32_16x16x32_bf16 v[96:99], v[12:15], v[204:207], v[96:99]
    v_cvt_pk_bf16_f32 v93, v94, v95
    v_mfma_f32_16x16x32_bf16 v[100:103], v[12:15], v[220:223], v[100:103]
    ds_write_b64 v71, v[92:93] offset:384
    v_mfma_f32_16x16x32_bf16 v[104:107], v[0:3], v[224:227], 0
    buffer_load_dwordx4 v[84:87], v69, s[12:15], s19 offen offset:1024 sc1
    s_add_u32 s21, s21, 4096
    s_add_u32 s19, s19, 4096
    v_mfma_f32_16x16x32_bf16 v[108:111], v[0:3], v[240:243], 0
    v_mfma_f32_16x16x32_bf16 v[104:107], v[4:7], v[228:231], v[104:107]
    v_cvt_pk_bf16_f32 v96, v96, v97
    v_mfma_f32_16x16x32_bf16 v[108:111], v[4:7], v[244:247], v[108:111]
    v_cvt_pk_bf16_f32 v97, v98, v99
    v_mfma_f32_16x16x32_bf16 v[104:107], v[8:11], v[232:235], v[104:107]
    ds_write_b64 v71, v[96:97] offset:512
    v_mfma_f32_16x16x32_bf16 v[108:111], v[8:11], v[248:251], v[108:111]
    v_cvt_pk_bf16_f32 v100, v100, v101
    v_mov_b64 v[0:1], s[80:81]
    v_mfma_f32_16x16x32_bf16 v[104:107], v[12:15], v[236:239], v[104:107]
    v_cvt_pk_bf16_f32 v101, v102, v103
    v_mov_b64 v[2:3], s[82:83]
    v_mfma_f32_16x16x32_bf16 v[108:111], v[12:15], v[252:255], v[108:111]
    ds_write_b64 v71, v[100:101] offset:640
    v_mov_b64 v[4:5], s[80:81]
    s_nop 1
    v_mov_b64 v[6:7], s[82:83]
    v_mov_b64 v[8:9], s[80:81]
    v_mov_b64 v[10:11], s[82:83]
    v_mov_b64 v[12:13], s[80:81]
    v_mov_b64 v[14:15], s[82:83]
    s_nop 4
    v_cvt_pk_bf16_f32 v104, v104, v105
    v_cvt_pk_bf16_f32 v105, v106, v107
    ds_write_b64 v71, v[104:105] offset:768
    v_cvt_pk_bf16_f32 v108, v108, v109
    v_cvt_pk_bf16_f32 v109, v110, v111
    ds_write_b64 v71, v[108:109] offset:896
    v_add_u32 v70, 0x18000, v70
    s_branch standalone__deep_cross_pnn__recsys_kernel_k2j
standalone__deep_cross_pnn__recsys_kernel_k2m:
    s_barrier

    s_setprio 0
    s_waitcnt vmcnt(0)

    buffer_load_dwordx4 v[136:139], v254, s[12:15], s44 offen offset:0 sc1
    ds_read_b128 v[128:131], v95 offset:0
    ds_read_b128 v[132:135], v95 offset:64
    ds_read_b128 v[144:147], v95 offset:2304
    ds_read_b128 v[148:151], v95 offset:2368
    v_fma_f32 v85, v188, v64, v240
    v_mov_b32 v84, v239
    v_mov_b32 v86, v241
    v_mov_b32 v113, v243
    v_mov_b32 v112, v94
    v_add_u32 v114, 144256, v254
    v_fmac_f32 v85, v189, v65
    v_fmac_f32 v85, v190, v66
    v_fmac_f32 v85, v191, v67
    v_fmac_f32 v85, v192, v68
    buffer_load_dwordx4 v[140:143], v254, s[12:15], s44 offen offset:1024 sc1
    ds_read_b128 v[160:163], v95 offset:4608
    ds_read_b128 v[164:167], v95 offset:4672
    ds_read_b128 v[176:179], v95 offset:6912
    ds_read_b128 v[180:183], v95 offset:6976
    v_fmac_f32 v85, v193, v69
    v_fmac_f32 v85, v194, v70
    v_fmac_f32 v85, v195, v71
    v_fmac_f32 v85, v196, v72
    v_fmac_f32 v85, v197, v73
    buffer_load_dwordx4 v[152:155], v254, s[12:15], s44 offen offset:2048 sc1
    ds_read_b128 v[208:211], v95 offset:11520
    ds_read_b128 v[212:215], v95 offset:11584
    ds_read_b128 v[224:227], v95 offset:13824
    ds_read_b128 v[228:231], v95 offset:13888
    v_fmac_f32 v85, v198, v74
    v_fmac_f32 v85, v199, v75
    v_fmac_f32 v85, v200, v76
    v_fmac_f32 v85, v201, v77
    v_fmac_f32 v85, v202, v78
    buffer_load_dwordx4 v[156:159], v254, s[12:15], s44 offen offset:3072 sc1
    s_add_u32 s44, s44, 4096
    ds_read_b128 v[240:243], v95 offset:16128
    ds_read_b128 v[244:247], v95 offset:16192
    ds_read_b128 v[192:195], v95 offset:9216
    ds_read_b128 v[196:199], v95 offset:9280
    v_fmac_f32 v85, v203, v79
    v_fmac_f32 v85, v204, v80
    v_fmac_f32 v85, v205, v81
    v_fmac_f32 v85, v206, v82
    v_fmac_f32 v85, v207, v83
    buffer_load_dwordx4 v[168:171], v254, s[12:15], s44 offen offset:0 sc1
    v_and_b32 v49, 15, v255
    v_lshrrev_b32 v50, 4, v255
    v_lshlrev_b32 v69, 4, v255
    v_lshlrev_b32 v70, 13, v50
    buffer_load_dwordx4 v[172:175], v254, s[12:15], s44 offen offset:1024 sc1
    v_lshl_add_u32 v70, v49, 3, v70
    v_add_u32 v70, s85, v70
    v_add_u32 v71, 0x10000, v70
    s_waitcnt lgkmcnt(0)
    s_barrier
    s_setprio 2
    ds_read_b128 v[0:3], v114 offset:0
    ds_read_b128 v[4:7], v114 offset:1024
    ds_read_b128 v[8:11], v114 offset:2048
    ds_read_b128 v[12:15], v114 offset:3072
    s_add_u32 s21, s77, 12288
    s_add_u32 s19, s78, 12288
    s_mov_b32 s20, s79
    s_lshr_b32 s33, s2, 1
    s_and_b32 s34, s2, 1
    v_lshrrev_b32 v52, 3, v255
    v_xor_b32 v52, v52, v50
    v_and_b32 v52, 1, v52
    v_bfe_u32 v53, v255, 2, 1
    v_lshl_or_b32 v52, v52, 1, v53
    v_mov_b32 v54, 0x3f80
    s_waitcnt lgkmcnt(0)
    v_mfma_f32_16x16x32_bf16 v[88:91], v[0:3], v[128:131], 0
    buffer_load_dwordx4 v[184:187], v69, s[12:15], s44 offen offset:2048 sc1
    v_cmp_eq_u32 vcc, 0, v52
    ds_read_b128 v[16:19], v114 offset:4096
    ds_read_b128 v[20:23], v114 offset:5120
    ds_read_b128 v[24:27], v114 offset:6144
    ds_read_b128 v[28:31], v114 offset:7168
    v_mfma_f32_16x16x32_bf16 v[92:95], v[0:3], v[144:147], 0
    v_permlane32_swap_b32 v84, v85
    v_mfma_f32_16x16x32_bf16 v[88:91], v[4:7], v[132:135], v[88:91]
    v_cmp_eq_u32 s[68:69], 1, v52
    v_mfma_f32_16x16x32_bf16 v[92:95], v[4:7], v[148:151], v[92:95]
    v_add_f32 v87, v84, v85
    buffer_load_dwordx4 v[188:191], v69, s[12:15], s44 offen offset:3072 sc1
    s_add_u32 s44, s44, 4096
    s_waitcnt vmcnt(4)
    v_mfma_f32_16x16x32_bf16 v[88:91], v[8:11], v[136:139], v[88:91]
    v_and_b32 v53, 3, v255
    v_mfma_f32_16x16x32_bf16 v[92:95], v[8:11], v[152:155], v[92:95]
    v_permlane16_swap_b32 v86, v87
    v_mfma_f32_16x16x32_bf16 v[88:91], v[12:15], v[140:143], v[88:91]
    buffer_load_dwordx4 v[200:203], v69, s[12:15], s44 offen offset:0 sc1
    v_mul_u32_u24 v68, 0x5555, v53
    ds_read_b128 v[32:35], v114 offset:8192
    ds_read_b128 v[36:39], v114 offset:9216
    ds_read_b128 v[40:43], v114 offset:10240
    ds_read_b128 v[44:47], v114 offset:11264
    v_mfma_f32_16x16x32_bf16 v[92:95], v[12:15], v[156:159], v[92:95]
    v_add_f32 v86, v86, v87
    s_waitcnt lgkmcnt(4)
    v_mfma_f32_16x16x32_bf16 v[96:99], v[16:19], v[128:131], 0
    v_cndmask_b32 v64, 0, v54, vcc
    v_mfma_f32_16x16x32_bf16 v[100:103], v[16:19], v[144:147], 0
    v_add_f32_dpp v86, v86, v86 row_ror:8 row_mask:0xf bank_mask:0xf
    buffer_load_dwordx4 v[204:207], v69, s[12:15], s44 offen offset:1024 sc1
    v_mfma_f32_16x16x32_bf16 v[96:99], v[20:23], v[132:135], v[96:99]
    v_cvt_pk_bf16_f32 v88, v88, v89
    v_cndmask_b32 v65, 0, v54, vcc
    v_mfma_f32_16x16x32_bf16 v[100:103], v[20:23], v[148:151], v[100:103]
    v_cvt_pk_bf16_f32 v89, v90, v91
    v_add_f32_dpp v86, v86, v86 row_ror:4 row_mask:0xf bank_mask:0xf
    v_mfma_f32_16x16x32_bf16 v[96:99], v[24:27], v[136:139], v[96:99]
    ds_write_b64 v70, v[88:89] offset:0
    buffer_load_dwordx4 v[216:219], v69, s[12:15], s44 offen offset:2048 sc1
    v_mfma_f32_16x16x32_bf16 v[100:103], v[24:27], v[152:155], v[100:103]
    v_cvt_pk_bf16_f32 v92, v92, v93
    v_cndmask_b32 v66, 0, v54, s[68:69]
    v_mfma_f32_16x16x32_bf16 v[96:99], v[28:31], v[140:143], v[96:99]
    v_cvt_pk_bf16_f32 v93, v94, v95
    v_add_f32_dpp v86, v86, v86 row_ror:2 row_mask:0xf bank_mask:0xf
    v_mfma_f32_16x16x32_bf16 v[100:103], v[28:31], v[156:159], v[100:103]
    ds_write_b64 v70, v[92:93] offset:128
    v_cndmask_b32 v67, 0, v54, s[68:69]
    s_waitcnt lgkmcnt(2)
    v_mfma_f32_16x16x32_bf16 v[104:107], v[32:35], v[128:131], 0
    v_add_f32_dpp v86, v86, v86 row_ror:1 row_mask:0xf bank_mask:0xf
    buffer_load_dwordx4 v[220:223], v69, s[12:15], s44 offen offset:3072 sc1
    s_add_u32 s44, s44, 4096
    v_mfma_f32_16x16x32_bf16 v[108:111], v[32:35], v[144:147], 0
    v_cndmask_b32 v113, v113, v86, s[70:71]
    v_mfma_f32_16x16x32_bf16 v[104:107], v[36:39], v[132:135], v[104:107]
    v_cvt_pk_bf16_f32 v96, v96, v97
    buffer_load_dwordx4 v[232:235], v69, s[12:15], s44 offen offset:0 sc1
    v_mfma_f32_16x16x32_bf16 v[108:111], v[36:39], v[148:151], v[108:111]
    v_cvt_pk_bf16_f32 v97, v98, v99
    v_mfma_f32_16x16x32_bf16 v[104:107], v[40:43], v[136:139], v[104:107]
    ds_write_b64 v70, v[96:97] offset:32768
    v_mfma_f32_16x16x32_bf16 v[108:111], v[40:43], v[152:155], v[108:111]
    v_cvt_pk_bf16_f32 v100, v100, v101
    buffer_load_dwordx4 v[236:239], v69, s[12:15], s44 offen offset:1024 sc1
    v_mfma_f32_16x16x32_bf16 v[104:107], v[44:47], v[140:143], v[104:107]
    v_cvt_pk_bf16_f32 v101, v102, v103
    s_mov_b64 exec, s[46:47]
    buffer_store_dword v113, v112, s[12:15], s76 offen sc1
    s_mov_b64 exec, -1
    v_mfma_f32_16x16x32_bf16 v[108:111], v[44:47], v[156:159], v[108:111]
    ds_write_b64 v70, v[100:101] offset:32896
    v_mov_b64 v[48:49], s[80:81]
    v_mfma_f32_16x16x32_bf16 v[88:91], v[0:3], v[160:163], 0
    buffer_load_dwordx4 v[248:251], v69, s[12:15], s44 offen offset:2048 sc1
    v_mov_b64 v[50:51], s[82:83]
    v_mfma_f32_16x16x32_bf16 v[92:95], v[0:3], v[176:179], 0
    v_mov_b64 v[52:53], s[80:81]
    v_mfma_f32_16x16x32_bf16 v[88:91], v[4:7], v[164:167], v[88:91]
    v_cvt_pk_bf16_f32 v104, v104, v105
    v_mov_b64 v[54:55], s[82:83]
    v_mfma_f32_16x16x32_bf16 v[92:95], v[4:7], v[180:183], v[92:95]
    v_cvt_pk_bf16_f32 v105, v106, v107
    buffer_load_dwordx4 v[252:255], v69, s[12:15], s44 offen offset:3072 sc1
    s_add_u32 s44, s44, 4096
    s_waitcnt vmcnt(9)
    v_mfma_f32_16x16x32_bf16 v[88:91], v[8:11], v[168:171], v[88:91]
    ds_write_b64 v71, v[104:105] offset:0
    v_mov_b64 v[56:57], s[80:81]
    v_mfma_f32_16x16x32_bf16 v[92:95], v[8:11], v[184:187], v[92:95]
    v_cvt_pk_bf16_f32 v108, v108, v109
    v_mov_b64 v[58:59], s[82:83]
    v_mfma_f32_16x16x32_bf16 v[88:91], v[12:15], v[172:175], v[88:91]
    v_cvt_pk_bf16_f32 v109, v110, v111
    v_mov_b64 v[60:61], s[80:81]
    v_mfma_f32_16x16x32_bf16 v[92:95], v[12:15], v[188:191], v[92:95]
    ds_write_b64 v71, v[108:109] offset:128
    buffer_load_dwordx4 v[116:119], v69, s[12:15], s20 offen offset:0 sc1
    v_mfma_f32_16x16x32_bf16 v[96:99], v[16:19], v[160:163], 0
    v_mov_b64 v[62:63], s[82:83]
    v_mfma_f32_16x16x32_bf16 v[100:103], v[16:19], v[176:179], 0
    buffer_load_dwordx4 v[120:123], v69, s[12:15], s20 offen offset:1024 sc1
    v_mfma_f32_16x16x32_bf16 v[96:99], v[20:23], v[164:167], v[96:99]
    v_cvt_pk_bf16_f32 v88, v88, v89
    v_mfma_f32_16x16x32_bf16 v[100:103], v[20:23], v[180:183], v[100:103]
    v_cvt_pk_bf16_f32 v89, v90, v91
    v_mfma_f32_16x16x32_bf16 v[96:99], v[24:27], v[168:171], v[96:99]
    ds_write_b64 v70, v[88:89] offset:256
    buffer_load_dwordx4 v[124:127], v69, s[12:15], s20 offen offset:2048 sc1
    v_mfma_f32_16x16x32_bf16 v[100:103], v[24:27], v[184:187], v[100:103]
    v_cvt_pk_bf16_f32 v92, v92, v93
    v_mfma_f32_16x16x32_bf16 v[96:99], v[28:31], v[172:175], v[96:99]
    v_cvt_pk_bf16_f32 v93, v94, v95
    v_mfma_f32_16x16x32_bf16 v[100:103], v[28:31], v[188:191], v[100:103]
    ds_write_b64 v70, v[92:93] offset:384
    buffer_load_dwordx4 v[72:75], v69, s[12:15], s21 offen offset:0 sc1
    v_mfma_f32_16x16x32_bf16 v[104:107], v[32:35], v[160:163], 0
    v_mfma_f32_16x16x32_bf16 v[108:111], v[32:35], v[176:179], 0
    s_load_dwordx4 s[56:59], s[0:1], 48
    v_mfma_f32_16x16x32_bf16 v[104:107], v[36:39], v[164:167], v[104:107]
    v_cvt_pk_bf16_f32 v96, v96, v97
    buffer_load_dwordx4 v[76:79], v69, s[12:15], s21 offen offset:1024 sc1
    v_mfma_f32_16x16x32_bf16 v[108:111], v[36:39], v[180:183], v[108:111]
    v_cvt_pk_bf16_f32 v97, v98, v99
    v_mfma_f32_16x16x32_bf16 v[104:107], v[40:43], v[168:171], v[104:107]
    ds_write_b64 v70, v[96:97] offset:33024
    v_mfma_f32_16x16x32_bf16 v[108:111], v[40:43], v[184:187], v[108:111]
    v_cvt_pk_bf16_f32 v100, v100, v101
    buffer_load_dwordx4 v[80:83], v69, s[12:15], s19 offen offset:0 sc1
    v_mfma_f32_16x16x32_bf16 v[104:107], v[44:47], v[172:175], v[104:107]
    v_cvt_pk_bf16_f32 v101, v102, v103
    v_mfma_f32_16x16x32_bf16 v[108:111], v[44:47], v[188:191], v[108:111]
    ds_write_b64 v70, v[100:101] offset:33152
    v_mfma_f32_16x16x32_bf16 v[88:91], v[0:3], v[192:195], 0
    buffer_load_dwordx4 v[84:87], v69, s[12:15], s19 offen offset:1024 sc1
    s_add_u32 s21, s21, 4096
    s_add_u32 s19, s19, 4096
    v_mfma_f32_16x16x32_bf16 v[92:95], v[0:3], v[208:211], 0
    v_mfma_f32_16x16x32_bf16 v[88:91], v[4:7], v[196:199], v[88:91]
    v_cvt_pk_bf16_f32 v104, v104, v105
    v_mfma_f32_16x16x32_bf16 v[92:95], v[4:7], v[212:215], v[92:95]
    v_cvt_pk_bf16_f32 v105, v106, v107
    s_waitcnt vmcnt(12)
    v_mfma_f32_16x16x32_bf16 v[88:91], v[8:11], v[200:203], v[88:91]
    ds_write_b64 v71, v[104:105] offset:256
    v_mfma_f32_16x16x32_bf16 v[92:95], v[8:11], v[216:219], v[92:95]
    v_cvt_pk_bf16_f32 v108, v108, v109
    v_mfma_f32_16x16x32_bf16 v[88:91], v[12:15], v[204:207], v[88:91]
    v_cvt_pk_bf16_f32 v109, v110, v111
    v_mfma_f32_16x16x32_bf16 v[92:95], v[12:15], v[220:223], v[92:95]
    ds_write_b64 v71, v[108:109] offset:384
    v_mfma_f32_16x16x32_bf16 v[96:99], v[16:19], v[192:195], 0
    v_mfma_f32_16x16x32_bf16 v[100:103], v[16:19], v[208:211], 0
    v_mfma_f32_16x16x32_bf16 v[96:99], v[20:23], v[196:199], v[96:99]
    v_cvt_pk_bf16_f32 v88, v88, v89
    v_mfma_f32_16x16x32_bf16 v[100:103], v[20:23], v[212:215], v[100:103]
    v_cvt_pk_bf16_f32 v89, v90, v91
    v_mfma_f32_16x16x32_bf16 v[96:99], v[24:27], v[200:203], v[96:99]
    ds_write_b64 v70, v[88:89] offset:512
    v_mfma_f32_16x16x32_bf16 v[100:103], v[24:27], v[216:219], v[100:103]
    v_cvt_pk_bf16_f32 v92, v92, v93
    v_mfma_f32_16x16x32_bf16 v[96:99], v[28:31], v[204:207], v[96:99]
    v_cvt_pk_bf16_f32 v93, v94, v95
    v_mfma_f32_16x16x32_bf16 v[100:103], v[28:31], v[220:223], v[100:103]
    ds_write_b64 v70, v[92:93] offset:640
    v_mfma_f32_16x16x32_bf16 v[104:107], v[32:35], v[192:195], 0
    v_mfma_f32_16x16x32_bf16 v[108:111], v[32:35], v[208:211], 0
    v_mfma_f32_16x16x32_bf16 v[104:107], v[36:39], v[196:199], v[104:107]
    v_cvt_pk_bf16_f32 v96, v96, v97
    v_mfma_f32_16x16x32_bf16 v[108:111], v[36:39], v[212:215], v[108:111]
    v_cvt_pk_bf16_f32 v97, v98, v99
    v_mfma_f32_16x16x32_bf16 v[104:107], v[40:43], v[200:203], v[104:107]
    ds_write_b64 v70, v[96:97] offset:33280
    v_mfma_f32_16x16x32_bf16 v[108:111], v[40:43], v[216:219], v[108:111]
    v_cvt_pk_bf16_f32 v100, v100, v101
    v_mfma_f32_16x16x32_bf16 v[104:107], v[44:47], v[204:207], v[104:107]
    v_cvt_pk_bf16_f32 v101, v102, v103
    v_mfma_f32_16x16x32_bf16 v[108:111], v[44:47], v[220:223], v[108:111]
    ds_write_b64 v70, v[100:101] offset:33408
    v_mfma_f32_16x16x32_bf16 v[88:91], v[0:3], v[224:227], 0
    v_mfma_f32_16x16x32_bf16 v[92:95], v[0:3], v[240:243], 0
    v_mfma_f32_16x16x32_bf16 v[88:91], v[4:7], v[228:231], v[88:91]
    v_cvt_pk_bf16_f32 v104, v104, v105
    v_mfma_f32_16x16x32_bf16 v[92:95], v[4:7], v[244:247], v[92:95]
    v_cvt_pk_bf16_f32 v105, v106, v107
    s_waitcnt vmcnt(7)
    v_mfma_f32_16x16x32_bf16 v[88:91], v[8:11], v[232:235], v[88:91]
    ds_write_b64 v71, v[104:105] offset:512
    v_mfma_f32_16x16x32_bf16 v[92:95], v[8:11], v[248:251], v[92:95]
    v_cvt_pk_bf16_f32 v108, v108, v109
    v_mov_b64 v[0:1], s[80:81]
    v_mfma_f32_16x16x32_bf16 v[88:91], v[12:15], v[236:239], v[88:91]
    v_cvt_pk_bf16_f32 v109, v110, v111
    v_mov_b64 v[2:3], s[82:83]
    v_mfma_f32_16x16x32_bf16 v[92:95], v[12:15], v[252:255], v[92:95]
    ds_write_b64 v71, v[108:109] offset:640
    v_mov_b64 v[4:5], s[80:81]
    v_mfma_f32_16x16x32_bf16 v[96:99], v[16:19], v[224:227], 0
    v_mov_b64 v[6:7], s[82:83]
    v_mfma_f32_16x16x32_bf16 v[100:103], v[16:19], v[240:243], 0
    v_mov_b64 v[8:9], s[80:81]
    v_mov_b64 v[10:11], s[82:83]
    v_mfma_f32_16x16x32_bf16 v[96:99], v[20:23], v[228:231], v[96:99]
    v_cvt_pk_bf16_f32 v88, v88, v89
    v_mfma_f32_16x16x32_bf16 v[100:103], v[20:23], v[244:247], v[100:103]
    v_cvt_pk_bf16_f32 v89, v90, v91
    v_mov_b64 v[12:13], s[80:81]
    v_mfma_f32_16x16x32_bf16 v[96:99], v[24:27], v[232:235], v[96:99]
    ds_write_b64 v70, v[88:89] offset:768
    v_mov_b64 v[14:15], s[82:83]
    v_mfma_f32_16x16x32_bf16 v[100:103], v[24:27], v[248:251], v[100:103]
    v_cvt_pk_bf16_f32 v92, v92, v93
    v_mov_b64 v[16:17], s[80:81]
    v_mfma_f32_16x16x32_bf16 v[96:99], v[28:31], v[236:239], v[96:99]
    v_cvt_pk_bf16_f32 v93, v94, v95
    v_mov_b64 v[18:19], s[82:83]
    v_mfma_f32_16x16x32_bf16 v[100:103], v[28:31], v[252:255], v[100:103]
    ds_write_b64 v70, v[92:93] offset:896
    v_mov_b64 v[20:21], s[80:81]
    v_mfma_f32_16x16x32_bf16 v[104:107], v[32:35], v[224:227], 0
    v_mov_b64 v[22:23], s[82:83]
    v_mfma_f32_16x16x32_bf16 v[108:111], v[32:35], v[240:243], 0
    v_mov_b64 v[24:25], s[80:81]
    v_mov_b64 v[26:27], s[82:83]
    v_mfma_f32_16x16x32_bf16 v[104:107], v[36:39], v[228:231], v[104:107]
    v_cvt_pk_bf16_f32 v96, v96, v97
    v_mfma_f32_16x16x32_bf16 v[108:111], v[36:39], v[244:247], v[108:111]
    v_cvt_pk_bf16_f32 v97, v98, v99
    v_mov_b64 v[28:29], s[80:81]
    v_mfma_f32_16x16x32_bf16 v[104:107], v[40:43], v[232:235], v[104:107]
    ds_write_b64 v70, v[96:97] offset:33536
    v_mov_b64 v[30:31], s[82:83]
    v_mfma_f32_16x16x32_bf16 v[108:111], v[40:43], v[248:251], v[108:111]
    v_cvt_pk_bf16_f32 v100, v100, v101
    v_mov_b64 v[32:33], s[80:81]
    v_mfma_f32_16x16x32_bf16 v[104:107], v[44:47], v[236:239], v[104:107]
    v_cvt_pk_bf16_f32 v101, v102, v103
    v_mov_b64 v[34:35], s[82:83]
    v_mfma_f32_16x16x32_bf16 v[108:111], v[44:47], v[252:255], v[108:111]
    ds_write_b64 v70, v[100:101] offset:33664
    v_mov_b64 v[36:37], s[80:81]
    s_nop 1
    v_mov_b64 v[38:39], s[82:83]
    v_mov_b64 v[40:41], s[80:81]
    v_mov_b64 v[42:43], s[82:83]
    v_mov_b64 v[44:45], s[80:81]
    v_mov_b64 v[46:47], s[82:83]
    s_nop 4
    v_cvt_pk_bf16_f32 v104, v104, v105
    v_cvt_pk_bf16_f32 v105, v106, v107
    ds_write_b64 v71, v[104:105] offset:768
    v_cvt_pk_bf16_f32 v108, v108, v109
    v_cvt_pk_bf16_f32 v109, v110, v111
    ds_write_b64 v71, v[108:109] offset:896
    v_add_u32 v70, 0x18000, v70
standalone__deep_cross_pnn__recsys_kernel_k2j:

    s_mov_b32 s22, 0
    s_mov_b32 s32, 0x8000
    s_mov_b32 s23, 3
    s_waitcnt vmcnt(0) lgkmcnt(0)
    s_barrier

    v_lshlrev_b32_sdwa v88, 3, v116 dst_sel:DWORD dst_unused:UNUSED_PAD src0_sel:DWORD src1_sel:WORD_0
    v_lshlrev_b32_sdwa v90, 3, v116 dst_sel:DWORD dst_unused:UNUSED_PAD src0_sel:DWORD src1_sel:WORD_1
    v_lshlrev_b32_sdwa v92, 3, v117 dst_sel:DWORD dst_unused:UNUSED_PAD src0_sel:DWORD src1_sel:WORD_0
    v_lshlrev_b32_sdwa v94, 3, v117 dst_sel:DWORD dst_unused:UNUSED_PAD src0_sel:DWORD src1_sel:WORD_1
    ds_read_b64 v[88:89], v88
    ds_read_b64 v[90:91], v90
    ds_read_b64 v[92:93], v92
    ds_read_b64 v[94:95], v94
    v_lshlrev_b32_sdwa v96, 3, v118 dst_sel:DWORD dst_unused:UNUSED_PAD src0_sel:DWORD src1_sel:WORD_0
    v_lshlrev_b32_sdwa v98, 3, v118 dst_sel:DWORD dst_unused:UNUSED_PAD src0_sel:DWORD src1_sel:WORD_1
    v_lshlrev_b32_sdwa v100, 3, v119 dst_sel:DWORD dst_unused:UNUSED_PAD src0_sel:DWORD src1_sel:WORD_0
    v_lshlrev_b32_sdwa v102, 3, v119 dst_sel:DWORD dst_unused:UNUSED_PAD src0_sel:DWORD src1_sel:WORD_1
    ds_read_b64 v[96:97], v96
    ds_read_b64 v[98:99], v98
    ds_read_b64 v[100:101], v100
    ds_read_b64 v[102:103], v102
    buffer_load_dwordx4 v[116:119], v69, s[12:15], s20 offen offset:3072 sc1
    s_add_u32 s20, s20, 4096
    s_bitcmp1_b32 s2, 1
    s_cselect_b32 s35, 0, 16
    s_lshl_b32 s28, s28, s35
    s_lshl_b32 s29, s29, s35
    s_lshl_b32 s30, s30, s35
    s_lshl_b32 s31, s31, s35
    s_and_b32 s28, s28, 0xffff0000
    s_and_b32 s29, s29, 0xffff0000
    s_and_b32 s30, s30, 0xffff0000
    s_and_b32 s31, s31, 0xffff0000
standalone__deep_cross_pnn__recsys_kernel_gloop:
    s_setprio 3
    s_waitcnt vmcnt(6)
    v_lshlrev_b32_sdwa v104, 3, v120 dst_sel:DWORD dst_unused:UNUSED_PAD src0_sel:DWORD src1_sel:WORD_0
    v_lshlrev_b32_sdwa v106, 3, v120 dst_sel:DWORD dst_unused:UNUSED_PAD src0_sel:DWORD src1_sel:WORD_1
    ds_read_b64 v[104:105], v104
    ds_read_b64 v[106:107], v106
    v_lshlrev_b32_sdwa v108, 3, v121 dst_sel:DWORD dst_unused:UNUSED_PAD src0_sel:DWORD src1_sel:WORD_0
    v_lshlrev_b32_sdwa v110, 3, v121 dst_sel:DWORD dst_unused:UNUSED_PAD src0_sel:DWORD src1_sel:WORD_1
    ds_read_b64 v[108:109], v108
    ds_read_b64 v[110:111], v110
    s_waitcnt lgkmcnt(8)
    v_smfmac_f32_16x16x64_bf16 v[0:3], v[64:67], v[88:95], v68
    s_waitcnt vmcnt(5)
    v_mfma_f32_16x16x32_bf16 v[112:115], v[72:75], v[128:131], 0
    v_lshlrev_b32_sdwa v88, 3, v122 dst_sel:DWORD dst_unused:UNUSED_PAD src0_sel:DWORD src1_sel:WORD_0
    v_lshlrev_b32_sdwa v90, 3, v122 dst_sel:DWORD dst_unused:UNUSED_PAD src0_sel:DWORD src1_sel:WORD_1
    ds_read_b64 v[88:89], v88
    ds_read_b64 v[90:91], v90
    s_waitcnt vmcnt(4)
    v_mfma_f32_16x16x32_bf16 v[112:115], v[76:79], v[132:135], v[112:115]
    v_lshlrev_b32_sdwa v92, 3, v123 dst_sel:DWORD dst_unused:UNUSED_PAD src0_sel:DWORD src1_sel:WORD_0
    v_lshlrev_b32_sdwa v94, 3, v123 dst_sel:DWORD dst_unused:UNUSED_PAD src0_sel:DWORD src1_sel:WORD_1
    ds_read_b64 v[92:93], v92
    ds_read_b64 v[94:95], v94
    buffer_load_dwordx4 v[120:123], v69, s[12:15], s20 offen offset:0 sc1
    s_waitcnt lgkmcnt(8)
    v_smfmac_f32_16x16x64_bf16 v[4:7], v[64:67], v[96:103], v68
    s_waitcnt vmcnt(4)
    v_mfma_f32_16x16x32_bf16 v[112:115], v[80:83], v[136:139], v[112:115]
    s_waitcnt vmcnt(2)
    v_lshlrev_b32_sdwa v96, 3, v124 dst_sel:DWORD dst_unused:UNUSED_PAD src0_sel:DWORD src1_sel:WORD_0
    v_lshlrev_b32_sdwa v98, 3, v124 dst_sel:DWORD dst_unused:UNUSED_PAD src0_sel:DWORD src1_sel:WORD_1
    ds_read_b64 v[96:97], v96
    ds_read_b64 v[98:99], v98
    s_waitcnt vmcnt(3)
    v_mfma_f32_16x16x32_bf16 v[112:115], v[84:87], v[140:143], v[112:115]
    v_lshlrev_b32_sdwa v100, 3, v125 dst_sel:DWORD dst_unused:UNUSED_PAD src0_sel:DWORD src1_sel:WORD_0
    v_lshlrev_b32_sdwa v102, 3, v125 dst_sel:DWORD dst_unused:UNUSED_PAD src0_sel:DWORD src1_sel:WORD_1
    ds_read_b64 v[100:101], v100
    ds_read_b64 v[102:103], v102
    s_waitcnt lgkmcnt(8)
    v_smfmac_f32_16x16x64_bf16 v[8:11], v[64:67], v[104:111], v68
    s_nop 1
    v_cvt_pk_bf16_f32 v112, v112, v113
    v_cvt_pk_bf16_f32 v113, v114, v115
    ds_write_b64 v70, v[112:113] offset:0
    v_mfma_f32_16x16x32_bf16 v[112:115], v[72:75], v[144:147], 0
    v_mfma_f32_16x16x32_bf16 v[112:115], v[76:79], v[148:151], v[112:115]
    v_lshlrev_b32_sdwa v104, 3, v126 dst_sel:DWORD dst_unused:UNUSED_PAD src0_sel:DWORD src1_sel:WORD_0
    v_lshlrev_b32_sdwa v106, 3, v126 dst_sel:DWORD dst_unused:UNUSED_PAD src0_sel:DWORD src1_sel:WORD_1
    ds_read_b64 v[104:105], v104
    ds_read_b64 v[106:107], v106
    v_mfma_f32_16x16x32_bf16 v[112:115], v[80:83], v[152:155], v[112:115]
    v_mfma_f32_16x16x32_bf16 v[112:115], v[84:87], v[156:159], v[112:115]
    v_lshlrev_b32_sdwa v108, 3, v127 dst_sel:DWORD dst_unused:UNUSED_PAD src0_sel:DWORD src1_sel:WORD_0
    v_lshlrev_b32_sdwa v110, 3, v127 dst_sel:DWORD dst_unused:UNUSED_PAD src0_sel:DWORD src1_sel:WORD_1
    ds_read_b64 v[108:109], v108
    ds_read_b64 v[110:111], v110
    buffer_load_dwordx4 v[124:127], v69, s[12:15], s20 offen offset:1024 sc1
    s_waitcnt lgkmcnt(9)
    v_smfmac_f32_16x16x64_bf16 v[12:15], v[64:67], v[88:95], v68
    s_nop 0
    v_cvt_pk_bf16_f32 v112, v112, v113
    v_cvt_pk_bf16_f32 v113, v114, v115
    ds_write_b64 v70, v[112:113] offset:128
    v_mfma_f32_16x16x32_bf16 v[112:115], v[72:75], v[160:163], 0
    s_waitcnt vmcnt(2)
    v_lshlrev_b32_sdwa v88, 3, v116 dst_sel:DWORD dst_unused:UNUSED_PAD src0_sel:DWORD src1_sel:WORD_0
    v_lshlrev_b32_sdwa v90, 3, v116 dst_sel:DWORD dst_unused:UNUSED_PAD src0_sel:DWORD src1_sel:WORD_1
    ds_read_b64 v[88:89], v88
    ds_read_b64 v[90:91], v90
    v_mfma_f32_16x16x32_bf16 v[112:115], v[76:79], v[164:167], v[112:115]
    v_lshlrev_b32_sdwa v92, 3, v117 dst_sel:DWORD dst_unused:UNUSED_PAD src0_sel:DWORD src1_sel:WORD_0
    v_lshlrev_b32_sdwa v94, 3, v117 dst_sel:DWORD dst_unused:UNUSED_PAD src0_sel:DWORD src1_sel:WORD_1
    ds_read_b64 v[92:93], v92
    ds_read_b64 v[94:95], v94
    s_waitcnt lgkmcnt(10)
    v_smfmac_f32_16x16x64_bf16 v[16:19], v[64:67], v[96:103], v68
    v_mfma_f32_16x16x32_bf16 v[112:115], v[80:83], v[168:171], v[112:115]
    v_lshlrev_b32_sdwa v96, 3, v118 dst_sel:DWORD dst_unused:UNUSED_PAD src0_sel:DWORD src1_sel:WORD_0
    v_lshlrev_b32_sdwa v98, 3, v118 dst_sel:DWORD dst_unused:UNUSED_PAD src0_sel:DWORD src1_sel:WORD_1
    ds_read_b64 v[96:97], v96
    ds_read_b64 v[98:99], v98
    v_mfma_f32_16x16x32_bf16 v[112:115], v[84:87], v[172:175], v[112:115]
    v_lshlrev_b32_sdwa v100, 3, v119 dst_sel:DWORD dst_unused:UNUSED_PAD src0_sel:DWORD src1_sel:WORD_0
    v_lshlrev_b32_sdwa v102, 3, v119 dst_sel:DWORD dst_unused:UNUSED_PAD src0_sel:DWORD src1_sel:WORD_1
    ds_read_b64 v[100:101], v100
    ds_read_b64 v[102:103], v102
    buffer_load_dwordx4 v[116:119], v69, s[12:15], s20 offen offset:2048 sc1
    s_waitcnt lgkmcnt(9)
    v_smfmac_f32_16x16x64_bf16 v[20:23], v[64:67], v[104:111], v68
    s_nop 0
    v_cvt_pk_bf16_f32 v112, v112, v113
    v_cvt_pk_bf16_f32 v113, v114, v115
    ds_write_b64 v70, v[112:113] offset:256
    v_mfma_f32_16x16x32_bf16 v[112:115], v[72:75], v[176:179], 0
    v_mfma_f32_16x16x32_bf16 v[112:115], v[76:79], v[180:183], v[112:115]
    s_waitcnt vmcnt(2)
    v_lshlrev_b32_sdwa v104, 3, v120 dst_sel:DWORD dst_unused:UNUSED_PAD src0_sel:DWORD src1_sel:WORD_0
    v_lshlrev_b32_sdwa v106, 3, v120 dst_sel:DWORD dst_unused:UNUSED_PAD src0_sel:DWORD src1_sel:WORD_1
    ds_read_b64 v[104:105], v104
    ds_read_b64 v[106:107], v106
    v_mfma_f32_16x16x32_bf16 v[112:115], v[80:83], v[184:187], v[112:115]
    v_mfma_f32_16x16x32_bf16 v[112:115], v[84:87], v[188:191], v[112:115]
    v_lshlrev_b32_sdwa v108, 3, v121 dst_sel:DWORD dst_unused:UNUSED_PAD src0_sel:DWORD src1_sel:WORD_0
    v_lshlrev_b32_sdwa v110, 3, v121 dst_sel:DWORD dst_unused:UNUSED_PAD src0_sel:DWORD src1_sel:WORD_1
    ds_read_b64 v[108:109], v108
    ds_read_b64 v[110:111], v110
    s_waitcnt lgkmcnt(9)
    v_smfmac_f32_16x16x64_bf16 v[24:27], v[64:67], v[88:95], v68
    s_nop 1
    v_cvt_pk_bf16_f32 v112, v112, v113
    v_cvt_pk_bf16_f32 v113, v114, v115
    ds_write_b64 v70, v[112:113] offset:384
    v_mfma_f32_16x16x32_bf16 v[112:115], v[72:75], v[192:195], 0
    v_lshlrev_b32_sdwa v88, 3, v122 dst_sel:DWORD dst_unused:UNUSED_PAD src0_sel:DWORD src1_sel:WORD_0
    v_lshlrev_b32_sdwa v90, 3, v122 dst_sel:DWORD dst_unused:UNUSED_PAD src0_sel:DWORD src1_sel:WORD_1
    ds_read_b64 v[88:89], v88
    ds_read_b64 v[90:91], v90
    v_mfma_f32_16x16x32_bf16 v[112:115], v[76:79], v[196:199], v[112:115]
    v_lshlrev_b32_sdwa v92, 3, v123 dst_sel:DWORD dst_unused:UNUSED_PAD src0_sel:DWORD src1_sel:WORD_0
    v_lshlrev_b32_sdwa v94, 3, v123 dst_sel:DWORD dst_unused:UNUSED_PAD src0_sel:DWORD src1_sel:WORD_1
    ds_read_b64 v[92:93], v92
    ds_read_b64 v[94:95], v94
    buffer_load_dwordx4 v[120:123], v69, s[12:15], s20 offen offset:3072 sc1
    s_add_u32 s20, s20, 61440
    s_waitcnt lgkmcnt(10)
    v_smfmac_f32_16x16x64_bf16 v[28:31], v[64:67], v[96:103], v68
    s_setprio 2
    v_mfma_f32_16x16x32_bf16 v[112:115], v[80:83], v[200:203], v[112:115]
    s_waitcnt vmcnt(2)
    v_lshlrev_b32_sdwa v96, 3, v124 dst_sel:DWORD dst_unused:UNUSED_PAD src0_sel:DWORD src1_sel:WORD_0
    v_lshlrev_b32_sdwa v98, 3, v124 dst_sel:DWORD dst_unused:UNUSED_PAD src0_sel:DWORD src1_sel:WORD_1
    ds_read_b64 v[96:97], v96
    ds_read_b64 v[98:99], v98
    v_mfma_f32_16x16x32_bf16 v[112:115], v[84:87], v[204:207], v[112:115]
    v_lshlrev_b32_sdwa v100, 3, v125 dst_sel:DWORD dst_unused:UNUSED_PAD src0_sel:DWORD src1_sel:WORD_0
    v_lshlrev_b32_sdwa v102, 3, v125 dst_sel:DWORD dst_unused:UNUSED_PAD src0_sel:DWORD src1_sel:WORD_1
    ds_read_b64 v[100:101], v100
    ds_read_b64 v[102:103], v102
    s_waitcnt lgkmcnt(9)
    v_smfmac_f32_16x16x64_bf16 v[32:35], v[64:67], v[104:111], v68
    s_nop 1
    v_cvt_pk_bf16_f32 v112, v112, v113
    v_cvt_pk_bf16_f32 v113, v114, v115
    ds_write_b64 v70, v[112:113] offset:512
    v_mfma_f32_16x16x32_bf16 v[112:115], v[72:75], v[208:211], 0
    v_lshlrev_b32_sdwa v104, 3, v126 dst_sel:DWORD dst_unused:UNUSED_PAD src0_sel:DWORD src1_sel:WORD_0
    v_lshlrev_b32_sdwa v106, 3, v126 dst_sel:DWORD dst_unused:UNUSED_PAD src0_sel:DWORD src1_sel:WORD_1
    ds_read_b64 v[104:105], v104
    ds_read_b64 v[106:107], v106
    v_mfma_f32_16x16x32_bf16 v[112:115], v[76:79], v[212:215], v[112:115]
    v_lshlrev_b32_sdwa v108, 3, v127 dst_sel:DWORD dst_unused:UNUSED_PAD src0_sel:DWORD src1_sel:WORD_0
    v_lshlrev_b32_sdwa v110, 3, v127 dst_sel:DWORD dst_unused:UNUSED_PAD src0_sel:DWORD src1_sel:WORD_1
    ds_read_b64 v[108:109], v108
    ds_read_b64 v[110:111], v110
    buffer_load_dwordx4 v[124:127], v69, s[12:15], s20 offen offset:0 sc1
    s_waitcnt lgkmcnt(9)
    v_smfmac_f32_16x16x64_bf16 v[36:39], v[64:67], v[88:95], v68
    v_mfma_f32_16x16x32_bf16 v[112:115], v[80:83], v[216:219], v[112:115]
    s_waitcnt vmcnt(2)
    v_lshlrev_b32_sdwa v88, 3, v116 dst_sel:DWORD dst_unused:UNUSED_PAD src0_sel:DWORD src1_sel:WORD_0
    v_lshlrev_b32_sdwa v90, 3, v116 dst_sel:DWORD dst_unused:UNUSED_PAD src0_sel:DWORD src1_sel:WORD_1
    ds_read_b64 v[88:89], v88
    ds_read_b64 v[90:91], v90
    v_mfma_f32_16x16x32_bf16 v[112:115], v[84:87], v[220:223], v[112:115]
    v_lshlrev_b32_sdwa v92, 3, v117 dst_sel:DWORD dst_unused:UNUSED_PAD src0_sel:DWORD src1_sel:WORD_0
    v_lshlrev_b32_sdwa v94, 3, v117 dst_sel:DWORD dst_unused:UNUSED_PAD src0_sel:DWORD src1_sel:WORD_1
    ds_read_b64 v[92:93], v92
    ds_read_b64 v[94:95], v94
    s_waitcnt lgkmcnt(9)
    v_smfmac_f32_16x16x64_bf16 v[40:43], v[64:67], v[96:103], v68
    s_nop 1
    v_cvt_pk_bf16_f32 v112, v112, v113
    v_cvt_pk_bf16_f32 v113, v114, v115
    ds_write_b64 v70, v[112:113] offset:640
    v_mfma_f32_16x16x32_bf16 v[112:115], v[72:75], v[224:227], 0
    v_mfma_f32_16x16x32_bf16 v[112:115], v[76:79], v[228:231], v[112:115]
    v_lshlrev_b32_sdwa v96, 3, v118 dst_sel:DWORD dst_unused:UNUSED_PAD src0_sel:DWORD src1_sel:WORD_0
    v_lshlrev_b32_sdwa v98, 3, v118 dst_sel:DWORD dst_unused:UNUSED_PAD src0_sel:DWORD src1_sel:WORD_1
    ds_read_b64 v[96:97], v96
    ds_read_b64 v[98:99], v98
    v_mfma_f32_16x16x32_bf16 v[112:115], v[80:83], v[232:235], v[112:115]
    v_mfma_f32_16x16x32_bf16 v[112:115], v[84:87], v[236:239], v[112:115]
    v_lshlrev_b32_sdwa v100, 3, v119 dst_sel:DWORD dst_unused:UNUSED_PAD src0_sel:DWORD src1_sel:WORD_0
    v_lshlrev_b32_sdwa v102, 3, v119 dst_sel:DWORD dst_unused:UNUSED_PAD src0_sel:DWORD src1_sel:WORD_1
    ds_read_b64 v[100:101], v100
    ds_read_b64 v[102:103], v102
    buffer_load_dwordx4 v[116:119], v69, s[12:15], s20 offen offset:1024 sc1
    s_waitcnt lgkmcnt(9)
    v_smfmac_f32_16x16x64_bf16 v[44:47], v[64:67], v[104:111], v68
    s_nop 0
    v_cvt_pk_bf16_f32 v112, v112, v113
    v_cvt_pk_bf16_f32 v113, v114, v115
    ds_write_b64 v70, v[112:113] offset:768
    s_setprio 1
    v_mfma_f32_16x16x32_bf16 v[112:115], v[72:75], v[240:243], 0
    buffer_load_dwordx4 v[72:75], v69, s[12:15], s21 offen offset:0
    s_waitcnt vmcnt(3)
    v_lshlrev_b32_sdwa v104, 3, v120 dst_sel:DWORD dst_unused:UNUSED_PAD src0_sel:DWORD src1_sel:WORD_0
    v_lshlrev_b32_sdwa v106, 3, v120 dst_sel:DWORD dst_unused:UNUSED_PAD src0_sel:DWORD src1_sel:WORD_1
    ds_read_b64 v[104:105], v104
    ds_read_b64 v[106:107], v106
    v_mfma_f32_16x16x32_bf16 v[112:115], v[76:79], v[244:247], v[112:115]
    buffer_load_dwordx4 v[76:79], v69, s[12:15], s21 offen offset:1024
    v_lshlrev_b32_sdwa v108, 3, v121 dst_sel:DWORD dst_unused:UNUSED_PAD src0_sel:DWORD src1_sel:WORD_0
    v_lshlrev_b32_sdwa v110, 3, v121 dst_sel:DWORD dst_unused:UNUSED_PAD src0_sel:DWORD src1_sel:WORD_1
    ds_read_b64 v[108:109], v108
    ds_read_b64 v[110:111], v110
    s_waitcnt lgkmcnt(10)
    v_smfmac_f32_16x16x64_bf16 v[48:51], v[64:67], v[88:95], v68
    v_mfma_f32_16x16x32_bf16 v[112:115], v[80:83], v[248:251], v[112:115]
    buffer_load_dwordx4 v[80:83], v69, s[12:15], s19 offen offset:0
    v_lshlrev_b32_sdwa v88, 3, v122 dst_sel:DWORD dst_unused:UNUSED_PAD src0_sel:DWORD src1_sel:WORD_0
    v_lshlrev_b32_sdwa v90, 3, v122 dst_sel:DWORD dst_unused:UNUSED_PAD src0_sel:DWORD src1_sel:WORD_1
    ds_read_b64 v[88:89], v88
    ds_read_b64 v[90:91], v90
    v_mfma_f32_16x16x32_bf16 v[112:115], v[84:87], v[252:255], v[112:115]
    buffer_load_dwordx4 v[84:87], v69, s[12:15], s19 offen offset:1024
    s_add_u32 s21, s21, 4096
    s_add_u32 s19, s19, 4096
    v_lshlrev_b32_sdwa v92, 3, v123 dst_sel:DWORD dst_unused:UNUSED_PAD src0_sel:DWORD src1_sel:WORD_0
    v_lshlrev_b32_sdwa v94, 3, v123 dst_sel:DWORD dst_unused:UNUSED_PAD src0_sel:DWORD src1_sel:WORD_1
    ds_read_b64 v[92:93], v92
    ds_read_b64 v[94:95], v94
    buffer_load_dwordx4 v[120:123], v69, s[12:15], s20 offen offset:2048 sc1
    s_waitcnt lgkmcnt(9)
    v_smfmac_f32_16x16x64_bf16 v[52:55], v[64:67], v[96:103], v68
    v_cvt_pk_bf16_f32 v112, v112, v113
    v_cvt_pk_bf16_f32 v113, v114, v115
    ds_write_b64 v70, v[112:113] offset:896
    s_add_u32 s23, s23, 1
    s_cmp_eq_u32 s23, 5
    s_cselect_b32 s35, 4294836224, s32
    s_cselect_b32 s23, 0, s23
    v_add_u32 v70, s35, v70
    s_waitcnt vmcnt(6)
    v_lshlrev_b32_sdwa v96, 3, v124 dst_sel:DWORD dst_unused:UNUSED_PAD src0_sel:DWORD src1_sel:WORD_0
    v_lshlrev_b32_sdwa v98, 3, v124 dst_sel:DWORD dst_unused:UNUSED_PAD src0_sel:DWORD src1_sel:WORD_1
    ds_read_b64 v[96:97], v96
    ds_read_b64 v[98:99], v98
    v_lshlrev_b32_sdwa v100, 3, v125 dst_sel:DWORD dst_unused:UNUSED_PAD src0_sel:DWORD src1_sel:WORD_0
    v_lshlrev_b32_sdwa v102, 3, v125 dst_sel:DWORD dst_unused:UNUSED_PAD src0_sel:DWORD src1_sel:WORD_1
    ds_read_b64 v[100:101], v100
    ds_read_b64 v[102:103], v102
    s_waitcnt lgkmcnt(9)
    v_smfmac_f32_16x16x64_bf16 v[56:59], v[64:67], v[104:111], v68
    s_setprio 0
    v_lshlrev_b32_sdwa v104, 3, v126 dst_sel:DWORD dst_unused:UNUSED_PAD src0_sel:DWORD src1_sel:WORD_0
    v_lshlrev_b32_sdwa v106, 3, v126 dst_sel:DWORD dst_unused:UNUSED_PAD src0_sel:DWORD src1_sel:WORD_1
    ds_read_b64 v[104:105], v104
    ds_read_b64 v[106:107], v106
    v_lshlrev_b32_sdwa v108, 3, v127 dst_sel:DWORD dst_unused:UNUSED_PAD src0_sel:DWORD src1_sel:WORD_0
    v_lshlrev_b32_sdwa v110, 3, v127 dst_sel:DWORD dst_unused:UNUSED_PAD src0_sel:DWORD src1_sel:WORD_1
    ds_read_b64 v[108:109], v108
    ds_read_b64 v[110:111], v110
    buffer_load_dwordx4 v[124:127], v69, s[12:15], s20 offen offset:3072 sc1
    s_add_u32 s20, s20, 4096
    s_waitcnt lgkmcnt(9)
    v_smfmac_f32_16x16x64_bf16 v[60:63], v[64:67], v[88:95], v68
    s_waitcnt lgkmcnt(8)
    s_barrier

    s_cmp_eq_u32 s22, 7
    s_cbranch_scc1 standalone__deep_cross_pnn__recsys_kernel_fin

    s_setprio 3
    s_waitcnt vmcnt(6)
    v_lshlrev_b32_sdwa v88, 3, v116 dst_sel:DWORD dst_unused:UNUSED_PAD src0_sel:DWORD src1_sel:WORD_0
    v_lshlrev_b32_sdwa v90, 3, v116 dst_sel:DWORD dst_unused:UNUSED_PAD src0_sel:DWORD src1_sel:WORD_1
    ds_read_b64 v[88:89], v88
    ds_read_b64 v[90:91], v90
    v_lshlrev_b32_sdwa v92, 3, v117 dst_sel:DWORD dst_unused:UNUSED_PAD src0_sel:DWORD src1_sel:WORD_0
    v_lshlrev_b32_sdwa v94, 3, v117 dst_sel:DWORD dst_unused:UNUSED_PAD src0_sel:DWORD src1_sel:WORD_1
    ds_read_b64 v[92:93], v92
    ds_read_b64 v[94:95], v94
    s_waitcnt lgkmcnt(8)
    v_smfmac_f32_16x16x64_bf16 v[0:3], v[64:67], v[96:103], v68
    s_waitcnt vmcnt(5)
    v_mfma_f32_16x16x32_bf16 v[112:115], v[72:75], v[128:131], 0
    v_lshlrev_b32_sdwa v96, 3, v118 dst_sel:DWORD dst_unused:UNUSED_PAD src0_sel:DWORD src1_sel:WORD_0
    v_lshlrev_b32_sdwa v98, 3, v118 dst_sel:DWORD dst_unused:UNUSED_PAD src0_sel:DWORD src1_sel:WORD_1
    ds_read_b64 v[96:97], v96
    ds_read_b64 v[98:99], v98
    s_waitcnt vmcnt(4)
    v_mfma_f32_16x16x32_bf16 v[112:115], v[76:79], v[132:135], v[112:115]
    v_lshlrev_b32_sdwa v100, 3, v119 dst_sel:DWORD dst_unused:UNUSED_PAD src0_sel:DWORD src1_sel:WORD_0
    v_lshlrev_b32_sdwa v102, 3, v119 dst_sel:DWORD dst_unused:UNUSED_PAD src0_sel:DWORD src1_sel:WORD_1
    ds_read_b64 v[100:101], v100
    ds_read_b64 v[102:103], v102
    buffer_load_dwordx4 v[116:119], v69, s[12:15], s20 offen offset:0 sc1
    s_waitcnt lgkmcnt(8)
    v_smfmac_f32_16x16x64_bf16 v[4:7], v[64:67], v[104:111], v68
    s_waitcnt vmcnt(4)
    v_mfma_f32_16x16x32_bf16 v[112:115], v[80:83], v[136:139], v[112:115]
    s_waitcnt vmcnt(2)
    v_lshlrev_b32_sdwa v104, 3, v120 dst_sel:DWORD dst_unused:UNUSED_PAD src0_sel:DWORD src1_sel:WORD_0
    v_lshlrev_b32_sdwa v106, 3, v120 dst_sel:DWORD dst_unused:UNUSED_PAD src0_sel:DWORD src1_sel:WORD_1
    ds_read_b64 v[104:105], v104
    ds_read_b64 v[106:107], v106
    s_waitcnt vmcnt(3)
    v_mfma_f32_16x16x32_bf16 v[112:115], v[84:87], v[140:143], v[112:115]
    v_lshlrev_b32_sdwa v108, 3, v121 dst_sel:DWORD dst_unused:UNUSED_PAD src0_sel:DWORD src1_sel:WORD_0
    v_lshlrev_b32_sdwa v110, 3, v121 dst_sel:DWORD dst_unused:UNUSED_PAD src0_sel:DWORD src1_sel:WORD_1
    ds_read_b64 v[108:109], v108
    ds_read_b64 v[110:111], v110
    s_waitcnt lgkmcnt(8)
    v_smfmac_f32_16x16x64_bf16 v[8:11], v[64:67], v[88:95], v68
    s_nop 1
    v_cvt_pk_bf16_f32 v112, v112, v113
    v_cvt_pk_bf16_f32 v113, v114, v115
    ds_write_b64 v70, v[112:113] offset:0
    v_mfma_f32_16x16x32_bf16 v[112:115], v[72:75], v[144:147], 0
    v_mfma_f32_16x16x32_bf16 v[112:115], v[76:79], v[148:151], v[112:115]
    v_lshlrev_b32_sdwa v88, 3, v122 dst_sel:DWORD dst_unused:UNUSED_PAD src0_sel:DWORD src1_sel:WORD_0
    v_lshlrev_b32_sdwa v90, 3, v122 dst_sel:DWORD dst_unused:UNUSED_PAD src0_sel:DWORD src1_sel:WORD_1
    ds_read_b64 v[88:89], v88
    ds_read_b64 v[90:91], v90
    v_mfma_f32_16x16x32_bf16 v[112:115], v[80:83], v[152:155], v[112:115]
    v_mfma_f32_16x16x32_bf16 v[112:115], v[84:87], v[156:159], v[112:115]
    v_lshlrev_b32_sdwa v92, 3, v123 dst_sel:DWORD dst_unused:UNUSED_PAD src0_sel:DWORD src1_sel:WORD_0
    v_lshlrev_b32_sdwa v94, 3, v123 dst_sel:DWORD dst_unused:UNUSED_PAD src0_sel:DWORD src1_sel:WORD_1
    ds_read_b64 v[92:93], v92
    ds_read_b64 v[94:95], v94
    buffer_load_dwordx4 v[120:123], v69, s[12:15], s20 offen offset:1024 sc1
    s_waitcnt lgkmcnt(9)
    v_smfmac_f32_16x16x64_bf16 v[12:15], v[64:67], v[96:103], v68
    s_nop 0
    v_cvt_pk_bf16_f32 v112, v112, v113
    v_cvt_pk_bf16_f32 v113, v114, v115
    ds_write_b64 v70, v[112:113] offset:128
    v_mfma_f32_16x16x32_bf16 v[112:115], v[72:75], v[160:163], 0
    s_waitcnt vmcnt(2)
    v_lshlrev_b32_sdwa v96, 3, v124 dst_sel:DWORD dst_unused:UNUSED_PAD src0_sel:DWORD src1_sel:WORD_0
    v_lshlrev_b32_sdwa v98, 3, v124 dst_sel:DWORD dst_unused:UNUSED_PAD src0_sel:DWORD src1_sel:WORD_1
    ds_read_b64 v[96:97], v96
    ds_read_b64 v[98:99], v98
    v_mfma_f32_16x16x32_bf16 v[112:115], v[76:79], v[164:167], v[112:115]
    v_lshlrev_b32_sdwa v100, 3, v125 dst_sel:DWORD dst_unused:UNUSED_PAD src0_sel:DWORD src1_sel:WORD_0
    v_lshlrev_b32_sdwa v102, 3, v125 dst_sel:DWORD dst_unused:UNUSED_PAD src0_sel:DWORD src1_sel:WORD_1
    ds_read_b64 v[100:101], v100
    ds_read_b64 v[102:103], v102
    s_waitcnt lgkmcnt(10)
    v_smfmac_f32_16x16x64_bf16 v[16:19], v[64:67], v[104:111], v68
    v_mfma_f32_16x16x32_bf16 v[112:115], v[80:83], v[168:171], v[112:115]
    v_lshlrev_b32_sdwa v104, 3, v126 dst_sel:DWORD dst_unused:UNUSED_PAD src0_sel:DWORD src1_sel:WORD_0
    v_lshlrev_b32_sdwa v106, 3, v126 dst_sel:DWORD dst_unused:UNUSED_PAD src0_sel:DWORD src1_sel:WORD_1
    ds_read_b64 v[104:105], v104
    ds_read_b64 v[106:107], v106
    v_mfma_f32_16x16x32_bf16 v[112:115], v[84:87], v[172:175], v[112:115]
    v_lshlrev_b32_sdwa v108, 3, v127 dst_sel:DWORD dst_unused:UNUSED_PAD src0_sel:DWORD src1_sel:WORD_0
    v_lshlrev_b32_sdwa v110, 3, v127 dst_sel:DWORD dst_unused:UNUSED_PAD src0_sel:DWORD src1_sel:WORD_1
    ds_read_b64 v[108:109], v108
    ds_read_b64 v[110:111], v110
    buffer_load_dwordx4 v[124:127], v69, s[12:15], s20 offen offset:2048 sc1
    s_waitcnt lgkmcnt(9)
    v_smfmac_f32_16x16x64_bf16 v[20:23], v[64:67], v[88:95], v68
    s_nop 0
    v_cvt_pk_bf16_f32 v112, v112, v113
    v_cvt_pk_bf16_f32 v113, v114, v115
    ds_write_b64 v70, v[112:113] offset:256
    v_mfma_f32_16x16x32_bf16 v[112:115], v[72:75], v[176:179], 0
    v_mfma_f32_16x16x32_bf16 v[112:115], v[76:79], v[180:183], v[112:115]
    s_waitcnt vmcnt(2)
    v_lshlrev_b32_sdwa v88, 3, v116 dst_sel:DWORD dst_unused:UNUSED_PAD src0_sel:DWORD src1_sel:WORD_0
    v_lshlrev_b32_sdwa v90, 3, v116 dst_sel:DWORD dst_unused:UNUSED_PAD src0_sel:DWORD src1_sel:WORD_1
    ds_read_b64 v[88:89], v88
    ds_read_b64 v[90:91], v90
    v_mfma_f32_16x16x32_bf16 v[112:115], v[80:83], v[184:187], v[112:115]
    v_mfma_f32_16x16x32_bf16 v[112:115], v[84:87], v[188:191], v[112:115]
    v_lshlrev_b32_sdwa v92, 3, v117 dst_sel:DWORD dst_unused:UNUSED_PAD src0_sel:DWORD src1_sel:WORD_0
    v_lshlrev_b32_sdwa v94, 3, v117 dst_sel:DWORD dst_unused:UNUSED_PAD src0_sel:DWORD src1_sel:WORD_1
    ds_read_b64 v[92:93], v92
    ds_read_b64 v[94:95], v94
    s_waitcnt lgkmcnt(9)
    v_smfmac_f32_16x16x64_bf16 v[24:27], v[64:67], v[96:103], v68
    s_nop 1
    v_cvt_pk_bf16_f32 v112, v112, v113
    v_cvt_pk_bf16_f32 v113, v114, v115
    ds_write_b64 v70, v[112:113] offset:384
    v_mfma_f32_16x16x32_bf16 v[112:115], v[72:75], v[192:195], 0
    v_lshlrev_b32_sdwa v96, 3, v118 dst_sel:DWORD dst_unused:UNUSED_PAD src0_sel:DWORD src1_sel:WORD_0
    v_lshlrev_b32_sdwa v98, 3, v118 dst_sel:DWORD dst_unused:UNUSED_PAD src0_sel:DWORD src1_sel:WORD_1
    ds_read_b64 v[96:97], v96
    ds_read_b64 v[98:99], v98
    v_mfma_f32_16x16x32_bf16 v[112:115], v[76:79], v[196:199], v[112:115]
    v_lshlrev_b32_sdwa v100, 3, v119 dst_sel:DWORD dst_unused:UNUSED_PAD src0_sel:DWORD src1_sel:WORD_0
    v_lshlrev_b32_sdwa v102, 3, v119 dst_sel:DWORD dst_unused:UNUSED_PAD src0_sel:DWORD src1_sel:WORD_1
    ds_read_b64 v[100:101], v100
    ds_read_b64 v[102:103], v102
    buffer_load_dwordx4 v[116:119], v69, s[12:15], s20 offen offset:3072 sc1
    s_add_u32 s20, s20, 61440
    s_waitcnt lgkmcnt(10)
    v_smfmac_f32_16x16x64_bf16 v[28:31], v[64:67], v[104:111], v68
    s_setprio 2
    v_mfma_f32_16x16x32_bf16 v[112:115], v[80:83], v[200:203], v[112:115]
    s_waitcnt vmcnt(2)
    v_lshlrev_b32_sdwa v104, 3, v120 dst_sel:DWORD dst_unused:UNUSED_PAD src0_sel:DWORD src1_sel:WORD_0
    v_lshlrev_b32_sdwa v106, 3, v120 dst_sel:DWORD dst_unused:UNUSED_PAD src0_sel:DWORD src1_sel:WORD_1
    ds_read_b64 v[104:105], v104
    ds_read_b64 v[106:107], v106
    v_mfma_f32_16x16x32_bf16 v[112:115], v[84:87], v[204:207], v[112:115]
    v_lshlrev_b32_sdwa v108, 3, v121 dst_sel:DWORD dst_unused:UNUSED_PAD src0_sel:DWORD src1_sel:WORD_0
    v_lshlrev_b32_sdwa v110, 3, v121 dst_sel:DWORD dst_unused:UNUSED_PAD src0_sel:DWORD src1_sel:WORD_1
    ds_read_b64 v[108:109], v108
    ds_read_b64 v[110:111], v110
    s_waitcnt lgkmcnt(9)
    v_smfmac_f32_16x16x64_bf16 v[32:35], v[64:67], v[88:95], v68
    s_nop 1
    v_cvt_pk_bf16_f32 v112, v112, v113
    v_cvt_pk_bf16_f32 v113, v114, v115
    ds_write_b64 v70, v[112:113] offset:512
    v_mfma_f32_16x16x32_bf16 v[112:115], v[72:75], v[208:211], 0
    v_lshlrev_b32_sdwa v88, 3, v122 dst_sel:DWORD dst_unused:UNUSED_PAD src0_sel:DWORD src1_sel:WORD_0
    v_lshlrev_b32_sdwa v90, 3, v122 dst_sel:DWORD dst_unused:UNUSED_PAD src0_sel:DWORD src1_sel:WORD_1
    ds_read_b64 v[88:89], v88
    ds_read_b64 v[90:91], v90
    v_mfma_f32_16x16x32_bf16 v[112:115], v[76:79], v[212:215], v[112:115]
    v_lshlrev_b32_sdwa v92, 3, v123 dst_sel:DWORD dst_unused:UNUSED_PAD src0_sel:DWORD src1_sel:WORD_0
    v_lshlrev_b32_sdwa v94, 3, v123 dst_sel:DWORD dst_unused:UNUSED_PAD src0_sel:DWORD src1_sel:WORD_1
    ds_read_b64 v[92:93], v92
    ds_read_b64 v[94:95], v94
    buffer_load_dwordx4 v[120:123], v69, s[12:15], s20 offen offset:0 sc1
    s_waitcnt lgkmcnt(9)
    v_smfmac_f32_16x16x64_bf16 v[36:39], v[64:67], v[96:103], v68
    v_mfma_f32_16x16x32_bf16 v[112:115], v[80:83], v[216:219], v[112:115]
    s_waitcnt vmcnt(2)
    v_lshlrev_b32_sdwa v96, 3, v124 dst_sel:DWORD dst_unused:UNUSED_PAD src0_sel:DWORD src1_sel:WORD_0
    v_lshlrev_b32_sdwa v98, 3, v124 dst_sel:DWORD dst_unused:UNUSED_PAD src0_sel:DWORD src1_sel:WORD_1
    ds_read_b64 v[96:97], v96
    ds_read_b64 v[98:99], v98
    v_mfma_f32_16x16x32_bf16 v[112:115], v[84:87], v[220:223], v[112:115]
    v_lshlrev_b32_sdwa v100, 3, v125 dst_sel:DWORD dst_unused:UNUSED_PAD src0_sel:DWORD src1_sel:WORD_0
    v_lshlrev_b32_sdwa v102, 3, v125 dst_sel:DWORD dst_unused:UNUSED_PAD src0_sel:DWORD src1_sel:WORD_1
    ds_read_b64 v[100:101], v100
    ds_read_b64 v[102:103], v102
    s_waitcnt lgkmcnt(9)
    v_smfmac_f32_16x16x64_bf16 v[40:43], v[64:67], v[104:111], v68
    s_nop 1
    v_cvt_pk_bf16_f32 v112, v112, v113
    v_cvt_pk_bf16_f32 v113, v114, v115
    ds_write_b64 v70, v[112:113] offset:640
    v_mfma_f32_16x16x32_bf16 v[112:115], v[72:75], v[224:227], 0
    v_mfma_f32_16x16x32_bf16 v[112:115], v[76:79], v[228:231], v[112:115]
    v_lshlrev_b32_sdwa v104, 3, v126 dst_sel:DWORD dst_unused:UNUSED_PAD src0_sel:DWORD src1_sel:WORD_0
    v_lshlrev_b32_sdwa v106, 3, v126 dst_sel:DWORD dst_unused:UNUSED_PAD src0_sel:DWORD src1_sel:WORD_1
    ds_read_b64 v[104:105], v104
    ds_read_b64 v[106:107], v106
    v_mfma_f32_16x16x32_bf16 v[112:115], v[80:83], v[232:235], v[112:115]
    v_mfma_f32_16x16x32_bf16 v[112:115], v[84:87], v[236:239], v[112:115]
    v_lshlrev_b32_sdwa v108, 3, v127 dst_sel:DWORD dst_unused:UNUSED_PAD src0_sel:DWORD src1_sel:WORD_0
    v_lshlrev_b32_sdwa v110, 3, v127 dst_sel:DWORD dst_unused:UNUSED_PAD src0_sel:DWORD src1_sel:WORD_1
    ds_read_b64 v[108:109], v108
    ds_read_b64 v[110:111], v110
    buffer_load_dwordx4 v[124:127], v69, s[12:15], s20 offen offset:1024 sc1
    s_waitcnt lgkmcnt(9)
    v_smfmac_f32_16x16x64_bf16 v[44:47], v[64:67], v[88:95], v68
    s_nop 0
    v_cvt_pk_bf16_f32 v112, v112, v113
    v_cvt_pk_bf16_f32 v113, v114, v115
    ds_write_b64 v70, v[112:113] offset:768
    s_setprio 1
    v_mfma_f32_16x16x32_bf16 v[112:115], v[72:75], v[240:243], 0
    buffer_load_dwordx4 v[72:75], v69, s[12:15], s21 offen offset:0
    s_waitcnt vmcnt(3)
    v_lshlrev_b32_sdwa v88, 3, v116 dst_sel:DWORD dst_unused:UNUSED_PAD src0_sel:DWORD src1_sel:WORD_0
    v_lshlrev_b32_sdwa v90, 3, v116 dst_sel:DWORD dst_unused:UNUSED_PAD src0_sel:DWORD src1_sel:WORD_1
    ds_read_b64 v[88:89], v88
    ds_read_b64 v[90:91], v90
    v_mfma_f32_16x16x32_bf16 v[112:115], v[76:79], v[244:247], v[112:115]
    buffer_load_dwordx4 v[76:79], v69, s[12:15], s21 offen offset:1024
    v_lshlrev_b32_sdwa v92, 3, v117 dst_sel:DWORD dst_unused:UNUSED_PAD src0_sel:DWORD src1_sel:WORD_0
    v_lshlrev_b32_sdwa v94, 3, v117 dst_sel:DWORD dst_unused:UNUSED_PAD src0_sel:DWORD src1_sel:WORD_1
    ds_read_b64 v[92:93], v92
    ds_read_b64 v[94:95], v94
    s_waitcnt lgkmcnt(10)
    v_smfmac_f32_16x16x64_bf16 v[48:51], v[64:67], v[96:103], v68
    v_mfma_f32_16x16x32_bf16 v[112:115], v[80:83], v[248:251], v[112:115]
    buffer_load_dwordx4 v[80:83], v69, s[12:15], s19 offen offset:0
    v_lshlrev_b32_sdwa v96, 3, v118 dst_sel:DWORD dst_unused:UNUSED_PAD src0_sel:DWORD src1_sel:WORD_0
    v_lshlrev_b32_sdwa v98, 3, v118 dst_sel:DWORD dst_unused:UNUSED_PAD src0_sel:DWORD src1_sel:WORD_1
    ds_read_b64 v[96:97], v96
    ds_read_b64 v[98:99], v98
    v_mfma_f32_16x16x32_bf16 v[112:115], v[84:87], v[252:255], v[112:115]
    buffer_load_dwordx4 v[84:87], v69, s[12:15], s19 offen offset:1024
    s_add_u32 s21, s21, 4096
    s_add_u32 s19, s19, 4096
    v_lshlrev_b32_sdwa v100, 3, v119 dst_sel:DWORD dst_unused:UNUSED_PAD src0_sel:DWORD src1_sel:WORD_0
    v_lshlrev_b32_sdwa v102, 3, v119 dst_sel:DWORD dst_unused:UNUSED_PAD src0_sel:DWORD src1_sel:WORD_1
    ds_read_b64 v[100:101], v100
    ds_read_b64 v[102:103], v102
    buffer_load_dwordx4 v[116:119], v69, s[12:15], s20 offen offset:2048 sc1
    s_waitcnt lgkmcnt(9)
    v_smfmac_f32_16x16x64_bf16 v[52:55], v[64:67], v[104:111], v68
    v_cvt_pk_bf16_f32 v112, v112, v113
    v_cvt_pk_bf16_f32 v113, v114, v115
    ds_write_b64 v70, v[112:113] offset:896
    s_add_u32 s23, s23, 1
    s_cmp_eq_u32 s23, 5
    s_cselect_b32 s35, 4294836224, s32
    s_cselect_b32 s23, 0, s23
    v_add_u32 v70, s35, v70
    s_waitcnt vmcnt(6)
    v_lshlrev_b32_sdwa v104, 3, v120 dst_sel:DWORD dst_unused:UNUSED_PAD src0_sel:DWORD src1_sel:WORD_0
    v_lshlrev_b32_sdwa v106, 3, v120 dst_sel:DWORD dst_unused:UNUSED_PAD src0_sel:DWORD src1_sel:WORD_1
    ds_read_b64 v[104:105], v104
    ds_read_b64 v[106:107], v106
    v_lshlrev_b32_sdwa v108, 3, v121 dst_sel:DWORD dst_unused:UNUSED_PAD src0_sel:DWORD src1_sel:WORD_0
    v_lshlrev_b32_sdwa v110, 3, v121 dst_sel:DWORD dst_unused:UNUSED_PAD src0_sel:DWORD src1_sel:WORD_1
    ds_read_b64 v[108:109], v108
    ds_read_b64 v[110:111], v110
    s_waitcnt lgkmcnt(9)
    v_smfmac_f32_16x16x64_bf16 v[56:59], v[64:67], v[88:95], v68
    s_setprio 0
    v_lshlrev_b32_sdwa v88, 3, v122 dst_sel:DWORD dst_unused:UNUSED_PAD src0_sel:DWORD src1_sel:WORD_0
    v_lshlrev_b32_sdwa v90, 3, v122 dst_sel:DWORD dst_unused:UNUSED_PAD src0_sel:DWORD src1_sel:WORD_1
    ds_read_b64 v[88:89], v88
    ds_read_b64 v[90:91], v90
    v_lshlrev_b32_sdwa v92, 3, v123 dst_sel:DWORD dst_unused:UNUSED_PAD src0_sel:DWORD src1_sel:WORD_0
    v_lshlrev_b32_sdwa v94, 3, v123 dst_sel:DWORD dst_unused:UNUSED_PAD src0_sel:DWORD src1_sel:WORD_1
    ds_read_b64 v[92:93], v92
    ds_read_b64 v[94:95], v94
    buffer_load_dwordx4 v[120:123], v69, s[12:15], s20 offen offset:3072 sc1
    s_add_u32 s20, s20, 4096
    s_waitcnt lgkmcnt(9)
    v_smfmac_f32_16x16x64_bf16 v[60:63], v[64:67], v[96:103], v68
    s_waitcnt lgkmcnt(8)
    s_barrier
    s_setprio 3
    s_waitcnt vmcnt(6)
    v_lshlrev_b32_sdwa v96, 3, v124 dst_sel:DWORD dst_unused:UNUSED_PAD src0_sel:DWORD src1_sel:WORD_0
    v_lshlrev_b32_sdwa v98, 3, v124 dst_sel:DWORD dst_unused:UNUSED_PAD src0_sel:DWORD src1_sel:WORD_1
    ds_read_b64 v[96:97], v96
    ds_read_b64 v[98:99], v98
    v_lshlrev_b32_sdwa v100, 3, v125 dst_sel:DWORD dst_unused:UNUSED_PAD src0_sel:DWORD src1_sel:WORD_0
    v_lshlrev_b32_sdwa v102, 3, v125 dst_sel:DWORD dst_unused:UNUSED_PAD src0_sel:DWORD src1_sel:WORD_1
    ds_read_b64 v[100:101], v100
    ds_read_b64 v[102:103], v102
    s_waitcnt lgkmcnt(8)
    v_smfmac_f32_16x16x64_bf16 v[0:3], v[64:67], v[104:111], v68
    s_waitcnt vmcnt(5)
    v_mfma_f32_16x16x32_bf16 v[112:115], v[72:75], v[128:131], 0
    v_lshlrev_b32_sdwa v104, 3, v126 dst_sel:DWORD dst_unused:UNUSED_PAD src0_sel:DWORD src1_sel:WORD_0
    v_lshlrev_b32_sdwa v106, 3, v126 dst_sel:DWORD dst_unused:UNUSED_PAD src0_sel:DWORD src1_sel:WORD_1
    ds_read_b64 v[104:105], v104
    ds_read_b64 v[106:107], v106
    s_waitcnt vmcnt(4)
    v_mfma_f32_16x16x32_bf16 v[112:115], v[76:79], v[132:135], v[112:115]
    v_lshlrev_b32_sdwa v108, 3, v127 dst_sel:DWORD dst_unused:UNUSED_PAD src0_sel:DWORD src1_sel:WORD_0
    v_lshlrev_b32_sdwa v110, 3, v127 dst_sel:DWORD dst_unused:UNUSED_PAD src0_sel:DWORD src1_sel:WORD_1
    ds_read_b64 v[108:109], v108
    ds_read_b64 v[110:111], v110
    buffer_load_dwordx4 v[124:127], v69, s[12:15], s20 offen offset:0 sc1
    s_waitcnt lgkmcnt(8)
    v_smfmac_f32_16x16x64_bf16 v[4:7], v[64:67], v[88:95], v68
    s_waitcnt vmcnt(4)
    v_mfma_f32_16x16x32_bf16 v[112:115], v[80:83], v[136:139], v[112:115]
    s_waitcnt vmcnt(2)
    v_lshlrev_b32_sdwa v88, 3, v116 dst_sel:DWORD dst_unused:UNUSED_PAD src0_sel:DWORD src1_sel:WORD_0
    v_lshlrev_b32_sdwa v90, 3, v116 dst_sel:DWORD dst_unused:UNUSED_PAD src0_sel:DWORD src1_sel:WORD_1
    ds_read_b64 v[88:89], v88
    ds_read_b64 v[90:91], v90
    s_waitcnt vmcnt(3)
    v_mfma_f32_16x16x32_bf16 v[112:115], v[84:87], v[140:143], v[112:115]
    v_lshlrev_b32_sdwa v92, 3, v117 dst_sel:DWORD dst_unused:UNUSED_PAD src0_sel:DWORD src1_sel:WORD_0
    v_lshlrev_b32_sdwa v94, 3, v117 dst_sel:DWORD dst_unused:UNUSED_PAD src0_sel:DWORD src1_sel:WORD_1
    ds_read_b64 v[92:93], v92
    ds_read_b64 v[94:95], v94
    s_waitcnt lgkmcnt(8)
    v_smfmac_f32_16x16x64_bf16 v[8:11], v[64:67], v[96:103], v68
    s_nop 1
    v_cvt_pk_bf16_f32 v112, v112, v113
    v_cvt_pk_bf16_f32 v113, v114, v115
    ds_write_b64 v70, v[112:113] offset:0
    v_mfma_f32_16x16x32_bf16 v[112:115], v[72:75], v[144:147], 0
    v_mfma_f32_16x16x32_bf16 v[112:115], v[76:79], v[148:151], v[112:115]
    v_lshlrev_b32_sdwa v96, 3, v118 dst_sel:DWORD dst_unused:UNUSED_PAD src0_sel:DWORD src1_sel:WORD_0
    v_lshlrev_b32_sdwa v98, 3, v118 dst_sel:DWORD dst_unused:UNUSED_PAD src0_sel:DWORD src1_sel:WORD_1
    ds_read_b64 v[96:97], v96
    ds_read_b64 v[98:99], v98
    v_mfma_f32_16x16x32_bf16 v[112:115], v[80:83], v[152:155], v[112:115]
    v_mfma_f32_16x16x32_bf16 v[112:115], v[84:87], v[156:159], v[112:115]
    v_lshlrev_b32_sdwa v100, 3, v119 dst_sel:DWORD dst_unused:UNUSED_PAD src0_sel:DWORD src1_sel:WORD_0
    v_lshlrev_b32_sdwa v102, 3, v119 dst_sel:DWORD dst_unused:UNUSED_PAD src0_sel:DWORD src1_sel:WORD_1
    ds_read_b64 v[100:101], v100
    ds_read_b64 v[102:103], v102
    buffer_load_dwordx4 v[116:119], v69, s[12:15], s20 offen offset:1024 sc1
    s_waitcnt lgkmcnt(9)
    v_smfmac_f32_16x16x64_bf16 v[12:15], v[64:67], v[104:111], v68
    s_nop 0
    v_cvt_pk_bf16_f32 v112, v112, v113
    v_cvt_pk_bf16_f32 v113, v114, v115
    ds_write_b64 v70, v[112:113] offset:128
    v_mfma_f32_16x16x32_bf16 v[112:115], v[72:75], v[160:163], 0
    s_waitcnt vmcnt(2)
    v_lshlrev_b32_sdwa v104, 3, v120 dst_sel:DWORD dst_unused:UNUSED_PAD src0_sel:DWORD src1_sel:WORD_0
    v_lshlrev_b32_sdwa v106, 3, v120 dst_sel:DWORD dst_unused:UNUSED_PAD src0_sel:DWORD src1_sel:WORD_1
    ds_read_b64 v[104:105], v104
    ds_read_b64 v[106:107], v106
    v_mfma_f32_16x16x32_bf16 v[112:115], v[76:79], v[164:167], v[112:115]
    v_lshlrev_b32_sdwa v108, 3, v121 dst_sel:DWORD dst_unused:UNUSED_PAD src0_sel:DWORD src1_sel:WORD_0
    v_lshlrev_b32_sdwa v110, 3, v121 dst_sel:DWORD dst_unused:UNUSED_PAD src0_sel:DWORD src1_sel:WORD_1
    ds_read_b64 v[108:109], v108
    ds_read_b64 v[110:111], v110
    s_waitcnt lgkmcnt(10)
    v_smfmac_f32_16x16x64_bf16 v[16:19], v[64:67], v[88:95], v68
    v_mfma_f32_16x16x32_bf16 v[112:115], v[80:83], v[168:171], v[112:115]
    v_lshlrev_b32_sdwa v88, 3, v122 dst_sel:DWORD dst_unused:UNUSED_PAD src0_sel:DWORD src1_sel:WORD_0
    v_lshlrev_b32_sdwa v90, 3, v122 dst_sel:DWORD dst_unused:UNUSED_PAD src0_sel:DWORD src1_sel:WORD_1
    ds_read_b64 v[88:89], v88
    ds_read_b64 v[90:91], v90
    v_mfma_f32_16x16x32_bf16 v[112:115], v[84:87], v[172:175], v[112:115]
    v_lshlrev_b32_sdwa v92, 3, v123 dst_sel:DWORD dst_unused:UNUSED_PAD src0_sel:DWORD src1_sel:WORD_0
    v_lshlrev_b32_sdwa v94, 3, v123 dst_sel:DWORD dst_unused:UNUSED_PAD src0_sel:DWORD src1_sel:WORD_1
    ds_read_b64 v[92:93], v92
    ds_read_b64 v[94:95], v94
    buffer_load_dwordx4 v[120:123], v69, s[12:15], s20 offen offset:2048 sc1
    s_waitcnt lgkmcnt(9)
    v_smfmac_f32_16x16x64_bf16 v[20:23], v[64:67], v[96:103], v68
    s_nop 0
    v_cvt_pk_bf16_f32 v112, v112, v113
    v_cvt_pk_bf16_f32 v113, v114, v115
    ds_write_b64 v70, v[112:113] offset:256
    v_mfma_f32_16x16x32_bf16 v[112:115], v[72:75], v[176:179], 0
    v_mfma_f32_16x16x32_bf16 v[112:115], v[76:79], v[180:183], v[112:115]
    s_waitcnt vmcnt(2)
    v_lshlrev_b32_sdwa v96, 3, v124 dst_sel:DWORD dst_unused:UNUSED_PAD src0_sel:DWORD src1_sel:WORD_0
    v_lshlrev_b32_sdwa v98, 3, v124 dst_sel:DWORD dst_unused:UNUSED_PAD src0_sel:DWORD src1_sel:WORD_1
    ds_read_b64 v[96:97], v96
    ds_read_b64 v[98:99], v98
    v_mfma_f32_16x16x32_bf16 v[112:115], v[80:83], v[184:187], v[112:115]
    v_mfma_f32_16x16x32_bf16 v[112:115], v[84:87], v[188:191], v[112:115]
    v_lshlrev_b32_sdwa v100, 3, v125 dst_sel:DWORD dst_unused:UNUSED_PAD src0_sel:DWORD src1_sel:WORD_0
    v_lshlrev_b32_sdwa v102, 3, v125 dst_sel:DWORD dst_unused:UNUSED_PAD src0_sel:DWORD src1_sel:WORD_1
    ds_read_b64 v[100:101], v100
    ds_read_b64 v[102:103], v102
    s_waitcnt lgkmcnt(9)
    v_smfmac_f32_16x16x64_bf16 v[24:27], v[64:67], v[104:111], v68
    s_nop 1
    v_cvt_pk_bf16_f32 v112, v112, v113
    v_cvt_pk_bf16_f32 v113, v114, v115
    ds_write_b64 v70, v[112:113] offset:384
    v_mfma_f32_16x16x32_bf16 v[112:115], v[72:75], v[192:195], 0
    v_lshlrev_b32_sdwa v104, 3, v126 dst_sel:DWORD dst_unused:UNUSED_PAD src0_sel:DWORD src1_sel:WORD_0
    v_lshlrev_b32_sdwa v106, 3, v126 dst_sel:DWORD dst_unused:UNUSED_PAD src0_sel:DWORD src1_sel:WORD_1
    ds_read_b64 v[104:105], v104
    ds_read_b64 v[106:107], v106
    v_mfma_f32_16x16x32_bf16 v[112:115], v[76:79], v[196:199], v[112:115]
    v_lshlrev_b32_sdwa v108, 3, v127 dst_sel:DWORD dst_unused:UNUSED_PAD src0_sel:DWORD src1_sel:WORD_0
    v_lshlrev_b32_sdwa v110, 3, v127 dst_sel:DWORD dst_unused:UNUSED_PAD src0_sel:DWORD src1_sel:WORD_1
    ds_read_b64 v[108:109], v108
    ds_read_b64 v[110:111], v110
    buffer_load_dwordx4 v[124:127], v69, s[12:15], s20 offen offset:3072 sc1
    s_add_u32 s20, s20, 61440
    s_waitcnt lgkmcnt(10)
    v_smfmac_f32_16x16x64_bf16 v[28:31], v[64:67], v[88:95], v68
    s_setprio 2
    v_mfma_f32_16x16x32_bf16 v[112:115], v[80:83], v[200:203], v[112:115]
    s_waitcnt vmcnt(2)
    v_lshlrev_b32_sdwa v88, 3, v116 dst_sel:DWORD dst_unused:UNUSED_PAD src0_sel:DWORD src1_sel:WORD_0
    v_lshlrev_b32_sdwa v90, 3, v116 dst_sel:DWORD dst_unused:UNUSED_PAD src0_sel:DWORD src1_sel:WORD_1
    ds_read_b64 v[88:89], v88
    ds_read_b64 v[90:91], v90
    v_mfma_f32_16x16x32_bf16 v[112:115], v[84:87], v[204:207], v[112:115]
    v_lshlrev_b32_sdwa v92, 3, v117 dst_sel:DWORD dst_unused:UNUSED_PAD src0_sel:DWORD src1_sel:WORD_0
    v_lshlrev_b32_sdwa v94, 3, v117 dst_sel:DWORD dst_unused:UNUSED_PAD src0_sel:DWORD src1_sel:WORD_1
    ds_read_b64 v[92:93], v92
    ds_read_b64 v[94:95], v94
    s_waitcnt lgkmcnt(9)
    v_smfmac_f32_16x16x64_bf16 v[32:35], v[64:67], v[96:103], v68
    s_nop 1
    v_cvt_pk_bf16_f32 v112, v112, v113
    v_cvt_pk_bf16_f32 v113, v114, v115
    ds_write_b64 v70, v[112:113] offset:512
    v_mfma_f32_16x16x32_bf16 v[112:115], v[72:75], v[208:211], 0
    v_lshlrev_b32_sdwa v96, 3, v118 dst_sel:DWORD dst_unused:UNUSED_PAD src0_sel:DWORD src1_sel:WORD_0
    v_lshlrev_b32_sdwa v98, 3, v118 dst_sel:DWORD dst_unused:UNUSED_PAD src0_sel:DWORD src1_sel:WORD_1
    ds_read_b64 v[96:97], v96
    ds_read_b64 v[98:99], v98
    v_mfma_f32_16x16x32_bf16 v[112:115], v[76:79], v[212:215], v[112:115]
    v_lshlrev_b32_sdwa v100, 3, v119 dst_sel:DWORD dst_unused:UNUSED_PAD src0_sel:DWORD src1_sel:WORD_0
    v_lshlrev_b32_sdwa v102, 3, v119 dst_sel:DWORD dst_unused:UNUSED_PAD src0_sel:DWORD src1_sel:WORD_1
    ds_read_b64 v[100:101], v100
    ds_read_b64 v[102:103], v102
    buffer_load_dwordx4 v[116:119], v69, s[12:15], s20 offen offset:0 sc1
    s_waitcnt lgkmcnt(9)
    v_smfmac_f32_16x16x64_bf16 v[36:39], v[64:67], v[104:111], v68
    v_mfma_f32_16x16x32_bf16 v[112:115], v[80:83], v[216:219], v[112:115]
    s_waitcnt vmcnt(2)
    v_lshlrev_b32_sdwa v104, 3, v120 dst_sel:DWORD dst_unused:UNUSED_PAD src0_sel:DWORD src1_sel:WORD_0
    v_lshlrev_b32_sdwa v106, 3, v120 dst_sel:DWORD dst_unused:UNUSED_PAD src0_sel:DWORD src1_sel:WORD_1
    ds_read_b64 v[104:105], v104
    ds_read_b64 v[106:107], v106
    v_mfma_f32_16x16x32_bf16 v[112:115], v[84:87], v[220:223], v[112:115]
    v_lshlrev_b32_sdwa v108, 3, v121 dst_sel:DWORD dst_unused:UNUSED_PAD src0_sel:DWORD src1_sel:WORD_0
    v_lshlrev_b32_sdwa v110, 3, v121 dst_sel:DWORD dst_unused:UNUSED_PAD src0_sel:DWORD src1_sel:WORD_1
    ds_read_b64 v[108:109], v108
    ds_read_b64 v[110:111], v110
    s_waitcnt lgkmcnt(9)
    v_smfmac_f32_16x16x64_bf16 v[40:43], v[64:67], v[88:95], v68
    s_nop 1
    v_cvt_pk_bf16_f32 v112, v112, v113
    v_cvt_pk_bf16_f32 v113, v114, v115
    ds_write_b64 v70, v[112:113] offset:640
    v_mfma_f32_16x16x32_bf16 v[112:115], v[72:75], v[224:227], 0
    v_mfma_f32_16x16x32_bf16 v[112:115], v[76:79], v[228:231], v[112:115]
    v_lshlrev_b32_sdwa v88, 3, v122 dst_sel:DWORD dst_unused:UNUSED_PAD src0_sel:DWORD src1_sel:WORD_0
    v_lshlrev_b32_sdwa v90, 3, v122 dst_sel:DWORD dst_unused:UNUSED_PAD src0_sel:DWORD src1_sel:WORD_1
    ds_read_b64 v[88:89], v88
    ds_read_b64 v[90:91], v90
    v_mfma_f32_16x16x32_bf16 v[112:115], v[80:83], v[232:235], v[112:115]
    v_mfma_f32_16x16x32_bf16 v[112:115], v[84:87], v[236:239], v[112:115]
    v_lshlrev_b32_sdwa v92, 3, v123 dst_sel:DWORD dst_unused:UNUSED_PAD src0_sel:DWORD src1_sel:WORD_0
    v_lshlrev_b32_sdwa v94, 3, v123 dst_sel:DWORD dst_unused:UNUSED_PAD src0_sel:DWORD src1_sel:WORD_1
    ds_read_b64 v[92:93], v92
    ds_read_b64 v[94:95], v94
    buffer_load_dwordx4 v[120:123], v69, s[12:15], s20 offen offset:1024 sc1
    s_waitcnt lgkmcnt(9)
    v_smfmac_f32_16x16x64_bf16 v[44:47], v[64:67], v[96:103], v68
    s_nop 0
    v_cvt_pk_bf16_f32 v112, v112, v113
    v_cvt_pk_bf16_f32 v113, v114, v115
    ds_write_b64 v70, v[112:113] offset:768
    s_setprio 1
    v_mfma_f32_16x16x32_bf16 v[112:115], v[72:75], v[240:243], 0
    buffer_load_dwordx4 v[72:75], v69, s[12:15], s21 offen offset:0
    s_waitcnt vmcnt(3)
    v_lshlrev_b32_sdwa v96, 3, v124 dst_sel:DWORD dst_unused:UNUSED_PAD src0_sel:DWORD src1_sel:WORD_0
    v_lshlrev_b32_sdwa v98, 3, v124 dst_sel:DWORD dst_unused:UNUSED_PAD src0_sel:DWORD src1_sel:WORD_1
    ds_read_b64 v[96:97], v96
    ds_read_b64 v[98:99], v98
    v_mfma_f32_16x16x32_bf16 v[112:115], v[76:79], v[244:247], v[112:115]
    buffer_load_dwordx4 v[76:79], v69, s[12:15], s21 offen offset:1024
    v_lshlrev_b32_sdwa v100, 3, v125 dst_sel:DWORD dst_unused:UNUSED_PAD src0_sel:DWORD src1_sel:WORD_0
    v_lshlrev_b32_sdwa v102, 3, v125 dst_sel:DWORD dst_unused:UNUSED_PAD src0_sel:DWORD src1_sel:WORD_1
    ds_read_b64 v[100:101], v100
    ds_read_b64 v[102:103], v102
    s_waitcnt lgkmcnt(10)
    v_smfmac_f32_16x16x64_bf16 v[48:51], v[64:67], v[104:111], v68
    v_mfma_f32_16x16x32_bf16 v[112:115], v[80:83], v[248:251], v[112:115]
    buffer_load_dwordx4 v[80:83], v69, s[12:15], s19 offen offset:0
    v_lshlrev_b32_sdwa v104, 3, v126 dst_sel:DWORD dst_unused:UNUSED_PAD src0_sel:DWORD src1_sel:WORD_0
    v_lshlrev_b32_sdwa v106, 3, v126 dst_sel:DWORD dst_unused:UNUSED_PAD src0_sel:DWORD src1_sel:WORD_1
    ds_read_b64 v[104:105], v104
    ds_read_b64 v[106:107], v106
    v_mfma_f32_16x16x32_bf16 v[112:115], v[84:87], v[252:255], v[112:115]
    buffer_load_dwordx4 v[84:87], v69, s[12:15], s19 offen offset:1024
    s_add_u32 s21, s21, 4096
    s_add_u32 s19, s19, 4096
    v_lshlrev_b32_sdwa v108, 3, v127 dst_sel:DWORD dst_unused:UNUSED_PAD src0_sel:DWORD src1_sel:WORD_0
    v_lshlrev_b32_sdwa v110, 3, v127 dst_sel:DWORD dst_unused:UNUSED_PAD src0_sel:DWORD src1_sel:WORD_1
    ds_read_b64 v[108:109], v108
    ds_read_b64 v[110:111], v110
    buffer_load_dwordx4 v[124:127], v69, s[12:15], s20 offen offset:2048 sc1
    s_waitcnt lgkmcnt(9)
    v_smfmac_f32_16x16x64_bf16 v[52:55], v[64:67], v[88:95], v68
    v_cvt_pk_bf16_f32 v112, v112, v113
    v_cvt_pk_bf16_f32 v113, v114, v115
    ds_write_b64 v70, v[112:113] offset:896
    s_add_u32 s23, s23, 1
    s_cmp_eq_u32 s23, 5
    s_cselect_b32 s35, 4294836224, s32
    s_cselect_b32 s23, 0, s23
    v_add_u32 v70, s35, v70
    s_waitcnt vmcnt(6)
    v_lshlrev_b32_sdwa v88, 3, v116 dst_sel:DWORD dst_unused:UNUSED_PAD src0_sel:DWORD src1_sel:WORD_0
    v_lshlrev_b32_sdwa v90, 3, v116 dst_sel:DWORD dst_unused:UNUSED_PAD src0_sel:DWORD src1_sel:WORD_1
    ds_read_b64 v[88:89], v88
    ds_read_b64 v[90:91], v90
    v_lshlrev_b32_sdwa v92, 3, v117 dst_sel:DWORD dst_unused:UNUSED_PAD src0_sel:DWORD src1_sel:WORD_0
    v_lshlrev_b32_sdwa v94, 3, v117 dst_sel:DWORD dst_unused:UNUSED_PAD src0_sel:DWORD src1_sel:WORD_1
    ds_read_b64 v[92:93], v92
    ds_read_b64 v[94:95], v94
    s_waitcnt lgkmcnt(9)
    v_smfmac_f32_16x16x64_bf16 v[56:59], v[64:67], v[96:103], v68
    s_setprio 0
    v_lshlrev_b32_sdwa v96, 3, v118 dst_sel:DWORD dst_unused:UNUSED_PAD src0_sel:DWORD src1_sel:WORD_0
    v_lshlrev_b32_sdwa v98, 3, v118 dst_sel:DWORD dst_unused:UNUSED_PAD src0_sel:DWORD src1_sel:WORD_1
    ds_read_b64 v[96:97], v96
    ds_read_b64 v[98:99], v98
    v_lshlrev_b32_sdwa v100, 3, v119 dst_sel:DWORD dst_unused:UNUSED_PAD src0_sel:DWORD src1_sel:WORD_0
    v_lshlrev_b32_sdwa v102, 3, v119 dst_sel:DWORD dst_unused:UNUSED_PAD src0_sel:DWORD src1_sel:WORD_1
    ds_read_b64 v[100:101], v100
    ds_read_b64 v[102:103], v102
    buffer_load_dwordx4 v[116:119], v69, s[12:15], s20 offen offset:3072 sc1
    s_add_u32 s20, s20, 4096
    s_waitcnt lgkmcnt(9)
    v_smfmac_f32_16x16x64_bf16 v[60:63], v[64:67], v[104:111], v68
    s_waitcnt lgkmcnt(8)
    s_barrier

    s_add_u32 s22, s22, 1
    s_branch standalone__deep_cross_pnn__recsys_kernel_gloop

standalone__deep_cross_pnn__recsys_kernel_fin:

    s_add_u32 s40, s20, 61440
    s_add_u32 s41, s20, 65536
    s_add_u32 s44, s20, 126976
    s_add_u32 s45, s20, 131072

    s_lshl_b32 s35, s33, 16
    s_lshl_b32 s42, s34, 15
    s_add_u32 s35, s35, s42
    s_lshl_b32 s42, s3, 12
    s_add_u32 s35, s35, s42
    s_add_u32 s35, s35, 20971520

    s_setprio 3
    v_mov_b32 v128, 0xbdd2d3e8
    v_mov_b32 v129, 0xbdd2d3e8
    v_mov_b32 v130, 0xc0135761
    v_mov_b32 v131, 0xc0135761
    v_mov_b32 v132, 1.0
    v_mov_b32 v133, 1.0
    v_mov_b32 v134, s28
    v_mov_b32 v135, s29
    s_waitcnt vmcnt(6)
    v_lshlrev_b32_sdwa v88, 3, v116 dst_sel:DWORD dst_unused:UNUSED_PAD src0_sel:DWORD src1_sel:WORD_0
    v_lshlrev_b32_sdwa v90, 3, v116 dst_sel:DWORD dst_unused:UNUSED_PAD src0_sel:DWORD src1_sel:WORD_1
    ds_read_b64 v[88:89], v88
    ds_read_b64 v[90:91], v90
    v_lshlrev_b32_sdwa v92, 3, v117 dst_sel:DWORD dst_unused:UNUSED_PAD src0_sel:DWORD src1_sel:WORD_0
    v_lshlrev_b32_sdwa v94, 3, v117 dst_sel:DWORD dst_unused:UNUSED_PAD src0_sel:DWORD src1_sel:WORD_1
    ds_read_b64 v[92:93], v92
    ds_read_b64 v[94:95], v94
    s_waitcnt lgkmcnt(8)
    v_smfmac_f32_16x16x64_bf16 v[0:3], v[64:67], v[96:103], v68
    v_mov_b32 v136, s30
    v_mov_b32 v137, s31
    v_lshrrev_b32 v70, 2, v69
    v_and_b32 v138, 128, v70
    v_add_u32 v70, v70, v138
    v_rcp_f32 v134, v134
    v_rcp_f32 v135, v135
    v_rcp_f32 v136, v136
    v_lshlrev_b32_sdwa v96, 3, v118 dst_sel:DWORD dst_unused:UNUSED_PAD src0_sel:DWORD src1_sel:WORD_0
    v_lshlrev_b32_sdwa v98, 3, v118 dst_sel:DWORD dst_unused:UNUSED_PAD src0_sel:DWORD src1_sel:WORD_1
    ds_read_b64 v[96:97], v96
    ds_read_b64 v[98:99], v98
    v_lshlrev_b32_sdwa v100, 3, v119 dst_sel:DWORD dst_unused:UNUSED_PAD src0_sel:DWORD src1_sel:WORD_0
    v_lshlrev_b32_sdwa v102, 3, v119 dst_sel:DWORD dst_unused:UNUSED_PAD src0_sel:DWORD src1_sel:WORD_1
    ds_read_b64 v[100:101], v100
    ds_read_b64 v[102:103], v102
    buffer_load_dwordx4 v[116:119], v69, s[12:15], s40 offen offset:0 sc1
    s_waitcnt lgkmcnt(8)
    v_smfmac_f32_16x16x64_bf16 v[4:7], v[64:67], v[104:111], v68
    v_rcp_f32 v137, v137
    v_mov_b32 v132, 0x7f7fffff
    v_mov_b32 v133, 0xff7fffff
    v_med3_f32 v134, v134, v132, v133
    v_med3_f32 v135, v135, v132, v133
    v_med3_f32 v136, v136, v132, v133
    v_med3_f32 v137, v137, v132, v133
    s_waitcnt vmcnt(2)
    v_lshlrev_b32_sdwa v104, 3, v120 dst_sel:DWORD dst_unused:UNUSED_PAD src0_sel:DWORD src1_sel:WORD_0
    v_lshlrev_b32_sdwa v106, 3, v120 dst_sel:DWORD dst_unused:UNUSED_PAD src0_sel:DWORD src1_sel:WORD_1
    ds_read_b64 v[104:105], v104
    ds_read_b64 v[106:107], v106
    v_lshlrev_b32_sdwa v108, 3, v121 dst_sel:DWORD dst_unused:UNUSED_PAD src0_sel:DWORD src1_sel:WORD_0
    v_lshlrev_b32_sdwa v110, 3, v121 dst_sel:DWORD dst_unused:UNUSED_PAD src0_sel:DWORD src1_sel:WORD_1
    ds_read_b64 v[108:109], v108
    ds_read_b64 v[110:111], v110
    s_waitcnt lgkmcnt(8)
    v_smfmac_f32_16x16x64_bf16 v[8:11], v[64:67], v[88:95], v68
    v_lshlrev_b32_sdwa v88, 3, v122 dst_sel:DWORD dst_unused:UNUSED_PAD src0_sel:DWORD src1_sel:WORD_0
    v_lshlrev_b32_sdwa v90, 3, v122 dst_sel:DWORD dst_unused:UNUSED_PAD src0_sel:DWORD src1_sel:WORD_1
    ds_read_b64 v[88:89], v88
    ds_read_b64 v[90:91], v90
    v_lshlrev_b32_sdwa v92, 3, v123 dst_sel:DWORD dst_unused:UNUSED_PAD src0_sel:DWORD src1_sel:WORD_0
    v_lshlrev_b32_sdwa v94, 3, v123 dst_sel:DWORD dst_unused:UNUSED_PAD src0_sel:DWORD src1_sel:WORD_1
    ds_read_b64 v[92:93], v92
    ds_read_b64 v[94:95], v94
    buffer_load_dwordx4 v[120:123], v69, s[12:15], s44 offen offset:0 sc1
    s_waitcnt lgkmcnt(8)
    v_smfmac_f32_16x16x64_bf16 v[12:15], v[64:67], v[96:103], v68
    s_waitcnt vmcnt(2)
    v_lshlrev_b32_sdwa v96, 3, v124 dst_sel:DWORD dst_unused:UNUSED_PAD src0_sel:DWORD src1_sel:WORD_0
    v_lshlrev_b32_sdwa v98, 3, v124 dst_sel:DWORD dst_unused:UNUSED_PAD src0_sel:DWORD src1_sel:WORD_1
    ds_read_b64 v[96:97], v96
    ds_read_b64 v[98:99], v98
    v_lshlrev_b32_sdwa v100, 3, v125 dst_sel:DWORD dst_unused:UNUSED_PAD src0_sel:DWORD src1_sel:WORD_0
    v_lshlrev_b32_sdwa v102, 3, v125 dst_sel:DWORD dst_unused:UNUSED_PAD src0_sel:DWORD src1_sel:WORD_1
    ds_read_b64 v[100:101], v100
    ds_read_b64 v[102:103], v102
    s_waitcnt lgkmcnt(8)
    v_smfmac_f32_16x16x64_bf16 v[16:19], v[64:67], v[104:111], v68
    v_lshlrev_b32_sdwa v104, 3, v126 dst_sel:DWORD dst_unused:UNUSED_PAD src0_sel:DWORD src1_sel:WORD_0
    v_lshlrev_b32_sdwa v106, 3, v126 dst_sel:DWORD dst_unused:UNUSED_PAD src0_sel:DWORD src1_sel:WORD_1
    ds_read_b64 v[104:105], v104
    ds_read_b64 v[106:107], v106
    v_lshlrev_b32_sdwa v108, 3, v127 dst_sel:DWORD dst_unused:UNUSED_PAD src0_sel:DWORD src1_sel:WORD_0
    v_lshlrev_b32_sdwa v110, 3, v127 dst_sel:DWORD dst_unused:UNUSED_PAD src0_sel:DWORD src1_sel:WORD_1
    ds_read_b64 v[108:109], v108
    ds_read_b64 v[110:111], v110
    buffer_load_dwordx4 v[124:127], v69, s[12:15], s40 offen offset:1024 sc1
    s_waitcnt lgkmcnt(8)
    v_smfmac_f32_16x16x64_bf16 v[20:23], v[64:67], v[88:95], v68
    s_waitcnt vmcnt(2)
    v_lshlrev_b32_sdwa v88, 3, v116 dst_sel:DWORD dst_unused:UNUSED_PAD src0_sel:DWORD src1_sel:WORD_0
    v_lshlrev_b32_sdwa v90, 3, v116 dst_sel:DWORD dst_unused:UNUSED_PAD src0_sel:DWORD src1_sel:WORD_1
    ds_read_b64 v[88:89], v88
    ds_read_b64 v[90:91], v90
    v_lshlrev_b32_sdwa v92, 3, v117 dst_sel:DWORD dst_unused:UNUSED_PAD src0_sel:DWORD src1_sel:WORD_0
    v_lshlrev_b32_sdwa v94, 3, v117 dst_sel:DWORD dst_unused:UNUSED_PAD src0_sel:DWORD src1_sel:WORD_1
    ds_read_b64 v[92:93], v92
    ds_read_b64 v[94:95], v94
    s_waitcnt lgkmcnt(8)
    v_smfmac_f32_16x16x64_bf16 v[24:27], v[64:67], v[96:103], v68
    v_lshlrev_b32_sdwa v96, 3, v118 dst_sel:DWORD dst_unused:UNUSED_PAD src0_sel:DWORD src1_sel:WORD_0
    v_lshlrev_b32_sdwa v98, 3, v118 dst_sel:DWORD dst_unused:UNUSED_PAD src0_sel:DWORD src1_sel:WORD_1
    ds_read_b64 v[96:97], v96
    ds_read_b64 v[98:99], v98
    v_lshlrev_b32_sdwa v100, 3, v119 dst_sel:DWORD dst_unused:UNUSED_PAD src0_sel:DWORD src1_sel:WORD_0
    v_lshlrev_b32_sdwa v102, 3, v119 dst_sel:DWORD dst_unused:UNUSED_PAD src0_sel:DWORD src1_sel:WORD_1
    ds_read_b64 v[100:101], v100
    ds_read_b64 v[102:103], v102
    buffer_load_dwordx4 v[116:119], v69, s[12:15], s44 offen offset:1024 sc1
    s_waitcnt lgkmcnt(8)
    v_smfmac_f32_16x16x64_bf16 v[28:31], v[64:67], v[104:111], v68
    s_waitcnt vmcnt(2)
    v_lshlrev_b32_sdwa v104, 3, v120 dst_sel:DWORD dst_unused:UNUSED_PAD src0_sel:DWORD src1_sel:WORD_0
    v_lshlrev_b32_sdwa v106, 3, v120 dst_sel:DWORD dst_unused:UNUSED_PAD src0_sel:DWORD src1_sel:WORD_1
    ds_read_b64 v[104:105], v104
    ds_read_b64 v[106:107], v106
    v_lshlrev_b32_sdwa v108, 3, v121 dst_sel:DWORD dst_unused:UNUSED_PAD src0_sel:DWORD src1_sel:WORD_0
    v_lshlrev_b32_sdwa v110, 3, v121 dst_sel:DWORD dst_unused:UNUSED_PAD src0_sel:DWORD src1_sel:WORD_1
    ds_read_b64 v[108:109], v108
    ds_read_b64 v[110:111], v110
    s_waitcnt lgkmcnt(8)
    v_smfmac_f32_16x16x64_bf16 v[0:3], v[64:67], v[88:95], v68
    v_lshlrev_b32_sdwa v88, 3, v122 dst_sel:DWORD dst_unused:UNUSED_PAD src0_sel:DWORD src1_sel:WORD_0
    v_lshlrev_b32_sdwa v90, 3, v122 dst_sel:DWORD dst_unused:UNUSED_PAD src0_sel:DWORD src1_sel:WORD_1
    ds_read_b64 v[88:89], v88
    ds_read_b64 v[90:91], v90
    v_lshlrev_b32_sdwa v92, 3, v123 dst_sel:DWORD dst_unused:UNUSED_PAD src0_sel:DWORD src1_sel:WORD_0
    v_lshlrev_b32_sdwa v94, 3, v123 dst_sel:DWORD dst_unused:UNUSED_PAD src0_sel:DWORD src1_sel:WORD_1
    ds_read_b64 v[92:93], v92
    ds_read_b64 v[94:95], v94
    buffer_load_dwordx4 v[120:123], v69, s[12:15], s40 offen offset:2048 sc1
    s_waitcnt lgkmcnt(8)
    v_smfmac_f32_16x16x64_bf16 v[4:7], v[64:67], v[96:103], v68
    s_waitcnt vmcnt(2)
    v_lshlrev_b32_sdwa v96, 3, v124 dst_sel:DWORD dst_unused:UNUSED_PAD src0_sel:DWORD src1_sel:WORD_0
    v_lshlrev_b32_sdwa v98, 3, v124 dst_sel:DWORD dst_unused:UNUSED_PAD src0_sel:DWORD src1_sel:WORD_1
    ds_read_b64 v[96:97], v96
    ds_read_b64 v[98:99], v98
    v_lshlrev_b32_sdwa v100, 3, v125 dst_sel:DWORD dst_unused:UNUSED_PAD src0_sel:DWORD src1_sel:WORD_0
    v_lshlrev_b32_sdwa v102, 3, v125 dst_sel:DWORD dst_unused:UNUSED_PAD src0_sel:DWORD src1_sel:WORD_1
    ds_read_b64 v[100:101], v100
    ds_read_b64 v[102:103], v102
    s_waitcnt lgkmcnt(8)
    v_smfmac_f32_16x16x64_bf16 v[0:3], v[64:67], v[104:111], v68
    v_lshlrev_b32_sdwa v104, 3, v126 dst_sel:DWORD dst_unused:UNUSED_PAD src0_sel:DWORD src1_sel:WORD_0
    v_lshlrev_b32_sdwa v106, 3, v126 dst_sel:DWORD dst_unused:UNUSED_PAD src0_sel:DWORD src1_sel:WORD_1
    ds_read_b64 v[104:105], v104
    ds_read_b64 v[106:107], v106
    v_lshlrev_b32_sdwa v108, 3, v127 dst_sel:DWORD dst_unused:UNUSED_PAD src0_sel:DWORD src1_sel:WORD_0
    v_lshlrev_b32_sdwa v110, 3, v127 dst_sel:DWORD dst_unused:UNUSED_PAD src0_sel:DWORD src1_sel:WORD_1
    ds_read_b64 v[108:109], v108
    ds_read_b64 v[110:111], v110
    buffer_load_dwordx4 v[124:127], v69, s[12:15], s44 offen offset:2048 sc1
    s_waitcnt lgkmcnt(8)
    v_smfmac_f32_16x16x64_bf16 v[4:7], v[64:67], v[88:95], v68
    s_waitcnt vmcnt(2)
    v_lshlrev_b32_sdwa v88, 3, v116 dst_sel:DWORD dst_unused:UNUSED_PAD src0_sel:DWORD src1_sel:WORD_0
    v_lshlrev_b32_sdwa v90, 3, v116 dst_sel:DWORD dst_unused:UNUSED_PAD src0_sel:DWORD src1_sel:WORD_1
    ds_read_b64 v[88:89], v88
    ds_read_b64 v[90:91], v90
    v_lshlrev_b32_sdwa v92, 3, v117 dst_sel:DWORD dst_unused:UNUSED_PAD src0_sel:DWORD src1_sel:WORD_0
    v_lshlrev_b32_sdwa v94, 3, v117 dst_sel:DWORD dst_unused:UNUSED_PAD src0_sel:DWORD src1_sel:WORD_1
    ds_read_b64 v[92:93], v92
    ds_read_b64 v[94:95], v94
    s_waitcnt lgkmcnt(8)
    v_smfmac_f32_16x16x64_bf16 v[8:11], v[64:67], v[96:103], v68
    v_pk_mul_f32 v[140:141], v[0:1], v[0:1]
    v_pk_mul_f32 v[142:143], v[2:3], v[2:3]
    v_pk_fma_f32 v[140:141], v[140:141], v[128:129], v[130:131]
    v_pk_fma_f32 v[142:143], v[142:143], v[128:129], v[130:131]
    v_pk_mul_f32 v[140:141], v[140:141], v[0:1]
    v_pk_mul_f32 v[142:143], v[142:143], v[2:3]
    v_exp_f32 v140, v140
    v_pk_mul_f32 v[146:147], v[4:5], v[4:5]
    v_lshlrev_b32_sdwa v96, 3, v118 dst_sel:DWORD dst_unused:UNUSED_PAD src0_sel:DWORD src1_sel:WORD_0
    v_lshlrev_b32_sdwa v98, 3, v118 dst_sel:DWORD dst_unused:UNUSED_PAD src0_sel:DWORD src1_sel:WORD_1
    ds_read_b64 v[96:97], v96
    ds_read_b64 v[98:99], v98
    v_lshlrev_b32_sdwa v100, 3, v119 dst_sel:DWORD dst_unused:UNUSED_PAD src0_sel:DWORD src1_sel:WORD_0
    v_lshlrev_b32_sdwa v102, 3, v119 dst_sel:DWORD dst_unused:UNUSED_PAD src0_sel:DWORD src1_sel:WORD_1
    ds_read_b64 v[100:101], v100
    ds_read_b64 v[102:103], v102
    buffer_load_dwordx4 v[116:119], v69, s[12:15], s40 offen offset:3072 sc1
    s_waitcnt lgkmcnt(8)
    v_smfmac_f32_16x16x64_bf16 v[12:15], v[64:67], v[104:111], v68
    v_exp_f32 v141, v141
    v_pk_fma_f32 v[146:147], v[146:147], v[128:129], v[130:131]
    v_pk_mul_f32 v[148:149], v[6:7], v[6:7]
    v_exp_f32 v142, v142
    v_pk_fma_f32 v[140:141], v[140:141], v[134:135], v[134:135]
    v_pk_mul_f32 v[146:147], v[146:147], v[4:5]
    v_rcp_f32 v140, v140
    v_pk_fma_f32 v[148:149], v[148:149], v[128:129], v[130:131]
    s_waitcnt vmcnt(2)
    v_lshlrev_b32_sdwa v104, 3, v120 dst_sel:DWORD dst_unused:UNUSED_PAD src0_sel:DWORD src1_sel:WORD_0
    v_lshlrev_b32_sdwa v106, 3, v120 dst_sel:DWORD dst_unused:UNUSED_PAD src0_sel:DWORD src1_sel:WORD_1
    ds_read_b64 v[104:105], v104
    ds_read_b64 v[106:107], v106
    v_lshlrev_b32_sdwa v108, 3, v121 dst_sel:DWORD dst_unused:UNUSED_PAD src0_sel:DWORD src1_sel:WORD_0
    v_lshlrev_b32_sdwa v110, 3, v121 dst_sel:DWORD dst_unused:UNUSED_PAD src0_sel:DWORD src1_sel:WORD_1
    ds_read_b64 v[108:109], v108
    ds_read_b64 v[110:111], v110
    s_waitcnt lgkmcnt(8)
    v_smfmac_f32_16x16x64_bf16 v[8:11], v[64:67], v[88:95], v68
    v_rcp_f32 v141, v141
    v_pk_mul_f32 v[148:149], v[148:149], v[6:7]
    v_exp_f32 v143, v143
    v_pk_mul_f32 v[144:145], v[0:1], v[140:141]
    v_exp_f32 v146, v146
    v_pk_fma_f32 v[142:143], v[142:143], v[136:137], v[136:137]
    v_exp_f32 v147, v147
    v_rcp_f32 v142, v142
    v_lshlrev_b32_sdwa v88, 3, v122 dst_sel:DWORD dst_unused:UNUSED_PAD src0_sel:DWORD src1_sel:WORD_0
    v_lshlrev_b32_sdwa v90, 3, v122 dst_sel:DWORD dst_unused:UNUSED_PAD src0_sel:DWORD src1_sel:WORD_1
    ds_read_b64 v[88:89], v88
    ds_read_b64 v[90:91], v90
    v_lshlrev_b32_sdwa v92, 3, v123 dst_sel:DWORD dst_unused:UNUSED_PAD src0_sel:DWORD src1_sel:WORD_0
    v_lshlrev_b32_sdwa v94, 3, v123 dst_sel:DWORD dst_unused:UNUSED_PAD src0_sel:DWORD src1_sel:WORD_1
    ds_read_b64 v[92:93], v92
    ds_read_b64 v[94:95], v94
    buffer_load_dwordx4 v[120:123], v69, s[12:15], s44 offen offset:3072 sc1
    s_waitcnt lgkmcnt(8)
    v_smfmac_f32_16x16x64_bf16 v[12:15], v[64:67], v[96:103], v68
    v_rcp_f32 v143, v143
    v_pk_fma_f32 v[146:147], v[146:147], v[134:135], v[134:135]
    v_pk_mul_f32 v[152:153], v[8:9], v[8:9]
    v_rcp_f32 v146, v146
    v_pk_fma_f32 v[144:145], v[2:3], v[142:143], v[144:145]
    v_pk_fma_f32 v[152:153], v[152:153], v[128:129], v[130:131]
    v_rcp_f32 v147, v147
    v_add_f32 v144, v144, v145
    s_waitcnt vmcnt(2)
    v_lshlrev_b32_sdwa v96, 3, v124 dst_sel:DWORD dst_unused:UNUSED_PAD src0_sel:DWORD src1_sel:WORD_0
    v_lshlrev_b32_sdwa v98, 3, v124 dst_sel:DWORD dst_unused:UNUSED_PAD src0_sel:DWORD src1_sel:WORD_1
    ds_read_b64 v[96:97], v96
    ds_read_b64 v[98:99], v98
    v_lshlrev_b32_sdwa v100, 3, v125 dst_sel:DWORD dst_unused:UNUSED_PAD src0_sel:DWORD src1_sel:WORD_0
    v_lshlrev_b32_sdwa v102, 3, v125 dst_sel:DWORD dst_unused:UNUSED_PAD src0_sel:DWORD src1_sel:WORD_1
    ds_read_b64 v[100:101], v100
    ds_read_b64 v[102:103], v102
    s_waitcnt lgkmcnt(8)
    v_smfmac_f32_16x16x64_bf16 v[16:19], v[64:67], v[104:111], v68
    v_exp_f32 v148, v148
    buffer_store_dword v144, v70, s[12:15], s35 offen offset:0 sc1
    v_pk_mul_f32 v[150:151], v[4:5], v[146:147]
    v_exp_f32 v149, v149
    v_pk_mul_f32 v[152:153], v[152:153], v[8:9]
    v_pk_mul_f32 v[154:155], v[10:11], v[10:11]
    v_exp_f32 v152, v152
    v_pk_fma_f32 v[148:149], v[148:149], v[136:137], v[136:137]
    v_lshlrev_b32_sdwa v104, 3, v126 dst_sel:DWORD dst_unused:UNUSED_PAD src0_sel:DWORD src1_sel:WORD_0
    v_lshlrev_b32_sdwa v106, 3, v126 dst_sel:DWORD dst_unused:UNUSED_PAD src0_sel:DWORD src1_sel:WORD_1
    ds_read_b64 v[104:105], v104
    ds_read_b64 v[106:107], v106
    v_lshlrev_b32_sdwa v108, 3, v127 dst_sel:DWORD dst_unused:UNUSED_PAD src0_sel:DWORD src1_sel:WORD_0
    v_lshlrev_b32_sdwa v110, 3, v127 dst_sel:DWORD dst_unused:UNUSED_PAD src0_sel:DWORD src1_sel:WORD_1
    ds_read_b64 v[108:109], v108
    ds_read_b64 v[110:111], v110
    buffer_load_dwordx4 v[124:127], v69, s[12:15], s20 offen offset:0 sc1
    s_waitcnt lgkmcnt(8)
    v_smfmac_f32_16x16x64_bf16 v[20:23], v[64:67], v[88:95], v68
    v_rcp_f32 v148, v148
    v_pk_fma_f32 v[154:155], v[154:155], v[128:129], v[130:131]
    v_pk_mul_f32 v[158:159], v[12:13], v[12:13]
    v_rcp_f32 v149, v149
    v_pk_mul_f32 v[154:155], v[154:155], v[10:11]
    v_pk_fma_f32 v[158:159], v[158:159], v[128:129], v[130:131]
    v_exp_f32 v153, v153
    v_pk_fma_f32 v[150:151], v[6:7], v[148:149], v[150:151]
    s_waitcnt vmcnt(3)
    v_lshlrev_b32_sdwa v88, 3, v116 dst_sel:DWORD dst_unused:UNUSED_PAD src0_sel:DWORD src1_sel:WORD_0
    v_lshlrev_b32_sdwa v90, 3, v116 dst_sel:DWORD dst_unused:UNUSED_PAD src0_sel:DWORD src1_sel:WORD_1
    ds_read_b64 v[88:89], v88
    ds_read_b64 v[90:91], v90
    v_lshlrev_b32_sdwa v92, 3, v117 dst_sel:DWORD dst_unused:UNUSED_PAD src0_sel:DWORD src1_sel:WORD_0
    v_lshlrev_b32_sdwa v94, 3, v117 dst_sel:DWORD dst_unused:UNUSED_PAD src0_sel:DWORD src1_sel:WORD_1
    ds_read_b64 v[92:93], v92
    ds_read_b64 v[94:95], v94
    s_waitcnt lgkmcnt(8)
    v_smfmac_f32_16x16x64_bf16 v[16:19], v[64:67], v[96:103], v68
    v_exp_f32 v154, v154
    v_add_f32 v150, v150, v151
    v_pk_fma_f32 v[152:153], v[152:153], v[134:135], v[134:135]
    v_exp_f32 v155, v155
    buffer_store_dword v150, v70, s[12:15], s35 offen offset:128 sc1
    v_pk_mul_f32 v[158:159], v[158:159], v[12:13]
    v_rcp_f32 v152, v152
    v_pk_fma_f32 v[154:155], v[154:155], v[136:137], v[136:137]
    v_lshlrev_b32_sdwa v96, 3, v118 dst_sel:DWORD dst_unused:UNUSED_PAD src0_sel:DWORD src1_sel:WORD_0
    v_lshlrev_b32_sdwa v98, 3, v118 dst_sel:DWORD dst_unused:UNUSED_PAD src0_sel:DWORD src1_sel:WORD_1
    ds_read_b64 v[96:97], v96
    ds_read_b64 v[98:99], v98
    v_lshlrev_b32_sdwa v100, 3, v119 dst_sel:DWORD dst_unused:UNUSED_PAD src0_sel:DWORD src1_sel:WORD_0
    v_lshlrev_b32_sdwa v102, 3, v119 dst_sel:DWORD dst_unused:UNUSED_PAD src0_sel:DWORD src1_sel:WORD_1
    ds_read_b64 v[100:101], v100
    ds_read_b64 v[102:103], v102
    buffer_load_dwordx4 v[116:119], v69, s[12:15], s41 offen offset:0 sc1
    s_waitcnt lgkmcnt(8)
    v_smfmac_f32_16x16x64_bf16 v[20:23], v[64:67], v[104:111], v68
    v_rcp_f32 v153, v153
    v_pk_mul_f32 v[160:161], v[14:15], v[14:15]
    v_pk_mul_f32 v[164:165], v[16:17], v[16:17]
    v_rcp_f32 v154, v154
    v_pk_mul_f32 v[156:157], v[8:9], v[152:153]
    v_pk_fma_f32 v[160:161], v[160:161], v[128:129], v[130:131]
    v_rcp_f32 v155, v155
    v_pk_mul_f32 v[160:161], v[160:161], v[14:15]
    s_waitcnt vmcnt(4)
    v_lshlrev_b32_sdwa v104, 3, v120 dst_sel:DWORD dst_unused:UNUSED_PAD src0_sel:DWORD src1_sel:WORD_0
    v_lshlrev_b32_sdwa v106, 3, v120 dst_sel:DWORD dst_unused:UNUSED_PAD src0_sel:DWORD src1_sel:WORD_1
    ds_read_b64 v[104:105], v104
    ds_read_b64 v[106:107], v106
    v_lshlrev_b32_sdwa v108, 3, v121 dst_sel:DWORD dst_unused:UNUSED_PAD src0_sel:DWORD src1_sel:WORD_0
    v_lshlrev_b32_sdwa v110, 3, v121 dst_sel:DWORD dst_unused:UNUSED_PAD src0_sel:DWORD src1_sel:WORD_1
    ds_read_b64 v[108:109], v108
    ds_read_b64 v[110:111], v110
    s_waitcnt lgkmcnt(8)
    v_smfmac_f32_16x16x64_bf16 v[24:27], v[64:67], v[88:95], v68
    v_exp_f32 v158, v158
    v_pk_fma_f32 v[156:157], v[10:11], v[154:155], v[156:157]
    v_pk_fma_f32 v[164:165], v[164:165], v[128:129], v[130:131]
    v_exp_f32 v159, v159
    v_add_f32 v156, v156, v157
    v_pk_mul_f32 v[164:165], v[164:165], v[16:17]
    v_exp_f32 v160, v160
    buffer_store_dword v156, v70, s[12:15], s35 offen offset:512 sc1
    v_lshlrev_b32_sdwa v88, 3, v122 dst_sel:DWORD dst_unused:UNUSED_PAD src0_sel:DWORD src1_sel:WORD_0
    v_lshlrev_b32_sdwa v90, 3, v122 dst_sel:DWORD dst_unused:UNUSED_PAD src0_sel:DWORD src1_sel:WORD_1
    ds_read_b64 v[88:89], v88
    ds_read_b64 v[90:91], v90
    v_lshlrev_b32_sdwa v92, 3, v123 dst_sel:DWORD dst_unused:UNUSED_PAD src0_sel:DWORD src1_sel:WORD_0
    v_lshlrev_b32_sdwa v94, 3, v123 dst_sel:DWORD dst_unused:UNUSED_PAD src0_sel:DWORD src1_sel:WORD_1
    ds_read_b64 v[92:93], v92
    ds_read_b64 v[94:95], v94
    buffer_load_dwordx4 v[120:123], v69, s[12:15], s45 offen offset:0 sc1
    s_waitcnt lgkmcnt(8)
    v_smfmac_f32_16x16x64_bf16 v[28:31], v[64:67], v[96:103], v68
    v_exp_f32 v161, v161
    v_pk_fma_f32 v[158:159], v[158:159], v[134:135], v[134:135]
    v_pk_mul_f32 v[166:167], v[18:19], v[18:19]
    v_rcp_f32 v158, v158
    v_pk_fma_f32 v[160:161], v[160:161], v[136:137], v[136:137]
    v_pk_fma_f32 v[166:167], v[166:167], v[128:129], v[130:131]
    v_rcp_f32 v159, v159
    v_pk_mul_f32 v[166:167], v[166:167], v[18:19]
    s_waitcnt vmcnt(4)
    v_lshlrev_b32_sdwa v96, 3, v124 dst_sel:DWORD dst_unused:UNUSED_PAD src0_sel:DWORD src1_sel:WORD_0
    v_lshlrev_b32_sdwa v98, 3, v124 dst_sel:DWORD dst_unused:UNUSED_PAD src0_sel:DWORD src1_sel:WORD_1
    ds_read_b64 v[96:97], v96
    ds_read_b64 v[98:99], v98
    v_lshlrev_b32_sdwa v100, 3, v125 dst_sel:DWORD dst_unused:UNUSED_PAD src0_sel:DWORD src1_sel:WORD_0
    v_lshlrev_b32_sdwa v102, 3, v125 dst_sel:DWORD dst_unused:UNUSED_PAD src0_sel:DWORD src1_sel:WORD_1
    ds_read_b64 v[100:101], v100
    ds_read_b64 v[102:103], v102
    s_waitcnt lgkmcnt(8)
    v_smfmac_f32_16x16x64_bf16 v[24:27], v[64:67], v[104:111], v68
    v_rcp_f32 v160, v160
    v_pk_mul_f32 v[162:163], v[12:13], v[158:159]
    v_pk_mul_f32 v[170:171], v[20:21], v[20:21]
    v_rcp_f32 v161, v161
    v_pk_fma_f32 v[170:171], v[170:171], v[128:129], v[130:131]
    v_pk_mul_f32 v[172:173], v[22:23], v[22:23]
    v_exp_f32 v164, v164
    v_pk_fma_f32 v[162:163], v[14:15], v[160:161], v[162:163]
    v_lshlrev_b32_sdwa v104, 3, v126 dst_sel:DWORD dst_unused:UNUSED_PAD src0_sel:DWORD src1_sel:WORD_0
    v_lshlrev_b32_sdwa v106, 3, v126 dst_sel:DWORD dst_unused:UNUSED_PAD src0_sel:DWORD src1_sel:WORD_1
    ds_read_b64 v[104:105], v104
    ds_read_b64 v[106:107], v106
    v_lshlrev_b32_sdwa v108, 3, v127 dst_sel:DWORD dst_unused:UNUSED_PAD src0_sel:DWORD src1_sel:WORD_0
    v_lshlrev_b32_sdwa v110, 3, v127 dst_sel:DWORD dst_unused:UNUSED_PAD src0_sel:DWORD src1_sel:WORD_1
    ds_read_b64 v[108:109], v108
    ds_read_b64 v[110:111], v110
    buffer_load_dwordx4 v[124:127], v69, s[12:15], s20 offen offset:1024 sc1
    s_waitcnt lgkmcnt(8)
    v_smfmac_f32_16x16x64_bf16 v[28:31], v[64:67], v[88:95], v68
    s_setprio 2
    v_exp_f32 v165, v165
    v_add_f32 v162, v162, v163
    v_pk_mul_f32 v[170:171], v[170:171], v[20:21]
    v_exp_f32 v166, v166
    buffer_store_dword v162, v70, s[12:15], s35 offen offset:640 sc1
    v_pk_fma_f32 v[164:165], v[164:165], v[134:135], v[134:135]
    v_exp_f32 v167, v167
    v_pk_fma_f32 v[172:173], v[172:173], v[128:129], v[130:131]
    s_waitcnt vmcnt(4)
    v_lshlrev_b32_sdwa v88, 3, v116 dst_sel:DWORD dst_unused:UNUSED_PAD src0_sel:DWORD src1_sel:WORD_0
    v_lshlrev_b32_sdwa v90, 3, v116 dst_sel:DWORD dst_unused:UNUSED_PAD src0_sel:DWORD src1_sel:WORD_1
    ds_read_b64 v[88:89], v88
    ds_read_b64 v[90:91], v90
    v_lshlrev_b32_sdwa v92, 3, v117 dst_sel:DWORD dst_unused:UNUSED_PAD src0_sel:DWORD src1_sel:WORD_0
    v_lshlrev_b32_sdwa v94, 3, v117 dst_sel:DWORD dst_unused:UNUSED_PAD src0_sel:DWORD src1_sel:WORD_1
    ds_read_b64 v[92:93], v92
    ds_read_b64 v[94:95], v94
    s_waitcnt lgkmcnt(8)
    v_smfmac_f32_16x16x64_bf16 v[32:35], v[64:67], v[96:103], v68
    v_rcp_f32 v164, v164
    v_pk_fma_f32 v[166:167], v[166:167], v[136:137], v[136:137]
    v_pk_mul_f32 v[172:173], v[172:173], v[22:23]
    v_rcp_f32 v165, v165
    v_pk_mul_f32 v[140:141], v[24:25], v[24:25]
    v_pk_mul_f32 v[142:143], v[26:27], v[26:27]
    v_rcp_f32 v166, v166
    v_pk_mul_f32 v[168:169], v[16:17], v[164:165]
    v_lshlrev_b32_sdwa v96, 3, v118 dst_sel:DWORD dst_unused:UNUSED_PAD src0_sel:DWORD src1_sel:WORD_0
    v_lshlrev_b32_sdwa v98, 3, v118 dst_sel:DWORD dst_unused:UNUSED_PAD src0_sel:DWORD src1_sel:WORD_1
    ds_read_b64 v[96:97], v96
    ds_read_b64 v[98:99], v98
    v_lshlrev_b32_sdwa v100, 3, v119 dst_sel:DWORD dst_unused:UNUSED_PAD src0_sel:DWORD src1_sel:WORD_0
    v_lshlrev_b32_sdwa v102, 3, v119 dst_sel:DWORD dst_unused:UNUSED_PAD src0_sel:DWORD src1_sel:WORD_1
    ds_read_b64 v[100:101], v100
    ds_read_b64 v[102:103], v102
    buffer_load_dwordx4 v[116:119], v69, s[12:15], s41 offen offset:1024 sc1
    s_waitcnt lgkmcnt(8)
    v_smfmac_f32_16x16x64_bf16 v[36:39], v[64:67], v[104:111], v68
    v_rcp_f32 v167, v167
    v_pk_fma_f32 v[140:141], v[140:141], v[128:129], v[130:131]
    v_pk_fma_f32 v[142:143], v[142:143], v[128:129], v[130:131]
    v_exp_f32 v170, v170
    v_pk_fma_f32 v[168:169], v[18:19], v[166:167], v[168:169]
    v_pk_mul_f32 v[140:141], v[140:141], v[24:25]
    v_exp_f32 v171, v171
    v_add_f32 v168, v168, v169
    s_waitcnt vmcnt(3)
    v_lshlrev_b32_sdwa v104, 3, v120 dst_sel:DWORD dst_unused:UNUSED_PAD src0_sel:DWORD src1_sel:WORD_0
    v_lshlrev_b32_sdwa v106, 3, v120 dst_sel:DWORD dst_unused:UNUSED_PAD src0_sel:DWORD src1_sel:WORD_1
    ds_read_b64 v[104:105], v104
    ds_read_b64 v[106:107], v106
    v_lshlrev_b32_sdwa v108, 3, v121 dst_sel:DWORD dst_unused:UNUSED_PAD src0_sel:DWORD src1_sel:WORD_0
    v_lshlrev_b32_sdwa v110, 3, v121 dst_sel:DWORD dst_unused:UNUSED_PAD src0_sel:DWORD src1_sel:WORD_1
    ds_read_b64 v[108:109], v108
    ds_read_b64 v[110:111], v110
    s_waitcnt lgkmcnt(8)
    v_smfmac_f32_16x16x64_bf16 v[32:35], v[64:67], v[88:95], v68
    v_exp_f32 v172, v172
    buffer_store_dword v168, v70, s[12:15], s35 offen offset:1024 sc1
    v_pk_fma_f32 v[170:171], v[170:171], v[134:135], v[134:135]
    v_exp_f32 v173, v173
    v_pk_mul_f32 v[142:143], v[142:143], v[26:27]
    v_pk_mul_f32 v[146:147], v[28:29], v[28:29]
    v_rcp_f32 v170, v170
    v_pk_fma_f32 v[172:173], v[172:173], v[136:137], v[136:137]
    v_lshlrev_b32_sdwa v88, 3, v122 dst_sel:DWORD dst_unused:UNUSED_PAD src0_sel:DWORD src1_sel:WORD_0
    v_lshlrev_b32_sdwa v90, 3, v122 dst_sel:DWORD dst_unused:UNUSED_PAD src0_sel:DWORD src1_sel:WORD_1
    ds_read_b64 v[88:89], v88
    ds_read_b64 v[90:91], v90
    v_lshlrev_b32_sdwa v92, 3, v123 dst_sel:DWORD dst_unused:UNUSED_PAD src0_sel:DWORD src1_sel:WORD_0
    v_lshlrev_b32_sdwa v94, 3, v123 dst_sel:DWORD dst_unused:UNUSED_PAD src0_sel:DWORD src1_sel:WORD_1
    ds_read_b64 v[92:93], v92
    ds_read_b64 v[94:95], v94
    buffer_load_dwordx4 v[120:123], v69, s[12:15], s45 offen offset:1024 sc1
    s_waitcnt lgkmcnt(8)
    v_smfmac_f32_16x16x64_bf16 v[36:39], v[64:67], v[96:103], v68
    v_rcp_f32 v171, v171
    v_pk_fma_f32 v[146:147], v[146:147], v[128:129], v[130:131]
    v_pk_mul_f32 v[148:149], v[30:31], v[30:31]
    v_rcp_f32 v172, v172
    v_pk_mul_f32 v[174:175], v[20:21], v[170:171]
    v_pk_mul_f32 v[146:147], v[146:147], v[28:29]
    v_rcp_f32 v173, v173
    v_pk_fma_f32 v[148:149], v[148:149], v[128:129], v[130:131]
    s_waitcnt vmcnt(4)
    v_lshlrev_b32_sdwa v96, 3, v124 dst_sel:DWORD dst_unused:UNUSED_PAD src0_sel:DWORD src1_sel:WORD_0
    v_lshlrev_b32_sdwa v98, 3, v124 dst_sel:DWORD dst_unused:UNUSED_PAD src0_sel:DWORD src1_sel:WORD_1
    ds_read_b64 v[96:97], v96
    ds_read_b64 v[98:99], v98
    v_lshlrev_b32_sdwa v100, 3, v125 dst_sel:DWORD dst_unused:UNUSED_PAD src0_sel:DWORD src1_sel:WORD_0
    v_lshlrev_b32_sdwa v102, 3, v125 dst_sel:DWORD dst_unused:UNUSED_PAD src0_sel:DWORD src1_sel:WORD_1
    ds_read_b64 v[100:101], v100
    ds_read_b64 v[102:103], v102
    s_waitcnt lgkmcnt(8)
    v_smfmac_f32_16x16x64_bf16 v[32:35], v[64:67], v[104:111], v68
    v_exp_f32 v140, v140
    v_pk_fma_f32 v[174:175], v[22:23], v[172:173], v[174:175]
    v_pk_mul_f32 v[148:149], v[148:149], v[30:31]
    v_exp_f32 v141, v141
    v_add_f32 v174, v174, v175
    v_exp_f32 v142, v142
    buffer_store_dword v174, v70, s[12:15], s35 offen offset:1152 sc1
    v_pk_fma_f32 v[140:141], v[140:141], v[134:135], v[134:135]
    v_lshlrev_b32_sdwa v104, 3, v126 dst_sel:DWORD dst_unused:UNUSED_PAD src0_sel:DWORD src1_sel:WORD_0
    v_lshlrev_b32_sdwa v106, 3, v126 dst_sel:DWORD dst_unused:UNUSED_PAD src0_sel:DWORD src1_sel:WORD_1
    ds_read_b64 v[104:105], v104
    ds_read_b64 v[106:107], v106
    v_lshlrev_b32_sdwa v108, 3, v127 dst_sel:DWORD dst_unused:UNUSED_PAD src0_sel:DWORD src1_sel:WORD_0
    v_lshlrev_b32_sdwa v110, 3, v127 dst_sel:DWORD dst_unused:UNUSED_PAD src0_sel:DWORD src1_sel:WORD_1
    ds_read_b64 v[108:109], v108
    ds_read_b64 v[110:111], v110
    buffer_load_dwordx4 v[124:127], v69, s[12:15], s20 offen offset:2048 sc1
    s_waitcnt lgkmcnt(8)
    v_smfmac_f32_16x16x64_bf16 v[36:39], v[64:67], v[88:95], v68
    v_rcp_f32 v140, v140
    v_pk_mul_f32 v[152:153], v[32:33], v[32:33]
    v_pk_mul_f32 v[154:155], v[34:35], v[34:35]
    v_rcp_f32 v141, v141
    v_pk_fma_f32 v[152:153], v[152:153], v[128:129], v[130:131]
    v_pk_fma_f32 v[154:155], v[154:155], v[128:129], v[130:131]
    v_exp_f32 v143, v143
    v_pk_mul_f32 v[144:145], v[24:25], v[140:141]
    s_waitcnt vmcnt(4)
    v_lshlrev_b32_sdwa v88, 3, v116 dst_sel:DWORD dst_unused:UNUSED_PAD src0_sel:DWORD src1_sel:WORD_0
    v_lshlrev_b32_sdwa v90, 3, v116 dst_sel:DWORD dst_unused:UNUSED_PAD src0_sel:DWORD src1_sel:WORD_1
    ds_read_b64 v[88:89], v88
    ds_read_b64 v[90:91], v90
    v_lshlrev_b32_sdwa v92, 3, v117 dst_sel:DWORD dst_unused:UNUSED_PAD src0_sel:DWORD src1_sel:WORD_0
    v_lshlrev_b32_sdwa v94, 3, v117 dst_sel:DWORD dst_unused:UNUSED_PAD src0_sel:DWORD src1_sel:WORD_1
    ds_read_b64 v[92:93], v92
    ds_read_b64 v[94:95], v94
    s_waitcnt lgkmcnt(8)
    v_smfmac_f32_16x16x64_bf16 v[40:43], v[64:67], v[96:103], v68
    v_exp_f32 v146, v146
    v_pk_fma_f32 v[142:143], v[142:143], v[136:137], v[136:137]
    v_pk_mul_f32 v[152:153], v[152:153], v[32:33]
    v_rcp_f32 v142, v142
    v_pk_mul_f32 v[154:155], v[154:155], v[34:35]
    v_pk_mul_f32 v[158:159], v[36:37], v[36:37]
    v_rcp_f32 v143, v143
    v_pk_fma_f32 v[158:159], v[158:159], v[128:129], v[130:131]
    v_lshlrev_b32_sdwa v96, 3, v118 dst_sel:DWORD dst_unused:UNUSED_PAD src0_sel:DWORD src1_sel:WORD_0
    v_lshlrev_b32_sdwa v98, 3, v118 dst_sel:DWORD dst_unused:UNUSED_PAD src0_sel:DWORD src1_sel:WORD_1
    ds_read_b64 v[96:97], v96
    ds_read_b64 v[98:99], v98
    v_lshlrev_b32_sdwa v100, 3, v119 dst_sel:DWORD dst_unused:UNUSED_PAD src0_sel:DWORD src1_sel:WORD_0
    v_lshlrev_b32_sdwa v102, 3, v119 dst_sel:DWORD dst_unused:UNUSED_PAD src0_sel:DWORD src1_sel:WORD_1
    ds_read_b64 v[100:101], v100
    ds_read_b64 v[102:103], v102
    buffer_load_dwordx4 v[116:119], v69, s[12:15], s41 offen offset:2048 sc1
    s_waitcnt lgkmcnt(8)
    v_smfmac_f32_16x16x64_bf16 v[44:47], v[64:67], v[104:111], v68
    v_exp_f32 v147, v147
    v_pk_fma_f32 v[144:145], v[26:27], v[142:143], v[144:145]
    v_pk_mul_f32 v[158:159], v[158:159], v[36:37]
    v_exp_f32 v148, v148
    v_add_f32 v144, v144, v145
    v_pk_fma_f32 v[146:147], v[146:147], v[134:135], v[134:135]
    v_exp_f32 v149, v149
    buffer_store_dword v144, v70, s[12:15], s35 offen offset:1536 sc1
    s_waitcnt vmcnt(4)
    v_lshlrev_b32_sdwa v104, 3, v120 dst_sel:DWORD dst_unused:UNUSED_PAD src0_sel:DWORD src1_sel:WORD_0
    v_lshlrev_b32_sdwa v106, 3, v120 dst_sel:DWORD dst_unused:UNUSED_PAD src0_sel:DWORD src1_sel:WORD_1
    ds_read_b64 v[104:105], v104
    ds_read_b64 v[106:107], v106
    v_lshlrev_b32_sdwa v108, 3, v121 dst_sel:DWORD dst_unused:UNUSED_PAD src0_sel:DWORD src1_sel:WORD_0
    v_lshlrev_b32_sdwa v110, 3, v121 dst_sel:DWORD dst_unused:UNUSED_PAD src0_sel:DWORD src1_sel:WORD_1
    ds_read_b64 v[108:109], v108
    ds_read_b64 v[110:111], v110
    s_waitcnt lgkmcnt(8)
    v_smfmac_f32_16x16x64_bf16 v[40:43], v[64:67], v[88:95], v68
    v_rcp_f32 v146, v146
    v_pk_fma_f32 v[148:149], v[148:149], v[136:137], v[136:137]
    v_pk_mul_f32 v[160:161], v[38:39], v[38:39]
    v_rcp_f32 v147, v147
    v_pk_fma_f32 v[160:161], v[160:161], v[128:129], v[130:131]
    v_rcp_f32 v148, v148
    v_pk_mul_f32 v[150:151], v[28:29], v[146:147]
    v_pk_mul_f32 v[160:161], v[160:161], v[38:39]
    v_lshlrev_b32_sdwa v88, 3, v122 dst_sel:DWORD dst_unused:UNUSED_PAD src0_sel:DWORD src1_sel:WORD_0
    v_lshlrev_b32_sdwa v90, 3, v122 dst_sel:DWORD dst_unused:UNUSED_PAD src0_sel:DWORD src1_sel:WORD_1
    ds_read_b64 v[88:89], v88
    ds_read_b64 v[90:91], v90
    v_lshlrev_b32_sdwa v92, 3, v123 dst_sel:DWORD dst_unused:UNUSED_PAD src0_sel:DWORD src1_sel:WORD_0
    v_lshlrev_b32_sdwa v94, 3, v123 dst_sel:DWORD dst_unused:UNUSED_PAD src0_sel:DWORD src1_sel:WORD_1
    ds_read_b64 v[92:93], v92
    ds_read_b64 v[94:95], v94
    buffer_load_dwordx4 v[120:123], v69, s[12:15], s45 offen offset:2048 sc1
    s_waitcnt lgkmcnt(8)
    v_smfmac_f32_16x16x64_bf16 v[44:47], v[64:67], v[96:103], v68
    v_rcp_f32 v149, v149
    v_exp_f32 v152, v152
    v_exp_f32 v153, v153
    v_pk_fma_f32 v[150:151], v[30:31], v[148:149], v[150:151]
    v_exp_f32 v154, v154
    v_add_f32 v150, v150, v151
    v_pk_fma_f32 v[152:153], v[152:153], v[134:135], v[134:135]
    v_exp_f32 v155, v155
    s_waitcnt vmcnt(3)
    v_lshlrev_b32_sdwa v96, 3, v124 dst_sel:DWORD dst_unused:UNUSED_PAD src0_sel:DWORD src1_sel:WORD_0
    v_lshlrev_b32_sdwa v98, 3, v124 dst_sel:DWORD dst_unused:UNUSED_PAD src0_sel:DWORD src1_sel:WORD_1
    ds_read_b64 v[96:97], v96
    ds_read_b64 v[98:99], v98
    v_lshlrev_b32_sdwa v100, 3, v125 dst_sel:DWORD dst_unused:UNUSED_PAD src0_sel:DWORD src1_sel:WORD_0
    v_lshlrev_b32_sdwa v102, 3, v125 dst_sel:DWORD dst_unused:UNUSED_PAD src0_sel:DWORD src1_sel:WORD_1
    ds_read_b64 v[100:101], v100
    ds_read_b64 v[102:103], v102
    s_waitcnt lgkmcnt(8)
    v_smfmac_f32_16x16x64_bf16 v[40:43], v[64:67], v[104:111], v68
    v_rcp_f32 v152, v152
    buffer_store_dword v150, v70, s[12:15], s35 offen offset:1664 sc1
    v_pk_fma_f32 v[154:155], v[154:155], v[136:137], v[136:137]
    v_rcp_f32 v153, v153
    v_rcp_f32 v154, v154
    v_rcp_f32 v155, v155
    v_pk_mul_f32 v[156:157], v[32:33], v[152:153]
    v_exp_f32 v158, v158
    v_lshlrev_b32_sdwa v104, 3, v126 dst_sel:DWORD dst_unused:UNUSED_PAD src0_sel:DWORD src1_sel:WORD_0
    v_lshlrev_b32_sdwa v106, 3, v126 dst_sel:DWORD dst_unused:UNUSED_PAD src0_sel:DWORD src1_sel:WORD_1
    ds_read_b64 v[104:105], v104
    ds_read_b64 v[106:107], v106
    v_lshlrev_b32_sdwa v108, 3, v127 dst_sel:DWORD dst_unused:UNUSED_PAD src0_sel:DWORD src1_sel:WORD_0
    v_lshlrev_b32_sdwa v110, 3, v127 dst_sel:DWORD dst_unused:UNUSED_PAD src0_sel:DWORD src1_sel:WORD_1
    ds_read_b64 v[108:109], v108
    ds_read_b64 v[110:111], v110
    buffer_load_dwordx4 v[124:127], v69, s[12:15], s20 offen offset:3072 sc1
    s_waitcnt lgkmcnt(8)
    v_smfmac_f32_16x16x64_bf16 v[44:47], v[64:67], v[88:95], v68
    v_exp_f32 v159, v159
    v_pk_fma_f32 v[156:157], v[34:35], v[154:155], v[156:157]
    v_pk_mul_f32 v[164:165], v[40:41], v[40:41]
    v_exp_f32 v160, v160
    v_add_f32 v156, v156, v157
    v_pk_fma_f32 v[158:159], v[158:159], v[134:135], v[134:135]
    v_exp_f32 v161, v161
    buffer_store_dword v156, v70, s[12:15], s35 offen offset:2048 sc1
    s_waitcnt vmcnt(5)
    v_lshlrev_b32_sdwa v88, 3, v116 dst_sel:DWORD dst_unused:UNUSED_PAD src0_sel:DWORD src1_sel:WORD_0
    v_lshlrev_b32_sdwa v90, 3, v116 dst_sel:DWORD dst_unused:UNUSED_PAD src0_sel:DWORD src1_sel:WORD_1
    ds_read_b64 v[88:89], v88
    ds_read_b64 v[90:91], v90
    v_lshlrev_b32_sdwa v92, 3, v117 dst_sel:DWORD dst_unused:UNUSED_PAD src0_sel:DWORD src1_sel:WORD_0
    v_lshlrev_b32_sdwa v94, 3, v117 dst_sel:DWORD dst_unused:UNUSED_PAD src0_sel:DWORD src1_sel:WORD_1
    ds_read_b64 v[92:93], v92
    ds_read_b64 v[94:95], v94
    s_waitcnt lgkmcnt(8)
    v_smfmac_f32_16x16x64_bf16 v[48:51], v[64:67], v[96:103], v68
    v_rcp_f32 v158, v158
    v_pk_fma_f32 v[160:161], v[160:161], v[136:137], v[136:137]
    v_pk_fma_f32 v[164:165], v[164:165], v[128:129], v[130:131]
    v_rcp_f32 v159, v159
    v_pk_mul_f32 v[164:165], v[164:165], v[40:41]
    v_pk_mul_f32 v[166:167], v[42:43], v[42:43]
    v_rcp_f32 v160, v160
    v_pk_mul_f32 v[162:163], v[36:37], v[158:159]
    v_lshlrev_b32_sdwa v96, 3, v118 dst_sel:DWORD dst_unused:UNUSED_PAD src0_sel:DWORD src1_sel:WORD_0
    v_lshlrev_b32_sdwa v98, 3, v118 dst_sel:DWORD dst_unused:UNUSED_PAD src0_sel:DWORD src1_sel:WORD_1
    ds_read_b64 v[96:97], v96
    ds_read_b64 v[98:99], v98
    v_lshlrev_b32_sdwa v100, 3, v119 dst_sel:DWORD dst_unused:UNUSED_PAD src0_sel:DWORD src1_sel:WORD_0
    v_lshlrev_b32_sdwa v102, 3, v119 dst_sel:DWORD dst_unused:UNUSED_PAD src0_sel:DWORD src1_sel:WORD_1
    ds_read_b64 v[100:101], v100
    ds_read_b64 v[102:103], v102
    buffer_load_dwordx4 v[116:119], v69, s[12:15], s41 offen offset:3072 sc1
    s_waitcnt lgkmcnt(8)
    v_smfmac_f32_16x16x64_bf16 v[52:55], v[64:67], v[104:111], v68
    s_setprio 1
    v_rcp_f32 v161, v161
    v_pk_fma_f32 v[166:167], v[166:167], v[128:129], v[130:131]
    v_pk_mul_f32 v[170:171], v[44:45], v[44:45]
    v_exp_f32 v164, v164
    v_pk_fma_f32 v[162:163], v[38:39], v[160:161], v[162:163]
    v_pk_mul_f32 v[166:167], v[166:167], v[42:43]
    v_exp_f32 v165, v165
    v_add_f32 v162, v162, v163
    s_waitcnt vmcnt(4)
    v_lshlrev_b32_sdwa v104, 3, v120 dst_sel:DWORD dst_unused:UNUSED_PAD src0_sel:DWORD src1_sel:WORD_0
    v_lshlrev_b32_sdwa v106, 3, v120 dst_sel:DWORD dst_unused:UNUSED_PAD src0_sel:DWORD src1_sel:WORD_1
    ds_read_b64 v[104:105], v104
    ds_read_b64 v[106:107], v106
    v_lshlrev_b32_sdwa v108, 3, v121 dst_sel:DWORD dst_unused:UNUSED_PAD src0_sel:DWORD src1_sel:WORD_0
    v_lshlrev_b32_sdwa v110, 3, v121 dst_sel:DWORD dst_unused:UNUSED_PAD src0_sel:DWORD src1_sel:WORD_1
    ds_read_b64 v[108:109], v108
    ds_read_b64 v[110:111], v110
    s_waitcnt lgkmcnt(8)
    v_smfmac_f32_16x16x64_bf16 v[48:51], v[64:67], v[88:95], v68
    v_exp_f32 v166, v166
    buffer_store_dword v162, v70, s[12:15], s35 offen offset:2176 sc1
    v_pk_fma_f32 v[164:165], v[164:165], v[134:135], v[134:135]
    v_exp_f32 v167, v167
    v_pk_fma_f32 v[170:171], v[170:171], v[128:129], v[130:131]
    v_pk_mul_f32 v[172:173], v[46:47], v[46:47]
    v_rcp_f32 v164, v164
    v_pk_fma_f32 v[166:167], v[166:167], v[136:137], v[136:137]
    v_lshlrev_b32_sdwa v88, 3, v122 dst_sel:DWORD dst_unused:UNUSED_PAD src0_sel:DWORD src1_sel:WORD_0
    v_lshlrev_b32_sdwa v90, 3, v122 dst_sel:DWORD dst_unused:UNUSED_PAD src0_sel:DWORD src1_sel:WORD_1
    ds_read_b64 v[88:89], v88
    ds_read_b64 v[90:91], v90
    v_lshlrev_b32_sdwa v92, 3, v123 dst_sel:DWORD dst_unused:UNUSED_PAD src0_sel:DWORD src1_sel:WORD_0
    v_lshlrev_b32_sdwa v94, 3, v123 dst_sel:DWORD dst_unused:UNUSED_PAD src0_sel:DWORD src1_sel:WORD_1
    ds_read_b64 v[92:93], v92
    ds_read_b64 v[94:95], v94
    buffer_load_dwordx4 v[120:123], v69, s[12:15], s45 offen offset:3072 sc1
    s_waitcnt lgkmcnt(8)
    v_smfmac_f32_16x16x64_bf16 v[52:55], v[64:67], v[96:103], v68
    v_rcp_f32 v165, v165
    v_pk_mul_f32 v[170:171], v[170:171], v[44:45]
    v_pk_fma_f32 v[172:173], v[172:173], v[128:129], v[130:131]
    v_rcp_f32 v166, v166
    v_pk_mul_f32 v[168:169], v[40:41], v[164:165]
    v_pk_mul_f32 v[172:173], v[172:173], v[46:47]
    v_rcp_f32 v167, v167
    v_exp_f32 v170, v170
    s_waitcnt vmcnt(4)
    v_lshlrev_b32_sdwa v96, 3, v124 dst_sel:DWORD dst_unused:UNUSED_PAD src0_sel:DWORD src1_sel:WORD_0
    v_lshlrev_b32_sdwa v98, 3, v124 dst_sel:DWORD dst_unused:UNUSED_PAD src0_sel:DWORD src1_sel:WORD_1
    ds_read_b64 v[96:97], v96
    ds_read_b64 v[98:99], v98
    v_lshlrev_b32_sdwa v100, 3, v125 dst_sel:DWORD dst_unused:UNUSED_PAD src0_sel:DWORD src1_sel:WORD_0
    v_lshlrev_b32_sdwa v102, 3, v125 dst_sel:DWORD dst_unused:UNUSED_PAD src0_sel:DWORD src1_sel:WORD_1
    ds_read_b64 v[100:101], v100
    ds_read_b64 v[102:103], v102
    s_waitcnt lgkmcnt(8)
    v_smfmac_f32_16x16x64_bf16 v[48:51], v[64:67], v[104:111], v68
    v_exp_f32 v171, v171
    v_pk_fma_f32 v[168:169], v[42:43], v[166:167], v[168:169]
    v_exp_f32 v172, v172
    v_add_f32 v168, v168, v169
    v_pk_fma_f32 v[170:171], v[170:171], v[134:135], v[134:135]
    v_exp_f32 v173, v173
    buffer_store_dword v168, v70, s[12:15], s35 offen offset:2560 sc1
    v_rcp_f32 v170, v170
    v_lshlrev_b32_sdwa v104, 3, v126 dst_sel:DWORD dst_unused:UNUSED_PAD src0_sel:DWORD src1_sel:WORD_0
    v_lshlrev_b32_sdwa v106, 3, v126 dst_sel:DWORD dst_unused:UNUSED_PAD src0_sel:DWORD src1_sel:WORD_1
    ds_read_b64 v[104:105], v104
    ds_read_b64 v[106:107], v106
    v_lshlrev_b32_sdwa v108, 3, v127 dst_sel:DWORD dst_unused:UNUSED_PAD src0_sel:DWORD src1_sel:WORD_0
    v_lshlrev_b32_sdwa v110, 3, v127 dst_sel:DWORD dst_unused:UNUSED_PAD src0_sel:DWORD src1_sel:WORD_1
    ds_read_b64 v[108:109], v108
    ds_read_b64 v[110:111], v110
    s_waitcnt lgkmcnt(8)
    v_smfmac_f32_16x16x64_bf16 v[52:55], v[64:67], v[88:95], v68
    v_rcp_f32 v171, v171
    v_pk_fma_f32 v[172:173], v[172:173], v[136:137], v[136:137]
    v_pk_mul_f32 v[140:141], v[48:49], v[48:49]
    v_rcp_f32 v172, v172
    v_pk_mul_f32 v[174:175], v[44:45], v[170:171]
    v_pk_fma_f32 v[140:141], v[140:141], v[128:129], v[130:131]
    v_rcp_f32 v173, v173
    v_pk_mul_f32 v[140:141], v[140:141], v[48:49]
    s_waitcnt vmcnt(3)
    v_lshlrev_b32_sdwa v88, 3, v116 dst_sel:DWORD dst_unused:UNUSED_PAD src0_sel:DWORD src1_sel:WORD_0
    v_lshlrev_b32_sdwa v90, 3, v116 dst_sel:DWORD dst_unused:UNUSED_PAD src0_sel:DWORD src1_sel:WORD_1
    ds_read_b64 v[88:89], v88
    ds_read_b64 v[90:91], v90
    v_lshlrev_b32_sdwa v92, 3, v117 dst_sel:DWORD dst_unused:UNUSED_PAD src0_sel:DWORD src1_sel:WORD_0
    v_lshlrev_b32_sdwa v94, 3, v117 dst_sel:DWORD dst_unused:UNUSED_PAD src0_sel:DWORD src1_sel:WORD_1
    ds_read_b64 v[92:93], v92
    ds_read_b64 v[94:95], v94
    s_waitcnt lgkmcnt(8)
    v_smfmac_f32_16x16x64_bf16 v[56:59], v[64:67], v[96:103], v68
    v_exp_f32 v140, v140
    v_pk_fma_f32 v[174:175], v[46:47], v[172:173], v[174:175]
    v_pk_mul_f32 v[142:143], v[50:51], v[50:51]
    v_exp_f32 v141, v141
    v_add_f32 v174, v174, v175
    v_pk_fma_f32 v[142:143], v[142:143], v[128:129], v[130:131]
    buffer_store_dword v174, v70, s[12:15], s35 offen offset:2688 sc1
    v_pk_fma_f32 v[140:141], v[140:141], v[134:135], v[134:135]
    v_lshlrev_b32_sdwa v96, 3, v118 dst_sel:DWORD dst_unused:UNUSED_PAD src0_sel:DWORD src1_sel:WORD_0
    v_lshlrev_b32_sdwa v98, 3, v118 dst_sel:DWORD dst_unused:UNUSED_PAD src0_sel:DWORD src1_sel:WORD_1
    ds_read_b64 v[96:97], v96
    ds_read_b64 v[98:99], v98
    v_lshlrev_b32_sdwa v100, 3, v119 dst_sel:DWORD dst_unused:UNUSED_PAD src0_sel:DWORD src1_sel:WORD_0
    v_lshlrev_b32_sdwa v102, 3, v119 dst_sel:DWORD dst_unused:UNUSED_PAD src0_sel:DWORD src1_sel:WORD_1
    ds_read_b64 v[100:101], v100
    ds_read_b64 v[102:103], v102
    s_waitcnt lgkmcnt(8)
    v_smfmac_f32_16x16x64_bf16 v[60:63], v[64:67], v[104:111], v68
    v_rcp_f32 v140, v140
    v_pk_mul_f32 v[142:143], v[142:143], v[50:51]
    v_pk_mul_f32 v[146:147], v[52:53], v[52:53]
    v_rcp_f32 v141, v141
    v_pk_fma_f32 v[146:147], v[146:147], v[128:129], v[130:131]
    v_pk_mul_f32 v[148:149], v[54:55], v[54:55]
    v_exp_f32 v142, v142
    v_pk_mul_f32 v[144:145], v[48:49], v[140:141]
    s_waitcnt vmcnt(2)
    v_lshlrev_b32_sdwa v104, 3, v120 dst_sel:DWORD dst_unused:UNUSED_PAD src0_sel:DWORD src1_sel:WORD_0
    v_lshlrev_b32_sdwa v106, 3, v120 dst_sel:DWORD dst_unused:UNUSED_PAD src0_sel:DWORD src1_sel:WORD_1
    ds_read_b64 v[104:105], v104
    ds_read_b64 v[106:107], v106
    v_lshlrev_b32_sdwa v108, 3, v121 dst_sel:DWORD dst_unused:UNUSED_PAD src0_sel:DWORD src1_sel:WORD_0
    v_lshlrev_b32_sdwa v110, 3, v121 dst_sel:DWORD dst_unused:UNUSED_PAD src0_sel:DWORD src1_sel:WORD_1
    ds_read_b64 v[108:109], v108
    ds_read_b64 v[110:111], v110
    s_waitcnt lgkmcnt(8)
    v_smfmac_f32_16x16x64_bf16 v[56:59], v[64:67], v[88:95], v68
    v_exp_f32 v143, v143
    v_pk_mul_f32 v[146:147], v[146:147], v[52:53]
    v_pk_fma_f32 v[148:149], v[148:149], v[128:129], v[130:131]
    v_exp_f32 v146, v146
    v_pk_fma_f32 v[142:143], v[142:143], v[136:137], v[136:137]
    v_pk_mul_f32 v[148:149], v[148:149], v[54:55]
    v_rcp_f32 v142, v142
    v_rcp_f32 v143, v143
    v_lshlrev_b32_sdwa v88, 3, v122 dst_sel:DWORD dst_unused:UNUSED_PAD src0_sel:DWORD src1_sel:WORD_0
    v_lshlrev_b32_sdwa v90, 3, v122 dst_sel:DWORD dst_unused:UNUSED_PAD src0_sel:DWORD src1_sel:WORD_1
    ds_read_b64 v[88:89], v88
    ds_read_b64 v[90:91], v90
    v_lshlrev_b32_sdwa v92, 3, v123 dst_sel:DWORD dst_unused:UNUSED_PAD src0_sel:DWORD src1_sel:WORD_0
    v_lshlrev_b32_sdwa v94, 3, v123 dst_sel:DWORD dst_unused:UNUSED_PAD src0_sel:DWORD src1_sel:WORD_1
    ds_read_b64 v[92:93], v92
    ds_read_b64 v[94:95], v94
    s_waitcnt lgkmcnt(8)
    v_smfmac_f32_16x16x64_bf16 v[60:63], v[64:67], v[96:103], v68
    s_setprio 0
    v_exp_f32 v147, v147
    v_pk_fma_f32 v[144:145], v[50:51], v[142:143], v[144:145]
    v_exp_f32 v148, v148
    v_add_f32 v144, v144, v145
    v_pk_fma_f32 v[146:147], v[146:147], v[134:135], v[134:135]
    v_exp_f32 v149, v149
    buffer_store_dword v144, v70, s[12:15], s35 offen offset:3072 sc1
    v_rcp_f32 v146, v146
    s_waitcnt lgkmcnt(4)
    v_smfmac_f32_16x16x64_bf16 v[56:59], v[64:67], v[104:111], v68
    v_rcp_f32 v147, v147
    v_pk_fma_f32 v[148:149], v[148:149], v[136:137], v[136:137]
    s_waitcnt lgkmcnt(0)
    v_smfmac_f32_16x16x64_bf16 v[60:63], v[64:67], v[88:95], v68
    v_rcp_f32 v148, v148
    v_pk_mul_f32 v[150:151], v[52:53], v[146:147]
    v_rcp_f32 v149, v149
    s_nop 0
    s_nop 0
    v_pk_fma_f32 v[150:151], v[54:55], v[148:149], v[150:151]
    s_nop 0
    v_add_f32 v150, v150, v151
    v_pk_mul_f32 v[152:153], v[56:57], v[56:57]
    buffer_store_dword v150, v70, s[12:15], s35 offen offset:3200 sc1
    v_pk_fma_f32 v[152:153], v[152:153], v[128:129], v[130:131]
    v_pk_mul_f32 v[154:155], v[58:59], v[58:59]
    v_pk_mul_f32 v[152:153], v[152:153], v[56:57]
    v_pk_fma_f32 v[154:155], v[154:155], v[128:129], v[130:131]
    v_exp_f32 v152, v152
    v_pk_mul_f32 v[154:155], v[154:155], v[58:59]
    v_pk_mul_f32 v[158:159], v[60:61], v[60:61]
    v_exp_f32 v153, v153
    v_pk_fma_f32 v[158:159], v[158:159], v[128:129], v[130:131]
    v_pk_mul_f32 v[160:161], v[62:63], v[62:63]
    v_exp_f32 v154, v154
    v_pk_fma_f32 v[152:153], v[152:153], v[134:135], v[134:135]
    v_pk_mul_f32 v[158:159], v[158:159], v[60:61]
    v_rcp_f32 v152, v152
    v_pk_fma_f32 v[160:161], v[160:161], v[128:129], v[130:131]
    v_rcp_f32 v153, v153
    v_pk_mul_f32 v[160:161], v[160:161], v[62:63]
    v_exp_f32 v155, v155
    v_pk_mul_f32 v[156:157], v[56:57], v[152:153]
    v_exp_f32 v158, v158
    v_pk_fma_f32 v[154:155], v[154:155], v[136:137], v[136:137]
    v_exp_f32 v159, v159
    v_rcp_f32 v154, v154
    v_rcp_f32 v155, v155
    v_pk_fma_f32 v[158:159], v[158:159], v[134:135], v[134:135]
    v_exp_f32 v160, v160
    v_pk_fma_f32 v[156:157], v[58:59], v[154:155], v[156:157]
    v_rcp_f32 v158, v158
    v_add_f32 v156, v156, v157
    v_rcp_f32 v159, v159
    buffer_store_dword v156, v70, s[12:15], s35 offen offset:3584 sc1
    v_exp_f32 v161, v161
    v_pk_mul_f32 v[162:163], v[60:61], v[158:159]
    s_nop 0
    v_pk_fma_f32 v[160:161], v[160:161], v[136:137], v[136:137]
    s_nop 0
    v_rcp_f32 v160, v160
    v_rcp_f32 v161, v161
    s_nop 0
    s_nop 0
    v_pk_fma_f32 v[162:163], v[62:63], v[160:161], v[162:163]
    s_nop 0
    v_add_f32 v162, v162, v163
    s_nop 0
    buffer_store_dword v162, v70, s[12:15], s35 offen offset:3712 sc1

    v_and_b32 v193, 0xf0, v69
    v_lshrrev_b32 v197, 8, v69
    v_lshl_or_b32 v192, v197, 16, v193
    v_lshrrev_b32 v198, 1, v197
    v_and_b32 v197, 1, v197
    v_lshl_or_b32 v193, v198, 2, v193
    v_lshl_or_b32 v193, v197, 3, v193
    v_mov_b32 v196, 0
    s_mov_b32 s65, 0

    s_lshl_b32 s68, s2, 8
    s_add_u32 s66, s68, 29360128
    s_add_u32 s67, s66, 65536
    s_add_u32 s60, s68, 20971520
    s_lshr_b32 s68, s68, 1

    s_lshl_b32 s61, s3, 20
    s_add_u32 s60, s60, s61

    s_add_u32 s61, s60, 262144
    s_add_u32 s62, s60, 524288
    s_add_u32 s63, s60, 786432

    s_mov_b32 s76, s56
    s_and_b32 s77, s57, 0xffff
    s_mov_b32 s78, 2
    s_mov_b32 s79, 0x00020000
    s_mov_b32 s72, s58
    s_and_b32 s73, s59, 0xffff
    s_mov_b32 s74, 32768
    s_mov_b32 s75, 0x00020000
    s_mov_b64 s[20:21], -1
    s_mov_b64 s[22:23], -1
    s_mov_b64 s[24:25], -1
    s_mov_b64 s[26:27], -1
    s_mov_b64 s[28:29], -1

    v_mov_b32 v216, -1
    buffer_load_short_d16_hi v196, v196, s[76:79], 0 offen
    s_bitcmp1_b32 s64, 30
    s_cbranch_scc0 standalone__deep_cross_pnn__recsys_kernel_rd

standalone__deep_cross_pnn__recsys_kernel_rp:
    s_mov_b64 exec, s[20:21]
    buffer_load_dwordx4 v[176:179], v192, s[12:15], s60 offen sc1
    s_mov_b64 exec, s[22:23]
    buffer_load_dwordx4 v[180:183], v192, s[12:15], s61 offen sc1
    s_mov_b64 exec, s[24:25]
    buffer_load_dwordx4 v[184:187], v192, s[12:15], s62 offen sc1
    s_mov_b64 exec, s[26:27]
    buffer_load_dwordx4 v[188:191], v192, s[12:15], s63 offen sc1
    s_mov_b64 exec, s[28:29]
    buffer_load_dword v194, v193, s[12:15], s66 offen sc1
    buffer_load_dword v195, v193, s[12:15], s67 offen sc1
    s_mov_b64 exec, -1
    s_waitcnt vmcnt(4)
    v_add_f32 v216, v176, v180
    v_add_f32 v217, v177, v181
    v_add_f32 v218, v178, v182
    v_add_f32 v219, v179, v183
    s_waitcnt vmcnt(2)
    v_add_f32 v220, v184, v188
    v_add_f32 v221, v185, v189
    v_add_f32 v222, v186, v190
    v_add_f32 v223, v187, v191
    v_add_f32 v216, v216, v220
    v_add_f32 v217, v217, v221
    v_add_f32 v218, v218, v222
    v_add_f32 v219, v219, v223

    s_nop 0
    v_permlane32_swap_b32 v216, v217
    v_permlane32_swap_b32 v218, v219
    v_add_f32 v216, v216, v217
    v_add_f32 v218, v218, v219
    s_nop 1
    v_permlane16_swap_b32 v216, v218
    s_nop 0
    v_add_f32 v216, v216, v218

    s_waitcnt vmcnt(0)
    v_add_f32 v201, v194, v195
    s_add_u32 s65, s65, 1
    v_add_f32 v197, v201, v216
    v_cmp_u_f32 vcc, v197, v197
    s_cbranch_vccz standalone__deep_cross_pnn__recsys_kernel_rd

    v_cmp_u_f32 s[20:21], v176, v177
    v_cmp_u_f32 vcc, v178, v179
    s_or_b64 s[20:21], s[20:21], vcc

    v_cmp_u_f32 s[22:23], v180, v181
    v_cmp_u_f32 vcc, v182, v183
    s_or_b64 s[22:23], s[22:23], vcc

    v_cmp_u_f32 s[24:25], v184, v185
    v_cmp_u_f32 vcc, v186, v187
    s_or_b64 s[24:25], s[24:25], vcc

    v_cmp_u_f32 s[26:27], v188, v189
    v_cmp_u_f32 vcc, v190, v191
    s_or_b64 s[26:27], s[26:27], vcc

    v_cmp_u_f32 s[28:29], v194, v195

    s_cmp_lt_u32 s65, 300
    s_cbranch_scc1 standalone__deep_cross_pnn__recsys_kernel_rp
    v_mov_b32 v216, -1

standalone__deep_cross_pnn__recsys_kernel_rd:

    v_lshrrev_b32 v197, 2, v69
    s_lshl_b32 s69, s3, 8
    v_add_u32 v198, s69, v197
    ds_write_b32 v198, v216
    v_mov_b32 v199, 0
    s_waitcnt vmcnt(0) lgkmcnt(0)

    s_barrier
    s_cmp_eq_u32 s3, 1
    s_cbranch_scc1 standalone__deep_cross_pnn__recsys_kernel_rc
    s_cmp_lg_u32 s3, 0
    s_cbranch_scc1 standalone__deep_cross_pnn__recsys_kernel_end

    ds_read_b32 v208, v197 offset:0
    ds_read_b32 v209, v197 offset:256
    ds_read_b32 v210, v197 offset:512
    ds_read_b32 v211, v197 offset:768
    ds_read_b32 v212, v197 offset:1024
    ds_read_b32 v213, v197 offset:1280
    ds_read_b32 v214, v197 offset:1536
    ds_read_b32 v215, v197 offset:1792
    s_waitcnt lgkmcnt(6)
    v_add_f32 v200, v208, v209
    s_waitcnt lgkmcnt(5)
    v_add_f32 v200, v200, v210
    s_waitcnt lgkmcnt(4)
    v_add_f32 v200, v200, v211
    s_waitcnt lgkmcnt(3)
    v_add_f32 v200, v200, v212
    s_waitcnt lgkmcnt(2)
    v_add_f32 v200, v200, v213
    s_waitcnt lgkmcnt(1)
    v_add_f32 v200, v200, v214
    s_waitcnt lgkmcnt(0)
    v_add_f32 v200, v200, v215

    v_cmp_u_f32 vcc, v200, v200
    s_cbranch_vccnz standalone__deep_cross_pnn__recsys_kernel_rf

    v_cvt_pk_bf16_f32 v197, v200, v201
    v_lshlrev_b32 v198, 16, v197
    v_and_b32 v197, 0xffff0000, v197
    v_add_f32 v198, v198, v196
    v_cvt_pk_bf16_f32 v198, v198, v198
    v_lshlrev_b32 v198, 16, v198
    v_add_f32 v198, v198, v197
    v_cvt_pk_bf16_f32 v198, v198, v198
    v_lshrrev_b32 v197, 1, v193
    buffer_store_short v198, v197, s[72:75], s68 offen

    s_endpgm
standalone__deep_cross_pnn__recsys_kernel_rf:

    s_lshr_b32 s69, s2, 5
    s_lshl_b32 s69, s69, 4
    s_lshl_b32 s70, 1, s2
    v_mov_b32 v198, s70
    s_mov_b64 exec, 1
    buffer_atomic_or v198, v199, s[52:55], s69 offen offset:136 sc0
    s_waitcnt vmcnt(0)

standalone__deep_cross_pnn__recsys_kernel_rc:

    s_mov_b64 exec, 0xff
    buffer_load_dwordx4 v[176:179], v69, s[52:55], 0 offen offset:128 sc1
    s_waitcnt vmcnt(0)
    v_cmp_ne_u32 vcc, 0, v178
    s_cbranch_vccz standalone__deep_cross_pnn__recsys_kernel_end
    v_cmp_ne_u32 vcc, -1, v176
    s_cbranch_vccnz standalone__deep_cross_pnn__recsys_kernel_end
    v_mov_b32 v199, v178
    s_mov_b64 exec, -1
    v_lshlrev_b32 v198, 3, v69
    s_mov_b32 s69, 14680064
    buffer_load_dwordx4 v[176:179], v198, s[12:15], s69 offen sc1
    s_waitcnt vmcnt(0)
    v_min3_u32 v198, v176, v177, v178
    v_min_u32 v198, v198, v179
    v_cmp_eq_u32 vcc, 0, v198
    s_cbranch_vccnz standalone__deep_cross_pnn__recsys_kernel_end

standalone__deep_cross_pnn__recsys_kernel_rn:

    v_cmp_ne_u32 vcc, 0, v199
    s_cbranch_vccz standalone__deep_cross_pnn__recsys_kernel_end
    s_ff1_i32_b64 s69, vcc
    s_mov_b32 m0, s69
    s_nop 3
    v_readlane_b32 s70, v199, s69
    s_ff1_i32_b32 s71, s70
    s_bitset0_b32 s70, s71
    s_nop 3
    v_writelane_b32 v199, s70, m0
    s_lshl_b32 s69, s69, 5
    s_add_u32 s69, s69, s71

    s_lshl_b32 s68, s69, 8
    s_add_u32 s66, s68, 29360128
    s_add_u32 s67, s66, 65536
    s_add_u32 s60, s68, 20971520
    s_lshr_b32 s68, s68, 1

    s_add_u32 s61, s60, 262144
    s_add_u32 s62, s60, 524288
    s_add_u32 s63, s60, 786432

    buffer_load_dword v194, v193, s[12:15], s66 offen sc1
    buffer_load_dword v195, v193, s[12:15], s67 offen sc1
    s_mov_b32 s65, 0
standalone__deep_cross_pnn__recsys_kernel_rw:
    buffer_load_dwordx4 v[176:179], v192, s[12:15], s60 offen sc1
    buffer_load_dwordx4 v[180:183], v192, s[12:15], s61 offen sc1
    buffer_load_dwordx4 v[184:187], v192, s[12:15], s62 offen sc1
    buffer_load_dwordx4 v[188:191], v192, s[12:15], s63 offen sc1
    s_waitcnt vmcnt(2)
    v_add_f32 v216, v176, v180
    v_add_f32 v217, v177, v181
    v_add_f32 v218, v178, v182
    v_add_f32 v219, v179, v183
    s_waitcnt vmcnt(0)
    v_add_f32 v220, v184, v188
    v_add_f32 v221, v185, v189
    v_add_f32 v222, v186, v190
    v_add_f32 v223, v187, v191
    v_add_f32 v216, v216, v220
    v_add_f32 v217, v217, v221
    v_add_f32 v218, v218, v222
    v_add_f32 v219, v219, v223

    s_nop 0
    v_permlane32_swap_b32 v216, v217
    v_permlane32_swap_b32 v218, v219
    v_add_f32 v216, v216, v217
    v_add_f32 v218, v218, v219
    s_nop 1
    v_permlane16_swap_b32 v216, v218
    s_nop 0
    v_add_f32 v216, v216, v218

    s_mov_b32 s70, 0xff800001
    s_mov_b64 s[20:21], 0
    v_cmp_eq_u32 vcc, s70, v194
    s_or_b64 s[20:21], s[20:21], vcc
    v_cmp_eq_u32 vcc, s70, v195
    s_or_b64 s[20:21], s[20:21], vcc
    v_cmp_eq_u32 vcc, s70, v176
    s_or_b64 s[20:21], s[20:21], vcc
    v_cmp_eq_u32 vcc, s70, v177
    s_or_b64 s[20:21], s[20:21], vcc
    v_cmp_eq_u32 vcc, s70, v178
    s_or_b64 s[20:21], s[20:21], vcc
    v_cmp_eq_u32 vcc, s70, v179
    s_or_b64 s[20:21], s[20:21], vcc
    v_cmp_eq_u32 vcc, s70, v180
    s_or_b64 s[20:21], s[20:21], vcc
    v_cmp_eq_u32 vcc, s70, v181
    s_or_b64 s[20:21], s[20:21], vcc
    v_cmp_eq_u32 vcc, s70, v182
    s_or_b64 s[20:21], s[20:21], vcc
    v_cmp_eq_u32 vcc, s70, v183
    s_or_b64 s[20:21], s[20:21], vcc
    v_cmp_eq_u32 vcc, s70, v184
    s_or_b64 s[20:21], s[20:21], vcc
    v_cmp_eq_u32 vcc, s70, v185
    s_or_b64 s[20:21], s[20:21], vcc
    v_cmp_eq_u32 vcc, s70, v186
    s_or_b64 s[20:21], s[20:21], vcc
    v_cmp_eq_u32 vcc, s70, v187
    s_or_b64 s[20:21], s[20:21], vcc
    v_cmp_eq_u32 vcc, s70, v188
    s_or_b64 s[20:21], s[20:21], vcc
    v_cmp_eq_u32 vcc, s70, v189
    s_or_b64 s[20:21], s[20:21], vcc
    v_cmp_eq_u32 vcc, s70, v190
    s_or_b64 s[20:21], s[20:21], vcc
    v_cmp_eq_u32 vcc, s70, v191
    s_or_b64 s[20:21], s[20:21], vcc

    s_cbranch_scc1 standalone__deep_cross_pnn__recsys_kernel_end
    s_cmp_eq_u32 s65, 0
    s_cselect_b64 vcc, -1, 0
    v_add_f32 v200, v200, v216
    v_cndmask_b32 v200, v200, v216, vcc
    s_add_u32 s60, s60, 1048576
    s_add_u32 s61, s61, 1048576
    s_add_u32 s62, s62, 1048576
    s_add_u32 s63, s63, 1048576
    s_add_u32 s65, s65, 1
    s_cmp_lt_u32 s65, 8
    s_cbranch_scc1 standalone__deep_cross_pnn__recsys_kernel_rw
    v_add_f32 v201, v194, v195

    v_cvt_pk_bf16_f32 v197, v200, v201
    v_lshlrev_b32 v198, 16, v197
    v_and_b32 v197, 0xffff0000, v197
    v_add_f32 v198, v198, v196
    v_cvt_pk_bf16_f32 v198, v198, v198
    v_lshlrev_b32 v198, 16, v198
    v_add_f32 v198, v198, v197
    v_cvt_pk_bf16_f32 v198, v198, v198
    v_lshrrev_b32 v197, 1, v193
    buffer_store_short v198, v197, s[72:75], s68 offen

    s_nop 1
    s_branch standalone__deep_cross_pnn__recsys_kernel_rn
standalone__deep_cross_pnn__recsys_kernel_end:
    s_endpgm
.section .rodata,"a"
.p2align 6
.amdhsa_kernel standalone__deep_cross_pnn__recsys_kernel
  .amdhsa_next_free_vgpr 256
  .amdhsa_next_free_sgpr 102
  .amdhsa_accum_offset 256
  .amdhsa_group_segment_fixed_size 0
  .amdhsa_kernarg_size 80
  .amdhsa_user_sgpr_count 2
  .amdhsa_user_sgpr_kernarg_segment_ptr 1
  .amdhsa_system_sgpr_workgroup_id_x 1
.end_amdhsa_kernel
```

```asm
; @launch grid=(256,1,1) block=(512,1,1) lds=163840
.amdgcn_target "amdgcn-amd-amdhsa--gfx950"
.text
.globl standalone__deep_cross_pnn__recsys_kernel
.p2align 8
.type standalone__deep_cross_pnn__recsys_kernel,@function
standalone__deep_cross_pnn__recsys_kernel:

    s_cmp_ge_u32 s2, 256
    s_cbranch_scc1 standalone__deep_cross_pnn__recsys_kernel_end
    s_load_dwordx8 s[4:11], s[0:1], 0
    s_load_dwordx2 s[12:13], s[0:1], 72
    s_load_dwordx2 s[52:53], s[0:1], 64
    s_load_dwordx4 s[60:63], s[0:1], 32
    v_lshrrev_b32 v1, 6, v0
    v_and_b32 v255, 63, v0
    s_bfe_u32 s36, s2, 0x10003
    v_readfirstlane_b32 s3, v1
    s_lshr_b32 s37, s2, 4
    s_lshl_b32 s37, s37, 3
    s_and_b32 s38, s2, 7
    s_or_b32 s37, s37, s38
    v_lshlrev_b32 v254, 4, v255
    v_mov_b32 v252, 163712
    v_mov_b32 v253, 1
    v_mov_b32 v40, 0
    v_cmp_gt_u32 vcc, 8, v0
    v_lshl_add_u32 v41, v0, 2, v252
    s_and_saveexec_b64 s[46:47], vcc
    ds_write_b32 v41, v40
    s_mov_b64 exec, s[46:47]
    v_mul_u32_u24 v6, 57, v255
    v_lshrrev_b32 v6, 9, v6
    v_mul_u32_u24 v5, 9, v6
    v_sub_u32 v5, v255, v5
    v_cmp_gt_u32 s[40:41], 8, v5
    v_lshlrev_b32 v5, 4, v5
    v_lshl_add_u32 v83, v6, 8, v5
    s_and_b32 s56, s3, 3
    s_mul_i32 s42, s56, 1792
    s_mul_i32 s43, s56, 1008
    s_lshl_b32 s38, s36, 7
    s_add_u32 s42, s42, s38
    s_bitset0_b32 s41, 31
    s_waitcnt lgkmcnt(0)

    s_mov_b32 s16, s4
    s_and_b32 s17, s5, 0xffff
    s_mov_b32 s18, 6553600
    s_mov_b32 s19, 0x00020000
    s_mov_b32 s20, s6
    s_and_b32 s21, s7, 0xffff
    s_mov_b32 s22, 256000
    s_mov_b32 s23, 0x00020000
    s_mov_b32 s24, s8
    s_and_b32 s25, s9, 0xffff
    s_mov_b32 s26, 20000
    s_mov_b32 s27, 0x00020000
    s_mov_b32 s28, s10
    s_and_b32 s29, s11, 0xffff
    s_mov_b32 s30, 13107200
    s_mov_b32 s31, 0x00020000
    s_mov_b32 s32, s12
    s_and_b32 s33, s13, 0xffff
    s_mov_b32 s34, 268435456
    s_mov_b32 s35, 0x00020000
    s_mov_b32 s12, s12
    s_and_b32 s13, s13, 0xffff
    s_mov_b32 s14, 268435456
    s_mov_b32 s15, 0x00020000
    s_mov_b32 s52, s52
    s_and_b32 s53, s53, 0xffff
    s_mov_b32 s54, 256
    s_mov_b32 s55, 0x00020000

    s_mov_b32 s50, s36
    s_lshr_b32 s44, s2, 4
    s_lshl_b32 s44, s44, 6
    s_and_b32 s45, s2, 12
    s_add_u32 s44, s44, s45
    s_add_u32 s60, s60, s44
    s_addc_u32 s61, s61, 0
    s_add_u32 s10, s62, s44
    s_addc_u32 s11, s63, 0

    s_cmp_ge_u32 s3, 4
    s_cbranch_scc1 standalone__deep_cross_pnn__recsys_kernel_aux

    s_setprio 3
    s_lshl_b32 s38, s3, 10
    s_add_u32 m0, s38, 144144
    v_and_b32 v5, 15, v255

    buffer_load_dwordx4 v254, s[24:27], s38 offen lds
    s_add_u32 m0, m0, 4096
    s_add_u32 s38, s38, 4096
    buffer_load_dwordx4 v254, s[24:27], s38 offen lds
    s_add_u32 m0, m0, 4096
    s_add_u32 s38, s38, 4096
    buffer_load_dwordx4 v254, s[24:27], s38 offen lds
    s_add_u32 m0, m0, 4096
    s_add_u32 s38, s38, 4096
    buffer_load_dwordx4 v254, s[24:27], s38 offen lds
    s_add_u32 m0, m0, 4096
    s_add_u32 s38, s38, 4096
    s_cmp_eq_u32 s3, 3
    s_cselect_b32 s45, 1024, 0
    s_sub_u32 m0, m0, s45
    s_sub_u32 s38, s38, s45
    buffer_load_dwordx4 v254, s[24:27], s38 offen lds

    v_lshrrev_b32 v6, 4, v255
    v_and_b32 v8, 3, v255
    v_bfe_u32 v7, v255, 2, 2
    v_mul_u32_u24 v245, 24, v5
    s_movk_i32 s45, 400
    v_lshlrev_b32 v246, 2, v7
    v_mad_u32_u24 v246, v8, s45, v246
    s_lshl_b32 s72, s37, 7
    s_lshl_b32 s73, s3, 5
    s_add_u32 s72, s72, s73
    s_mul_i32 s74, s72, 400
    s_add_u32 s58, s74, 12800
    s_mov_b32 s18, s58
    v_mul_u32_u24 v184, 12, v5
    s_movk_i32 s45, 200
    v_mad_u32_u24 v185, v6, s45, v184
    v_lshlrev_b32 v186, 1, v7
    v_mad_u32_u24 v186, v6, s45, v186
    v_mov_b32 v90, 0
    s_movk_i32 s45, 19200

    buffer_load_dwordx3 v[188:190], v185, s[24:27], s45 offen
    buffer_load_short_d16_hi v90, v186, s[24:27], s45 offen offset:192
    buffer_load_dwordx4 v[192:195], v245, s[16:19], s74 offen
    buffer_load_dwordx2 v[196:197], v245, s[16:19], s74 offen offset:16
    buffer_load_dword v198, v246, s[16:19], s74 offen offset:384
    buffer_load_dwordx4 v[218:221], v245, s[16:19], s74 offen offset:400
    buffer_load_dwordx2 v[222:223], v245, s[16:19], s74 offen offset:416
    buffer_load_dwordx4 v[224:227], v245, s[16:19], s74 offen offset:800
    buffer_load_dwordx2 v[228:229], v245, s[16:19], s74 offen offset:816
    buffer_load_dwordx4 v[230:233], v245, s[16:19], s74 offen offset:1200
    buffer_load_dwordx2 v[234:235], v245, s[16:19], s74 offen offset:1216
    buffer_load_dwordx4 v[212:215], v245, s[16:19], s74 offen offset:1600
    buffer_load_dwordx2 v[216:217], v245, s[16:19], s74 offen offset:1616
    buffer_load_dword v236, v246, s[16:19], s74 offen offset:1984
    s_load_dword s24, s[60:61], 0
    s_load_dword s25, s[60:61], 16
    s_load_dword s26, s[60:61], 32
    s_load_dword s27, s[60:61], 48
    s_load_dword s28, s[10:11], 0
    s_load_dword s29, s[10:11], 16
    s_load_dword s30, s[10:11], 32
    s_load_dword s31, s[10:11], 48

    v_add_u32 v40, -1, v5
    v_cmp_gt_u32 s[46:47], 8, v40
    s_lshl_b32 s76, s36, 14
    s_add_u32 s76, s76, s72
    s_lshl_b32 s76, s76, 2
    s_add_u32 s76, s76, 29360128
    v_lshlrev_b32 v40, 4, v40
    v_lshrrev_b32 v41, 5, v255
    v_lshl_add_u32 v40, v41, 2, v40
    v_bfe_u32 v41, v255, 4, 1
    v_lshl_add_u32 v94, v41, 3, v40
    s_lshl_b32 s45, s3, 7
    s_add_u32 s45, s45, 512
    s_min_u32 s45, s45, 880
    s_mul_i32 s44, s45, 144
    v_mul_u32_u24 v95, 144, v5
    v_lshl_add_u32 v95, v6, 4, v95
    v_add_u32 v95, s44, v95
    s_xor_b32 s44, s36, 1
    s_lshl_b32 s44, s44, 10
    s_add_u32 s44, s44, s45
    s_lshl_b32 s44, s44, 7
    s_add_u32 s44, s44, 15204352
    s_mov_b32 s64, 0x40000000
    v_add_u32 v184, 144144, v184
    s_movk_i32 s45, 4800
    v_mad_u32_u24 v184, v6, s45, v184
    v_mul_u32_u24 v186, 1200, v5
    v_add_u32 v186, 144144, v186
    v_mad_u32_u24 v185, v6, 48, v186
    v_lshl_add_u32 v186, v6, 1, v186
    v_and_b32 v244, 48, v255
    s_movk_i32 s57, 144
    v_cmp_eq_u32 s[60:61], 0, v8
    v_cmp_eq_u32 s[62:63], 1, v8
    v_cmp_eq_u32 s[66:67], 2, v8
    v_cmp_eq_u32 s[68:69], 3, v8
    s_mov_b32 s70, 0x00010001
    s_mov_b32 s71, 0x00010001

    s_lshr_b32 s79, s2, 1
    s_mul_i32 s77, s79, 102656
    s_lshl_b32 s85, s50, 11
    s_xor_b32 s78, s85, 2048
    s_add_u32 s78, s78, s77
    s_add_u32 s77, s77, s85
    s_and_b32 s79, s2, 1
    s_mul_i32 s79, s79, 1638400
    s_add_u32 s79, s79, 16777216
    s_lshl_b32 s85, s3, 13
    s_add_u32 s79, s79, s85
    s_xor_b32 s85, s3, 4
    s_lshl_b32 s85, s85, 10
    s_min_u32 s85, s85, 7040
    v_mov_b32 v0, 0
    v_mov_b32 v1, 0
    v_mov_b32 v2, 0
    v_mov_b32 v3, 0
    v_mov_b32 v4, 0
    v_mov_b32 v5, 0
    v_mov_b32 v6, 0
    v_mov_b32 v7, 0
    v_mov_b32 v8, 0
    v_mov_b32 v9, 0
    v_mov_b32 v10, 0
    v_mov_b32 v11, 0
    v_mov_b32 v12, 0
    v_mov_b32 v13, 0
    v_mov_b32 v14, 0
    v_mov_b32 v15, 0
    v_mov_b32 v16, 0
    v_mov_b32 v17, 0
    v_mov_b32 v18, 0
    v_mov_b32 v19, 0
    v_mov_b32 v20, 0
    v_mov_b32 v21, 0
    v_mov_b32 v22, 0
    v_mov_b32 v23, 0
    v_mov_b32 v24, 0
    v_mov_b32 v25, 0
    v_mov_b32 v26, 0
    v_mov_b32 v27, 0
    v_mov_b32 v28, 0
    v_mov_b32 v29, 0
    v_mov_b32 v30, 0
    v_mov_b32 v31, 0
    v_mov_b32 v32, 0
    v_mov_b32 v33, 0
    v_mov_b32 v34, 0
    v_mov_b32 v35, 0
    v_mov_b32 v36, 0
    v_mov_b32 v37, 0
    v_mov_b32 v38, 0
    v_mov_b32 v39, 0
    v_mov_b32 v40, 0
    v_mov_b32 v41, 0
    v_mov_b32 v42, 0
    v_mov_b32 v43, 0
    v_mov_b32 v44, 0
    v_mov_b32 v45, 0
    v_mov_b32 v46, 0
    v_mov_b32 v47, 0
    v_mov_b32 v48, 0
    v_mov_b32 v49, 0
    v_mov_b32 v50, 0
    v_mov_b32 v51, 0
    v_mov_b32 v52, 0
    v_mov_b32 v53, 0
    v_mov_b32 v54, 0
    v_mov_b32 v55, 0
    v_mov_b32 v56, 0
    v_mov_b32 v57, 0
    v_mov_b32 v58, 0
    v_mov_b32 v59, 0
    v_mov_b32 v60, 0
    v_mov_b32 v61, 0
    v_mov_b32 v62, 0
    v_mov_b32 v63, 0
    v_mov_b32 v64, 0
    v_mov_b32 v65, 0
    v_mov_b32 v66, 0
    v_mov_b32 v67, 0
    v_mov_b32 v68, 0
    v_mov_b32 v69, 0
    v_mov_b32 v70, 0
    v_mov_b32 v71, 0
    v_mov_b32 v72, 0
    v_mov_b32 v73, 0
    v_mov_b32 v74, 0
    v_mov_b32 v75, 0
    v_mov_b32 v76, 0
    v_mov_b32 v77, 0
    v_mov_b32 v78, 0
    v_mov_b32 v79, 0
    v_mov_b32 v80, 0
    v_mov_b32 v81, 0
    v_mov_b32 v82, 0
    v_mov_b32 v83, 0
    v_mov_b32 v84, 0
    v_mov_b32 v85, 0
    v_mov_b32 v86, 0
    v_mov_b32 v87, 0
    v_mov_b32 v88, 0
    v_mov_b32 v89, 0
    s_waitcnt vmcnt(14)
    s_barrier
    ds_read_b64 v[96:97], v185 offset:200
    ds_read_b64 v[98:99], v185 offset:208
    ds_read_b64 v[100:101], v185 offset:224
    ds_read_b64 v[102:103], v185 offset:232
    ds_read_b64 v[104:105], v185 offset:400
    ds_read_b64 v[106:107], v185 offset:408
    ds_read_b64 v[108:109], v185 offset:424
    ds_read_b64 v[110:111], v185 offset:432
    ds_read_b64 v[112:113], v185 offset:600
    ds_read_b64 v[114:115], v185 offset:608
    ds_read_b64 v[116:117], v185 offset:616
    ds_read_b64 v[118:119], v185 offset:624
    ds_read_b64 v[120:121], v185 offset:632
    ds_read_b64 v[122:123], v185 offset:640
    ds_read_b64 v[124:125], v185 offset:800
    ds_read_b64 v[126:127], v185 offset:808
    ds_read_b64 v[128:129], v185 offset:816
    ds_read_b64 v[130:131], v185 offset:824
    ds_read_b64 v[132:133], v185 offset:832
    ds_read_b64 v[134:135], v185 offset:840
    ds_read_b64 v[136:137], v185 offset:1000
    ds_read_b64 v[138:139], v185 offset:1008
    ds_read_b64 v[140:141], v185 offset:1016
    ds_read_b64 v[142:143], v185 offset:1024
    ds_read_b64 v[144:145], v185 offset:1032
    ds_read_b64 v[146:147], v185 offset:1040
    ds_read_u16_d16_hi v84, v186 offset:192
    ds_read_u16_d16_hi v85, v186 offset:392
    ds_read_u16_d16_hi v86, v186 offset:592
    ds_read_u16_d16_hi v87, v186 offset:792
    ds_read_u16_d16_hi v88, v186 offset:992
    ds_read_u16_d16_hi v89, v186 offset:1192
    ds_read_u16_d16_hi v4, v184 offset:2
    ds_read_u16_d16_hi v5, v184 offset:1202
    ds_read_u16_d16_hi v6, v184 offset:2402
    ds_read_u16_d16_hi v7, v184 offset:3602
    ds_read_u16_d16_hi v8, v184 offset:4
    ds_read_u16_d16_hi v9, v184 offset:1204
    ds_read_u16_d16_hi v10, v184 offset:2404
    ds_read_u16_d16_hi v11, v184 offset:3604
    ds_read_u16_d16_hi v12, v184 offset:6
    ds_read_u16_d16_hi v13, v184 offset:1206
    ds_read_u16_d16_hi v14, v184 offset:2406
    ds_read_u16_d16_hi v15, v184 offset:3606
    ds_read_u16_d16_hi v16, v184 offset:8
    ds_read_u16_d16_hi v17, v184 offset:1208
    ds_read_u16_d16_hi v18, v184 offset:2408
    ds_read_u16_d16_hi v19, v184 offset:3608
    ds_read_u16_d16_hi v20, v184 offset:10
    ds_read_u16_d16_hi v21, v184 offset:1210
    ds_read_u16_d16_hi v22, v184 offset:2410
    ds_read_u16_d16_hi v23, v184 offset:3610
    ds_read_u16_d16_hi v28, v184 offset:204
    ds_read_u16_d16_hi v29, v184 offset:1404
    ds_read_u16_d16_hi v30, v184 offset:2604
    ds_read_u16_d16_hi v31, v184 offset:3804
    ds_read_u16_d16_hi v32, v184 offset:206
    ds_read_u16_d16_hi v33, v184 offset:1406
    ds_read_u16_d16_hi v34, v184 offset:2606
    ds_read_u16_d16_hi v35, v184 offset:3806
    ds_read_u16_d16_hi v36, v184 offset:208
    ds_read_u16_d16_hi v37, v184 offset:1408
    ds_read_u16_d16_hi v38, v184 offset:2608
    ds_read_u16_d16_hi v39, v184 offset:3808
    ds_read_u16_d16_hi v40, v184 offset:210
    ds_read_u16_d16_hi v41, v184 offset:1410
    ds_read_u16_d16_hi v42, v184 offset:2610
    ds_read_u16_d16_hi v43, v184 offset:3810
    ds_read_u16_d16_hi v48, v184 offset:406
    ds_read_u16_d16_hi v49, v184 offset:1606
    ds_read_u16_d16_hi v50, v184 offset:2806
    ds_read_u16_d16_hi v51, v184 offset:4006
    ds_read_u16_d16_hi v52, v184 offset:408
    ds_read_u16_d16_hi v53, v184 offset:1608
    ds_read_u16_d16_hi v54, v184 offset:2808
    ds_read_u16_d16_hi v55, v184 offset:4008
    ds_read_u16_d16_hi v56, v184 offset:410
    ds_read_u16_d16_hi v57, v184 offset:1610
    ds_read_u16_d16_hi v58, v184 offset:2810
    ds_read_u16_d16_hi v59, v184 offset:4010
    ds_read_u16_d16_hi v64, v184 offset:608
    ds_read_u16_d16_hi v65, v184 offset:1808
    ds_read_u16_d16_hi v66, v184 offset:3008
    ds_read_u16_d16_hi v67, v184 offset:4208
    ds_read_u16_d16_hi v68, v184 offset:610
    ds_read_u16_d16_hi v69, v184 offset:1810
    ds_read_u16_d16_hi v70, v184 offset:3010
    ds_read_u16_d16_hi v71, v184 offset:4210
    ds_read_u16_d16_hi v76, v184 offset:810
    ds_read_u16_d16_hi v77, v184 offset:2010
    ds_read_u16_d16_hi v78, v184 offset:3210
    ds_read_u16_d16_hi v79, v184 offset:4410
    ds_read_u16_d16_hi v0, v184 offset:0
    ds_read_u16_d16_hi v1, v184 offset:1200
    ds_read_u16_d16_hi v2, v184 offset:2400
    ds_read_u16_d16_hi v3, v184 offset:3600
    ds_read_u16_d16_hi v24, v184 offset:202
    ds_read_u16_d16_hi v25, v184 offset:1402
    ds_read_u16_d16_hi v26, v184 offset:2602
    ds_read_u16_d16_hi v27, v184 offset:3802
    ds_read_u16_d16_hi v44, v184 offset:404
    ds_read_u16_d16_hi v45, v184 offset:1604
    ds_read_u16_d16_hi v46, v184 offset:2804
    ds_read_u16_d16_hi v47, v184 offset:4004
    ds_read_u16_d16_hi v60, v184 offset:606
    ds_read_u16_d16_hi v61, v184 offset:1806
    ds_read_u16_d16_hi v62, v184 offset:3006
    ds_read_u16_d16_hi v63, v184 offset:4206
    ds_read_u16_d16_hi v72, v184 offset:808
    ds_read_u16_d16_hi v73, v184 offset:2008
    ds_read_u16_d16_hi v74, v184 offset:3208
    ds_read_u16_d16_hi v75, v184 offset:4408
    ds_read_u16_d16_hi v80, v184 offset:1010
    ds_read_u16_d16_hi v81, v184 offset:2210
    ds_read_u16_d16_hi v82, v184 offset:3410
    ds_read_u16_d16_hi v83, v184 offset:4610
    s_waitcnt vmcnt(9) lgkmcnt(15)
    v_lshlrev_b32 v200, 16, v96
    v_add_f32 v4, v4, v200
    v_lshlrev_b32 v201, 16, v99
    v_add_f32 v5, v5, v201
    v_lshlrev_b32 v200, 16, v100
    v_add_f32 v6, v6, v200
    v_lshlrev_b32 v201, 16, v103
    v_add_f32 v7, v7, v201
    v_lshlrev_b32 v200, 16, v104
    v_add_f32 v8, v8, v200
    v_lshlrev_b32 v201, 16, v107
    v_add_f32 v9, v9, v201
    v_lshlrev_b32 v200, 16, v108
    v_add_f32 v10, v10, v200
    v_lshlrev_b32 v201, 16, v111
    v_add_f32 v11, v11, v201
    v_lshlrev_b32 v200, 16, v112
    v_add_f32 v12, v12, v200
    v_lshlrev_b32 v201, 16, v115
    v_add_f32 v13, v13, v201
    v_lshlrev_b32 v200, 16, v118
    v_add_f32 v14, v14, v200
    v_lshlrev_b32 v201, 16, v121
    v_add_f32 v15, v15, v201
    v_lshlrev_b32 v200, 16, v124
    v_add_f32 v16, v16, v200
    v_lshlrev_b32 v201, 16, v127
    v_add_f32 v17, v17, v201
    v_lshlrev_b32 v200, 16, v130
    v_add_f32 v18, v18, v200
    v_lshlrev_b32 v201, 16, v133
    v_add_f32 v19, v19, v201
    v_lshlrev_b32 v200, 16, v136
    v_add_f32 v20, v20, v200
    v_lshlrev_b32 v201, 16, v139
    v_add_f32 v21, v21, v201
    v_lshlrev_b32 v200, 16, v142
    v_add_f32 v22, v22, v200
    v_lshlrev_b32 v201, 16, v145
    v_add_f32 v23, v23, v201
    v_and_b32 v200, 0xffff0000, v104
    v_add_f32 v28, v28, v200
    v_and_b32 v201, 0xffff0000, v107
    v_add_f32 v29, v29, v201
    v_and_b32 v200, 0xffff0000, v108
    v_add_f32 v30, v30, v200
    v_and_b32 v201, 0xffff0000, v111
    v_add_f32 v31, v31, v201
    v_and_b32 v200, 0xffff0000, v112
    v_add_f32 v32, v32, v200
    v_and_b32 v201, 0xffff0000, v115
    v_add_f32 v33, v33, v201
    v_and_b32 v200, 0xffff0000, v118
    v_add_f32 v34, v34, v200
    v_and_b32 v201, 0xffff0000, v121
    v_add_f32 v35, v35, v201
    v_and_b32 v200, 0xffff0000, v124
    v_add_f32 v36, v36, v200
    v_and_b32 v201, 0xffff0000, v127
    v_add_f32 v37, v37, v201
    v_and_b32 v200, 0xffff0000, v130
    v_add_f32 v38, v38, v200
    v_and_b32 v201, 0xffff0000, v133
    v_add_f32 v39, v39, v201
    v_and_b32 v200, 0xffff0000, v136
    v_add_f32 v40, v40, v200
    v_and_b32 v201, 0xffff0000, v139
    v_add_f32 v41, v41, v201
    v_and_b32 v200, 0xffff0000, v142
    v_add_f32 v42, v42, v200
    v_and_b32 v201, 0xffff0000, v145
    v_add_f32 v43, v43, v201
    v_lshlrev_b32 v200, 16, v113
    v_add_f32 v48, v48, v200
    v_lshlrev_b32 v201, 16, v116
    v_add_f32 v49, v49, v201
    v_lshlrev_b32 v200, 16, v119
    v_add_f32 v50, v50, v200
    v_lshlrev_b32 v201, 16, v122
    v_add_f32 v51, v51, v201
    v_lshlrev_b32 v200, 16, v125
    v_add_f32 v52, v52, v200
    v_lshlrev_b32 v201, 16, v128
    v_add_f32 v53, v53, v201
    v_lshlrev_b32 v200, 16, v131
    v_add_f32 v54, v54, v200
    v_lshlrev_b32 v201, 16, v134
    v_add_f32 v55, v55, v201
    v_lshlrev_b32 v200, 16, v137
    v_add_f32 v56, v56, v200
    v_lshlrev_b32 v201, 16, v140
    v_add_f32 v57, v57, v201
    v_lshlrev_b32 v200, 16, v143
    v_add_f32 v58, v58, v200
    v_lshlrev_b32 v201, 16, v146
    v_add_f32 v59, v59, v201
    v_and_b32 v200, 0xffff0000, v125
    v_add_f32 v64, v64, v200
    v_and_b32 v201, 0xffff0000, v128
    v_add_f32 v65, v65, v201
    v_and_b32 v200, 0xffff0000, v131
    v_add_f32 v66, v66, v200
    v_and_b32 v201, 0xffff0000, v134
    v_add_f32 v67, v67, v201
    v_and_b32 v200, 0xffff0000, v137
    v_add_f32 v68, v68, v200
    v_and_b32 v201, 0xffff0000, v140
    v_add_f32 v69, v69, v201
    v_and_b32 v200, 0xffff0000, v143
    v_add_f32 v70, v70, v200
    v_and_b32 v201, 0xffff0000, v146
    v_add_f32 v71, v71, v201
    v_lshlrev_b32 v200, 16, v138
    v_add_f32 v76, v76, v200
    v_lshlrev_b32 v201, 16, v141
    v_add_f32 v77, v77, v201
    v_lshlrev_b32 v200, 16, v144
    v_add_f32 v78, v78, v200
    v_lshlrev_b32 v201, 16, v147
    v_add_f32 v79, v79, v201
    v_lshlrev_b32 v200, 16, v188
    v_add_f32 v84, v84, v200
    v_and_b32 v201, 0xffff0000, v188
    v_add_f32 v85, v85, v201
    v_lshlrev_b32 v200, 16, v189
    v_add_f32 v86, v86, v200
    v_and_b32 v201, 0xffff0000, v189
    v_add_f32 v87, v87, v201
    v_lshlrev_b32 v200, 16, v190
    v_add_f32 v88, v88, v200
    v_and_b32 v201, 0xffff0000, v190
    v_add_f32 v89, v89, v201
    v_mad_u32_u24 v192, v192, s57, v244
    v_mad_u32_u24 v193, v193, s57, v244
    v_mad_u32_u24 v194, v194, s57, v244
    v_mad_u32_u24 v195, v195, s57, v244
    v_mad_u32_u24 v196, v196, s57, v244
    v_mad_u32_u24 v197, v197, s57, v244
    v_mad_u32_u24 v198, v198, s57, v244
    v_cndmask_b32 v93, 0, v90, s[68:69]
    v_cndmask_b32 v92, 0, v90, s[66:67]
    v_cndmask_b32 v91, 0, v90, s[62:63]
    v_cndmask_b32 v90, 0, v90, s[60:61]
    s_waitcnt lgkmcnt(0)
    s_bitcmp1_b32 s2, 1
    s_cselect_b32 s83, 0, 16
    s_lshl_b32 s80, s24, s83
    s_lshl_b32 s81, s25, s83
    s_lshl_b32 s82, s26, s83
    s_lshl_b32 s83, s27, s83
    s_and_b32 s80, s80, 0xffff0000
    s_and_b32 s81, s81, 0xffff0000
    s_and_b32 s82, s82, 0xffff0000
    s_and_b32 s83, s83, 0xffff0000
    s_barrier
    s_setprio 0
    ds_read_b128 v[96:99], v192 offset:0
    ds_read_b128 v[100:103], v192 offset:64
    ds_read_b128 v[104:107], v193 offset:0
    ds_read_b128 v[108:111], v193 offset:64
    ds_read_b128 v[112:115], v194 offset:0
    ds_read_b128 v[116:119], v194 offset:64
    ds_read_b128 v[128:131], v195 offset:0
    ds_read_b128 v[132:135], v195 offset:64
    ds_read_b128 v[144:147], v196 offset:0
    ds_read_b128 v[148:151], v196 offset:64
    ds_read_b128 v[160:163], v197 offset:0
    ds_read_b128 v[164:167], v197 offset:64
    ds_read_b128 v[176:179], v198 offset:0
    ds_read_b128 v[180:183], v198 offset:64
    s_waitcnt vmcnt(7) lgkmcnt(0)
standalone__deep_cross_pnn__recsys_kernel_loop:
    v_mfma_f32_16x16x32_bf16 v[184:187], v[96:99], v[96:99], 0
    v_fmac_f32 v240, v188, v64
    v_fmac_f32 v240, v189, v65
    v_mfma_f32_16x16x32_bf16 v[184:187], v[100:103], v[100:103], v[184:187]
    v_fmac_f32 v240, v190, v66
    v_fmac_f32 v240, v191, v67
    v_mfma_f32_16x16x32_bf16 v[188:191], v[96:99], v[104:107], 0
    v_fmac_f32 v240, v192, v68
    v_fmac_f32 v240, v193, v69
    v_fmac_f32 v240, v194, v70
    v_fmac_f32 v240, v195, v71
    v_mad_u32_u24 v220, v220, s57, v244
    v_mfma_f32_16x16x32_bf16 v[188:191], v[100:103], v[108:111], v[188:191]
    ds_read_b128 v[120:123], v220 offset:0
    ds_read_b128 v[124:127], v220 offset:64
    v_mfma_f32_16x16x32_bf16 v[192:195], v[96:99], v[112:115], 0
    v_fmac_f32 v240, v196, v72
    v_fmac_f32 v240, v197, v73
    v_mfma_f32_16x16x32_bf16 v[192:195], v[100:103], v[116:119], v[192:195]
    v_fmac_f32 v240, v198, v74
    v_fmac_f32 v240, v199, v75
    v_mfma_f32_16x16x32_bf16 v[196:199], v[176:179], v[96:99], 0
    v_fmac_f32 v240, v200, v76
    v_fmac_f32 v240, v201, v77
    v_mfma_f32_16x16x32_bf16 v[196:199], v[180:183], v[100:103], v[196:199]
    v_fmac_f32 v240, v202, v78
    v_fmac_f32 v240, v203, v79
    v_mad_u32_u24 v221, v221, s57, v244
    v_mfma_f32_16x16x32_bf16 v[200:203], v[96:99], v[128:131], 0
    ds_read_b128 v[136:139], v221 offset:0
    ds_read_b128 v[140:143], v221 offset:64
    v_mfma_f32_16x16x32_bf16 v[200:203], v[100:103], v[132:135], v[200:203]
    v_fmac_f32 v240, v204, v80
    v_fmac_f32 v240, v205, v81
    v_fmac_f32 v240, v206, v82
    v_fmac_f32 v240, v207, v83
    v_mfma_f32_16x16x32_bf16 v[204:207], v[96:99], v[144:147], 0
    v_mad_u32_u24 v218, v218, s57, v244
    v_mul_f32 v237, v184, v0
    v_mfma_f32_16x16x32_bf16 v[204:207], v[100:103], v[148:151], v[204:207]
    v_fmac_f32 v237, v185, v1
    v_fmac_f32 v237, v186, v2
    v_mfma_f32_16x16x32_bf16 v[208:211], v[96:99], v[160:163], 0
    v_fmac_f32 v237, v187, v3
    v_fmac_f32 v237, v188, v4
    v_mfma_f32_16x16x32_bf16 v[208:211], v[100:103], v[164:167], v[208:211]
    ds_read_b128 v[96:99], v218 offset:0
    ds_read_b128 v[100:103], v218 offset:64
    v_mfma_f32_16x16x32_bf16 v[184:187], v[104:107], v[104:107], 0
    v_fmac_f32 v237, v189, v5
    v_fmac_f32 v237, v190, v6
    v_mfma_f32_16x16x32_bf16 v[184:187], v[108:111], v[108:111], v[184:187]
    v_fmac_f32 v237, v191, v7
    v_fmac_f32 v237, v192, v8
    v_mfma_f32_16x16x32_bf16 v[188:191], v[104:107], v[112:115], 0
    v_fmac_f32 v237, v193, v9
    v_fmac_f32 v237, v194, v10
    v_mfma_f32_16x16x32_bf16 v[188:191], v[108:111], v[116:119], v[188:191]
    v_fmac_f32 v237, v195, v11
    v_mad_u32_u24 v222, v222, s57, v244
    v_mfma_f32_16x16x32_bf16 v[192:195], v[176:179], v[104:107], 0
    v_fmac_f32 v237, v196, v84
    v_fmac_f32 v237, v200, v12
    v_mfma_f32_16x16x32_bf16 v[192:195], v[180:183], v[108:111], v[192:195]
    ds_read_b128 v[152:155], v222 offset:0
    ds_read_b128 v[156:159], v222 offset:64
    v_mfma_f32_16x16x32_bf16 v[196:199], v[104:107], v[128:131], 0
    v_fmac_f32 v237, v201, v13
    v_fmac_f32 v237, v202, v14
    v_mfma_f32_16x16x32_bf16 v[196:199], v[108:111], v[132:135], v[196:199]
    v_fmac_f32 v237, v203, v15
    v_fmac_f32 v237, v204, v16
    v_mfma_f32_16x16x32_bf16 v[200:203], v[104:107], v[144:147], 0
    v_fmac_f32 v237, v205, v17
    v_fmac_f32 v237, v206, v18
    v_mfma_f32_16x16x32_bf16 v[200:203], v[108:111], v[148:151], v[200:203]
    v_fmac_f32 v237, v207, v19
    v_mad_u32_u24 v219, v219, s57, v244
    v_mfma_f32_16x16x32_bf16 v[204:207], v[104:107], v[160:163], 0
    v_fmac_f32 v237, v208, v20
    v_fmac_f32 v237, v209, v21
    v_fmac_f32 v237, v210, v22
    v_fmac_f32 v237, v211, v23
    v_mfma_f32_16x16x32_bf16 v[204:207], v[108:111], v[164:167], v[204:207]
    ds_read_b128 v[104:107], v219 offset:0
    ds_read_b128 v[108:111], v219 offset:64
    v_mfma_f32_16x16x32_bf16 v[208:211], v[112:115], v[112:115], 0
    v_fmac_f32 v237, v184, v24
    v_fmac_f32 v237, v185, v25
    v_mfma_f32_16x16x32_bf16 v[208:211], v[116:119], v[116:119], v[208:211]
    v_fmac_f32 v237, v186, v26
    v_fmac_f32 v237, v187, v27
    v_mfma_f32_16x16x32_bf16 v[184:187], v[176:179], v[112:115], 0
    v_fmac_f32 v237, v188, v28
    v_fmac_f32 v237, v189, v29
    v_mfma_f32_16x16x32_bf16 v[184:187], v[180:183], v[116:119], v[184:187]
    v_fmac_f32 v237, v190, v30
    v_fmac_f32 v237, v191, v31
    v_mfma_f32_16x16x32_bf16 v[188:191], v[112:115], v[128:131], 0
    v_permlane32_swap_b32 v239, v240
    v_mad_u32_u24 v223, v223, s57, v244
    v_fmac_f32 v237, v192, v85
    v_mfma_f32_16x16x32_bf16 v[188:191], v[116:119], v[132:135], v[188:191]
    ds_read_b128 v[168:171], v223 offset:0
    ds_read_b128 v[172:175], v223 offset:64
    v_mfma_f32_16x16x32_bf16 v[192:195], v[112:115], v[144:147], 0
    v_add_f32 v242, v239, v240
    v_fmac_f32 v237, v196, v32
    v_fmac_f32 v237, v197, v33
    v_fmac_f32 v237, v198, v34
    v_fmac_f32 v237, v199, v35
    v_mfma_f32_16x16x32_bf16 v[192:195], v[116:119], v[148:151], v[192:195]
    buffer_load_dwordx4 v[218:221], v245, s[16:19], s74 offen offset:2000
    buffer_load_dwordx2 v[222:223], v245, s[16:19], s74 offen offset:2016
    v_mfma_f32_16x16x32_bf16 v[196:199], v[176:179], v[128:131], 0
    v_permlane16_swap_b32 v241, v242
    v_mfma_f32_16x16x32_bf16 v[196:199], v[180:183], v[132:135], v[196:199]
    v_fmac_f32 v237, v200, v36
    v_fmac_f32 v237, v201, v37
    v_fmac_f32 v237, v202, v38
    v_fmac_f32 v237, v203, v39
    v_mfma_f32_16x16x32_bf16 v[200:203], v[112:115], v[160:163], 0
    v_add_f32 v241, v241, v242
    v_fmac_f32 v237, v204, v40
    v_mfma_f32_16x16x32_bf16 v[200:203], v[116:119], v[164:167], v[200:203]
    v_fmac_f32 v237, v205, v41
    v_fmac_f32 v237, v206, v42
    v_fmac_f32 v237, v207, v43
    v_mfma_f32_16x16x32_bf16 v[204:207], v[128:131], v[128:131], 0
    v_add_f32_dpp v241, v241, v241 row_ror:8 row_mask:0xf bank_mask:0xf
    v_fmac_f32 v237, v208, v44
    v_mfma_f32_16x16x32_bf16 v[204:207], v[132:135], v[132:135], v[204:207]
    v_fmac_f32 v237, v209, v45
    v_fmac_f32 v237, v210, v46
    v_fmac_f32 v237, v211, v47
    v_mfma_f32_16x16x32_bf16 v[208:211], v[176:179], v[144:147], 0
    v_add_f32_dpp v241, v241, v241 row_ror:4 row_mask:0xf bank_mask:0xf
    v_fmac_f32 v237, v184, v86
    v_mfma_f32_16x16x32_bf16 v[208:211], v[180:183], v[148:151], v[208:211]
    v_fmac_f32 v237, v188, v48
    v_fmac_f32 v237, v189, v49
    v_mfma_f32_16x16x32_bf16 v[184:187], v[128:131], v[144:147], 0
    v_add_f32_dpp v241, v241, v241 row_ror:2 row_mask:0xf bank_mask:0xf
    v_fmac_f32 v237, v190, v50
    v_mfma_f32_16x16x32_bf16 v[184:187], v[132:135], v[148:151], v[184:187]
    v_fmac_f32 v237, v191, v51
    v_fmac_f32 v237, v192, v52
    v_mfma_f32_16x16x32_bf16 v[188:191], v[128:131], v[160:163], 0
    v_add_f32_dpp v241, v241, v241 row_ror:1 row_mask:0xf bank_mask:0xf
    v_fmac_f32 v237, v193, v53
    v_mfma_f32_16x16x32_bf16 v[188:191], v[132:135], v[164:167], v[188:191]
    v_fmac_f32 v237, v194, v54
    v_fmac_f32 v237, v195, v55
    v_mfma_f32_16x16x32_bf16 v[192:195], v[176:179], v[160:163], 0
    v_cndmask_b32 v243, v243, v241, s[70:71]
    v_fmac_f32 v237, v196, v87
    v_mfma_f32_16x16x32_bf16 v[192:195], v[180:183], v[164:167], v[192:195]
    s_lshl_b64 s[70:71], s[70:71], 1
    v_fmac_f32 v237, v200, v56
    v_mfma_f32_16x16x32_bf16 v[196:199], v[144:147], v[144:147], 0
    v_fmac_f32 v237, v201, v57
    v_fmac_f32 v237, v202, v58
    v_mfma_f32_16x16x32_bf16 v[196:199], v[148:151], v[148:151], v[196:199]
    v_fmac_f32 v237, v203, v59
    v_fmac_f32 v237, v204, v60
    v_mfma_f32_16x16x32_bf16 v[200:203], v[144:147], v[160:163], 0
    v_fmac_f32 v237, v205, v61
    v_fmac_f32 v237, v206, v62
    v_mfma_f32_16x16x32_bf16 v[200:203], v[148:151], v[164:167], v[200:203]
    v_fmac_f32 v237, v207, v63
    v_fmac_f32 v237, v208, v88
    v_mfma_f32_16x16x32_bf16 v[204:207], v[160:163], v[160:163], 0
    v_fmac_f32 v237, v184, v64
    v_fmac_f32 v237, v185, v65
    v_mfma_f32_16x16x32_bf16 v[204:207], v[164:167], v[164:167], v[204:207]
    v_fmac_f32 v237, v186, v66
    s_waitcnt vmcnt(7) lgkmcnt(0)
    v_mfma_f32_16x16x32_bf16 v[208:211], v[96:99], v[96:99], 0
    v_fmac_f32 v237, v187, v67
    v_mad_u32_u24 v226, v226, s57, v244
    v_mfma_f32_16x16x32_bf16 v[208:211], v[100:103], v[100:103], v[208:211]
    v_fmac_f32 v237, v188, v68
    v_fmac_f32 v237, v189, v69
    v_mfma_f32_16x16x32_bf16 v[184:187], v[96:99], v[104:107], 0
    v_fmac_f32 v237, v190, v70
    v_fmac_f32 v237, v191, v71
    v_mfma_f32_16x16x32_bf16 v[184:187], v[100:103], v[108:111], v[184:187]
    ds_read_b128 v[112:115], v226 offset:0
    ds_read_b128 v[116:119], v226 offset:64
    v_mfma_f32_16x16x32_bf16 v[188:191], v[96:99], v[120:123], 0
    v_fmac_f32 v237, v192, v89
    v_mad_u32_u24 v227, v227, s57, v244
    v_mfma_f32_16x16x32_bf16 v[188:191], v[100:103], v[124:127], v[188:191]
    v_fmac_f32 v237, v196, v72
    v_fmac_f32 v237, v197, v73
    v_mfma_f32_16x16x32_bf16 v[192:195], v[176:179], v[96:99], 0
    v_fmac_f32 v237, v198, v74
    v_fmac_f32 v237, v199, v75
    v_mfma_f32_16x16x32_bf16 v[192:195], v[180:183], v[100:103], v[192:195]
    v_fmac_f32 v237, v200, v76
    v_fmac_f32 v237, v201, v77
    v_mfma_f32_16x16x32_bf16 v[196:199], v[96:99], v[136:139], 0
    ds_read_b128 v[128:131], v227 offset:0
    ds_read_b128 v[132:135], v227 offset:64
    v_mfma_f32_16x16x32_bf16 v[196:199], v[100:103], v[140:143], v[196:199]
    v_fmac_f32 v237, v202, v78
    v_fmac_f32 v237, v203, v79
    v_mfma_f32_16x16x32_bf16 v[200:203], v[96:99], v[152:155], 0
    v_fmac_f32 v237, v204, v80
    v_fmac_f32 v237, v205, v81
    v_mfma_f32_16x16x32_bf16 v[200:203], v[100:103], v[156:159], v[200:203]
    v_fmac_f32 v237, v206, v82
    v_fmac_f32 v237, v207, v83
    v_mfma_f32_16x16x32_bf16 v[204:207], v[96:99], v[168:171], 0
    v_mad_u32_u24 v224, v224, s57, v244
    v_mul_f32 v238, v208, v0
    v_fmac_f32 v238, v209, v1
    v_fmac_f32 v238, v210, v2
    v_fmac_f32 v238, v211, v3
    v_mfma_f32_16x16x32_bf16 v[204:207], v[100:103], v[172:175], v[204:207]
    ds_read_b128 v[96:99], v224 offset:0
    ds_read_b128 v[100:103], v224 offset:64
    v_mfma_f32_16x16x32_bf16 v[208:211], v[104:107], v[104:107], 0
    v_fmac_f32 v238, v184, v4
    v_fmac_f32 v238, v185, v5
    v_mfma_f32_16x16x32_bf16 v[208:211], v[108:111], v[108:111], v[208:211]
    v_fmac_f32 v238, v186, v6
    v_fmac_f32 v238, v187, v7
    v_mfma_f32_16x16x32_bf16 v[184:187], v[104:107], v[120:123], 0
    v_fmac_f32 v238, v188, v8
    v_fmac_f32 v238, v189, v9
    v_mfma_f32_16x16x32_bf16 v[184:187], v[108:111], v[124:127], v[184:187]
    v_fmac_f32 v238, v190, v10
    v_fmac_f32 v238, v191, v11
    v_mfma_f32_16x16x32_bf16 v[188:191], v[176:179], v[104:107], 0
    v_mad_u32_u24 v228, v228, s57, v244
    v_fmac_f32 v238, v193, v84
    v_mfma_f32_16x16x32_bf16 v[188:191], v[180:183], v[108:111], v[188:191]
    ds_read_b128 v[144:147], v228 offset:0
    ds_read_b128 v[148:151], v228 offset:64
    v_mfma_f32_16x16x32_bf16 v[192:195], v[104:107], v[136:139], 0
    v_fmac_f32 v238, v196, v12
    v_fmac_f32 v238, v197, v13
    v_mfma_f32_16x16x32_bf16 v[192:195], v[108:111], v[140:143], v[192:195]
    v_fmac_f32 v238, v198, v14
    v_fmac_f32 v238, v199, v15
    v_mfma_f32_16x16x32_bf16 v[196:199], v[104:107], v[152:155], 0
    v_fmac_f32 v238, v200, v16
    v_fmac_f32 v238, v201, v17
    v_mfma_f32_16x16x32_bf16 v[196:199], v[108:111], v[156:159], v[196:199]
    v_fmac_f32 v238, v202, v18
    v_fmac_f32 v238, v203, v19
    v_mfma_f32_16x16x32_bf16 v[200:203], v[104:107], v[168:171], 0
    v_mad_u32_u24 v225, v225, s57, v244
    v_fmac_f32 v238, v204, v20
    v_fmac_f32 v238, v205, v21
    v_fmac_f32 v238, v206, v22
    v_fmac_f32 v238, v207, v23
    v_mfma_f32_16x16x32_bf16 v[200:203], v[108:111], v[172:175], v[200:203]
    ds_read_b128 v[104:107], v225 offset:0
    ds_read_b128 v[108:111], v225 offset:64
    v_mfma_f32_16x16x32_bf16 v[204:207], v[120:123], v[120:123], 0
    v_fmac_f32 v238, v208, v24
    v_fmac_f32 v238, v209, v25
    v_mfma_f32_16x16x32_bf16 v[204:207], v[124:127], v[124:127], v[204:207]
    v_fmac_f32 v238, v210, v26
    v_fmac_f32 v238, v211, v27
    v_fmac_f32 v238, v184, v28
    v_fmac_f32 v238, v185, v29
    v_fmac_f32 v238, v186, v30
    v_fmac_f32 v238, v187, v31
    v_mfma_f32_16x16x32_bf16 v[184:187], v[176:179], v[120:123], 0
    v_fmac_f32 v238, v189, v85
    v_mad_u32_u24 v229, v229, s57, v244
    v_mfma_f32_16x16x32_bf16 v[184:187], v[180:183], v[124:127], v[184:187]
    v_fmac_f32 v238, v192, v32
    v_fmac_f32 v238, v193, v33
    v_mfma_f32_16x16x32_bf16 v[188:191], v[120:123], v[136:139], 0
    v_fmac_f32 v238, v194, v34
    v_fmac_f32 v238, v195, v35
    v_mfma_f32_16x16x32_bf16 v[188:191], v[124:127], v[140:143], v[188:191]
    ds_read_b128 v[160:163], v229 offset:0
    ds_read_b128 v[164:167], v229 offset:64
    v_mfma_f32_16x16x32_bf16 v[192:195], v[120:123], v[152:155], 0
    v_fmac_f32 v238, v196, v36
    v_fmac_f32 v238, v197, v37
    v_fmac_f32 v238, v198, v38
    v_fmac_f32 v238, v199, v39
    v_mfma_f32_16x16x32_bf16 v[192:195], v[124:127], v[156:159], v[192:195]
    buffer_load_dwordx4 v[224:227], v245, s[16:19], s74 offen offset:2400
    buffer_load_dwordx2 v[228:229], v245, s[16:19], s74 offen offset:2416
    v_mfma_f32_16x16x32_bf16 v[196:199], v[176:179], v[136:139], 0
    v_fmac_f32 v238, v200, v40
    v_fmac_f32 v238, v201, v41
    v_mfma_f32_16x16x32_bf16 v[196:199], v[180:183], v[140:143], v[196:199]
    v_fmac_f32 v238, v202, v42
    v_fmac_f32 v238, v203, v43
    v_mfma_f32_16x16x32_bf16 v[200:203], v[120:123], v[168:171], 0
    v_fmac_f32 v238, v204, v44
    v_fmac_f32 v238, v205, v45
    v_mfma_f32_16x16x32_bf16 v[200:203], v[124:127], v[172:175], v[200:203]
    v_fmac_f32 v238, v206, v46
    v_fmac_f32 v238, v207, v47
    v_mfma_f32_16x16x32_bf16 v[204:207], v[136:139], v[136:139], 0
    v_fmac_f32 v238, v185, v86
    v_fmac_f32 v238, v188, v48
    v_mfma_f32_16x16x32_bf16 v[204:207], v[140:143], v[140:143], v[204:207]
    v_fmac_f32 v238, v189, v49
    v_fmac_f32 v238, v190, v50
    v_mfma_f32_16x16x32_bf16 v[208:211], v[176:179], v[176:179], 0
    v_fmac_f32 v238, v191, v51
    v_fmac_f32 v238, v192, v52
    v_mfma_f32_16x16x32_bf16 v[208:211], v[180:183], v[180:183], v[208:211]
    v_fmac_f32 v238, v193, v53
    v_fmac_f32 v238, v194, v54
    v_mfma_f32_16x16x32_bf16 v[184:187], v[176:179], v[152:155], 0
    v_fmac_f32 v238, v195, v55
    v_fmac_f32 v238, v197, v87
    v_mfma_f32_16x16x32_bf16 v[184:187], v[180:183], v[156:159], v[184:187]
    v_fmac_f32 v238, v200, v56
    v_fmac_f32 v238, v201, v57
    v_mfma_f32_16x16x32_bf16 v[188:191], v[136:139], v[152:155], 0
    v_fmac_f32 v238, v202, v58
    v_fmac_f32 v238, v203, v59
    v_mfma_f32_16x16x32_bf16 v[188:191], v[140:143], v[156:159], v[188:191]
    v_fmac_f32 v238, v204, v60
    v_fmac_f32 v238, v205, v61
    v_mfma_f32_16x16x32_bf16 v[192:195], v[136:139], v[168:171], 0
    v_fmac_f32 v238, v206, v62
    v_fmac_f32 v238, v207, v63
    v_mfma_f32_16x16x32_bf16 v[192:195], v[140:143], v[172:175], v[192:195]
    v_fmac_f32 v237, v208, v90
    v_fmac_f32 v238, v209, v91
    v_mfma_f32_16x16x32_bf16 v[196:199], v[176:179], v[168:171], 0
    v_mul_f32 v239, v210, v92
    v_mul_f32 v240, v211, v93
    v_mfma_f32_16x16x32_bf16 v[196:199], v[180:183], v[172:175], v[196:199]
    v_fmac_f32 v238, v185, v88
    v_fmac_f32 v238, v188, v64
    v_mfma_f32_16x16x32_bf16 v[200:203], v[152:155], v[152:155], 0
    v_fmac_f32 v238, v189, v65
    v_fmac_f32 v238, v190, v66
    v_mfma_f32_16x16x32_bf16 v[200:203], v[156:159], v[156:159], v[200:203]
    v_fmac_f32 v238, v191, v67
    v_fmac_f32 v238, v192, v68
    v_mfma_f32_16x16x32_bf16 v[204:207], v[152:155], v[168:171], 0
    v_fmac_f32 v238, v193, v69
    v_fmac_f32 v238, v194, v70
    v_mfma_f32_16x16x32_bf16 v[204:207], v[156:159], v[172:175], v[204:207]
    v_fmac_f32 v238, v195, v71
    v_fmac_f32 v238, v197, v89
    v_mfma_f32_16x16x32_bf16 v[208:211], v[168:171], v[168:171], 0
    v_fmac_f32 v238, v200, v72
    v_fmac_f32 v238, v201, v73
    v_mfma_f32_16x16x32_bf16 v[208:211], v[172:175], v[172:175], v[208:211]
    v_fmac_f32 v238, v202, v74
    s_waitcnt vmcnt(7) lgkmcnt(0)
    v_mfma_f32_16x16x32_bf16 v[184:187], v[96:99], v[96:99], 0
    v_mad_u32_u24 v232, v232, s57, v244
    v_mad_u32_u24 v233, v233, s57, v244
    v_mfma_f32_16x16x32_bf16 v[184:187], v[100:103], v[100:103], v[184:187]
    v_fmac_f32 v238, v203, v75
    v_fmac_f32 v238, v204, v76
    v_mfma_f32_16x16x32_bf16 v[188:191], v[96:99], v[104:107], 0
    v_fmac_f32 v238, v205, v77
    v_fmac_f32 v238, v206, v78
    v_mfma_f32_16x16x32_bf16 v[188:191], v[100:103], v[108:111], v[188:191]
    ds_read_b128 v[120:123], v232 offset:0
    ds_read_b128 v[124:127], v232 offset:64
    v_mfma_f32_16x16x32_bf16 v[192:195], v[96:99], v[112:115], 0
    v_fmac_f32 v238, v207, v79
    v_fmac_f32 v238, v208, v80
    v_mfma_f32_16x16x32_bf16 v[192:195], v[100:103], v[116:119], v[192:195]
    v_fmac_f32 v238, v209, v81
    v_fmac_f32 v238, v210, v82
    v_mfma_f32_16x16x32_bf16 v[196:199], v[176:179], v[96:99], 0
    v_fmac_f32 v238, v211, v83
    v_mad_u32_u24 v230, v230, s57, v244
    v_mfma_f32_16x16x32_bf16 v[196:199], v[180:183], v[100:103], v[196:199]
    v_fmac_f32 v239, v184, v0
    v_fmac_f32 v239, v185, v1
    v_mfma_f32_16x16x32_bf16 v[200:203], v[96:99], v[128:131], 0
    ds_read_b128 v[136:139], v233 offset:0
    ds_read_b128 v[140:143], v233 offset:64
    v_mfma_f32_16x16x32_bf16 v[200:203], v[100:103], v[132:135], v[200:203]
    v_fmac_f32 v239, v186, v2
    v_fmac_f32 v239, v187, v3
    v_mfma_f32_16x16x32_bf16 v[204:207], v[96:99], v[144:147], 0
    v_fmac_f32 v239, v188, v4
    v_fmac_f32 v239, v189, v5
    v_mfma_f32_16x16x32_bf16 v[204:207], v[100:103], v[148:151], v[204:207]
    v_fmac_f32 v239, v190, v6
    v_fmac_f32 v239, v191, v7
    v_mfma_f32_16x16x32_bf16 v[208:211], v[96:99], v[160:163], 0
    v_fmac_f32 v239, v192, v8
    v_fmac_f32 v239, v193, v9
    v_mfma_f32_16x16x32_bf16 v[208:211], v[100:103], v[164:167], v[208:211]
    ds_read_b128 v[96:99], v230 offset:0
    ds_read_b128 v[100:103], v230 offset:64
    v_mfma_f32_16x16x32_bf16 v[184:187], v[104:107], v[104:107], 0
    v_fmac_f32 v239, v194, v10
    v_fmac_f32 v239, v195, v11
    v_mfma_f32_16x16x32_bf16 v[184:187], v[108:111], v[108:111], v[184:187]
    v_mad_u32_u24 v234, v234, s57, v244
    v_fmac_f32 v239, v198, v84
    v_mfma_f32_16x16x32_bf16 v[188:191], v[104:107], v[112:115], 0
    v_fmac_f32 v239, v200, v12
    v_fmac_f32 v239, v201, v13
    v_mfma_f32_16x16x32_bf16 v[188:191], v[108:111], v[116:119], v[188:191]
    v_fmac_f32 v239, v202, v14
    v_fmac_f32 v239, v203, v15
    v_mfma_f32_16x16x32_bf16 v[192:195], v[176:179], v[104:107], 0
    v_fmac_f32 v239, v204, v16
    v_fmac_f32 v239, v205, v17
    v_mfma_f32_16x16x32_bf16 v[192:195], v[180:183], v[108:111], v[192:195]
    ds_read_b128 v[152:155], v234 offset:0
    ds_read_b128 v[156:159], v234 offset:64
    v_mfma_f32_16x16x32_bf16 v[196:199], v[104:107], v[128:131], 0
    v_fmac_f32 v239, v206, v18
    v_fmac_f32 v239, v207, v19
    v_mfma_f32_16x16x32_bf16 v[196:199], v[108:111], v[132:135], v[196:199]
    v_mad_u32_u24 v231, v231, s57, v244
    v_fmac_f32 v239, v208, v20
    v_mfma_f32_16x16x32_bf16 v[200:203], v[104:107], v[144:147], 0
    v_fmac_f32 v239, v209, v21
    v_fmac_f32 v239, v210, v22
    v_mfma_f32_16x16x32_bf16 v[200:203], v[108:111], v[148:151], v[200:203]
    v_fmac_f32 v239, v211, v23
    v_fmac_f32 v239, v184, v24
    v_mfma_f32_16x16x32_bf16 v[204:207], v[104:107], v[160:163], 0
    v_fmac_f32 v239, v185, v25
    v_fmac_f32 v239, v186, v26
    v_mfma_f32_16x16x32_bf16 v[204:207], v[108:111], v[164:167], v[204:207]
    ds_read_b128 v[104:107], v231 offset:0
    ds_read_b128 v[108:111], v231 offset:64
    v_mfma_f32_16x16x32_bf16 v[208:211], v[112:115], v[112:115], 0
    v_fmac_f32 v239, v187, v27
    v_fmac_f32 v239, v188, v28
    v_mfma_f32_16x16x32_bf16 v[208:211], v[116:119], v[116:119], v[208:211]
    v_fmac_f32 v239, v189, v29
    v_fmac_f32 v239, v190, v30
    v_mfma_f32_16x16x32_bf16 v[184:187], v[176:179], v[112:115], 0
    v_fmac_f32 v239, v191, v31
    v_mad_u32_u24 v235, v235, s57, v244
    v_mfma_f32_16x16x32_bf16 v[184:187], v[180:183], v[116:119], v[184:187]
    v_fmac_f32 v239, v194, v85
    v_fmac_f32 v239, v196, v32
    v_mfma_f32_16x16x32_bf16 v[188:191], v[112:115], v[128:131], 0
    v_fmac_f32 v239, v197, v33
    v_fmac_f32 v239, v198, v34
    v_mfma_f32_16x16x32_bf16 v[188:191], v[116:119], v[132:135], v[188:191]
    ds_read_b128 v[168:171], v235 offset:0
    ds_read_b128 v[172:175], v235 offset:64
    v_mfma_f32_16x16x32_bf16 v[192:195], v[112:115], v[144:147], 0
    v_fmac_f32 v239, v199, v35
    v_fmac_f32 v239, v200, v36
    v_mfma_f32_16x16x32_bf16 v[192:195], v[116:119], v[148:151], v[192:195]
    buffer_load_dwordx4 v[230:233], v245, s[16:19], s74 offen offset:2800
    buffer_load_dwordx2 v[234:235], v245, s[16:19], s74 offen offset:2816
    v_mfma_f32_16x16x32_bf16 v[196:199], v[176:179], v[128:131], 0
    v_fmac_f32 v239, v201, v37
    v_fmac_f32 v239, v202, v38
    v_mfma_f32_16x16x32_bf16 v[196:199], v[180:183], v[132:135], v[196:199]
    v_fmac_f32 v239, v203, v39
    v_fmac_f32 v239, v204, v40
    v_mfma_f32_16x16x32_bf16 v[200:203], v[112:115], v[160:163], 0
    v_fmac_f32 v239, v205, v41
    v_fmac_f32 v239, v206, v42
    v_mfma_f32_16x16x32_bf16 v[200:203], v[116:119], v[164:167], v[200:203]
    v_fmac_f32 v239, v207, v43
    v_fmac_f32 v239, v208, v44
    v_mfma_f32_16x16x32_bf16 v[204:207], v[128:131], v[128:131], 0
    v_fmac_f32 v239, v209, v45
    v_fmac_f32 v239, v210, v46
    v_mfma_f32_16x16x32_bf16 v[204:207], v[132:135], v[132:135], v[204:207]
    v_fmac_f32 v239, v211, v47
    v_fmac_f32 v239, v186, v86
    v_mfma_f32_16x16x32_bf16 v[184:187], v[176:179], v[144:147], 0
    v_fmac_f32 v239, v188, v48
    v_fmac_f32 v239, v189, v49
    v_mfma_f32_16x16x32_bf16 v[184:187], v[180:183], v[148:151], v[184:187]
    v_fmac_f32 v239, v190, v50
    v_fmac_f32 v239, v191, v51
    v_mfma_f32_16x16x32_bf16 v[188:191], v[128:131], v[144:147], 0
    v_fmac_f32 v239, v192, v52
    v_fmac_f32 v239, v193, v53
    v_mfma_f32_16x16x32_bf16 v[188:191], v[132:135], v[148:151], v[188:191]
    v_fmac_f32 v239, v194, v54
    v_fmac_f32 v239, v195, v55
    v_mfma_f32_16x16x32_bf16 v[192:195], v[128:131], v[160:163], 0
    v_fmac_f32 v239, v198, v87
    v_fmac_f32 v239, v200, v56
    v_mfma_f32_16x16x32_bf16 v[192:195], v[132:135], v[164:167], v[192:195]
    v_fmac_f32 v239, v201, v57
    v_fmac_f32 v239, v202, v58
    v_mfma_f32_16x16x32_bf16 v[196:199], v[176:179], v[160:163], 0
    v_fmac_f32 v239, v203, v59
    v_fmac_f32 v239, v204, v60
    v_mfma_f32_16x16x32_bf16 v[196:199], v[180:183], v[164:167], v[196:199]
    v_fmac_f32 v239, v205, v61
    v_fmac_f32 v239, v206, v62
    v_mfma_f32_16x16x32_bf16 v[200:203], v[144:147], v[144:147], 0
    v_fmac_f32 v239, v207, v63
    v_fmac_f32 v239, v186, v88
    v_mfma_f32_16x16x32_bf16 v[200:203], v[148:151], v[148:151], v[200:203]
    v_fmac_f32 v239, v188, v64
    v_fmac_f32 v239, v189, v65
    v_mfma_f32_16x16x32_bf16 v[204:207], v[144:147], v[160:163], 0
    v_fmac_f32 v239, v190, v66
    v_fmac_f32 v239, v191, v67
    v_mfma_f32_16x16x32_bf16 v[204:207], v[148:151], v[164:167], v[204:207]
    v_fmac_f32 v239, v192, v68
    v_fmac_f32 v239, v193, v69
    v_mfma_f32_16x16x32_bf16 v[208:211], v[160:163], v[160:163], 0
    v_fmac_f32 v239, v194, v70
    v_fmac_f32 v239, v195, v71
    v_mfma_f32_16x16x32_bf16 v[208:211], v[164:167], v[164:167], v[208:211]
    v_fmac_f32 v239, v198, v89
    s_waitcnt vmcnt(6) lgkmcnt(0)
    v_mfma_f32_16x16x32_bf16 v[184:187], v[96:99], v[96:99], 0
    v_mad_u32_u24 v214, v214, s57, v244
    v_mad_u32_u24 v215, v215, s57, v244
    v_mfma_f32_16x16x32_bf16 v[184:187], v[100:103], v[100:103], v[184:187]
    v_fmac_f32 v239, v200, v72
    v_fmac_f32 v239, v201, v73
    v_mfma_f32_16x16x32_bf16 v[188:191], v[96:99], v[104:107], 0
    v_fmac_f32 v239, v202, v74
    v_fmac_f32 v239, v203, v75
    v_mfma_f32_16x16x32_bf16 v[188:191], v[100:103], v[108:111], v[188:191]
    ds_read_b128 v[112:115], v214 offset:0
    ds_read_b128 v[116:119], v214 offset:64
    v_mfma_f32_16x16x32_bf16 v[192:195], v[176:179], v[120:123], 0
    v_fmac_f32 v239, v204, v76
    v_fmac_f32 v239, v205, v77
    v_mfma_f32_16x16x32_bf16 v[192:195], v[180:183], v[124:127], v[192:195]
    v_fmac_f32 v239, v206, v78
    v_fmac_f32 v239, v207, v79
    v_mfma_f32_16x16x32_bf16 v[196:199], v[96:99], v[120:123], 0
    v_fmac_f32 v239, v208, v80
    v_fmac_f32 v239, v209, v81
    v_mfma_f32_16x16x32_bf16 v[196:199], v[100:103], v[124:127], v[196:199]
    v_fmac_f32 v239, v210, v82
    v_fmac_f32 v239, v211, v83
    v_mfma_f32_16x16x32_bf16 v[200:203], v[176:179], v[96:99], 0
    ds_read_b128 v[128:131], v215 offset:0
    ds_read_b128 v[132:135], v215 offset:64
    v_mfma_f32_16x16x32_bf16 v[200:203], v[180:183], v[100:103], v[200:203]
    v_fmac_f32 v240, v184, v0
    v_fmac_f32 v240, v185, v1
    v_mfma_f32_16x16x32_bf16 v[204:207], v[96:99], v[136:139], 0
    v_fmac_f32 v240, v186, v2
    v_fmac_f32 v240, v187, v3
    v_mfma_f32_16x16x32_bf16 v[204:207], v[100:103], v[140:143], v[204:207]
    v_fmac_f32 v240, v188, v4
    v_fmac_f32 v240, v189, v5
    v_mfma_f32_16x16x32_bf16 v[208:211], v[176:179], v[136:139], 0
    v_fmac_f32 v240, v190, v6
    v_fmac_f32 v240, v191, v7
    v_mfma_f32_16x16x32_bf16 v[208:211], v[180:183], v[140:143], v[208:211]
    v_mad_u32_u24 v212, v212, s57, v244
    v_fmac_f32 v240, v195, v86
    v_mfma_f32_16x16x32_bf16 v[184:187], v[96:99], v[152:155], 0
    v_mad_u32_u24 v216, v216, s57, v244
    v_fmac_f32 v240, v196, v8
    v_mfma_f32_16x16x32_bf16 v[184:187], v[100:103], v[156:159], v[184:187]
    v_fmac_f32 v240, v197, v9
    v_fmac_f32 v240, v198, v10
    v_mfma_f32_16x16x32_bf16 v[188:191], v[96:99], v[168:171], 0
    v_fmac_f32 v240, v199, v11
    v_fmac_f32 v240, v203, v84
    v_mfma_f32_16x16x32_bf16 v[188:191], v[100:103], v[172:175], v[188:191]
    ds_read_b128 v[96:99], v212 offset:0
    ds_read_b128 v[100:103], v212 offset:64
    v_mfma_f32_16x16x32_bf16 v[192:195], v[104:107], v[104:107], 0
    v_fmac_f32 v240, v204, v12
    v_fmac_f32 v240, v205, v13
    v_mfma_f32_16x16x32_bf16 v[192:195], v[108:111], v[108:111], v[192:195]
    ds_read_b128 v[144:147], v216 offset:0
    ds_read_b128 v[148:151], v216 offset:64
    v_mfma_f32_16x16x32_bf16 v[196:199], v[104:107], v[120:123], 0
    v_fmac_f32 v240, v206, v14
    v_fmac_f32 v240, v207, v15
    v_mfma_f32_16x16x32_bf16 v[196:199], v[108:111], v[124:127], v[196:199]
    v_fmac_f32 v240, v211, v87
    v_fmac_f32 v240, v184, v16
    v_mfma_f32_16x16x32_bf16 v[200:203], v[176:179], v[152:155], 0
    v_fmac_f32 v240, v185, v17
    v_fmac_f32 v240, v186, v18
    v_mfma_f32_16x16x32_bf16 v[200:203], v[180:183], v[156:159], v[200:203]
    v_fmac_f32 v240, v187, v19
    v_fmac_f32 v240, v188, v20
    v_mfma_f32_16x16x32_bf16 v[204:207], v[176:179], v[104:107], 0
    v_fmac_f32 v240, v189, v21
    v_fmac_f32 v240, v190, v22
    v_mfma_f32_16x16x32_bf16 v[204:207], v[180:183], v[108:111], v[204:207]
    v_fmac_f32 v240, v191, v23
    v_mad_u32_u24 v217, v217, s57, v244
    v_mfma_f32_16x16x32_bf16 v[208:211], v[104:107], v[136:139], 0
    v_mad_u32_u24 v236, v236, s57, v244
    v_mad_u32_u24 v213, v213, s57, v244
    v_mfma_f32_16x16x32_bf16 v[208:211], v[108:111], v[140:143], v[208:211]
    v_fmac_f32 v240, v192, v24
    v_fmac_f32 v240, v193, v25
    v_mfma_f32_16x16x32_bf16 v[184:187], v[104:107], v[152:155], 0
    v_fmac_f32 v240, v194, v26
    v_fmac_f32 v240, v195, v27
    v_mfma_f32_16x16x32_bf16 v[184:187], v[108:111], v[156:159], v[184:187]
    v_fmac_f32 v240, v196, v28
    v_fmac_f32 v240, v197, v29
    v_mfma_f32_16x16x32_bf16 v[188:191], v[176:179], v[168:171], 0
    v_fmac_f32 v240, v198, v30
    v_fmac_f32 v240, v199, v31
    v_mfma_f32_16x16x32_bf16 v[188:191], v[180:183], v[172:175], v[188:191]
    ds_read_b128 v[160:163], v217 offset:0
    ds_read_b128 v[164:167], v217 offset:64
    v_mfma_f32_16x16x32_bf16 v[192:195], v[104:107], v[168:171], 0
    ds_read_b128 v[176:179], v236 offset:0
    ds_read_b128 v[180:183], v236 offset:64
    v_mfma_f32_16x16x32_bf16 v[192:195], v[108:111], v[172:175], v[192:195]
    ds_read_b128 v[104:107], v213 offset:0
    ds_read_b128 v[108:111], v213 offset:64
    v_mfma_f32_16x16x32_bf16 v[196:199], v[120:123], v[120:123], 0
    v_fmac_f32 v240, v203, v88
    v_fmac_f32 v240, v207, v85
    v_mfma_f32_16x16x32_bf16 v[196:199], v[124:127], v[124:127], v[196:199]
    buffer_load_dwordx4 v[212:215], v245, s[16:19], s74 offen offset:3200
    buffer_load_dwordx2 v[216:217], v245, s[16:19], s74 offen offset:3216
    buffer_load_dword v236, v246, s[16:19], s74 offen offset:3584
    v_mfma_f32_16x16x32_bf16 v[200:203], v[120:123], v[136:139], 0
    v_fmac_f32 v240, v208, v32
    v_fmac_f32 v240, v209, v33
    v_mfma_f32_16x16x32_bf16 v[200:203], v[124:127], v[140:143], v[200:203]
    v_fmac_f32 v240, v210, v34
    v_fmac_f32 v240, v211, v35
    v_mfma_f32_16x16x32_bf16 v[204:207], v[120:123], v[152:155], 0
    v_fmac_f32 v240, v184, v36
    v_fmac_f32 v240, v185, v37
    v_mfma_f32_16x16x32_bf16 v[204:207], v[124:127], v[156:159], v[204:207]
    v_fmac_f32 v240, v186, v38
    v_fmac_f32 v240, v187, v39
    v_mfma_f32_16x16x32_bf16 v[208:211], v[120:123], v[168:171], 0
    v_fmac_f32 v240, v191, v89
    v_fmac_f32 v240, v192, v40
    v_mfma_f32_16x16x32_bf16 v[208:211], v[124:127], v[172:175], v[208:211]
    v_fmac_f32 v240, v193, v41
    v_fmac_f32 v240, v194, v42
    v_mfma_f32_16x16x32_bf16 v[184:187], v[136:139], v[136:139], 0
    v_fmac_f32 v240, v195, v43
    v_permlane32_swap_b32 v237, v238
    v_mfma_f32_16x16x32_bf16 v[184:187], v[140:143], v[140:143], v[184:187]
    s_add_u32 s74, s74, 1600
    v_fmac_f32 v240, v196, v44
    v_mfma_f32_16x16x32_bf16 v[188:191], v[136:139], v[152:155], 0
    v_fmac_f32 v240, v197, v45
    v_fmac_f32 v240, v198, v46
    v_mfma_f32_16x16x32_bf16 v[188:191], v[140:143], v[156:159], v[188:191]
    v_fmac_f32 v240, v199, v47
    v_add_f32 v241, v237, v238
    v_mfma_f32_16x16x32_bf16 v[192:195], v[136:139], v[168:171], 0
    s_cmp_lt_u32 s74, s58
    v_fmac_f32 v240, v200, v48
    v_mfma_f32_16x16x32_bf16 v[192:195], v[140:143], v[172:175], v[192:195]
    v_fmac_f32 v240, v201, v49
    v_fmac_f32 v240, v202, v50
    v_mfma_f32_16x16x32_bf16 v[196:199], v[152:155], v[152:155], 0
    v_fmac_f32 v240, v203, v51
    v_fmac_f32 v240, v204, v52
    v_mfma_f32_16x16x32_bf16 v[196:199], v[156:159], v[156:159], v[196:199]
    v_fmac_f32 v240, v205, v53
    v_fmac_f32 v240, v206, v54
    v_mfma_f32_16x16x32_bf16 v[200:203], v[152:155], v[168:171], 0
    v_fmac_f32 v240, v207, v55
    v_fmac_f32 v240, v208, v56
    v_mfma_f32_16x16x32_bf16 v[200:203], v[156:159], v[172:175], v[200:203]
    v_fmac_f32 v240, v209, v57
    v_fmac_f32 v240, v210, v58
    v_mfma_f32_16x16x32_bf16 v[204:207], v[168:171], v[168:171], 0
    v_fmac_f32 v240, v211, v59
    v_fmac_f32 v240, v184, v60
    v_mfma_f32_16x16x32_bf16 v[204:207], v[172:175], v[172:175], v[204:207]
    v_fmac_f32 v240, v185, v61
    v_fmac_f32 v240, v186, v62
    v_fmac_f32 v240, v187, v63
    s_waitcnt vmcnt(7) lgkmcnt(0)
    s_cbranch_scc1 standalone__deep_cross_pnn__recsys_kernel_loop
    s_branch standalone__deep_cross_pnn__recsys_kernel_k2m
standalone__deep_cross_pnn__recsys_kernel_aux:

    s_setprio 0
    s_load_dword s24, s[60:61], 0
    s_load_dword s25, s[60:61], 16
    s_load_dword s26, s[60:61], 32
    s_load_dword s27, s[60:61], 48
    v_mov_b32 v8, v255
    v_mov_b32 v9, v254
    v_mov_b32 v10, v253
    v_mov_b32 v11, v252
    s_mov_b32 s51, s2
    s_mov_b32 s64, 0
    s_mov_b32 s65, 0

    v_mov_b32 v35, v83
    s_lshr_b32 s72, s2, 3
    s_mul_i32 s72, s72, 36
    s_lshr_b32 s72, s72, 5
    s_lshl_b32 s75, s36, 7
    s_add_u32 s75, s75, 254464
    s_mov_b32 s76, 143136
    s_lshl_b32 s6, s2, 15
    s_lshl_b32 s7, s56, 13
    s_add_u32 s6, s6, s7
    s_add_u32 s6, s6, 20971520
    s_add_u32 s7, s6, 4096
    s_lshl_b32 s8, s36, 7
    s_add_u32 s8, s8, s37
    s_lshl_b32 s8, s8, 9
    s_add_u32 s8, s8, 29360128
    s_and_b32 s9, s2, 63
    s_lshl_b32 s9, s9, 5
    s_lshr_b32 s38, s2, 6
    s_add_u32 s9, s9, s38
    s_lshl_b32 s9, s9, 2
    s_add_u32 s9, s9, 14680064
    v_mov_b32 v112, 0

standalone__deep_cross_pnn__recsys_kernel_unit:

    s_bfe_u32 s36, s51, 0x10003

    s_lshr_b32 s38, s51, 4
    s_and_b32 s39, s51, 7
    s_sub_u32 s57, 2, s36
    s_lshl_b32 s57, s39, s57
    s_lshl_b32 s37, s36, 5
    s_add_u32 s57, s57, s37
    s_add_u32 s57, s57, s56
    s_mul_i32 s37, s38, 48
    s_add_u32 s37, s37, s57
    s_lshl_b32 s38, s38, 1
    s_lshr_b32 s39, s39, 2
    s_add_u32 s38, s38, s39
    s_add_u32 s38, s38, 768
    s_and_b32 s57, s57, 7
    s_cmp_eq_u32 s57, 2
    s_cselect_b32 s38, s38, 1000
    s_lshl_b32 s39, s36, 1
    s_and_b32 s39, s39, s56
    s_cselect_b32 s57, s38, s37

    s_lshr_b32 s37, s51, 4
    s_lshl_b32 s37, s37, 3
    s_and_b32 s38, s51, 7
    s_or_b32 s37, s37, s38
    s_and_b32 s58, s56, 1
    s_lshl_b32 s59, s37, 1
    s_add_u32 s58, s58, s59
    s_lshr_b32 s59, s56, 1
    s_xor_b32 s60, s36, 1
    s_mul_i32 s46, s60, 13
    s_lshl_b32 s60, s60, 1
    s_add_u32 s59, s59, s60
    s_add_u32 s61, s46, 6
    s_add_u32 s60, s46, 12
    s_bitcmp1_b32 s59, 0
    s_cselect_b32 s46, s60, s46
    s_cselect_b32 s63, -1, 1
    s_cselect_b32 s61, 24, s61
    v_lshrrev_b32 v1, 3, v8
    v_and_b32 v2, 7, v8
    v_mul_i32_i24 v7, s63, v2
    v_add_u32 v7, s46, v7
    v_cmp_ge_u32 s[48:49], s61, v7
    s_mul_i32 s60, s58, 25600
    s_movk_i32 s61, 400
    s_lshl_b32 s63, s63, 16
    v_mul_u32_u24 v0, s61, v1
    v_lshl_add_u32 v0, v7, 4, v0
    v_and_b32 v5, 15, v8
    v_and_b32 v6, 48, v8
    v_lshl_add_u32 v56, v5, 8, v6
    s_lshr_b32 s44, s37, 1
    s_lshl_b32 s44, s44, 12
    s_lshl_b32 s38, s36, 1
    s_and_b32 s39, s37, 1
    s_add_u32 s38, s38, s39
    s_lshl_b32 s38, s38, 6
    s_add_u32 s44, s44, s38
    s_lshl_b32 s47, s36, 7
    s_add_u32 s47, s47, s37
    s_lshl_b32 s47, s47, 10
    s_add_u32 s47, s47, 15204352

    s_cmp_eq_u32 s56, 0
    s_cselect_b64 s[4:5], -1, 0
    s_cmp_lg_u32 s64, 0
    s_cbranch_scc1 standalone__deep_cross_pnn__recsys_kernel_nd1
    s_mov_b64 exec, s[40:41]

    s_mul_i32 s73, s72, 4032
    s_mul_i32 s74, s72, 7168
    s_add_u32 s73, s73, s43
    s_add_u32 s74, s74, s42
    s_min_u32 m0, s73, s76
    s_min_u32 s74, s74, s75
    s_add_u32 s72, s72, 1

    buffer_load_dwordx4 v35, s[20:23], s74 offen lds
    s_cmp_eq_u32 s72, 36
    s_cselect_b32 s72, 0, s72

    s_mul_i32 s73, s72, 4032
    s_mul_i32 s74, s72, 7168
    s_add_u32 s73, s73, s43
    s_add_u32 s74, s74, s42
    s_min_u32 m0, s73, s76
    s_min_u32 s74, s74, s75
    s_add_u32 s72, s72, 1

    buffer_load_dwordx4 v35, s[20:23], s74 offen lds
    s_cmp_eq_u32 s72, 36
    s_cselect_b32 s72, 0, s72

    s_mul_i32 s73, s72, 4032
    s_mul_i32 s74, s72, 7168
    s_add_u32 s73, s73, s43
    s_add_u32 s74, s74, s42
    s_min_u32 m0, s73, s76
    s_min_u32 s74, s74, s75
    s_add_u32 s72, s72, 1

    buffer_load_dwordx4 v35, s[20:23], s74 offen lds
    s_cmp_eq_u32 s72, 36
    s_cselect_b32 s72, 0, s72

    s_mul_i32 s73, s72, 4032
    s_mul_i32 s74, s72, 7168
    s_add_u32 s73, s73, s43
    s_add_u32 s74, s74, s42
    s_min_u32 m0, s73, s76
    s_min_u32 s74, s74, s75
    s_add_u32 s72, s72, 1

    buffer_load_dwordx4 v35, s[20:23], s74 offen lds
    s_cmp_eq_u32 s72, 36
    s_cselect_b32 s72, 0, s72

    s_mul_i32 s73, s72, 4032
    s_mul_i32 s74, s72, 7168
    s_add_u32 s73, s73, s43
    s_add_u32 s74, s74, s42
    s_min_u32 m0, s73, s76
    s_min_u32 s74, s74, s75
    s_add_u32 s72, s72, 1

    buffer_load_dwordx4 v35, s[20:23], s74 offen lds
    s_cmp_eq_u32 s72, 36
    s_cselect_b32 s72, 0, s72

    s_mul_i32 s73, s72, 4032
    s_mul_i32 s74, s72, 7168
    s_add_u32 s73, s73, s43
    s_add_u32 s74, s74, s42
    s_min_u32 m0, s73, s76
    s_min_u32 s74, s74, s75
    s_add_u32 s72, s72, 1

    buffer_load_dwordx4 v35, s[20:23], s74 offen lds
    s_cmp_eq_u32 s72, 36
    s_cselect_b32 s72, 0, s72

    s_mul_i32 s73, s72, 4032
    s_mul_i32 s74, s72, 7168
    s_add_u32 s73, s73, s43
    s_add_u32 s74, s74, s42
    s_min_u32 m0, s73, s76
    s_min_u32 s74, s74, s75
    s_add_u32 s72, s72, 1

    buffer_load_dwordx4 v35, s[20:23], s74 offen lds
    s_cmp_eq_u32 s72, 36
    s_cselect_b32 s72, 0, s72

    s_mul_i32 s73, s72, 4032
    s_mul_i32 s74, s72, 7168
    s_add_u32 s73, s73, s43
    s_add_u32 s74, s74, s42
    s_min_u32 m0, s73, s76
    s_min_u32 s74, s74, s75
    s_add_u32 s72, s72, 1

    buffer_load_dwordx4 v35, s[20:23], s74 offen lds
    s_cmp_eq_u32 s72, 36
    s_cselect_b32 s72, 0, s72

    s_mul_i32 s73, s72, 4032
    s_mul_i32 s74, s72, 7168
    s_add_u32 s73, s73, s43
    s_add_u32 s74, s74, s42
    s_min_u32 m0, s73, s76
    s_min_u32 s74, s74, s75
    s_add_u32 s72, s72, 1
    s_barrier

    buffer_load_dwordx4 v35, s[20:23], s74 offen lds
    s_cmp_eq_u32 s72, 36
    s_cselect_b32 s72, 0, s72

    s_mul_i32 s73, s72, 4032
    s_mul_i32 s74, s72, 7168
    s_add_u32 s73, s73, s43
    s_add_u32 s74, s74, s42
    s_min_u32 m0, s73, s76
    s_min_u32 s74, s74, s75
    s_add_u32 s72, s72, 1

    buffer_load_dwordx4 v35, s[20:23], s74 offen lds
    s_cmp_eq_u32 s72, 36
    s_cselect_b32 s72, 0, s72

    s_mul_i32 s73, s72, 4032
    s_mul_i32 s74, s72, 7168
    s_add_u32 s73, s73, s43
    s_add_u32 s74, s74, s42
    s_min_u32 m0, s73, s76
    s_min_u32 s74, s74, s75
    s_add_u32 s72, s72, 1

    buffer_load_dwordx4 v35, s[20:23], s74 offen lds
    s_cmp_eq_u32 s72, 36
    s_cselect_b32 s72, 0, s72

    s_mul_i32 s73, s72, 4032
    s_mul_i32 s74, s72, 7168
    s_add_u32 s73, s73, s43
    s_add_u32 s74, s74, s42
    s_min_u32 m0, s73, s76
    s_min_u32 s74, s74, s75
    s_add_u32 s72, s72, 1

    buffer_load_dwordx4 v35, s[20:23], s74 offen lds
    s_cmp_eq_u32 s72, 36
    s_cselect_b32 s72, 0, s72

    s_mov_b64 exec, -1
standalone__deep_cross_pnn__recsys_kernel_nd1:

    s_lshr_b32 s78, s57, 5
    s_bfe_u32 s79, s57, 0x20003
    s_bfe_u32 s80, s57, 0x20001
    s_and_b32 s81, s57, 1
    s_lshl_b32 s77, s78, 2
    s_lshl_b32 s83, s81, 1
    s_add_u32 s77, s77, s83
    s_lshl_b32 s77, s77, 7
    s_lshl_b32 s83, s79, 5
    s_add_u32 s77, s77, s83
    s_lshl_b32 s83, s80, 3
    s_add_u32 s77, s77, s83
    s_lshl_b32 s77, s77, 10
    s_lshl_b32 s82, s78, 12
    s_lshl_b32 s83, s79, 10
    s_add_u32 s82, s82, s83
    s_lshl_b32 s83, s80, 8
    s_add_u32 s82, s82, s83
    s_lshl_b32 s83, s81, 7
    s_add_u32 s82, s82, s83
    s_mov_b32 s84, 821248
    v_mul_lo_u32 v14, v1, s84
    v_lshl_add_u32 v14, v2, 4, v14
    s_cmp_ge_u32 s57, 800
    s_cselect_b32 s83, 0x40000000, 0
    v_or_b32 v14, s83, v14
    v_and_b32 v3, 3, v8
    v_lshlrev_b32 v3, 4, v3
    v_lshl_or_b32 v3, v1, 6, v3
    v_and_b32 v4, 4, v8
    v_lshl_or_b32 v15, v4, 15, v3
    s_mov_b32 s84, 0x05040100
    s_mov_b32 s85, 0x07060302

    s_cmp_lg_u32 s64, 0
    s_cbranch_scc1 standalone__deep_cross_pnn__recsys_kernel_nd2
    s_mov_b64 exec, s[40:41]

    s_mul_i32 s73, s72, 4032
    s_mul_i32 s74, s72, 7168
    s_add_u32 s73, s73, s43
    s_add_u32 s74, s74, s42
    s_min_u32 m0, s73, s76
    s_min_u32 s74, s74, s75
    s_add_u32 s72, s72, 1

    buffer_load_dwordx4 v35, s[20:23], s74 offen lds
    s_cmp_eq_u32 s72, 36
    s_cselect_b32 s72, 0, s72

    s_mul_i32 s73, s72, 4032
    s_mul_i32 s74, s72, 7168
    s_add_u32 s73, s73, s43
    s_add_u32 s74, s74, s42
    s_min_u32 m0, s73, s76
    s_min_u32 s74, s74, s75
    s_add_u32 s72, s72, 1

    buffer_load_dwordx4 v35, s[20:23], s74 offen lds
    s_cmp_eq_u32 s72, 36
    s_cselect_b32 s72, 0, s72

    s_mul_i32 s73, s72, 4032
    s_mul_i32 s74, s72, 7168
    s_add_u32 s73, s73, s43
    s_add_u32 s74, s74, s42
    s_min_u32 m0, s73, s76
    s_min_u32 s74, s74, s75
    s_add_u32 s72, s72, 1

    buffer_load_dwordx4 v35, s[20:23], s74 offen lds
    s_cmp_eq_u32 s72, 36
    s_cselect_b32 s72, 0, s72

    s_mul_i32 s73, s72, 4032
    s_mul_i32 s74, s72, 7168
    s_add_u32 s73, s73, s43
    s_add_u32 s74, s74, s42
    s_min_u32 m0, s73, s76
    s_min_u32 s74, s74, s75
    s_add_u32 s72, s72, 1

    buffer_load_dwordx4 v35, s[20:23], s74 offen lds
    s_cmp_eq_u32 s72, 36
    s_cselect_b32 s72, 0, s72

    s_mul_i32 s73, s72, 4032
    s_mul_i32 s74, s72, 7168
    s_add_u32 s73, s73, s43
    s_add_u32 s74, s74, s42
    s_min_u32 m0, s73, s76
    s_min_u32 s74, s74, s75
    s_add_u32 s72, s72, 1

    buffer_load_dwordx4 v35, s[20:23], s74 offen lds
    s_cmp_eq_u32 s72, 36
    s_cselect_b32 s72, 0, s72

    s_mul_i32 s73, s72, 4032
    s_mul_i32 s74, s72, 7168
    s_add_u32 s73, s73, s43
    s_add_u32 s74, s74, s42
    s_min_u32 m0, s73, s76
    s_min_u32 s74, s74, s75
    s_add_u32 s72, s72, 1

    buffer_load_dwordx4 v35, s[20:23], s74 offen lds
    s_cmp_eq_u32 s72, 36
    s_cselect_b32 s72, 0, s72

    s_mul_i32 s73, s72, 4032
    s_mul_i32 s74, s72, 7168
    s_add_u32 s73, s73, s43
    s_add_u32 s74, s74, s42
    s_min_u32 m0, s73, s76
    s_min_u32 s74, s74, s75
    s_add_u32 s72, s72, 1

    buffer_load_dwordx4 v35, s[20:23], s74 offen lds
    s_cmp_eq_u32 s72, 36
    s_cselect_b32 s72, 0, s72

    s_mul_i32 s73, s72, 4032
    s_mul_i32 s74, s72, 7168
    s_add_u32 s73, s73, s43
    s_add_u32 s74, s74, s42
    s_min_u32 m0, s73, s76
    s_min_u32 s74, s74, s75
    s_add_u32 s72, s72, 1

    buffer_load_dwordx4 v35, s[20:23], s74 offen lds
    s_cmp_eq_u32 s72, 36
    s_cselect_b32 s72, 0, s72

    s_mul_i32 s73, s72, 4032
    s_mul_i32 s74, s72, 7168
    s_add_u32 s73, s73, s43
    s_add_u32 s74, s74, s42
    s_min_u32 m0, s73, s76
    s_min_u32 s74, s74, s75
    s_add_u32 s72, s72, 1

    buffer_load_dwordx4 v35, s[20:23], s74 offen lds
    s_cmp_eq_u32 s72, 36
    s_cselect_b32 s72, 0, s72

    s_mul_i32 s73, s72, 4032
    s_mul_i32 s74, s72, 7168
    s_add_u32 s73, s73, s43
    s_add_u32 s74, s74, s42
    s_min_u32 m0, s73, s76
    s_min_u32 s74, s74, s75
    s_add_u32 s72, s72, 1

    buffer_load_dwordx4 v35, s[20:23], s74 offen lds
    s_cmp_eq_u32 s72, 36
    s_cselect_b32 s72, 0, s72

    s_mul_i32 s73, s72, 4032
    s_mul_i32 s74, s72, 7168
    s_add_u32 s73, s73, s43
    s_add_u32 s74, s74, s42
    s_min_u32 m0, s73, s76
    s_min_u32 s74, s74, s75
    s_add_u32 s72, s72, 1

    buffer_load_dwordx4 v35, s[20:23], s74 offen lds
    s_cmp_eq_u32 s72, 36
    s_cselect_b32 s72, 0, s72

    s_mul_i32 s73, s72, 4032
    s_mul_i32 s74, s72, 7168
    s_add_u32 s73, s73, s43
    s_add_u32 s74, s74, s42
    s_min_u32 m0, s73, s76
    s_min_u32 s74, s74, s75
    s_add_u32 s72, s72, 1

    buffer_load_dwordx4 v35, s[20:23], s74 offen lds
    s_cmp_eq_u32 s72, 36
    s_cselect_b32 s72, 0, s72

    s_mul_i32 s73, s72, 4032
    s_mul_i32 s74, s72, 7168
    s_add_u32 s73, s73, s43
    s_add_u32 s74, s74, s42
    s_min_u32 m0, s73, s76
    s_min_u32 s74, s74, s75
    s_add_u32 s72, s72, 1

    buffer_load_dwordx4 v35, s[20:23], s74 offen lds
    s_cmp_eq_u32 s72, 36
    s_cselect_b32 s72, 0, s72

    s_mul_i32 s73, s72, 4032
    s_mul_i32 s74, s72, 7168
    s_add_u32 s73, s73, s43
    s_add_u32 s74, s74, s42
    s_min_u32 m0, s73, s76
    s_min_u32 s74, s74, s75
    s_add_u32 s72, s72, 1

    buffer_load_dwordx4 v35, s[20:23], s74 offen lds
    s_cmp_eq_u32 s72, 36
    s_cselect_b32 s72, 0, s72

    s_mul_i32 s73, s72, 4032
    s_mul_i32 s74, s72, 7168
    s_add_u32 s73, s73, s43
    s_add_u32 s74, s74, s42
    s_min_u32 m0, s73, s76
    s_min_u32 s74, s74, s75
    s_add_u32 s72, s72, 1

    buffer_load_dwordx4 v35, s[20:23], s74 offen lds
    s_cmp_eq_u32 s72, 36
    s_cselect_b32 s72, 0, s72

    s_mul_i32 s73, s72, 4032
    s_mul_i32 s74, s72, 7168
    s_add_u32 s73, s73, s43
    s_add_u32 s74, s74, s42
    s_min_u32 m0, s73, s76
    s_min_u32 s74, s74, s75
    s_add_u32 s72, s72, 1

    buffer_load_dwordx4 v35, s[20:23], s74 offen lds
    s_cmp_eq_u32 s72, 36
    s_cselect_b32 s72, 0, s72

    s_mul_i32 s73, s72, 4032
    s_mul_i32 s74, s72, 7168
    s_add_u32 s73, s73, s43
    s_add_u32 s74, s74, s42
    s_min_u32 m0, s73, s76
    s_min_u32 s74, s74, s75
    s_add_u32 s72, s72, 1

    buffer_load_dwordx4 v35, s[20:23], s74 offen lds
    s_cmp_eq_u32 s72, 36
    s_cselect_b32 s72, 0, s72

    s_mul_i32 s73, s72, 4032
    s_mul_i32 s74, s72, 7168
    s_add_u32 s73, s73, s43
    s_add_u32 s74, s74, s42
    s_min_u32 m0, s73, s76
    s_min_u32 s74, s74, s75
    s_add_u32 s72, s72, 1

    buffer_load_dwordx4 v35, s[20:23], s74 offen lds
    s_cmp_eq_u32 s72, 36
    s_cselect_b32 s72, 0, s72

    s_mul_i32 s73, s72, 4032
    s_mul_i32 s74, s72, 7168
    s_add_u32 s73, s73, s43
    s_add_u32 s74, s74, s42
    s_min_u32 m0, s73, s76
    s_min_u32 s74, s74, s75
    s_add_u32 s72, s72, 1

    buffer_load_dwordx4 v35, s[20:23], s74 offen lds
    s_cmp_eq_u32 s72, 36
    s_cselect_b32 s72, 0, s72

    s_mul_i32 s73, s72, 4032
    s_mul_i32 s74, s72, 7168
    s_add_u32 s73, s73, s43
    s_add_u32 s74, s74, s42
    s_min_u32 m0, s73, s76
    s_min_u32 s74, s74, s75
    s_add_u32 s72, s72, 1

    buffer_load_dwordx4 v35, s[20:23], s74 offen lds
    s_cmp_eq_u32 s72, 36
    s_cselect_b32 s72, 0, s72

    s_mul_i32 s73, s72, 4032
    s_mul_i32 s74, s72, 7168
    s_add_u32 s73, s73, s43
    s_add_u32 s74, s74, s42
    s_min_u32 m0, s73, s76
    s_min_u32 s74, s74, s75
    s_add_u32 s72, s72, 1

    buffer_load_dwordx4 v35, s[20:23], s74 offen lds
    s_cmp_eq_u32 s72, 36
    s_cselect_b32 s72, 0, s72

    s_mul_i32 s73, s72, 4032
    s_mul_i32 s74, s72, 7168
    s_add_u32 s73, s73, s43
    s_add_u32 s74, s74, s42
    s_min_u32 m0, s73, s76
    s_min_u32 s74, s74, s75
    s_add_u32 s72, s72, 1

    buffer_load_dwordx4 v35, s[20:23], s74 offen lds
    s_cmp_eq_u32 s72, 36
    s_cselect_b32 s72, 0, s72

    s_mul_i32 s73, s72, 4032
    s_mul_i32 s74, s72, 7168
    s_add_u32 s73, s73, s43
    s_add_u32 s74, s74, s42
    s_min_u32 m0, s73, s76
    s_min_u32 s74, s74, s75
    s_add_u32 s72, s72, 1

    buffer_load_dwordx4 v35, s[20:23], s74 offen lds
    s_cmp_eq_u32 s72, 36
    s_cselect_b32 s72, 0, s72

    s_mul_i32 s73, s72, 4032
    s_mul_i32 s74, s72, 7168
    s_add_u32 s73, s73, s43
    s_add_u32 s74, s74, s42
    s_min_u32 m0, s73, s76
    s_min_u32 s74, s74, s75
    s_add_u32 s72, s72, 1

    buffer_load_dwordx4 v35, s[20:23], s74 offen lds
    s_cmp_eq_u32 s72, 36
    s_cselect_b32 s72, 0, s72

    s_mov_b64 exec, -1
standalone__deep_cross_pnn__recsys_kernel_nd2:

    s_cmp_lg_u32 s64, 0
    s_cbranch_scc1 standalone__deep_cross_pnn__recsys_kernel_nsig
    s_waitcnt vmcnt(0)
    s_barrier

standalone__deep_cross_pnn__recsys_kernel_nsig:
    s_setprio 1
    s_mov_b64 exec, s[48:49]
    buffer_load_dwordx4 v[224:227], v0, s[16:19], s60 offen
    s_add_u32 s60, s60, 3200
    buffer_load_dwordx4 v[228:231], v0, s[16:19], s60 offen
    s_add_u32 s60, s60, 3200
    buffer_load_dwordx4 v[232:235], v0, s[16:19], s60 offen
    s_add_u32 s60, s60, 3200
    buffer_load_dwordx4 v[236:239], v0, s[16:19], s60 offen
    s_add_u32 s60, s60, 3200
    buffer_load_dwordx4 v[240:243], v0, s[16:19], s60 offen
    s_add_u32 s60, s60, 3200
    buffer_load_dwordx4 v[244:247], v0, s[16:19], s60 offen
    s_add_u32 s60, s60, 3200
    buffer_load_dwordx4 v[248:251], v0, s[16:19], s60 offen
    s_add_u32 s60, s60, 3200
    buffer_load_dwordx4 v[252:255], v0, s[16:19], s60 offen
    s_add_u32 s60, s60, 3200
    s_mov_b64 exec, -1

    s_lshl_b32 s61, s56, 8
    s_add_u32 s61, s61, 162688
    v_lshlrev_b32 v86, 2, v8
    v_add_u32 v86, s61, v86
    v_and_b32 v85, 0xffffff80, v86
    v_lshrrev_b32 v27, 5, v8
    v_mul_u32_u24 v27, 0x40404, v27
    v_lshl_or_b32 v27, v27, 8, v27
    s_mul_i32 s61, s56, 4608
    s_add_u32 s61, s61, 144256
    v_mul_u32_u24 v31, 72, v8
    v_add3_u32 v31, s61, v31, -8
    v_mul_u32_u24 v34, 72, v1
    v_lshl_add_u32 v34, v2, 3, v34
    v_add_u32 v34, s61, v34
    v_mul_u32_u24 v3, 52, v7
    v_lshrrev_b32 v3, 8, v3
    v_mad_i32_i24 v2, v3, -5, v7
    v_mov_b32 v13, 0
    v_mul_u32_u24 v2, 0x10001, v2
    v_lshlrev_b32 v2, 12, v2
    v_add_u32 v32, 67108864, v2
    v_add_u32 v33, 201328640, v2
    s_cmp_eq_u32 s59, 3
    s_cselect_b32 s61, 0x0fffff00, -16
    s_cmp_eq_u32 s59, 1
    s_cselect_b32 s61, 0x0ffffff0, s61
    v_mov_b32 v59, s61
    s_lshr_b32 s62, s58, 7
    s_mul_i32 s62, s62, 25
    s_min_u32 s46, s46, 24
    s_add_u32 s62, s62, s46
    s_lshl_b32 s62, s62, 3
    s_bfe_u32 s61, s58, 0x30004
    s_add_u32 s62, s62, s61
    s_lshl_b32 s62, s62, 13
    s_bfe_u32 s61, s58, 0x30001
    s_lshl_b32 s61, s61, 10
    s_add_u32 s62, s62, s61
    s_and_b32 s61, s58, 1
    s_lshl_b32 s46, s61, 2
    s_add_u32 s46, s46, 163712
    s_lshl_b32 s61, s61, 9
    s_add_u32 s62, s62, s61
    s_add_u32 s62, s62, 16777216
    v_and_b32 v30, 31, v8
    v_lshrrev_b32 v3, 5, v8
    v_lshlrev_b32 v30, 4, v30
    v_lshl_add_u32 v30, v3, 3, v30
    s_movk_i32 s66, 0x7c
    s_mov_b32 s67, 0x03030303
    s_mov_b32 s75, 0x06040200
    v_mov_b32 v57, 0x08040201
    v_mov_b32 v58, 0x80402010
    v_mov_b32 v108, 0xff800001
    v_mov_b32 v109, 0xff800001
    v_mov_b32 v110, 0xff800001
    v_mov_b32 v111, 0xff800001

    s_mov_b64 exec, s[48:49]

    s_waitcnt vmcnt(7)
    v_lshl_or_b32 v224, v225, 16, v224
    v_lshl_or_b32 v225, v227, 16, v226
    v_add_u32 v224, v32, v224
    v_add_u32 v225, v33, v225

    ds_write_b64 v34, v[224:225] offset:0

    s_waitcnt vmcnt(6)
    v_lshl_or_b32 v228, v229, 16, v228
    v_lshl_or_b32 v229, v231, 16, v230
    v_add_u32 v228, v32, v228
    v_add_u32 v229, v33, v229

    ds_write_b64 v34, v[228:229] offset:576

    s_waitcnt vmcnt(5)
    v_lshl_or_b32 v232, v233, 16, v232
    v_lshl_or_b32 v233, v235, 16, v234
    v_add_u32 v232, v32, v232
    v_add_u32 v233, v33, v233

    ds_write_b64 v34, v[232:233] offset:1152

    s_waitcnt vmcnt(4)
    v_lshl_or_b32 v236, v237, 16, v236
    v_lshl_or_b32 v237, v239, 16, v238
    v_add_u32 v236, v32, v236
    v_add_u32 v237, v33, v237

    ds_write_b64 v34, v[236:237] offset:1728

    s_waitcnt vmcnt(3)
    v_lshl_or_b32 v240, v241, 16, v240
    v_lshl_or_b32 v241, v243, 16, v242
    v_add_u32 v240, v32, v240
    v_add_u32 v241, v33, v241

    ds_write_b64 v34, v[240:241] offset:2304

    s_waitcnt vmcnt(2)
    v_lshl_or_b32 v244, v245, 16, v244
    v_lshl_or_b32 v245, v247, 16, v246
    v_add_u32 v244, v32, v244
    v_add_u32 v245, v33, v245

    ds_write_b64 v34, v[244:245] offset:2880

    s_waitcnt vmcnt(1)
    v_lshl_or_b32 v248, v249, 16, v248
    v_lshl_or_b32 v249, v251, 16, v250
    v_add_u32 v248, v32, v248
    v_add_u32 v249, v33, v249

    ds_write_b64 v34, v[248:249] offset:3456

    s_waitcnt vmcnt(0)
    v_lshl_or_b32 v252, v253, 16, v252
    v_lshl_or_b32 v253, v255, 16, v254
    v_add_u32 v252, v32, v252
    v_add_u32 v253, v33, v253

    ds_write_b64 v34, v[252:253] offset:4032
    s_mov_b64 exec, -1
    ds_read_b64 v[40:41], v31 offset:8
    ds_read_b64 v[42:43], v31 offset:16
    ds_read_b64 v[44:45], v31 offset:24
    ds_read_b64 v[46:47], v31 offset:32
    ds_read_b64 v[48:49], v31 offset:40
    ds_read_b64 v[50:51], v31 offset:48
    ds_read_b64 v[52:53], v31 offset:56
    ds_read_b64 v[54:55], v31 offset:64

    s_waitcnt lgkmcnt(7)
    v_perm_b32 v60, v41, v40, s75
    v_lshlrev_b32 v72, 2, v60

    v_lshrrev_b32 v61, 3, v60
    v_and_b32 v60, 0x07070707, v60
    v_and_or_b32 v0, v61, s67, v27
    v_perm_b32 v16, v58, v57, v60
    v_add_u32 v64, v57, v16

    s_waitcnt lgkmcnt(6)
    v_perm_b32 v60, v43, v42, s75
    v_lshlrev_b32 v73, 2, v60

    v_lshrrev_b32 v61, 3, v60
    v_and_b32 v60, 0x07070707, v60
    v_and_or_b32 v1, v61, s67, v27
    v_perm_b32 v17, v58, v57, v60
    v_add_u32 v65, v57, v17

    s_waitcnt lgkmcnt(5)
    v_perm_b32 v60, v45, v44, s75
    v_lshlrev_b32 v74, 2, v60

    v_lshrrev_b32 v61, 3, v60
    v_and_b32 v60, 0x07070707, v60
    v_and_or_b32 v2, v61, s67, v27
    v_perm_b32 v18, v58, v57, v60
    v_add_u32 v66, v57, v18

    s_waitcnt lgkmcnt(4)
    v_perm_b32 v60, v47, v46, s75
    v_lshlrev_b32 v75, 2, v60

    v_lshrrev_b32 v61, 3, v60
    v_and_b32 v60, 0x07070707, v60
    v_and_or_b32 v3, v61, s67, v27
    v_perm_b32 v19, v58, v57, v60
    v_add_u32 v67, v57, v19

    s_waitcnt lgkmcnt(3)
    v_perm_b32 v60, v49, v48, s75
    v_lshlrev_b32 v76, 2, v60

    v_lshrrev_b32 v61, 3, v60
    v_and_b32 v60, 0x07070707, v60
    v_and_or_b32 v4, v61, s67, v27
    v_perm_b32 v20, v58, v57, v60
    v_add_u32 v68, v57, v20

    s_waitcnt lgkmcnt(2)
    v_perm_b32 v60, v51, v50, s75
    v_lshlrev_b32 v77, 2, v60

    v_lshrrev_b32 v61, 3, v60
    v_and_b32 v60, 0x07070707, v60
    v_and_or_b32 v5, v61, s67, v27
    v_perm_b32 v21, v58, v57, v60
    v_add_u32 v69, v57, v21

    s_waitcnt lgkmcnt(1)
    v_perm_b32 v60, v53, v52, s75
    v_lshlrev_b32 v78, 2, v60

    v_lshrrev_b32 v61, 3, v60
    v_and_b32 v60, 0x07070707, v60
    v_and_or_b32 v6, v61, s67, v27
    v_perm_b32 v22, v58, v57, v60
    v_add_u32 v70, v57, v22

    s_waitcnt lgkmcnt(0)
    v_perm_b32 v60, v55, v54, s75
    v_lshlrev_b32 v79, 2, v60

    v_lshrrev_b32 v61, 3, v60
    v_and_b32 v60, 0x07070707, v60
    v_and_or_b32 v7, v61, s67, v27
    v_perm_b32 v23, v58, v57, v60
    v_add_u32 v71, v57, v23

    ds_write_b32 v86, v13
    s_cmp_eq_u32 s59, 3
    s_cbranch_scc1 standalone__deep_cross_pnn__recsys_kernel_sk1
    v_add_u32 v63, v58, v16
    v_ffbl_b32 v84, v59
    v_perm_b32 v60, v72, v72, v84
    v_and_or_b32 v60, v60, s66, v85
    ds_add_rtn_u32 v87, v60, v10
    ds_wrxchg_rtn_b32 v116, v86, v13

    s_waitcnt lgkmcnt(0)
    v_cmp_gt_u32 s[68:69], 2, v116

    v_cmp_eq_u32 s[72:73], 0, v116
    s_nop 0
    v_cmpx_le_u32 vcc, 2, v87
    v_mov_b32 v62, s69
    v_mov_b32 v123, s73
    v_perm_b32 v121, v62, s68, v1
    v_perm_b32 v122, v123, s72, v0
    v_and_b32 v121, v121, v17
    v_and_b32 v122, v122, v16
    v_msad_u8 v120, v65, v121, 0
    v_lshlrev_b32 v120, 8, v120
    v_msad_u8 v120, v63, v122, v120
    v_and_b32 v120, v120, v59

    v_ffbl_b32 v120, v120
    v_max_i32 v84, v84, v120
    s_mov_b64 exec, -1
    v_lshl_add_u32 v59, -1, v84, v59

    v_lshl_add_u32 v61, v84, 1, v31
    ds_read_u16 v80, v61 offset:0
    s_setprio 0
    v_ffbl_b32 v84, v59
    v_perm_b32 v60, v72, v72, v84
    v_and_or_b32 v60, v60, s66, v85
    ds_add_rtn_u32 v87, v60, v10
    ds_wrxchg_rtn_b32 v116, v86, v13

    s_waitcnt lgkmcnt(0)
    v_cmp_gt_u32 s[68:69], 2, v116

    v_cmp_eq_u32 s[72:73], 0, v116
    s_nop 0
    v_cmpx_le_u32 vcc, 2, v87
    v_mov_b32 v62, s69
    v_mov_b32 v123, s73
    v_perm_b32 v121, v62, s68, v1
    v_perm_b32 v122, v123, s72, v0
    v_and_b32 v121, v121, v17
    v_and_b32 v122, v122, v16
    v_msad_u8 v120, v65, v121, 0
    v_lshlrev_b32 v120, 8, v120
    v_msad_u8 v120, v63, v122, v120
    v_and_b32 v120, v120, v59

    v_ffbl_b32 v120, v120
    v_max_i32 v84, v84, v120
    s_mov_b64 exec, -1
    v_lshl_add_u32 v59, -1, v84, v59

    v_lshl_add_u32 v61, v84, 1, v31
    ds_read_u16 v81, v61 offset:0
    s_setprio 1
    v_ffbl_b32 v84, v59
    v_perm_b32 v60, v72, v72, v84
    v_and_or_b32 v60, v60, s66, v85
    ds_add_rtn_u32 v87, v60, v10
    ds_wrxchg_rtn_b32 v116, v86, v13

    s_waitcnt lgkmcnt(0)
    v_cmp_gt_u32 s[68:69], 2, v116

    v_cmp_eq_u32 s[72:73], 0, v116
    s_nop 0
    v_cmpx_le_u32 vcc, 2, v87
    v_mov_b32 v62, s69
    v_mov_b32 v123, s73
    v_perm_b32 v121, v62, s68, v1
    v_perm_b32 v122, v123, s72, v0
    v_and_b32 v121, v121, v17
    v_and_b32 v122, v122, v16
    v_msad_u8 v120, v65, v121, 0
    v_lshlrev_b32 v120, 8, v120
    v_msad_u8 v120, v63, v122, v120
    v_and_b32 v120, v120, v59

    v_ffbl_b32 v120, v120
    v_max_i32 v84, v84, v120
    s_mov_b64 exec, -1
    v_lshl_add_u32 v59, -1, v84, v59

    v_lshl_add_u32 v61, v84, 1, v31
    ds_read_u16 v82, v61 offset:0
    s_setprio 0
    v_ffbl_b32 v84, v59
    v_perm_b32 v60, v72, v72, v84
    v_and_or_b32 v60, v60, s66, v85
    ds_add_rtn_u32 v87, v60, v10
    ds_wrxchg_rtn_b32 v116, v86, v13

    s_waitcnt lgkmcnt(0)
    v_cmp_gt_u32 s[68:69], 2, v116

    s_nop 0
    v_cmpx_le_u32 vcc, 2, v87
    v_mov_b32 v62, s69
    v_perm_b32 v121, v62, s68, v1
    v_and_b32 v121, v121, v17
    v_msad_u8 v120, v65, v121, 0
    v_and_b32_sdwa v120, v120, v59 dst_sel:BYTE_1 dst_unused:UNUSED_PAD src0_sel:DWORD src1_sel:BYTE_1
    s_nop 0

    v_ffbl_b32 v120, v120
    v_max_i32 v84, v84, v120
    s_mov_b64 exec, -1
    v_lshl_add_u32 v59, -1, v84, v59

    v_lshl_add_u32 v61, v84, 1, v31
    ds_read_u16 v83, v61 offset:0
standalone__deep_cross_pnn__recsys_kernel_sk1:
    v_lshrrev_b32 v59, 4, v59
    v_add_u32 v63, v58, v17
    s_setprio 1
    v_ffbl_b32 v84, v59
    v_perm_b32 v60, v73, v72, v84
    v_and_or_b32 v60, v60, s66, v85

    v_cmpx_ge_u32 vcc, 0, v84
    ds_add_u32 v60, v10
    s_not_b64 s[70:71], vcc
    s_mov_b64 exec, s[70:71]
    ds_add_rtn_u32 v87, v60, v10
    s_mov_b64 exec, -1

    ds_wrxchg_rtn_b32 v116, v86, v13
    v_lshlrev_b32 v104, 13, v8
    s_cmp_eq_u32 s64, 0
    s_cselect_b32 s45, s4, 0
    s_and_b32 exec_lo, s45, 3
    s_mov_b32 exec_hi, 0
    buffer_store_dword v13, v104, s[12:15], s9 offen sc1
    s_mov_b64 exec, -1
    buffer_load_dwordx4 v[128:131], v15, s[28:31], s77 offen offset:0
    buffer_load_dwordx4 v[160:163], v15, s[28:31], s77 offen offset:512

    s_waitcnt lgkmcnt(0)
    v_cmp_gt_u32 s[68:69], 2, v116

    v_cmp_eq_u32 s[72:73], 0, v116
    s_cmp_eq_u32 s59, 3
    s_cbranch_scc1 standalone__deep_cross_pnn__recsys_kernel_nf1
    v_lshl_or_b32 v24, v81, 16, v80
    v_lshl_or_b32 v25, v83, 16, v82
    buffer_store_dwordx2 v[24:25], v30, s[32:35], s62 offen sc1
    s_add_u32 s62, s62, s63
standalone__deep_cross_pnn__recsys_kernel_nf1:
    s_mov_b64 exec, s[70:71]
    v_cmpx_le_u32 vcc, 2, v87
    v_mov_b32 v62, s69
    v_mov_b32 v123, s73
    v_perm_b32 v121, v62, s68, v2
    v_perm_b32 v122, v123, s72, v1
    v_and_b32 v121, v121, v18
    v_and_b32 v122, v122, v17
    v_msad_u8 v120, v66, v121, 0
    v_lshlrev_b32 v120, 8, v120
    v_msad_u8 v120, v63, v122, v120
    v_and_b32 v120, v120, v59

    v_ffbl_b32 v120, v120
    v_max_i32 v84, v84, v120
    s_mov_b64 exec, -1
    v_lshl_add_u32 v59, -1, v84, v59

    v_lshl_add_u32 v61, v84, 1, v31
    ds_read_u16 v80, v61 offset:8
    s_setprio 0
    v_ffbl_b32 v84, v59
    v_perm_b32 v60, v73, v72, v84
    v_and_or_b32 v60, v60, s66, v85

    v_cmpx_ge_u32 vcc, 1, v84
    ds_add_u32 v60, v10
    s_not_b64 s[70:71], vcc
    s_mov_b64 exec, s[70:71]
    ds_add_rtn_u32 v87, v60, v10
    s_mov_b64 exec, -1

    ds_wrxchg_rtn_b32 v116, v86, v13
    s_mov_b64 exec, s[4:5]
    buffer_load_dwordx4 v[104:107], v56, s[20:23], s44 offen
    s_mov_b64 exec, -1
    buffer_load_dwordx4 v[132:135], v15, s[28:31], s77 offen offset:1024
    buffer_load_dwordx4 v[164:167], v15, s[28:31], s77 offen offset:1536

    s_waitcnt lgkmcnt(0)
    v_cmp_gt_u32 s[68:69], 2, v116

    v_cmp_eq_u32 s[72:73], 0, v116
    s_mov_b64 exec, s[70:71]
    v_cmpx_le_u32 vcc, 2, v87
    v_mov_b32 v62, s69
    v_mov_b32 v123, s73
    v_perm_b32 v121, v62, s68, v2
    v_perm_b32 v122, v123, s72, v1
    v_and_b32 v121, v121, v18
    v_and_b32 v122, v122, v17
    v_msad_u8 v120, v66, v121, 0
    v_lshlrev_b32 v120, 8, v120
    v_msad_u8 v120, v63, v122, v120
    v_and_b32 v120, v120, v59

    v_ffbl_b32 v120, v120
    v_max_i32 v84, v84, v120
    s_mov_b64 exec, -1
    v_lshl_add_u32 v59, -1, v84, v59

    v_lshl_add_u32 v61, v84, 1, v31
    ds_read_u16 v81, v61 offset:8
    s_setprio 1
    v_ffbl_b32 v84, v59
    v_perm_b32 v60, v73, v72, v84
    v_and_or_b32 v60, v60, s66, v85

    v_cmpx_ge_u32 vcc, 2, v84
    ds_add_u32 v60, v10
    s_not_b64 s[70:71], vcc
    s_mov_b64 exec, s[70:71]
    ds_add_rtn_u32 v87, v60, v10
    s_mov_b64 exec, -1

    ds_wrxchg_rtn_b32 v116, v86, v13
    buffer_load_dwordx4 v[136:139], v15, s[28:31], s77 offen offset:2048
    buffer_load_dwordx4 v[168:171], v15, s[28:31], s77 offen offset:2560

    s_waitcnt lgkmcnt(0)
    v_cmp_gt_u32 s[68:69], 2, v116

    v_cmp_eq_u32 s[72:73], 0, v116
    s_mov_b64 exec, s[70:71]
    v_cmpx_le_u32 vcc, 2, v87
    v_mov_b32 v62, s69
    v_mov_b32 v123, s73
    v_perm_b32 v121, v62, s68, v2
    v_perm_b32 v122, v123, s72, v1
    v_and_b32 v121, v121, v18
    v_and_b32 v122, v122, v17
    v_msad_u8 v120, v66, v121, 0
    v_lshlrev_b32 v120, 8, v120
    v_msad_u8 v120, v63, v122, v120
    v_and_b32 v120, v120, v59

    v_ffbl_b32 v120, v120
    v_max_i32 v84, v84, v120
    s_mov_b64 exec, -1
    v_lshl_add_u32 v59, -1, v84, v59

    v_lshl_add_u32 v61, v84, 1, v31
    ds_read_u16 v82, v61 offset:8
    s_setprio 0
    v_ffbl_b32 v84, v59
    v_perm_b32 v60, v73, v72, v84
    v_and_or_b32 v60, v60, s66, v85

    v_cmpx_ge_u32 vcc, 3, v84
    ds_add_u32 v60, v10
    s_not_b64 s[70:71], vcc
    s_mov_b64 exec, s[70:71]
    ds_add_rtn_u32 v87, v60, v10
    s_mov_b64 exec, -1

    ds_wrxchg_rtn_b32 v116, v86, v13
    buffer_load_dwordx4 v[140:143], v15, s[28:31], s77 offen offset:3072
    buffer_load_dwordx4 v[172:175], v15, s[28:31], s77 offen offset:3584
    s_add_u32 s77, s77, 4096

    s_waitcnt lgkmcnt(0)
    v_cmp_gt_u32 s[68:69], 2, v116

    s_mov_b64 exec, s[70:71]
    v_cmpx_le_u32 vcc, 2, v87
    v_mov_b32 v62, s69
    v_perm_b32 v121, v62, s68, v2
    v_and_b32 v121, v121, v18
    v_msad_u8 v120, v66, v121, 0
    v_and_b32_sdwa v120, v120, v59 dst_sel:BYTE_1 dst_unused:UNUSED_PAD src0_sel:DWORD src1_sel:BYTE_1
    s_nop 0

    v_ffbl_b32 v120, v120
    v_max_i32 v84, v84, v120
    s_mov_b64 exec, -1
    v_lshl_add_u32 v59, -1, v84, v59

    v_lshl_add_u32 v61, v84, 1, v31
    ds_read_u16 v83, v61 offset:8
    v_lshrrev_b32 v59, 4, v59
    v_add_u32 v63, v58, v18
    s_setprio 1
    v_ffbl_b32 v84, v59
    v_perm_b32 v60, v74, v73, v84
    v_and_or_b32 v60, v60, s66, v85

    v_cmpx_ge_u32 vcc, 0, v84
    ds_add_u32 v60, v10
    s_not_b64 s[70:71], vcc
    s_mov_b64 exec, s[70:71]
    ds_add_rtn_u32 v87, v60, v10
    s_mov_b64 exec, -1

    ds_wrxchg_rtn_b32 v116, v86, v13
    buffer_load_dwordx4 v[144:147], v15, s[28:31], s77 offen offset:0
    buffer_load_dwordx4 v[176:179], v15, s[28:31], s77 offen offset:512

    s_waitcnt lgkmcnt(0)
    v_cmp_gt_u32 s[68:69], 2, v116

    v_cmp_eq_u32 s[72:73], 0, v116
    v_lshl_or_b32 v24, v81, 16, v80
    v_lshl_or_b32 v25, v83, 16, v82
    buffer_store_dwordx2 v[24:25], v30, s[32:35], s62 offen sc1
    s_add_u32 s62, s62, s63
    s_mov_b64 exec, s[70:71]
    v_cmpx_le_u32 vcc, 2, v87
    v_mov_b32 v62, s69
    v_mov_b32 v123, s73
    v_perm_b32 v121, v62, s68, v3
    v_perm_b32 v122, v123, s72, v2
    v_and_b32 v121, v121, v19
    v_and_b32 v122, v122, v18
    v_msad_u8 v120, v67, v121, 0
    v_lshlrev_b32 v120, 8, v120
    v_msad_u8 v120, v63, v122, v120
    v_and_b32 v120, v120, v59

    v_ffbl_b32 v120, v120
    v_max_i32 v84, v84, v120
    s_mov_b64 exec, -1
    v_lshl_add_u32 v59, -1, v84, v59

    v_lshl_add_u32 v61, v84, 1, v31
    ds_read_u16 v80, v61 offset:16
    s_setprio 0
    v_ffbl_b32 v84, v59
    v_perm_b32 v60, v74, v73, v84
    v_and_or_b32 v60, v60, s66, v85

    v_cmpx_ge_u32 vcc, 1, v84
    ds_add_u32 v60, v10
    s_not_b64 s[70:71], vcc
    s_mov_b64 exec, s[70:71]
    ds_add_rtn_u32 v87, v60, v10
    s_mov_b64 exec, -1

    ds_wrxchg_rtn_b32 v116, v86, v13
    buffer_load_dwordx4 v[148:151], v15, s[28:31], s77 offen offset:1024
    buffer_load_dwordx4 v[180:183], v15, s[28:31], s77 offen offset:1536

    s_waitcnt lgkmcnt(0)
    v_cmp_gt_u32 s[68:69], 2, v116

    v_cmp_eq_u32 s[72:73], 0, v116
    s_mov_b64 exec, s[70:71]
    v_cmpx_le_u32 vcc, 2, v87
    v_mov_b32 v62, s69
    v_mov_b32 v123, s73
    v_perm_b32 v121, v62, s68, v3
    v_perm_b32 v122, v123, s72, v2
    v_and_b32 v121, v121, v19
    v_and_b32 v122, v122, v18
    v_msad_u8 v120, v67, v121, 0
    v_lshlrev_b32 v120, 8, v120
    v_msad_u8 v120, v63, v122, v120
    v_and_b32 v120, v120, v59

    v_ffbl_b32 v120, v120
    v_max_i32 v84, v84, v120
    s_mov_b64 exec, -1
    v_lshl_add_u32 v59, -1, v84, v59

    v_lshl_add_u32 v61, v84, 1, v31
    ds_read_u16 v81, v61 offset:16
    s_setprio 1
    v_ffbl_b32 v84, v59
    v_perm_b32 v60, v74, v73, v84
    v_and_or_b32 v60, v60, s66, v85

    v_cmpx_ge_u32 vcc, 2, v84
    ds_add_u32 v60, v10
    s_not_b64 s[70:71], vcc
    s_mov_b64 exec, s[70:71]
    ds_add_rtn_u32 v87, v60, v10
    s_mov_b64 exec, -1

    ds_wrxchg_rtn_b32 v116, v86, v13
    s_waitcnt vmcnt(11)
    s_mov_b64 exec, s[4:5]
    buffer_store_dwordx4 v[104:107], v9, s[32:35], s47 offen sc1
    s_mov_b64 exec, -1
    buffer_load_dwordx4 v[152:155], v15, s[28:31], s77 offen offset:2048
    buffer_load_dwordx4 v[184:187], v15, s[28:31], s77 offen offset:2560

    s_waitcnt lgkmcnt(0)
    v_cmp_gt_u32 s[68:69], 2, v116

    v_cmp_eq_u32 s[72:73], 0, v116
    s_mov_b64 exec, s[70:71]
    v_cmpx_le_u32 vcc, 2, v87
    v_mov_b32 v62, s69
    v_mov_b32 v123, s73
    v_perm_b32 v121, v62, s68, v3
    v_perm_b32 v122, v123, s72, v2
    v_and_b32 v121, v121, v19
    v_and_b32 v122, v122, v18
    v_msad_u8 v120, v67, v121, 0
    v_lshlrev_b32 v120, 8, v120
    v_msad_u8 v120, v63, v122, v120
    v_and_b32 v120, v120, v59

    v_ffbl_b32 v120, v120
    v_max_i32 v84, v84, v120
    s_mov_b64 exec, -1
    v_lshl_add_u32 v59, -1, v84, v59

    v_lshl_add_u32 v61, v84, 1, v31
    ds_read_u16 v82, v61 offset:16
    s_setprio 0
    v_ffbl_b32 v84, v59
    v_perm_b32 v60, v74, v73, v84
    v_and_or_b32 v60, v60, s66, v85

    v_cmpx_ge_u32 vcc, 3, v84
    ds_add_u32 v60, v10
    s_not_b64 s[70:71], vcc
    s_mov_b64 exec, s[70:71]
    ds_add_rtn_u32 v87, v60, v10
    s_mov_b64 exec, -1

    ds_wrxchg_rtn_b32 v116, v86, v13
    buffer_load_dwordx4 v[156:159], v15, s[28:31], s77 offen offset:3072
    buffer_load_dwordx4 v[188:191], v15, s[28:31], s77 offen offset:3584

    s_waitcnt lgkmcnt(0)
    v_cmp_gt_u32 s[68:69], 2, v116

    s_mov_b64 exec, s[70:71]
    v_cmpx_le_u32 vcc, 2, v87
    v_mov_b32 v62, s69
    v_perm_b32 v121, v62, s68, v3
    v_and_b32 v121, v121, v19
    v_msad_u8 v120, v67, v121, 0
    v_and_b32_sdwa v120, v120, v59 dst_sel:BYTE_1 dst_unused:UNUSED_PAD src0_sel:DWORD src1_sel:BYTE_1
    s_nop 0

    v_ffbl_b32 v120, v120
    v_max_i32 v84, v84, v120
    s_mov_b64 exec, -1
    v_lshl_add_u32 v59, -1, v84, v59

    v_lshl_add_u32 v61, v84, 1, v31
    ds_read_u16 v83, v61 offset:16
    v_lshrrev_b32 v59, 4, v59
    v_add_u32 v63, v58, v19
    s_setprio 1
    v_ffbl_b32 v84, v59
    v_perm_b32 v60, v75, v74, v84
    v_and_or_b32 v60, v60, s66, v85

    v_cmpx_ge_u32 vcc, 0, v84
    ds_add_u32 v60, v10
    s_not_b64 s[70:71], vcc
    s_mov_b64 exec, s[70:71]
    ds_add_rtn_u32 v87, v60, v10
    s_mov_b64 exec, -1

    ds_wrxchg_rtn_b32 v116, v86, v13

    s_waitcnt lgkmcnt(0)
    v_cmp_gt_u32 s[68:69], 2, v116

    v_cmp_eq_u32 s[72:73], 0, v116
    v_lshl_or_b32 v24, v81, 16, v80
    v_lshl_or_b32 v25, v83, 16, v82
    buffer_store_dwordx2 v[24:25], v30, s[32:35], s62 offen sc1
    s_add_u32 s62, s62, s63
    s_mov_b64 exec, s[70:71]
    v_cmpx_le_u32 vcc, 2, v87
    v_mov_b32 v62, s69
    v_mov_b32 v123, s73
    v_perm_b32 v121, v62, s68, v4
    v_perm_b32 v122, v123, s72, v3
    v_and_b32 v121, v121, v20
    v_and_b32 v122, v122, v19
    v_msad_u8 v120, v68, v121, 0
    v_lshlrev_b32 v120, 8, v120
    v_msad_u8 v120, v63, v122, v120
    v_and_b32 v120, v120, v59

    v_ffbl_b32 v120, v120
    v_max_i32 v84, v84, v120
    s_mov_b64 exec, -1
    v_lshl_add_u32 v59, -1, v84, v59

    v_lshl_add_u32 v61, v84, 1, v31
    ds_read_u16 v80, v61 offset:24
    s_setprio 0
    v_ffbl_b32 v84, v59
    v_perm_b32 v60, v75, v74, v84
    v_and_or_b32 v60, v60, s66, v85

    v_cmpx_ge_u32 vcc, 1, v84
    ds_add_u32 v60, v10
    s_not_b64 s[70:71], vcc
    s_mov_b64 exec, s[70:71]
    ds_add_rtn_u32 v87, v60, v10
    s_mov_b64 exec, -1

    ds_wrxchg_rtn_b32 v116, v86, v13

    s_waitcnt lgkmcnt(0)
    v_cmp_gt_u32 s[68:69], 2, v116

    v_cmp_eq_u32 s[72:73], 0, v116
    s_mov_b64 exec, s[70:71]
    v_cmpx_le_u32 vcc, 2, v87
    v_mov_b32 v62, s69
    v_mov_b32 v123, s73
    v_perm_b32 v121, v62, s68, v4
    v_perm_b32 v122, v123, s72, v3
    v_and_b32 v121, v121, v20
    v_and_b32 v122, v122, v19
    v_msad_u8 v120, v68, v121, 0
    v_lshlrev_b32 v120, 8, v120
    v_msad_u8 v120, v63, v122, v120
    v_and_b32 v120, v120, v59

    v_ffbl_b32 v120, v120
    v_max_i32 v84, v84, v120
    s_mov_b64 exec, -1
    v_lshl_add_u32 v59, -1, v84, v59

    v_lshl_add_u32 v61, v84, 1, v31
    ds_read_u16 v81, v61 offset:24
    s_setprio 1

    s_cmp_ge_u32 s57, 800
    s_cbranch_scc1 standalone__deep_cross_pnn__recsys_kernel_norl
    s_waitcnt vmcnt(0)

    s_lshl_b32 s39, 1, s2
    s_cmp_eq_u32 s64, 0
    s_cselect_b32 s39, s39, 0

    s_lshr_b32 s38, s2, 5
    v_mov_b32 v60, s39
    s_lshl_b32 s38, s38, 4
    s_and_b64 exec, s[4:5], 1
    buffer_atomic_or v60, v13, s[52:55], s38 offen offset:128
    s_mov_b64 exec, -1

standalone__deep_cross_pnn__recsys_kernel_norl:
standalone__deep_cross_pnn__recsys_kernel_rld:
    v_ffbl_b32 v84, v59
    v_perm_b32 v60, v75, v74, v84
    v_and_or_b32 v60, v60, s66, v85

    v_cmpx_ge_u32 vcc, 2, v84
    ds_add_u32 v60, v10
    s_not_b64 s[70:71], vcc
    s_mov_b64 exec, s[70:71]
    ds_add_rtn_u32 v87, v60, v10
    s_mov_b64 exec, -1

    ds_wrxchg_rtn_b32 v116, v86, v13
    s_cmp_ge_u32 s57, 800
    s_cbranch_scc1 standalone__deep_cross_pnn__recsys_kernel_nr14
    v_perm_b32 v192, v132, v128, s84
    v_perm_b32 v193, v140, v136, s84
    v_perm_b32 v194, v148, v144, s84
    v_perm_b32 v195, v156, v152, s84
    s_add_u32 s83, s82, 0
    buffer_store_dwordx4 v[192:195], v14, s[32:35], s83 offen sc1
    v_perm_b32 v196, v132, v128, s85
    v_perm_b32 v197, v140, v136, s85
    v_perm_b32 v198, v148, v144, s85
    v_perm_b32 v199, v156, v152, s85
    s_add_u32 s83, s82, 102656
    buffer_store_dwordx4 v[196:199], v14, s[32:35], s83 offen sc1
standalone__deep_cross_pnn__recsys_kernel_nr14:

    s_waitcnt lgkmcnt(0)
    v_cmp_gt_u32 s[68:69], 2, v116

    v_cmp_eq_u32 s[72:73], 0, v116
    s_mov_b64 exec, s[70:71]
    v_cmpx_le_u32 vcc, 2, v87
    v_mov_b32 v62, s69
    v_mov_b32 v123, s73
    v_perm_b32 v121, v62, s68, v4
    v_perm_b32 v122, v123, s72, v3
    v_and_b32 v121, v121, v20
    v_and_b32 v122, v122, v19
    v_msad_u8 v120, v68, v121, 0
    v_lshlrev_b32 v120, 8, v120
    v_msad_u8 v120, v63, v122, v120
    v_and_b32 v120, v120, v59

    v_ffbl_b32 v120, v120
    v_max_i32 v84, v84, v120
    s_mov_b64 exec, -1
    v_lshl_add_u32 v59, -1, v84, v59

    v_lshl_add_u32 v61, v84, 1, v31
    ds_read_u16 v82, v61 offset:24
    v_ffbl_b32 v84, v59
    v_perm_b32 v60, v75, v74, v84
    v_and_or_b32 v60, v60, s66, v85

    v_cmpx_ge_u32 vcc, 3, v84
    ds_add_u32 v60, v10
    s_not_b64 s[70:71], vcc
    s_mov_b64 exec, s[70:71]
    ds_add_rtn_u32 v87, v60, v10
    s_mov_b64 exec, -1

    ds_wrxchg_rtn_b32 v116, v86, v13
    s_cmp_ge_u32 s57, 800
    s_cbranch_scc1 standalone__deep_cross_pnn__recsys_kernel_nr15
    v_perm_b32 v200, v133, v129, s84
    v_perm_b32 v201, v141, v137, s84
    v_perm_b32 v202, v149, v145, s84
    v_perm_b32 v203, v157, v153, s84
    s_add_u32 s83, s82, 205312
    buffer_store_dwordx4 v[200:203], v14, s[32:35], s83 offen sc1
    v_perm_b32 v204, v133, v129, s85
    v_perm_b32 v205, v141, v137, s85
    v_perm_b32 v206, v149, v145, s85
    v_perm_b32 v207, v157, v153, s85
    s_add_u32 s83, s82, 307968
    buffer_store_dwordx4 v[204:207], v14, s[32:35], s83 offen sc1
standalone__deep_cross_pnn__recsys_kernel_nr15:

    s_waitcnt lgkmcnt(0)
    v_cmp_gt_u32 s[68:69], 2, v116

    s_mov_b64 exec, s[70:71]
    v_cmpx_le_u32 vcc, 2, v87
    v_mov_b32 v62, s69
    v_perm_b32 v121, v62, s68, v4
    v_and_b32 v121, v121, v20
    v_msad_u8 v120, v68, v121, 0
    v_and_b32_sdwa v120, v120, v59 dst_sel:BYTE_1 dst_unused:UNUSED_PAD src0_sel:DWORD src1_sel:BYTE_1
    s_nop 0

    v_ffbl_b32 v120, v120
    v_max_i32 v84, v84, v120
    s_mov_b64 exec, -1
    v_lshl_add_u32 v59, -1, v84, v59

    v_lshl_add_u32 v61, v84, 1, v31
    ds_read_u16 v83, v61 offset:24
    v_lshrrev_b32 v59, 4, v59
    v_add_u32 v63, v58, v20
    v_ffbl_b32 v84, v59
    v_perm_b32 v60, v76, v75, v84
    v_and_or_b32 v60, v60, s66, v85

    v_cmpx_ge_u32 vcc, 0, v84
    ds_add_u32 v60, v10
    s_not_b64 s[70:71], vcc
    s_mov_b64 exec, s[70:71]
    ds_add_rtn_u32 v87, v60, v10
    s_mov_b64 exec, -1

    ds_wrxchg_rtn_b32 v116, v86, v13
    s_cmp_ge_u32 s57, 800
    s_cbranch_scc1 standalone__deep_cross_pnn__recsys_kernel_nr16
    v_perm_b32 v208, v134, v130, s84
    v_perm_b32 v209, v142, v138, s84
    v_perm_b32 v210, v150, v146, s84
    v_perm_b32 v211, v158, v154, s84
    s_add_u32 s83, s82, 410624
    buffer_store_dwordx4 v[208:211], v14, s[32:35], s83 offen sc1
    v_perm_b32 v212, v134, v130, s85
    v_perm_b32 v213, v142, v138, s85
    v_perm_b32 v214, v150, v146, s85
    v_perm_b32 v215, v158, v154, s85
    s_add_u32 s83, s82, 513280
    buffer_store_dwordx4 v[212:215], v14, s[32:35], s83 offen sc1
standalone__deep_cross_pnn__recsys_kernel_nr16:

    s_waitcnt lgkmcnt(0)
    v_cmp_gt_u32 s[68:69], 2, v116

    v_cmp_eq_u32 s[72:73], 0, v116
    v_lshl_or_b32 v24, v81, 16, v80
    v_lshl_or_b32 v25, v83, 16, v82
    buffer_store_dwordx2 v[24:25], v30, s[32:35], s62 offen sc1
    s_add_u32 s62, s62, s63
    s_mov_b64 exec, s[70:71]
    v_cmpx_le_u32 vcc, 2, v87
    v_mov_b32 v62, s69
    v_mov_b32 v123, s73
    v_perm_b32 v121, v62, s68, v5
    v_perm_b32 v122, v123, s72, v4
    v_and_b32 v121, v121, v21
    v_and_b32 v122, v122, v20
    v_msad_u8 v120, v69, v121, 0
    v_lshlrev_b32 v120, 8, v120
    v_msad_u8 v120, v63, v122, v120
    v_and_b32 v120, v120, v59

    v_ffbl_b32 v120, v120
    v_max_i32 v84, v84, v120
    s_mov_b64 exec, -1
    v_lshl_add_u32 v59, -1, v84, v59

    v_lshl_add_u32 v61, v84, 1, v31
    ds_read_u16 v80, v61 offset:32
    s_setprio 0
    v_ffbl_b32 v84, v59
    v_perm_b32 v60, v76, v75, v84
    v_and_or_b32 v60, v60, s66, v85

    v_cmpx_ge_u32 vcc, 1, v84
    ds_add_u32 v60, v10
    s_not_b64 s[70:71], vcc
    s_mov_b64 exec, s[70:71]
    ds_add_rtn_u32 v87, v60, v10
    s_mov_b64 exec, -1

    ds_wrxchg_rtn_b32 v116, v86, v13
    s_cmp_ge_u32 s57, 800
    s_cbranch_scc1 standalone__deep_cross_pnn__recsys_kernel_nr17
    v_perm_b32 v216, v135, v131, s84
    v_perm_b32 v217, v143, v139, s84
    v_perm_b32 v218, v151, v147, s84
    v_perm_b32 v219, v159, v155, s84
    s_add_u32 s83, s82, 615936
    buffer_store_dwordx4 v[216:219], v14, s[32:35], s83 offen sc1
    v_perm_b32 v220, v135, v131, s85
    v_perm_b32 v221, v143, v139, s85
    v_perm_b32 v222, v151, v147, s85
    v_perm_b32 v223, v159, v155, s85
    s_add_u32 s83, s82, 718592
    buffer_store_dwordx4 v[220:223], v14, s[32:35], s83 offen sc1
standalone__deep_cross_pnn__recsys_kernel_nr17:

    s_waitcnt lgkmcnt(0)
    v_cmp_gt_u32 s[68:69], 2, v116

    v_cmp_eq_u32 s[72:73], 0, v116
    s_mov_b64 exec, s[70:71]
    v_cmpx_le_u32 vcc, 2, v87
    v_mov_b32 v62, s69
    v_mov_b32 v123, s73
    v_perm_b32 v121, v62, s68, v5
    v_perm_b32 v122, v123, s72, v4
    v_and_b32 v121, v121, v21
    v_and_b32 v122, v122, v20
    v_msad_u8 v120, v69, v121, 0
    v_lshlrev_b32 v120, 8, v120
    v_msad_u8 v120, v63, v122, v120
    v_and_b32 v120, v120, v59

    v_ffbl_b32 v120, v120
    v_max_i32 v84, v84, v120
    s_mov_b64 exec, -1
    v_lshl_add_u32 v59, -1, v84, v59

    v_lshl_add_u32 v61, v84, 1, v31
    ds_read_u16 v81, v61 offset:32
    s_setprio 1
    v_ffbl_b32 v84, v59
    v_perm_b32 v60, v76, v75, v84
    v_and_or_b32 v60, v60, s66, v85

    v_cmpx_ge_u32 vcc, 2, v84
    ds_add_u32 v60, v10
    s_not_b64 s[70:71], vcc
    s_mov_b64 exec, s[70:71]
    ds_add_rtn_u32 v87, v60, v10
    s_mov_b64 exec, -1

    ds_wrxchg_rtn_b32 v116, v86, v13
    s_cmp_ge_u32 s57, 800
    s_cbranch_scc1 standalone__deep_cross_pnn__recsys_kernel_nr18
    v_perm_b32 v224, v164, v160, s84
    v_perm_b32 v225, v172, v168, s84
    v_perm_b32 v226, v180, v176, s84
    v_perm_b32 v227, v188, v184, s84
    s_add_u32 s83, s82, 6569984
    buffer_store_dwordx4 v[224:227], v14, s[32:35], s83 offen sc1
    v_perm_b32 v228, v164, v160, s85
    v_perm_b32 v229, v172, v168, s85
    v_perm_b32 v230, v180, v176, s85
    v_perm_b32 v231, v188, v184, s85
    s_add_u32 s83, s82, 6672640
    buffer_store_dwordx4 v[228:231], v14, s[32:35], s83 offen sc1
standalone__deep_cross_pnn__recsys_kernel_nr18:

    s_waitcnt lgkmcnt(0)
    v_cmp_gt_u32 s[68:69], 2, v116

    v_cmp_eq_u32 s[72:73], 0, v116
    s_mov_b64 exec, s[70:71]
    v_cmpx_le_u32 vcc, 2, v87
    v_mov_b32 v62, s69
    v_mov_b32 v123, s73
    v_perm_b32 v121, v62, s68, v5
    v_perm_b32 v122, v123, s72, v4
    v_and_b32 v121, v121, v21
    v_and_b32 v122, v122, v20
    v_msad_u8 v120, v69, v121, 0
    v_lshlrev_b32 v120, 8, v120
    v_msad_u8 v120, v63, v122, v120
    v_and_b32 v120, v120, v59

    v_ffbl_b32 v120, v120
    v_max_i32 v84, v84, v120
    s_mov_b64 exec, -1
    v_lshl_add_u32 v59, -1, v84, v59

    v_lshl_add_u32 v61, v84, 1, v31
    ds_read_u16 v82, v61 offset:32
    v_ffbl_b32 v84, v59
    v_perm_b32 v60, v76, v75, v84
    v_and_or_b32 v60, v60, s66, v85

    v_cmpx_ge_u32 vcc, 3, v84
    ds_add_u32 v60, v10
    s_not_b64 s[70:71], vcc
    s_mov_b64 exec, s[70:71]
    ds_add_rtn_u32 v87, v60, v10
    s_mov_b64 exec, -1

    ds_wrxchg_rtn_b32 v116, v86, v13
    s_cmp_ge_u32 s57, 800
    s_cbranch_scc1 standalone__deep_cross_pnn__recsys_kernel_nr19
    v_perm_b32 v232, v165, v161, s84
    v_perm_b32 v233, v173, v169, s84
    v_perm_b32 v234, v181, v177, s84
    v_perm_b32 v235, v189, v185, s84
    s_add_u32 s83, s82, 6775296
    buffer_store_dwordx4 v[232:235], v14, s[32:35], s83 offen sc1
    v_perm_b32 v236, v165, v161, s85
    v_perm_b32 v237, v173, v169, s85
    v_perm_b32 v238, v181, v177, s85
    v_perm_b32 v239, v189, v185, s85
    s_add_u32 s83, s82, 6877952
    buffer_store_dwordx4 v[236:239], v14, s[32:35], s83 offen sc1
standalone__deep_cross_pnn__recsys_kernel_nr19:

    s_waitcnt lgkmcnt(0)
    v_cmp_gt_u32 s[68:69], 2, v116

    s_mov_b64 exec, s[70:71]
    v_cmpx_le_u32 vcc, 2, v87
    v_mov_b32 v62, s69
    v_perm_b32 v121, v62, s68, v5
    v_and_b32 v121, v121, v21
    v_msad_u8 v120, v69, v121, 0
    v_and_b32_sdwa v120, v120, v59 dst_sel:BYTE_1 dst_unused:UNUSED_PAD src0_sel:DWORD src1_sel:BYTE_1
    s_nop 0

    v_ffbl_b32 v120, v120
    v_max_i32 v84, v84, v120
    s_mov_b64 exec, -1
    v_lshl_add_u32 v59, -1, v84, v59

    v_lshl_add_u32 v61, v84, 1, v31
    ds_read_u16 v83, v61 offset:32
    v_lshrrev_b32 v59, 4, v59
    v_add_u32 v63, v58, v21

    s_bitcmp0_b32 s59, 0
    s_cbranch_scc1 standalone__deep_cross_pnn__recsys_kernel_mg2
    v_mov_b32 v60, s46
    v_subrev_u32 v61, 512, v86

standalone__deep_cross_pnn__recsys_kernel_mg1:

    ds_read_b32 v12, v60
    ds_read_b32 v120, v61
    s_waitcnt lgkmcnt(0)
    v_readfirstlane_b32 s45, v12
    s_cmp_lg_u32 s45, 0
    s_cbranch_scc1 standalone__deep_cross_pnn__recsys_kernel_mg3
    s_sleep 2
    s_branch standalone__deep_cross_pnn__recsys_kernel_mg1

standalone__deep_cross_pnn__recsys_kernel_mg3:

    ds_write_b32 v60, v13
    s_mov_b32 s45, 0xff00
    v_lshl_or_b32 v120, v120, 8, v120
    v_and_or_b32 v59, v120, s45, v59

standalone__deep_cross_pnn__recsys_kernel_mg2:
    v_ffbl_b32 v84, v59
    v_perm_b32 v60, v77, v76, v84
    v_and_or_b32 v60, v60, s66, v85

    v_cmpx_ge_u32 vcc, 0, v84
    ds_add_u32 v60, v10
    s_not_b64 s[70:71], vcc
    s_mov_b64 exec, s[70:71]
    ds_add_rtn_u32 v87, v60, v10
    s_mov_b64 exec, -1

    ds_wrxchg_rtn_b32 v116, v86, v13
    s_cmp_ge_u32 s57, 800
    s_cbranch_scc1 standalone__deep_cross_pnn__recsys_kernel_nr20
    v_perm_b32 v240, v166, v162, s84
    v_perm_b32 v241, v174, v170, s84
    v_perm_b32 v242, v182, v178, s84
    v_perm_b32 v243, v190, v186, s84
    s_add_u32 s83, s82, 6980608
    buffer_store_dwordx4 v[240:243], v14, s[32:35], s83 offen sc1
    v_perm_b32 v244, v166, v162, s85
    v_perm_b32 v245, v174, v170, s85
    v_perm_b32 v246, v182, v178, s85
    v_perm_b32 v247, v190, v186, s85
    s_add_u32 s83, s82, 7083264
    buffer_store_dwordx4 v[244:247], v14, s[32:35], s83 offen sc1
standalone__deep_cross_pnn__recsys_kernel_nr20:
    buffer_store_dwordx4 v[108:111], v9, s[12:15], s6 offen offset:0 sc1
    buffer_store_dwordx4 v[108:111], v9, s[12:15], s6 offen offset:1024 sc1

    s_waitcnt lgkmcnt(0)
    v_cmp_gt_u32 s[68:69], 2, v116

    v_cmp_eq_u32 s[72:73], 0, v116
    v_lshl_or_b32 v24, v81, 16, v80
    v_lshl_or_b32 v25, v83, 16, v82
    buffer_store_dwordx2 v[24:25], v30, s[32:35], s62 offen sc1
    s_add_u32 s62, s62, s63
    s_mov_b64 exec, s[70:71]
    v_cmpx_le_u32 vcc, 2, v87
    v_mov_b32 v62, s69
    v_mov_b32 v123, s73
    v_perm_b32 v121, v62, s68, v6
    v_perm_b32 v122, v123, s72, v5
    v_and_b32 v121, v121, v22
    v_and_b32 v122, v122, v21
    v_msad_u8 v120, v70, v121, 0
    v_lshlrev_b32 v120, 8, v120
    v_msad_u8 v120, v63, v122, v120
    v_and_b32 v120, v120, v59

    v_ffbl_b32 v120, v120
    v_max_i32 v84, v84, v120
    s_mov_b64 exec, -1
    v_lshl_add_u32 v59, -1, v84, v59

    v_lshl_add_u32 v61, v84, 1, v31
    ds_read_u16 v80, v61 offset:40
    s_setprio 0
    v_ffbl_b32 v84, v59
    v_perm_b32 v60, v77, v76, v84
    v_and_or_b32 v60, v60, s66, v85

    v_cmpx_ge_u32 vcc, 1, v84
    ds_add_u32 v60, v10
    s_not_b64 s[70:71], vcc
    s_mov_b64 exec, s[70:71]
    ds_add_rtn_u32 v87, v60, v10
    s_mov_b64 exec, -1

    ds_wrxchg_rtn_b32 v116, v86, v13
    s_cmp_ge_u32 s57, 800
    s_cbranch_scc1 standalone__deep_cross_pnn__recsys_kernel_nr21
    v_perm_b32 v248, v167, v163, s84
    v_perm_b32 v249, v175, v171, s84
    v_perm_b32 v250, v183, v179, s84
    v_perm_b32 v251, v191, v187, s84
    s_add_u32 s83, s82, 7185920
    buffer_store_dwordx4 v[248:251], v14, s[32:35], s83 offen sc1
    v_perm_b32 v252, v167, v163, s85
    v_perm_b32 v253, v175, v171, s85
    v_perm_b32 v254, v183, v179, s85
    v_perm_b32 v255, v191, v187, s85
    s_add_u32 s83, s82, 7288576
    buffer_store_dwordx4 v[252:255], v14, s[32:35], s83 offen sc1
standalone__deep_cross_pnn__recsys_kernel_nr21:
    buffer_store_dwordx4 v[108:111], v9, s[12:15], s6 offen offset:2048 sc1
    buffer_store_dwordx4 v[108:111], v9, s[12:15], s6 offen offset:3072 sc1

    s_waitcnt lgkmcnt(0)
    v_cmp_gt_u32 s[68:69], 2, v116

    v_cmp_eq_u32 s[72:73], 0, v116
    s_mov_b64 exec, s[70:71]
    v_cmpx_le_u32 vcc, 2, v87
    v_mov_b32 v62, s69
    v_mov_b32 v123, s73
    v_perm_b32 v121, v62, s68, v6
    v_perm_b32 v122, v123, s72, v5
    v_and_b32 v121, v121, v22
    v_and_b32 v122, v122, v21
    v_msad_u8 v120, v70, v121, 0
    v_lshlrev_b32 v120, 8, v120
    v_msad_u8 v120, v63, v122, v120
    v_and_b32 v120, v120, v59

    v_ffbl_b32 v120, v120
    v_max_i32 v84, v84, v120
    s_mov_b64 exec, -1
    v_lshl_add_u32 v59, -1, v84, v59

    v_lshl_add_u32 v61, v84, 1, v31
    ds_read_u16 v81, v61 offset:40
    s_setprio 1
    v_ffbl_b32 v84, v59
    v_perm_b32 v60, v77, v76, v84
    v_and_or_b32 v60, v60, s66, v85

    v_cmpx_ge_u32 vcc, 2, v84
    ds_add_u32 v60, v10
    s_not_b64 s[70:71], vcc
    s_mov_b64 exec, s[70:71]
    ds_add_rtn_u32 v87, v60, v10
    s_mov_b64 exec, -1

    ds_wrxchg_rtn_b32 v116, v86, v13
    buffer_store_dwordx4 v[108:111], v9, s[12:15], s7 offen offset:0 sc1
    buffer_store_dwordx4 v[108:111], v9, s[12:15], s7 offen offset:1024 sc1

    s_waitcnt lgkmcnt(0)
    v_cmp_gt_u32 s[68:69], 2, v116

    v_cmp_eq_u32 s[72:73], 0, v116
    s_mov_b64 exec, s[70:71]
    v_cmpx_le_u32 vcc, 2, v87
    v_mov_b32 v62, s69
    v_mov_b32 v123, s73
    v_perm_b32 v121, v62, s68, v6
    v_perm_b32 v122, v123, s72, v5
    v_and_b32 v121, v121, v22
    v_and_b32 v122, v122, v21
    v_msad_u8 v120, v70, v121, 0
    v_lshlrev_b32 v120, 8, v120
    v_msad_u8 v120, v63, v122, v120
    v_and_b32 v120, v120, v59

    v_ffbl_b32 v120, v120
    v_max_i32 v84, v84, v120
    s_mov_b64 exec, -1
    v_lshl_add_u32 v59, -1, v84, v59

    v_lshl_add_u32 v61, v84, 1, v31
    ds_read_u16 v82, v61 offset:40
    s_setprio 0
    v_ffbl_b32 v84, v59
    v_perm_b32 v60, v77, v76, v84
    v_and_or_b32 v60, v60, s66, v85

    v_cmpx_ge_u32 vcc, 3, v84
    ds_add_u32 v60, v10
    s_not_b64 s[70:71], vcc
    s_mov_b64 exec, s[70:71]
    ds_add_rtn_u32 v87, v60, v10
    s_mov_b64 exec, -1

    ds_wrxchg_rtn_b32 v116, v86, v13
    buffer_store_dwordx4 v[108:111], v9, s[12:15], s7 offen offset:2048 sc1
    buffer_store_dwordx4 v[108:111], v9, s[12:15], s7 offen offset:3072 sc1
    buffer_store_dwordx2 v[108:109], v30, s[12:15], s8 offen sc1
    s_mov_b64 exec, 0xff
    buffer_load_dword v104, v9, s[52:55], 0 offen offset:128 sc1
    s_mov_b64 exec, -1

    s_waitcnt lgkmcnt(0)
    v_cmp_gt_u32 s[68:69], 2, v116

    s_mov_b64 exec, s[70:71]
    v_cmpx_le_u32 vcc, 2, v87
    v_mov_b32 v62, s69
    v_perm_b32 v121, v62, s68, v6
    v_and_b32 v121, v121, v22
    v_msad_u8 v120, v70, v121, 0
    v_and_b32_sdwa v120, v120, v59 dst_sel:BYTE_1 dst_unused:UNUSED_PAD src0_sel:DWORD src1_sel:BYTE_1
    s_nop 0

    v_ffbl_b32 v120, v120
    v_max_i32 v84, v84, v120
    s_mov_b64 exec, -1
    v_lshl_add_u32 v59, -1, v84, v59

    v_lshl_add_u32 v61, v84, 1, v31
    ds_read_u16 v83, v61 offset:40

    s_bitcmp1_b32 s59, 0
    s_cbranch_scc1 standalone__deep_cross_pnn__recsys_kernel_sk6
    v_mov_b32 v60, s46
    ds_write_b32 v86, v59
    ds_write_b32 v60, v10
    s_branch standalone__deep_cross_pnn__recsys_kernel_sdone

standalone__deep_cross_pnn__recsys_kernel_sk6:
    v_lshrrev_b32 v59, 4, v59
    v_add_u32 v63, v58, v22
    s_setprio 1
    v_ffbl_b32 v84, v59
    v_perm_b32 v60, v78, v77, v84

    v_cmp_lt_u32 vcc, 7, v84
    v_alignbyte_b32 v61, v79, v79, v84
    s_nop 0
    v_cndmask_b32 v60, v60, v61, vcc

    v_and_or_b32 v60, v60, s66, v85
    ds_add_rtn_u32 v87, v60, v10
    ds_wrxchg_rtn_b32 v116, v86, v13

    s_waitcnt lgkmcnt(0)
    v_cmp_gt_u32 s[68:69], 2, v116

    v_lshl_or_b32 v24, v81, 16, v80
    v_lshl_or_b32 v25, v83, 16, v82
    buffer_store_dwordx2 v[24:25], v30, s[32:35], s62 offen sc1
    s_add_u32 s62, s62, s63
    s_nop 0
    v_cmpx_le_u32 vcc, 2, v87
    v_mov_b32 v62, s69
    v_perm_b32 v121, v62, s68, v7
    v_perm_b32 v122, v62, s68, v6
    v_perm_b32 v123, v62, s68, v5
    v_and_b32 v121, v121, v23
    v_and_b32 v122, v122, v22
    v_and_b32 v123, v123, v21
    v_msad_u8 v120, v71, v121, 0
    v_lshlrev_b32 v120, 8, v120
    v_msad_u8 v120, v63, v122, v120
    v_msad_u8 v120, v69, v123, v120
    v_and_b32 v120, v120, v59

    v_ffbl_b32 v120, v120
    v_max_i32 v84, v84, v120
    s_mov_b64 exec, -1
    v_lshl_add_u32 v59, -1, v84, v59

    v_lshl_add_u32 v61, v84, 1, v31
    ds_read_u16 v80, v61 offset:48
    v_ffbl_b32 v84, v59
    v_perm_b32 v60, v78, v77, v84

    v_cmp_lt_u32 vcc, 7, v84
    v_alignbyte_b32 v61, v79, v79, v84
    s_nop 0
    v_cndmask_b32 v60, v60, v61, vcc

    v_and_or_b32 v60, v60, s66, v85
    ds_add_rtn_u32 v87, v60, v10
    ds_wrxchg_rtn_b32 v116, v86, v13

    s_waitcnt lgkmcnt(0)
    v_cmp_gt_u32 s[68:69], 2, v116

    s_nop 0
    v_cmpx_le_u32 vcc, 2, v87
    v_mov_b32 v62, s69
    v_perm_b32 v121, v62, s68, v7
    v_perm_b32 v122, v62, s68, v6
    v_perm_b32 v123, v62, s68, v5
    v_and_b32 v121, v121, v23
    v_and_b32 v122, v122, v22
    v_and_b32 v123, v123, v21
    v_msad_u8 v120, v71, v121, 0
    v_lshlrev_b32 v120, 8, v120
    v_msad_u8 v120, v63, v122, v120
    v_msad_u8 v120, v69, v123, v120
    v_and_b32 v120, v120, v59

    v_ffbl_b32 v120, v120
    v_max_i32 v84, v84, v120
    s_mov_b64 exec, -1
    v_lshl_add_u32 v59, -1, v84, v59

    v_lshl_add_u32 v61, v84, 1, v31
    ds_read_u16 v81, v61 offset:48
    v_ffbl_b32 v84, v59
    v_perm_b32 v60, v78, v77, v84

    v_cmp_lt_u32 vcc, 7, v84
    v_alignbyte_b32 v61, v79, v79, v84
    s_nop 0
    v_cndmask_b32 v60, v60, v61, vcc

    v_and_or_b32 v60, v60, s66, v85
    ds_add_rtn_u32 v87, v60, v10
    ds_wrxchg_rtn_b32 v116, v86, v13

    s_waitcnt lgkmcnt(0)
    v_cmp_gt_u32 s[68:69], 2, v116

    s_nop 0
    v_cmpx_le_u32 vcc, 2, v87
    v_mov_b32 v62, s69
    v_perm_b32 v121, v62, s68, v7
    v_perm_b32 v122, v62, s68, v6
    v_perm_b32 v123, v62, s68, v5
    v_and_b32 v121, v121, v23
    v_and_b32 v122, v122, v22
    v_and_b32 v123, v123, v21
    v_msad_u8 v120, v71, v121, 0
    v_lshlrev_b32 v120, 8, v120
    v_msad_u8 v120, v63, v122, v120
    v_msad_u8 v120, v69, v123, v120
    v_and_b32 v120, v120, v59

    v_ffbl_b32 v120, v120
    v_max_i32 v84, v84, v120
    s_mov_b64 exec, -1
    v_lshl_add_u32 v59, -1, v84, v59

    v_lshl_add_u32 v61, v84, 1, v31
    ds_read_u16 v82, v61 offset:48
    v_ffbl_b32 v84, v59
    v_lshl_add_u32 v61, v84, 1, v31
    ds_read_u16 v83, v61 offset:48
standalone__deep_cross_pnn__recsys_kernel_sdone:
    s_waitcnt lgkmcnt(0)
    v_lshl_or_b32 v24, v81, 16, v80
    v_lshl_or_b32 v25, v83, 16, v82
    buffer_store_dwordx2 v[24:25], v30, s[32:35], s62 offen sc1
    s_add_u32 s62, s62, s63
standalone__deep_cross_pnn__recsys_kernel_udone:
    s_setprio 0

    s_waitcnt vmcnt(0)

    s_mov_b64 exec, 1
    ds_add_rtn_u32 v12, v11, v10 offset:20
    s_mov_b32 s49, 0
    s_waitcnt lgkmcnt(0)
    v_readfirstlane_b32 s48, v12
    s_and_b32 s48, s48, 3

    s_mov_b64 exec, 0xff
standalone__deep_cross_pnn__recsys_kernel_ec1:

    v_cmp_ne_u32 vcc, -1, v104
    s_cbranch_vccz standalone__deep_cross_pnn__recsys_kernel_tbl
    buffer_load_dword v104, v9, s[52:55], 0 offen offset:128 sc1
    s_add_u32 s49, s49, 1
    s_waitcnt vmcnt(0)
    s_cmp_lt_u32 s49, 12
    s_cbranch_scc1 standalone__deep_cross_pnn__recsys_kernel_ec1
    s_branch standalone__deep_cross_pnn__recsys_kernel_enx

standalone__deep_cross_pnn__recsys_kernel_hset:

    s_lshl_b32 s39, 1, s51
    s_lshr_b32 s38, s51, 5
    v_mov_b32 v1, s39
    s_lshl_b32 s38, s38, 4
    s_mov_b64 exec, 1
    buffer_atomic_or v1, v13, s[52:55], s38 offen offset:132
    s_mov_b64 exec, -1
    s_waitcnt vmcnt(0)
    s_branch standalone__deep_cross_pnn__recsys_kernel_slow

standalone__deep_cross_pnn__recsys_kernel_tbl:
    s_mov_b64 exec, -1
    s_mov_b32 s49, -1

    s_xor_b32 s44, s50, 1
    s_lshl_b32 s44, s44, 3
    s_add_u32 s44, s44, s56
    s_lshl_b32 s44, s44, 14
    s_add_u32 s44, s44, 15204352
    s_add_u32 s47, s44, 65536

    buffer_load_dwordx4 v[136:139], v9, s[12:15], s44 offen offset:0 sc1
    buffer_load_dwordx4 v[140:143], v9, s[12:15], s44 offen offset:1024 sc1
    buffer_load_dwordx4 v[152:155], v9, s[12:15], s44 offen offset:2048 sc1
    buffer_load_dwordx4 v[156:159], v9, s[12:15], s44 offen offset:3072 sc1
    s_add_u32 s44, s44, 4096
    buffer_load_dwordx4 v[168:171], v9, s[12:15], s44 offen offset:0 sc1
    buffer_load_dwordx4 v[172:175], v9, s[12:15], s44 offen offset:1024 sc1
    buffer_load_dwordx4 v[184:187], v9, s[12:15], s44 offen offset:2048 sc1
    buffer_load_dwordx4 v[188:191], v9, s[12:15], s44 offen offset:3072 sc1
    s_add_u32 s44, s44, 4096
    s_waitcnt vmcnt(7)
    buffer_load_dwordx4 v[200:203], v9, s[12:15], s44 offen offset:0 sc1
    s_waitcnt vmcnt(7)
    buffer_load_dwordx4 v[204:207], v9, s[12:15], s44 offen offset:1024 sc1
    s_waitcnt vmcnt(7)
    buffer_load_dwordx4 v[216:219], v9, s[12:15], s44 offen offset:2048 sc1
    s_waitcnt vmcnt(7)
    buffer_load_dwordx4 v[220:223], v9, s[12:15], s44 offen offset:3072 sc1
    s_add_u32 s44, s44, 4096
    s_waitcnt vmcnt(7)
    buffer_load_dwordx4 v[232:235], v9, s[12:15], s44 offen offset:0 sc1
    s_waitcnt vmcnt(7)
    buffer_load_dwordx4 v[236:239], v9, s[12:15], s44 offen offset:1024 sc1
    s_waitcnt vmcnt(7)
    buffer_load_dwordx4 v[248:251], v9, s[12:15], s44 offen offset:2048 sc1
    s_waitcnt vmcnt(7)
    buffer_load_dwordx4 v[252:255], v9, s[12:15], s44 offen offset:3072 sc1
    s_add_u32 s44, s44, 4096
    s_waitcnt vmcnt(7)
    buffer_load_dwordx4 v[88:91], v9, s[12:15], s47 offen offset:0 sc1
    s_waitcnt vmcnt(7)
    buffer_load_dwordx4 v[88:91], v9, s[12:15], s47 offen offset:1024 sc1
    s_waitcnt vmcnt(7)
    buffer_load_dwordx4 v[88:91], v9, s[12:15], s47 offen offset:2048 sc1
    s_waitcnt vmcnt(7)
    buffer_load_dwordx4 v[88:91], v9, s[12:15], s47 offen offset:3072 sc1
    s_add_u32 s47, s47, 4096
    s_waitcnt vmcnt(7)
    buffer_load_dwordx4 v[88:91], v9, s[12:15], s47 offen offset:0 sc1
    s_waitcnt vmcnt(7)
    buffer_load_dwordx4 v[88:91], v9, s[12:15], s47 offen offset:1024 sc1
    s_waitcnt vmcnt(7)
    buffer_load_dwordx4 v[88:91], v9, s[12:15], s47 offen offset:2048 sc1
    s_waitcnt vmcnt(7)
    buffer_load_dwordx4 v[88:91], v9, s[12:15], s47 offen offset:3072 sc1
    s_add_u32 s47, s47, 4096
    s_waitcnt vmcnt(7)
    buffer_load_dwordx4 v[88:91], v9, s[12:15], s47 offen offset:0 sc1
    s_waitcnt vmcnt(7)
    buffer_load_dwordx4 v[88:91], v9, s[12:15], s47 offen offset:1024 sc1
    s_waitcnt vmcnt(7)
    buffer_load_dwordx4 v[88:91], v9, s[12:15], s47 offen offset:2048 sc1
    s_waitcnt vmcnt(7)
    buffer_load_dwordx4 v[88:91], v9, s[12:15], s47 offen offset:3072 sc1
    s_add_u32 s47, s47, 4096
    s_waitcnt vmcnt(7)
    buffer_load_dwordx4 v[88:91], v9, s[12:15], s47 offen offset:0 sc1
    s_waitcnt vmcnt(7)
    buffer_load_dwordx4 v[88:91], v9, s[12:15], s47 offen offset:1024 sc1
    s_waitcnt vmcnt(7)
    buffer_load_dwordx4 v[88:91], v9, s[12:15], s47 offen offset:2048 sc1
    s_waitcnt vmcnt(7)
    buffer_load_dwordx4 v[88:91], v9, s[12:15], s47 offen offset:3072 sc1
    s_add_u32 s47, s47, 4096
standalone__deep_cross_pnn__recsys_kernel_enx:

    s_mov_b64 exec, -1
    s_mul_i32 s85, s56, 18432
    v_and_b32 v25, 15, v8
    v_lshrrev_b32 v26, 4, v8
    v_mul_u32_u24 v24, 144, v25
    v_lshl_add_u32 v24, v26, 4, v24
    v_add_u32 v24, s85, v24

    s_lshr_b32 s79, s2, 1
    s_mul_i32 s77, s79, 102656
    s_lshl_b32 s85, s50, 11
    s_xor_b32 s78, s85, 2048
    s_add_u32 s78, s78, s77
    s_add_u32 s77, s77, s85
    s_and_b32 s79, s2, 1
    s_mul_i32 s79, s79, 1638400
    s_add_u32 s79, s79, 16777216
    s_lshl_b32 s85, s3, 13
    s_add_u32 s79, s79, s85
    s_xor_b32 s85, s3, 4
    s_lshl_b32 s85, s85, 10
    s_min_u32 s85, s85, 7040
    s_bitcmp1_b32 s2, 1
    s_cselect_b32 s83, 0, 16
    s_lshl_b32 s80, s24, s83
    s_lshl_b32 s81, s25, s83
    s_lshl_b32 s82, s26, s83
    s_lshl_b32 s83, s27, s83
    s_and_b32 s80, s80, 0xffff0000
    s_and_b32 s81, s81, 0xffff0000
    s_and_b32 s82, s82, 0xffff0000
    s_and_b32 s83, s83, 0xffff0000
    ds_read_b128 v[128:131], v24 offset:0
    ds_read_b128 v[132:135], v24 offset:64
    v_lshlrev_b32 v69, 4, v8
    v_lshlrev_b32 v70, 13, v26
    v_lshl_add_u32 v70, v25, 3, v70
    v_add_u32 v70, s85, v70
    ds_read_b128 v[144:147], v24 offset:2304
    ds_read_b128 v[148:151], v24 offset:2368
    v_lshrrev_b32 v28, 3, v8
    v_xor_b32 v28, v28, v26
    v_and_b32 v28, 1, v28
    v_bfe_u32 v29, v8, 2, 1
    ds_read_b128 v[160:163], v24 offset:4608
    ds_read_b128 v[164:167], v24 offset:4672
    v_lshl_or_b32 v28, v28, 1, v29
    v_mov_b32 v30, 0x3f80
    v_cmp_eq_u32 vcc, 0, v28
    v_cmp_eq_u32 s[68:69], 1, v28
    ds_read_b128 v[176:179], v24 offset:6912
    ds_read_b128 v[180:183], v24 offset:6976
    v_and_b32 v29, 3, v8
    v_mul_u32_u24 v68, 0x5555, v29
    v_cndmask_b32 v64, 0, v30, vcc
    v_cndmask_b32 v65, 0, v30, vcc
    ds_read_b128 v[192:195], v24 offset:9216
    ds_read_b128 v[196:199], v24 offset:9280
    v_cndmask_b32 v66, 0, v30, s[68:69]
    v_cndmask_b32 v67, 0, v30, s[68:69]
    v_add_u32 v114, 144256, v69
    v_add_u32 v71, 0x10000, v70
    ds_read_b128 v[208:211], v24 offset:11520
    ds_read_b128 v[212:215], v24 offset:11584
    v_mov_b64 v[32:33], s[80:81]
    v_mov_b64 v[34:35], s[82:83]
    v_mov_b64 v[36:37], s[80:81]
    v_mov_b64 v[38:39], s[82:83]
    ds_read_b128 v[224:227], v24 offset:13824
    ds_read_b128 v[228:231], v24 offset:13888
    v_mov_b64 v[40:41], s[80:81]
    v_mov_b64 v[42:43], s[82:83]
    v_mov_b64 v[44:45], s[80:81]
    v_mov_b64 v[46:47], s[82:83]
    ds_read_b128 v[240:243], v24 offset:16128
    ds_read_b128 v[244:247], v24 offset:16192
    v_mov_b64 v[48:49], s[80:81]
    v_mov_b64 v[50:51], s[82:83]
    v_mov_b64 v[52:53], s[80:81]
    v_mov_b64 v[54:55], s[82:83]
    v_mov_b64 v[56:57], s[80:81]
    v_mov_b64 v[58:59], s[82:83]
    v_mov_b64 v[60:61], s[80:81]
    v_mov_b64 v[62:63], s[82:83]

    s_bitcmp1_b32 s56, 1
    s_cselect_b32 s84, s78, s77
    s_lshl_b32 s85, s56, 10
    s_add_u32 m0, s85, 144256
    s_and_b32 s85, s85, 1024
    s_add_u32 s84, s84, s85

    s_add_u32 s85, s84, 0
    buffer_load_dwordx4 v[88:91], v69, s[12:15], s85 offen sc1
    s_add_u32 s85, s84, 4096
    buffer_load_dwordx4 v[88:91], v69, s[12:15], s85 offen sc1
    s_add_u32 s85, s84, 8192
    buffer_load_dwordx4 v[88:91], v69, s[12:15], s85 offen sc1
    s_add_u32 s85, s84, 12288
    buffer_load_dwordx4 v[88:91], v69, s[12:15], s85 offen sc1

    s_cmp_lg_u32 s48, 0
    s_cbranch_scc1 standalone__deep_cross_pnn__recsys_kernel_wdec
    s_mov_b64 exec, -1
    v_lshlrev_b32 v0, 7, v8
    v_lshrrev_b32 v2, 5, v8
    v_lshlrev_b32 v2, 4, v2
    v_lshlrev_b32 v3, 2, v8
    s_mov_b32 s44, 14680064
    s_bfe_u32 s46, s2, 131072
    s_lshl_b32 s47, s46, 7
    s_add_u32 s47, s47, 14688256
    s_lshl_b32 s46, s46, 2
    s_mov_b32 s38, 3221225472

standalone__deep_cross_pnn__recsys_kernel_p0:

    ds_read_b32 v12, v11 offset:20
    s_waitcnt lgkmcnt(0)
    v_readfirstlane_b32 s45, v12
    s_and_b32 s45, s45, 3
    s_cbranch_scc0 standalone__deep_cross_pnn__recsys_kernel_p1s
    s_sleep 1
    s_branch standalone__deep_cross_pnn__recsys_kernel_p0

standalone__deep_cross_pnn__recsys_kernel_p1s:

    s_cmp_lg_u32 s64, 0
    s_cbranch_scc1 standalone__deep_cross_pnn__recsys_kernel_hset

    s_mov_b64 exec, 1
    s_cmp_lg_u32 s49, -1
    s_cbranch_scc1 standalone__deep_cross_pnn__recsys_kernel_nfp
    v_mov_b32 v1, 1
    buffer_atomic_add v1, v13, s[12:15], s47 offen sc0
    buffer_store_dword v10, v13, s[12:15], s9 offen sc1
    s_waitcnt vmcnt(1)
    v_cmpx_eq_u32 vcc, 63, v1
    buffer_store_dword v10, v13, s[52:55], s46 offen sc1
    s_mov_b64 exec, 0xf

standalone__deep_cross_pnn__recsys_kernel_p1:

    buffer_load_dword v1, v3, s[52:55], 0 offen sc1
    s_add_u32 s65, s65, 1
    s_waitcnt vmcnt(0)
    v_cmp_eq_u32 vcc, 0, v1
    s_cbranch_vccz standalone__deep_cross_pnn__recsys_kernel_dec
    s_sleep 4
    s_cmp_lt_u32 s65, 200
    s_cbranch_scc1 standalone__deep_cross_pnn__recsys_kernel_p1
    s_mov_b64 exec, 1

standalone__deep_cross_pnn__recsys_kernel_nfp:

    buffer_store_dword v10, v13, s[12:15], s9 offen sc1
    s_mov_b64 exec, -1

standalone__deep_cross_pnn__recsys_kernel_slow:
    buffer_load_dwordx2 v[16:17], v2, s[52:55], 0 offen offset:128 sc1
    buffer_load_dwordx2 v[18:19], v2, s[52:55], 0 offen offset:160 sc1
    buffer_load_dwordx2 v[20:21], v2, s[52:55], 0 offen offset:192 sc1
    buffer_load_dwordx2 v[22:23], v2, s[52:55], 0 offen offset:224 sc1

    s_waitcnt vmcnt(0)
    buffer_load_dwordx4 v[4:7], v0, s[12:15], s44 offen sc1
    s_add_u32 s65, s65, 1
    s_waitcnt vmcnt(0)

    v_bfe_u32 v16, v16, v8, 1
    v_bfe_u32 v17, v17, v8, 1
    v_and_b32 v4, v4, v16
    v_or_b32 v17, v17, v4

    v_bfe_u32 v18, v18, v8, 1
    v_bfe_u32 v19, v19, v8, 1
    v_and_b32 v5, v5, v18
    v_or_b32 v19, v19, v5

    v_bfe_u32 v20, v20, v8, 1
    v_bfe_u32 v21, v21, v8, 1
    v_and_b32 v6, v6, v20
    v_or_b32 v21, v21, v6

    v_bfe_u32 v22, v22, v8, 1
    v_bfe_u32 v23, v23, v8, 1
    v_and_b32 v7, v7, v22
    v_or_b32 v23, v23, v7

    v_min3_u32 v1, v4, v5, v6
    v_min_u32 v1, v1, v7
    v_cmp_eq_u32 vcc, 0, v1
    s_mov_b32 s38, 3221225472
    s_cbranch_vccz standalone__deep_cross_pnn__recsys_kernel_dec
    v_min3_u32 v1, v17, v19, v21
    v_min_u32 v1, v1, v23
    v_cmp_eq_u32 vcc, 0, v1
    s_mov_b32 s38, 2147483648
    s_cbranch_vccz standalone__deep_cross_pnn__recsys_kernel_dec
    s_cmp_lt_u32 s65, 200
    s_cbranch_scc1 standalone__deep_cross_pnn__recsys_kernel_slow

    v_cmp_eq_u32 vcc, 0, v17
    s_movk_i32 s38, 0
    s_cbranch_vccnz standalone__deep_cross_pnn__recsys_kernel_fnd
    v_cmp_eq_u32 vcc, 0, v19
    s_movk_i32 s38, 64
    s_cbranch_vccnz standalone__deep_cross_pnn__recsys_kernel_fnd
    v_cmp_eq_u32 vcc, 0, v21
    s_movk_i32 s38, 128
    s_cbranch_vccnz standalone__deep_cross_pnn__recsys_kernel_fnd
    v_cmp_eq_u32 vcc, 0, v23
    s_movk_i32 s38, 192
standalone__deep_cross_pnn__recsys_kernel_fnd:

    s_ff1_i32_b64 s39, vcc
    s_add_u32 s38, s38, s39
    s_andn2_b32 s39, s64, 255
    s_add_u32 s39, s39, 256
    s_or_b32 s38, s38, s39

standalone__deep_cross_pnn__recsys_kernel_dec:

    s_mov_b64 exec, 1
    v_mov_b32 v1, s38
    ds_write_b32 v11, v1 offset:24

standalone__deep_cross_pnn__recsys_kernel_wdec:

    s_mov_b64 exec, -1
    ds_read_b32 v12, v11 offset:24
    s_waitcnt lgkmcnt(0)
    v_readfirstlane_b32 s45, v12
    s_cmp_lg_u32 s45, s64
    s_cbranch_scc1 standalone__deep_cross_pnn__recsys_kernel_gotd
    s_sleep 2
    s_branch standalone__deep_cross_pnn__recsys_kernel_wdec

standalone__deep_cross_pnn__recsys_kernel_hlp:
    s_waitcnt vmcnt(0)
    s_branch standalone__deep_cross_pnn__recsys_kernel_unit
standalone__deep_cross_pnn__recsys_kernel_gotd:

    s_mov_b32 s64, s45
    s_and_b32 s51, s45, 255

    s_mov_b32 s65, 200
    s_bitcmp0_b32 s45, 31
    s_cbranch_scc1 standalone__deep_cross_pnn__recsys_kernel_hlp

    s_cmp_eq_u32 s49, -1
    s_cbranch_scc1 standalone__deep_cross_pnn__recsys_kernel_k2

    s_xor_b32 s44, s50, 1
    s_lshl_b32 s44, s44, 3
    s_add_u32 s44, s44, s56
    s_lshl_b32 s44, s44, 14
    s_add_u32 s44, s44, 15204352
    s_add_u32 s47, s44, 65536

    buffer_load_dwordx4 v[136:139], v9, s[12:15], s44 offen offset:0 sc1
    buffer_load_dwordx4 v[140:143], v9, s[12:15], s44 offen offset:1024 sc1
    buffer_load_dwordx4 v[152:155], v9, s[12:15], s44 offen offset:2048 sc1
    buffer_load_dwordx4 v[156:159], v9, s[12:15], s44 offen offset:3072 sc1
    s_add_u32 s44, s44, 4096
    buffer_load_dwordx4 v[168:171], v9, s[12:15], s44 offen offset:0 sc1
    buffer_load_dwordx4 v[172:175], v9, s[12:15], s44 offen offset:1024 sc1
    buffer_load_dwordx4 v[184:187], v9, s[12:15], s44 offen offset:2048 sc1
    buffer_load_dwordx4 v[188:191], v9, s[12:15], s44 offen offset:3072 sc1
    s_add_u32 s44, s44, 4096
    s_waitcnt vmcnt(7)
    buffer_load_dwordx4 v[200:203], v9, s[12:15], s44 offen offset:0 sc1
    s_waitcnt vmcnt(7)
    buffer_load_dwordx4 v[204:207], v9, s[12:15], s44 offen offset:1024 sc1
    s_waitcnt vmcnt(7)
    buffer_load_dwordx4 v[216:219], v9, s[12:15], s44 offen offset:2048 sc1
    s_waitcnt vmcnt(7)
    buffer_load_dwordx4 v[220:223], v9, s[12:15], s44 offen offset:3072 sc1
    s_add_u32 s44, s44, 4096
    s_waitcnt vmcnt(7)
    buffer_load_dwordx4 v[232:235], v9, s[12:15], s44 offen offset:0 sc1
    s_waitcnt vmcnt(7)
    buffer_load_dwordx4 v[236:239], v9, s[12:15], s44 offen offset:1024 sc1
    s_waitcnt vmcnt(7)
    buffer_load_dwordx4 v[248:251], v9, s[12:15], s44 offen offset:2048 sc1
    s_waitcnt vmcnt(7)
    buffer_load_dwordx4 v[252:255], v9, s[12:15], s44 offen offset:3072 sc1
    s_add_u32 s44, s44, 4096
    s_waitcnt vmcnt(7)
    buffer_load_dwordx4 v[88:91], v9, s[12:15], s47 offen offset:0 sc1
    s_waitcnt vmcnt(7)
    buffer_load_dwordx4 v[88:91], v9, s[12:15], s47 offen offset:1024 sc1
    s_waitcnt vmcnt(7)
    buffer_load_dwordx4 v[88:91], v9, s[12:15], s47 offen offset:2048 sc1
    s_waitcnt vmcnt(7)
    buffer_load_dwordx4 v[88:91], v9, s[12:15], s47 offen offset:3072 sc1
    s_add_u32 s47, s47, 4096
    s_waitcnt vmcnt(7)
    buffer_load_dwordx4 v[88:91], v9, s[12:15], s47 offen offset:0 sc1
    s_waitcnt vmcnt(7)
    buffer_load_dwordx4 v[88:91], v9, s[12:15], s47 offen offset:1024 sc1
    s_waitcnt vmcnt(7)
    buffer_load_dwordx4 v[88:91], v9, s[12:15], s47 offen offset:2048 sc1
    s_waitcnt vmcnt(7)
    buffer_load_dwordx4 v[88:91], v9, s[12:15], s47 offen offset:3072 sc1
    s_add_u32 s47, s47, 4096
    s_waitcnt vmcnt(7)
    buffer_load_dwordx4 v[88:91], v9, s[12:15], s47 offen offset:0 sc1
    s_waitcnt vmcnt(7)
    buffer_load_dwordx4 v[88:91], v9, s[12:15], s47 offen offset:1024 sc1
    s_waitcnt vmcnt(7)
    buffer_load_dwordx4 v[88:91], v9, s[12:15], s47 offen offset:2048 sc1
    s_waitcnt vmcnt(7)
    buffer_load_dwordx4 v[88:91], v9, s[12:15], s47 offen offset:3072 sc1
    s_add_u32 s47, s47, 4096
    s_waitcnt vmcnt(7)
    buffer_load_dwordx4 v[88:91], v9, s[12:15], s47 offen offset:0 sc1
    s_waitcnt vmcnt(7)
    buffer_load_dwordx4 v[88:91], v9, s[12:15], s47 offen offset:1024 sc1
    s_waitcnt vmcnt(7)
    buffer_load_dwordx4 v[88:91], v9, s[12:15], s47 offen offset:2048 sc1
    s_waitcnt vmcnt(7)
    buffer_load_dwordx4 v[88:91], v9, s[12:15], s47 offen offset:3072 sc1
    s_add_u32 s47, s47, 4096
standalone__deep_cross_pnn__recsys_kernel_k2:
    s_setprio 1
    buffer_load_dwordx4 v[0:3], v69, s[12:15], s77 offen offset:0 sc1
    buffer_load_dwordx4 v[4:7], v69, s[12:15], s77 offen offset:1024 sc1
    buffer_load_dwordx4 v[8:11], v69, s[12:15], s78 offen offset:0 sc1
    buffer_load_dwordx4 v[12:15], v69, s[12:15], s78 offen offset:1024 sc1
    buffer_load_dwordx4 v69, s[12:15], s84 offen sc1 lds
    s_add_u32 m0, m0, 4096
    s_add_u32 s84, s84, 4096
    buffer_load_dwordx4 v69, s[12:15], s84 offen sc1 lds
    s_add_u32 m0, m0, 4096
    s_add_u32 s84, s84, 4096
    buffer_load_dwordx4 v69, s[12:15], s84 offen sc1 lds
    s_add_u32 s44, s77, 4096
    s_add_u32 s45, s78, 4096
    buffer_load_dwordx4 v[16:19], v69, s[12:15], s44 offen offset:0 sc1
    buffer_load_dwordx4 v[20:23], v69, s[12:15], s44 offen offset:1024 sc1
    buffer_load_dwordx4 v[24:27], v69, s[12:15], s45 offen offset:0 sc1
    buffer_load_dwordx4 v[28:31], v69, s[12:15], s45 offen offset:1024 sc1
    s_barrier
    s_waitcnt vmcnt(7)
    v_mfma_f32_16x16x32_bf16 v[88:91], v[0:3], v[128:131], 0
    v_mfma_f32_16x16x32_bf16 v[92:95], v[0:3], v[144:147], 0
    s_add_u32 s21, s77, 12288
    v_mfma_f32_16x16x32_bf16 v[88:91], v[4:7], v[132:135], v[88:91]
    s_add_u32 s19, s78, 12288
    v_mfma_f32_16x16x32_bf16 v[92:95], v[4:7], v[148:151], v[92:95]
    s_mov_b32 s20, s79
    v_mfma_f32_16x16x32_bf16 v[88:91], v[8:11], v[136:139], v[88:91]
    s_lshr_b32 s33, s2, 1
    v_mfma_f32_16x16x32_bf16 v[92:95], v[8:11], v[152:155], v[92:95]
    s_and_b32 s34, s2, 1
    v_mfma_f32_16x16x32_bf16 v[88:91], v[12:15], v[140:143], v[88:91]
    s_load_dwordx4 s[56:59], s[0:1], 48
    s_load_dword s28, s[10:11], 0
    s_load_dword s29, s[10:11], 16
    s_load_dword s30, s[10:11], 32
    s_load_dword s31, s[10:11], 48
    v_mfma_f32_16x16x32_bf16 v[92:95], v[12:15], v[156:159], v[92:95]
    v_mfma_f32_16x16x32_bf16 v[96:99], v[0:3], v[160:163], 0
    v_mfma_f32_16x16x32_bf16 v[100:103], v[0:3], v[176:179], 0
    v_mfma_f32_16x16x32_bf16 v[96:99], v[4:7], v[164:167], v[96:99]
    v_cvt_pk_bf16_f32 v116, v88, v89
    v_mfma_f32_16x16x32_bf16 v[100:103], v[4:7], v[180:183], v[100:103]
    v_cvt_pk_bf16_f32 v117, v90, v91
    v_mfma_f32_16x16x32_bf16 v[96:99], v[8:11], v[168:171], v[96:99]
    v_mfma_f32_16x16x32_bf16 v[100:103], v[8:11], v[184:187], v[100:103]
    v_cvt_pk_bf16_f32 v118, v92, v93
    v_mfma_f32_16x16x32_bf16 v[96:99], v[12:15], v[172:175], v[96:99]
    v_cvt_pk_bf16_f32 v119, v94, v95
    v_mfma_f32_16x16x32_bf16 v[100:103], v[12:15], v[188:191], v[100:103]
    v_mfma_f32_16x16x32_bf16 v[104:107], v[0:3], v[192:195], 0
    v_mfma_f32_16x16x32_bf16 v[108:111], v[0:3], v[208:211], 0
    v_mfma_f32_16x16x32_bf16 v[104:107], v[4:7], v[196:199], v[104:107]
    v_cvt_pk_bf16_f32 v120, v96, v97
    v_mfma_f32_16x16x32_bf16 v[108:111], v[4:7], v[212:215], v[108:111]
    v_cvt_pk_bf16_f32 v121, v98, v99
    v_mfma_f32_16x16x32_bf16 v[104:107], v[8:11], v[200:203], v[104:107]
    v_mfma_f32_16x16x32_bf16 v[108:111], v[8:11], v[216:219], v[108:111]
    v_cvt_pk_bf16_f32 v122, v100, v101
    v_mfma_f32_16x16x32_bf16 v[104:107], v[12:15], v[204:207], v[104:107]
    v_cvt_pk_bf16_f32 v123, v102, v103
    v_mfma_f32_16x16x32_bf16 v[108:111], v[12:15], v[220:223], v[108:111]
    v_mfma_f32_16x16x32_bf16 v[88:91], v[0:3], v[224:227], 0
    v_mfma_f32_16x16x32_bf16 v[92:95], v[0:3], v[240:243], 0
    v_mfma_f32_16x16x32_bf16 v[88:91], v[4:7], v[228:231], v[88:91]
    v_cvt_pk_bf16_f32 v124, v104, v105
    v_mfma_f32_16x16x32_bf16 v[92:95], v[4:7], v[244:247], v[92:95]
    v_cvt_pk_bf16_f32 v125, v106, v107
    v_mfma_f32_16x16x32_bf16 v[88:91], v[8:11], v[232:235], v[88:91]
    v_mfma_f32_16x16x32_bf16 v[92:95], v[8:11], v[248:251], v[92:95]
    v_cvt_pk_bf16_f32 v126, v108, v109
    v_mfma_f32_16x16x32_bf16 v[88:91], v[12:15], v[236:239], v[88:91]
    v_cvt_pk_bf16_f32 v127, v110, v111
    v_mfma_f32_16x16x32_bf16 v[92:95], v[12:15], v[252:255], v[92:95]
    s_waitcnt vmcnt(0)
    v_mfma_f32_16x16x32_bf16 v[96:99], v[16:19], v[128:131], 0
    v_mfma_f32_16x16x32_bf16 v[100:103], v[16:19], v[144:147], 0
    v_mfma_f32_16x16x32_bf16 v[96:99], v[20:23], v[132:135], v[96:99]
    v_cvt_pk_bf16_f32 v72, v88, v89
    v_mfma_f32_16x16x32_bf16 v[100:103], v[20:23], v[148:151], v[100:103]
    v_cvt_pk_bf16_f32 v73, v90, v91
    s_waitcnt vmcnt(4)
    s_barrier
    v_mfma_f32_16x16x32_bf16 v[96:99], v[24:27], v[136:139], v[96:99]
    v_mfma_f32_16x16x32_bf16 v[100:103], v[24:27], v[152:155], v[100:103]
    v_cvt_pk_bf16_f32 v74, v92, v93
    v_mfma_f32_16x16x32_bf16 v[96:99], v[28:31], v[140:143], v[96:99]
    v_cvt_pk_bf16_f32 v75, v94, v95
    v_mfma_f32_16x16x32_bf16 v[100:103], v[28:31], v[156:159], v[100:103]
    v_mfma_f32_16x16x32_bf16 v[104:107], v[16:19], v[160:163], 0
    v_mfma_f32_16x16x32_bf16 v[108:111], v[16:19], v[176:179], 0
    v_mfma_f32_16x16x32_bf16 v[104:107], v[20:23], v[164:167], v[104:107]
    v_cvt_pk_bf16_f32 v76, v96, v97
    v_mfma_f32_16x16x32_bf16 v[108:111], v[20:23], v[180:183], v[108:111]
    v_cvt_pk_bf16_f32 v77, v98, v99
    v_mfma_f32_16x16x32_bf16 v[104:107], v[24:27], v[168:171], v[104:107]
    v_mfma_f32_16x16x32_bf16 v[108:111], v[24:27], v[184:187], v[108:111]
    v_cvt_pk_bf16_f32 v78, v100, v101
    v_mfma_f32_16x16x32_bf16 v[104:107], v[28:31], v[172:175], v[104:107]
    v_cvt_pk_bf16_f32 v79, v102, v103
    v_mfma_f32_16x16x32_bf16 v[108:111], v[28:31], v[188:191], v[108:111]
    v_mfma_f32_16x16x32_bf16 v[88:91], v[16:19], v[192:195], 0
    v_mfma_f32_16x16x32_bf16 v[92:95], v[16:19], v[208:211], 0
    v_mfma_f32_16x16x32_bf16 v[88:91], v[20:23], v[196:199], v[88:91]
    v_cvt_pk_bf16_f32 v80, v104, v105
    v_mfma_f32_16x16x32_bf16 v[92:95], v[20:23], v[212:215], v[92:95]
    v_cvt_pk_bf16_f32 v81, v106, v107
    v_mfma_f32_16x16x32_bf16 v[88:91], v[24:27], v[200:203], v[88:91]
    v_mfma_f32_16x16x32_bf16 v[92:95], v[24:27], v[216:219], v[92:95]
    v_cvt_pk_bf16_f32 v82, v108, v109
    v_mfma_f32_16x16x32_bf16 v[88:91], v[28:31], v[204:207], v[88:91]
    v_cvt_pk_bf16_f32 v83, v110, v111
    ds_write_b64 v70, v[116:117] offset:0
    v_mfma_f32_16x16x32_bf16 v[92:95], v[28:31], v[220:223], v[92:95]
    ds_read_b128 v[0:3], v114 offset:8192
    ds_read_b128 v[4:7], v114 offset:9216
    ds_read_b128 v[8:11], v114 offset:10240
    ds_read_b128 v[12:15], v114 offset:11264
    v_mfma_f32_16x16x32_bf16 v[96:99], v[16:19], v[224:227], 0
    ds_write_b64 v70, v[118:119] offset:128
    v_mfma_f32_16x16x32_bf16 v[100:103], v[16:19], v[240:243], 0
    v_mfma_f32_16x16x32_bf16 v[96:99], v[20:23], v[228:231], v[96:99]
    v_cvt_pk_bf16_f32 v88, v88, v89
    ds_write_b64 v70, v[120:121] offset:256
    v_mfma_f32_16x16x32_bf16 v[100:103], v[20:23], v[244:247], v[100:103]
    v_cvt_pk_bf16_f32 v89, v90, v91
    v_mfma_f32_16x16x32_bf16 v[96:99], v[24:27], v[232:235], v[96:99]
    ds_write_b64 v70, v[88:89] offset:33280
    ds_write_b64 v70, v[122:123] offset:384
    v_mfma_f32_16x16x32_bf16 v[100:103], v[24:27], v[248:251], v[100:103]
    v_cvt_pk_bf16_f32 v92, v92, v93
    v_mfma_f32_16x16x32_bf16 v[96:99], v[28:31], v[236:239], v[96:99]
    v_cvt_pk_bf16_f32 v93, v94, v95
    ds_write_b64 v70, v[124:125] offset:512
    v_mfma_f32_16x16x32_bf16 v[100:103], v[28:31], v[252:255], v[100:103]
    ds_write_b64 v70, v[92:93] offset:33408
    s_waitcnt lgkmcnt(6)
    v_mfma_f32_16x16x32_bf16 v[104:107], v[0:3], v[128:131], 0
    buffer_load_dwordx4 v[116:119], v69, s[12:15], s20 offen offset:0 sc1
    ds_write_b64 v70, v[126:127] offset:640
    v_mfma_f32_16x16x32_bf16 v[108:111], v[0:3], v[144:147], 0
    v_mfma_f32_16x16x32_bf16 v[104:107], v[4:7], v[132:135], v[104:107]
    v_cvt_pk_bf16_f32 v96, v96, v97
    ds_write_b64 v70, v[72:73] offset:768
    v_mfma_f32_16x16x32_bf16 v[108:111], v[4:7], v[148:151], v[108:111]
    v_cvt_pk_bf16_f32 v97, v98, v99
    v_mfma_f32_16x16x32_bf16 v[104:107], v[8:11], v[136:139], v[104:107]
    ds_write_b64 v70, v[96:97] offset:33536
    buffer_load_dwordx4 v[120:123], v69, s[12:15], s20 offen offset:1024 sc1
    v_mfma_f32_16x16x32_bf16 v[108:111], v[8:11], v[152:155], v[108:111]
    v_cvt_pk_bf16_f32 v100, v100, v101
    ds_write_b64 v70, v[74:75] offset:896
    v_mfma_f32_16x16x32_bf16 v[104:107], v[12:15], v[140:143], v[104:107]
    v_cvt_pk_bf16_f32 v101, v102, v103
    v_mov_b64 v[16:17], s[80:81]
    v_mfma_f32_16x16x32_bf16 v[108:111], v[12:15], v[156:159], v[108:111]
    ds_write_b64 v70, v[100:101] offset:33664
    v_mov_b64 v[18:19], s[82:83]
    v_mfma_f32_16x16x32_bf16 v[88:91], v[0:3], v[160:163], 0
    v_mov_b64 v[20:21], s[80:81]
    v_mov_b64 v[22:23], s[82:83]
    v_mfma_f32_16x16x32_bf16 v[92:95], v[0:3], v[176:179], 0
    v_mov_b64 v[24:25], s[80:81]
    v_mov_b64 v[26:27], s[82:83]
    v_mfma_f32_16x16x32_bf16 v[88:91], v[4:7], v[164:167], v[88:91]
    v_cvt_pk_bf16_f32 v104, v104, v105
    v_mov_b64 v[28:29], s[80:81]
    v_mfma_f32_16x16x32_bf16 v[92:95], v[4:7], v[180:183], v[92:95]
    v_cvt_pk_bf16_f32 v105, v106, v107
    v_mov_b64 v[30:31], s[82:83]
    v_mfma_f32_16x16x32_bf16 v[88:91], v[8:11], v[168:171], v[88:91]
    ds_write_b64 v71, v[104:105] offset:0
    ds_write_b64 v70, v[76:77] offset:32768
    v_mfma_f32_16x16x32_bf16 v[92:95], v[8:11], v[184:187], v[92:95]
    v_cvt_pk_bf16_f32 v108, v108, v109
    buffer_load_dwordx4 v[124:127], v69, s[12:15], s20 offen offset:2048 sc1
    v_mfma_f32_16x16x32_bf16 v[88:91], v[12:15], v[172:175], v[88:91]
    v_cvt_pk_bf16_f32 v109, v110, v111
    ds_write_b64 v70, v[78:79] offset:32896
    v_mfma_f32_16x16x32_bf16 v[92:95], v[12:15], v[188:191], v[92:95]
    ds_write_b64 v71, v[108:109] offset:128
    ds_write_b64 v70, v[80:81] offset:33024
    v_mfma_f32_16x16x32_bf16 v[96:99], v[0:3], v[192:195], 0
    buffer_load_dwordx4 v[72:75], v69, s[12:15], s21 offen offset:0 sc1
    ds_write_b64 v70, v[82:83] offset:33152
    v_mfma_f32_16x16x32_bf16 v[100:103], v[0:3], v[208:211], 0
    buffer_load_dwordx4 v[76:79], v69, s[12:15], s21 offen offset:1024 sc1
    v_mfma_f32_16x16x32_bf16 v[96:99], v[4:7], v[196:199], v[96:99]
    v_cvt_pk_bf16_f32 v88, v88, v89
    v_mfma_f32_16x16x32_bf16 v[100:103], v[4:7], v[212:215], v[100:103]
    v_cvt_pk_bf16_f32 v89, v90, v91
    v_mfma_f32_16x16x32_bf16 v[96:99], v[8:11], v[200:203], v[96:99]
    ds_write_b64 v71, v[88:89] offset:256
    buffer_load_dwordx4 v[80:83], v69, s[12:15], s19 offen offset:0 sc1
    v_mfma_f32_16x16x32_bf16 v[100:103], v[8:11], v[216:219], v[100:103]
    v_cvt_pk_bf16_f32 v92, v92, v93
    v_mfma_f32_16x16x32_bf16 v[96:99], v[12:15], v[204:207], v[96:99]
    v_cvt_pk_bf16_f32 v93, v94, v95
    v_mfma_f32_16x16x32_bf16 v[100:103], v[12:15], v[220:223], v[100:103]
    ds_write_b64 v71, v[92:93] offset:384
    v_mfma_f32_16x16x32_bf16 v[104:107], v[0:3], v[224:227], 0
    buffer_load_dwordx4 v[84:87], v69, s[12:15], s19 offen offset:1024 sc1
    s_add_u32 s21, s21, 4096
    s_add_u32 s19, s19, 4096
    v_mfma_f32_16x16x32_bf16 v[108:111], v[0:3], v[240:243], 0
    v_mfma_f32_16x16x32_bf16 v[104:107], v[4:7], v[228:231], v[104:107]
    v_cvt_pk_bf16_f32 v96, v96, v97
    v_mfma_f32_16x16x32_bf16 v[108:111], v[4:7], v[244:247], v[108:111]
    v_cvt_pk_bf16_f32 v97, v98, v99
    v_mfma_f32_16x16x32_bf16 v[104:107], v[8:11], v[232:235], v[104:107]
    ds_write_b64 v71, v[96:97] offset:512
    v_mfma_f32_16x16x32_bf16 v[108:111], v[8:11], v[248:251], v[108:111]
    v_cvt_pk_bf16_f32 v100, v100, v101
    v_mov_b64 v[0:1], s[80:81]
    v_mfma_f32_16x16x32_bf16 v[104:107], v[12:15], v[236:239], v[104:107]
    v_cvt_pk_bf16_f32 v101, v102, v103
    v_mov_b64 v[2:3], s[82:83]
    v_mfma_f32_16x16x32_bf16 v[108:111], v[12:15], v[252:255], v[108:111]
    ds_write_b64 v71, v[100:101] offset:640
    v_mov_b64 v[4:5], s[80:81]
    s_nop 1
    v_mov_b64 v[6:7], s[82:83]
    v_mov_b64 v[8:9], s[80:81]
    v_mov_b64 v[10:11], s[82:83]
    v_mov_b64 v[12:13], s[80:81]
    v_mov_b64 v[14:15], s[82:83]
    s_nop 4
    v_cvt_pk_bf16_f32 v104, v104, v105
    v_cvt_pk_bf16_f32 v105, v106, v107
    ds_write_b64 v71, v[104:105] offset:768
    v_cvt_pk_bf16_f32 v108, v108, v109
    v_cvt_pk_bf16_f32 v109, v110, v111
    ds_write_b64 v71, v[108:109] offset:896
    v_add_u32 v70, 0x18000, v70
    s_branch standalone__deep_cross_pnn__recsys_kernel_k2j
standalone__deep_cross_pnn__recsys_kernel_k2m:
    s_barrier

    s_setprio 0
    s_waitcnt vmcnt(0)

    buffer_load_dwordx4 v[136:139], v254, s[12:15], s44 offen offset:0 sc1
    ds_read_b128 v[128:131], v95 offset:0
    ds_read_b128 v[132:135], v95 offset:64
    ds_read_b128 v[144:147], v95 offset:2304
    ds_read_b128 v[148:151], v95 offset:2368
    v_fma_f32 v85, v188, v64, v240
    v_mov_b32 v84, v239
    v_mov_b32 v86, v241
    v_mov_b32 v113, v243
    v_mov_b32 v112, v94
    v_add_u32 v114, 144256, v254
    v_fmac_f32 v85, v189, v65
    v_fmac_f32 v85, v190, v66
    v_fmac_f32 v85, v191, v67
    v_fmac_f32 v85, v192, v68
    buffer_load_dwordx4 v[140:143], v254, s[12:15], s44 offen offset:1024 sc1
    ds_read_b128 v[160:163], v95 offset:4608
    ds_read_b128 v[164:167], v95 offset:4672
    ds_read_b128 v[176:179], v95 offset:6912
    ds_read_b128 v[180:183], v95 offset:6976
    v_fmac_f32 v85, v193, v69
    v_fmac_f32 v85, v194, v70
    v_fmac_f32 v85, v195, v71
    v_fmac_f32 v85, v196, v72
    v_fmac_f32 v85, v197, v73
    buffer_load_dwordx4 v[152:155], v254, s[12:15], s44 offen offset:2048 sc1
    ds_read_b128 v[208:211], v95 offset:11520
    ds_read_b128 v[212:215], v95 offset:11584
    ds_read_b128 v[224:227], v95 offset:13824
    ds_read_b128 v[228:231], v95 offset:13888
    v_fmac_f32 v85, v198, v74
    v_fmac_f32 v85, v199, v75
    v_fmac_f32 v85, v200, v76
    v_fmac_f32 v85, v201, v77
    v_fmac_f32 v85, v202, v78
    buffer_load_dwordx4 v[156:159], v254, s[12:15], s44 offen offset:3072 sc1
    s_add_u32 s44, s44, 4096
    ds_read_b128 v[240:243], v95 offset:16128
    ds_read_b128 v[244:247], v95 offset:16192
    ds_read_b128 v[192:195], v95 offset:9216
    ds_read_b128 v[196:199], v95 offset:9280
    v_fmac_f32 v85, v203, v79
    v_fmac_f32 v85, v204, v80
    v_fmac_f32 v85, v205, v81
    v_fmac_f32 v85, v206, v82
    v_fmac_f32 v85, v207, v83
    buffer_load_dwordx4 v[168:171], v254, s[12:15], s44 offen offset:0 sc1
    v_and_b32 v49, 15, v255
    v_lshrrev_b32 v50, 4, v255
    v_lshlrev_b32 v69, 4, v255
    v_lshlrev_b32 v70, 13, v50
    buffer_load_dwordx4 v[172:175], v254, s[12:15], s44 offen offset:1024 sc1
    v_lshl_add_u32 v70, v49, 3, v70
    v_add_u32 v70, s85, v70
    v_add_u32 v71, 0x10000, v70
    s_waitcnt lgkmcnt(0)
    s_barrier
    s_setprio 2
    ds_read_b128 v[0:3], v114 offset:0
    ds_read_b128 v[4:7], v114 offset:1024
    ds_read_b128 v[8:11], v114 offset:2048
    ds_read_b128 v[12:15], v114 offset:3072
    s_add_u32 s21, s77, 12288
    s_add_u32 s19, s78, 12288
    s_mov_b32 s20, s79
    s_lshr_b32 s33, s2, 1
    s_and_b32 s34, s2, 1
    v_lshrrev_b32 v52, 3, v255
    v_xor_b32 v52, v52, v50
    v_and_b32 v52, 1, v52
    v_bfe_u32 v53, v255, 2, 1
    v_lshl_or_b32 v52, v52, 1, v53
    v_mov_b32 v54, 0x3f80
    s_waitcnt lgkmcnt(0)
    v_mfma_f32_16x16x32_bf16 v[88:91], v[0:3], v[128:131], 0
    buffer_load_dwordx4 v[184:187], v69, s[12:15], s44 offen offset:2048 sc1
    v_cmp_eq_u32 vcc, 0, v52
    ds_read_b128 v[16:19], v114 offset:4096
    ds_read_b128 v[20:23], v114 offset:5120
    ds_read_b128 v[24:27], v114 offset:6144
    ds_read_b128 v[28:31], v114 offset:7168
    v_mfma_f32_16x16x32_bf16 v[92:95], v[0:3], v[144:147], 0
    v_permlane32_swap_b32 v84, v85
    v_mfma_f32_16x16x32_bf16 v[88:91], v[4:7], v[132:135], v[88:91]
    v_cmp_eq_u32 s[68:69], 1, v52
    v_mfma_f32_16x16x32_bf16 v[92:95], v[4:7], v[148:151], v[92:95]
    v_add_f32 v87, v84, v85
    buffer_load_dwordx4 v[188:191], v69, s[12:15], s44 offen offset:3072 sc1
    s_add_u32 s44, s44, 4096
    s_waitcnt vmcnt(4)
    v_mfma_f32_16x16x32_bf16 v[88:91], v[8:11], v[136:139], v[88:91]
    v_and_b32 v53, 3, v255
    v_mfma_f32_16x16x32_bf16 v[92:95], v[8:11], v[152:155], v[92:95]
    v_permlane16_swap_b32 v86, v87
    v_mfma_f32_16x16x32_bf16 v[88:91], v[12:15], v[140:143], v[88:91]
    buffer_load_dwordx4 v[200:203], v69, s[12:15], s44 offen offset:0 sc1
    v_mul_u32_u24 v68, 0x5555, v53
    ds_read_b128 v[32:35], v114 offset:8192
    ds_read_b128 v[36:39], v114 offset:9216
    ds_read_b128 v[40:43], v114 offset:10240
    ds_read_b128 v[44:47], v114 offset:11264
    v_mfma_f32_16x16x32_bf16 v[92:95], v[12:15], v[156:159], v[92:95]
    v_add_f32 v86, v86, v87
    s_waitcnt lgkmcnt(4)
    v_mfma_f32_16x16x32_bf16 v[96:99], v[16:19], v[128:131], 0
    v_cndmask_b32 v64, 0, v54, vcc
    v_mfma_f32_16x16x32_bf16 v[100:103], v[16:19], v[144:147], 0
    v_add_f32_dpp v86, v86, v86 row_ror:8 row_mask:0xf bank_mask:0xf
    buffer_load_dwordx4 v[204:207], v69, s[12:15], s44 offen offset:1024 sc1
    v_mfma_f32_16x16x32_bf16 v[96:99], v[20:23], v[132:135], v[96:99]
    v_cvt_pk_bf16_f32 v88, v88, v89
    v_cndmask_b32 v65, 0, v54, vcc
    v_mfma_f32_16x16x32_bf16 v[100:103], v[20:23], v[148:151], v[100:103]
    v_cvt_pk_bf16_f32 v89, v90, v91
    v_add_f32_dpp v86, v86, v86 row_ror:4 row_mask:0xf bank_mask:0xf
    v_mfma_f32_16x16x32_bf16 v[96:99], v[24:27], v[136:139], v[96:99]
    ds_write_b64 v70, v[88:89] offset:0
    buffer_load_dwordx4 v[216:219], v69, s[12:15], s44 offen offset:2048 sc1
    v_mfma_f32_16x16x32_bf16 v[100:103], v[24:27], v[152:155], v[100:103]
    v_cvt_pk_bf16_f32 v92, v92, v93
    v_cndmask_b32 v66, 0, v54, s[68:69]
    v_mfma_f32_16x16x32_bf16 v[96:99], v[28:31], v[140:143], v[96:99]
    v_cvt_pk_bf16_f32 v93, v94, v95
    v_add_f32_dpp v86, v86, v86 row_ror:2 row_mask:0xf bank_mask:0xf
    v_mfma_f32_16x16x32_bf16 v[100:103], v[28:31], v[156:159], v[100:103]
    ds_write_b64 v70, v[92:93] offset:128
    v_cndmask_b32 v67, 0, v54, s[68:69]
    s_waitcnt lgkmcnt(2)
    v_mfma_f32_16x16x32_bf16 v[104:107], v[32:35], v[128:131], 0
    v_add_f32_dpp v86, v86, v86 row_ror:1 row_mask:0xf bank_mask:0xf
    buffer_load_dwordx4 v[220:223], v69, s[12:15], s44 offen offset:3072 sc1
    s_add_u32 s44, s44, 4096
    v_mfma_f32_16x16x32_bf16 v[108:111], v[32:35], v[144:147], 0
    v_cndmask_b32 v113, v113, v86, s[70:71]
    v_mfma_f32_16x16x32_bf16 v[104:107], v[36:39], v[132:135], v[104:107]
    v_cvt_pk_bf16_f32 v96, v96, v97
    buffer_load_dwordx4 v[232:235], v69, s[12:15], s44 offen offset:0 sc1
    v_mfma_f32_16x16x32_bf16 v[108:111], v[36:39], v[148:151], v[108:111]
    v_cvt_pk_bf16_f32 v97, v98, v99
    v_mfma_f32_16x16x32_bf16 v[104:107], v[40:43], v[136:139], v[104:107]
    ds_write_b64 v70, v[96:97] offset:32768
    v_mfma_f32_16x16x32_bf16 v[108:111], v[40:43], v[152:155], v[108:111]
    v_cvt_pk_bf16_f32 v100, v100, v101
    buffer_load_dwordx4 v[236:239], v69, s[12:15], s44 offen offset:1024 sc1
    v_mfma_f32_16x16x32_bf16 v[104:107], v[44:47], v[140:143], v[104:107]
    v_cvt_pk_bf16_f32 v101, v102, v103
    s_mov_b64 exec, s[46:47]
    buffer_store_dword v113, v112, s[12:15], s76 offen sc1
    s_mov_b64 exec, -1
    v_mfma_f32_16x16x32_bf16 v[108:111], v[44:47], v[156:159], v[108:111]
    ds_write_b64 v70, v[100:101] offset:32896
    v_mov_b64 v[48:49], s[80:81]
    v_mfma_f32_16x16x32_bf16 v[88:91], v[0:3], v[160:163], 0
    buffer_load_dwordx4 v[248:251], v69, s[12:15], s44 offen offset:2048 sc1
    v_mov_b64 v[50:51], s[82:83]
    v_mfma_f32_16x16x32_bf16 v[92:95], v[0:3], v[176:179], 0
    v_mov_b64 v[52:53], s[80:81]
    v_mfma_f32_16x16x32_bf16 v[88:91], v[4:7], v[164:167], v[88:91]
    v_cvt_pk_bf16_f32 v104, v104, v105
    v_mov_b64 v[54:55], s[82:83]
    v_mfma_f32_16x16x32_bf16 v[92:95], v[4:7], v[180:183], v[92:95]
    v_cvt_pk_bf16_f32 v105, v106, v107
    buffer_load_dwordx4 v[252:255], v69, s[12:15], s44 offen offset:3072 sc1
    s_add_u32 s44, s44, 4096
    s_waitcnt vmcnt(9)
    v_mfma_f32_16x16x32_bf16 v[88:91], v[8:11], v[168:171], v[88:91]
    ds_write_b64 v71, v[104:105] offset:0
    v_mov_b64 v[56:57], s[80:81]
    v_mfma_f32_16x16x32_bf16 v[92:95], v[8:11], v[184:187], v[92:95]
    v_cvt_pk_bf16_f32 v108, v108, v109
    v_mov_b64 v[58:59], s[82:83]
    v_mfma_f32_16x16x32_bf16 v[88:91], v[12:15], v[172:175], v[88:91]
    v_cvt_pk_bf16_f32 v109, v110, v111
    v_mov_b64 v[60:61], s[80:81]
    v_mfma_f32_16x16x32_bf16 v[92:95], v[12:15], v[188:191], v[92:95]
    ds_write_b64 v71, v[108:109] offset:128
    buffer_load_dwordx4 v[116:119], v69, s[12:15], s20 offen offset:0 sc1
    v_mfma_f32_16x16x32_bf16 v[96:99], v[16:19], v[160:163], 0
    v_mov_b64 v[62:63], s[82:83]
    v_mfma_f32_16x16x32_bf16 v[100:103], v[16:19], v[176:179], 0
    buffer_load_dwordx4 v[120:123], v69, s[12:15], s20 offen offset:1024 sc1
    v_mfma_f32_16x16x32_bf16 v[96:99], v[20:23], v[164:167], v[96:99]
    v_cvt_pk_bf16_f32 v88, v88, v89
    v_mfma_f32_16x16x32_bf16 v[100:103], v[20:23], v[180:183], v[100:103]
    v_cvt_pk_bf16_f32 v89, v90, v91
    v_mfma_f32_16x16x32_bf16 v[96:99], v[24:27], v[168:171], v[96:99]
    ds_write_b64 v70, v[88:89] offset:256
    buffer_load_dwordx4 v[124:127], v69, s[12:15], s20 offen offset:2048 sc1
    v_mfma_f32_16x16x32_bf16 v[100:103], v[24:27], v[184:187], v[100:103]
    v_cvt_pk_bf16_f32 v92, v92, v93
    v_mfma_f32_16x16x32_bf16 v[96:99], v[28:31], v[172:175], v[96:99]
    v_cvt_pk_bf16_f32 v93, v94, v95
    v_mfma_f32_16x16x32_bf16 v[100:103], v[28:31], v[188:191], v[100:103]
    ds_write_b64 v70, v[92:93] offset:384
    buffer_load_dwordx4 v[72:75], v69, s[12:15], s21 offen offset:0 sc1
    v_mfma_f32_16x16x32_bf16 v[104:107], v[32:35], v[160:163], 0
    v_mfma_f32_16x16x32_bf16 v[108:111], v[32:35], v[176:179], 0
    s_load_dwordx4 s[56:59], s[0:1], 48
    v_mfma_f32_16x16x32_bf16 v[104:107], v[36:39], v[164:167], v[104:107]
    v_cvt_pk_bf16_f32 v96, v96, v97
    buffer_load_dwordx4 v[76:79], v69, s[12:15], s21 offen offset:1024 sc1
    v_mfma_f32_16x16x32_bf16 v[108:111], v[36:39], v[180:183], v[108:111]
    v_cvt_pk_bf16_f32 v97, v98, v99
    v_mfma_f32_16x16x32_bf16 v[104:107], v[40:43], v[168:171], v[104:107]
    ds_write_b64 v70, v[96:97] offset:33024
    v_mfma_f32_16x16x32_bf16 v[108:111], v[40:43], v[184:187], v[108:111]
    v_cvt_pk_bf16_f32 v100, v100, v101
    buffer_load_dwordx4 v[80:83], v69, s[12:15], s19 offen offset:0 sc1
    v_mfma_f32_16x16x32_bf16 v[104:107], v[44:47], v[172:175], v[104:107]
    v_cvt_pk_bf16_f32 v101, v102, v103
    v_mfma_f32_16x16x32_bf16 v[108:111], v[44:47], v[188:191], v[108:111]
    ds_write_b64 v70, v[100:101] offset:33152
    v_mfma_f32_16x16x32_bf16 v[88:91], v[0:3], v[192:195], 0
    buffer_load_dwordx4 v[84:87], v69, s[12:15], s19 offen offset:1024 sc1
    s_add_u32 s21, s21, 4096
    s_add_u32 s19, s19, 4096
    v_mfma_f32_16x16x32_bf16 v[92:95], v[0:3], v[208:211], 0
    v_mfma_f32_16x16x32_bf16 v[88:91], v[4:7], v[196:199], v[88:91]
    v_cvt_pk_bf16_f32 v104, v104, v105
    v_mfma_f32_16x16x32_bf16 v[92:95], v[4:7], v[212:215], v[92:95]
    v_cvt_pk_bf16_f32 v105, v106, v107
    s_waitcnt vmcnt(12)
    v_mfma_f32_16x16x32_bf16 v[88:91], v[8:11], v[200:203], v[88:91]
    ds_write_b64 v71, v[104:105] offset:256
    v_mfma_f32_16x16x32_bf16 v[92:95], v[8:11], v[216:219], v[92:95]
    v_cvt_pk_bf16_f32 v108, v108, v109
    v_mfma_f32_16x16x32_bf16 v[88:91], v[12:15], v[204:207], v[88:91]
    v_cvt_pk_bf16_f32 v109, v110, v111
    v_mfma_f32_16x16x32_bf16 v[92:95], v[12:15], v[220:223], v[92:95]
    ds_write_b64 v71, v[108:109] offset:384
    v_mfma_f32_16x16x32_bf16 v[96:99], v[16:19], v[192:195], 0
    v_mfma_f32_16x16x32_bf16 v[100:103], v[16:19], v[208:211], 0
    v_mfma_f32_16x16x32_bf16 v[96:99], v[20:23], v[196:199], v[96:99]
    v_cvt_pk_bf16_f32 v88, v88, v89
    v_mfma_f32_16x16x32_bf16 v[100:103], v[20:23], v[212:215], v[100:103]
    v_cvt_pk_bf16_f32 v89, v90, v91
    v_mfma_f32_16x16x32_bf16 v[96:99], v[24:27], v[200:203], v[96:99]
    ds_write_b64 v70, v[88:89] offset:512
    v_mfma_f32_16x16x32_bf16 v[100:103], v[24:27], v[216:219], v[100:103]
    v_cvt_pk_bf16_f32 v92, v92, v93
    v_mfma_f32_16x16x32_bf16 v[96:99], v[28:31], v[204:207], v[96:99]
    v_cvt_pk_bf16_f32 v93, v94, v95
    v_mfma_f32_16x16x32_bf16 v[100:103], v[28:31], v[220:223], v[100:103]
    ds_write_b64 v70, v[92:93] offset:640
    v_mfma_f32_16x16x32_bf16 v[104:107], v[32:35], v[192:195], 0
    v_mfma_f32_16x16x32_bf16 v[108:111], v[32:35], v[208:211], 0
    v_mfma_f32_16x16x32_bf16 v[104:107], v[36:39], v[196:199], v[104:107]
    v_cvt_pk_bf16_f32 v96, v96, v97
    v_mfma_f32_16x16x32_bf16 v[108:111], v[36:39], v[212:215], v[108:111]
    v_cvt_pk_bf16_f32 v97, v98, v99
    v_mfma_f32_16x16x32_bf16 v[104:107], v[40:43], v[200:203], v[104:107]
    ds_write_b64 v70, v[96:97] offset:33280
    v_mfma_f32_16x16x32_bf16 v[108:111], v[40:43], v[216:219], v[108:111]
    v_cvt_pk_bf16_f32 v100, v100, v101
    v_mfma_f32_16x16x32_bf16 v[104:107], v[44:47], v[204:207], v[104:107]
    v_cvt_pk_bf16_f32 v101, v102, v103
    v_mfma_f32_16x16x32_bf16 v[108:111], v[44:47], v[220:223], v[108:111]
    ds_write_b64 v70, v[100:101] offset:33408
    v_mfma_f32_16x16x32_bf16 v[88:91], v[0:3], v[224:227], 0
    v_mfma_f32_16x16x32_bf16 v[92:95], v[0:3], v[240:243], 0
    v_mfma_f32_16x16x32_bf16 v[88:91], v[4:7], v[228:231], v[88:91]
    v_cvt_pk_bf16_f32 v104, v104, v105
    v_mfma_f32_16x16x32_bf16 v[92:95], v[4:7], v[244:247], v[92:95]
    v_cvt_pk_bf16_f32 v105, v106, v107
    s_waitcnt vmcnt(7)
    v_mfma_f32_16x16x32_bf16 v[88:91], v[8:11], v[232:235], v[88:91]
    ds_write_b64 v71, v[104:105] offset:512
    v_mfma_f32_16x16x32_bf16 v[92:95], v[8:11], v[248:251], v[92:95]
    v_cvt_pk_bf16_f32 v108, v108, v109
    v_mov_b64 v[0:1], s[80:81]
    v_mfma_f32_16x16x32_bf16 v[88:91], v[12:15], v[236:239], v[88:91]
    v_cvt_pk_bf16_f32 v109, v110, v111
    v_mov_b64 v[2:3], s[82:83]
    v_mfma_f32_16x16x32_bf16 v[92:95], v[12:15], v[252:255], v[92:95]
    ds_write_b64 v71, v[108:109] offset:640
    v_mov_b64 v[4:5], s[80:81]
    v_mfma_f32_16x16x32_bf16 v[96:99], v[16:19], v[224:227], 0
    v_mov_b64 v[6:7], s[82:83]
    v_mfma_f32_16x16x32_bf16 v[100:103], v[16:19], v[240:243], 0
    v_mov_b64 v[8:9], s[80:81]
    v_mov_b64 v[10:11], s[82:83]
    v_mfma_f32_16x16x32_bf16 v[96:99], v[20:23], v[228:231], v[96:99]
    v_cvt_pk_bf16_f32 v88, v88, v89
    v_mfma_f32_16x16x32_bf16 v[100:103], v[20:23], v[244:247], v[100:103]
    v_cvt_pk_bf16_f32 v89, v90, v91
    v_mov_b64 v[12:13], s[80:81]
    v_mfma_f32_16x16x32_bf16 v[96:99], v[24:27], v[232:235], v[96:99]
    ds_write_b64 v70, v[88:89] offset:768
    v_mov_b64 v[14:15], s[82:83]
    v_mfma_f32_16x16x32_bf16 v[100:103], v[24:27], v[248:251], v[100:103]
    v_cvt_pk_bf16_f32 v92, v92, v93
    v_mov_b64 v[16:17], s[80:81]
    v_mfma_f32_16x16x32_bf16 v[96:99], v[28:31], v[236:239], v[96:99]
    v_cvt_pk_bf16_f32 v93, v94, v95
    v_mov_b64 v[18:19], s[82:83]
    v_mfma_f32_16x16x32_bf16 v[100:103], v[28:31], v[252:255], v[100:103]
    ds_write_b64 v70, v[92:93] offset:896
    v_mov_b64 v[20:21], s[80:81]
    v_mfma_f32_16x16x32_bf16 v[104:107], v[32:35], v[224:227], 0
    v_mov_b64 v[22:23], s[82:83]
    v_mfma_f32_16x16x32_bf16 v[108:111], v[32:35], v[240:243], 0
    v_mov_b64 v[24:25], s[80:81]
    v_mov_b64 v[26:27], s[82:83]
    v_mfma_f32_16x16x32_bf16 v[104:107], v[36:39], v[228:231], v[104:107]
    v_cvt_pk_bf16_f32 v96, v96, v97
    v_mfma_f32_16x16x32_bf16 v[108:111], v[36:39], v[244:247], v[108:111]
    v_cvt_pk_bf16_f32 v97, v98, v99
    v_mov_b64 v[28:29], s[80:81]
    v_mfma_f32_16x16x32_bf16 v[104:107], v[40:43], v[232:235], v[104:107]
    ds_write_b64 v70, v[96:97] offset:33536
    v_mov_b64 v[30:31], s[82:83]
    v_mfma_f32_16x16x32_bf16 v[108:111], v[40:43], v[248:251], v[108:111]
    v_cvt_pk_bf16_f32 v100, v100, v101
    v_mov_b64 v[32:33], s[80:81]
    v_mfma_f32_16x16x32_bf16 v[104:107], v[44:47], v[236:239], v[104:107]
    v_cvt_pk_bf16_f32 v101, v102, v103
    v_mov_b64 v[34:35], s[82:83]
    v_mfma_f32_16x16x32_bf16 v[108:111], v[44:47], v[252:255], v[108:111]
    ds_write_b64 v70, v[100:101] offset:33664
    v_mov_b64 v[36:37], s[80:81]
    s_nop 1
    v_mov_b64 v[38:39], s[82:83]
    v_mov_b64 v[40:41], s[80:81]
    v_mov_b64 v[42:43], s[82:83]
    v_mov_b64 v[44:45], s[80:81]
    v_mov_b64 v[46:47], s[82:83]
    s_nop 4
    v_cvt_pk_bf16_f32 v104, v104, v105
    v_cvt_pk_bf16_f32 v105, v106, v107
    ds_write_b64 v71, v[104:105] offset:768
    v_cvt_pk_bf16_f32 v108, v108, v109
    v_cvt_pk_bf16_f32 v109, v110, v111
    ds_write_b64 v71, v[108:109] offset:896
    v_add_u32 v70, 0x18000, v70
standalone__deep_cross_pnn__recsys_kernel_k2j:

    s_mov_b32 s22, 0
    s_mov_b32 s32, 0x8000
    s_mov_b32 s23, 1108378657
    s_mov_b64 exec, 2
    ds_write_b64 v69, v[66:67] offset:8064
    s_mov_b64 exec, -1
    s_mov_b32 s37, 0

    s_mov_b32 m0, 0
    s_waitcnt vmcnt(0) lgkmcnt(0)
    s_barrier

    v_lshlrev_b32_sdwa v88, 3, v116 dst_sel:DWORD dst_unused:UNUSED_PAD src0_sel:DWORD src1_sel:WORD_0
    v_lshlrev_b32_sdwa v90, 3, v116 dst_sel:DWORD dst_unused:UNUSED_PAD src0_sel:DWORD src1_sel:WORD_1
    v_lshlrev_b32_sdwa v92, 3, v117 dst_sel:DWORD dst_unused:UNUSED_PAD src0_sel:DWORD src1_sel:WORD_0
    v_lshlrev_b32_sdwa v94, 3, v117 dst_sel:DWORD dst_unused:UNUSED_PAD src0_sel:DWORD src1_sel:WORD_1
    ds_read_b64 v[88:89], v88
    ds_read_b64 v[90:91], v90
    ds_read_b64 v[92:93], v92
    ds_read_b64 v[94:95], v94
    v_lshlrev_b32_sdwa v96, 3, v118 dst_sel:DWORD dst_unused:UNUSED_PAD src0_sel:DWORD src1_sel:WORD_0
    v_lshlrev_b32_sdwa v98, 3, v118 dst_sel:DWORD dst_unused:UNUSED_PAD src0_sel:DWORD src1_sel:WORD_1
    v_lshlrev_b32_sdwa v100, 3, v119 dst_sel:DWORD dst_unused:UNUSED_PAD src0_sel:DWORD src1_sel:WORD_0
    v_lshlrev_b32_sdwa v102, 3, v119 dst_sel:DWORD dst_unused:UNUSED_PAD src0_sel:DWORD src1_sel:WORD_1
    ds_read_b64 v[96:97], v96
    ds_read_b64 v[98:99], v98
    ds_read_b64 v[100:101], v100
    ds_read_b64 v[102:103], v102
    buffer_load_dwordx4 v[116:119], v69, s[12:15], s20 offen offset:3072 sc1
    s_add_u32 s20, s20, 4096
    s_bitcmp1_b32 s2, 1
    s_cselect_b32 s35, 0, 16
    s_lshl_b32 s28, s28, s35
    s_lshl_b32 s29, s29, s35
    s_lshl_b32 s30, s30, s35
    s_lshl_b32 s31, s31, s35
    s_and_b32 s28, s28, 0xffff0000
    s_and_b32 s29, s29, 0xffff0000
    s_and_b32 s30, s30, 0xffff0000
    s_and_b32 s31, s31, 0xffff0000
    s_cmp_ge_u32 s3, 4
    s_cbranch_scc1 standalone__deep_cross_pnn__recsys_kernel_k2x
    s_waitcnt lgkmcnt(0)
standalone__deep_cross_pnn__recsys_kernel_gloop:
    s_waitcnt vmcnt(6)
    v_lshlrev_b32_sdwa v104, 3, v120 dst_sel:DWORD dst_unused:UNUSED_PAD src0_sel:DWORD src1_sel:WORD_0
    v_lshlrev_b32_sdwa v106, 3, v120 dst_sel:DWORD dst_unused:UNUSED_PAD src0_sel:DWORD src1_sel:WORD_1
    ds_read_b64 v[104:105], v104
    ds_read_b64 v[106:107], v106
    v_lshlrev_b32_sdwa v108, 3, v121 dst_sel:DWORD dst_unused:UNUSED_PAD src0_sel:DWORD src1_sel:WORD_0
    v_lshlrev_b32_sdwa v110, 3, v121 dst_sel:DWORD dst_unused:UNUSED_PAD src0_sel:DWORD src1_sel:WORD_1
    ds_read_b64 v[108:109], v108
    ds_read_b64 v[110:111], v110
    s_waitcnt lgkmcnt(10)
    v_smfmac_f32_16x16x64_bf16 v[0:3], v[64:67], v[88:95], v68
    v_lshlrev_b32_sdwa v88, 3, v122 dst_sel:DWORD dst_unused:UNUSED_PAD src0_sel:DWORD src1_sel:WORD_0
    v_lshlrev_b32_sdwa v90, 3, v122 dst_sel:DWORD dst_unused:UNUSED_PAD src0_sel:DWORD src1_sel:WORD_1
    ds_read_b64 v[88:89], v88
    ds_read_b64 v[90:91], v90
    v_lshlrev_b32_sdwa v92, 3, v123 dst_sel:DWORD dst_unused:UNUSED_PAD src0_sel:DWORD src1_sel:WORD_0
    v_lshlrev_b32_sdwa v94, 3, v123 dst_sel:DWORD dst_unused:UNUSED_PAD src0_sel:DWORD src1_sel:WORD_1
    ds_read_b64 v[92:93], v92
    ds_read_addtid_b32 v71 offset:8080
    ds_read_b64 v[94:95], v94
    s_waitcnt lgkmcnt(9)
    v_smfmac_f32_16x16x64_bf16 v[4:7], v[64:67], v[96:103], v68
    buffer_load_dwordx4 v[120:123], v69, s[12:15], s20 offen offset:0 sc1
    s_waitcnt vmcnt(6)
    v_mfma_f32_16x16x32_bf16 v[112:115], v[72:75], v[128:131], 0
    s_waitcnt vmcnt(5)
    v_lshlrev_b32_sdwa v96, 3, v124 dst_sel:DWORD dst_unused:UNUSED_PAD src0_sel:DWORD src1_sel:WORD_0
    v_lshlrev_b32_sdwa v98, 3, v124 dst_sel:DWORD dst_unused:UNUSED_PAD src0_sel:DWORD src1_sel:WORD_1
    ds_read_b64 v[96:97], v96
    ds_read_b64 v[98:99], v98
    s_waitcnt vmcnt(4)
    v_mfma_f32_16x16x32_bf16 v[112:115], v[76:79], v[132:135], v[112:115]
    v_lshlrev_b32_sdwa v100, 3, v125 dst_sel:DWORD dst_unused:UNUSED_PAD src0_sel:DWORD src1_sel:WORD_0
    v_lshlrev_b32_sdwa v102, 3, v125 dst_sel:DWORD dst_unused:UNUSED_PAD src0_sel:DWORD src1_sel:WORD_1
    ds_read_b64 v[100:101], v100
    ds_read_b64 v[102:103], v102
    s_waitcnt lgkmcnt(9)
    v_smfmac_f32_16x16x64_bf16 v[8:11], v[64:67], v[104:111], v68
    s_waitcnt vmcnt(3)
    v_mfma_f32_16x16x32_bf16 v[112:115], v[80:83], v[136:139], v[112:115]
    v_lshlrev_b32_sdwa v104, 3, v126 dst_sel:DWORD dst_unused:UNUSED_PAD src0_sel:DWORD src1_sel:WORD_0
    v_lshlrev_b32_sdwa v106, 3, v126 dst_sel:DWORD dst_unused:UNUSED_PAD src0_sel:DWORD src1_sel:WORD_1
    ds_read_b64 v[104:105], v104
    ds_read_b64 v[106:107], v106
    s_waitcnt vmcnt(2)
    v_mfma_f32_16x16x32_bf16 v[112:115], v[84:87], v[140:143], v[112:115]
    v_lshlrev_b32_sdwa v108, 3, v127 dst_sel:DWORD dst_unused:UNUSED_PAD src0_sel:DWORD src1_sel:WORD_0
    v_lshlrev_b32_sdwa v110, 3, v127 dst_sel:DWORD dst_unused:UNUSED_PAD src0_sel:DWORD src1_sel:WORD_1
    ds_read_b64 v[108:109], v108
    ds_read_b64 v[110:111], v110
    s_waitcnt lgkmcnt(8)
    v_smfmac_f32_16x16x64_bf16 v[12:15], v[64:67], v[88:95], v68
    buffer_load_dwordx4 v[124:127], v69, s[12:15], s20 offen offset:1024 sc1
    v_readfirstlane_b32 s36, v71
    v_cvt_pk_bf16_f32 v112, v112, v113
    v_cvt_pk_bf16_f32 v113, v114, v115
    s_cmp_lt_u32 s36, s37
    s_cbranch_scc1 standalone__deep_cross_pnn__recsys_kernel_sp0
standalone__deep_cross_pnn__recsys_kernel_sr0:
    s_add_u32 s37, s37, 512
    ds_write_b64 v70, v[112:113] offset:0
    v_mfma_f32_16x16x32_bf16 v[112:115], v[72:75], v[144:147], 0
    v_mfma_f32_16x16x32_bf16 v[112:115], v[76:79], v[148:151], v[112:115]
    s_waitcnt vmcnt(2)
    v_lshlrev_b32_sdwa v88, 3, v116 dst_sel:DWORD dst_unused:UNUSED_PAD src0_sel:DWORD src1_sel:WORD_0
    v_lshlrev_b32_sdwa v90, 3, v116 dst_sel:DWORD dst_unused:UNUSED_PAD src0_sel:DWORD src1_sel:WORD_1
    ds_read_b64 v[88:89], v88
    ds_read_b64 v[90:91], v90
    v_mfma_f32_16x16x32_bf16 v[112:115], v[80:83], v[152:155], v[112:115]
    v_mfma_f32_16x16x32_bf16 v[112:115], v[84:87], v[156:159], v[112:115]
    v_lshlrev_b32_sdwa v92, 3, v117 dst_sel:DWORD dst_unused:UNUSED_PAD src0_sel:DWORD src1_sel:WORD_0
    v_lshlrev_b32_sdwa v94, 3, v117 dst_sel:DWORD dst_unused:UNUSED_PAD src0_sel:DWORD src1_sel:WORD_1
    ds_read_b64 v[92:93], v92
    ds_read_b64 v[94:95], v94
    s_waitcnt lgkmcnt(9)
    v_smfmac_f32_16x16x64_bf16 v[16:19], v[64:67], v[96:103], v68
    s_nop 1
    v_cvt_pk_bf16_f32 v112, v112, v113
    v_cvt_pk_bf16_f32 v113, v114, v115
    ds_write_b64 v70, v[112:113] offset:128
    v_mfma_f32_16x16x32_bf16 v[112:115], v[72:75], v[160:163], 0
    v_lshlrev_b32_sdwa v96, 3, v118 dst_sel:DWORD dst_unused:UNUSED_PAD src0_sel:DWORD src1_sel:WORD_0
    v_lshlrev_b32_sdwa v98, 3, v118 dst_sel:DWORD dst_unused:UNUSED_PAD src0_sel:DWORD src1_sel:WORD_1
    ds_read_b64 v[96:97], v96
    ds_read_b64 v[98:99], v98
    v_mfma_f32_16x16x32_bf16 v[112:115], v[76:79], v[164:167], v[112:115]
    v_lshlrev_b32_sdwa v100, 3, v119 dst_sel:DWORD dst_unused:UNUSED_PAD src0_sel:DWORD src1_sel:WORD_0
    v_lshlrev_b32_sdwa v102, 3, v119 dst_sel:DWORD dst_unused:UNUSED_PAD src0_sel:DWORD src1_sel:WORD_1
    ds_read_b64 v[100:101], v100
    ds_read_b64 v[102:103], v102
    s_waitcnt lgkmcnt(10)
    v_smfmac_f32_16x16x64_bf16 v[20:23], v[64:67], v[104:111], v68
    buffer_load_dwordx4 v[116:119], v69, s[12:15], s20 offen offset:2048 sc1
    s_setprio 2
    v_mfma_f32_16x16x32_bf16 v[112:115], v[80:83], v[168:171], v[112:115]
    s_waitcnt vmcnt(2)
    v_lshlrev_b32_sdwa v104, 3, v120 dst_sel:DWORD dst_unused:UNUSED_PAD src0_sel:DWORD src1_sel:WORD_0
    v_lshlrev_b32_sdwa v106, 3, v120 dst_sel:DWORD dst_unused:UNUSED_PAD src0_sel:DWORD src1_sel:WORD_1
    ds_read_b64 v[104:105], v104
    ds_read_b64 v[106:107], v106
    v_mfma_f32_16x16x32_bf16 v[112:115], v[84:87], v[172:175], v[112:115]
    v_lshlrev_b32_sdwa v108, 3, v121 dst_sel:DWORD dst_unused:UNUSED_PAD src0_sel:DWORD src1_sel:WORD_0
    v_lshlrev_b32_sdwa v110, 3, v121 dst_sel:DWORD dst_unused:UNUSED_PAD src0_sel:DWORD src1_sel:WORD_1
    ds_read_b64 v[108:109], v108
    ds_read_b64 v[110:111], v110
    s_waitcnt lgkmcnt(9)
    v_smfmac_f32_16x16x64_bf16 v[24:27], v[64:67], v[88:95], v68
    s_nop 1
    v_cvt_pk_bf16_f32 v112, v112, v113
    v_cvt_pk_bf16_f32 v113, v114, v115
    ds_write_b64 v70, v[112:113] offset:256
    v_mfma_f32_16x16x32_bf16 v[112:115], v[72:75], v[176:179], 0
    v_mfma_f32_16x16x32_bf16 v[112:115], v[76:79], v[180:183], v[112:115]
    v_lshlrev_b32_sdwa v88, 3, v122 dst_sel:DWORD dst_unused:UNUSED_PAD src0_sel:DWORD src1_sel:WORD_0
    v_lshlrev_b32_sdwa v90, 3, v122 dst_sel:DWORD dst_unused:UNUSED_PAD src0_sel:DWORD src1_sel:WORD_1
    ds_read_b64 v[88:89], v88
    ds_read_b64 v[90:91], v90
    v_mfma_f32_16x16x32_bf16 v[112:115], v[80:83], v[184:187], v[112:115]
    v_mfma_f32_16x16x32_bf16 v[112:115], v[84:87], v[188:191], v[112:115]
    v_lshlrev_b32_sdwa v92, 3, v123 dst_sel:DWORD dst_unused:UNUSED_PAD src0_sel:DWORD src1_sel:WORD_0
    v_lshlrev_b32_sdwa v94, 3, v123 dst_sel:DWORD dst_unused:UNUSED_PAD src0_sel:DWORD src1_sel:WORD_1
    ds_read_b64 v[92:93], v92
    ds_read_b64 v[94:95], v94
    s_waitcnt lgkmcnt(9)
    v_smfmac_f32_16x16x64_bf16 v[28:31], v[64:67], v[96:103], v68
    buffer_load_dwordx4 v[120:123], v69, s[12:15], s20 offen offset:3072 sc1
    s_add_u32 s20, s20, 61440
    v_cvt_pk_bf16_f32 v112, v112, v113
    v_cvt_pk_bf16_f32 v113, v114, v115
    ds_write_b64 v70, v[112:113] offset:384
    v_mfma_f32_16x16x32_bf16 v[112:115], v[72:75], v[192:195], 0
    s_waitcnt vmcnt(2)
    v_lshlrev_b32_sdwa v96, 3, v124 dst_sel:DWORD dst_unused:UNUSED_PAD src0_sel:DWORD src1_sel:WORD_0
    v_lshlrev_b32_sdwa v98, 3, v124 dst_sel:DWORD dst_unused:UNUSED_PAD src0_sel:DWORD src1_sel:WORD_1
    ds_read_b64 v[96:97], v96
    ds_read_b64 v[98:99], v98
    v_mfma_f32_16x16x32_bf16 v[112:115], v[76:79], v[196:199], v[112:115]
    v_lshlrev_b32_sdwa v100, 3, v125 dst_sel:DWORD dst_unused:UNUSED_PAD src0_sel:DWORD src1_sel:WORD_0
    v_lshlrev_b32_sdwa v102, 3, v125 dst_sel:DWORD dst_unused:UNUSED_PAD src0_sel:DWORD src1_sel:WORD_1
    ds_read_b64 v[100:101], v100
    ds_read_b64 v[102:103], v102
    s_waitcnt lgkmcnt(10)
    v_smfmac_f32_16x16x64_bf16 v[32:35], v[64:67], v[104:111], v68
    s_setprio 3
    v_lshlrev_b32_sdwa v104, 3, v126 dst_sel:DWORD dst_unused:UNUSED_PAD src0_sel:DWORD src1_sel:WORD_0
    v_lshlrev_b32_sdwa v106, 3, v126 dst_sel:DWORD dst_unused:UNUSED_PAD src0_sel:DWORD src1_sel:WORD_1
    v_mfma_f32_16x16x32_bf16 v[112:115], v[80:83], v[200:203], v[112:115]
    ds_read_b64 v[104:105], v104
    ds_read_b64 v[106:107], v106
    v_mfma_f32_16x16x32_bf16 v[112:115], v[84:87], v[204:207], v[112:115]
    v_lshlrev_b32_sdwa v108, 3, v127 dst_sel:DWORD dst_unused:UNUSED_PAD src0_sel:DWORD src1_sel:WORD_0
    v_lshlrev_b32_sdwa v110, 3, v127 dst_sel:DWORD dst_unused:UNUSED_PAD src0_sel:DWORD src1_sel:WORD_1
    buffer_load_dwordx4 v[124:127], v69, s[12:15], s20 offen offset:0 sc1
    ds_read_b64 v[108:109], v108
    ds_read_b64 v[110:111], v110
    s_waitcnt lgkmcnt(9)
    v_smfmac_f32_16x16x64_bf16 v[36:39], v[64:67], v[88:95], v68
    s_nop 0
    v_cvt_pk_bf16_f32 v112, v112, v113
    v_cvt_pk_bf16_f32 v113, v114, v115
    ds_write_b64 v70, v[112:113] offset:512
    v_mfma_f32_16x16x32_bf16 v[112:115], v[72:75], v[208:211], 0
    v_mfma_f32_16x16x32_bf16 v[112:115], v[76:79], v[212:215], v[112:115]
    s_waitcnt vmcnt(2)
    v_lshlrev_b32_sdwa v88, 3, v116 dst_sel:DWORD dst_unused:UNUSED_PAD src0_sel:DWORD src1_sel:WORD_0
    v_lshlrev_b32_sdwa v90, 3, v116 dst_sel:DWORD dst_unused:UNUSED_PAD src0_sel:DWORD src1_sel:WORD_1
    ds_read_b64 v[88:89], v88
    ds_read_b64 v[90:91], v90
    v_mfma_f32_16x16x32_bf16 v[112:115], v[80:83], v[216:219], v[112:115]
    v_mfma_f32_16x16x32_bf16 v[112:115], v[84:87], v[220:223], v[112:115]
    v_lshlrev_b32_sdwa v92, 3, v117 dst_sel:DWORD dst_unused:UNUSED_PAD src0_sel:DWORD src1_sel:WORD_0
    v_lshlrev_b32_sdwa v94, 3, v117 dst_sel:DWORD dst_unused:UNUSED_PAD src0_sel:DWORD src1_sel:WORD_1
    ds_read_b64 v[92:93], v92
    ds_read_b64 v[94:95], v94
    s_waitcnt lgkmcnt(9)
    v_smfmac_f32_16x16x64_bf16 v[40:43], v[64:67], v[96:103], v68
    s_nop 1
    v_cvt_pk_bf16_f32 v112, v112, v113
    v_cvt_pk_bf16_f32 v113, v114, v115
    ds_write_b64 v70, v[112:113] offset:640
    v_mfma_f32_16x16x32_bf16 v[112:115], v[72:75], v[224:227], 0
    v_lshlrev_b32_sdwa v96, 3, v118 dst_sel:DWORD dst_unused:UNUSED_PAD src0_sel:DWORD src1_sel:WORD_0
    v_lshlrev_b32_sdwa v98, 3, v118 dst_sel:DWORD dst_unused:UNUSED_PAD src0_sel:DWORD src1_sel:WORD_1
    ds_read_b64 v[96:97], v96
    ds_read_b64 v[98:99], v98
    v_mfma_f32_16x16x32_bf16 v[112:115], v[76:79], v[228:231], v[112:115]
    v_lshlrev_b32_sdwa v100, 3, v119 dst_sel:DWORD dst_unused:UNUSED_PAD src0_sel:DWORD src1_sel:WORD_0
    v_lshlrev_b32_sdwa v102, 3, v119 dst_sel:DWORD dst_unused:UNUSED_PAD src0_sel:DWORD src1_sel:WORD_1
    ds_read_b64 v[100:101], v100
    ds_read_b64 v[102:103], v102
    s_waitcnt lgkmcnt(10)
    v_smfmac_f32_16x16x64_bf16 v[44:47], v[64:67], v[104:111], v68
    buffer_load_dwordx4 v[116:119], v69, s[12:15], s20 offen offset:1024 sc1
    s_setprio 1
    s_waitcnt vmcnt(2)
    v_lshlrev_b32_sdwa v104, 3, v120 dst_sel:DWORD dst_unused:UNUSED_PAD src0_sel:DWORD src1_sel:WORD_0
    v_lshlrev_b32_sdwa v106, 3, v120 dst_sel:DWORD dst_unused:UNUSED_PAD src0_sel:DWORD src1_sel:WORD_1
    v_mfma_f32_16x16x32_bf16 v[112:115], v[80:83], v[232:235], v[112:115]
    ds_read_b64 v[104:105], v104
    ds_read_b64 v[106:107], v106
    v_lshlrev_b32_sdwa v108, 3, v121 dst_sel:DWORD dst_unused:UNUSED_PAD src0_sel:DWORD src1_sel:WORD_0
    v_lshlrev_b32_sdwa v110, 3, v121 dst_sel:DWORD dst_unused:UNUSED_PAD src0_sel:DWORD src1_sel:WORD_1
    v_mfma_f32_16x16x32_bf16 v[112:115], v[84:87], v[236:239], v[112:115]
    ds_read_b64 v[108:109], v108
    ds_read_b64 v[110:111], v110
    s_waitcnt lgkmcnt(9)
    v_smfmac_f32_16x16x64_bf16 v[48:51], v[64:67], v[88:95], v68
    v_lshlrev_b32_sdwa v88, 3, v122 dst_sel:DWORD dst_unused:UNUSED_PAD src0_sel:DWORD src1_sel:WORD_0
    v_lshlrev_b32_sdwa v90, 3, v122 dst_sel:DWORD dst_unused:UNUSED_PAD src0_sel:DWORD src1_sel:WORD_1
    s_nop 1
    v_cvt_pk_bf16_f32 v112, v112, v113
    v_cvt_pk_bf16_f32 v113, v114, v115
    ds_write_b64 v70, v[112:113] offset:768
    v_mfma_f32_16x16x32_bf16 v[112:115], v[72:75], v[240:243], 0
    buffer_load_dwordx4 v[72:75], v69, s[12:15], s21 offen offset:0
    ds_read_b64 v[88:89], v88
    ds_read_b64 v[90:91], v90
    v_lshlrev_b32_sdwa v92, 3, v123 dst_sel:DWORD dst_unused:UNUSED_PAD src0_sel:DWORD src1_sel:WORD_0
    v_lshlrev_b32_sdwa v94, 3, v123 dst_sel:DWORD dst_unused:UNUSED_PAD src0_sel:DWORD src1_sel:WORD_1
    buffer_load_dwordx4 v[120:123], v69, s[12:15], s20 offen offset:2048 sc1
    ds_read_b64 v[92:93], v92
    ds_read_b64 v[94:95], v94
    v_mfma_f32_16x16x32_bf16 v[112:115], v[76:79], v[244:247], v[112:115]
    buffer_load_dwordx4 v[76:79], v69, s[12:15], s21 offen offset:1024
    s_waitcnt lgkmcnt(9)
    v_smfmac_f32_16x16x64_bf16 v[52:55], v[64:67], v[96:103], v68
    s_waitcnt vmcnt(4)
    v_lshlrev_b32_sdwa v96, 3, v124 dst_sel:DWORD dst_unused:UNUSED_PAD src0_sel:DWORD src1_sel:WORD_0
    v_lshlrev_b32_sdwa v98, 3, v124 dst_sel:DWORD dst_unused:UNUSED_PAD src0_sel:DWORD src1_sel:WORD_1
    ds_read_b64 v[96:97], v96
    ds_read_b64 v[98:99], v98
    v_mfma_f32_16x16x32_bf16 v[112:115], v[80:83], v[248:251], v[112:115]
    buffer_load_dwordx4 v[80:83], v69, s[12:15], s19 offen offset:0
    v_lshlrev_b32_sdwa v100, 3, v125 dst_sel:DWORD dst_unused:UNUSED_PAD src0_sel:DWORD src1_sel:WORD_0
    v_lshlrev_b32_sdwa v102, 3, v125 dst_sel:DWORD dst_unused:UNUSED_PAD src0_sel:DWORD src1_sel:WORD_1
    v_mfma_f32_16x16x32_bf16 v[112:115], v[84:87], v[252:255], v[112:115]
    buffer_load_dwordx4 v[84:87], v69, s[12:15], s19 offen offset:1024
    s_add_u32 s21, s21, 4096
    s_add_u32 s19, s19, 4096
    ds_read_b64 v[100:101], v100
    ds_read_b64 v[102:103], v102
    s_waitcnt lgkmcnt(9)
    v_smfmac_f32_16x16x64_bf16 v[56:59], v[64:67], v[104:111], v68
    s_setprio 0
    v_cvt_pk_bf16_f32 v112, v112, v113
    v_cvt_pk_bf16_f32 v113, v114, v115
    ds_write_b64 v70, v[112:113] offset:896
    ds_append v71 offset:8080
    s_add_u32 s23, s23, s23
    s_cselect_b32 s35, 4294836224, s32
    v_add_u32 v70, s35, v70
    v_lshlrev_b32_sdwa v104, 3, v126 dst_sel:DWORD dst_unused:UNUSED_PAD src0_sel:DWORD src1_sel:WORD_0
    v_lshlrev_b32_sdwa v106, 3, v126 dst_sel:DWORD dst_unused:UNUSED_PAD src0_sel:DWORD src1_sel:WORD_1
    ds_read_b64 v[104:105], v104
    ds_read_b64 v[106:107], v106
    v_lshlrev_b32_sdwa v108, 3, v127 dst_sel:DWORD dst_unused:UNUSED_PAD src0_sel:DWORD src1_sel:WORD_0
    v_lshlrev_b32_sdwa v110, 3, v127 dst_sel:DWORD dst_unused:UNUSED_PAD src0_sel:DWORD src1_sel:WORD_1
    buffer_load_dwordx4 v[124:127], v69, s[12:15], s20 offen offset:3072 sc1
    s_add_u32 s20, s20, 4096
    ds_read_b64 v[108:109], v108
    ds_read_b64 v[110:111], v110
    s_waitcnt lgkmcnt(10)
    v_smfmac_f32_16x16x64_bf16 v[60:63], v[64:67], v[88:95], v68

    s_cmpk_eq_u32 s37, 11264
    s_cbranch_scc1 standalone__deep_cross_pnn__recsys_kernel_fin

    s_waitcnt vmcnt(6)
    v_lshlrev_b32_sdwa v88, 3, v116 dst_sel:DWORD dst_unused:UNUSED_PAD src0_sel:DWORD src1_sel:WORD_0
    v_lshlrev_b32_sdwa v90, 3, v116 dst_sel:DWORD dst_unused:UNUSED_PAD src0_sel:DWORD src1_sel:WORD_1
    ds_read_b64 v[88:89], v88
    ds_read_b64 v[90:91], v90
    v_lshlrev_b32_sdwa v92, 3, v117 dst_sel:DWORD dst_unused:UNUSED_PAD src0_sel:DWORD src1_sel:WORD_0
    v_lshlrev_b32_sdwa v94, 3, v117 dst_sel:DWORD dst_unused:UNUSED_PAD src0_sel:DWORD src1_sel:WORD_1
    ds_read_b64 v[92:93], v92
    ds_read_b64 v[94:95], v94
    s_waitcnt lgkmcnt(10)
    v_smfmac_f32_16x16x64_bf16 v[0:3], v[64:67], v[96:103], v68
    v_lshlrev_b32_sdwa v96, 3, v118 dst_sel:DWORD dst_unused:UNUSED_PAD src0_sel:DWORD src1_sel:WORD_0
    v_lshlrev_b32_sdwa v98, 3, v118 dst_sel:DWORD dst_unused:UNUSED_PAD src0_sel:DWORD src1_sel:WORD_1
    ds_read_b64 v[96:97], v96
    ds_read_b64 v[98:99], v98
    v_lshlrev_b32_sdwa v100, 3, v119 dst_sel:DWORD dst_unused:UNUSED_PAD src0_sel:DWORD src1_sel:WORD_0
    v_lshlrev_b32_sdwa v102, 3, v119 dst_sel:DWORD dst_unused:UNUSED_PAD src0_sel:DWORD src1_sel:WORD_1
    ds_read_b64 v[100:101], v100
    ds_read_addtid_b32 v71 offset:8080
    ds_read_b64 v[102:103], v102
    s_waitcnt lgkmcnt(9)
    v_smfmac_f32_16x16x64_bf16 v[4:7], v[64:67], v[104:111], v68
    buffer_load_dwordx4 v[116:119], v69, s[12:15], s20 offen offset:0 sc1
    s_waitcnt vmcnt(6)
    v_mfma_f32_16x16x32_bf16 v[112:115], v[72:75], v[128:131], 0
    s_waitcnt vmcnt(5)
    v_lshlrev_b32_sdwa v104, 3, v120 dst_sel:DWORD dst_unused:UNUSED_PAD src0_sel:DWORD src1_sel:WORD_0
    v_lshlrev_b32_sdwa v106, 3, v120 dst_sel:DWORD dst_unused:UNUSED_PAD src0_sel:DWORD src1_sel:WORD_1
    ds_read_b64 v[104:105], v104
    ds_read_b64 v[106:107], v106
    s_waitcnt vmcnt(4)
    v_mfma_f32_16x16x32_bf16 v[112:115], v[76:79], v[132:135], v[112:115]
    v_lshlrev_b32_sdwa v108, 3, v121 dst_sel:DWORD dst_unused:UNUSED_PAD src0_sel:DWORD src1_sel:WORD_0
    v_lshlrev_b32_sdwa v110, 3, v121 dst_sel:DWORD dst_unused:UNUSED_PAD src0_sel:DWORD src1_sel:WORD_1
    ds_read_b64 v[108:109], v108
    ds_read_b64 v[110:111], v110
    s_waitcnt lgkmcnt(9)
    v_smfmac_f32_16x16x64_bf16 v[8:11], v[64:67], v[88:95], v68
    s_waitcnt vmcnt(3)
    v_mfma_f32_16x16x32_bf16 v[112:115], v[80:83], v[136:139], v[112:115]
    v_lshlrev_b32_sdwa v88, 3, v122 dst_sel:DWORD dst_unused:UNUSED_PAD src0_sel:DWORD src1_sel:WORD_0
    v_lshlrev_b32_sdwa v90, 3, v122 dst_sel:DWORD dst_unused:UNUSED_PAD src0_sel:DWORD src1_sel:WORD_1
    ds_read_b64 v[88:89], v88
    ds_read_b64 v[90:91], v90
    s_waitcnt vmcnt(2)
    v_mfma_f32_16x16x32_bf16 v[112:115], v[84:87], v[140:143], v[112:115]
    v_lshlrev_b32_sdwa v92, 3, v123 dst_sel:DWORD dst_unused:UNUSED_PAD src0_sel:DWORD src1_sel:WORD_0
    v_lshlrev_b32_sdwa v94, 3, v123 dst_sel:DWORD dst_unused:UNUSED_PAD src0_sel:DWORD src1_sel:WORD_1
    ds_read_b64 v[92:93], v92
    ds_read_b64 v[94:95], v94
    s_waitcnt lgkmcnt(8)
    v_smfmac_f32_16x16x64_bf16 v[12:15], v[64:67], v[96:103], v68
    buffer_load_dwordx4 v[120:123], v69, s[12:15], s20 offen offset:1024 sc1
    v_readfirstlane_b32 s36, v71
    v_cvt_pk_bf16_f32 v112, v112, v113
    v_cvt_pk_bf16_f32 v113, v114, v115
    s_cmp_lt_u32 s36, s37
    s_cbranch_scc1 standalone__deep_cross_pnn__recsys_kernel_sp1
standalone__deep_cross_pnn__recsys_kernel_sr1:
    s_add_u32 s37, s37, 512
    ds_write_b64 v70, v[112:113] offset:0
    v_mfma_f32_16x16x32_bf16 v[112:115], v[72:75], v[144:147], 0
    v_mfma_f32_16x16x32_bf16 v[112:115], v[76:79], v[148:151], v[112:115]
    s_waitcnt vmcnt(2)
    v_lshlrev_b32_sdwa v96, 3, v124 dst_sel:DWORD dst_unused:UNUSED_PAD src0_sel:DWORD src1_sel:WORD_0
    v_lshlrev_b32_sdwa v98, 3, v124 dst_sel:DWORD dst_unused:UNUSED_PAD src0_sel:DWORD src1_sel:WORD_1
    ds_read_b64 v[96:97], v96
    ds_read_b64 v[98:99], v98
    v_mfma_f32_16x16x32_bf16 v[112:115], v[80:83], v[152:155], v[112:115]
    v_mfma_f32_16x16x32_bf16 v[112:115], v[84:87], v[156:159], v[112:115]
    v_lshlrev_b32_sdwa v100, 3, v125 dst_sel:DWORD dst_unused:UNUSED_PAD src0_sel:DWORD src1_sel:WORD_0
    v_lshlrev_b32_sdwa v102, 3, v125 dst_sel:DWORD dst_unused:UNUSED_PAD src0_sel:DWORD src1_sel:WORD_1
    ds_read_b64 v[100:101], v100
    ds_read_b64 v[102:103], v102
    s_waitcnt lgkmcnt(9)
    v_smfmac_f32_16x16x64_bf16 v[16:19], v[64:67], v[104:111], v68
    s_nop 1
    v_cvt_pk_bf16_f32 v112, v112, v113
    v_cvt_pk_bf16_f32 v113, v114, v115
    ds_write_b64 v70, v[112:113] offset:128
    v_mfma_f32_16x16x32_bf16 v[112:115], v[72:75], v[160:163], 0
    v_lshlrev_b32_sdwa v104, 3, v126 dst_sel:DWORD dst_unused:UNUSED_PAD src0_sel:DWORD src1_sel:WORD_0
    v_lshlrev_b32_sdwa v106, 3, v126 dst_sel:DWORD dst_unused:UNUSED_PAD src0_sel:DWORD src1_sel:WORD_1
    ds_read_b64 v[104:105], v104
    ds_read_b64 v[106:107], v106
    v_mfma_f32_16x16x32_bf16 v[112:115], v[76:79], v[164:167], v[112:115]
    v_lshlrev_b32_sdwa v108, 3, v127 dst_sel:DWORD dst_unused:UNUSED_PAD src0_sel:DWORD src1_sel:WORD_0
    v_lshlrev_b32_sdwa v110, 3, v127 dst_sel:DWORD dst_unused:UNUSED_PAD src0_sel:DWORD src1_sel:WORD_1
    ds_read_b64 v[108:109], v108
    ds_read_b64 v[110:111], v110
    s_waitcnt lgkmcnt(10)
    v_smfmac_f32_16x16x64_bf16 v[20:23], v[64:67], v[88:95], v68
    buffer_load_dwordx4 v[124:127], v69, s[12:15], s20 offen offset:2048 sc1
    s_setprio 2
    v_mfma_f32_16x16x32_bf16 v[112:115], v[80:83], v[168:171], v[112:115]
    s_waitcnt vmcnt(2)
    v_lshlrev_b32_sdwa v88, 3, v116 dst_sel:DWORD dst_unused:UNUSED_PAD src0_sel:DWORD src1_sel:WORD_0
    v_lshlrev_b32_sdwa v90, 3, v116 dst_sel:DWORD dst_unused:UNUSED_PAD src0_sel:DWORD src1_sel:WORD_1
    ds_read_b64 v[88:89], v88
    ds_read_b64 v[90:91], v90
    v_mfma_f32_16x16x32_bf16 v[112:115], v[84:87], v[172:175], v[112:115]
    v_lshlrev_b32_sdwa v92, 3, v117 dst_sel:DWORD dst_unused:UNUSED_PAD src0_sel:DWORD src1_sel:WORD_0
    v_lshlrev_b32_sdwa v94, 3, v117 dst_sel:DWORD dst_unused:UNUSED_PAD src0_sel:DWORD src1_sel:WORD_1
    ds_read_b64 v[92:93], v92
    ds_read_b64 v[94:95], v94
    s_waitcnt lgkmcnt(9)
    v_smfmac_f32_16x16x64_bf16 v[24:27], v[64:67], v[96:103], v68
    s_nop 1
    v_cvt_pk_bf16_f32 v112, v112, v113
    v_cvt_pk_bf16_f32 v113, v114, v115
    ds_write_b64 v70, v[112:113] offset:256
    v_mfma_f32_16x16x32_bf16 v[112:115], v[72:75], v[176:179], 0
    v_mfma_f32_16x16x32_bf16 v[112:115], v[76:79], v[180:183], v[112:115]
    v_lshlrev_b32_sdwa v96, 3, v118 dst_sel:DWORD dst_unused:UNUSED_PAD src0_sel:DWORD src1_sel:WORD_0
    v_lshlrev_b32_sdwa v98, 3, v118 dst_sel:DWORD dst_unused:UNUSED_PAD src0_sel:DWORD src1_sel:WORD_1
    ds_read_b64 v[96:97], v96
    ds_read_b64 v[98:99], v98
    v_mfma_f32_16x16x32_bf16 v[112:115], v[80:83], v[184:187], v[112:115]
    v_mfma_f32_16x16x32_bf16 v[112:115], v[84:87], v[188:191], v[112:115]
    v_lshlrev_b32_sdwa v100, 3, v119 dst_sel:DWORD dst_unused:UNUSED_PAD src0_sel:DWORD src1_sel:WORD_0
    v_lshlrev_b32_sdwa v102, 3, v119 dst_sel:DWORD dst_unused:UNUSED_PAD src0_sel:DWORD src1_sel:WORD_1
    ds_read_b64 v[100:101], v100
    ds_read_b64 v[102:103], v102
    s_waitcnt lgkmcnt(9)
    v_smfmac_f32_16x16x64_bf16 v[28:31], v[64:67], v[104:111], v68
    buffer_load_dwordx4 v[116:119], v69, s[12:15], s20 offen offset:3072 sc1
    s_add_u32 s20, s20, 61440
    v_cvt_pk_bf16_f32 v112, v112, v113
    v_cvt_pk_bf16_f32 v113, v114, v115
    ds_write_b64 v70, v[112:113] offset:384
    v_mfma_f32_16x16x32_bf16 v[112:115], v[72:75], v[192:195], 0
    s_waitcnt vmcnt(2)
    v_lshlrev_b32_sdwa v104, 3, v120 dst_sel:DWORD dst_unused:UNUSED_PAD src0_sel:DWORD src1_sel:WORD_0
    v_lshlrev_b32_sdwa v106, 3, v120 dst_sel:DWORD dst_unused:UNUSED_PAD src0_sel:DWORD src1_sel:WORD_1
    ds_read_b64 v[104:105], v104
    ds_read_b64 v[106:107], v106
    v_mfma_f32_16x16x32_bf16 v[112:115], v[76:79], v[196:199], v[112:115]
    v_lshlrev_b32_sdwa v108, 3, v121 dst_sel:DWORD dst_unused:UNUSED_PAD src0_sel:DWORD src1_sel:WORD_0
    v_lshlrev_b32_sdwa v110, 3, v121 dst_sel:DWORD dst_unused:UNUSED_PAD src0_sel:DWORD src1_sel:WORD_1
    ds_read_b64 v[108:109], v108
    ds_read_b64 v[110:111], v110
    s_waitcnt lgkmcnt(10)
    v_smfmac_f32_16x16x64_bf16 v[32:35], v[64:67], v[88:95], v68
    s_setprio 3
    v_lshlrev_b32_sdwa v88, 3, v122 dst_sel:DWORD dst_unused:UNUSED_PAD src0_sel:DWORD src1_sel:WORD_0
    v_lshlrev_b32_sdwa v90, 3, v122 dst_sel:DWORD dst_unused:UNUSED_PAD src0_sel:DWORD src1_sel:WORD_1
    v_mfma_f32_16x16x32_bf16 v[112:115], v[80:83], v[200:203], v[112:115]
    ds_read_b64 v[88:89], v88
    ds_read_b64 v[90:91], v90
    v_mfma_f32_16x16x32_bf16 v[112:115], v[84:87], v[204:207], v[112:115]
    v_lshlrev_b32_sdwa v92, 3, v123 dst_sel:DWORD dst_unused:UNUSED_PAD src0_sel:DWORD src1_sel:WORD_0
    v_lshlrev_b32_sdwa v94, 3, v123 dst_sel:DWORD dst_unused:UNUSED_PAD src0_sel:DWORD src1_sel:WORD_1
    buffer_load_dwordx4 v[120:123], v69, s[12:15], s20 offen offset:0 sc1
    ds_read_b64 v[92:93], v92
    ds_read_b64 v[94:95], v94
    s_waitcnt lgkmcnt(9)
    v_smfmac_f32_16x16x64_bf16 v[36:39], v[64:67], v[96:103], v68
    s_nop 0
    v_cvt_pk_bf16_f32 v112, v112, v113
    v_cvt_pk_bf16_f32 v113, v114, v115
    ds_write_b64 v70, v[112:113] offset:512
    v_mfma_f32_16x16x32_bf16 v[112:115], v[72:75], v[208:211], 0
    v_mfma_f32_16x16x32_bf16 v[112:115], v[76:79], v[212:215], v[112:115]
    s_waitcnt vmcnt(2)
    v_lshlrev_b32_sdwa v96, 3, v124 dst_sel:DWORD dst_unused:UNUSED_PAD src0_sel:DWORD src1_sel:WORD_0
    v_lshlrev_b32_sdwa v98, 3, v124 dst_sel:DWORD dst_unused:UNUSED_PAD src0_sel:DWORD src1_sel:WORD_1
    ds_read_b64 v[96:97], v96
    ds_read_b64 v[98:99], v98
    v_mfma_f32_16x16x32_bf16 v[112:115], v[80:83], v[216:219], v[112:115]
    v_mfma_f32_16x16x32_bf16 v[112:115], v[84:87], v[220:223], v[112:115]
    v_lshlrev_b32_sdwa v100, 3, v125 dst_sel:DWORD dst_unused:UNUSED_PAD src0_sel:DWORD src1_sel:WORD_0
    v_lshlrev_b32_sdwa v102, 3, v125 dst_sel:DWORD dst_unused:UNUSED_PAD src0_sel:DWORD src1_sel:WORD_1
    ds_read_b64 v[100:101], v100
    ds_read_b64 v[102:103], v102
    s_waitcnt lgkmcnt(9)
    v_smfmac_f32_16x16x64_bf16 v[40:43], v[64:67], v[104:111], v68
    s_nop 1
    v_cvt_pk_bf16_f32 v112, v112, v113
    v_cvt_pk_bf16_f32 v113, v114, v115
    ds_write_b64 v70, v[112:113] offset:640
    v_mfma_f32_16x16x32_bf16 v[112:115], v[72:75], v[224:227], 0
    v_lshlrev_b32_sdwa v104, 3, v126 dst_sel:DWORD dst_unused:UNUSED_PAD src0_sel:DWORD src1_sel:WORD_0
    v_lshlrev_b32_sdwa v106, 3, v126 dst_sel:DWORD dst_unused:UNUSED_PAD src0_sel:DWORD src1_sel:WORD_1
    ds_read_b64 v[104:105], v104
    ds_read_b64 v[106:107], v106
    v_mfma_f32_16x16x32_bf16 v[112:115], v[76:79], v[228:231], v[112:115]
    v_lshlrev_b32_sdwa v108, 3, v127 dst_sel:DWORD dst_unused:UNUSED_PAD src0_sel:DWORD src1_sel:WORD_0
    v_lshlrev_b32_sdwa v110, 3, v127 dst_sel:DWORD dst_unused:UNUSED_PAD src0_sel:DWORD src1_sel:WORD_1
    ds_read_b64 v[108:109], v108
    ds_read_b64 v[110:111], v110
    s_waitcnt lgkmcnt(10)
    v_smfmac_f32_16x16x64_bf16 v[44:47], v[64:67], v[88:95], v68
    buffer_load_dwordx4 v[124:127], v69, s[12:15], s20 offen offset:1024 sc1
    s_setprio 1
    s_waitcnt vmcnt(2)
    v_lshlrev_b32_sdwa v88, 3, v116 dst_sel:DWORD dst_unused:UNUSED_PAD src0_sel:DWORD src1_sel:WORD_0
    v_lshlrev_b32_sdwa v90, 3, v116 dst_sel:DWORD dst_unused:UNUSED_PAD src0_sel:DWORD src1_sel:WORD_1
    v_mfma_f32_16x16x32_bf16 v[112:115], v[80:83], v[232:235], v[112:115]
    ds_read_b64 v[88:89], v88
    ds_read_b64 v[90:91], v90
    v_lshlrev_b32_sdwa v92, 3, v117 dst_sel:DWORD dst_unused:UNUSED_PAD src0_sel:DWORD src1_sel:WORD_0
    v_lshlrev_b32_sdwa v94, 3, v117 dst_sel:DWORD dst_unused:UNUSED_PAD src0_sel:DWORD src1_sel:WORD_1
    v_mfma_f32_16x16x32_bf16 v[112:115], v[84:87], v[236:239], v[112:115]
    ds_read_b64 v[92:93], v92
    ds_read_b64 v[94:95], v94
    s_waitcnt lgkmcnt(9)
    v_smfmac_f32_16x16x64_bf16 v[48:51], v[64:67], v[96:103], v68
    v_lshlrev_b32_sdwa v96, 3, v118 dst_sel:DWORD dst_unused:UNUSED_PAD src0_sel:DWORD src1_sel:WORD_0
    v_lshlrev_b32_sdwa v98, 3, v118 dst_sel:DWORD dst_unused:UNUSED_PAD src0_sel:DWORD src1_sel:WORD_1
    s_nop 1
    v_cvt_pk_bf16_f32 v112, v112, v113
    v_cvt_pk_bf16_f32 v113, v114, v115
    ds_write_b64 v70, v[112:113] offset:768
    v_mfma_f32_16x16x32_bf16 v[112:115], v[72:75], v[240:243], 0
    buffer_load_dwordx4 v[72:75], v69, s[12:15], s21 offen offset:0
    ds_read_b64 v[96:97], v96
    ds_read_b64 v[98:99], v98
    v_lshlrev_b32_sdwa v100, 3, v119 dst_sel:DWORD dst_unused:UNUSED_PAD src0_sel:DWORD src1_sel:WORD_0
    v_lshlrev_b32_sdwa v102, 3, v119 dst_sel:DWORD dst_unused:UNUSED_PAD src0_sel:DWORD src1_sel:WORD_1
    buffer_load_dwordx4 v[116:119], v69, s[12:15], s20 offen offset:2048 sc1
    ds_read_b64 v[100:101], v100
    ds_read_b64 v[102:103], v102
    v_mfma_f32_16x16x32_bf16 v[112:115], v[76:79], v[244:247], v[112:115]
    buffer_load_dwordx4 v[76:79], v69, s[12:15], s21 offen offset:1024
    s_waitcnt lgkmcnt(9)
    v_smfmac_f32_16x16x64_bf16 v[52:55], v[64:67], v[104:111], v68
    s_waitcnt vmcnt(4)
    v_lshlrev_b32_sdwa v104, 3, v120 dst_sel:DWORD dst_unused:UNUSED_PAD src0_sel:DWORD src1_sel:WORD_0
    v_lshlrev_b32_sdwa v106, 3, v120 dst_sel:DWORD dst_unused:UNUSED_PAD src0_sel:DWORD src1_sel:WORD_1
    ds_read_b64 v[104:105], v104
    ds_read_b64 v[106:107], v106
    v_mfma_f32_16x16x32_bf16 v[112:115], v[80:83], v[248:251], v[112:115]
    buffer_load_dwordx4 v[80:83], v69, s[12:15], s19 offen offset:0
    v_lshlrev_b32_sdwa v108, 3, v121 dst_sel:DWORD dst_unused:UNUSED_PAD src0_sel:DWORD src1_sel:WORD_0
    v_lshlrev_b32_sdwa v110, 3, v121 dst_sel:DWORD dst_unused:UNUSED_PAD src0_sel:DWORD src1_sel:WORD_1
    v_mfma_f32_16x16x32_bf16 v[112:115], v[84:87], v[252:255], v[112:115]
    buffer_load_dwordx4 v[84:87], v69, s[12:15], s19 offen offset:1024
    s_add_u32 s21, s21, 4096
    s_add_u32 s19, s19, 4096
    ds_read_b64 v[108:109], v108
    ds_read_b64 v[110:111], v110
    s_waitcnt lgkmcnt(9)
    v_smfmac_f32_16x16x64_bf16 v[56:59], v[64:67], v[88:95], v68
    s_setprio 0
    v_cvt_pk_bf16_f32 v112, v112, v113
    v_cvt_pk_bf16_f32 v113, v114, v115
    ds_write_b64 v70, v[112:113] offset:896
    ds_append v71 offset:8080
    s_add_u32 s23, s23, s23
    s_cselect_b32 s35, 4294836224, s32
    v_add_u32 v70, s35, v70
    v_lshlrev_b32_sdwa v88, 3, v122 dst_sel:DWORD dst_unused:UNUSED_PAD src0_sel:DWORD src1_sel:WORD_0
    v_lshlrev_b32_sdwa v90, 3, v122 dst_sel:DWORD dst_unused:UNUSED_PAD src0_sel:DWORD src1_sel:WORD_1
    ds_read_b64 v[88:89], v88
    ds_read_b64 v[90:91], v90
    v_lshlrev_b32_sdwa v92, 3, v123 dst_sel:DWORD dst_unused:UNUSED_PAD src0_sel:DWORD src1_sel:WORD_0
    v_lshlrev_b32_sdwa v94, 3, v123 dst_sel:DWORD dst_unused:UNUSED_PAD src0_sel:DWORD src1_sel:WORD_1
    buffer_load_dwordx4 v[120:123], v69, s[12:15], s20 offen offset:3072 sc1
    s_add_u32 s20, s20, 4096
    ds_read_b64 v[92:93], v92
    ds_read_b64 v[94:95], v94
    s_waitcnt lgkmcnt(10)
    v_smfmac_f32_16x16x64_bf16 v[60:63], v[64:67], v[96:103], v68
    s_waitcnt vmcnt(6)
    v_lshlrev_b32_sdwa v96, 3, v124 dst_sel:DWORD dst_unused:UNUSED_PAD src0_sel:DWORD src1_sel:WORD_0
    v_lshlrev_b32_sdwa v98, 3, v124 dst_sel:DWORD dst_unused:UNUSED_PAD src0_sel:DWORD src1_sel:WORD_1
    ds_read_b64 v[96:97], v96
    ds_read_b64 v[98:99], v98
    v_lshlrev_b32_sdwa v100, 3, v125 dst_sel:DWORD dst_unused:UNUSED_PAD src0_sel:DWORD src1_sel:WORD_0
    v_lshlrev_b32_sdwa v102, 3, v125 dst_sel:DWORD dst_unused:UNUSED_PAD src0_sel:DWORD src1_sel:WORD_1
    ds_read_b64 v[100:101], v100
    ds_read_b64 v[102:103], v102
    s_waitcnt lgkmcnt(10)
    v_smfmac_f32_16x16x64_bf16 v[0:3], v[64:67], v[104:111], v68
    v_lshlrev_b32_sdwa v104, 3, v126 dst_sel:DWORD dst_unused:UNUSED_PAD src0_sel:DWORD src1_sel:WORD_0
    v_lshlrev_b32_sdwa v106, 3, v126 dst_sel:DWORD dst_unused:UNUSED_PAD src0_sel:DWORD src1_sel:WORD_1
    ds_read_b64 v[104:105], v104
    ds_read_b64 v[106:107], v106
    v_lshlrev_b32_sdwa v108, 3, v127 dst_sel:DWORD dst_unused:UNUSED_PAD src0_sel:DWORD src1_sel:WORD_0
    v_lshlrev_b32_sdwa v110, 3, v127 dst_sel:DWORD dst_unused:UNUSED_PAD src0_sel:DWORD src1_sel:WORD_1
    ds_read_b64 v[108:109], v108
    ds_read_addtid_b32 v71 offset:8080
    ds_read_b64 v[110:111], v110
    s_waitcnt lgkmcnt(9)
    v_smfmac_f32_16x16x64_bf16 v[4:7], v[64:67], v[88:95], v68
    buffer_load_dwordx4 v[124:127], v69, s[12:15], s20 offen offset:0 sc1
    s_waitcnt vmcnt(6)
    v_mfma_f32_16x16x32_bf16 v[112:115], v[72:75], v[128:131], 0
    s_waitcnt vmcnt(5)
    v_lshlrev_b32_sdwa v88, 3, v116 dst_sel:DWORD dst_unused:UNUSED_PAD src0_sel:DWORD src1_sel:WORD_0
    v_lshlrev_b32_sdwa v90, 3, v116 dst_sel:DWORD dst_unused:UNUSED_PAD src0_sel:DWORD src1_sel:WORD_1
    ds_read_b64 v[88:89], v88
    ds_read_b64 v[90:91], v90
    s_waitcnt vmcnt(4)
    v_mfma_f32_16x16x32_bf16 v[112:115], v[76:79], v[132:135], v[112:115]
    v_lshlrev_b32_sdwa v92, 3, v117 dst_sel:DWORD dst_unused:UNUSED_PAD src0_sel:DWORD src1_sel:WORD_0
    v_lshlrev_b32_sdwa v94, 3, v117 dst_sel:DWORD dst_unused:UNUSED_PAD src0_sel:DWORD src1_sel:WORD_1
    ds_read_b64 v[92:93], v92
    ds_read_b64 v[94:95], v94
    s_waitcnt lgkmcnt(9)
    v_smfmac_f32_16x16x64_bf16 v[8:11], v[64:67], v[96:103], v68
    s_waitcnt vmcnt(3)
    v_mfma_f32_16x16x32_bf16 v[112:115], v[80:83], v[136:139], v[112:115]
    v_lshlrev_b32_sdwa v96, 3, v118 dst_sel:DWORD dst_unused:UNUSED_PAD src0_sel:DWORD src1_sel:WORD_0
    v_lshlrev_b32_sdwa v98, 3, v118 dst_sel:DWORD dst_unused:UNUSED_PAD src0_sel:DWORD src1_sel:WORD_1
    ds_read_b64 v[96:97], v96
    ds_read_b64 v[98:99], v98
    s_waitcnt vmcnt(2)
    v_mfma_f32_16x16x32_bf16 v[112:115], v[84:87], v[140:143], v[112:115]
    v_lshlrev_b32_sdwa v100, 3, v119 dst_sel:DWORD dst_unused:UNUSED_PAD src0_sel:DWORD src1_sel:WORD_0
    v_lshlrev_b32_sdwa v102, 3, v119 dst_sel:DWORD dst_unused:UNUSED_PAD src0_sel:DWORD src1_sel:WORD_1
    ds_read_b64 v[100:101], v100
    ds_read_b64 v[102:103], v102
    s_waitcnt lgkmcnt(8)
    v_smfmac_f32_16x16x64_bf16 v[12:15], v[64:67], v[104:111], v68
    buffer_load_dwordx4 v[116:119], v69, s[12:15], s20 offen offset:1024 sc1
    v_readfirstlane_b32 s36, v71
    v_cvt_pk_bf16_f32 v112, v112, v113
    v_cvt_pk_bf16_f32 v113, v114, v115
    s_cmp_lt_u32 s36, s37
    s_cbranch_scc1 standalone__deep_cross_pnn__recsys_kernel_sp2
standalone__deep_cross_pnn__recsys_kernel_sr2:
    s_add_u32 s37, s37, 512
    ds_write_b64 v70, v[112:113] offset:0
    v_mfma_f32_16x16x32_bf16 v[112:115], v[72:75], v[144:147], 0
    v_mfma_f32_16x16x32_bf16 v[112:115], v[76:79], v[148:151], v[112:115]
    s_waitcnt vmcnt(2)
    v_lshlrev_b32_sdwa v104, 3, v120 dst_sel:DWORD dst_unused:UNUSED_PAD src0_sel:DWORD src1_sel:WORD_0
    v_lshlrev_b32_sdwa v106, 3, v120 dst_sel:DWORD dst_unused:UNUSED_PAD src0_sel:DWORD src1_sel:WORD_1
    ds_read_b64 v[104:105], v104
    ds_read_b64 v[106:107], v106
    v_mfma_f32_16x16x32_bf16 v[112:115], v[80:83], v[152:155], v[112:115]
    v_mfma_f32_16x16x32_bf16 v[112:115], v[84:87], v[156:159], v[112:115]
    v_lshlrev_b32_sdwa v108, 3, v121 dst_sel:DWORD dst_unused:UNUSED_PAD src0_sel:DWORD src1_sel:WORD_0
    v_lshlrev_b32_sdwa v110, 3, v121 dst_sel:DWORD dst_unused:UNUSED_PAD src0_sel:DWORD src1_sel:WORD_1
    ds_read_b64 v[108:109], v108
    ds_read_b64 v[110:111], v110
    s_waitcnt lgkmcnt(9)
    v_smfmac_f32_16x16x64_bf16 v[16:19], v[64:67], v[88:95], v68
    s_nop 1
    v_cvt_pk_bf16_f32 v112, v112, v113
    v_cvt_pk_bf16_f32 v113, v114, v115
    ds_write_b64 v70, v[112:113] offset:128
    v_mfma_f32_16x16x32_bf16 v[112:115], v[72:75], v[160:163], 0
    v_lshlrev_b32_sdwa v88, 3, v122 dst_sel:DWORD dst_unused:UNUSED_PAD src0_sel:DWORD src1_sel:WORD_0
    v_lshlrev_b32_sdwa v90, 3, v122 dst_sel:DWORD dst_unused:UNUSED_PAD src0_sel:DWORD src1_sel:WORD_1
    ds_read_b64 v[88:89], v88
    ds_read_b64 v[90:91], v90
    v_mfma_f32_16x16x32_bf16 v[112:115], v[76:79], v[164:167], v[112:115]
    v_lshlrev_b32_sdwa v92, 3, v123 dst_sel:DWORD dst_unused:UNUSED_PAD src0_sel:DWORD src1_sel:WORD_0
    v_lshlrev_b32_sdwa v94, 3, v123 dst_sel:DWORD dst_unused:UNUSED_PAD src0_sel:DWORD src1_sel:WORD_1
    ds_read_b64 v[92:93], v92
    ds_read_b64 v[94:95], v94
    s_waitcnt lgkmcnt(10)
    v_smfmac_f32_16x16x64_bf16 v[20:23], v[64:67], v[96:103], v68
    buffer_load_dwordx4 v[120:123], v69, s[12:15], s20 offen offset:2048 sc1
    s_setprio 2
    v_mfma_f32_16x16x32_bf16 v[112:115], v[80:83], v[168:171], v[112:115]
    s_waitcnt vmcnt(2)
    v_lshlrev_b32_sdwa v96, 3, v124 dst_sel:DWORD dst_unused:UNUSED_PAD src0_sel:DWORD src1_sel:WORD_0
    v_lshlrev_b32_sdwa v98, 3, v124 dst_sel:DWORD dst_unused:UNUSED_PAD src0_sel:DWORD src1_sel:WORD_1
    ds_read_b64 v[96:97], v96
    ds_read_b64 v[98:99], v98
    v_mfma_f32_16x16x32_bf16 v[112:115], v[84:87], v[172:175], v[112:115]
    v_lshlrev_b32_sdwa v100, 3, v125 dst_sel:DWORD dst_unused:UNUSED_PAD src0_sel:DWORD src1_sel:WORD_0
    v_lshlrev_b32_sdwa v102, 3, v125 dst_sel:DWORD dst_unused:UNUSED_PAD src0_sel:DWORD src1_sel:WORD_1
    ds_read_b64 v[100:101], v100
    ds_read_b64 v[102:103], v102
    s_waitcnt lgkmcnt(9)
    v_smfmac_f32_16x16x64_bf16 v[24:27], v[64:67], v[104:111], v68
    s_nop 1
    v_cvt_pk_bf16_f32 v112, v112, v113
    v_cvt_pk_bf16_f32 v113, v114, v115
    ds_write_b64 v70, v[112:113] offset:256
    v_mfma_f32_16x16x32_bf16 v[112:115], v[72:75], v[176:179], 0
    v_mfma_f32_16x16x32_bf16 v[112:115], v[76:79], v[180:183], v[112:115]
    v_lshlrev_b32_sdwa v104, 3, v126 dst_sel:DWORD dst_unused:UNUSED_PAD src0_sel:DWORD src1_sel:WORD_0
    v_lshlrev_b32_sdwa v106, 3, v126 dst_sel:DWORD dst_unused:UNUSED_PAD src0_sel:DWORD src1_sel:WORD_1
    ds_read_b64 v[104:105], v104
    ds_read_b64 v[106:107], v106
    v_mfma_f32_16x16x32_bf16 v[112:115], v[80:83], v[184:187], v[112:115]
    v_mfma_f32_16x16x32_bf16 v[112:115], v[84:87], v[188:191], v[112:115]
    v_lshlrev_b32_sdwa v108, 3, v127 dst_sel:DWORD dst_unused:UNUSED_PAD src0_sel:DWORD src1_sel:WORD_0
    v_lshlrev_b32_sdwa v110, 3, v127 dst_sel:DWORD dst_unused:UNUSED_PAD src0_sel:DWORD src1_sel:WORD_1
    ds_read_b64 v[108:109], v108
    ds_read_b64 v[110:111], v110
    s_waitcnt lgkmcnt(9)
    v_smfmac_f32_16x16x64_bf16 v[28:31], v[64:67], v[88:95], v68
    buffer_load_dwordx4 v[124:127], v69, s[12:15], s20 offen offset:3072 sc1
    s_add_u32 s20, s20, 61440
    v_cvt_pk_bf16_f32 v112, v112, v113
    v_cvt_pk_bf16_f32 v113, v114, v115
    ds_write_b64 v70, v[112:113] offset:384
    v_mfma_f32_16x16x32_bf16 v[112:115], v[72:75], v[192:195], 0
    s_waitcnt vmcnt(2)
    v_lshlrev_b32_sdwa v88, 3, v116 dst_sel:DWORD dst_unused:UNUSED_PAD src0_sel:DWORD src1_sel:WORD_0
    v_lshlrev_b32_sdwa v90, 3, v116 dst_sel:DWORD dst_unused:UNUSED_PAD src0_sel:DWORD src1_sel:WORD_1
    ds_read_b64 v[88:89], v88
    ds_read_b64 v[90:91], v90
    v_mfma_f32_16x16x32_bf16 v[112:115], v[76:79], v[196:199], v[112:115]
    v_lshlrev_b32_sdwa v92, 3, v117 dst_sel:DWORD dst_unused:UNUSED_PAD src0_sel:DWORD src1_sel:WORD_0
    v_lshlrev_b32_sdwa v94, 3, v117 dst_sel:DWORD dst_unused:UNUSED_PAD src0_sel:DWORD src1_sel:WORD_1
    ds_read_b64 v[92:93], v92
    ds_read_b64 v[94:95], v94
    s_waitcnt lgkmcnt(10)
    v_smfmac_f32_16x16x64_bf16 v[32:35], v[64:67], v[96:103], v68
    s_setprio 3
    v_lshlrev_b32_sdwa v96, 3, v118 dst_sel:DWORD dst_unused:UNUSED_PAD src0_sel:DWORD src1_sel:WORD_0
    v_lshlrev_b32_sdwa v98, 3, v118 dst_sel:DWORD dst_unused:UNUSED_PAD src0_sel:DWORD src1_sel:WORD_1
    v_mfma_f32_16x16x32_bf16 v[112:115], v[80:83], v[200:203], v[112:115]
    ds_read_b64 v[96:97], v96
    ds_read_b64 v[98:99], v98
    v_mfma_f32_16x16x32_bf16 v[112:115], v[84:87], v[204:207], v[112:115]
    v_lshlrev_b32_sdwa v100, 3, v119 dst_sel:DWORD dst_unused:UNUSED_PAD src0_sel:DWORD src1_sel:WORD_0
    v_lshlrev_b32_sdwa v102, 3, v119 dst_sel:DWORD dst_unused:UNUSED_PAD src0_sel:DWORD src1_sel:WORD_1
    buffer_load_dwordx4 v[116:119], v69, s[12:15], s20 offen offset:0 sc1
    ds_read_b64 v[100:101], v100
    ds_read_b64 v[102:103], v102
    s_waitcnt lgkmcnt(9)
    v_smfmac_f32_16x16x64_bf16 v[36:39], v[64:67], v[104:111], v68
    s_nop 0
    v_cvt_pk_bf16_f32 v112, v112, v113
    v_cvt_pk_bf16_f32 v113, v114, v115
    ds_write_b64 v70, v[112:113] offset:512
    v_mfma_f32_16x16x32_bf16 v[112:115], v[72:75], v[208:211], 0
    v_mfma_f32_16x16x32_bf16 v[112:115], v[76:79], v[212:215], v[112:115]
    s_waitcnt vmcnt(2)
    v_lshlrev_b32_sdwa v104, 3, v120 dst_sel:DWORD dst_unused:UNUSED_PAD src0_sel:DWORD src1_sel:WORD_0
    v_lshlrev_b32_sdwa v106, 3, v120 dst_sel:DWORD dst_unused:UNUSED_PAD src0_sel:DWORD src1_sel:WORD_1
    ds_read_b64 v[104:105], v104
    ds_read_b64 v[106:107], v106
    v_mfma_f32_16x16x32_bf16 v[112:115], v[80:83], v[216:219], v[112:115]
    v_mfma_f32_16x16x32_bf16 v[112:115], v[84:87], v[220:223], v[112:115]
    v_lshlrev_b32_sdwa v108, 3, v121 dst_sel:DWORD dst_unused:UNUSED_PAD src0_sel:DWORD src1_sel:WORD_0
    v_lshlrev_b32_sdwa v110, 3, v121 dst_sel:DWORD dst_unused:UNUSED_PAD src0_sel:DWORD src1_sel:WORD_1
    ds_read_b64 v[108:109], v108
    ds_read_b64 v[110:111], v110
    s_waitcnt lgkmcnt(9)
    v_smfmac_f32_16x16x64_bf16 v[40:43], v[64:67], v[88:95], v68
    s_nop 1
    v_cvt_pk_bf16_f32 v112, v112, v113
    v_cvt_pk_bf16_f32 v113, v114, v115
    ds_write_b64 v70, v[112:113] offset:640
    v_mfma_f32_16x16x32_bf16 v[112:115], v[72:75], v[224:227], 0
    v_lshlrev_b32_sdwa v88, 3, v122 dst_sel:DWORD dst_unused:UNUSED_PAD src0_sel:DWORD src1_sel:WORD_0
    v_lshlrev_b32_sdwa v90, 3, v122 dst_sel:DWORD dst_unused:UNUSED_PAD src0_sel:DWORD src1_sel:WORD_1
    ds_read_b64 v[88:89], v88
    ds_read_b64 v[90:91], v90
    v_mfma_f32_16x16x32_bf16 v[112:115], v[76:79], v[228:231], v[112:115]
    v_lshlrev_b32_sdwa v92, 3, v123 dst_sel:DWORD dst_unused:UNUSED_PAD src0_sel:DWORD src1_sel:WORD_0
    v_lshlrev_b32_sdwa v94, 3, v123 dst_sel:DWORD dst_unused:UNUSED_PAD src0_sel:DWORD src1_sel:WORD_1
    ds_read_b64 v[92:93], v92
    ds_read_b64 v[94:95], v94
    s_waitcnt lgkmcnt(10)
    v_smfmac_f32_16x16x64_bf16 v[44:47], v[64:67], v[96:103], v68
    buffer_load_dwordx4 v[120:123], v69, s[12:15], s20 offen offset:1024 sc1
    s_setprio 1
    s_waitcnt vmcnt(2)
    v_lshlrev_b32_sdwa v96, 3, v124 dst_sel:DWORD dst_unused:UNUSED_PAD src0_sel:DWORD src1_sel:WORD_0
    v_lshlrev_b32_sdwa v98, 3, v124 dst_sel:DWORD dst_unused:UNUSED_PAD src0_sel:DWORD src1_sel:WORD_1
    v_mfma_f32_16x16x32_bf16 v[112:115], v[80:83], v[232:235], v[112:115]
    ds_read_b64 v[96:97], v96
    ds_read_b64 v[98:99], v98
    v_lshlrev_b32_sdwa v100, 3, v125 dst_sel:DWORD dst_unused:UNUSED_PAD src0_sel:DWORD src1_sel:WORD_0
    v_lshlrev_b32_sdwa v102, 3, v125 dst_sel:DWORD dst_unused:UNUSED_PAD src0_sel:DWORD src1_sel:WORD_1
    v_mfma_f32_16x16x32_bf16 v[112:115], v[84:87], v[236:239], v[112:115]
    ds_read_b64 v[100:101], v100
    ds_read_b64 v[102:103], v102
    s_waitcnt lgkmcnt(9)
    v_smfmac_f32_16x16x64_bf16 v[48:51], v[64:67], v[104:111], v68
    v_lshlrev_b32_sdwa v104, 3, v126 dst_sel:DWORD dst_unused:UNUSED_PAD src0_sel:DWORD src1_sel:WORD_0
    v_lshlrev_b32_sdwa v106, 3, v126 dst_sel:DWORD dst_unused:UNUSED_PAD src0_sel:DWORD src1_sel:WORD_1
    s_nop 1
    v_cvt_pk_bf16_f32 v112, v112, v113
    v_cvt_pk_bf16_f32 v113, v114, v115
    ds_write_b64 v70, v[112:113] offset:768
    v_mfma_f32_16x16x32_bf16 v[112:115], v[72:75], v[240:243], 0
    buffer_load_dwordx4 v[72:75], v69, s[12:15], s21 offen offset:0
    ds_read_b64 v[104:105], v104
    ds_read_b64 v[106:107], v106
    v_lshlrev_b32_sdwa v108, 3, v127 dst_sel:DWORD dst_unused:UNUSED_PAD src0_sel:DWORD src1_sel:WORD_0
    v_lshlrev_b32_sdwa v110, 3, v127 dst_sel:DWORD dst_unused:UNUSED_PAD src0_sel:DWORD src1_sel:WORD_1
    buffer_load_dwordx4 v[124:127], v69, s[12:15], s20 offen offset:2048 sc1
    ds_read_b64 v[108:109], v108
    ds_read_b64 v[110:111], v110
    v_mfma_f32_16x16x32_bf16 v[112:115], v[76:79], v[244:247], v[112:115]
    buffer_load_dwordx4 v[76:79], v69, s[12:15], s21 offen offset:1024
    s_waitcnt lgkmcnt(9)
    v_smfmac_f32_16x16x64_bf16 v[52:55], v[64:67], v[88:95], v68
    s_waitcnt vmcnt(4)
    v_lshlrev_b32_sdwa v88, 3, v116 dst_sel:DWORD dst_unused:UNUSED_PAD src0_sel:DWORD src1_sel:WORD_0
    v_lshlrev_b32_sdwa v90, 3, v116 dst_sel:DWORD dst_unused:UNUSED_PAD src0_sel:DWORD src1_sel:WORD_1
    ds_read_b64 v[88:89], v88
    ds_read_b64 v[90:91], v90
    v_mfma_f32_16x16x32_bf16 v[112:115], v[80:83], v[248:251], v[112:115]
    buffer_load_dwordx4 v[80:83], v69, s[12:15], s19 offen offset:0
    v_lshlrev_b32_sdwa v92, 3, v117 dst_sel:DWORD dst_unused:UNUSED_PAD src0_sel:DWORD src1_sel:WORD_0
    v_lshlrev_b32_sdwa v94, 3, v117 dst_sel:DWORD dst_unused:UNUSED_PAD src0_sel:DWORD src1_sel:WORD_1
    v_mfma_f32_16x16x32_bf16 v[112:115], v[84:87], v[252:255], v[112:115]
    buffer_load_dwordx4 v[84:87], v69, s[12:15], s19 offen offset:1024
    s_add_u32 s21, s21, 4096
    s_add_u32 s19, s19, 4096
    ds_read_b64 v[92:93], v92
    ds_read_b64 v[94:95], v94
    s_waitcnt lgkmcnt(9)
    v_smfmac_f32_16x16x64_bf16 v[56:59], v[64:67], v[96:103], v68
    s_setprio 0
    v_cvt_pk_bf16_f32 v112, v112, v113
    v_cvt_pk_bf16_f32 v113, v114, v115
    ds_write_b64 v70, v[112:113] offset:896
    ds_append v71 offset:8080
    s_add_u32 s23, s23, s23
    s_cselect_b32 s35, 4294836224, s32
    v_add_u32 v70, s35, v70
    v_lshlrev_b32_sdwa v96, 3, v118 dst_sel:DWORD dst_unused:UNUSED_PAD src0_sel:DWORD src1_sel:WORD_0
    v_lshlrev_b32_sdwa v98, 3, v118 dst_sel:DWORD dst_unused:UNUSED_PAD src0_sel:DWORD src1_sel:WORD_1
    ds_read_b64 v[96:97], v96
    ds_read_b64 v[98:99], v98
    v_lshlrev_b32_sdwa v100, 3, v119 dst_sel:DWORD dst_unused:UNUSED_PAD src0_sel:DWORD src1_sel:WORD_0
    v_lshlrev_b32_sdwa v102, 3, v119 dst_sel:DWORD dst_unused:UNUSED_PAD src0_sel:DWORD src1_sel:WORD_1
    buffer_load_dwordx4 v[116:119], v69, s[12:15], s20 offen offset:3072 sc1
    s_add_u32 s20, s20, 4096
    ds_read_b64 v[100:101], v100
    ds_read_b64 v[102:103], v102
    s_waitcnt lgkmcnt(10)
    v_smfmac_f32_16x16x64_bf16 v[60:63], v[64:67], v[104:111], v68

    s_branch standalone__deep_cross_pnn__recsys_kernel_gloop

standalone__deep_cross_pnn__recsys_kernel_sp0:
    s_sleep 1
    ds_read_addtid_b32 v71 offset:8080
    s_waitcnt lgkmcnt(0)
    v_readfirstlane_b32 s36, v71

    s_cmp_lt_u32 s36, s37
    s_cbranch_scc1 standalone__deep_cross_pnn__recsys_kernel_sp0
    s_branch standalone__deep_cross_pnn__recsys_kernel_sr0
standalone__deep_cross_pnn__recsys_kernel_sp1:
    s_sleep 1
    ds_read_addtid_b32 v71 offset:8080
    s_waitcnt lgkmcnt(0)
    v_readfirstlane_b32 s36, v71

    s_cmp_lt_u32 s36, s37
    s_cbranch_scc1 standalone__deep_cross_pnn__recsys_kernel_sp1
    s_branch standalone__deep_cross_pnn__recsys_kernel_sr1
standalone__deep_cross_pnn__recsys_kernel_sp2:
    s_sleep 1
    ds_read_addtid_b32 v71 offset:8080
    s_waitcnt lgkmcnt(0)
    v_readfirstlane_b32 s36, v71

    s_cmp_lt_u32 s36, s37
    s_cbranch_scc1 standalone__deep_cross_pnn__recsys_kernel_sp2
    s_branch standalone__deep_cross_pnn__recsys_kernel_sr2
standalone__deep_cross_pnn__recsys_kernel_sp3:
    s_sleep 1
    ds_read_addtid_b32 v71 offset:8080
    s_waitcnt lgkmcnt(0)
    v_readfirstlane_b32 s36, v71

    s_cmp_lt_u32 s36, s37
    s_cbranch_scc1 standalone__deep_cross_pnn__recsys_kernel_sp3
    s_branch standalone__deep_cross_pnn__recsys_kernel_sr3
standalone__deep_cross_pnn__recsys_kernel_fin:

    s_add_u32 s40, s20, 61440
    s_add_u32 s41, s20, 65536
    s_add_u32 s44, s20, 126976
    s_add_u32 s45, s20, 131072

    s_lshl_b32 s35, s33, 16
    s_lshl_b32 s42, s34, 15
    s_add_u32 s35, s35, s42
    s_lshl_b32 s42, s3, 12
    s_add_u32 s35, s35, s42
    s_add_u32 s35, s35, 20971520

    v_mov_b32 v128, 0xbdd2d3e8
    v_mov_b32 v129, 0xbdd2d3e8
    v_mov_b32 v130, 0xc0135761
    v_mov_b32 v131, 0xc0135761
    v_mov_b32 v132, 1.0
    v_mov_b32 v133, 1.0
    v_mov_b32 v134, s28
    v_mov_b32 v135, s29
    s_waitcnt vmcnt(6)
    v_lshlrev_b32_sdwa v88, 3, v116 dst_sel:DWORD dst_unused:UNUSED_PAD src0_sel:DWORD src1_sel:WORD_0
    v_lshlrev_b32_sdwa v90, 3, v116 dst_sel:DWORD dst_unused:UNUSED_PAD src0_sel:DWORD src1_sel:WORD_1
    ds_read_b64 v[88:89], v88
    ds_read_b64 v[90:91], v90
    v_lshlrev_b32_sdwa v92, 3, v117 dst_sel:DWORD dst_unused:UNUSED_PAD src0_sel:DWORD src1_sel:WORD_0
    v_lshlrev_b32_sdwa v94, 3, v117 dst_sel:DWORD dst_unused:UNUSED_PAD src0_sel:DWORD src1_sel:WORD_1
    ds_read_b64 v[92:93], v92
    ds_read_b64 v[94:95], v94
    s_waitcnt lgkmcnt(10)
    v_smfmac_f32_16x16x64_bf16 v[0:3], v[64:67], v[96:103], v68
    v_mov_b32 v136, s30
    v_mov_b32 v137, s31
    v_lshrrev_b32 v70, 2, v69
    v_and_b32 v138, 128, v70
    v_add_u32 v70, v70, v138
    v_rcp_f32 v134, v134
    v_rcp_f32 v135, v135
    v_rcp_f32 v136, v136
    v_lshlrev_b32_sdwa v96, 3, v118 dst_sel:DWORD dst_unused:UNUSED_PAD src0_sel:DWORD src1_sel:WORD_0
    v_lshlrev_b32_sdwa v98, 3, v118 dst_sel:DWORD dst_unused:UNUSED_PAD src0_sel:DWORD src1_sel:WORD_1
    ds_read_b64 v[96:97], v96
    ds_read_b64 v[98:99], v98
    v_lshlrev_b32_sdwa v100, 3, v119 dst_sel:DWORD dst_unused:UNUSED_PAD src0_sel:DWORD src1_sel:WORD_0
    v_lshlrev_b32_sdwa v102, 3, v119 dst_sel:DWORD dst_unused:UNUSED_PAD src0_sel:DWORD src1_sel:WORD_1
    ds_read_b64 v[100:101], v100
    ds_read_b64 v[102:103], v102
    buffer_load_dwordx4 v[116:119], v69, s[12:15], s40 offen offset:0 sc1
    s_waitcnt lgkmcnt(8)
    v_smfmac_f32_16x16x64_bf16 v[4:7], v[64:67], v[104:111], v68
    v_rcp_f32 v137, v137
    v_mov_b32 v132, 0x7f7fffff
    v_mov_b32 v133, 0xff7fffff
    v_med3_f32 v134, v134, v132, v133
    v_med3_f32 v135, v135, v132, v133
    v_med3_f32 v136, v136, v132, v133
    v_med3_f32 v137, v137, v132, v133
    s_waitcnt vmcnt(5)
    v_lshlrev_b32_sdwa v104, 3, v120 dst_sel:DWORD dst_unused:UNUSED_PAD src0_sel:DWORD src1_sel:WORD_0
    v_lshlrev_b32_sdwa v106, 3, v120 dst_sel:DWORD dst_unused:UNUSED_PAD src0_sel:DWORD src1_sel:WORD_1
    ds_read_b64 v[104:105], v104
    ds_read_b64 v[106:107], v106
    v_lshlrev_b32_sdwa v108, 3, v121 dst_sel:DWORD dst_unused:UNUSED_PAD src0_sel:DWORD src1_sel:WORD_0
    v_lshlrev_b32_sdwa v110, 3, v121 dst_sel:DWORD dst_unused:UNUSED_PAD src0_sel:DWORD src1_sel:WORD_1
    ds_read_b64 v[108:109], v108
    ds_read_b64 v[110:111], v110
    s_waitcnt lgkmcnt(8)
    v_smfmac_f32_16x16x64_bf16 v[8:11], v[64:67], v[88:95], v68
    v_lshlrev_b32_sdwa v88, 3, v122 dst_sel:DWORD dst_unused:UNUSED_PAD src0_sel:DWORD src1_sel:WORD_0
    v_lshlrev_b32_sdwa v90, 3, v122 dst_sel:DWORD dst_unused:UNUSED_PAD src0_sel:DWORD src1_sel:WORD_1
    ds_read_b64 v[88:89], v88
    ds_read_b64 v[90:91], v90
    ds_read_addtid_b32 v71 offset:8080
    v_lshlrev_b32_sdwa v92, 3, v123 dst_sel:DWORD dst_unused:UNUSED_PAD src0_sel:DWORD src1_sel:WORD_0
    v_lshlrev_b32_sdwa v94, 3, v123 dst_sel:DWORD dst_unused:UNUSED_PAD src0_sel:DWORD src1_sel:WORD_1
    ds_read_b64 v[92:93], v92
    ds_read_b64 v[94:95], v94
    buffer_load_dwordx4 v[120:123], v69, s[12:15], s44 offen offset:0 sc1
    s_waitcnt lgkmcnt(9)
    v_smfmac_f32_16x16x64_bf16 v[12:15], v[64:67], v[96:103], v68
    s_waitcnt vmcnt(2)
    v_lshlrev_b32_sdwa v96, 3, v124 dst_sel:DWORD dst_unused:UNUSED_PAD src0_sel:DWORD src1_sel:WORD_0
    v_lshlrev_b32_sdwa v98, 3, v124 dst_sel:DWORD dst_unused:UNUSED_PAD src0_sel:DWORD src1_sel:WORD_1
    ds_read_b64 v[96:97], v96
    ds_read_b64 v[98:99], v98
    v_lshlrev_b32_sdwa v100, 3, v125 dst_sel:DWORD dst_unused:UNUSED_PAD src0_sel:DWORD src1_sel:WORD_0
    v_lshlrev_b32_sdwa v102, 3, v125 dst_sel:DWORD dst_unused:UNUSED_PAD src0_sel:DWORD src1_sel:WORD_1
    ds_read_b64 v[100:101], v100
    ds_read_b64 v[102:103], v102
    s_waitcnt lgkmcnt(9)
    v_smfmac_f32_16x16x64_bf16 v[16:19], v[64:67], v[104:111], v68
    v_lshlrev_b32_sdwa v104, 3, v126 dst_sel:DWORD dst_unused:UNUSED_PAD src0_sel:DWORD src1_sel:WORD_0
    v_lshlrev_b32_sdwa v106, 3, v126 dst_sel:DWORD dst_unused:UNUSED_PAD src0_sel:DWORD src1_sel:WORD_1
    ds_read_b64 v[104:105], v104
    ds_read_b64 v[106:107], v106
    v_lshlrev_b32_sdwa v108, 3, v127 dst_sel:DWORD dst_unused:UNUSED_PAD src0_sel:DWORD src1_sel:WORD_0
    v_lshlrev_b32_sdwa v110, 3, v127 dst_sel:DWORD dst_unused:UNUSED_PAD src0_sel:DWORD src1_sel:WORD_1
    ds_read_b64 v[108:109], v108
    ds_read_b64 v[110:111], v110
    buffer_load_dwordx4 v[124:127], v69, s[12:15], s40 offen offset:1024 sc1
    s_waitcnt lgkmcnt(8)
    v_smfmac_f32_16x16x64_bf16 v[20:23], v[64:67], v[88:95], v68
    v_readfirstlane_b32 s36, v71
    s_waitcnt vmcnt(2)
    s_cmp_lt_u32 s36, s37
    s_cbranch_scc1 standalone__deep_cross_pnn__recsys_kernel_sp3
standalone__deep_cross_pnn__recsys_kernel_sr3:
    v_lshlrev_b32_sdwa v88, 3, v116 dst_sel:DWORD dst_unused:UNUSED_PAD src0_sel:DWORD src1_sel:WORD_0
    v_lshlrev_b32_sdwa v90, 3, v116 dst_sel:DWORD dst_unused:UNUSED_PAD src0_sel:DWORD src1_sel:WORD_1
    ds_read_b64 v[88:89], v88
    ds_read_b64 v[90:91], v90
    v_lshlrev_b32_sdwa v92, 3, v117 dst_sel:DWORD dst_unused:UNUSED_PAD src0_sel:DWORD src1_sel:WORD_0
    v_lshlrev_b32_sdwa v94, 3, v117 dst_sel:DWORD dst_unused:UNUSED_PAD src0_sel:DWORD src1_sel:WORD_1
    ds_read_b64 v[92:93], v92
    ds_read_b64 v[94:95], v94
    s_waitcnt lgkmcnt(8)
    v_smfmac_f32_16x16x64_bf16 v[24:27], v[64:67], v[96:103], v68
    v_lshlrev_b32_sdwa v96, 3, v118 dst_sel:DWORD dst_unused:UNUSED_PAD src0_sel:DWORD src1_sel:WORD_0
    v_lshlrev_b32_sdwa v98, 3, v118 dst_sel:DWORD dst_unused:UNUSED_PAD src0_sel:DWORD src1_sel:WORD_1
    ds_read_b64 v[96:97], v96
    ds_read_b64 v[98:99], v98
    v_lshlrev_b32_sdwa v100, 3, v119 dst_sel:DWORD dst_unused:UNUSED_PAD src0_sel:DWORD src1_sel:WORD_0
    v_lshlrev_b32_sdwa v102, 3, v119 dst_sel:DWORD dst_unused:UNUSED_PAD src0_sel:DWORD src1_sel:WORD_1
    ds_read_b64 v[100:101], v100
    ds_read_b64 v[102:103], v102
    buffer_load_dwordx4 v[116:119], v69, s[12:15], s44 offen offset:1024 sc1
    s_waitcnt lgkmcnt(8)
    v_smfmac_f32_16x16x64_bf16 v[28:31], v[64:67], v[104:111], v68
    s_waitcnt vmcnt(2)
    v_lshlrev_b32_sdwa v104, 3, v120 dst_sel:DWORD dst_unused:UNUSED_PAD src0_sel:DWORD src1_sel:WORD_0
    v_lshlrev_b32_sdwa v106, 3, v120 dst_sel:DWORD dst_unused:UNUSED_PAD src0_sel:DWORD src1_sel:WORD_1
    ds_read_b64 v[104:105], v104
    ds_read_b64 v[106:107], v106
    v_lshlrev_b32_sdwa v108, 3, v121 dst_sel:DWORD dst_unused:UNUSED_PAD src0_sel:DWORD src1_sel:WORD_0
    v_lshlrev_b32_sdwa v110, 3, v121 dst_sel:DWORD dst_unused:UNUSED_PAD src0_sel:DWORD src1_sel:WORD_1
    ds_read_b64 v[108:109], v108
    ds_read_b64 v[110:111], v110
    s_waitcnt lgkmcnt(8)
    v_smfmac_f32_16x16x64_bf16 v[0:3], v[64:67], v[88:95], v68
    v_lshlrev_b32_sdwa v88, 3, v122 dst_sel:DWORD dst_unused:UNUSED_PAD src0_sel:DWORD src1_sel:WORD_0
    v_lshlrev_b32_sdwa v90, 3, v122 dst_sel:DWORD dst_unused:UNUSED_PAD src0_sel:DWORD src1_sel:WORD_1
    ds_read_b64 v[88:89], v88
    ds_read_b64 v[90:91], v90
    v_lshlrev_b32_sdwa v92, 3, v123 dst_sel:DWORD dst_unused:UNUSED_PAD src0_sel:DWORD src1_sel:WORD_0
    v_lshlrev_b32_sdwa v94, 3, v123 dst_sel:DWORD dst_unused:UNUSED_PAD src0_sel:DWORD src1_sel:WORD_1
    ds_read_b64 v[92:93], v92
    ds_read_b64 v[94:95], v94
    buffer_load_dwordx4 v[120:123], v69, s[12:15], s40 offen offset:2048 sc1
    s_waitcnt lgkmcnt(8)
    v_smfmac_f32_16x16x64_bf16 v[4:7], v[64:67], v[96:103], v68
    s_waitcnt vmcnt(2)
    v_lshlrev_b32_sdwa v96, 3, v124 dst_sel:DWORD dst_unused:UNUSED_PAD src0_sel:DWORD src1_sel:WORD_0
    v_lshlrev_b32_sdwa v98, 3, v124 dst_sel:DWORD dst_unused:UNUSED_PAD src0_sel:DWORD src1_sel:WORD_1
    ds_read_b64 v[96:97], v96
    ds_read_b64 v[98:99], v98
    v_lshlrev_b32_sdwa v100, 3, v125 dst_sel:DWORD dst_unused:UNUSED_PAD src0_sel:DWORD src1_sel:WORD_0
    v_lshlrev_b32_sdwa v102, 3, v125 dst_sel:DWORD dst_unused:UNUSED_PAD src0_sel:DWORD src1_sel:WORD_1
    ds_read_b64 v[100:101], v100
    ds_read_b64 v[102:103], v102
    s_waitcnt lgkmcnt(8)
    v_smfmac_f32_16x16x64_bf16 v[0:3], v[64:67], v[104:111], v68
    v_lshlrev_b32_sdwa v104, 3, v126 dst_sel:DWORD dst_unused:UNUSED_PAD src0_sel:DWORD src1_sel:WORD_0
    v_lshlrev_b32_sdwa v106, 3, v126 dst_sel:DWORD dst_unused:UNUSED_PAD src0_sel:DWORD src1_sel:WORD_1
    ds_read_b64 v[104:105], v104
    ds_read_b64 v[106:107], v106
    v_lshlrev_b32_sdwa v108, 3, v127 dst_sel:DWORD dst_unused:UNUSED_PAD src0_sel:DWORD src1_sel:WORD_0
    v_lshlrev_b32_sdwa v110, 3, v127 dst_sel:DWORD dst_unused:UNUSED_PAD src0_sel:DWORD src1_sel:WORD_1
    ds_read_b64 v[108:109], v108
    ds_read_b64 v[110:111], v110
    buffer_load_dwordx4 v[124:127], v69, s[12:15], s44 offen offset:2048 sc1
    s_waitcnt lgkmcnt(8)
    v_smfmac_f32_16x16x64_bf16 v[4:7], v[64:67], v[88:95], v68
    s_waitcnt vmcnt(2)
    v_lshlrev_b32_sdwa v88, 3, v116 dst_sel:DWORD dst_unused:UNUSED_PAD src0_sel:DWORD src1_sel:WORD_0
    v_lshlrev_b32_sdwa v90, 3, v116 dst_sel:DWORD dst_unused:UNUSED_PAD src0_sel:DWORD src1_sel:WORD_1
    ds_read_b64 v[88:89], v88
    ds_read_b64 v[90:91], v90
    v_lshlrev_b32_sdwa v92, 3, v117 dst_sel:DWORD dst_unused:UNUSED_PAD src0_sel:DWORD src1_sel:WORD_0
    v_lshlrev_b32_sdwa v94, 3, v117 dst_sel:DWORD dst_unused:UNUSED_PAD src0_sel:DWORD src1_sel:WORD_1
    ds_read_b64 v[92:93], v92
    ds_read_b64 v[94:95], v94
    s_waitcnt lgkmcnt(8)
    v_smfmac_f32_16x16x64_bf16 v[8:11], v[64:67], v[96:103], v68
    v_pk_mul_f32 v[140:141], v[0:1], v[0:1]
    v_pk_mul_f32 v[142:143], v[2:3], v[2:3]
    v_pk_fma_f32 v[140:141], v[140:141], v[128:129], v[130:131]
    v_pk_fma_f32 v[142:143], v[142:143], v[128:129], v[130:131]
    v_pk_mul_f32 v[140:141], v[140:141], v[0:1]
    v_pk_mul_f32 v[142:143], v[142:143], v[2:3]
    v_exp_f32 v140, v140
    v_pk_mul_f32 v[146:147], v[4:5], v[4:5]
    v_lshlrev_b32_sdwa v96, 3, v118 dst_sel:DWORD dst_unused:UNUSED_PAD src0_sel:DWORD src1_sel:WORD_0
    v_lshlrev_b32_sdwa v98, 3, v118 dst_sel:DWORD dst_unused:UNUSED_PAD src0_sel:DWORD src1_sel:WORD_1
    ds_read_b64 v[96:97], v96
    ds_read_b64 v[98:99], v98
    v_lshlrev_b32_sdwa v100, 3, v119 dst_sel:DWORD dst_unused:UNUSED_PAD src0_sel:DWORD src1_sel:WORD_0
    v_lshlrev_b32_sdwa v102, 3, v119 dst_sel:DWORD dst_unused:UNUSED_PAD src0_sel:DWORD src1_sel:WORD_1
    ds_read_b64 v[100:101], v100
    ds_read_b64 v[102:103], v102
    buffer_load_dwordx4 v[116:119], v69, s[12:15], s40 offen offset:3072 sc1
    s_waitcnt lgkmcnt(8)
    v_smfmac_f32_16x16x64_bf16 v[12:15], v[64:67], v[104:111], v68
    v_exp_f32 v141, v141
    v_pk_fma_f32 v[146:147], v[146:147], v[128:129], v[130:131]
    v_pk_mul_f32 v[148:149], v[6:7], v[6:7]
    v_exp_f32 v142, v142
    v_pk_fma_f32 v[140:141], v[140:141], v[134:135], v[134:135]
    v_pk_mul_f32 v[146:147], v[146:147], v[4:5]
    v_rcp_f32 v140, v140
    v_pk_fma_f32 v[148:149], v[148:149], v[128:129], v[130:131]
    s_waitcnt vmcnt(2)
    v_lshlrev_b32_sdwa v104, 3, v120 dst_sel:DWORD dst_unused:UNUSED_PAD src0_sel:DWORD src1_sel:WORD_0
    v_lshlrev_b32_sdwa v106, 3, v120 dst_sel:DWORD dst_unused:UNUSED_PAD src0_sel:DWORD src1_sel:WORD_1
    ds_read_b64 v[104:105], v104
    ds_read_b64 v[106:107], v106
    v_lshlrev_b32_sdwa v108, 3, v121 dst_sel:DWORD dst_unused:UNUSED_PAD src0_sel:DWORD src1_sel:WORD_0
    v_lshlrev_b32_sdwa v110, 3, v121 dst_sel:DWORD dst_unused:UNUSED_PAD src0_sel:DWORD src1_sel:WORD_1
    ds_read_b64 v[108:109], v108
    ds_read_b64 v[110:111], v110
    s_waitcnt lgkmcnt(8)
    v_smfmac_f32_16x16x64_bf16 v[8:11], v[64:67], v[88:95], v68
    v_rcp_f32 v141, v141
    v_pk_mul_f32 v[148:149], v[148:149], v[6:7]
    v_exp_f32 v143, v143
    v_pk_mul_f32 v[144:145], v[0:1], v[140:141]
    v_exp_f32 v146, v146
    v_pk_fma_f32 v[142:143], v[142:143], v[136:137], v[136:137]
    v_exp_f32 v147, v147
    v_rcp_f32 v142, v142
    v_lshlrev_b32_sdwa v88, 3, v122 dst_sel:DWORD dst_unused:UNUSED_PAD src0_sel:DWORD src1_sel:WORD_0
    v_lshlrev_b32_sdwa v90, 3, v122 dst_sel:DWORD dst_unused:UNUSED_PAD src0_sel:DWORD src1_sel:WORD_1
    ds_read_b64 v[88:89], v88
    ds_read_b64 v[90:91], v90
    v_lshlrev_b32_sdwa v92, 3, v123 dst_sel:DWORD dst_unused:UNUSED_PAD src0_sel:DWORD src1_sel:WORD_0
    v_lshlrev_b32_sdwa v94, 3, v123 dst_sel:DWORD dst_unused:UNUSED_PAD src0_sel:DWORD src1_sel:WORD_1
    ds_read_b64 v[92:93], v92
    ds_read_b64 v[94:95], v94
    buffer_load_dwordx4 v[120:123], v69, s[12:15], s44 offen offset:3072 sc1
    s_waitcnt lgkmcnt(8)
    v_smfmac_f32_16x16x64_bf16 v[12:15], v[64:67], v[96:103], v68
    v_rcp_f32 v143, v143
    v_pk_fma_f32 v[146:147], v[146:147], v[134:135], v[134:135]
    v_pk_mul_f32 v[152:153], v[8:9], v[8:9]
    v_rcp_f32 v146, v146
    v_pk_fma_f32 v[144:145], v[2:3], v[142:143], v[144:145]
    v_pk_fma_f32 v[152:153], v[152:153], v[128:129], v[130:131]
    v_rcp_f32 v147, v147
    v_add_f32 v144, v144, v145
    s_waitcnt vmcnt(2)
    v_lshlrev_b32_sdwa v96, 3, v124 dst_sel:DWORD dst_unused:UNUSED_PAD src0_sel:DWORD src1_sel:WORD_0
    v_lshlrev_b32_sdwa v98, 3, v124 dst_sel:DWORD dst_unused:UNUSED_PAD src0_sel:DWORD src1_sel:WORD_1
    ds_read_b64 v[96:97], v96
    ds_read_b64 v[98:99], v98
    v_lshlrev_b32_sdwa v100, 3, v125 dst_sel:DWORD dst_unused:UNUSED_PAD src0_sel:DWORD src1_sel:WORD_0
    v_lshlrev_b32_sdwa v102, 3, v125 dst_sel:DWORD dst_unused:UNUSED_PAD src0_sel:DWORD src1_sel:WORD_1
    ds_read_b64 v[100:101], v100
    ds_read_b64 v[102:103], v102
    s_waitcnt lgkmcnt(8)
    v_smfmac_f32_16x16x64_bf16 v[16:19], v[64:67], v[104:111], v68
    v_exp_f32 v148, v148
    buffer_store_dword v144, v70, s[12:15], s35 offen offset:0 sc1
    v_pk_mul_f32 v[150:151], v[4:5], v[146:147]
    v_exp_f32 v149, v149
    v_pk_mul_f32 v[152:153], v[152:153], v[8:9]
    v_pk_mul_f32 v[154:155], v[10:11], v[10:11]
    v_exp_f32 v152, v152
    v_pk_fma_f32 v[148:149], v[148:149], v[136:137], v[136:137]
    v_lshlrev_b32_sdwa v104, 3, v126 dst_sel:DWORD dst_unused:UNUSED_PAD src0_sel:DWORD src1_sel:WORD_0
    v_lshlrev_b32_sdwa v106, 3, v126 dst_sel:DWORD dst_unused:UNUSED_PAD src0_sel:DWORD src1_sel:WORD_1
    ds_read_b64 v[104:105], v104
    ds_read_b64 v[106:107], v106
    v_lshlrev_b32_sdwa v108, 3, v127 dst_sel:DWORD dst_unused:UNUSED_PAD src0_sel:DWORD src1_sel:WORD_0
    v_lshlrev_b32_sdwa v110, 3, v127 dst_sel:DWORD dst_unused:UNUSED_PAD src0_sel:DWORD src1_sel:WORD_1
    ds_read_b64 v[108:109], v108
    ds_read_b64 v[110:111], v110
    buffer_load_dwordx4 v[124:127], v69, s[12:15], s20 offen offset:0 sc1
    s_waitcnt lgkmcnt(8)
    v_smfmac_f32_16x16x64_bf16 v[20:23], v[64:67], v[88:95], v68
    v_rcp_f32 v148, v148
    v_pk_fma_f32 v[154:155], v[154:155], v[128:129], v[130:131]
    v_pk_mul_f32 v[158:159], v[12:13], v[12:13]
    v_rcp_f32 v149, v149
    v_pk_mul_f32 v[154:155], v[154:155], v[10:11]
    v_pk_fma_f32 v[158:159], v[158:159], v[128:129], v[130:131]
    v_exp_f32 v153, v153
    v_pk_fma_f32 v[150:151], v[6:7], v[148:149], v[150:151]
    s_waitcnt vmcnt(3)
    v_lshlrev_b32_sdwa v88, 3, v116 dst_sel:DWORD dst_unused:UNUSED_PAD src0_sel:DWORD src1_sel:WORD_0
    v_lshlrev_b32_sdwa v90, 3, v116 dst_sel:DWORD dst_unused:UNUSED_PAD src0_sel:DWORD src1_sel:WORD_1
    ds_read_b64 v[88:89], v88
    ds_read_b64 v[90:91], v90
    v_lshlrev_b32_sdwa v92, 3, v117 dst_sel:DWORD dst_unused:UNUSED_PAD src0_sel:DWORD src1_sel:WORD_0
    v_lshlrev_b32_sdwa v94, 3, v117 dst_sel:DWORD dst_unused:UNUSED_PAD src0_sel:DWORD src1_sel:WORD_1
    ds_read_b64 v[92:93], v92
    ds_read_b64 v[94:95], v94
    s_waitcnt lgkmcnt(8)
    v_smfmac_f32_16x16x64_bf16 v[16:19], v[64:67], v[96:103], v68
    v_exp_f32 v154, v154
    v_add_f32 v150, v150, v151
    v_pk_fma_f32 v[152:153], v[152:153], v[134:135], v[134:135]
    v_exp_f32 v155, v155
    buffer_store_dword v150, v70, s[12:15], s35 offen offset:128 sc1
    v_pk_mul_f32 v[158:159], v[158:159], v[12:13]
    v_rcp_f32 v152, v152
    v_pk_fma_f32 v[154:155], v[154:155], v[136:137], v[136:137]
    v_lshlrev_b32_sdwa v96, 3, v118 dst_sel:DWORD dst_unused:UNUSED_PAD src0_sel:DWORD src1_sel:WORD_0
    v_lshlrev_b32_sdwa v98, 3, v118 dst_sel:DWORD dst_unused:UNUSED_PAD src0_sel:DWORD src1_sel:WORD_1
    ds_read_b64 v[96:97], v96
    ds_read_b64 v[98:99], v98
    v_lshlrev_b32_sdwa v100, 3, v119 dst_sel:DWORD dst_unused:UNUSED_PAD src0_sel:DWORD src1_sel:WORD_0
    v_lshlrev_b32_sdwa v102, 3, v119 dst_sel:DWORD dst_unused:UNUSED_PAD src0_sel:DWORD src1_sel:WORD_1
    ds_read_b64 v[100:101], v100
    ds_read_b64 v[102:103], v102
    buffer_load_dwordx4 v[116:119], v69, s[12:15], s41 offen offset:0 sc1
    s_waitcnt lgkmcnt(8)
    v_smfmac_f32_16x16x64_bf16 v[20:23], v[64:67], v[104:111], v68
    v_rcp_f32 v153, v153
    v_pk_mul_f32 v[160:161], v[14:15], v[14:15]
    v_pk_mul_f32 v[164:165], v[16:17], v[16:17]
    v_rcp_f32 v154, v154
    v_pk_mul_f32 v[156:157], v[8:9], v[152:153]
    v_pk_fma_f32 v[160:161], v[160:161], v[128:129], v[130:131]
    v_rcp_f32 v155, v155
    v_pk_mul_f32 v[160:161], v[160:161], v[14:15]
    s_waitcnt vmcnt(4)
    v_lshlrev_b32_sdwa v104, 3, v120 dst_sel:DWORD dst_unused:UNUSED_PAD src0_sel:DWORD src1_sel:WORD_0
    v_lshlrev_b32_sdwa v106, 3, v120 dst_sel:DWORD dst_unused:UNUSED_PAD src0_sel:DWORD src1_sel:WORD_1
    ds_read_b64 v[104:105], v104
    ds_read_b64 v[106:107], v106
    v_lshlrev_b32_sdwa v108, 3, v121 dst_sel:DWORD dst_unused:UNUSED_PAD src0_sel:DWORD src1_sel:WORD_0
    v_lshlrev_b32_sdwa v110, 3, v121 dst_sel:DWORD dst_unused:UNUSED_PAD src0_sel:DWORD src1_sel:WORD_1
    ds_read_b64 v[108:109], v108
    ds_read_b64 v[110:111], v110
    s_waitcnt lgkmcnt(8)
    v_smfmac_f32_16x16x64_bf16 v[24:27], v[64:67], v[88:95], v68
    v_exp_f32 v158, v158
    v_pk_fma_f32 v[156:157], v[10:11], v[154:155], v[156:157]
    v_pk_fma_f32 v[164:165], v[164:165], v[128:129], v[130:131]
    v_exp_f32 v159, v159
    v_add_f32 v156, v156, v157
    v_pk_mul_f32 v[164:165], v[164:165], v[16:17]
    v_exp_f32 v160, v160
    buffer_store_dword v156, v70, s[12:15], s35 offen offset:512 sc1
    v_lshlrev_b32_sdwa v88, 3, v122 dst_sel:DWORD dst_unused:UNUSED_PAD src0_sel:DWORD src1_sel:WORD_0
    v_lshlrev_b32_sdwa v90, 3, v122 dst_sel:DWORD dst_unused:UNUSED_PAD src0_sel:DWORD src1_sel:WORD_1
    ds_read_b64 v[88:89], v88
    ds_read_b64 v[90:91], v90
    v_lshlrev_b32_sdwa v92, 3, v123 dst_sel:DWORD dst_unused:UNUSED_PAD src0_sel:DWORD src1_sel:WORD_0
    v_lshlrev_b32_sdwa v94, 3, v123 dst_sel:DWORD dst_unused:UNUSED_PAD src0_sel:DWORD src1_sel:WORD_1
    ds_read_b64 v[92:93], v92
    ds_read_b64 v[94:95], v94
    buffer_load_dwordx4 v[120:123], v69, s[12:15], s45 offen offset:0 sc1
    s_waitcnt lgkmcnt(8)
    v_smfmac_f32_16x16x64_bf16 v[28:31], v[64:67], v[96:103], v68
    v_exp_f32 v161, v161
    v_pk_fma_f32 v[158:159], v[158:159], v[134:135], v[134:135]
    v_pk_mul_f32 v[166:167], v[18:19], v[18:19]
    v_rcp_f32 v158, v158
    v_pk_fma_f32 v[160:161], v[160:161], v[136:137], v[136:137]
    v_pk_fma_f32 v[166:167], v[166:167], v[128:129], v[130:131]
    v_rcp_f32 v159, v159
    v_pk_mul_f32 v[166:167], v[166:167], v[18:19]
    s_waitcnt vmcnt(4)
    v_lshlrev_b32_sdwa v96, 3, v124 dst_sel:DWORD dst_unused:UNUSED_PAD src0_sel:DWORD src1_sel:WORD_0
    v_lshlrev_b32_sdwa v98, 3, v124 dst_sel:DWORD dst_unused:UNUSED_PAD src0_sel:DWORD src1_sel:WORD_1
    ds_read_b64 v[96:97], v96
    ds_read_b64 v[98:99], v98
    v_lshlrev_b32_sdwa v100, 3, v125 dst_sel:DWORD dst_unused:UNUSED_PAD src0_sel:DWORD src1_sel:WORD_0
    v_lshlrev_b32_sdwa v102, 3, v125 dst_sel:DWORD dst_unused:UNUSED_PAD src0_sel:DWORD src1_sel:WORD_1
    ds_read_b64 v[100:101], v100
    ds_read_b64 v[102:103], v102
    s_waitcnt lgkmcnt(8)
    v_smfmac_f32_16x16x64_bf16 v[24:27], v[64:67], v[104:111], v68
    v_rcp_f32 v160, v160
    v_pk_mul_f32 v[162:163], v[12:13], v[158:159]
    v_pk_mul_f32 v[170:171], v[20:21], v[20:21]
    v_rcp_f32 v161, v161
    v_pk_fma_f32 v[170:171], v[170:171], v[128:129], v[130:131]
    v_pk_mul_f32 v[172:173], v[22:23], v[22:23]
    v_exp_f32 v164, v164
    v_pk_fma_f32 v[162:163], v[14:15], v[160:161], v[162:163]
    v_lshlrev_b32_sdwa v104, 3, v126 dst_sel:DWORD dst_unused:UNUSED_PAD src0_sel:DWORD src1_sel:WORD_0
    v_lshlrev_b32_sdwa v106, 3, v126 dst_sel:DWORD dst_unused:UNUSED_PAD src0_sel:DWORD src1_sel:WORD_1
    ds_read_b64 v[104:105], v104
    ds_read_b64 v[106:107], v106
    v_lshlrev_b32_sdwa v108, 3, v127 dst_sel:DWORD dst_unused:UNUSED_PAD src0_sel:DWORD src1_sel:WORD_0
    v_lshlrev_b32_sdwa v110, 3, v127 dst_sel:DWORD dst_unused:UNUSED_PAD src0_sel:DWORD src1_sel:WORD_1
    ds_read_b64 v[108:109], v108
    ds_read_b64 v[110:111], v110
    buffer_load_dwordx4 v[124:127], v69, s[12:15], s20 offen offset:1024 sc1
    s_waitcnt lgkmcnt(8)
    v_smfmac_f32_16x16x64_bf16 v[28:31], v[64:67], v[88:95], v68
    s_setprio 2
    v_exp_f32 v165, v165
    v_add_f32 v162, v162, v163
    v_pk_mul_f32 v[170:171], v[170:171], v[20:21]
    v_exp_f32 v166, v166
    buffer_store_dword v162, v70, s[12:15], s35 offen offset:640 sc1
    v_pk_fma_f32 v[164:165], v[164:165], v[134:135], v[134:135]
    v_exp_f32 v167, v167
    v_pk_fma_f32 v[172:173], v[172:173], v[128:129], v[130:131]
    s_waitcnt vmcnt(4)
    v_lshlrev_b32_sdwa v88, 3, v116 dst_sel:DWORD dst_unused:UNUSED_PAD src0_sel:DWORD src1_sel:WORD_0
    v_lshlrev_b32_sdwa v90, 3, v116 dst_sel:DWORD dst_unused:UNUSED_PAD src0_sel:DWORD src1_sel:WORD_1
    ds_read_b64 v[88:89], v88
    ds_read_b64 v[90:91], v90
    v_lshlrev_b32_sdwa v92, 3, v117 dst_sel:DWORD dst_unused:UNUSED_PAD src0_sel:DWORD src1_sel:WORD_0
    v_lshlrev_b32_sdwa v94, 3, v117 dst_sel:DWORD dst_unused:UNUSED_PAD src0_sel:DWORD src1_sel:WORD_1
    ds_read_b64 v[92:93], v92
    ds_read_b64 v[94:95], v94
    s_waitcnt lgkmcnt(8)
    v_smfmac_f32_16x16x64_bf16 v[32:35], v[64:67], v[96:103], v68
    v_rcp_f32 v164, v164
    v_pk_fma_f32 v[166:167], v[166:167], v[136:137], v[136:137]
    v_pk_mul_f32 v[172:173], v[172:173], v[22:23]
    v_rcp_f32 v165, v165
    v_pk_mul_f32 v[140:141], v[24:25], v[24:25]
    v_pk_mul_f32 v[142:143], v[26:27], v[26:27]
    v_rcp_f32 v166, v166
    v_pk_mul_f32 v[168:169], v[16:17], v[164:165]
    v_lshlrev_b32_sdwa v96, 3, v118 dst_sel:DWORD dst_unused:UNUSED_PAD src0_sel:DWORD src1_sel:WORD_0
    v_lshlrev_b32_sdwa v98, 3, v118 dst_sel:DWORD dst_unused:UNUSED_PAD src0_sel:DWORD src1_sel:WORD_1
    ds_read_b64 v[96:97], v96
    ds_read_b64 v[98:99], v98
    v_lshlrev_b32_sdwa v100, 3, v119 dst_sel:DWORD dst_unused:UNUSED_PAD src0_sel:DWORD src1_sel:WORD_0
    v_lshlrev_b32_sdwa v102, 3, v119 dst_sel:DWORD dst_unused:UNUSED_PAD src0_sel:DWORD src1_sel:WORD_1
    ds_read_b64 v[100:101], v100
    ds_read_b64 v[102:103], v102
    buffer_load_dwordx4 v[116:119], v69, s[12:15], s41 offen offset:1024 sc1
    s_waitcnt lgkmcnt(8)
    v_smfmac_f32_16x16x64_bf16 v[36:39], v[64:67], v[104:111], v68
    v_rcp_f32 v167, v167
    v_pk_fma_f32 v[140:141], v[140:141], v[128:129], v[130:131]
    v_pk_fma_f32 v[142:143], v[142:143], v[128:129], v[130:131]
    v_exp_f32 v170, v170
    v_pk_fma_f32 v[168:169], v[18:19], v[166:167], v[168:169]
    v_pk_mul_f32 v[140:141], v[140:141], v[24:25]
    v_exp_f32 v171, v171
    v_add_f32 v168, v168, v169
    s_waitcnt vmcnt(3)
    v_lshlrev_b32_sdwa v104, 3, v120 dst_sel:DWORD dst_unused:UNUSED_PAD src0_sel:DWORD src1_sel:WORD_0
    v_lshlrev_b32_sdwa v106, 3, v120 dst_sel:DWORD dst_unused:UNUSED_PAD src0_sel:DWORD src1_sel:WORD_1
    ds_read_b64 v[104:105], v104
    ds_read_b64 v[106:107], v106
    v_lshlrev_b32_sdwa v108, 3, v121 dst_sel:DWORD dst_unused:UNUSED_PAD src0_sel:DWORD src1_sel:WORD_0
    v_lshlrev_b32_sdwa v110, 3, v121 dst_sel:DWORD dst_unused:UNUSED_PAD src0_sel:DWORD src1_sel:WORD_1
    ds_read_b64 v[108:109], v108
    ds_read_b64 v[110:111], v110
    s_waitcnt lgkmcnt(8)
    v_smfmac_f32_16x16x64_bf16 v[32:35], v[64:67], v[88:95], v68
    v_exp_f32 v172, v172
    buffer_store_dword v168, v70, s[12:15], s35 offen offset:1024 sc1
    v_pk_fma_f32 v[170:171], v[170:171], v[134:135], v[134:135]
    v_exp_f32 v173, v173
    v_pk_mul_f32 v[142:143], v[142:143], v[26:27]
    v_pk_mul_f32 v[146:147], v[28:29], v[28:29]
    v_rcp_f32 v170, v170
    v_pk_fma_f32 v[172:173], v[172:173], v[136:137], v[136:137]
    v_lshlrev_b32_sdwa v88, 3, v122 dst_sel:DWORD dst_unused:UNUSED_PAD src0_sel:DWORD src1_sel:WORD_0
    v_lshlrev_b32_sdwa v90, 3, v122 dst_sel:DWORD dst_unused:UNUSED_PAD src0_sel:DWORD src1_sel:WORD_1
    ds_read_b64 v[88:89], v88
    ds_read_b64 v[90:91], v90
    v_lshlrev_b32_sdwa v92, 3, v123 dst_sel:DWORD dst_unused:UNUSED_PAD src0_sel:DWORD src1_sel:WORD_0
    v_lshlrev_b32_sdwa v94, 3, v123 dst_sel:DWORD dst_unused:UNUSED_PAD src0_sel:DWORD src1_sel:WORD_1
    ds_read_b64 v[92:93], v92
    ds_read_b64 v[94:95], v94
    buffer_load_dwordx4 v[120:123], v69, s[12:15], s45 offen offset:1024 sc1
    s_waitcnt lgkmcnt(8)
    v_smfmac_f32_16x16x64_bf16 v[36:39], v[64:67], v[96:103], v68
    v_rcp_f32 v171, v171
    v_pk_fma_f32 v[146:147], v[146:147], v[128:129], v[130:131]
    v_pk_mul_f32 v[148:149], v[30:31], v[30:31]
    v_rcp_f32 v172, v172
    v_pk_mul_f32 v[174:175], v[20:21], v[170:171]
    v_pk_mul_f32 v[146:147], v[146:147], v[28:29]
    v_rcp_f32 v173, v173
    v_pk_fma_f32 v[148:149], v[148:149], v[128:129], v[130:131]
    s_waitcnt vmcnt(4)
    v_lshlrev_b32_sdwa v96, 3, v124 dst_sel:DWORD dst_unused:UNUSED_PAD src0_sel:DWORD src1_sel:WORD_0
    v_lshlrev_b32_sdwa v98, 3, v124 dst_sel:DWORD dst_unused:UNUSED_PAD src0_sel:DWORD src1_sel:WORD_1
    ds_read_b64 v[96:97], v96
    ds_read_b64 v[98:99], v98
    v_lshlrev_b32_sdwa v100, 3, v125 dst_sel:DWORD dst_unused:UNUSED_PAD src0_sel:DWORD src1_sel:WORD_0
    v_lshlrev_b32_sdwa v102, 3, v125 dst_sel:DWORD dst_unused:UNUSED_PAD src0_sel:DWORD src1_sel:WORD_1
    ds_read_b64 v[100:101], v100
    ds_read_b64 v[102:103], v102
    s_waitcnt lgkmcnt(8)
    v_smfmac_f32_16x16x64_bf16 v[32:35], v[64:67], v[104:111], v68
    v_exp_f32 v140, v140
    v_pk_fma_f32 v[174:175], v[22:23], v[172:173], v[174:175]
    v_pk_mul_f32 v[148:149], v[148:149], v[30:31]
    v_exp_f32 v141, v141
    v_add_f32 v174, v174, v175
    v_exp_f32 v142, v142
    buffer_store_dword v174, v70, s[12:15], s35 offen offset:1152 sc1
    v_pk_fma_f32 v[140:141], v[140:141], v[134:135], v[134:135]
    v_lshlrev_b32_sdwa v104, 3, v126 dst_sel:DWORD dst_unused:UNUSED_PAD src0_sel:DWORD src1_sel:WORD_0
    v_lshlrev_b32_sdwa v106, 3, v126 dst_sel:DWORD dst_unused:UNUSED_PAD src0_sel:DWORD src1_sel:WORD_1
    ds_read_b64 v[104:105], v104
    ds_read_b64 v[106:107], v106
    v_lshlrev_b32_sdwa v108, 3, v127 dst_sel:DWORD dst_unused:UNUSED_PAD src0_sel:DWORD src1_sel:WORD_0
    v_lshlrev_b32_sdwa v110, 3, v127 dst_sel:DWORD dst_unused:UNUSED_PAD src0_sel:DWORD src1_sel:WORD_1
    ds_read_b64 v[108:109], v108
    ds_read_b64 v[110:111], v110
    buffer_load_dwordx4 v[124:127], v69, s[12:15], s20 offen offset:2048 sc1
    s_waitcnt lgkmcnt(8)
    v_smfmac_f32_16x16x64_bf16 v[36:39], v[64:67], v[88:95], v68
    v_rcp_f32 v140, v140
    v_pk_mul_f32 v[152:153], v[32:33], v[32:33]
    v_pk_mul_f32 v[154:155], v[34:35], v[34:35]
    v_rcp_f32 v141, v141
    v_pk_fma_f32 v[152:153], v[152:153], v[128:129], v[130:131]
    v_pk_fma_f32 v[154:155], v[154:155], v[128:129], v[130:131]
    v_exp_f32 v143, v143
    v_pk_mul_f32 v[144:145], v[24:25], v[140:141]
    s_waitcnt vmcnt(4)
    v_lshlrev_b32_sdwa v88, 3, v116 dst_sel:DWORD dst_unused:UNUSED_PAD src0_sel:DWORD src1_sel:WORD_0
    v_lshlrev_b32_sdwa v90, 3, v116 dst_sel:DWORD dst_unused:UNUSED_PAD src0_sel:DWORD src1_sel:WORD_1
    ds_read_b64 v[88:89], v88
    ds_read_b64 v[90:91], v90
    v_lshlrev_b32_sdwa v92, 3, v117 dst_sel:DWORD dst_unused:UNUSED_PAD src0_sel:DWORD src1_sel:WORD_0
    v_lshlrev_b32_sdwa v94, 3, v117 dst_sel:DWORD dst_unused:UNUSED_PAD src0_sel:DWORD src1_sel:WORD_1
    ds_read_b64 v[92:93], v92
    ds_read_b64 v[94:95], v94
    s_waitcnt lgkmcnt(8)
    v_smfmac_f32_16x16x64_bf16 v[40:43], v[64:67], v[96:103], v68
    v_exp_f32 v146, v146
    v_pk_fma_f32 v[142:143], v[142:143], v[136:137], v[136:137]
    v_pk_mul_f32 v[152:153], v[152:153], v[32:33]
    v_rcp_f32 v142, v142
    v_pk_mul_f32 v[154:155], v[154:155], v[34:35]
    v_pk_mul_f32 v[158:159], v[36:37], v[36:37]
    v_rcp_f32 v143, v143
    v_pk_fma_f32 v[158:159], v[158:159], v[128:129], v[130:131]
    v_lshlrev_b32_sdwa v96, 3, v118 dst_sel:DWORD dst_unused:UNUSED_PAD src0_sel:DWORD src1_sel:WORD_0
    v_lshlrev_b32_sdwa v98, 3, v118 dst_sel:DWORD dst_unused:UNUSED_PAD src0_sel:DWORD src1_sel:WORD_1
    ds_read_b64 v[96:97], v96
    ds_read_b64 v[98:99], v98
    v_lshlrev_b32_sdwa v100, 3, v119 dst_sel:DWORD dst_unused:UNUSED_PAD src0_sel:DWORD src1_sel:WORD_0
    v_lshlrev_b32_sdwa v102, 3, v119 dst_sel:DWORD dst_unused:UNUSED_PAD src0_sel:DWORD src1_sel:WORD_1
    ds_read_b64 v[100:101], v100
    ds_read_b64 v[102:103], v102
    buffer_load_dwordx4 v[116:119], v69, s[12:15], s41 offen offset:2048 sc1
    s_waitcnt lgkmcnt(8)
    v_smfmac_f32_16x16x64_bf16 v[44:47], v[64:67], v[104:111], v68
    v_exp_f32 v147, v147
    v_pk_fma_f32 v[144:145], v[26:27], v[142:143], v[144:145]
    v_pk_mul_f32 v[158:159], v[158:159], v[36:37]
    v_exp_f32 v148, v148
    v_add_f32 v144, v144, v145
    v_pk_fma_f32 v[146:147], v[146:147], v[134:135], v[134:135]
    v_exp_f32 v149, v149
    buffer_store_dword v144, v70, s[12:15], s35 offen offset:1536 sc1
    s_waitcnt vmcnt(4)
    v_lshlrev_b32_sdwa v104, 3, v120 dst_sel:DWORD dst_unused:UNUSED_PAD src0_sel:DWORD src1_sel:WORD_0
    v_lshlrev_b32_sdwa v106, 3, v120 dst_sel:DWORD dst_unused:UNUSED_PAD src0_sel:DWORD src1_sel:WORD_1
    ds_read_b64 v[104:105], v104
    ds_read_b64 v[106:107], v106
    v_lshlrev_b32_sdwa v108, 3, v121 dst_sel:DWORD dst_unused:UNUSED_PAD src0_sel:DWORD src1_sel:WORD_0
    v_lshlrev_b32_sdwa v110, 3, v121 dst_sel:DWORD dst_unused:UNUSED_PAD src0_sel:DWORD src1_sel:WORD_1
    ds_read_b64 v[108:109], v108
    ds_read_b64 v[110:111], v110
    s_waitcnt lgkmcnt(8)
    v_smfmac_f32_16x16x64_bf16 v[40:43], v[64:67], v[88:95], v68
    v_rcp_f32 v146, v146
    v_pk_fma_f32 v[148:149], v[148:149], v[136:137], v[136:137]
    v_pk_mul_f32 v[160:161], v[38:39], v[38:39]
    v_rcp_f32 v147, v147
    v_pk_fma_f32 v[160:161], v[160:161], v[128:129], v[130:131]
    v_rcp_f32 v148, v148
    v_pk_mul_f32 v[150:151], v[28:29], v[146:147]
    v_pk_mul_f32 v[160:161], v[160:161], v[38:39]
    v_lshlrev_b32_sdwa v88, 3, v122 dst_sel:DWORD dst_unused:UNUSED_PAD src0_sel:DWORD src1_sel:WORD_0
    v_lshlrev_b32_sdwa v90, 3, v122 dst_sel:DWORD dst_unused:UNUSED_PAD src0_sel:DWORD src1_sel:WORD_1
    ds_read_b64 v[88:89], v88
    ds_read_b64 v[90:91], v90
    v_lshlrev_b32_sdwa v92, 3, v123 dst_sel:DWORD dst_unused:UNUSED_PAD src0_sel:DWORD src1_sel:WORD_0
    v_lshlrev_b32_sdwa v94, 3, v123 dst_sel:DWORD dst_unused:UNUSED_PAD src0_sel:DWORD src1_sel:WORD_1
    ds_read_b64 v[92:93], v92
    ds_read_b64 v[94:95], v94
    buffer_load_dwordx4 v[120:123], v69, s[12:15], s45 offen offset:2048 sc1
    s_waitcnt lgkmcnt(8)
    v_smfmac_f32_16x16x64_bf16 v[44:47], v[64:67], v[96:103], v68
    s_setprio 1
    v_rcp_f32 v149, v149
    v_exp_f32 v152, v152
    v_exp_f32 v153, v153
    v_pk_fma_f32 v[150:151], v[30:31], v[148:149], v[150:151]
    v_exp_f32 v154, v154
    v_add_f32 v150, v150, v151
    v_pk_fma_f32 v[152:153], v[152:153], v[134:135], v[134:135]
    v_exp_f32 v155, v155
    s_waitcnt vmcnt(3)
    v_lshlrev_b32_sdwa v96, 3, v124 dst_sel:DWORD dst_unused:UNUSED_PAD src0_sel:DWORD src1_sel:WORD_0
    v_lshlrev_b32_sdwa v98, 3, v124 dst_sel:DWORD dst_unused:UNUSED_PAD src0_sel:DWORD src1_sel:WORD_1
    ds_read_b64 v[96:97], v96
    ds_read_b64 v[98:99], v98
    v_lshlrev_b32_sdwa v100, 3, v125 dst_sel:DWORD dst_unused:UNUSED_PAD src0_sel:DWORD src1_sel:WORD_0
    v_lshlrev_b32_sdwa v102, 3, v125 dst_sel:DWORD dst_unused:UNUSED_PAD src0_sel:DWORD src1_sel:WORD_1
    ds_read_b64 v[100:101], v100
    ds_read_b64 v[102:103], v102
    s_waitcnt lgkmcnt(8)
    v_smfmac_f32_16x16x64_bf16 v[40:43], v[64:67], v[104:111], v68
    v_rcp_f32 v152, v152
    buffer_store_dword v150, v70, s[12:15], s35 offen offset:1664 sc1
    v_pk_fma_f32 v[154:155], v[154:155], v[136:137], v[136:137]
    v_rcp_f32 v153, v153
    v_rcp_f32 v154, v154
    v_rcp_f32 v155, v155
    v_pk_mul_f32 v[156:157], v[32:33], v[152:153]
    v_exp_f32 v158, v158
    v_lshlrev_b32_sdwa v104, 3, v126 dst_sel:DWORD dst_unused:UNUSED_PAD src0_sel:DWORD src1_sel:WORD_0
    v_lshlrev_b32_sdwa v106, 3, v126 dst_sel:DWORD dst_unused:UNUSED_PAD src0_sel:DWORD src1_sel:WORD_1
    ds_read_b64 v[104:105], v104
    ds_read_b64 v[106:107], v106
    v_lshlrev_b32_sdwa v108, 3, v127 dst_sel:DWORD dst_unused:UNUSED_PAD src0_sel:DWORD src1_sel:WORD_0
    v_lshlrev_b32_sdwa v110, 3, v127 dst_sel:DWORD dst_unused:UNUSED_PAD src0_sel:DWORD src1_sel:WORD_1
    ds_read_b64 v[108:109], v108
    ds_read_b64 v[110:111], v110
    buffer_load_dwordx4 v[124:127], v69, s[12:15], s20 offen offset:3072 sc1
    s_waitcnt lgkmcnt(8)
    v_smfmac_f32_16x16x64_bf16 v[44:47], v[64:67], v[88:95], v68
    v_exp_f32 v159, v159
    v_pk_fma_f32 v[156:157], v[34:35], v[154:155], v[156:157]
    v_pk_mul_f32 v[164:165], v[40:41], v[40:41]
    v_exp_f32 v160, v160
    v_add_f32 v156, v156, v157
    v_pk_fma_f32 v[158:159], v[158:159], v[134:135], v[134:135]
    v_exp_f32 v161, v161
    buffer_store_dword v156, v70, s[12:15], s35 offen offset:2048 sc1
    s_waitcnt vmcnt(5)
    v_lshlrev_b32_sdwa v88, 3, v116 dst_sel:DWORD dst_unused:UNUSED_PAD src0_sel:DWORD src1_sel:WORD_0
    v_lshlrev_b32_sdwa v90, 3, v116 dst_sel:DWORD dst_unused:UNUSED_PAD src0_sel:DWORD src1_sel:WORD_1
    ds_read_b64 v[88:89], v88
    ds_read_b64 v[90:91], v90
    v_lshlrev_b32_sdwa v92, 3, v117 dst_sel:DWORD dst_unused:UNUSED_PAD src0_sel:DWORD src1_sel:WORD_0
    v_lshlrev_b32_sdwa v94, 3, v117 dst_sel:DWORD dst_unused:UNUSED_PAD src0_sel:DWORD src1_sel:WORD_1
    ds_read_b64 v[92:93], v92
    ds_read_b64 v[94:95], v94
    s_waitcnt lgkmcnt(8)
    v_smfmac_f32_16x16x64_bf16 v[48:51], v[64:67], v[96:103], v68
    v_rcp_f32 v158, v158
    v_pk_fma_f32 v[160:161], v[160:161], v[136:137], v[136:137]
    v_pk_fma_f32 v[164:165], v[164:165], v[128:129], v[130:131]
    v_rcp_f32 v159, v159
    v_pk_mul_f32 v[164:165], v[164:165], v[40:41]
    v_pk_mul_f32 v[166:167], v[42:43], v[42:43]
    v_rcp_f32 v160, v160
    v_pk_mul_f32 v[162:163], v[36:37], v[158:159]
    v_lshlrev_b32_sdwa v96, 3, v118 dst_sel:DWORD dst_unused:UNUSED_PAD src0_sel:DWORD src1_sel:WORD_0
    v_lshlrev_b32_sdwa v98, 3, v118 dst_sel:DWORD dst_unused:UNUSED_PAD src0_sel:DWORD src1_sel:WORD_1
    ds_read_b64 v[96:97], v96
    ds_read_b64 v[98:99], v98
    v_lshlrev_b32_sdwa v100, 3, v119 dst_sel:DWORD dst_unused:UNUSED_PAD src0_sel:DWORD src1_sel:WORD_0
    v_lshlrev_b32_sdwa v102, 3, v119 dst_sel:DWORD dst_unused:UNUSED_PAD src0_sel:DWORD src1_sel:WORD_1
    ds_read_b64 v[100:101], v100
    ds_read_b64 v[102:103], v102
    buffer_load_dwordx4 v[116:119], v69, s[12:15], s41 offen offset:3072 sc1
    s_waitcnt lgkmcnt(8)
    v_smfmac_f32_16x16x64_bf16 v[52:55], v[64:67], v[104:111], v68
    v_rcp_f32 v161, v161
    v_pk_fma_f32 v[166:167], v[166:167], v[128:129], v[130:131]
    v_pk_mul_f32 v[170:171], v[44:45], v[44:45]
    v_exp_f32 v164, v164
    v_pk_fma_f32 v[162:163], v[38:39], v[160:161], v[162:163]
    v_pk_mul_f32 v[166:167], v[166:167], v[42:43]
    v_exp_f32 v165, v165
    v_add_f32 v162, v162, v163
    s_waitcnt vmcnt(4)
    v_lshlrev_b32_sdwa v104, 3, v120 dst_sel:DWORD dst_unused:UNUSED_PAD src0_sel:DWORD src1_sel:WORD_0
    v_lshlrev_b32_sdwa v106, 3, v120 dst_sel:DWORD dst_unused:UNUSED_PAD src0_sel:DWORD src1_sel:WORD_1
    ds_read_b64 v[104:105], v104
    ds_read_b64 v[106:107], v106
    v_lshlrev_b32_sdwa v108, 3, v121 dst_sel:DWORD dst_unused:UNUSED_PAD src0_sel:DWORD src1_sel:WORD_0
    v_lshlrev_b32_sdwa v110, 3, v121 dst_sel:DWORD dst_unused:UNUSED_PAD src0_sel:DWORD src1_sel:WORD_1
    ds_read_b64 v[108:109], v108
    ds_read_b64 v[110:111], v110
    s_waitcnt lgkmcnt(8)
    v_smfmac_f32_16x16x64_bf16 v[48:51], v[64:67], v[88:95], v68
    v_exp_f32 v166, v166
    buffer_store_dword v162, v70, s[12:15], s35 offen offset:2176 sc1
    v_pk_fma_f32 v[164:165], v[164:165], v[134:135], v[134:135]
    v_exp_f32 v167, v167
    v_pk_fma_f32 v[170:171], v[170:171], v[128:129], v[130:131]
    v_pk_mul_f32 v[172:173], v[46:47], v[46:47]
    v_rcp_f32 v164, v164
    v_pk_fma_f32 v[166:167], v[166:167], v[136:137], v[136:137]
    v_lshlrev_b32_sdwa v88, 3, v122 dst_sel:DWORD dst_unused:UNUSED_PAD src0_sel:DWORD src1_sel:WORD_0
    v_lshlrev_b32_sdwa v90, 3, v122 dst_sel:DWORD dst_unused:UNUSED_PAD src0_sel:DWORD src1_sel:WORD_1
    ds_read_b64 v[88:89], v88
    ds_read_b64 v[90:91], v90
    v_lshlrev_b32_sdwa v92, 3, v123 dst_sel:DWORD dst_unused:UNUSED_PAD src0_sel:DWORD src1_sel:WORD_0
    v_lshlrev_b32_sdwa v94, 3, v123 dst_sel:DWORD dst_unused:UNUSED_PAD src0_sel:DWORD src1_sel:WORD_1
    ds_read_b64 v[92:93], v92
    ds_read_b64 v[94:95], v94
    buffer_load_dwordx4 v[120:123], v69, s[12:15], s45 offen offset:3072 sc1
    s_waitcnt lgkmcnt(8)
    v_smfmac_f32_16x16x64_bf16 v[52:55], v[64:67], v[96:103], v68
    v_rcp_f32 v165, v165
    v_pk_mul_f32 v[170:171], v[170:171], v[44:45]
    v_pk_fma_f32 v[172:173], v[172:173], v[128:129], v[130:131]
    v_rcp_f32 v166, v166
    v_pk_mul_f32 v[168:169], v[40:41], v[164:165]
    v_pk_mul_f32 v[172:173], v[172:173], v[46:47]
    v_rcp_f32 v167, v167
    v_exp_f32 v170, v170
    s_waitcnt vmcnt(4)
    v_lshlrev_b32_sdwa v96, 3, v124 dst_sel:DWORD dst_unused:UNUSED_PAD src0_sel:DWORD src1_sel:WORD_0
    v_lshlrev_b32_sdwa v98, 3, v124 dst_sel:DWORD dst_unused:UNUSED_PAD src0_sel:DWORD src1_sel:WORD_1
    ds_read_b64 v[96:97], v96
    ds_read_b64 v[98:99], v98
    v_lshlrev_b32_sdwa v100, 3, v125 dst_sel:DWORD dst_unused:UNUSED_PAD src0_sel:DWORD src1_sel:WORD_0
    v_lshlrev_b32_sdwa v102, 3, v125 dst_sel:DWORD dst_unused:UNUSED_PAD src0_sel:DWORD src1_sel:WORD_1
    ds_read_b64 v[100:101], v100
    ds_read_b64 v[102:103], v102
    s_waitcnt lgkmcnt(8)
    v_smfmac_f32_16x16x64_bf16 v[48:51], v[64:67], v[104:111], v68
    v_exp_f32 v171, v171
    v_pk_fma_f32 v[168:169], v[42:43], v[166:167], v[168:169]
    v_exp_f32 v172, v172
    v_add_f32 v168, v168, v169
    v_pk_fma_f32 v[170:171], v[170:171], v[134:135], v[134:135]
    v_exp_f32 v173, v173
    buffer_store_dword v168, v70, s[12:15], s35 offen offset:2560 sc1
    v_rcp_f32 v170, v170
    v_lshlrev_b32_sdwa v104, 3, v126 dst_sel:DWORD dst_unused:UNUSED_PAD src0_sel:DWORD src1_sel:WORD_0
    v_lshlrev_b32_sdwa v106, 3, v126 dst_sel:DWORD dst_unused:UNUSED_PAD src0_sel:DWORD src1_sel:WORD_1
    ds_read_b64 v[104:105], v104
    ds_read_b64 v[106:107], v106
    v_lshlrev_b32_sdwa v108, 3, v127 dst_sel:DWORD dst_unused:UNUSED_PAD src0_sel:DWORD src1_sel:WORD_0
    v_lshlrev_b32_sdwa v110, 3, v127 dst_sel:DWORD dst_unused:UNUSED_PAD src0_sel:DWORD src1_sel:WORD_1
    ds_read_b64 v[108:109], v108
    ds_read_b64 v[110:111], v110
    s_waitcnt lgkmcnt(8)
    v_smfmac_f32_16x16x64_bf16 v[52:55], v[64:67], v[88:95], v68
    s_setprio 0
    v_rcp_f32 v171, v171
    v_pk_fma_f32 v[172:173], v[172:173], v[136:137], v[136:137]
    v_pk_mul_f32 v[140:141], v[48:49], v[48:49]
    v_rcp_f32 v172, v172
    v_pk_mul_f32 v[174:175], v[44:45], v[170:171]
    v_pk_fma_f32 v[140:141], v[140:141], v[128:129], v[130:131]
    v_rcp_f32 v173, v173
    v_pk_mul_f32 v[140:141], v[140:141], v[48:49]
    s_waitcnt vmcnt(3)
    v_lshlrev_b32_sdwa v88, 3, v116 dst_sel:DWORD dst_unused:UNUSED_PAD src0_sel:DWORD src1_sel:WORD_0
    v_lshlrev_b32_sdwa v90, 3, v116 dst_sel:DWORD dst_unused:UNUSED_PAD src0_sel:DWORD src1_sel:WORD_1
    ds_read_b64 v[88:89], v88
    ds_read_b64 v[90:91], v90
    v_lshlrev_b32_sdwa v92, 3, v117 dst_sel:DWORD dst_unused:UNUSED_PAD src0_sel:DWORD src1_sel:WORD_0
    v_lshlrev_b32_sdwa v94, 3, v117 dst_sel:DWORD dst_unused:UNUSED_PAD src0_sel:DWORD src1_sel:WORD_1
    ds_read_b64 v[92:93], v92
    ds_read_b64 v[94:95], v94
    s_waitcnt lgkmcnt(8)
    v_smfmac_f32_16x16x64_bf16 v[56:59], v[64:67], v[96:103], v68
    v_exp_f32 v140, v140
    v_pk_fma_f32 v[174:175], v[46:47], v[172:173], v[174:175]
    v_pk_mul_f32 v[142:143], v[50:51], v[50:51]
    v_exp_f32 v141, v141
    v_add_f32 v174, v174, v175
    v_pk_fma_f32 v[142:143], v[142:143], v[128:129], v[130:131]
    buffer_store_dword v174, v70, s[12:15], s35 offen offset:2688 sc1
    v_pk_fma_f32 v[140:141], v[140:141], v[134:135], v[134:135]
    v_lshlrev_b32_sdwa v96, 3, v118 dst_sel:DWORD dst_unused:UNUSED_PAD src0_sel:DWORD src1_sel:WORD_0
    v_lshlrev_b32_sdwa v98, 3, v118 dst_sel:DWORD dst_unused:UNUSED_PAD src0_sel:DWORD src1_sel:WORD_1
    ds_read_b64 v[96:97], v96
    ds_read_b64 v[98:99], v98
    v_lshlrev_b32_sdwa v100, 3, v119 dst_sel:DWORD dst_unused:UNUSED_PAD src0_sel:DWORD src1_sel:WORD_0
    v_lshlrev_b32_sdwa v102, 3, v119 dst_sel:DWORD dst_unused:UNUSED_PAD src0_sel:DWORD src1_sel:WORD_1
    ds_read_b64 v[100:101], v100
    ds_read_b64 v[102:103], v102
    s_waitcnt lgkmcnt(8)
    v_smfmac_f32_16x16x64_bf16 v[60:63], v[64:67], v[104:111], v68
    v_rcp_f32 v140, v140
    v_pk_mul_f32 v[142:143], v[142:143], v[50:51]
    v_pk_mul_f32 v[146:147], v[52:53], v[52:53]
    v_rcp_f32 v141, v141
    v_pk_fma_f32 v[146:147], v[146:147], v[128:129], v[130:131]
    v_pk_mul_f32 v[148:149], v[54:55], v[54:55]
    v_exp_f32 v142, v142
    v_pk_mul_f32 v[144:145], v[48:49], v[140:141]
    s_waitcnt vmcnt(2)
    v_lshlrev_b32_sdwa v104, 3, v120 dst_sel:DWORD dst_unused:UNUSED_PAD src0_sel:DWORD src1_sel:WORD_0
    v_lshlrev_b32_sdwa v106, 3, v120 dst_sel:DWORD dst_unused:UNUSED_PAD src0_sel:DWORD src1_sel:WORD_1
    ds_read_b64 v[104:105], v104
    ds_read_b64 v[106:107], v106
    v_lshlrev_b32_sdwa v108, 3, v121 dst_sel:DWORD dst_unused:UNUSED_PAD src0_sel:DWORD src1_sel:WORD_0
    v_lshlrev_b32_sdwa v110, 3, v121 dst_sel:DWORD dst_unused:UNUSED_PAD src0_sel:DWORD src1_sel:WORD_1
    ds_read_b64 v[108:109], v108
    ds_read_b64 v[110:111], v110
    s_waitcnt lgkmcnt(8)
    v_smfmac_f32_16x16x64_bf16 v[56:59], v[64:67], v[88:95], v68
    v_exp_f32 v143, v143
    v_pk_mul_f32 v[146:147], v[146:147], v[52:53]
    v_pk_fma_f32 v[148:149], v[148:149], v[128:129], v[130:131]
    v_exp_f32 v146, v146
    v_pk_fma_f32 v[142:143], v[142:143], v[136:137], v[136:137]
    v_pk_mul_f32 v[148:149], v[148:149], v[54:55]
    v_rcp_f32 v142, v142
    v_rcp_f32 v143, v143
    v_lshlrev_b32_sdwa v88, 3, v122 dst_sel:DWORD dst_unused:UNUSED_PAD src0_sel:DWORD src1_sel:WORD_0
    v_lshlrev_b32_sdwa v90, 3, v122 dst_sel:DWORD dst_unused:UNUSED_PAD src0_sel:DWORD src1_sel:WORD_1
    ds_read_b64 v[88:89], v88
    ds_read_b64 v[90:91], v90
    v_lshlrev_b32_sdwa v92, 3, v123 dst_sel:DWORD dst_unused:UNUSED_PAD src0_sel:DWORD src1_sel:WORD_0
    v_lshlrev_b32_sdwa v94, 3, v123 dst_sel:DWORD dst_unused:UNUSED_PAD src0_sel:DWORD src1_sel:WORD_1
    ds_read_b64 v[92:93], v92
    ds_read_b64 v[94:95], v94
    s_waitcnt lgkmcnt(8)
    v_smfmac_f32_16x16x64_bf16 v[60:63], v[64:67], v[96:103], v68
    v_exp_f32 v147, v147
    v_pk_fma_f32 v[144:145], v[50:51], v[142:143], v[144:145]
    v_exp_f32 v148, v148
    v_add_f32 v144, v144, v145
    v_pk_fma_f32 v[146:147], v[146:147], v[134:135], v[134:135]
    v_exp_f32 v149, v149
    buffer_store_dword v144, v70, s[12:15], s35 offen offset:3072 sc1
    v_rcp_f32 v146, v146
    s_waitcnt lgkmcnt(4)
    v_smfmac_f32_16x16x64_bf16 v[56:59], v[64:67], v[104:111], v68
    s_setprio 3
    v_rcp_f32 v147, v147
    v_pk_fma_f32 v[148:149], v[148:149], v[136:137], v[136:137]
    s_waitcnt lgkmcnt(0)
    v_smfmac_f32_16x16x64_bf16 v[60:63], v[64:67], v[88:95], v68
    v_rcp_f32 v148, v148
    v_pk_mul_f32 v[150:151], v[52:53], v[146:147]
    v_rcp_f32 v149, v149
    s_nop 0
    s_nop 0
    v_pk_fma_f32 v[150:151], v[54:55], v[148:149], v[150:151]
    s_nop 0
    v_add_f32 v150, v150, v151
    v_pk_mul_f32 v[152:153], v[56:57], v[56:57]
    buffer_store_dword v150, v70, s[12:15], s35 offen offset:3200 sc1
    v_pk_fma_f32 v[152:153], v[152:153], v[128:129], v[130:131]
    v_pk_mul_f32 v[154:155], v[58:59], v[58:59]
    v_pk_mul_f32 v[152:153], v[152:153], v[56:57]
    v_pk_fma_f32 v[154:155], v[154:155], v[128:129], v[130:131]
    v_exp_f32 v152, v152
    v_pk_mul_f32 v[154:155], v[154:155], v[58:59]
    v_pk_mul_f32 v[158:159], v[60:61], v[60:61]
    v_exp_f32 v153, v153
    v_pk_fma_f32 v[158:159], v[158:159], v[128:129], v[130:131]
    v_pk_mul_f32 v[160:161], v[62:63], v[62:63]
    v_exp_f32 v154, v154
    v_pk_fma_f32 v[152:153], v[152:153], v[134:135], v[134:135]
    v_pk_mul_f32 v[158:159], v[158:159], v[60:61]
    v_rcp_f32 v152, v152
    v_pk_fma_f32 v[160:161], v[160:161], v[128:129], v[130:131]
    v_rcp_f32 v153, v153
    v_pk_mul_f32 v[160:161], v[160:161], v[62:63]
    v_exp_f32 v155, v155
    v_pk_mul_f32 v[156:157], v[56:57], v[152:153]
    v_exp_f32 v158, v158
    v_pk_fma_f32 v[154:155], v[154:155], v[136:137], v[136:137]
    v_exp_f32 v159, v159
    v_rcp_f32 v154, v154
    v_rcp_f32 v155, v155
    v_pk_fma_f32 v[158:159], v[158:159], v[134:135], v[134:135]
    v_exp_f32 v160, v160
    v_pk_fma_f32 v[156:157], v[58:59], v[154:155], v[156:157]
    v_rcp_f32 v158, v158
    v_add_f32 v156, v156, v157
    v_rcp_f32 v159, v159
    buffer_store_dword v156, v70, s[12:15], s35 offen offset:3584 sc1
    v_exp_f32 v161, v161
    v_pk_mul_f32 v[162:163], v[60:61], v[158:159]
    s_nop 0
    v_pk_fma_f32 v[160:161], v[160:161], v[136:137], v[136:137]
    s_nop 0
    v_rcp_f32 v160, v160
    v_rcp_f32 v161, v161
    s_nop 0
    s_nop 0
    v_pk_fma_f32 v[162:163], v[62:63], v[160:161], v[162:163]
    s_nop 0
    v_add_f32 v162, v162, v163
    s_nop 0
    buffer_store_dword v162, v70, s[12:15], s35 offen offset:3712 sc1
standalone__deep_cross_pnn__recsys_kernel_red:

    v_and_b32 v193, 0xf0, v69
    v_lshrrev_b32 v197, 8, v69
    v_lshl_or_b32 v192, v197, 16, v193
    v_lshrrev_b32 v198, 1, v197
    v_and_b32 v197, 1, v197
    v_lshl_or_b32 v193, v198, 2, v193
    v_lshl_or_b32 v193, v197, 3, v193
    v_mov_b32 v196, 0
    s_mov_b32 s65, 0

    s_lshl_b32 s68, s2, 8
    s_add_u32 s66, s68, 29360128
    s_add_u32 s67, s66, 65536
    s_add_u32 s60, s68, 20971520
    s_lshr_b32 s68, s68, 1

    s_lshl_b32 s61, s3, 20
    s_add_u32 s60, s60, s61

    s_add_u32 s61, s60, 262144
    s_add_u32 s62, s60, 524288
    s_add_u32 s63, s60, 786432

    s_mov_b32 s76, s56
    s_and_b32 s77, s57, 0xffff
    s_mov_b32 s78, 2
    s_mov_b32 s79, 0x00020000
    s_mov_b32 s72, s58
    s_and_b32 s73, s59, 0xffff
    s_mov_b32 s74, 32768
    s_mov_b32 s75, 0x00020000
    s_mov_b64 s[20:21], -1
    s_mov_b64 s[22:23], -1
    s_mov_b64 s[24:25], -1
    s_mov_b64 s[26:27], -1
    s_mov_b64 s[28:29], -1

    v_mov_b32 v216, -1
    buffer_load_short_d16_hi v196, v196, s[76:79], 0 offen
    s_bitcmp1_b32 s64, 30
    s_cbranch_scc0 standalone__deep_cross_pnn__recsys_kernel_rd

standalone__deep_cross_pnn__recsys_kernel_rp:
    s_mov_b64 exec, s[20:21]
    buffer_load_dwordx4 v[176:179], v192, s[12:15], s60 offen sc1
    s_mov_b64 exec, s[22:23]
    buffer_load_dwordx4 v[180:183], v192, s[12:15], s61 offen sc1
    s_mov_b64 exec, s[24:25]
    buffer_load_dwordx4 v[184:187], v192, s[12:15], s62 offen sc1
    s_mov_b64 exec, s[26:27]
    buffer_load_dwordx4 v[188:191], v192, s[12:15], s63 offen sc1
    s_mov_b64 exec, s[28:29]
    buffer_load_dword v194, v193, s[12:15], s66 offen sc1
    buffer_load_dword v195, v193, s[12:15], s67 offen sc1
    s_mov_b64 exec, -1
    s_waitcnt vmcnt(4)
    v_add_f32 v216, v176, v180
    v_add_f32 v217, v177, v181
    v_add_f32 v218, v178, v182
    v_add_f32 v219, v179, v183
    s_waitcnt vmcnt(2)
    v_add_f32 v220, v184, v188
    v_add_f32 v221, v185, v189
    v_add_f32 v222, v186, v190
    v_add_f32 v223, v187, v191
    v_add_f32 v216, v216, v220
    v_add_f32 v217, v217, v221
    v_add_f32 v218, v218, v222
    v_add_f32 v219, v219, v223

    s_nop 0
    v_permlane32_swap_b32 v216, v217
    v_permlane32_swap_b32 v218, v219
    v_add_f32 v216, v216, v217
    v_add_f32 v218, v218, v219
    s_nop 1
    v_permlane16_swap_b32 v216, v218
    s_nop 0
    v_add_f32 v216, v216, v218

    s_waitcnt vmcnt(0)
    v_add_f32 v201, v194, v195
    s_add_u32 s65, s65, 1
    v_add_f32 v197, v201, v216
    v_cmp_u_f32 vcc, v197, v197
    s_cbranch_vccz standalone__deep_cross_pnn__recsys_kernel_rd

    v_cmp_u_f32 s[20:21], v176, v177
    v_cmp_u_f32 vcc, v178, v179
    s_or_b64 s[20:21], s[20:21], vcc

    v_cmp_u_f32 s[22:23], v180, v181
    v_cmp_u_f32 vcc, v182, v183
    s_or_b64 s[22:23], s[22:23], vcc

    v_cmp_u_f32 s[24:25], v184, v185
    v_cmp_u_f32 vcc, v186, v187
    s_or_b64 s[24:25], s[24:25], vcc

    v_cmp_u_f32 s[26:27], v188, v189
    v_cmp_u_f32 vcc, v190, v191
    s_or_b64 s[26:27], s[26:27], vcc

    v_cmp_u_f32 s[28:29], v194, v195

    s_cmp_lt_u32 s65, 300
    s_cbranch_scc1 standalone__deep_cross_pnn__recsys_kernel_rp
    v_mov_b32 v216, -1

standalone__deep_cross_pnn__recsys_kernel_rd:

    v_lshrrev_b32 v197, 2, v69
    s_lshl_b32 s69, s3, 8
    v_add_u32 v198, s69, v197
    ds_write_b32 v198, v216
    v_mov_b32 v199, 0
    s_waitcnt vmcnt(0) lgkmcnt(0)

    s_barrier
    s_cmp_eq_u32 s3, 1
    s_cbranch_scc1 standalone__deep_cross_pnn__recsys_kernel_rc
    s_cmp_lg_u32 s3, 0
    s_cbranch_scc1 standalone__deep_cross_pnn__recsys_kernel_end

    ds_read_b32 v208, v197 offset:0
    ds_read_b32 v209, v197 offset:256
    ds_read_b32 v210, v197 offset:512
    ds_read_b32 v211, v197 offset:768
    ds_read_b32 v212, v197 offset:1024
    ds_read_b32 v213, v197 offset:1280
    ds_read_b32 v214, v197 offset:1536
    ds_read_b32 v215, v197 offset:1792
    s_waitcnt lgkmcnt(6)
    v_add_f32 v200, v208, v209
    s_waitcnt lgkmcnt(5)
    v_add_f32 v200, v200, v210
    s_waitcnt lgkmcnt(4)
    v_add_f32 v200, v200, v211
    s_waitcnt lgkmcnt(3)
    v_add_f32 v200, v200, v212
    s_waitcnt lgkmcnt(2)
    v_add_f32 v200, v200, v213
    s_waitcnt lgkmcnt(1)
    v_add_f32 v200, v200, v214
    s_waitcnt lgkmcnt(0)
    v_add_f32 v200, v200, v215

    v_cmp_u_f32 vcc, v200, v200
    s_cbranch_vccnz standalone__deep_cross_pnn__recsys_kernel_rf

    v_cvt_pk_bf16_f32 v197, v200, v201
    v_lshlrev_b32 v198, 16, v197
    v_and_b32 v197, 0xffff0000, v197
    v_add_f32 v198, v198, v196
    v_cvt_pk_bf16_f32 v198, v198, v198
    v_lshlrev_b32 v198, 16, v198
    v_add_f32 v198, v198, v197
    v_cvt_pk_bf16_f32 v198, v198, v198
    v_lshrrev_b32 v197, 1, v193
    buffer_store_short v198, v197, s[72:75], s68 offen

    s_endpgm
standalone__deep_cross_pnn__recsys_kernel_rf:

    s_lshr_b32 s69, s2, 5
    s_lshl_b32 s69, s69, 4
    s_lshl_b32 s70, 1, s2
    v_mov_b32 v198, s70
    s_mov_b64 exec, 1
    buffer_atomic_or v198, v199, s[52:55], s69 offen offset:136 sc0
    s_waitcnt vmcnt(0)

standalone__deep_cross_pnn__recsys_kernel_rc:

    s_mov_b64 exec, 0xff
    buffer_load_dwordx4 v[176:179], v69, s[52:55], 0 offen offset:128 sc1
    s_waitcnt vmcnt(0)
    v_cmp_ne_u32 vcc, 0, v178
    s_cbranch_vccz standalone__deep_cross_pnn__recsys_kernel_end
    v_cmp_ne_u32 vcc, -1, v176
    s_cbranch_vccnz standalone__deep_cross_pnn__recsys_kernel_end
    v_mov_b32 v199, v178
    s_mov_b64 exec, -1
    v_lshlrev_b32 v198, 3, v69
    s_mov_b32 s69, 14680064
    buffer_load_dwordx4 v[176:179], v198, s[12:15], s69 offen sc1
    s_waitcnt vmcnt(0)
    v_min3_u32 v198, v176, v177, v178
    v_min_u32 v198, v198, v179
    v_cmp_eq_u32 vcc, 0, v198
    s_cbranch_vccnz standalone__deep_cross_pnn__recsys_kernel_end

standalone__deep_cross_pnn__recsys_kernel_rn:

    v_cmp_ne_u32 vcc, 0, v199
    s_cbranch_vccz standalone__deep_cross_pnn__recsys_kernel_end
    s_ff1_i32_b64 s69, vcc
    s_mov_b32 m0, s69
    s_nop 3
    v_readlane_b32 s70, v199, s69
    s_ff1_i32_b32 s71, s70
    s_bitset0_b32 s70, s71
    s_nop 3
    v_writelane_b32 v199, s70, m0
    s_lshl_b32 s69, s69, 5
    s_add_u32 s69, s69, s71

    s_lshl_b32 s68, s69, 8
    s_add_u32 s66, s68, 29360128
    s_add_u32 s67, s66, 65536
    s_add_u32 s60, s68, 20971520
    s_lshr_b32 s68, s68, 1

    s_add_u32 s61, s60, 262144
    s_add_u32 s62, s60, 524288
    s_add_u32 s63, s60, 786432

    buffer_load_dword v194, v193, s[12:15], s66 offen sc1
    buffer_load_dword v195, v193, s[12:15], s67 offen sc1
    s_mov_b32 s65, 0
standalone__deep_cross_pnn__recsys_kernel_rw:
    buffer_load_dwordx4 v[176:179], v192, s[12:15], s60 offen sc1
    buffer_load_dwordx4 v[180:183], v192, s[12:15], s61 offen sc1
    buffer_load_dwordx4 v[184:187], v192, s[12:15], s62 offen sc1
    buffer_load_dwordx4 v[188:191], v192, s[12:15], s63 offen sc1
    s_waitcnt vmcnt(2)
    v_add_f32 v216, v176, v180
    v_add_f32 v217, v177, v181
    v_add_f32 v218, v178, v182
    v_add_f32 v219, v179, v183
    s_waitcnt vmcnt(0)
    v_add_f32 v220, v184, v188
    v_add_f32 v221, v185, v189
    v_add_f32 v222, v186, v190
    v_add_f32 v223, v187, v191
    v_add_f32 v216, v216, v220
    v_add_f32 v217, v217, v221
    v_add_f32 v218, v218, v222
    v_add_f32 v219, v219, v223

    s_nop 0
    v_permlane32_swap_b32 v216, v217
    v_permlane32_swap_b32 v218, v219
    v_add_f32 v216, v216, v217
    v_add_f32 v218, v218, v219
    s_nop 1
    v_permlane16_swap_b32 v216, v218
    s_nop 0
    v_add_f32 v216, v216, v218

    s_mov_b32 s70, 0xff800001
    s_mov_b64 s[20:21], 0
    v_cmp_eq_u32 vcc, s70, v194
    s_or_b64 s[20:21], s[20:21], vcc
    v_cmp_eq_u32 vcc, s70, v195
    s_or_b64 s[20:21], s[20:21], vcc
    v_cmp_eq_u32 vcc, s70, v176
    s_or_b64 s[20:21], s[20:21], vcc
    v_cmp_eq_u32 vcc, s70, v177
    s_or_b64 s[20:21], s[20:21], vcc
    v_cmp_eq_u32 vcc, s70, v178
    s_or_b64 s[20:21], s[20:21], vcc
    v_cmp_eq_u32 vcc, s70, v179
    s_or_b64 s[20:21], s[20:21], vcc
    v_cmp_eq_u32 vcc, s70, v180
    s_or_b64 s[20:21], s[20:21], vcc
    v_cmp_eq_u32 vcc, s70, v181
    s_or_b64 s[20:21], s[20:21], vcc
    v_cmp_eq_u32 vcc, s70, v182
    s_or_b64 s[20:21], s[20:21], vcc
    v_cmp_eq_u32 vcc, s70, v183
    s_or_b64 s[20:21], s[20:21], vcc
    v_cmp_eq_u32 vcc, s70, v184
    s_or_b64 s[20:21], s[20:21], vcc
    v_cmp_eq_u32 vcc, s70, v185
    s_or_b64 s[20:21], s[20:21], vcc
    v_cmp_eq_u32 vcc, s70, v186
    s_or_b64 s[20:21], s[20:21], vcc
    v_cmp_eq_u32 vcc, s70, v187
    s_or_b64 s[20:21], s[20:21], vcc
    v_cmp_eq_u32 vcc, s70, v188
    s_or_b64 s[20:21], s[20:21], vcc
    v_cmp_eq_u32 vcc, s70, v189
    s_or_b64 s[20:21], s[20:21], vcc
    v_cmp_eq_u32 vcc, s70, v190
    s_or_b64 s[20:21], s[20:21], vcc
    v_cmp_eq_u32 vcc, s70, v191
    s_or_b64 s[20:21], s[20:21], vcc

    s_cbranch_scc1 standalone__deep_cross_pnn__recsys_kernel_end
    s_cmp_eq_u32 s65, 0
    s_cselect_b64 vcc, -1, 0
    v_add_f32 v200, v200, v216
    v_cndmask_b32 v200, v200, v216, vcc
    s_add_u32 s60, s60, 1048576
    s_add_u32 s61, s61, 1048576
    s_add_u32 s62, s62, 1048576
    s_add_u32 s63, s63, 1048576
    s_add_u32 s65, s65, 1
    s_cmp_lt_u32 s65, 8
    s_cbranch_scc1 standalone__deep_cross_pnn__recsys_kernel_rw
    v_add_f32 v201, v194, v195

    v_cvt_pk_bf16_f32 v197, v200, v201
    v_lshlrev_b32 v198, 16, v197
    v_and_b32 v197, 0xffff0000, v197
    v_add_f32 v198, v198, v196
    v_cvt_pk_bf16_f32 v198, v198, v198
    v_lshlrev_b32 v198, 16, v198
    v_add_f32 v198, v198, v197
    v_cvt_pk_bf16_f32 v198, v198, v198
    v_lshrrev_b32 v197, 1, v193
    buffer_store_short v198, v197, s[72:75], s68 offen

    s_nop 1
    s_branch standalone__deep_cross_pnn__recsys_kernel_rn
standalone__deep_cross_pnn__recsys_kernel_k2x:
    s_waitcnt lgkmcnt(0)
standalone__deep_cross_pnn__recsys_kernelx_gloop:
    s_waitcnt vmcnt(6)
    v_lshlrev_b32_sdwa v104, 3, v120 dst_sel:DWORD dst_unused:UNUSED_PAD src0_sel:DWORD src1_sel:WORD_0
    v_lshlrev_b32_sdwa v106, 3, v120 dst_sel:DWORD dst_unused:UNUSED_PAD src0_sel:DWORD src1_sel:WORD_1
    ds_read_b64 v[104:105], v104
    ds_read_b64 v[106:107], v106
    v_lshlrev_b32_sdwa v108, 3, v121 dst_sel:DWORD dst_unused:UNUSED_PAD src0_sel:DWORD src1_sel:WORD_0
    v_lshlrev_b32_sdwa v110, 3, v121 dst_sel:DWORD dst_unused:UNUSED_PAD src0_sel:DWORD src1_sel:WORD_1
    ds_read_b64 v[108:109], v108
    ds_read_b64 v[110:111], v110
    s_waitcnt lgkmcnt(10)
    v_smfmac_f32_16x16x64_bf16 v[0:3], v[64:67], v[88:95], v68
    v_lshlrev_b32_sdwa v88, 3, v122 dst_sel:DWORD dst_unused:UNUSED_PAD src0_sel:DWORD src1_sel:WORD_0
    v_lshlrev_b32_sdwa v90, 3, v122 dst_sel:DWORD dst_unused:UNUSED_PAD src0_sel:DWORD src1_sel:WORD_1
    ds_read_b64 v[88:89], v88
    ds_read_b64 v[90:91], v90
    v_lshlrev_b32_sdwa v92, 3, v123 dst_sel:DWORD dst_unused:UNUSED_PAD src0_sel:DWORD src1_sel:WORD_0
    v_lshlrev_b32_sdwa v94, 3, v123 dst_sel:DWORD dst_unused:UNUSED_PAD src0_sel:DWORD src1_sel:WORD_1
    ds_read_b64 v[92:93], v92
    ds_read_addtid_b32 v71 offset:8080
    ds_read_b64 v[94:95], v94
    s_waitcnt lgkmcnt(9)
    v_smfmac_f32_16x16x64_bf16 v[4:7], v[64:67], v[96:103], v68
    buffer_load_dwordx4 v[120:123], v69, s[12:15], s20 offen offset:0 sc1
    s_waitcnt vmcnt(6)
    v_mfma_f32_16x16x32_bf16 v[112:115], v[72:75], v[128:131], 0
    s_waitcnt vmcnt(5)
    v_lshlrev_b32_sdwa v96, 3, v124 dst_sel:DWORD dst_unused:UNUSED_PAD src0_sel:DWORD src1_sel:WORD_0
    v_lshlrev_b32_sdwa v98, 3, v124 dst_sel:DWORD dst_unused:UNUSED_PAD src0_sel:DWORD src1_sel:WORD_1
    ds_read_b64 v[96:97], v96
    ds_read_b64 v[98:99], v98
    s_waitcnt vmcnt(4)
    v_mfma_f32_16x16x32_bf16 v[112:115], v[76:79], v[132:135], v[112:115]
    v_lshlrev_b32_sdwa v100, 3, v125 dst_sel:DWORD dst_unused:UNUSED_PAD src0_sel:DWORD src1_sel:WORD_0
    v_lshlrev_b32_sdwa v102, 3, v125 dst_sel:DWORD dst_unused:UNUSED_PAD src0_sel:DWORD src1_sel:WORD_1
    ds_read_b64 v[100:101], v100
    ds_read_b64 v[102:103], v102
    s_waitcnt lgkmcnt(9)
    v_smfmac_f32_16x16x64_bf16 v[8:11], v[64:67], v[104:111], v68
    s_waitcnt vmcnt(3)
    v_mfma_f32_16x16x32_bf16 v[112:115], v[80:83], v[136:139], v[112:115]
    v_lshlrev_b32_sdwa v104, 3, v126 dst_sel:DWORD dst_unused:UNUSED_PAD src0_sel:DWORD src1_sel:WORD_0
    v_lshlrev_b32_sdwa v106, 3, v126 dst_sel:DWORD dst_unused:UNUSED_PAD src0_sel:DWORD src1_sel:WORD_1
    ds_read_b64 v[104:105], v104
    ds_read_b64 v[106:107], v106
    s_waitcnt vmcnt(2)
    v_mfma_f32_16x16x32_bf16 v[112:115], v[84:87], v[140:143], v[112:115]
    v_lshlrev_b32_sdwa v108, 3, v127 dst_sel:DWORD dst_unused:UNUSED_PAD src0_sel:DWORD src1_sel:WORD_0
    v_lshlrev_b32_sdwa v110, 3, v127 dst_sel:DWORD dst_unused:UNUSED_PAD src0_sel:DWORD src1_sel:WORD_1
    ds_read_b64 v[108:109], v108
    ds_read_b64 v[110:111], v110
    s_waitcnt lgkmcnt(8)
    v_smfmac_f32_16x16x64_bf16 v[12:15], v[64:67], v[88:95], v68
    buffer_load_dwordx4 v[124:127], v69, s[12:15], s20 offen offset:1024 sc1
    v_readfirstlane_b32 s36, v71
    v_cvt_pk_bf16_f32 v112, v112, v113
    v_cvt_pk_bf16_f32 v113, v114, v115
    s_cmp_lt_u32 s36, s37
    s_cbranch_scc1 standalone__deep_cross_pnn__recsys_kernelx_sp0
standalone__deep_cross_pnn__recsys_kernelx_sr0:
    s_add_u32 s37, s37, 512
    ds_write_b64 v70, v[112:113] offset:0
    v_mfma_f32_16x16x32_bf16 v[112:115], v[72:75], v[144:147], 0
    v_mfma_f32_16x16x32_bf16 v[112:115], v[76:79], v[148:151], v[112:115]
    s_waitcnt vmcnt(2)
    v_lshlrev_b32_sdwa v88, 3, v116 dst_sel:DWORD dst_unused:UNUSED_PAD src0_sel:DWORD src1_sel:WORD_0
    v_lshlrev_b32_sdwa v90, 3, v116 dst_sel:DWORD dst_unused:UNUSED_PAD src0_sel:DWORD src1_sel:WORD_1
    ds_read_b64 v[88:89], v88
    ds_read_b64 v[90:91], v90
    v_mfma_f32_16x16x32_bf16 v[112:115], v[80:83], v[152:155], v[112:115]
    v_mfma_f32_16x16x32_bf16 v[112:115], v[84:87], v[156:159], v[112:115]
    v_lshlrev_b32_sdwa v92, 3, v117 dst_sel:DWORD dst_unused:UNUSED_PAD src0_sel:DWORD src1_sel:WORD_0
    v_lshlrev_b32_sdwa v94, 3, v117 dst_sel:DWORD dst_unused:UNUSED_PAD src0_sel:DWORD src1_sel:WORD_1
    ds_read_b64 v[92:93], v92
    ds_read_b64 v[94:95], v94
    s_waitcnt lgkmcnt(9)
    v_smfmac_f32_16x16x64_bf16 v[16:19], v[64:67], v[96:103], v68
    s_nop 1
    v_cvt_pk_bf16_f32 v112, v112, v113
    v_cvt_pk_bf16_f32 v113, v114, v115
    ds_write_b64 v70, v[112:113] offset:128
    v_mfma_f32_16x16x32_bf16 v[112:115], v[72:75], v[160:163], 0
    v_lshlrev_b32_sdwa v96, 3, v118 dst_sel:DWORD dst_unused:UNUSED_PAD src0_sel:DWORD src1_sel:WORD_0
    v_lshlrev_b32_sdwa v98, 3, v118 dst_sel:DWORD dst_unused:UNUSED_PAD src0_sel:DWORD src1_sel:WORD_1
    ds_read_b64 v[96:97], v96
    ds_read_b64 v[98:99], v98
    v_mfma_f32_16x16x32_bf16 v[112:115], v[76:79], v[164:167], v[112:115]
    v_lshlrev_b32_sdwa v100, 3, v119 dst_sel:DWORD dst_unused:UNUSED_PAD src0_sel:DWORD src1_sel:WORD_0
    v_lshlrev_b32_sdwa v102, 3, v119 dst_sel:DWORD dst_unused:UNUSED_PAD src0_sel:DWORD src1_sel:WORD_1
    ds_read_b64 v[100:101], v100
    ds_read_b64 v[102:103], v102
    s_waitcnt lgkmcnt(10)
    v_smfmac_f32_16x16x64_bf16 v[20:23], v[64:67], v[104:111], v68
    buffer_load_dwordx4 v[116:119], v69, s[12:15], s20 offen offset:2048 sc1
    s_setprio 2
    v_mfma_f32_16x16x32_bf16 v[112:115], v[80:83], v[168:171], v[112:115]
    s_waitcnt vmcnt(2)
    v_lshlrev_b32_sdwa v104, 3, v120 dst_sel:DWORD dst_unused:UNUSED_PAD src0_sel:DWORD src1_sel:WORD_0
    v_lshlrev_b32_sdwa v106, 3, v120 dst_sel:DWORD dst_unused:UNUSED_PAD src0_sel:DWORD src1_sel:WORD_1
    ds_read_b64 v[104:105], v104
    ds_read_b64 v[106:107], v106
    v_mfma_f32_16x16x32_bf16 v[112:115], v[84:87], v[172:175], v[112:115]
    v_lshlrev_b32_sdwa v108, 3, v121 dst_sel:DWORD dst_unused:UNUSED_PAD src0_sel:DWORD src1_sel:WORD_0
    v_lshlrev_b32_sdwa v110, 3, v121 dst_sel:DWORD dst_unused:UNUSED_PAD src0_sel:DWORD src1_sel:WORD_1
    ds_read_b64 v[108:109], v108
    ds_read_b64 v[110:111], v110
    s_waitcnt lgkmcnt(9)
    v_smfmac_f32_16x16x64_bf16 v[24:27], v[64:67], v[88:95], v68
    s_nop 1
    v_cvt_pk_bf16_f32 v112, v112, v113
    v_cvt_pk_bf16_f32 v113, v114, v115
    ds_write_b64 v70, v[112:113] offset:256
    v_mfma_f32_16x16x32_bf16 v[112:115], v[72:75], v[176:179], 0
    v_mfma_f32_16x16x32_bf16 v[112:115], v[76:79], v[180:183], v[112:115]
    v_lshlrev_b32_sdwa v88, 3, v122 dst_sel:DWORD dst_unused:UNUSED_PAD src0_sel:DWORD src1_sel:WORD_0
    v_lshlrev_b32_sdwa v90, 3, v122 dst_sel:DWORD dst_unused:UNUSED_PAD src0_sel:DWORD src1_sel:WORD_1
    ds_read_b64 v[88:89], v88
    ds_read_b64 v[90:91], v90
    v_mfma_f32_16x16x32_bf16 v[112:115], v[80:83], v[184:187], v[112:115]
    v_mfma_f32_16x16x32_bf16 v[112:115], v[84:87], v[188:191], v[112:115]
    v_lshlrev_b32_sdwa v92, 3, v123 dst_sel:DWORD dst_unused:UNUSED_PAD src0_sel:DWORD src1_sel:WORD_0
    v_lshlrev_b32_sdwa v94, 3, v123 dst_sel:DWORD dst_unused:UNUSED_PAD src0_sel:DWORD src1_sel:WORD_1
    ds_read_b64 v[92:93], v92
    ds_read_b64 v[94:95], v94
    s_waitcnt lgkmcnt(9) vmcnt(1)
    v_smfmac_f32_16x16x64_bf16 v[28:31], v[64:67], v[96:103], v68
    buffer_load_dwordx4 v[120:123], v69, s[12:15], s20 offen offset:3072 sc1
    s_add_u32 s20, s20, 61440
    v_cvt_pk_bf16_f32 v112, v112, v113
    v_cvt_pk_bf16_f32 v113, v114, v115
    ds_write_b64 v70, v[112:113] offset:384
    v_mfma_f32_16x16x32_bf16 v[112:115], v[72:75], v[192:195], 0
    v_lshlrev_b32_sdwa v96, 3, v124 dst_sel:DWORD dst_unused:UNUSED_PAD src0_sel:DWORD src1_sel:WORD_0
    v_lshlrev_b32_sdwa v98, 3, v124 dst_sel:DWORD dst_unused:UNUSED_PAD src0_sel:DWORD src1_sel:WORD_1
    ds_read_b64 v[96:97], v96
    ds_read_b64 v[98:99], v98
    v_mfma_f32_16x16x32_bf16 v[112:115], v[76:79], v[196:199], v[112:115]
    v_lshlrev_b32_sdwa v100, 3, v125 dst_sel:DWORD dst_unused:UNUSED_PAD src0_sel:DWORD src1_sel:WORD_0
    v_lshlrev_b32_sdwa v102, 3, v125 dst_sel:DWORD dst_unused:UNUSED_PAD src0_sel:DWORD src1_sel:WORD_1
    ds_read_b64 v[100:101], v100
    ds_read_b64 v[102:103], v102
    s_waitcnt lgkmcnt(10)
    v_smfmac_f32_16x16x64_bf16 v[32:35], v[64:67], v[104:111], v68
    v_lshlrev_b32_sdwa v104, 3, v126 dst_sel:DWORD dst_unused:UNUSED_PAD src0_sel:DWORD src1_sel:WORD_0
    v_lshlrev_b32_sdwa v106, 3, v126 dst_sel:DWORD dst_unused:UNUSED_PAD src0_sel:DWORD src1_sel:WORD_1
    v_mfma_f32_16x16x32_bf16 v[112:115], v[80:83], v[200:203], v[112:115]
    ds_read_b64 v[104:105], v104
    ds_read_b64 v[106:107], v106
    v_mfma_f32_16x16x32_bf16 v[112:115], v[84:87], v[204:207], v[112:115]
    v_lshlrev_b32_sdwa v108, 3, v127 dst_sel:DWORD dst_unused:UNUSED_PAD src0_sel:DWORD src1_sel:WORD_0
    v_lshlrev_b32_sdwa v110, 3, v127 dst_sel:DWORD dst_unused:UNUSED_PAD src0_sel:DWORD src1_sel:WORD_1
    buffer_load_dwordx4 v[124:127], v69, s[12:15], s20 offen offset:0 sc1
    ds_read_b64 v[108:109], v108
    ds_read_b64 v[110:111], v110
    s_waitcnt lgkmcnt(9) vmcnt(2)
    v_smfmac_f32_16x16x64_bf16 v[36:39], v[64:67], v[88:95], v68
    s_setprio 1
    v_cvt_pk_bf16_f32 v112, v112, v113
    v_cvt_pk_bf16_f32 v113, v114, v115
    ds_write_b64 v70, v[112:113] offset:512
    v_mfma_f32_16x16x32_bf16 v[112:115], v[72:75], v[208:211], 0
    v_mfma_f32_16x16x32_bf16 v[112:115], v[76:79], v[212:215], v[112:115]
    v_lshlrev_b32_sdwa v88, 3, v116 dst_sel:DWORD dst_unused:UNUSED_PAD src0_sel:DWORD src1_sel:WORD_0
    v_lshlrev_b32_sdwa v90, 3, v116 dst_sel:DWORD dst_unused:UNUSED_PAD src0_sel:DWORD src1_sel:WORD_1
    ds_read_b64 v[88:89], v88
    ds_read_b64 v[90:91], v90
    v_mfma_f32_16x16x32_bf16 v[112:115], v[80:83], v[216:219], v[112:115]
    v_mfma_f32_16x16x32_bf16 v[112:115], v[84:87], v[220:223], v[112:115]
    v_lshlrev_b32_sdwa v92, 3, v117 dst_sel:DWORD dst_unused:UNUSED_PAD src0_sel:DWORD src1_sel:WORD_0
    v_lshlrev_b32_sdwa v94, 3, v117 dst_sel:DWORD dst_unused:UNUSED_PAD src0_sel:DWORD src1_sel:WORD_1
    ds_read_b64 v[92:93], v92
    ds_read_b64 v[94:95], v94
    s_waitcnt lgkmcnt(9)
    v_smfmac_f32_16x16x64_bf16 v[40:43], v[64:67], v[96:103], v68
    v_lshlrev_b32_sdwa v96, 3, v118 dst_sel:DWORD dst_unused:UNUSED_PAD src0_sel:DWORD src1_sel:WORD_0
    v_lshlrev_b32_sdwa v98, 3, v118 dst_sel:DWORD dst_unused:UNUSED_PAD src0_sel:DWORD src1_sel:WORD_1
    v_cvt_pk_bf16_f32 v112, v112, v113
    v_cvt_pk_bf16_f32 v113, v114, v115
    ds_write_b64 v70, v[112:113] offset:640
    v_mfma_f32_16x16x32_bf16 v[112:115], v[72:75], v[224:227], 0
    ds_read_b64 v[96:97], v96
    ds_read_b64 v[98:99], v98
    v_lshlrev_b32_sdwa v100, 3, v119 dst_sel:DWORD dst_unused:UNUSED_PAD src0_sel:DWORD src1_sel:WORD_0
    v_lshlrev_b32_sdwa v102, 3, v119 dst_sel:DWORD dst_unused:UNUSED_PAD src0_sel:DWORD src1_sel:WORD_1
    v_mfma_f32_16x16x32_bf16 v[112:115], v[76:79], v[228:231], v[112:115]
    ds_read_b64 v[100:101], v100
    ds_read_b64 v[102:103], v102
    s_waitcnt lgkmcnt(10)
    v_smfmac_f32_16x16x64_bf16 v[44:47], v[64:67], v[104:111], v68
    buffer_load_dwordx4 v[116:119], v69, s[12:15], s20 offen offset:1024 sc1
    s_waitcnt vmcnt(2)
    v_lshlrev_b32_sdwa v104, 3, v120 dst_sel:DWORD dst_unused:UNUSED_PAD src0_sel:DWORD src1_sel:WORD_0
    v_lshlrev_b32_sdwa v106, 3, v120 dst_sel:DWORD dst_unused:UNUSED_PAD src0_sel:DWORD src1_sel:WORD_1
    v_mfma_f32_16x16x32_bf16 v[112:115], v[80:83], v[232:235], v[112:115]
    ds_read_b64 v[104:105], v104
    ds_read_b64 v[106:107], v106
    v_lshlrev_b32_sdwa v108, 3, v121 dst_sel:DWORD dst_unused:UNUSED_PAD src0_sel:DWORD src1_sel:WORD_0
    v_lshlrev_b32_sdwa v110, 3, v121 dst_sel:DWORD dst_unused:UNUSED_PAD src0_sel:DWORD src1_sel:WORD_1
    v_mfma_f32_16x16x32_bf16 v[112:115], v[84:87], v[236:239], v[112:115]
    ds_read_b64 v[108:109], v108
    ds_read_b64 v[110:111], v110
    s_waitcnt lgkmcnt(9)
    v_smfmac_f32_16x16x64_bf16 v[48:51], v[64:67], v[88:95], v68
    v_lshlrev_b32_sdwa v88, 3, v122 dst_sel:DWORD dst_unused:UNUSED_PAD src0_sel:DWORD src1_sel:WORD_0
    v_lshlrev_b32_sdwa v90, 3, v122 dst_sel:DWORD dst_unused:UNUSED_PAD src0_sel:DWORD src1_sel:WORD_1
    s_nop 1
    v_cvt_pk_bf16_f32 v112, v112, v113
    v_cvt_pk_bf16_f32 v113, v114, v115
    ds_write_b64 v70, v[112:113] offset:768
    v_mfma_f32_16x16x32_bf16 v[112:115], v[72:75], v[240:243], 0
    buffer_load_dwordx4 v[72:75], v69, s[12:15], s21 offen offset:0
    ds_read_b64 v[88:89], v88
    ds_read_b64 v[90:91], v90
    v_lshlrev_b32_sdwa v92, 3, v123 dst_sel:DWORD dst_unused:UNUSED_PAD src0_sel:DWORD src1_sel:WORD_0
    v_lshlrev_b32_sdwa v94, 3, v123 dst_sel:DWORD dst_unused:UNUSED_PAD src0_sel:DWORD src1_sel:WORD_1
    buffer_load_dwordx4 v[120:123], v69, s[12:15], s20 offen offset:2048 sc1
    ds_read_b64 v[92:93], v92
    ds_read_b64 v[94:95], v94
    v_mfma_f32_16x16x32_bf16 v[112:115], v[76:79], v[244:247], v[112:115]
    buffer_load_dwordx4 v[76:79], v69, s[12:15], s21 offen offset:1024
    s_waitcnt lgkmcnt(9)
    v_smfmac_f32_16x16x64_bf16 v[52:55], v[64:67], v[96:103], v68
    s_waitcnt vmcnt(4)
    v_lshlrev_b32_sdwa v96, 3, v124 dst_sel:DWORD dst_unused:UNUSED_PAD src0_sel:DWORD src1_sel:WORD_0
    v_lshlrev_b32_sdwa v98, 3, v124 dst_sel:DWORD dst_unused:UNUSED_PAD src0_sel:DWORD src1_sel:WORD_1
    ds_read_b64 v[96:97], v96
    ds_read_b64 v[98:99], v98
    v_mfma_f32_16x16x32_bf16 v[112:115], v[80:83], v[248:251], v[112:115]
    buffer_load_dwordx4 v[80:83], v69, s[12:15], s19 offen offset:0
    v_lshlrev_b32_sdwa v100, 3, v125 dst_sel:DWORD dst_unused:UNUSED_PAD src0_sel:DWORD src1_sel:WORD_0
    v_lshlrev_b32_sdwa v102, 3, v125 dst_sel:DWORD dst_unused:UNUSED_PAD src0_sel:DWORD src1_sel:WORD_1
    v_mfma_f32_16x16x32_bf16 v[112:115], v[84:87], v[252:255], v[112:115]
    buffer_load_dwordx4 v[84:87], v69, s[12:15], s19 offen offset:1024
    s_add_u32 s21, s21, 4096
    s_add_u32 s19, s19, 4096
    ds_read_b64 v[100:101], v100
    ds_read_b64 v[102:103], v102
    s_nop 2
    v_cvt_pk_bf16_f32 v112, v112, v113
    v_cvt_pk_bf16_f32 v113, v114, v115
    ds_write_b64 v70, v[112:113] offset:896
    ds_append v71 offset:8080
    s_add_u32 s23, s23, s23
    s_cselect_b32 s35, 4294836224, s32
    v_add_u32 v70, s35, v70
    s_waitcnt lgkmcnt(11)
    v_smfmac_f32_16x16x64_bf16 v[56:59], v[64:67], v[104:111], v68
    s_setprio 0
    v_lshlrev_b32_sdwa v104, 3, v126 dst_sel:DWORD dst_unused:UNUSED_PAD src0_sel:DWORD src1_sel:WORD_0
    v_lshlrev_b32_sdwa v106, 3, v126 dst_sel:DWORD dst_unused:UNUSED_PAD src0_sel:DWORD src1_sel:WORD_1
    ds_read_b64 v[104:105], v104
    ds_read_b64 v[106:107], v106
    v_lshlrev_b32_sdwa v108, 3, v127 dst_sel:DWORD dst_unused:UNUSED_PAD src0_sel:DWORD src1_sel:WORD_0
    v_lshlrev_b32_sdwa v110, 3, v127 dst_sel:DWORD dst_unused:UNUSED_PAD src0_sel:DWORD src1_sel:WORD_1
    buffer_load_dwordx4 v[124:127], v69, s[12:15], s20 offen offset:3072 sc1
    s_add_u32 s20, s20, 4096
    ds_read_b64 v[108:109], v108
    ds_read_b64 v[110:111], v110
    s_waitcnt lgkmcnt(10)
    v_smfmac_f32_16x16x64_bf16 v[60:63], v[64:67], v[88:95], v68

    s_cmpk_eq_u32 s37, 11264
    s_cbranch_scc1 standalone__deep_cross_pnn__recsys_kernelx_fin

    s_waitcnt vmcnt(6)
    v_lshlrev_b32_sdwa v88, 3, v116 dst_sel:DWORD dst_unused:UNUSED_PAD src0_sel:DWORD src1_sel:WORD_0
    v_lshlrev_b32_sdwa v90, 3, v116 dst_sel:DWORD dst_unused:UNUSED_PAD src0_sel:DWORD src1_sel:WORD_1
    ds_read_b64 v[88:89], v88
    ds_read_b64 v[90:91], v90
    v_lshlrev_b32_sdwa v92, 3, v117 dst_sel:DWORD dst_unused:UNUSED_PAD src0_sel:DWORD src1_sel:WORD_0
    v_lshlrev_b32_sdwa v94, 3, v117 dst_sel:DWORD dst_unused:UNUSED_PAD src0_sel:DWORD src1_sel:WORD_1
    ds_read_b64 v[92:93], v92
    ds_read_b64 v[94:95], v94
    s_waitcnt lgkmcnt(10)
    v_smfmac_f32_16x16x64_bf16 v[0:3], v[64:67], v[96:103], v68
    v_lshlrev_b32_sdwa v96, 3, v118 dst_sel:DWORD dst_unused:UNUSED_PAD src0_sel:DWORD src1_sel:WORD_0
    v_lshlrev_b32_sdwa v98, 3, v118 dst_sel:DWORD dst_unused:UNUSED_PAD src0_sel:DWORD src1_sel:WORD_1
    ds_read_b64 v[96:97], v96
    ds_read_b64 v[98:99], v98
    v_lshlrev_b32_sdwa v100, 3, v119 dst_sel:DWORD dst_unused:UNUSED_PAD src0_sel:DWORD src1_sel:WORD_0
    v_lshlrev_b32_sdwa v102, 3, v119 dst_sel:DWORD dst_unused:UNUSED_PAD src0_sel:DWORD src1_sel:WORD_1
    ds_read_b64 v[100:101], v100
    ds_read_addtid_b32 v71 offset:8080
    ds_read_b64 v[102:103], v102
    s_waitcnt lgkmcnt(9)
    v_smfmac_f32_16x16x64_bf16 v[4:7], v[64:67], v[104:111], v68
    buffer_load_dwordx4 v[116:119], v69, s[12:15], s20 offen offset:0 sc1
    s_waitcnt vmcnt(6)
    v_mfma_f32_16x16x32_bf16 v[112:115], v[72:75], v[128:131], 0
    s_waitcnt vmcnt(5)
    v_lshlrev_b32_sdwa v104, 3, v120 dst_sel:DWORD dst_unused:UNUSED_PAD src0_sel:DWORD src1_sel:WORD_0
    v_lshlrev_b32_sdwa v106, 3, v120 dst_sel:DWORD dst_unused:UNUSED_PAD src0_sel:DWORD src1_sel:WORD_1
    ds_read_b64 v[104:105], v104
    ds_read_b64 v[106:107], v106
    s_waitcnt vmcnt(4)
    v_mfma_f32_16x16x32_bf16 v[112:115], v[76:79], v[132:135], v[112:115]
    v_lshlrev_b32_sdwa v108, 3, v121 dst_sel:DWORD dst_unused:UNUSED_PAD src0_sel:DWORD src1_sel:WORD_0
    v_lshlrev_b32_sdwa v110, 3, v121 dst_sel:DWORD dst_unused:UNUSED_PAD src0_sel:DWORD src1_sel:WORD_1
    ds_read_b64 v[108:109], v108
    ds_read_b64 v[110:111], v110
    s_waitcnt lgkmcnt(9)
    v_smfmac_f32_16x16x64_bf16 v[8:11], v[64:67], v[88:95], v68
    s_waitcnt vmcnt(3)
    v_mfma_f32_16x16x32_bf16 v[112:115], v[80:83], v[136:139], v[112:115]
    v_lshlrev_b32_sdwa v88, 3, v122 dst_sel:DWORD dst_unused:UNUSED_PAD src0_sel:DWORD src1_sel:WORD_0
    v_lshlrev_b32_sdwa v90, 3, v122 dst_sel:DWORD dst_unused:UNUSED_PAD src0_sel:DWORD src1_sel:WORD_1
    ds_read_b64 v[88:89], v88
    ds_read_b64 v[90:91], v90
    s_waitcnt vmcnt(2)
    v_mfma_f32_16x16x32_bf16 v[112:115], v[84:87], v[140:143], v[112:115]
    v_lshlrev_b32_sdwa v92, 3, v123 dst_sel:DWORD dst_unused:UNUSED_PAD src0_sel:DWORD src1_sel:WORD_0
    v_lshlrev_b32_sdwa v94, 3, v123 dst_sel:DWORD dst_unused:UNUSED_PAD src0_sel:DWORD src1_sel:WORD_1
    ds_read_b64 v[92:93], v92
    ds_read_b64 v[94:95], v94
    s_waitcnt lgkmcnt(8)
    v_smfmac_f32_16x16x64_bf16 v[12:15], v[64:67], v[96:103], v68
    buffer_load_dwordx4 v[120:123], v69, s[12:15], s20 offen offset:1024 sc1
    v_readfirstlane_b32 s36, v71
    v_cvt_pk_bf16_f32 v112, v112, v113
    v_cvt_pk_bf16_f32 v113, v114, v115
    s_cmp_lt_u32 s36, s37
    s_cbranch_scc1 standalone__deep_cross_pnn__recsys_kernelx_sp1
standalone__deep_cross_pnn__recsys_kernelx_sr1:
    s_add_u32 s37, s37, 512
    ds_write_b64 v70, v[112:113] offset:0
    v_mfma_f32_16x16x32_bf16 v[112:115], v[72:75], v[144:147], 0
    v_mfma_f32_16x16x32_bf16 v[112:115], v[76:79], v[148:151], v[112:115]
    s_waitcnt vmcnt(2)
    v_lshlrev_b32_sdwa v96, 3, v124 dst_sel:DWORD dst_unused:UNUSED_PAD src0_sel:DWORD src1_sel:WORD_0
    v_lshlrev_b32_sdwa v98, 3, v124 dst_sel:DWORD dst_unused:UNUSED_PAD src0_sel:DWORD src1_sel:WORD_1
    ds_read_b64 v[96:97], v96
    ds_read_b64 v[98:99], v98
    v_mfma_f32_16x16x32_bf16 v[112:115], v[80:83], v[152:155], v[112:115]
    v_mfma_f32_16x16x32_bf16 v[112:115], v[84:87], v[156:159], v[112:115]
    v_lshlrev_b32_sdwa v100, 3, v125 dst_sel:DWORD dst_unused:UNUSED_PAD src0_sel:DWORD src1_sel:WORD_0
    v_lshlrev_b32_sdwa v102, 3, v125 dst_sel:DWORD dst_unused:UNUSED_PAD src0_sel:DWORD src1_sel:WORD_1
    ds_read_b64 v[100:101], v100
    ds_read_b64 v[102:103], v102
    s_waitcnt lgkmcnt(9)
    v_smfmac_f32_16x16x64_bf16 v[16:19], v[64:67], v[104:111], v68
    s_nop 1
    v_cvt_pk_bf16_f32 v112, v112, v113
    v_cvt_pk_bf16_f32 v113, v114, v115
    ds_write_b64 v70, v[112:113] offset:128
    v_mfma_f32_16x16x32_bf16 v[112:115], v[72:75], v[160:163], 0
    v_lshlrev_b32_sdwa v104, 3, v126 dst_sel:DWORD dst_unused:UNUSED_PAD src0_sel:DWORD src1_sel:WORD_0
    v_lshlrev_b32_sdwa v106, 3, v126 dst_sel:DWORD dst_unused:UNUSED_PAD src0_sel:DWORD src1_sel:WORD_1
    ds_read_b64 v[104:105], v104
    ds_read_b64 v[106:107], v106
    v_mfma_f32_16x16x32_bf16 v[112:115], v[76:79], v[164:167], v[112:115]
    v_lshlrev_b32_sdwa v108, 3, v127 dst_sel:DWORD dst_unused:UNUSED_PAD src0_sel:DWORD src1_sel:WORD_0
    v_lshlrev_b32_sdwa v110, 3, v127 dst_sel:DWORD dst_unused:UNUSED_PAD src0_sel:DWORD src1_sel:WORD_1
    ds_read_b64 v[108:109], v108
    ds_read_b64 v[110:111], v110
    s_waitcnt lgkmcnt(10)
    v_smfmac_f32_16x16x64_bf16 v[20:23], v[64:67], v[88:95], v68
    buffer_load_dwordx4 v[124:127], v69, s[12:15], s20 offen offset:2048 sc1
    s_setprio 2
    v_mfma_f32_16x16x32_bf16 v[112:115], v[80:83], v[168:171], v[112:115]
    s_waitcnt vmcnt(2)
    v_lshlrev_b32_sdwa v88, 3, v116 dst_sel:DWORD dst_unused:UNUSED_PAD src0_sel:DWORD src1_sel:WORD_0
    v_lshlrev_b32_sdwa v90, 3, v116 dst_sel:DWORD dst_unused:UNUSED_PAD src0_sel:DWORD src1_sel:WORD_1
    ds_read_b64 v[88:89], v88
    ds_read_b64 v[90:91], v90
    v_mfma_f32_16x16x32_bf16 v[112:115], v[84:87], v[172:175], v[112:115]
    v_lshlrev_b32_sdwa v92, 3, v117 dst_sel:DWORD dst_unused:UNUSED_PAD src0_sel:DWORD src1_sel:WORD_0
    v_lshlrev_b32_sdwa v94, 3, v117 dst_sel:DWORD dst_unused:UNUSED_PAD src0_sel:DWORD src1_sel:WORD_1
    ds_read_b64 v[92:93], v92
    ds_read_b64 v[94:95], v94
    s_waitcnt lgkmcnt(9)
    v_smfmac_f32_16x16x64_bf16 v[24:27], v[64:67], v[96:103], v68
    s_nop 1
    v_cvt_pk_bf16_f32 v112, v112, v113
    v_cvt_pk_bf16_f32 v113, v114, v115
    ds_write_b64 v70, v[112:113] offset:256
    v_mfma_f32_16x16x32_bf16 v[112:115], v[72:75], v[176:179], 0
    v_mfma_f32_16x16x32_bf16 v[112:115], v[76:79], v[180:183], v[112:115]
    v_lshlrev_b32_sdwa v96, 3, v118 dst_sel:DWORD dst_unused:UNUSED_PAD src0_sel:DWORD src1_sel:WORD_0
    v_lshlrev_b32_sdwa v98, 3, v118 dst_sel:DWORD dst_unused:UNUSED_PAD src0_sel:DWORD src1_sel:WORD_1
    ds_read_b64 v[96:97], v96
    ds_read_b64 v[98:99], v98
    v_mfma_f32_16x16x32_bf16 v[112:115], v[80:83], v[184:187], v[112:115]
    v_mfma_f32_16x16x32_bf16 v[112:115], v[84:87], v[188:191], v[112:115]
    v_lshlrev_b32_sdwa v100, 3, v119 dst_sel:DWORD dst_unused:UNUSED_PAD src0_sel:DWORD src1_sel:WORD_0
    v_lshlrev_b32_sdwa v102, 3, v119 dst_sel:DWORD dst_unused:UNUSED_PAD src0_sel:DWORD src1_sel:WORD_1
    ds_read_b64 v[100:101], v100
    ds_read_b64 v[102:103], v102
    s_waitcnt lgkmcnt(9) vmcnt(1)
    v_smfmac_f32_16x16x64_bf16 v[28:31], v[64:67], v[104:111], v68
    buffer_load_dwordx4 v[116:119], v69, s[12:15], s20 offen offset:3072 sc1
    s_add_u32 s20, s20, 61440
    v_cvt_pk_bf16_f32 v112, v112, v113
    v_cvt_pk_bf16_f32 v113, v114, v115
    ds_write_b64 v70, v[112:113] offset:384
    v_mfma_f32_16x16x32_bf16 v[112:115], v[72:75], v[192:195], 0
    v_lshlrev_b32_sdwa v104, 3, v120 dst_sel:DWORD dst_unused:UNUSED_PAD src0_sel:DWORD src1_sel:WORD_0
    v_lshlrev_b32_sdwa v106, 3, v120 dst_sel:DWORD dst_unused:UNUSED_PAD src0_sel:DWORD src1_sel:WORD_1
    ds_read_b64 v[104:105], v104
    ds_read_b64 v[106:107], v106
    v_mfma_f32_16x16x32_bf16 v[112:115], v[76:79], v[196:199], v[112:115]
    v_lshlrev_b32_sdwa v108, 3, v121 dst_sel:DWORD dst_unused:UNUSED_PAD src0_sel:DWORD src1_sel:WORD_0
    v_lshlrev_b32_sdwa v110, 3, v121 dst_sel:DWORD dst_unused:UNUSED_PAD src0_sel:DWORD src1_sel:WORD_1
    ds_read_b64 v[108:109], v108
    ds_read_b64 v[110:111], v110
    s_waitcnt lgkmcnt(10)
    v_smfmac_f32_16x16x64_bf16 v[32:35], v[64:67], v[88:95], v68
    v_lshlrev_b32_sdwa v88, 3, v122 dst_sel:DWORD dst_unused:UNUSED_PAD src0_sel:DWORD src1_sel:WORD_0
    v_lshlrev_b32_sdwa v90, 3, v122 dst_sel:DWORD dst_unused:UNUSED_PAD src0_sel:DWORD src1_sel:WORD_1
    v_mfma_f32_16x16x32_bf16 v[112:115], v[80:83], v[200:203], v[112:115]
    ds_read_b64 v[88:89], v88
    ds_read_b64 v[90:91], v90
    v_mfma_f32_16x16x32_bf16 v[112:115], v[84:87], v[204:207], v[112:115]
    v_lshlrev_b32_sdwa v92, 3, v123 dst_sel:DWORD dst_unused:UNUSED_PAD src0_sel:DWORD src1_sel:WORD_0
    v_lshlrev_b32_sdwa v94, 3, v123 dst_sel:DWORD dst_unused:UNUSED_PAD src0_sel:DWORD src1_sel:WORD_1
    buffer_load_dwordx4 v[120:123], v69, s[12:15], s20 offen offset:0 sc1
    ds_read_b64 v[92:93], v92
    ds_read_b64 v[94:95], v94
    s_waitcnt lgkmcnt(9) vmcnt(2)
    v_smfmac_f32_16x16x64_bf16 v[36:39], v[64:67], v[96:103], v68
    s_setprio 1
    v_cvt_pk_bf16_f32 v112, v112, v113
    v_cvt_pk_bf16_f32 v113, v114, v115
    ds_write_b64 v70, v[112:113] offset:512
    v_mfma_f32_16x16x32_bf16 v[112:115], v[72:75], v[208:211], 0
    v_mfma_f32_16x16x32_bf16 v[112:115], v[76:79], v[212:215], v[112:115]
    v_lshlrev_b32_sdwa v96, 3, v124 dst_sel:DWORD dst_unused:UNUSED_PAD src0_sel:DWORD src1_sel:WORD_0
    v_lshlrev_b32_sdwa v98, 3, v124 dst_sel:DWORD dst_unused:UNUSED_PAD src0_sel:DWORD src1_sel:WORD_1
    ds_read_b64 v[96:97], v96
    ds_read_b64 v[98:99], v98
    v_mfma_f32_16x16x32_bf16 v[112:115], v[80:83], v[216:219], v[112:115]
    v_mfma_f32_16x16x32_bf16 v[112:115], v[84:87], v[220:223], v[112:115]
    v_lshlrev_b32_sdwa v100, 3, v125 dst_sel:DWORD dst_unused:UNUSED_PAD src0_sel:DWORD src1_sel:WORD_0
    v_lshlrev_b32_sdwa v102, 3, v125 dst_sel:DWORD dst_unused:UNUSED_PAD src0_sel:DWORD src1_sel:WORD_1
    ds_read_b64 v[100:101], v100
    ds_read_b64 v[102:103], v102
    s_waitcnt lgkmcnt(9)
    v_smfmac_f32_16x16x64_bf16 v[40:43], v[64:67], v[104:111], v68
    v_lshlrev_b32_sdwa v104, 3, v126 dst_sel:DWORD dst_unused:UNUSED_PAD src0_sel:DWORD src1_sel:WORD_0
    v_lshlrev_b32_sdwa v106, 3, v126 dst_sel:DWORD dst_unused:UNUSED_PAD src0_sel:DWORD src1_sel:WORD_1
    v_cvt_pk_bf16_f32 v112, v112, v113
    v_cvt_pk_bf16_f32 v113, v114, v115
    ds_write_b64 v70, v[112:113] offset:640
    v_mfma_f32_16x16x32_bf16 v[112:115], v[72:75], v[224:227], 0
    ds_read_b64 v[104:105], v104
    ds_read_b64 v[106:107], v106
    v_lshlrev_b32_sdwa v108, 3, v127 dst_sel:DWORD dst_unused:UNUSED_PAD src0_sel:DWORD src1_sel:WORD_0
    v_lshlrev_b32_sdwa v110, 3, v127 dst_sel:DWORD dst_unused:UNUSED_PAD src0_sel:DWORD src1_sel:WORD_1
    v_mfma_f32_16x16x32_bf16 v[112:115], v[76:79], v[228:231], v[112:115]
    ds_read_b64 v[108:109], v108
    ds_read_b64 v[110:111], v110
    s_waitcnt lgkmcnt(10)
    v_smfmac_f32_16x16x64_bf16 v[44:47], v[64:67], v[88:95], v68
    buffer_load_dwordx4 v[124:127], v69, s[12:15], s20 offen offset:1024 sc1
    s_waitcnt vmcnt(2)
    v_lshlrev_b32_sdwa v88, 3, v116 dst_sel:DWORD dst_unused:UNUSED_PAD src0_sel:DWORD src1_sel:WORD_0
    v_lshlrev_b32_sdwa v90, 3, v116 dst_sel:DWORD dst_unused:UNUSED_PAD src0_sel:DWORD src1_sel:WORD_1
    v_mfma_f32_16x16x32_bf16 v[112:115], v[80:83], v[232:235], v[112:115]
    ds_read_b64 v[88:89], v88
    ds_read_b64 v[90:91], v90
    v_lshlrev_b32_sdwa v92, 3, v117 dst_sel:DWORD dst_unused:UNUSED_PAD src0_sel:DWORD src1_sel:WORD_0
    v_lshlrev_b32_sdwa v94, 3, v117 dst_sel:DWORD dst_unused:UNUSED_PAD src0_sel:DWORD src1_sel:WORD_1
    v_mfma_f32_16x16x32_bf16 v[112:115], v[84:87], v[236:239], v[112:115]
    ds_read_b64 v[92:93], v92
    ds_read_b64 v[94:95], v94
    s_waitcnt lgkmcnt(9)
    v_smfmac_f32_16x16x64_bf16 v[48:51], v[64:67], v[96:103], v68
    v_lshlrev_b32_sdwa v96, 3, v118 dst_sel:DWORD dst_unused:UNUSED_PAD src0_sel:DWORD src1_sel:WORD_0
    v_lshlrev_b32_sdwa v98, 3, v118 dst_sel:DWORD dst_unused:UNUSED_PAD src0_sel:DWORD src1_sel:WORD_1
    s_nop 1
    v_cvt_pk_bf16_f32 v112, v112, v113
    v_cvt_pk_bf16_f32 v113, v114, v115
    ds_write_b64 v70, v[112:113] offset:768
    v_mfma_f32_16x16x32_bf16 v[112:115], v[72:75], v[240:243], 0
    buffer_load_dwordx4 v[72:75], v69, s[12:15], s21 offen offset:0
    ds_read_b64 v[96:97], v96
    ds_read_b64 v[98:99], v98
    v_lshlrev_b32_sdwa v100, 3, v119 dst_sel:DWORD dst_unused:UNUSED_PAD src0_sel:DWORD src1_sel:WORD_0
    v_lshlrev_b32_sdwa v102, 3, v119 dst_sel:DWORD dst_unused:UNUSED_PAD src0_sel:DWORD src1_sel:WORD_1
    buffer_load_dwordx4 v[116:119], v69, s[12:15], s20 offen offset:2048 sc1
    ds_read_b64 v[100:101], v100
    ds_read_b64 v[102:103], v102
    v_mfma_f32_16x16x32_bf16 v[112:115], v[76:79], v[244:247], v[112:115]
    buffer_load_dwordx4 v[76:79], v69, s[12:15], s21 offen offset:1024
    s_waitcnt lgkmcnt(9)
    v_smfmac_f32_16x16x64_bf16 v[52:55], v[64:67], v[104:111], v68
    s_waitcnt vmcnt(4)
    v_lshlrev_b32_sdwa v104, 3, v120 dst_sel:DWORD dst_unused:UNUSED_PAD src0_sel:DWORD src1_sel:WORD_0
    v_lshlrev_b32_sdwa v106, 3, v120 dst_sel:DWORD dst_unused:UNUSED_PAD src0_sel:DWORD src1_sel:WORD_1
    ds_read_b64 v[104:105], v104
    ds_read_b64 v[106:107], v106
    v_mfma_f32_16x16x32_bf16 v[112:115], v[80:83], v[248:251], v[112:115]
    buffer_load_dwordx4 v[80:83], v69, s[12:15], s19 offen offset:0
    v_lshlrev_b32_sdwa v108, 3, v121 dst_sel:DWORD dst_unused:UNUSED_PAD src0_sel:DWORD src1_sel:WORD_0
    v_lshlrev_b32_sdwa v110, 3, v121 dst_sel:DWORD dst_unused:UNUSED_PAD src0_sel:DWORD src1_sel:WORD_1
    v_mfma_f32_16x16x32_bf16 v[112:115], v[84:87], v[252:255], v[112:115]
    buffer_load_dwordx4 v[84:87], v69, s[12:15], s19 offen offset:1024
    s_add_u32 s21, s21, 4096
    s_add_u32 s19, s19, 4096
    ds_read_b64 v[108:109], v108
    ds_read_b64 v[110:111], v110
    s_nop 2
    v_cvt_pk_bf16_f32 v112, v112, v113
    v_cvt_pk_bf16_f32 v113, v114, v115
    ds_write_b64 v70, v[112:113] offset:896
    ds_append v71 offset:8080
    s_add_u32 s23, s23, s23
    s_cselect_b32 s35, 4294836224, s32
    v_add_u32 v70, s35, v70
    s_waitcnt lgkmcnt(11)
    v_smfmac_f32_16x16x64_bf16 v[56:59], v[64:67], v[88:95], v68
    s_setprio 0
    v_lshlrev_b32_sdwa v88, 3, v122 dst_sel:DWORD dst_unused:UNUSED_PAD src0_sel:DWORD src1_sel:WORD_0
    v_lshlrev_b32_sdwa v90, 3, v122 dst_sel:DWORD dst_unused:UNUSED_PAD src0_sel:DWORD src1_sel:WORD_1
    ds_read_b64 v[88:89], v88
    ds_read_b64 v[90:91], v90
    v_lshlrev_b32_sdwa v92, 3, v123 dst_sel:DWORD dst_unused:UNUSED_PAD src0_sel:DWORD src1_sel:WORD_0
    v_lshlrev_b32_sdwa v94, 3, v123 dst_sel:DWORD dst_unused:UNUSED_PAD src0_sel:DWORD src1_sel:WORD_1
    buffer_load_dwordx4 v[120:123], v69, s[12:15], s20 offen offset:3072 sc1
    s_add_u32 s20, s20, 4096
    ds_read_b64 v[92:93], v92
    ds_read_b64 v[94:95], v94
    s_waitcnt lgkmcnt(10)
    v_smfmac_f32_16x16x64_bf16 v[60:63], v[64:67], v[96:103], v68
    s_waitcnt vmcnt(6)
    v_lshlrev_b32_sdwa v96, 3, v124 dst_sel:DWORD dst_unused:UNUSED_PAD src0_sel:DWORD src1_sel:WORD_0
    v_lshlrev_b32_sdwa v98, 3, v124 dst_sel:DWORD dst_unused:UNUSED_PAD src0_sel:DWORD src1_sel:WORD_1
    ds_read_b64 v[96:97], v96
    ds_read_b64 v[98:99], v98
    v_lshlrev_b32_sdwa v100, 3, v125 dst_sel:DWORD dst_unused:UNUSED_PAD src0_sel:DWORD src1_sel:WORD_0
    v_lshlrev_b32_sdwa v102, 3, v125 dst_sel:DWORD dst_unused:UNUSED_PAD src0_sel:DWORD src1_sel:WORD_1
    ds_read_b64 v[100:101], v100
    ds_read_b64 v[102:103], v102
    s_waitcnt lgkmcnt(10)
    v_smfmac_f32_16x16x64_bf16 v[0:3], v[64:67], v[104:111], v68
    v_lshlrev_b32_sdwa v104, 3, v126 dst_sel:DWORD dst_unused:UNUSED_PAD src0_sel:DWORD src1_sel:WORD_0
    v_lshlrev_b32_sdwa v106, 3, v126 dst_sel:DWORD dst_unused:UNUSED_PAD src0_sel:DWORD src1_sel:WORD_1
    ds_read_b64 v[104:105], v104
    ds_read_b64 v[106:107], v106
    v_lshlrev_b32_sdwa v108, 3, v127 dst_sel:DWORD dst_unused:UNUSED_PAD src0_sel:DWORD src1_sel:WORD_0
    v_lshlrev_b32_sdwa v110, 3, v127 dst_sel:DWORD dst_unused:UNUSED_PAD src0_sel:DWORD src1_sel:WORD_1
    ds_read_b64 v[108:109], v108
    ds_read_addtid_b32 v71 offset:8080
    ds_read_b64 v[110:111], v110
    s_waitcnt lgkmcnt(9)
    v_smfmac_f32_16x16x64_bf16 v[4:7], v[64:67], v[88:95], v68
    buffer_load_dwordx4 v[124:127], v69, s[12:15], s20 offen offset:0 sc1
    s_waitcnt vmcnt(6)
    v_mfma_f32_16x16x32_bf16 v[112:115], v[72:75], v[128:131], 0
    s_waitcnt vmcnt(5)
    v_lshlrev_b32_sdwa v88, 3, v116 dst_sel:DWORD dst_unused:UNUSED_PAD src0_sel:DWORD src1_sel:WORD_0
    v_lshlrev_b32_sdwa v90, 3, v116 dst_sel:DWORD dst_unused:UNUSED_PAD src0_sel:DWORD src1_sel:WORD_1
    ds_read_b64 v[88:89], v88
    ds_read_b64 v[90:91], v90
    s_waitcnt vmcnt(4)
    v_mfma_f32_16x16x32_bf16 v[112:115], v[76:79], v[132:135], v[112:115]
    v_lshlrev_b32_sdwa v92, 3, v117 dst_sel:DWORD dst_unused:UNUSED_PAD src0_sel:DWORD src1_sel:WORD_0
    v_lshlrev_b32_sdwa v94, 3, v117 dst_sel:DWORD dst_unused:UNUSED_PAD src0_sel:DWORD src1_sel:WORD_1
    ds_read_b64 v[92:93], v92
    ds_read_b64 v[94:95], v94
    s_waitcnt lgkmcnt(9)
    v_smfmac_f32_16x16x64_bf16 v[8:11], v[64:67], v[96:103], v68
    s_waitcnt vmcnt(3)
    v_mfma_f32_16x16x32_bf16 v[112:115], v[80:83], v[136:139], v[112:115]
    v_lshlrev_b32_sdwa v96, 3, v118 dst_sel:DWORD dst_unused:UNUSED_PAD src0_sel:DWORD src1_sel:WORD_0
    v_lshlrev_b32_sdwa v98, 3, v118 dst_sel:DWORD dst_unused:UNUSED_PAD src0_sel:DWORD src1_sel:WORD_1
    ds_read_b64 v[96:97], v96
    ds_read_b64 v[98:99], v98
    s_waitcnt vmcnt(2)
    v_mfma_f32_16x16x32_bf16 v[112:115], v[84:87], v[140:143], v[112:115]
    v_lshlrev_b32_sdwa v100, 3, v119 dst_sel:DWORD dst_unused:UNUSED_PAD src0_sel:DWORD src1_sel:WORD_0
    v_lshlrev_b32_sdwa v102, 3, v119 dst_sel:DWORD dst_unused:UNUSED_PAD src0_sel:DWORD src1_sel:WORD_1
    ds_read_b64 v[100:101], v100
    ds_read_b64 v[102:103], v102
    s_waitcnt lgkmcnt(8)
    v_smfmac_f32_16x16x64_bf16 v[12:15], v[64:67], v[104:111], v68
    buffer_load_dwordx4 v[116:119], v69, s[12:15], s20 offen offset:1024 sc1
    v_readfirstlane_b32 s36, v71
    v_cvt_pk_bf16_f32 v112, v112, v113
    v_cvt_pk_bf16_f32 v113, v114, v115
    s_cmp_lt_u32 s36, s37
    s_cbranch_scc1 standalone__deep_cross_pnn__recsys_kernelx_sp2
standalone__deep_cross_pnn__recsys_kernelx_sr2:
    s_add_u32 s37, s37, 512
    ds_write_b64 v70, v[112:113] offset:0
    v_mfma_f32_16x16x32_bf16 v[112:115], v[72:75], v[144:147], 0
    v_mfma_f32_16x16x32_bf16 v[112:115], v[76:79], v[148:151], v[112:115]
    s_waitcnt vmcnt(2)
    v_lshlrev_b32_sdwa v104, 3, v120 dst_sel:DWORD dst_unused:UNUSED_PAD src0_sel:DWORD src1_sel:WORD_0
    v_lshlrev_b32_sdwa v106, 3, v120 dst_sel:DWORD dst_unused:UNUSED_PAD src0_sel:DWORD src1_sel:WORD_1
    ds_read_b64 v[104:105], v104
    ds_read_b64 v[106:107], v106
    v_mfma_f32_16x16x32_bf16 v[112:115], v[80:83], v[152:155], v[112:115]
    v_mfma_f32_16x16x32_bf16 v[112:115], v[84:87], v[156:159], v[112:115]
    v_lshlrev_b32_sdwa v108, 3, v121 dst_sel:DWORD dst_unused:UNUSED_PAD src0_sel:DWORD src1_sel:WORD_0
    v_lshlrev_b32_sdwa v110, 3, v121 dst_sel:DWORD dst_unused:UNUSED_PAD src0_sel:DWORD src1_sel:WORD_1
    ds_read_b64 v[108:109], v108
    ds_read_b64 v[110:111], v110
    s_waitcnt lgkmcnt(9)
    v_smfmac_f32_16x16x64_bf16 v[16:19], v[64:67], v[88:95], v68
    s_nop 1
    v_cvt_pk_bf16_f32 v112, v112, v113
    v_cvt_pk_bf16_f32 v113, v114, v115
    ds_write_b64 v70, v[112:113] offset:128
    v_mfma_f32_16x16x32_bf16 v[112:115], v[72:75], v[160:163], 0
    v_lshlrev_b32_sdwa v88, 3, v122 dst_sel:DWORD dst_unused:UNUSED_PAD src0_sel:DWORD src1_sel:WORD_0
    v_lshlrev_b32_sdwa v90, 3, v122 dst_sel:DWORD dst_unused:UNUSED_PAD src0_sel:DWORD src1_sel:WORD_1
    ds_read_b64 v[88:89], v88
    ds_read_b64 v[90:91], v90
    v_mfma_f32_16x16x32_bf16 v[112:115], v[76:79], v[164:167], v[112:115]
    v_lshlrev_b32_sdwa v92, 3, v123 dst_sel:DWORD dst_unused:UNUSED_PAD src0_sel:DWORD src1_sel:WORD_0
    v_lshlrev_b32_sdwa v94, 3, v123 dst_sel:DWORD dst_unused:UNUSED_PAD src0_sel:DWORD src1_sel:WORD_1
    ds_read_b64 v[92:93], v92
    ds_read_b64 v[94:95], v94
    s_waitcnt lgkmcnt(10)
    v_smfmac_f32_16x16x64_bf16 v[20:23], v[64:67], v[96:103], v68
    buffer_load_dwordx4 v[120:123], v69, s[12:15], s20 offen offset:2048 sc1
    s_setprio 2
    v_mfma_f32_16x16x32_bf16 v[112:115], v[80:83], v[168:171], v[112:115]
    s_waitcnt vmcnt(2)
    v_lshlrev_b32_sdwa v96, 3, v124 dst_sel:DWORD dst_unused:UNUSED_PAD src0_sel:DWORD src1_sel:WORD_0
    v_lshlrev_b32_sdwa v98, 3, v124 dst_sel:DWORD dst_unused:UNUSED_PAD src0_sel:DWORD src1_sel:WORD_1
    ds_read_b64 v[96:97], v96
    ds_read_b64 v[98:99], v98
    v_mfma_f32_16x16x32_bf16 v[112:115], v[84:87], v[172:175], v[112:115]
    v_lshlrev_b32_sdwa v100, 3, v125 dst_sel:DWORD dst_unused:UNUSED_PAD src0_sel:DWORD src1_sel:WORD_0
    v_lshlrev_b32_sdwa v102, 3, v125 dst_sel:DWORD dst_unused:UNUSED_PAD src0_sel:DWORD src1_sel:WORD_1
    ds_read_b64 v[100:101], v100
    ds_read_b64 v[102:103], v102
    s_waitcnt lgkmcnt(9)
    v_smfmac_f32_16x16x64_bf16 v[24:27], v[64:67], v[104:111], v68
    s_nop 1
    v_cvt_pk_bf16_f32 v112, v112, v113
    v_cvt_pk_bf16_f32 v113, v114, v115
    ds_write_b64 v70, v[112:113] offset:256
    v_mfma_f32_16x16x32_bf16 v[112:115], v[72:75], v[176:179], 0
    v_mfma_f32_16x16x32_bf16 v[112:115], v[76:79], v[180:183], v[112:115]
    v_lshlrev_b32_sdwa v104, 3, v126 dst_sel:DWORD dst_unused:UNUSED_PAD src0_sel:DWORD src1_sel:WORD_0
    v_lshlrev_b32_sdwa v106, 3, v126 dst_sel:DWORD dst_unused:UNUSED_PAD src0_sel:DWORD src1_sel:WORD_1
    ds_read_b64 v[104:105], v104
    ds_read_b64 v[106:107], v106
    v_mfma_f32_16x16x32_bf16 v[112:115], v[80:83], v[184:187], v[112:115]
    v_mfma_f32_16x16x32_bf16 v[112:115], v[84:87], v[188:191], v[112:115]
    v_lshlrev_b32_sdwa v108, 3, v127 dst_sel:DWORD dst_unused:UNUSED_PAD src0_sel:DWORD src1_sel:WORD_0
    v_lshlrev_b32_sdwa v110, 3, v127 dst_sel:DWORD dst_unused:UNUSED_PAD src0_sel:DWORD src1_sel:WORD_1
    ds_read_b64 v[108:109], v108
    ds_read_b64 v[110:111], v110
    s_waitcnt lgkmcnt(9) vmcnt(1)
    v_smfmac_f32_16x16x64_bf16 v[28:31], v[64:67], v[88:95], v68
    buffer_load_dwordx4 v[124:127], v69, s[12:15], s20 offen offset:3072 sc1
    s_add_u32 s20, s20, 61440
    v_cvt_pk_bf16_f32 v112, v112, v113
    v_cvt_pk_bf16_f32 v113, v114, v115
    ds_write_b64 v70, v[112:113] offset:384
    v_mfma_f32_16x16x32_bf16 v[112:115], v[72:75], v[192:195], 0
    v_lshlrev_b32_sdwa v88, 3, v116 dst_sel:DWORD dst_unused:UNUSED_PAD src0_sel:DWORD src1_sel:WORD_0
    v_lshlrev_b32_sdwa v90, 3, v116 dst_sel:DWORD dst_unused:UNUSED_PAD src0_sel:DWORD src1_sel:WORD_1
    ds_read_b64 v[88:89], v88
    ds_read_b64 v[90:91], v90
    v_mfma_f32_16x16x32_bf16 v[112:115], v[76:79], v[196:199], v[112:115]
    v_lshlrev_b32_sdwa v92, 3, v117 dst_sel:DWORD dst_unused:UNUSED_PAD src0_sel:DWORD src1_sel:WORD_0
    v_lshlrev_b32_sdwa v94, 3, v117 dst_sel:DWORD dst_unused:UNUSED_PAD src0_sel:DWORD src1_sel:WORD_1
    ds_read_b64 v[92:93], v92
    ds_read_b64 v[94:95], v94
    s_waitcnt lgkmcnt(10)
    v_smfmac_f32_16x16x64_bf16 v[32:35], v[64:67], v[96:103], v68
    v_lshlrev_b32_sdwa v96, 3, v118 dst_sel:DWORD dst_unused:UNUSED_PAD src0_sel:DWORD src1_sel:WORD_0
    v_lshlrev_b32_sdwa v98, 3, v118 dst_sel:DWORD dst_unused:UNUSED_PAD src0_sel:DWORD src1_sel:WORD_1
    v_mfma_f32_16x16x32_bf16 v[112:115], v[80:83], v[200:203], v[112:115]
    ds_read_b64 v[96:97], v96
    ds_read_b64 v[98:99], v98
    v_mfma_f32_16x16x32_bf16 v[112:115], v[84:87], v[204:207], v[112:115]
    v_lshlrev_b32_sdwa v100, 3, v119 dst_sel:DWORD dst_unused:UNUSED_PAD src0_sel:DWORD src1_sel:WORD_0
    v_lshlrev_b32_sdwa v102, 3, v119 dst_sel:DWORD dst_unused:UNUSED_PAD src0_sel:DWORD src1_sel:WORD_1
    buffer_load_dwordx4 v[116:119], v69, s[12:15], s20 offen offset:0 sc1
    ds_read_b64 v[100:101], v100
    ds_read_b64 v[102:103], v102
    s_waitcnt lgkmcnt(9) vmcnt(2)
    v_smfmac_f32_16x16x64_bf16 v[36:39], v[64:67], v[104:111], v68
    s_setprio 1
    v_cvt_pk_bf16_f32 v112, v112, v113
    v_cvt_pk_bf16_f32 v113, v114, v115
    ds_write_b64 v70, v[112:113] offset:512
    v_mfma_f32_16x16x32_bf16 v[112:115], v[72:75], v[208:211], 0
    v_mfma_f32_16x16x32_bf16 v[112:115], v[76:79], v[212:215], v[112:115]
    v_lshlrev_b32_sdwa v104, 3, v120 dst_sel:DWORD dst_unused:UNUSED_PAD src0_sel:DWORD src1_sel:WORD_0
    v_lshlrev_b32_sdwa v106, 3, v120 dst_sel:DWORD dst_unused:UNUSED_PAD src0_sel:DWORD src1_sel:WORD_1
    ds_read_b64 v[104:105], v104
    ds_read_b64 v[106:107], v106
    v_mfma_f32_16x16x32_bf16 v[112:115], v[80:83], v[216:219], v[112:115]
    v_mfma_f32_16x16x32_bf16 v[112:115], v[84:87], v[220:223], v[112:115]
    v_lshlrev_b32_sdwa v108, 3, v121 dst_sel:DWORD dst_unused:UNUSED_PAD src0_sel:DWORD src1_sel:WORD_0
    v_lshlrev_b32_sdwa v110, 3, v121 dst_sel:DWORD dst_unused:UNUSED_PAD src0_sel:DWORD src1_sel:WORD_1
    ds_read_b64 v[108:109], v108
    ds_read_b64 v[110:111], v110
    s_waitcnt lgkmcnt(9)
    v_smfmac_f32_16x16x64_bf16 v[40:43], v[64:67], v[88:95], v68
    v_lshlrev_b32_sdwa v88, 3, v122 dst_sel:DWORD dst_unused:UNUSED_PAD src0_sel:DWORD src1_sel:WORD_0
    v_lshlrev_b32_sdwa v90, 3, v122 dst_sel:DWORD dst_unused:UNUSED_PAD src0_sel:DWORD src1_sel:WORD_1
    v_cvt_pk_bf16_f32 v112, v112, v113
    v_cvt_pk_bf16_f32 v113, v114, v115
    ds_write_b64 v70, v[112:113] offset:640
    v_mfma_f32_16x16x32_bf16 v[112:115], v[72:75], v[224:227], 0
    ds_read_b64 v[88:89], v88
    ds_read_b64 v[90:91], v90
    v_lshlrev_b32_sdwa v92, 3, v123 dst_sel:DWORD dst_unused:UNUSED_PAD src0_sel:DWORD src1_sel:WORD_0
    v_lshlrev_b32_sdwa v94, 3, v123 dst_sel:DWORD dst_unused:UNUSED_PAD src0_sel:DWORD src1_sel:WORD_1
    v_mfma_f32_16x16x32_bf16 v[112:115], v[76:79], v[228:231], v[112:115]
    ds_read_b64 v[92:93], v92
    ds_read_b64 v[94:95], v94
    s_waitcnt lgkmcnt(10)
    v_smfmac_f32_16x16x64_bf16 v[44:47], v[64:67], v[96:103], v68
    buffer_load_dwordx4 v[120:123], v69, s[12:15], s20 offen offset:1024 sc1
    s_waitcnt vmcnt(2)
    v_lshlrev_b32_sdwa v96, 3, v124 dst_sel:DWORD dst_unused:UNUSED_PAD src0_sel:DWORD src1_sel:WORD_0
    v_lshlrev_b32_sdwa v98, 3, v124 dst_sel:DWORD dst_unused:UNUSED_PAD src0_sel:DWORD src1_sel:WORD_1
    v_mfma_f32_16x16x32_bf16 v[112:115], v[80:83], v[232:235], v[112:115]
    ds_read_b64 v[96:97], v96
    ds_read_b64 v[98:99], v98
    v_lshlrev_b32_sdwa v100, 3, v125 dst_sel:DWORD dst_unused:UNUSED_PAD src0_sel:DWORD src1_sel:WORD_0
    v_lshlrev_b32_sdwa v102, 3, v125 dst_sel:DWORD dst_unused:UNUSED_PAD src0_sel:DWORD src1_sel:WORD_1
    v_mfma_f32_16x16x32_bf16 v[112:115], v[84:87], v[236:239], v[112:115]
    ds_read_b64 v[100:101], v100
    ds_read_b64 v[102:103], v102
    s_waitcnt lgkmcnt(9)
    v_smfmac_f32_16x16x64_bf16 v[48:51], v[64:67], v[104:111], v68
    v_lshlrev_b32_sdwa v104, 3, v126 dst_sel:DWORD dst_unused:UNUSED_PAD src0_sel:DWORD src1_sel:WORD_0
    v_lshlrev_b32_sdwa v106, 3, v126 dst_sel:DWORD dst_unused:UNUSED_PAD src0_sel:DWORD src1_sel:WORD_1
    s_nop 1
    v_cvt_pk_bf16_f32 v112, v112, v113
    v_cvt_pk_bf16_f32 v113, v114, v115
    ds_write_b64 v70, v[112:113] offset:768
    v_mfma_f32_16x16x32_bf16 v[112:115], v[72:75], v[240:243], 0
    buffer_load_dwordx4 v[72:75], v69, s[12:15], s21 offen offset:0
    ds_read_b64 v[104:105], v104
    ds_read_b64 v[106:107], v106
    v_lshlrev_b32_sdwa v108, 3, v127 dst_sel:DWORD dst_unused:UNUSED_PAD src0_sel:DWORD src1_sel:WORD_0
    v_lshlrev_b32_sdwa v110, 3, v127 dst_sel:DWORD dst_unused:UNUSED_PAD src0_sel:DWORD src1_sel:WORD_1
    buffer_load_dwordx4 v[124:127], v69, s[12:15], s20 offen offset:2048 sc1
    ds_read_b64 v[108:109], v108
    ds_read_b64 v[110:111], v110
    v_mfma_f32_16x16x32_bf16 v[112:115], v[76:79], v[244:247], v[112:115]
    buffer_load_dwordx4 v[76:79], v69, s[12:15], s21 offen offset:1024
    s_waitcnt lgkmcnt(9)
    v_smfmac_f32_16x16x64_bf16 v[52:55], v[64:67], v[88:95], v68
    s_waitcnt vmcnt(4)
    v_lshlrev_b32_sdwa v88, 3, v116 dst_sel:DWORD dst_unused:UNUSED_PAD src0_sel:DWORD src1_sel:WORD_0
    v_lshlrev_b32_sdwa v90, 3, v116 dst_sel:DWORD dst_unused:UNUSED_PAD src0_sel:DWORD src1_sel:WORD_1
    ds_read_b64 v[88:89], v88
    ds_read_b64 v[90:91], v90
    v_mfma_f32_16x16x32_bf16 v[112:115], v[80:83], v[248:251], v[112:115]
    buffer_load_dwordx4 v[80:83], v69, s[12:15], s19 offen offset:0
    v_lshlrev_b32_sdwa v92, 3, v117 dst_sel:DWORD dst_unused:UNUSED_PAD src0_sel:DWORD src1_sel:WORD_0
    v_lshlrev_b32_sdwa v94, 3, v117 dst_sel:DWORD dst_unused:UNUSED_PAD src0_sel:DWORD src1_sel:WORD_1
    v_mfma_f32_16x16x32_bf16 v[112:115], v[84:87], v[252:255], v[112:115]
    buffer_load_dwordx4 v[84:87], v69, s[12:15], s19 offen offset:1024
    s_add_u32 s21, s21, 4096
    s_add_u32 s19, s19, 4096
    ds_read_b64 v[92:93], v92
    ds_read_b64 v[94:95], v94
    s_nop 2
    v_cvt_pk_bf16_f32 v112, v112, v113
    v_cvt_pk_bf16_f32 v113, v114, v115
    ds_write_b64 v70, v[112:113] offset:896
    ds_append v71 offset:8080
    s_add_u32 s23, s23, s23
    s_cselect_b32 s35, 4294836224, s32
    v_add_u32 v70, s35, v70
    s_waitcnt lgkmcnt(11)
    v_smfmac_f32_16x16x64_bf16 v[56:59], v[64:67], v[96:103], v68
    s_setprio 0
    v_lshlrev_b32_sdwa v96, 3, v118 dst_sel:DWORD dst_unused:UNUSED_PAD src0_sel:DWORD src1_sel:WORD_0
    v_lshlrev_b32_sdwa v98, 3, v118 dst_sel:DWORD dst_unused:UNUSED_PAD src0_sel:DWORD src1_sel:WORD_1
    ds_read_b64 v[96:97], v96
    ds_read_b64 v[98:99], v98
    v_lshlrev_b32_sdwa v100, 3, v119 dst_sel:DWORD dst_unused:UNUSED_PAD src0_sel:DWORD src1_sel:WORD_0
    v_lshlrev_b32_sdwa v102, 3, v119 dst_sel:DWORD dst_unused:UNUSED_PAD src0_sel:DWORD src1_sel:WORD_1
    buffer_load_dwordx4 v[116:119], v69, s[12:15], s20 offen offset:3072 sc1
    s_add_u32 s20, s20, 4096
    ds_read_b64 v[100:101], v100
    ds_read_b64 v[102:103], v102
    s_waitcnt lgkmcnt(10)
    v_smfmac_f32_16x16x64_bf16 v[60:63], v[64:67], v[104:111], v68

    s_branch standalone__deep_cross_pnn__recsys_kernelx_gloop

standalone__deep_cross_pnn__recsys_kernelx_sp0:
    s_sleep 1
    ds_read_addtid_b32 v71 offset:8080
    s_waitcnt lgkmcnt(0)
    v_readfirstlane_b32 s36, v71

    s_cmp_lt_u32 s36, s37
    s_cbranch_scc1 standalone__deep_cross_pnn__recsys_kernelx_sp0
    s_branch standalone__deep_cross_pnn__recsys_kernelx_sr0
standalone__deep_cross_pnn__recsys_kernelx_sp1:
    s_sleep 1
    ds_read_addtid_b32 v71 offset:8080
    s_waitcnt lgkmcnt(0)
    v_readfirstlane_b32 s36, v71

    s_cmp_lt_u32 s36, s37
    s_cbranch_scc1 standalone__deep_cross_pnn__recsys_kernelx_sp1
    s_branch standalone__deep_cross_pnn__recsys_kernelx_sr1
standalone__deep_cross_pnn__recsys_kernelx_sp2:
    s_sleep 1
    ds_read_addtid_b32 v71 offset:8080
    s_waitcnt lgkmcnt(0)
    v_readfirstlane_b32 s36, v71

    s_cmp_lt_u32 s36, s37
    s_cbranch_scc1 standalone__deep_cross_pnn__recsys_kernelx_sp2
    s_branch standalone__deep_cross_pnn__recsys_kernelx_sr2
standalone__deep_cross_pnn__recsys_kernelx_sp3:
    s_sleep 1
    ds_read_addtid_b32 v71 offset:8080
    s_waitcnt lgkmcnt(0)
    v_readfirstlane_b32 s36, v71

    s_cmp_lt_u32 s36, s37
    s_cbranch_scc1 standalone__deep_cross_pnn__recsys_kernelx_sp3
    s_branch standalone__deep_cross_pnn__recsys_kernelx_sr3
standalone__deep_cross_pnn__recsys_kernelx_fin:

    s_add_u32 s40, s20, 61440
    s_add_u32 s41, s20, 65536
    s_add_u32 s44, s20, 126976
    s_add_u32 s45, s20, 131072

    s_lshl_b32 s35, s33, 16
    s_lshl_b32 s42, s34, 15
    s_add_u32 s35, s35, s42
    s_lshl_b32 s42, s3, 12
    s_add_u32 s35, s35, s42
    s_add_u32 s35, s35, 20971520

    v_mov_b32 v128, 0xbdd2d3e8
    v_mov_b32 v129, 0xbdd2d3e8
    v_mov_b32 v130, 0xc0135761
    v_mov_b32 v131, 0xc0135761
    v_mov_b32 v132, 1.0
    v_mov_b32 v133, 1.0
    v_mov_b32 v134, s28
    v_mov_b32 v135, s29
    s_waitcnt vmcnt(6)
    v_lshlrev_b32_sdwa v88, 3, v116 dst_sel:DWORD dst_unused:UNUSED_PAD src0_sel:DWORD src1_sel:WORD_0
    v_lshlrev_b32_sdwa v90, 3, v116 dst_sel:DWORD dst_unused:UNUSED_PAD src0_sel:DWORD src1_sel:WORD_1
    ds_read_b64 v[88:89], v88
    ds_read_b64 v[90:91], v90
    v_lshlrev_b32_sdwa v92, 3, v117 dst_sel:DWORD dst_unused:UNUSED_PAD src0_sel:DWORD src1_sel:WORD_0
    v_lshlrev_b32_sdwa v94, 3, v117 dst_sel:DWORD dst_unused:UNUSED_PAD src0_sel:DWORD src1_sel:WORD_1
    ds_read_b64 v[92:93], v92
    ds_read_b64 v[94:95], v94
    s_waitcnt lgkmcnt(10)
    v_smfmac_f32_16x16x64_bf16 v[0:3], v[64:67], v[96:103], v68
    s_setprio 3
    v_mov_b32 v136, s30
    v_mov_b32 v137, s31
    v_lshrrev_b32 v70, 2, v69
    v_and_b32 v138, 128, v70
    v_add_u32 v70, v70, v138
    v_rcp_f32 v134, v134
    v_rcp_f32 v135, v135
    v_rcp_f32 v136, v136
    v_lshlrev_b32_sdwa v96, 3, v118 dst_sel:DWORD dst_unused:UNUSED_PAD src0_sel:DWORD src1_sel:WORD_0
    v_lshlrev_b32_sdwa v98, 3, v118 dst_sel:DWORD dst_unused:UNUSED_PAD src0_sel:DWORD src1_sel:WORD_1
    ds_read_b64 v[96:97], v96
    ds_read_b64 v[98:99], v98
    v_lshlrev_b32_sdwa v100, 3, v119 dst_sel:DWORD dst_unused:UNUSED_PAD src0_sel:DWORD src1_sel:WORD_0
    v_lshlrev_b32_sdwa v102, 3, v119 dst_sel:DWORD dst_unused:UNUSED_PAD src0_sel:DWORD src1_sel:WORD_1
    ds_read_b64 v[100:101], v100
    ds_read_b64 v[102:103], v102
    buffer_load_dwordx4 v[116:119], v69, s[12:15], s40 offen offset:0 sc1
    s_waitcnt lgkmcnt(8)
    v_smfmac_f32_16x16x64_bf16 v[4:7], v[64:67], v[104:111], v68
    v_rcp_f32 v137, v137
    v_mov_b32 v132, 0x7f7fffff
    v_mov_b32 v133, 0xff7fffff
    v_med3_f32 v134, v134, v132, v133
    v_med3_f32 v135, v135, v132, v133
    v_med3_f32 v136, v136, v132, v133
    v_med3_f32 v137, v137, v132, v133
    s_waitcnt vmcnt(5)
    v_lshlrev_b32_sdwa v104, 3, v120 dst_sel:DWORD dst_unused:UNUSED_PAD src0_sel:DWORD src1_sel:WORD_0
    v_lshlrev_b32_sdwa v106, 3, v120 dst_sel:DWORD dst_unused:UNUSED_PAD src0_sel:DWORD src1_sel:WORD_1
    ds_read_b64 v[104:105], v104
    ds_read_b64 v[106:107], v106
    v_lshlrev_b32_sdwa v108, 3, v121 dst_sel:DWORD dst_unused:UNUSED_PAD src0_sel:DWORD src1_sel:WORD_0
    v_lshlrev_b32_sdwa v110, 3, v121 dst_sel:DWORD dst_unused:UNUSED_PAD src0_sel:DWORD src1_sel:WORD_1
    ds_read_b64 v[108:109], v108
    ds_read_b64 v[110:111], v110
    s_waitcnt lgkmcnt(8)
    v_smfmac_f32_16x16x64_bf16 v[8:11], v[64:67], v[88:95], v68
    v_lshlrev_b32_sdwa v88, 3, v122 dst_sel:DWORD dst_unused:UNUSED_PAD src0_sel:DWORD src1_sel:WORD_0
    v_lshlrev_b32_sdwa v90, 3, v122 dst_sel:DWORD dst_unused:UNUSED_PAD src0_sel:DWORD src1_sel:WORD_1
    ds_read_b64 v[88:89], v88
    ds_read_b64 v[90:91], v90
    ds_read_addtid_b32 v71 offset:8080
    v_lshlrev_b32_sdwa v92, 3, v123 dst_sel:DWORD dst_unused:UNUSED_PAD src0_sel:DWORD src1_sel:WORD_0
    v_lshlrev_b32_sdwa v94, 3, v123 dst_sel:DWORD dst_unused:UNUSED_PAD src0_sel:DWORD src1_sel:WORD_1
    ds_read_b64 v[92:93], v92
    ds_read_b64 v[94:95], v94
    buffer_load_dwordx4 v[120:123], v69, s[12:15], s44 offen offset:0 sc1
    s_waitcnt lgkmcnt(9)
    v_smfmac_f32_16x16x64_bf16 v[12:15], v[64:67], v[96:103], v68
    s_waitcnt vmcnt(2)
    v_lshlrev_b32_sdwa v96, 3, v124 dst_sel:DWORD dst_unused:UNUSED_PAD src0_sel:DWORD src1_sel:WORD_0
    v_lshlrev_b32_sdwa v98, 3, v124 dst_sel:DWORD dst_unused:UNUSED_PAD src0_sel:DWORD src1_sel:WORD_1
    ds_read_b64 v[96:97], v96
    ds_read_b64 v[98:99], v98
    v_lshlrev_b32_sdwa v100, 3, v125 dst_sel:DWORD dst_unused:UNUSED_PAD src0_sel:DWORD src1_sel:WORD_0
    v_lshlrev_b32_sdwa v102, 3, v125 dst_sel:DWORD dst_unused:UNUSED_PAD src0_sel:DWORD src1_sel:WORD_1
    ds_read_b64 v[100:101], v100
    ds_read_b64 v[102:103], v102
    s_waitcnt lgkmcnt(9)
    v_smfmac_f32_16x16x64_bf16 v[16:19], v[64:67], v[104:111], v68
    v_lshlrev_b32_sdwa v104, 3, v126 dst_sel:DWORD dst_unused:UNUSED_PAD src0_sel:DWORD src1_sel:WORD_0
    v_lshlrev_b32_sdwa v106, 3, v126 dst_sel:DWORD dst_unused:UNUSED_PAD src0_sel:DWORD src1_sel:WORD_1
    ds_read_b64 v[104:105], v104
    ds_read_b64 v[106:107], v106
    v_lshlrev_b32_sdwa v108, 3, v127 dst_sel:DWORD dst_unused:UNUSED_PAD src0_sel:DWORD src1_sel:WORD_0
    v_lshlrev_b32_sdwa v110, 3, v127 dst_sel:DWORD dst_unused:UNUSED_PAD src0_sel:DWORD src1_sel:WORD_1
    ds_read_b64 v[108:109], v108
    ds_read_b64 v[110:111], v110
    buffer_load_dwordx4 v[124:127], v69, s[12:15], s40 offen offset:1024 sc1
    s_waitcnt lgkmcnt(8)
    v_smfmac_f32_16x16x64_bf16 v[20:23], v[64:67], v[88:95], v68
    v_readfirstlane_b32 s36, v71
    s_waitcnt vmcnt(2)
    s_cmp_lt_u32 s36, s37
    s_cbranch_scc1 standalone__deep_cross_pnn__recsys_kernelx_sp3
standalone__deep_cross_pnn__recsys_kernelx_sr3:
    v_lshlrev_b32_sdwa v88, 3, v116 dst_sel:DWORD dst_unused:UNUSED_PAD src0_sel:DWORD src1_sel:WORD_0
    v_lshlrev_b32_sdwa v90, 3, v116 dst_sel:DWORD dst_unused:UNUSED_PAD src0_sel:DWORD src1_sel:WORD_1
    ds_read_b64 v[88:89], v88
    ds_read_b64 v[90:91], v90
    v_lshlrev_b32_sdwa v92, 3, v117 dst_sel:DWORD dst_unused:UNUSED_PAD src0_sel:DWORD src1_sel:WORD_0
    v_lshlrev_b32_sdwa v94, 3, v117 dst_sel:DWORD dst_unused:UNUSED_PAD src0_sel:DWORD src1_sel:WORD_1
    ds_read_b64 v[92:93], v92
    ds_read_b64 v[94:95], v94
    s_waitcnt lgkmcnt(8)
    v_smfmac_f32_16x16x64_bf16 v[24:27], v[64:67], v[96:103], v68
    v_lshlrev_b32_sdwa v96, 3, v118 dst_sel:DWORD dst_unused:UNUSED_PAD src0_sel:DWORD src1_sel:WORD_0
    v_lshlrev_b32_sdwa v98, 3, v118 dst_sel:DWORD dst_unused:UNUSED_PAD src0_sel:DWORD src1_sel:WORD_1
    ds_read_b64 v[96:97], v96
    ds_read_b64 v[98:99], v98
    v_lshlrev_b32_sdwa v100, 3, v119 dst_sel:DWORD dst_unused:UNUSED_PAD src0_sel:DWORD src1_sel:WORD_0
    v_lshlrev_b32_sdwa v102, 3, v119 dst_sel:DWORD dst_unused:UNUSED_PAD src0_sel:DWORD src1_sel:WORD_1
    ds_read_b64 v[100:101], v100
    ds_read_b64 v[102:103], v102
    buffer_load_dwordx4 v[116:119], v69, s[12:15], s44 offen offset:1024 sc1
    s_waitcnt lgkmcnt(8)
    v_smfmac_f32_16x16x64_bf16 v[28:31], v[64:67], v[104:111], v68
    s_waitcnt vmcnt(2)
    v_lshlrev_b32_sdwa v104, 3, v120 dst_sel:DWORD dst_unused:UNUSED_PAD src0_sel:DWORD src1_sel:WORD_0
    v_lshlrev_b32_sdwa v106, 3, v120 dst_sel:DWORD dst_unused:UNUSED_PAD src0_sel:DWORD src1_sel:WORD_1
    ds_read_b64 v[104:105], v104
    ds_read_b64 v[106:107], v106
    v_lshlrev_b32_sdwa v108, 3, v121 dst_sel:DWORD dst_unused:UNUSED_PAD src0_sel:DWORD src1_sel:WORD_0
    v_lshlrev_b32_sdwa v110, 3, v121 dst_sel:DWORD dst_unused:UNUSED_PAD src0_sel:DWORD src1_sel:WORD_1
    ds_read_b64 v[108:109], v108
    ds_read_b64 v[110:111], v110
    s_waitcnt lgkmcnt(8)
    v_smfmac_f32_16x16x64_bf16 v[0:3], v[64:67], v[88:95], v68
    v_lshlrev_b32_sdwa v88, 3, v122 dst_sel:DWORD dst_unused:UNUSED_PAD src0_sel:DWORD src1_sel:WORD_0
    v_lshlrev_b32_sdwa v90, 3, v122 dst_sel:DWORD dst_unused:UNUSED_PAD src0_sel:DWORD src1_sel:WORD_1
    ds_read_b64 v[88:89], v88
    ds_read_b64 v[90:91], v90
    v_lshlrev_b32_sdwa v92, 3, v123 dst_sel:DWORD dst_unused:UNUSED_PAD src0_sel:DWORD src1_sel:WORD_0
    v_lshlrev_b32_sdwa v94, 3, v123 dst_sel:DWORD dst_unused:UNUSED_PAD src0_sel:DWORD src1_sel:WORD_1
    ds_read_b64 v[92:93], v92
    ds_read_b64 v[94:95], v94
    buffer_load_dwordx4 v[120:123], v69, s[12:15], s40 offen offset:2048 sc1
    s_waitcnt lgkmcnt(8)
    v_smfmac_f32_16x16x64_bf16 v[4:7], v[64:67], v[96:103], v68
    s_waitcnt vmcnt(2)
    v_lshlrev_b32_sdwa v96, 3, v124 dst_sel:DWORD dst_unused:UNUSED_PAD src0_sel:DWORD src1_sel:WORD_0
    v_lshlrev_b32_sdwa v98, 3, v124 dst_sel:DWORD dst_unused:UNUSED_PAD src0_sel:DWORD src1_sel:WORD_1
    ds_read_b64 v[96:97], v96
    ds_read_b64 v[98:99], v98
    v_lshlrev_b32_sdwa v100, 3, v125 dst_sel:DWORD dst_unused:UNUSED_PAD src0_sel:DWORD src1_sel:WORD_0
    v_lshlrev_b32_sdwa v102, 3, v125 dst_sel:DWORD dst_unused:UNUSED_PAD src0_sel:DWORD src1_sel:WORD_1
    ds_read_b64 v[100:101], v100
    ds_read_b64 v[102:103], v102
    s_waitcnt lgkmcnt(8)
    v_smfmac_f32_16x16x64_bf16 v[0:3], v[64:67], v[104:111], v68
    v_lshlrev_b32_sdwa v104, 3, v126 dst_sel:DWORD dst_unused:UNUSED_PAD src0_sel:DWORD src1_sel:WORD_0
    v_lshlrev_b32_sdwa v106, 3, v126 dst_sel:DWORD dst_unused:UNUSED_PAD src0_sel:DWORD src1_sel:WORD_1
    ds_read_b64 v[104:105], v104
    ds_read_b64 v[106:107], v106
    v_lshlrev_b32_sdwa v108, 3, v127 dst_sel:DWORD dst_unused:UNUSED_PAD src0_sel:DWORD src1_sel:WORD_0
    v_lshlrev_b32_sdwa v110, 3, v127 dst_sel:DWORD dst_unused:UNUSED_PAD src0_sel:DWORD src1_sel:WORD_1
    ds_read_b64 v[108:109], v108
    ds_read_b64 v[110:111], v110
    buffer_load_dwordx4 v[124:127], v69, s[12:15], s44 offen offset:2048 sc1
    s_waitcnt lgkmcnt(8)
    v_smfmac_f32_16x16x64_bf16 v[4:7], v[64:67], v[88:95], v68
    s_waitcnt vmcnt(2)
    v_lshlrev_b32_sdwa v88, 3, v116 dst_sel:DWORD dst_unused:UNUSED_PAD src0_sel:DWORD src1_sel:WORD_0
    v_lshlrev_b32_sdwa v90, 3, v116 dst_sel:DWORD dst_unused:UNUSED_PAD src0_sel:DWORD src1_sel:WORD_1
    ds_read_b64 v[88:89], v88
    ds_read_b64 v[90:91], v90
    v_lshlrev_b32_sdwa v92, 3, v117 dst_sel:DWORD dst_unused:UNUSED_PAD src0_sel:DWORD src1_sel:WORD_0
    v_lshlrev_b32_sdwa v94, 3, v117 dst_sel:DWORD dst_unused:UNUSED_PAD src0_sel:DWORD src1_sel:WORD_1
    ds_read_b64 v[92:93], v92
    ds_read_b64 v[94:95], v94
    s_waitcnt lgkmcnt(8)
    v_smfmac_f32_16x16x64_bf16 v[8:11], v[64:67], v[96:103], v68
    v_pk_mul_f32 v[140:141], v[0:1], v[0:1]
    v_pk_mul_f32 v[142:143], v[2:3], v[2:3]
    v_pk_fma_f32 v[140:141], v[140:141], v[128:129], v[130:131]
    v_pk_fma_f32 v[142:143], v[142:143], v[128:129], v[130:131]
    v_pk_mul_f32 v[140:141], v[140:141], v[0:1]
    v_pk_mul_f32 v[142:143], v[142:143], v[2:3]
    v_exp_f32 v140, v140
    v_pk_mul_f32 v[146:147], v[4:5], v[4:5]
    v_lshlrev_b32_sdwa v96, 3, v118 dst_sel:DWORD dst_unused:UNUSED_PAD src0_sel:DWORD src1_sel:WORD_0
    v_lshlrev_b32_sdwa v98, 3, v118 dst_sel:DWORD dst_unused:UNUSED_PAD src0_sel:DWORD src1_sel:WORD_1
    ds_read_b64 v[96:97], v96
    ds_read_b64 v[98:99], v98
    v_lshlrev_b32_sdwa v100, 3, v119 dst_sel:DWORD dst_unused:UNUSED_PAD src0_sel:DWORD src1_sel:WORD_0
    v_lshlrev_b32_sdwa v102, 3, v119 dst_sel:DWORD dst_unused:UNUSED_PAD src0_sel:DWORD src1_sel:WORD_1
    ds_read_b64 v[100:101], v100
    ds_read_b64 v[102:103], v102
    buffer_load_dwordx4 v[116:119], v69, s[12:15], s40 offen offset:3072 sc1
    s_waitcnt lgkmcnt(8)
    v_smfmac_f32_16x16x64_bf16 v[12:15], v[64:67], v[104:111], v68
    v_exp_f32 v141, v141
    v_pk_fma_f32 v[146:147], v[146:147], v[128:129], v[130:131]
    v_pk_mul_f32 v[148:149], v[6:7], v[6:7]
    v_exp_f32 v142, v142
    v_pk_fma_f32 v[140:141], v[140:141], v[134:135], v[134:135]
    v_pk_mul_f32 v[146:147], v[146:147], v[4:5]
    v_rcp_f32 v140, v140
    v_pk_fma_f32 v[148:149], v[148:149], v[128:129], v[130:131]
    s_waitcnt vmcnt(2)
    v_lshlrev_b32_sdwa v104, 3, v120 dst_sel:DWORD dst_unused:UNUSED_PAD src0_sel:DWORD src1_sel:WORD_0
    v_lshlrev_b32_sdwa v106, 3, v120 dst_sel:DWORD dst_unused:UNUSED_PAD src0_sel:DWORD src1_sel:WORD_1
    ds_read_b64 v[104:105], v104
    ds_read_b64 v[106:107], v106
    v_lshlrev_b32_sdwa v108, 3, v121 dst_sel:DWORD dst_unused:UNUSED_PAD src0_sel:DWORD src1_sel:WORD_0
    v_lshlrev_b32_sdwa v110, 3, v121 dst_sel:DWORD dst_unused:UNUSED_PAD src0_sel:DWORD src1_sel:WORD_1
    ds_read_b64 v[108:109], v108
    ds_read_b64 v[110:111], v110
    s_waitcnt lgkmcnt(8)
    v_smfmac_f32_16x16x64_bf16 v[8:11], v[64:67], v[88:95], v68
    v_rcp_f32 v141, v141
    v_pk_mul_f32 v[148:149], v[148:149], v[6:7]
    v_exp_f32 v143, v143
    v_pk_mul_f32 v[144:145], v[0:1], v[140:141]
    v_exp_f32 v146, v146
    v_pk_fma_f32 v[142:143], v[142:143], v[136:137], v[136:137]
    v_exp_f32 v147, v147
    v_rcp_f32 v142, v142
    v_lshlrev_b32_sdwa v88, 3, v122 dst_sel:DWORD dst_unused:UNUSED_PAD src0_sel:DWORD src1_sel:WORD_0
    v_lshlrev_b32_sdwa v90, 3, v122 dst_sel:DWORD dst_unused:UNUSED_PAD src0_sel:DWORD src1_sel:WORD_1
    ds_read_b64 v[88:89], v88
    ds_read_b64 v[90:91], v90
    v_lshlrev_b32_sdwa v92, 3, v123 dst_sel:DWORD dst_unused:UNUSED_PAD src0_sel:DWORD src1_sel:WORD_0
    v_lshlrev_b32_sdwa v94, 3, v123 dst_sel:DWORD dst_unused:UNUSED_PAD src0_sel:DWORD src1_sel:WORD_1
    ds_read_b64 v[92:93], v92
    ds_read_b64 v[94:95], v94
    buffer_load_dwordx4 v[120:123], v69, s[12:15], s44 offen offset:3072 sc1
    s_waitcnt lgkmcnt(8)
    v_smfmac_f32_16x16x64_bf16 v[12:15], v[64:67], v[96:103], v68
    v_rcp_f32 v143, v143
    v_pk_fma_f32 v[146:147], v[146:147], v[134:135], v[134:135]
    v_pk_mul_f32 v[152:153], v[8:9], v[8:9]
    v_rcp_f32 v146, v146
    v_pk_fma_f32 v[144:145], v[2:3], v[142:143], v[144:145]
    v_pk_fma_f32 v[152:153], v[152:153], v[128:129], v[130:131]
    v_rcp_f32 v147, v147
    v_add_f32 v144, v144, v145
    s_waitcnt vmcnt(2)
    v_lshlrev_b32_sdwa v96, 3, v124 dst_sel:DWORD dst_unused:UNUSED_PAD src0_sel:DWORD src1_sel:WORD_0
    v_lshlrev_b32_sdwa v98, 3, v124 dst_sel:DWORD dst_unused:UNUSED_PAD src0_sel:DWORD src1_sel:WORD_1
    ds_read_b64 v[96:97], v96
    ds_read_b64 v[98:99], v98
    v_lshlrev_b32_sdwa v100, 3, v125 dst_sel:DWORD dst_unused:UNUSED_PAD src0_sel:DWORD src1_sel:WORD_0
    v_lshlrev_b32_sdwa v102, 3, v125 dst_sel:DWORD dst_unused:UNUSED_PAD src0_sel:DWORD src1_sel:WORD_1
    ds_read_b64 v[100:101], v100
    ds_read_b64 v[102:103], v102
    s_waitcnt lgkmcnt(8)
    v_smfmac_f32_16x16x64_bf16 v[16:19], v[64:67], v[104:111], v68
    v_exp_f32 v148, v148
    buffer_store_dword v144, v70, s[12:15], s35 offen offset:0 sc1
    v_pk_mul_f32 v[150:151], v[4:5], v[146:147]
    v_exp_f32 v149, v149
    v_pk_mul_f32 v[152:153], v[152:153], v[8:9]
    v_pk_mul_f32 v[154:155], v[10:11], v[10:11]
    v_exp_f32 v152, v152
    v_pk_fma_f32 v[148:149], v[148:149], v[136:137], v[136:137]
    v_lshlrev_b32_sdwa v104, 3, v126 dst_sel:DWORD dst_unused:UNUSED_PAD src0_sel:DWORD src1_sel:WORD_0
    v_lshlrev_b32_sdwa v106, 3, v126 dst_sel:DWORD dst_unused:UNUSED_PAD src0_sel:DWORD src1_sel:WORD_1
    ds_read_b64 v[104:105], v104
    ds_read_b64 v[106:107], v106
    v_lshlrev_b32_sdwa v108, 3, v127 dst_sel:DWORD dst_unused:UNUSED_PAD src0_sel:DWORD src1_sel:WORD_0
    v_lshlrev_b32_sdwa v110, 3, v127 dst_sel:DWORD dst_unused:UNUSED_PAD src0_sel:DWORD src1_sel:WORD_1
    ds_read_b64 v[108:109], v108
    ds_read_b64 v[110:111], v110
    buffer_load_dwordx4 v[124:127], v69, s[12:15], s20 offen offset:0 sc1
    s_waitcnt lgkmcnt(8)
    v_smfmac_f32_16x16x64_bf16 v[20:23], v[64:67], v[88:95], v68
    v_rcp_f32 v148, v148
    v_pk_fma_f32 v[154:155], v[154:155], v[128:129], v[130:131]
    v_pk_mul_f32 v[158:159], v[12:13], v[12:13]
    v_rcp_f32 v149, v149
    v_pk_mul_f32 v[154:155], v[154:155], v[10:11]
    v_pk_fma_f32 v[158:159], v[158:159], v[128:129], v[130:131]
    v_exp_f32 v153, v153
    v_pk_fma_f32 v[150:151], v[6:7], v[148:149], v[150:151]
    s_waitcnt vmcnt(3)
    v_lshlrev_b32_sdwa v88, 3, v116 dst_sel:DWORD dst_unused:UNUSED_PAD src0_sel:DWORD src1_sel:WORD_0
    v_lshlrev_b32_sdwa v90, 3, v116 dst_sel:DWORD dst_unused:UNUSED_PAD src0_sel:DWORD src1_sel:WORD_1
    ds_read_b64 v[88:89], v88
    ds_read_b64 v[90:91], v90
    v_lshlrev_b32_sdwa v92, 3, v117 dst_sel:DWORD dst_unused:UNUSED_PAD src0_sel:DWORD src1_sel:WORD_0
    v_lshlrev_b32_sdwa v94, 3, v117 dst_sel:DWORD dst_unused:UNUSED_PAD src0_sel:DWORD src1_sel:WORD_1
    ds_read_b64 v[92:93], v92
    ds_read_b64 v[94:95], v94
    s_waitcnt lgkmcnt(8)
    v_smfmac_f32_16x16x64_bf16 v[16:19], v[64:67], v[96:103], v68
    v_exp_f32 v154, v154
    v_add_f32 v150, v150, v151
    v_pk_fma_f32 v[152:153], v[152:153], v[134:135], v[134:135]
    v_exp_f32 v155, v155
    buffer_store_dword v150, v70, s[12:15], s35 offen offset:128 sc1
    v_pk_mul_f32 v[158:159], v[158:159], v[12:13]
    v_rcp_f32 v152, v152
    v_pk_fma_f32 v[154:155], v[154:155], v[136:137], v[136:137]
    v_lshlrev_b32_sdwa v96, 3, v118 dst_sel:DWORD dst_unused:UNUSED_PAD src0_sel:DWORD src1_sel:WORD_0
    v_lshlrev_b32_sdwa v98, 3, v118 dst_sel:DWORD dst_unused:UNUSED_PAD src0_sel:DWORD src1_sel:WORD_1
    ds_read_b64 v[96:97], v96
    ds_read_b64 v[98:99], v98
    v_lshlrev_b32_sdwa v100, 3, v119 dst_sel:DWORD dst_unused:UNUSED_PAD src0_sel:DWORD src1_sel:WORD_0
    v_lshlrev_b32_sdwa v102, 3, v119 dst_sel:DWORD dst_unused:UNUSED_PAD src0_sel:DWORD src1_sel:WORD_1
    ds_read_b64 v[100:101], v100
    ds_read_b64 v[102:103], v102
    buffer_load_dwordx4 v[116:119], v69, s[12:15], s41 offen offset:0 sc1
    s_waitcnt lgkmcnt(8)
    v_smfmac_f32_16x16x64_bf16 v[20:23], v[64:67], v[104:111], v68
    v_rcp_f32 v153, v153
    v_pk_mul_f32 v[160:161], v[14:15], v[14:15]
    v_pk_mul_f32 v[164:165], v[16:17], v[16:17]
    v_rcp_f32 v154, v154
    v_pk_mul_f32 v[156:157], v[8:9], v[152:153]
    v_pk_fma_f32 v[160:161], v[160:161], v[128:129], v[130:131]
    v_rcp_f32 v155, v155
    v_pk_mul_f32 v[160:161], v[160:161], v[14:15]
    s_waitcnt vmcnt(4)
    v_lshlrev_b32_sdwa v104, 3, v120 dst_sel:DWORD dst_unused:UNUSED_PAD src0_sel:DWORD src1_sel:WORD_0
    v_lshlrev_b32_sdwa v106, 3, v120 dst_sel:DWORD dst_unused:UNUSED_PAD src0_sel:DWORD src1_sel:WORD_1
    ds_read_b64 v[104:105], v104
    ds_read_b64 v[106:107], v106
    v_lshlrev_b32_sdwa v108, 3, v121 dst_sel:DWORD dst_unused:UNUSED_PAD src0_sel:DWORD src1_sel:WORD_0
    v_lshlrev_b32_sdwa v110, 3, v121 dst_sel:DWORD dst_unused:UNUSED_PAD src0_sel:DWORD src1_sel:WORD_1
    ds_read_b64 v[108:109], v108
    ds_read_b64 v[110:111], v110
    s_waitcnt lgkmcnt(8)
    v_smfmac_f32_16x16x64_bf16 v[24:27], v[64:67], v[88:95], v68
    v_exp_f32 v158, v158
    v_pk_fma_f32 v[156:157], v[10:11], v[154:155], v[156:157]
    v_pk_fma_f32 v[164:165], v[164:165], v[128:129], v[130:131]
    v_exp_f32 v159, v159
    v_add_f32 v156, v156, v157
    v_pk_mul_f32 v[164:165], v[164:165], v[16:17]
    v_exp_f32 v160, v160
    buffer_store_dword v156, v70, s[12:15], s35 offen offset:512 sc1
    v_lshlrev_b32_sdwa v88, 3, v122 dst_sel:DWORD dst_unused:UNUSED_PAD src0_sel:DWORD src1_sel:WORD_0
    v_lshlrev_b32_sdwa v90, 3, v122 dst_sel:DWORD dst_unused:UNUSED_PAD src0_sel:DWORD src1_sel:WORD_1
    ds_read_b64 v[88:89], v88
    ds_read_b64 v[90:91], v90
    v_lshlrev_b32_sdwa v92, 3, v123 dst_sel:DWORD dst_unused:UNUSED_PAD src0_sel:DWORD src1_sel:WORD_0
    v_lshlrev_b32_sdwa v94, 3, v123 dst_sel:DWORD dst_unused:UNUSED_PAD src0_sel:DWORD src1_sel:WORD_1
    ds_read_b64 v[92:93], v92
    ds_read_b64 v[94:95], v94
    buffer_load_dwordx4 v[120:123], v69, s[12:15], s45 offen offset:0 sc1
    s_waitcnt lgkmcnt(8)
    v_smfmac_f32_16x16x64_bf16 v[28:31], v[64:67], v[96:103], v68
    v_exp_f32 v161, v161
    v_pk_fma_f32 v[158:159], v[158:159], v[134:135], v[134:135]
    v_pk_mul_f32 v[166:167], v[18:19], v[18:19]
    v_rcp_f32 v158, v158
    v_pk_fma_f32 v[160:161], v[160:161], v[136:137], v[136:137]
    v_pk_fma_f32 v[166:167], v[166:167], v[128:129], v[130:131]
    v_rcp_f32 v159, v159
    v_pk_mul_f32 v[166:167], v[166:167], v[18:19]
    s_waitcnt vmcnt(4)
    v_lshlrev_b32_sdwa v96, 3, v124 dst_sel:DWORD dst_unused:UNUSED_PAD src0_sel:DWORD src1_sel:WORD_0
    v_lshlrev_b32_sdwa v98, 3, v124 dst_sel:DWORD dst_unused:UNUSED_PAD src0_sel:DWORD src1_sel:WORD_1
    ds_read_b64 v[96:97], v96
    ds_read_b64 v[98:99], v98
    v_lshlrev_b32_sdwa v100, 3, v125 dst_sel:DWORD dst_unused:UNUSED_PAD src0_sel:DWORD src1_sel:WORD_0
    v_lshlrev_b32_sdwa v102, 3, v125 dst_sel:DWORD dst_unused:UNUSED_PAD src0_sel:DWORD src1_sel:WORD_1
    ds_read_b64 v[100:101], v100
    ds_read_b64 v[102:103], v102
    s_waitcnt lgkmcnt(8)
    v_smfmac_f32_16x16x64_bf16 v[24:27], v[64:67], v[104:111], v68
    v_rcp_f32 v160, v160
    v_pk_mul_f32 v[162:163], v[12:13], v[158:159]
    v_pk_mul_f32 v[170:171], v[20:21], v[20:21]
    v_rcp_f32 v161, v161
    v_pk_fma_f32 v[170:171], v[170:171], v[128:129], v[130:131]
    v_pk_mul_f32 v[172:173], v[22:23], v[22:23]
    v_exp_f32 v164, v164
    v_pk_fma_f32 v[162:163], v[14:15], v[160:161], v[162:163]
    v_lshlrev_b32_sdwa v104, 3, v126 dst_sel:DWORD dst_unused:UNUSED_PAD src0_sel:DWORD src1_sel:WORD_0
    v_lshlrev_b32_sdwa v106, 3, v126 dst_sel:DWORD dst_unused:UNUSED_PAD src0_sel:DWORD src1_sel:WORD_1
    ds_read_b64 v[104:105], v104
    ds_read_b64 v[106:107], v106
    v_lshlrev_b32_sdwa v108, 3, v127 dst_sel:DWORD dst_unused:UNUSED_PAD src0_sel:DWORD src1_sel:WORD_0
    v_lshlrev_b32_sdwa v110, 3, v127 dst_sel:DWORD dst_unused:UNUSED_PAD src0_sel:DWORD src1_sel:WORD_1
    ds_read_b64 v[108:109], v108
    ds_read_b64 v[110:111], v110
    buffer_load_dwordx4 v[124:127], v69, s[12:15], s20 offen offset:1024 sc1
    s_waitcnt lgkmcnt(8)
    v_smfmac_f32_16x16x64_bf16 v[28:31], v[64:67], v[88:95], v68
    s_setprio 2
    v_exp_f32 v165, v165
    v_add_f32 v162, v162, v163
    v_pk_mul_f32 v[170:171], v[170:171], v[20:21]
    v_exp_f32 v166, v166
    buffer_store_dword v162, v70, s[12:15], s35 offen offset:640 sc1
    v_pk_fma_f32 v[164:165], v[164:165], v[134:135], v[134:135]
    v_exp_f32 v167, v167
    v_pk_fma_f32 v[172:173], v[172:173], v[128:129], v[130:131]
    s_waitcnt vmcnt(4)
    v_lshlrev_b32_sdwa v88, 3, v116 dst_sel:DWORD dst_unused:UNUSED_PAD src0_sel:DWORD src1_sel:WORD_0
    v_lshlrev_b32_sdwa v90, 3, v116 dst_sel:DWORD dst_unused:UNUSED_PAD src0_sel:DWORD src1_sel:WORD_1
    ds_read_b64 v[88:89], v88
    ds_read_b64 v[90:91], v90
    v_lshlrev_b32_sdwa v92, 3, v117 dst_sel:DWORD dst_unused:UNUSED_PAD src0_sel:DWORD src1_sel:WORD_0
    v_lshlrev_b32_sdwa v94, 3, v117 dst_sel:DWORD dst_unused:UNUSED_PAD src0_sel:DWORD src1_sel:WORD_1
    ds_read_b64 v[92:93], v92
    ds_read_b64 v[94:95], v94
    s_waitcnt lgkmcnt(8)
    v_smfmac_f32_16x16x64_bf16 v[32:35], v[64:67], v[96:103], v68
    v_rcp_f32 v164, v164
    v_pk_fma_f32 v[166:167], v[166:167], v[136:137], v[136:137]
    v_pk_mul_f32 v[172:173], v[172:173], v[22:23]
    v_rcp_f32 v165, v165
    v_pk_mul_f32 v[140:141], v[24:25], v[24:25]
    v_pk_mul_f32 v[142:143], v[26:27], v[26:27]
    v_rcp_f32 v166, v166
    v_pk_mul_f32 v[168:169], v[16:17], v[164:165]
    v_lshlrev_b32_sdwa v96, 3, v118 dst_sel:DWORD dst_unused:UNUSED_PAD src0_sel:DWORD src1_sel:WORD_0
    v_lshlrev_b32_sdwa v98, 3, v118 dst_sel:DWORD dst_unused:UNUSED_PAD src0_sel:DWORD src1_sel:WORD_1
    ds_read_b64 v[96:97], v96
    ds_read_b64 v[98:99], v98
    v_lshlrev_b32_sdwa v100, 3, v119 dst_sel:DWORD dst_unused:UNUSED_PAD src0_sel:DWORD src1_sel:WORD_0
    v_lshlrev_b32_sdwa v102, 3, v119 dst_sel:DWORD dst_unused:UNUSED_PAD src0_sel:DWORD src1_sel:WORD_1
    ds_read_b64 v[100:101], v100
    ds_read_b64 v[102:103], v102
    buffer_load_dwordx4 v[116:119], v69, s[12:15], s41 offen offset:1024 sc1
    s_waitcnt lgkmcnt(8)
    v_smfmac_f32_16x16x64_bf16 v[36:39], v[64:67], v[104:111], v68
    v_rcp_f32 v167, v167
    v_pk_fma_f32 v[140:141], v[140:141], v[128:129], v[130:131]
    v_pk_fma_f32 v[142:143], v[142:143], v[128:129], v[130:131]
    v_exp_f32 v170, v170
    v_pk_fma_f32 v[168:169], v[18:19], v[166:167], v[168:169]
    v_pk_mul_f32 v[140:141], v[140:141], v[24:25]
    v_exp_f32 v171, v171
    v_add_f32 v168, v168, v169
    s_waitcnt vmcnt(3)
    v_lshlrev_b32_sdwa v104, 3, v120 dst_sel:DWORD dst_unused:UNUSED_PAD src0_sel:DWORD src1_sel:WORD_0
    v_lshlrev_b32_sdwa v106, 3, v120 dst_sel:DWORD dst_unused:UNUSED_PAD src0_sel:DWORD src1_sel:WORD_1
    ds_read_b64 v[104:105], v104
    ds_read_b64 v[106:107], v106
    v_lshlrev_b32_sdwa v108, 3, v121 dst_sel:DWORD dst_unused:UNUSED_PAD src0_sel:DWORD src1_sel:WORD_0
    v_lshlrev_b32_sdwa v110, 3, v121 dst_sel:DWORD dst_unused:UNUSED_PAD src0_sel:DWORD src1_sel:WORD_1
    ds_read_b64 v[108:109], v108
    ds_read_b64 v[110:111], v110
    s_waitcnt lgkmcnt(8)
    v_smfmac_f32_16x16x64_bf16 v[32:35], v[64:67], v[88:95], v68
    v_exp_f32 v172, v172
    buffer_store_dword v168, v70, s[12:15], s35 offen offset:1024 sc1
    v_pk_fma_f32 v[170:171], v[170:171], v[134:135], v[134:135]
    v_exp_f32 v173, v173
    v_pk_mul_f32 v[142:143], v[142:143], v[26:27]
    v_pk_mul_f32 v[146:147], v[28:29], v[28:29]
    v_rcp_f32 v170, v170
    v_pk_fma_f32 v[172:173], v[172:173], v[136:137], v[136:137]
    v_lshlrev_b32_sdwa v88, 3, v122 dst_sel:DWORD dst_unused:UNUSED_PAD src0_sel:DWORD src1_sel:WORD_0
    v_lshlrev_b32_sdwa v90, 3, v122 dst_sel:DWORD dst_unused:UNUSED_PAD src0_sel:DWORD src1_sel:WORD_1
    ds_read_b64 v[88:89], v88
    ds_read_b64 v[90:91], v90
    v_lshlrev_b32_sdwa v92, 3, v123 dst_sel:DWORD dst_unused:UNUSED_PAD src0_sel:DWORD src1_sel:WORD_0
    v_lshlrev_b32_sdwa v94, 3, v123 dst_sel:DWORD dst_unused:UNUSED_PAD src0_sel:DWORD src1_sel:WORD_1
    ds_read_b64 v[92:93], v92
    ds_read_b64 v[94:95], v94
    buffer_load_dwordx4 v[120:123], v69, s[12:15], s45 offen offset:1024 sc1
    s_waitcnt lgkmcnt(8)
    v_smfmac_f32_16x16x64_bf16 v[36:39], v[64:67], v[96:103], v68
    v_rcp_f32 v171, v171
    v_pk_fma_f32 v[146:147], v[146:147], v[128:129], v[130:131]
    v_pk_mul_f32 v[148:149], v[30:31], v[30:31]
    v_rcp_f32 v172, v172
    v_pk_mul_f32 v[174:175], v[20:21], v[170:171]
    v_pk_mul_f32 v[146:147], v[146:147], v[28:29]
    v_rcp_f32 v173, v173
    v_pk_fma_f32 v[148:149], v[148:149], v[128:129], v[130:131]
    s_waitcnt vmcnt(4)
    v_lshlrev_b32_sdwa v96, 3, v124 dst_sel:DWORD dst_unused:UNUSED_PAD src0_sel:DWORD src1_sel:WORD_0
    v_lshlrev_b32_sdwa v98, 3, v124 dst_sel:DWORD dst_unused:UNUSED_PAD src0_sel:DWORD src1_sel:WORD_1
    ds_read_b64 v[96:97], v96
    ds_read_b64 v[98:99], v98
    v_lshlrev_b32_sdwa v100, 3, v125 dst_sel:DWORD dst_unused:UNUSED_PAD src0_sel:DWORD src1_sel:WORD_0
    v_lshlrev_b32_sdwa v102, 3, v125 dst_sel:DWORD dst_unused:UNUSED_PAD src0_sel:DWORD src1_sel:WORD_1
    ds_read_b64 v[100:101], v100
    ds_read_b64 v[102:103], v102
    s_waitcnt lgkmcnt(8)
    v_smfmac_f32_16x16x64_bf16 v[32:35], v[64:67], v[104:111], v68
    v_exp_f32 v140, v140
    v_pk_fma_f32 v[174:175], v[22:23], v[172:173], v[174:175]
    v_pk_mul_f32 v[148:149], v[148:149], v[30:31]
    v_exp_f32 v141, v141
    v_add_f32 v174, v174, v175
    v_exp_f32 v142, v142
    buffer_store_dword v174, v70, s[12:15], s35 offen offset:1152 sc1
    v_pk_fma_f32 v[140:141], v[140:141], v[134:135], v[134:135]
    v_lshlrev_b32_sdwa v104, 3, v126 dst_sel:DWORD dst_unused:UNUSED_PAD src0_sel:DWORD src1_sel:WORD_0
    v_lshlrev_b32_sdwa v106, 3, v126 dst_sel:DWORD dst_unused:UNUSED_PAD src0_sel:DWORD src1_sel:WORD_1
    ds_read_b64 v[104:105], v104
    ds_read_b64 v[106:107], v106
    v_lshlrev_b32_sdwa v108, 3, v127 dst_sel:DWORD dst_unused:UNUSED_PAD src0_sel:DWORD src1_sel:WORD_0
    v_lshlrev_b32_sdwa v110, 3, v127 dst_sel:DWORD dst_unused:UNUSED_PAD src0_sel:DWORD src1_sel:WORD_1
    ds_read_b64 v[108:109], v108
    ds_read_b64 v[110:111], v110
    buffer_load_dwordx4 v[124:127], v69, s[12:15], s20 offen offset:2048 sc1
    s_waitcnt lgkmcnt(8)
    v_smfmac_f32_16x16x64_bf16 v[36:39], v[64:67], v[88:95], v68
    v_rcp_f32 v140, v140
    v_pk_mul_f32 v[152:153], v[32:33], v[32:33]
    v_pk_mul_f32 v[154:155], v[34:35], v[34:35]
    v_rcp_f32 v141, v141
    v_pk_fma_f32 v[152:153], v[152:153], v[128:129], v[130:131]
    v_pk_fma_f32 v[154:155], v[154:155], v[128:129], v[130:131]
    v_exp_f32 v143, v143
    v_pk_mul_f32 v[144:145], v[24:25], v[140:141]
    s_waitcnt vmcnt(4)
    v_lshlrev_b32_sdwa v88, 3, v116 dst_sel:DWORD dst_unused:UNUSED_PAD src0_sel:DWORD src1_sel:WORD_0
    v_lshlrev_b32_sdwa v90, 3, v116 dst_sel:DWORD dst_unused:UNUSED_PAD src0_sel:DWORD src1_sel:WORD_1
    ds_read_b64 v[88:89], v88
    ds_read_b64 v[90:91], v90
    v_lshlrev_b32_sdwa v92, 3, v117 dst_sel:DWORD dst_unused:UNUSED_PAD src0_sel:DWORD src1_sel:WORD_0
    v_lshlrev_b32_sdwa v94, 3, v117 dst_sel:DWORD dst_unused:UNUSED_PAD src0_sel:DWORD src1_sel:WORD_1
    ds_read_b64 v[92:93], v92
    ds_read_b64 v[94:95], v94
    s_waitcnt lgkmcnt(8)
    v_smfmac_f32_16x16x64_bf16 v[40:43], v[64:67], v[96:103], v68
    v_exp_f32 v146, v146
    v_pk_fma_f32 v[142:143], v[142:143], v[136:137], v[136:137]
    v_pk_mul_f32 v[152:153], v[152:153], v[32:33]
    v_rcp_f32 v142, v142
    v_pk_mul_f32 v[154:155], v[154:155], v[34:35]
    v_pk_mul_f32 v[158:159], v[36:37], v[36:37]
    v_rcp_f32 v143, v143
    v_pk_fma_f32 v[158:159], v[158:159], v[128:129], v[130:131]
    v_lshlrev_b32_sdwa v96, 3, v118 dst_sel:DWORD dst_unused:UNUSED_PAD src0_sel:DWORD src1_sel:WORD_0
    v_lshlrev_b32_sdwa v98, 3, v118 dst_sel:DWORD dst_unused:UNUSED_PAD src0_sel:DWORD src1_sel:WORD_1
    ds_read_b64 v[96:97], v96
    ds_read_b64 v[98:99], v98
    v_lshlrev_b32_sdwa v100, 3, v119 dst_sel:DWORD dst_unused:UNUSED_PAD src0_sel:DWORD src1_sel:WORD_0
    v_lshlrev_b32_sdwa v102, 3, v119 dst_sel:DWORD dst_unused:UNUSED_PAD src0_sel:DWORD src1_sel:WORD_1
    ds_read_b64 v[100:101], v100
    ds_read_b64 v[102:103], v102
    buffer_load_dwordx4 v[116:119], v69, s[12:15], s41 offen offset:2048 sc1
    s_waitcnt lgkmcnt(8)
    v_smfmac_f32_16x16x64_bf16 v[44:47], v[64:67], v[104:111], v68
    v_exp_f32 v147, v147
    v_pk_fma_f32 v[144:145], v[26:27], v[142:143], v[144:145]
    v_pk_mul_f32 v[158:159], v[158:159], v[36:37]
    v_exp_f32 v148, v148
    v_add_f32 v144, v144, v145
    v_pk_fma_f32 v[146:147], v[146:147], v[134:135], v[134:135]
    v_exp_f32 v149, v149
    buffer_store_dword v144, v70, s[12:15], s35 offen offset:1536 sc1
    s_waitcnt vmcnt(4)
    v_lshlrev_b32_sdwa v104, 3, v120 dst_sel:DWORD dst_unused:UNUSED_PAD src0_sel:DWORD src1_sel:WORD_0
    v_lshlrev_b32_sdwa v106, 3, v120 dst_sel:DWORD dst_unused:UNUSED_PAD src0_sel:DWORD src1_sel:WORD_1
    ds_read_b64 v[104:105], v104
    ds_read_b64 v[106:107], v106
    v_lshlrev_b32_sdwa v108, 3, v121 dst_sel:DWORD dst_unused:UNUSED_PAD src0_sel:DWORD src1_sel:WORD_0
    v_lshlrev_b32_sdwa v110, 3, v121 dst_sel:DWORD dst_unused:UNUSED_PAD src0_sel:DWORD src1_sel:WORD_1
    ds_read_b64 v[108:109], v108
    ds_read_b64 v[110:111], v110
    s_waitcnt lgkmcnt(8)
    v_smfmac_f32_16x16x64_bf16 v[40:43], v[64:67], v[88:95], v68
    v_rcp_f32 v146, v146
    v_pk_fma_f32 v[148:149], v[148:149], v[136:137], v[136:137]
    v_pk_mul_f32 v[160:161], v[38:39], v[38:39]
    v_rcp_f32 v147, v147
    v_pk_fma_f32 v[160:161], v[160:161], v[128:129], v[130:131]
    v_rcp_f32 v148, v148
    v_pk_mul_f32 v[150:151], v[28:29], v[146:147]
    v_pk_mul_f32 v[160:161], v[160:161], v[38:39]
    v_lshlrev_b32_sdwa v88, 3, v122 dst_sel:DWORD dst_unused:UNUSED_PAD src0_sel:DWORD src1_sel:WORD_0
    v_lshlrev_b32_sdwa v90, 3, v122 dst_sel:DWORD dst_unused:UNUSED_PAD src0_sel:DWORD src1_sel:WORD_1
    ds_read_b64 v[88:89], v88
    ds_read_b64 v[90:91], v90
    v_lshlrev_b32_sdwa v92, 3, v123 dst_sel:DWORD dst_unused:UNUSED_PAD src0_sel:DWORD src1_sel:WORD_0
    v_lshlrev_b32_sdwa v94, 3, v123 dst_sel:DWORD dst_unused:UNUSED_PAD src0_sel:DWORD src1_sel:WORD_1
    ds_read_b64 v[92:93], v92
    ds_read_b64 v[94:95], v94
    buffer_load_dwordx4 v[120:123], v69, s[12:15], s45 offen offset:2048 sc1
    s_waitcnt lgkmcnt(8)
    v_smfmac_f32_16x16x64_bf16 v[44:47], v[64:67], v[96:103], v68
    v_rcp_f32 v149, v149
    v_exp_f32 v152, v152
    v_exp_f32 v153, v153
    v_pk_fma_f32 v[150:151], v[30:31], v[148:149], v[150:151]
    v_exp_f32 v154, v154
    v_add_f32 v150, v150, v151
    v_pk_fma_f32 v[152:153], v[152:153], v[134:135], v[134:135]
    v_exp_f32 v155, v155
    s_waitcnt vmcnt(3)
    v_lshlrev_b32_sdwa v96, 3, v124 dst_sel:DWORD dst_unused:UNUSED_PAD src0_sel:DWORD src1_sel:WORD_0
    v_lshlrev_b32_sdwa v98, 3, v124 dst_sel:DWORD dst_unused:UNUSED_PAD src0_sel:DWORD src1_sel:WORD_1
    ds_read_b64 v[96:97], v96
    ds_read_b64 v[98:99], v98
    v_lshlrev_b32_sdwa v100, 3, v125 dst_sel:DWORD dst_unused:UNUSED_PAD src0_sel:DWORD src1_sel:WORD_0
    v_lshlrev_b32_sdwa v102, 3, v125 dst_sel:DWORD dst_unused:UNUSED_PAD src0_sel:DWORD src1_sel:WORD_1
    ds_read_b64 v[100:101], v100
    ds_read_b64 v[102:103], v102
    s_waitcnt lgkmcnt(8)
    v_smfmac_f32_16x16x64_bf16 v[40:43], v[64:67], v[104:111], v68
    v_rcp_f32 v152, v152
    buffer_store_dword v150, v70, s[12:15], s35 offen offset:1664 sc1
    v_pk_fma_f32 v[154:155], v[154:155], v[136:137], v[136:137]
    v_rcp_f32 v153, v153
    v_rcp_f32 v154, v154
    v_rcp_f32 v155, v155
    v_pk_mul_f32 v[156:157], v[32:33], v[152:153]
    v_exp_f32 v158, v158
    v_lshlrev_b32_sdwa v104, 3, v126 dst_sel:DWORD dst_unused:UNUSED_PAD src0_sel:DWORD src1_sel:WORD_0
    v_lshlrev_b32_sdwa v106, 3, v126 dst_sel:DWORD dst_unused:UNUSED_PAD src0_sel:DWORD src1_sel:WORD_1
    ds_read_b64 v[104:105], v104
    ds_read_b64 v[106:107], v106
    v_lshlrev_b32_sdwa v108, 3, v127 dst_sel:DWORD dst_unused:UNUSED_PAD src0_sel:DWORD src1_sel:WORD_0
    v_lshlrev_b32_sdwa v110, 3, v127 dst_sel:DWORD dst_unused:UNUSED_PAD src0_sel:DWORD src1_sel:WORD_1
    ds_read_b64 v[108:109], v108
    ds_read_b64 v[110:111], v110
    buffer_load_dwordx4 v[124:127], v69, s[12:15], s20 offen offset:3072 sc1
    s_waitcnt lgkmcnt(8)
    v_smfmac_f32_16x16x64_bf16 v[44:47], v[64:67], v[88:95], v68
    v_exp_f32 v159, v159
    v_pk_fma_f32 v[156:157], v[34:35], v[154:155], v[156:157]
    v_pk_mul_f32 v[164:165], v[40:41], v[40:41]
    v_exp_f32 v160, v160
    v_add_f32 v156, v156, v157
    v_pk_fma_f32 v[158:159], v[158:159], v[134:135], v[134:135]
    v_exp_f32 v161, v161
    buffer_store_dword v156, v70, s[12:15], s35 offen offset:2048 sc1
    s_waitcnt vmcnt(5)
    v_lshlrev_b32_sdwa v88, 3, v116 dst_sel:DWORD dst_unused:UNUSED_PAD src0_sel:DWORD src1_sel:WORD_0
    v_lshlrev_b32_sdwa v90, 3, v116 dst_sel:DWORD dst_unused:UNUSED_PAD src0_sel:DWORD src1_sel:WORD_1
    ds_read_b64 v[88:89], v88
    ds_read_b64 v[90:91], v90
    v_lshlrev_b32_sdwa v92, 3, v117 dst_sel:DWORD dst_unused:UNUSED_PAD src0_sel:DWORD src1_sel:WORD_0
    v_lshlrev_b32_sdwa v94, 3, v117 dst_sel:DWORD dst_unused:UNUSED_PAD src0_sel:DWORD src1_sel:WORD_1
    ds_read_b64 v[92:93], v92
    ds_read_b64 v[94:95], v94
    s_waitcnt lgkmcnt(8)
    v_smfmac_f32_16x16x64_bf16 v[48:51], v[64:67], v[96:103], v68
    v_rcp_f32 v158, v158
    v_pk_fma_f32 v[160:161], v[160:161], v[136:137], v[136:137]
    v_pk_fma_f32 v[164:165], v[164:165], v[128:129], v[130:131]
    v_rcp_f32 v159, v159
    v_pk_mul_f32 v[164:165], v[164:165], v[40:41]
    v_pk_mul_f32 v[166:167], v[42:43], v[42:43]
    v_rcp_f32 v160, v160
    v_pk_mul_f32 v[162:163], v[36:37], v[158:159]
    v_lshlrev_b32_sdwa v96, 3, v118 dst_sel:DWORD dst_unused:UNUSED_PAD src0_sel:DWORD src1_sel:WORD_0
    v_lshlrev_b32_sdwa v98, 3, v118 dst_sel:DWORD dst_unused:UNUSED_PAD src0_sel:DWORD src1_sel:WORD_1
    ds_read_b64 v[96:97], v96
    ds_read_b64 v[98:99], v98
    v_lshlrev_b32_sdwa v100, 3, v119 dst_sel:DWORD dst_unused:UNUSED_PAD src0_sel:DWORD src1_sel:WORD_0
    v_lshlrev_b32_sdwa v102, 3, v119 dst_sel:DWORD dst_unused:UNUSED_PAD src0_sel:DWORD src1_sel:WORD_1
    ds_read_b64 v[100:101], v100
    ds_read_b64 v[102:103], v102
    buffer_load_dwordx4 v[116:119], v69, s[12:15], s41 offen offset:3072 sc1
    s_waitcnt lgkmcnt(8)
    v_smfmac_f32_16x16x64_bf16 v[52:55], v[64:67], v[104:111], v68
    s_setprio 1
    v_rcp_f32 v161, v161
    v_pk_fma_f32 v[166:167], v[166:167], v[128:129], v[130:131]
    v_pk_mul_f32 v[170:171], v[44:45], v[44:45]
    v_exp_f32 v164, v164
    v_pk_fma_f32 v[162:163], v[38:39], v[160:161], v[162:163]
    v_pk_mul_f32 v[166:167], v[166:167], v[42:43]
    v_exp_f32 v165, v165
    v_add_f32 v162, v162, v163
    s_waitcnt vmcnt(4)
    v_lshlrev_b32_sdwa v104, 3, v120 dst_sel:DWORD dst_unused:UNUSED_PAD src0_sel:DWORD src1_sel:WORD_0
    v_lshlrev_b32_sdwa v106, 3, v120 dst_sel:DWORD dst_unused:UNUSED_PAD src0_sel:DWORD src1_sel:WORD_1
    ds_read_b64 v[104:105], v104
    ds_read_b64 v[106:107], v106
    v_lshlrev_b32_sdwa v108, 3, v121 dst_sel:DWORD dst_unused:UNUSED_PAD src0_sel:DWORD src1_sel:WORD_0
    v_lshlrev_b32_sdwa v110, 3, v121 dst_sel:DWORD dst_unused:UNUSED_PAD src0_sel:DWORD src1_sel:WORD_1
    ds_read_b64 v[108:109], v108
    ds_read_b64 v[110:111], v110
    s_waitcnt lgkmcnt(8)
    v_smfmac_f32_16x16x64_bf16 v[48:51], v[64:67], v[88:95], v68
    v_exp_f32 v166, v166
    buffer_store_dword v162, v70, s[12:15], s35 offen offset:2176 sc1
    v_pk_fma_f32 v[164:165], v[164:165], v[134:135], v[134:135]
    v_exp_f32 v167, v167
    v_pk_fma_f32 v[170:171], v[170:171], v[128:129], v[130:131]
    v_pk_mul_f32 v[172:173], v[46:47], v[46:47]
    v_rcp_f32 v164, v164
    v_pk_fma_f32 v[166:167], v[166:167], v[136:137], v[136:137]
    v_lshlrev_b32_sdwa v88, 3, v122 dst_sel:DWORD dst_unused:UNUSED_PAD src0_sel:DWORD src1_sel:WORD_0
    v_lshlrev_b32_sdwa v90, 3, v122 dst_sel:DWORD dst_unused:UNUSED_PAD src0_sel:DWORD src1_sel:WORD_1
    ds_read_b64 v[88:89], v88
    ds_read_b64 v[90:91], v90
    v_lshlrev_b32_sdwa v92, 3, v123 dst_sel:DWORD dst_unused:UNUSED_PAD src0_sel:DWORD src1_sel:WORD_0
    v_lshlrev_b32_sdwa v94, 3, v123 dst_sel:DWORD dst_unused:UNUSED_PAD src0_sel:DWORD src1_sel:WORD_1
    ds_read_b64 v[92:93], v92
    ds_read_b64 v[94:95], v94
    buffer_load_dwordx4 v[120:123], v69, s[12:15], s45 offen offset:3072 sc1
    s_waitcnt lgkmcnt(8)
    v_smfmac_f32_16x16x64_bf16 v[52:55], v[64:67], v[96:103], v68
    v_rcp_f32 v165, v165
    v_pk_mul_f32 v[170:171], v[170:171], v[44:45]
    v_pk_fma_f32 v[172:173], v[172:173], v[128:129], v[130:131]
    v_rcp_f32 v166, v166
    v_pk_mul_f32 v[168:169], v[40:41], v[164:165]
    v_pk_mul_f32 v[172:173], v[172:173], v[46:47]
    v_rcp_f32 v167, v167
    v_exp_f32 v170, v170
    s_waitcnt vmcnt(4)
    v_lshlrev_b32_sdwa v96, 3, v124 dst_sel:DWORD dst_unused:UNUSED_PAD src0_sel:DWORD src1_sel:WORD_0
    v_lshlrev_b32_sdwa v98, 3, v124 dst_sel:DWORD dst_unused:UNUSED_PAD src0_sel:DWORD src1_sel:WORD_1
    ds_read_b64 v[96:97], v96
    ds_read_b64 v[98:99], v98
    v_lshlrev_b32_sdwa v100, 3, v125 dst_sel:DWORD dst_unused:UNUSED_PAD src0_sel:DWORD src1_sel:WORD_0
    v_lshlrev_b32_sdwa v102, 3, v125 dst_sel:DWORD dst_unused:UNUSED_PAD src0_sel:DWORD src1_sel:WORD_1
    ds_read_b64 v[100:101], v100
    ds_read_b64 v[102:103], v102
    s_waitcnt lgkmcnt(8)
    v_smfmac_f32_16x16x64_bf16 v[48:51], v[64:67], v[104:111], v68
    v_exp_f32 v171, v171
    v_pk_fma_f32 v[168:169], v[42:43], v[166:167], v[168:169]
    v_exp_f32 v172, v172
    v_add_f32 v168, v168, v169
    v_pk_fma_f32 v[170:171], v[170:171], v[134:135], v[134:135]
    v_exp_f32 v173, v173
    buffer_store_dword v168, v70, s[12:15], s35 offen offset:2560 sc1
    v_rcp_f32 v170, v170
    v_lshlrev_b32_sdwa v104, 3, v126 dst_sel:DWORD dst_unused:UNUSED_PAD src0_sel:DWORD src1_sel:WORD_0
    v_lshlrev_b32_sdwa v106, 3, v126 dst_sel:DWORD dst_unused:UNUSED_PAD src0_sel:DWORD src1_sel:WORD_1
    ds_read_b64 v[104:105], v104
    ds_read_b64 v[106:107], v106
    v_lshlrev_b32_sdwa v108, 3, v127 dst_sel:DWORD dst_unused:UNUSED_PAD src0_sel:DWORD src1_sel:WORD_0
    v_lshlrev_b32_sdwa v110, 3, v127 dst_sel:DWORD dst_unused:UNUSED_PAD src0_sel:DWORD src1_sel:WORD_1
    ds_read_b64 v[108:109], v108
    ds_read_b64 v[110:111], v110
    s_waitcnt lgkmcnt(8)
    v_smfmac_f32_16x16x64_bf16 v[52:55], v[64:67], v[88:95], v68
    v_rcp_f32 v171, v171
    v_pk_fma_f32 v[172:173], v[172:173], v[136:137], v[136:137]
    v_pk_mul_f32 v[140:141], v[48:49], v[48:49]
    v_rcp_f32 v172, v172
    v_pk_mul_f32 v[174:175], v[44:45], v[170:171]
    v_pk_fma_f32 v[140:141], v[140:141], v[128:129], v[130:131]
    v_rcp_f32 v173, v173
    v_pk_mul_f32 v[140:141], v[140:141], v[48:49]
    s_waitcnt vmcnt(3)
    v_lshlrev_b32_sdwa v88, 3, v116 dst_sel:DWORD dst_unused:UNUSED_PAD src0_sel:DWORD src1_sel:WORD_0
    v_lshlrev_b32_sdwa v90, 3, v116 dst_sel:DWORD dst_unused:UNUSED_PAD src0_sel:DWORD src1_sel:WORD_1
    ds_read_b64 v[88:89], v88
    ds_read_b64 v[90:91], v90
    v_lshlrev_b32_sdwa v92, 3, v117 dst_sel:DWORD dst_unused:UNUSED_PAD src0_sel:DWORD src1_sel:WORD_0
    v_lshlrev_b32_sdwa v94, 3, v117 dst_sel:DWORD dst_unused:UNUSED_PAD src0_sel:DWORD src1_sel:WORD_1
    ds_read_b64 v[92:93], v92
    ds_read_b64 v[94:95], v94
    s_waitcnt lgkmcnt(8)
    v_smfmac_f32_16x16x64_bf16 v[56:59], v[64:67], v[96:103], v68
    v_exp_f32 v140, v140
    v_pk_fma_f32 v[174:175], v[46:47], v[172:173], v[174:175]
    v_pk_mul_f32 v[142:143], v[50:51], v[50:51]
    v_exp_f32 v141, v141
    v_add_f32 v174, v174, v175
    v_pk_fma_f32 v[142:143], v[142:143], v[128:129], v[130:131]
    buffer_store_dword v174, v70, s[12:15], s35 offen offset:2688 sc1
    v_pk_fma_f32 v[140:141], v[140:141], v[134:135], v[134:135]
    v_lshlrev_b32_sdwa v96, 3, v118 dst_sel:DWORD dst_unused:UNUSED_PAD src0_sel:DWORD src1_sel:WORD_0
    v_lshlrev_b32_sdwa v98, 3, v118 dst_sel:DWORD dst_unused:UNUSED_PAD src0_sel:DWORD src1_sel:WORD_1
    ds_read_b64 v[96:97], v96
    ds_read_b64 v[98:99], v98
    v_lshlrev_b32_sdwa v100, 3, v119 dst_sel:DWORD dst_unused:UNUSED_PAD src0_sel:DWORD src1_sel:WORD_0
    v_lshlrev_b32_sdwa v102, 3, v119 dst_sel:DWORD dst_unused:UNUSED_PAD src0_sel:DWORD src1_sel:WORD_1
    ds_read_b64 v[100:101], v100
    ds_read_b64 v[102:103], v102
    s_waitcnt lgkmcnt(8)
    v_smfmac_f32_16x16x64_bf16 v[60:63], v[64:67], v[104:111], v68
    v_rcp_f32 v140, v140
    v_pk_mul_f32 v[142:143], v[142:143], v[50:51]
    v_pk_mul_f32 v[146:147], v[52:53], v[52:53]
    v_rcp_f32 v141, v141
    v_pk_fma_f32 v[146:147], v[146:147], v[128:129], v[130:131]
    v_pk_mul_f32 v[148:149], v[54:55], v[54:55]
    v_exp_f32 v142, v142
    v_pk_mul_f32 v[144:145], v[48:49], v[140:141]
    s_waitcnt vmcnt(2)
    v_lshlrev_b32_sdwa v104, 3, v120 dst_sel:DWORD dst_unused:UNUSED_PAD src0_sel:DWORD src1_sel:WORD_0
    v_lshlrev_b32_sdwa v106, 3, v120 dst_sel:DWORD dst_unused:UNUSED_PAD src0_sel:DWORD src1_sel:WORD_1
    ds_read_b64 v[104:105], v104
    ds_read_b64 v[106:107], v106
    v_lshlrev_b32_sdwa v108, 3, v121 dst_sel:DWORD dst_unused:UNUSED_PAD src0_sel:DWORD src1_sel:WORD_0
    v_lshlrev_b32_sdwa v110, 3, v121 dst_sel:DWORD dst_unused:UNUSED_PAD src0_sel:DWORD src1_sel:WORD_1
    ds_read_b64 v[108:109], v108
    ds_read_b64 v[110:111], v110
    s_waitcnt lgkmcnt(8)
    v_smfmac_f32_16x16x64_bf16 v[56:59], v[64:67], v[88:95], v68
    v_exp_f32 v143, v143
    v_pk_mul_f32 v[146:147], v[146:147], v[52:53]
    v_pk_fma_f32 v[148:149], v[148:149], v[128:129], v[130:131]
    v_exp_f32 v146, v146
    v_pk_fma_f32 v[142:143], v[142:143], v[136:137], v[136:137]
    v_pk_mul_f32 v[148:149], v[148:149], v[54:55]
    v_rcp_f32 v142, v142
    v_rcp_f32 v143, v143
    v_lshlrev_b32_sdwa v88, 3, v122 dst_sel:DWORD dst_unused:UNUSED_PAD src0_sel:DWORD src1_sel:WORD_0
    v_lshlrev_b32_sdwa v90, 3, v122 dst_sel:DWORD dst_unused:UNUSED_PAD src0_sel:DWORD src1_sel:WORD_1
    ds_read_b64 v[88:89], v88
    ds_read_b64 v[90:91], v90
    v_lshlrev_b32_sdwa v92, 3, v123 dst_sel:DWORD dst_unused:UNUSED_PAD src0_sel:DWORD src1_sel:WORD_0
    v_lshlrev_b32_sdwa v94, 3, v123 dst_sel:DWORD dst_unused:UNUSED_PAD src0_sel:DWORD src1_sel:WORD_1
    ds_read_b64 v[92:93], v92
    ds_read_b64 v[94:95], v94
    s_waitcnt lgkmcnt(8)
    v_smfmac_f32_16x16x64_bf16 v[60:63], v[64:67], v[96:103], v68
    s_setprio 0
    v_exp_f32 v147, v147
    v_pk_fma_f32 v[144:145], v[50:51], v[142:143], v[144:145]
    v_exp_f32 v148, v148
    v_add_f32 v144, v144, v145
    v_pk_fma_f32 v[146:147], v[146:147], v[134:135], v[134:135]
    v_exp_f32 v149, v149
    buffer_store_dword v144, v70, s[12:15], s35 offen offset:3072 sc1
    v_rcp_f32 v146, v146
    s_waitcnt lgkmcnt(4)
    v_smfmac_f32_16x16x64_bf16 v[56:59], v[64:67], v[104:111], v68
    v_rcp_f32 v147, v147
    v_pk_fma_f32 v[148:149], v[148:149], v[136:137], v[136:137]
    s_waitcnt lgkmcnt(0)
    v_smfmac_f32_16x16x64_bf16 v[60:63], v[64:67], v[88:95], v68
    v_rcp_f32 v148, v148
    v_pk_mul_f32 v[150:151], v[52:53], v[146:147]
    v_rcp_f32 v149, v149
    s_nop 0
    s_nop 0
    v_pk_fma_f32 v[150:151], v[54:55], v[148:149], v[150:151]
    s_nop 0
    v_add_f32 v150, v150, v151
    v_pk_mul_f32 v[152:153], v[56:57], v[56:57]
    buffer_store_dword v150, v70, s[12:15], s35 offen offset:3200 sc1
    v_pk_fma_f32 v[152:153], v[152:153], v[128:129], v[130:131]
    v_pk_mul_f32 v[154:155], v[58:59], v[58:59]
    v_pk_mul_f32 v[152:153], v[152:153], v[56:57]
    v_pk_fma_f32 v[154:155], v[154:155], v[128:129], v[130:131]
    v_exp_f32 v152, v152
    v_pk_mul_f32 v[154:155], v[154:155], v[58:59]
    v_pk_mul_f32 v[158:159], v[60:61], v[60:61]
    v_exp_f32 v153, v153
    v_pk_fma_f32 v[158:159], v[158:159], v[128:129], v[130:131]
    v_pk_mul_f32 v[160:161], v[62:63], v[62:63]
    v_exp_f32 v154, v154
    v_pk_fma_f32 v[152:153], v[152:153], v[134:135], v[134:135]
    v_pk_mul_f32 v[158:159], v[158:159], v[60:61]
    v_rcp_f32 v152, v152
    v_pk_fma_f32 v[160:161], v[160:161], v[128:129], v[130:131]
    v_rcp_f32 v153, v153
    v_pk_mul_f32 v[160:161], v[160:161], v[62:63]
    v_exp_f32 v155, v155
    v_pk_mul_f32 v[156:157], v[56:57], v[152:153]
    v_exp_f32 v158, v158
    v_pk_fma_f32 v[154:155], v[154:155], v[136:137], v[136:137]
    v_exp_f32 v159, v159
    v_rcp_f32 v154, v154
    v_rcp_f32 v155, v155
    v_pk_fma_f32 v[158:159], v[158:159], v[134:135], v[134:135]
    v_exp_f32 v160, v160
    v_pk_fma_f32 v[156:157], v[58:59], v[154:155], v[156:157]
    v_rcp_f32 v158, v158
    v_add_f32 v156, v156, v157
    v_rcp_f32 v159, v159
    buffer_store_dword v156, v70, s[12:15], s35 offen offset:3584 sc1
    v_exp_f32 v161, v161
    v_pk_mul_f32 v[162:163], v[60:61], v[158:159]
    s_nop 0
    v_pk_fma_f32 v[160:161], v[160:161], v[136:137], v[136:137]
    s_nop 0
    v_rcp_f32 v160, v160
    v_rcp_f32 v161, v161
    s_nop 0
    s_nop 0
    v_pk_fma_f32 v[162:163], v[62:63], v[160:161], v[162:163]
    s_nop 0
    v_add_f32 v162, v162, v163
    s_nop 0
    buffer_store_dword v162, v70, s[12:15], s35 offen offset:3712 sc1
    s_branch standalone__deep_cross_pnn__recsys_kernel_red
standalone__deep_cross_pnn__recsys_kernel_end:
    s_endpgm
.section .rodata,"a"
.p2align 6
.amdhsa_kernel standalone__deep_cross_pnn__recsys_kernel
  .amdhsa_next_free_vgpr 256
  .amdhsa_next_free_sgpr 102
  .amdhsa_accum_offset 256
  .amdhsa_group_segment_fixed_size 0
  .amdhsa_kernarg_size 80
  .amdhsa_user_sgpr_count 2
  .amdhsa_user_sgpr_kernarg_segment_ptr 1
  .amdhsa_system_sgpr_workgroup_id_x 1
.end_amdhsa_kernel
```

```asm
; @launch grid=(256,1,1) block=(512,1,1) lds=163840
.amdgcn_target "amdgcn-amd-amdhsa--gfx950"
.text
.globl standalone__deep_cross_pnn__recsys_kernel
.p2align 8
.type standalone__deep_cross_pnn__recsys_kernel,@function
standalone__deep_cross_pnn__recsys_kernel:

    s_cmp_ge_u32 s2, 256
    s_cbranch_scc1 standalone__deep_cross_pnn__recsys_kernel_end
    s_load_dwordx8 s[4:11], s[0:1], 0
    s_load_dwordx2 s[12:13], s[0:1], 72
    s_load_dwordx2 s[52:53], s[0:1], 64
    s_load_dwordx4 s[60:63], s[0:1], 32

    s_getpc_b64 s[84:85]
standalone__deep_cross_pnn__recsys_kernel_pc0:
    s_lshr_b32 s44, s2, 3
    s_lshl_b32 s44, s44, 11
    v_lshl_add_u32 v2, v0, 2, s44
    v_min_u32 v2, standalone__deep_cross_pnn__recsys_kernel_end - standalone__deep_cross_pnn__recsys_kernel_pc0, v2
    global_load_dword v100, v2, s[84:85]

    v_lshrrev_b32 v1, 6, v0
    v_and_b32 v255, 63, v0
    s_bfe_u32 s36, s2, 0x10003
    v_readfirstlane_b32 s3, v1

    s_lshr_b32 s37, s2, 4
    s_lshl_b32 s37, s37, 3
    s_and_b32 s38, s2, 7
    s_or_b32 s37, s37, s38
    v_lshlrev_b32 v254, 4, v255
    v_mov_b32 v252, 163712
    v_mov_b32 v253, 1
    v_mov_b32 v40, 0
    v_cmp_gt_u32 vcc, 8, v0
    v_lshl_add_u32 v41, v0, 2, v252
    s_and_saveexec_b64 s[46:47], vcc
    ds_write_b32 v41, v40
    s_mov_b64 exec, s[46:47]
    v_mul_u32_u24 v6, 57, v255
    v_lshrrev_b32 v6, 9, v6
    v_mul_u32_u24 v5, 9, v6
    v_sub_u32 v5, v255, v5
    v_cmp_gt_u32 s[40:41], 8, v5
    v_lshlrev_b32 v5, 4, v5
    v_lshl_add_u32 v83, v6, 8, v5
    s_and_b32 s56, s3, 3
    s_mul_i32 s42, s56, 1792
    s_mul_i32 s43, s56, 1008
    s_lshl_b32 s38, s36, 7
    s_add_u32 s42, s42, s38
    s_bitset0_b32 s41, 31
    s_waitcnt lgkmcnt(0)

    s_mov_b32 s16, s4
    s_and_b32 s17, s5, 0xffff
    s_mov_b32 s18, 6553600
    s_mov_b32 s19, 0x00020000
    s_mov_b32 s20, s6
    s_and_b32 s21, s7, 0xffff
    s_mov_b32 s22, 256000
    s_mov_b32 s23, 0x00020000
    s_mov_b32 s24, s8
    s_and_b32 s25, s9, 0xffff
    s_mov_b32 s26, 20000
    s_mov_b32 s27, 0x00020000
    s_mov_b32 s28, s10
    s_and_b32 s29, s11, 0xffff
    s_mov_b32 s30, 13107200
    s_mov_b32 s31, 0x00020000
    s_mov_b32 s32, s12
    s_and_b32 s33, s13, 0xffff
    s_mov_b32 s34, 268435456
    s_mov_b32 s35, 0x00020000
    s_mov_b32 s12, s12
    s_and_b32 s13, s13, 0xffff
    s_mov_b32 s14, 268435456
    s_mov_b32 s15, 0x00020000
    s_mov_b32 s52, s52
    s_and_b32 s53, s53, 0xffff
    s_mov_b32 s54, 256
    s_mov_b32 s55, 0x00020000

    s_mov_b32 s50, s36
    s_lshr_b32 s44, s2, 4
    s_lshl_b32 s44, s44, 6
    s_and_b32 s45, s2, 12
    s_add_u32 s44, s44, s45
    s_add_u32 s60, s60, s44
    s_addc_u32 s61, s61, 0
    s_add_u32 s10, s62, s44
    s_addc_u32 s11, s63, 0

    s_cmp_ge_u32 s3, 4
    s_cbranch_scc1 standalone__deep_cross_pnn__recsys_kernel_aux

    s_setprio 3
    s_lshl_b32 s38, s3, 10
    s_add_u32 m0, s38, 144144
    v_and_b32 v5, 15, v255

    buffer_load_dwordx4 v254, s[24:27], s38 offen lds
    s_add_u32 m0, m0, 4096
    s_add_u32 s38, s38, 4096
    buffer_load_dwordx4 v254, s[24:27], s38 offen lds
    s_add_u32 m0, m0, 4096
    s_add_u32 s38, s38, 4096
    buffer_load_dwordx4 v254, s[24:27], s38 offen lds
    s_add_u32 m0, m0, 4096
    s_add_u32 s38, s38, 4096
    buffer_load_dwordx4 v254, s[24:27], s38 offen lds
    s_add_u32 m0, m0, 4096
    s_add_u32 s38, s38, 4096
    s_cmp_eq_u32 s3, 3
    s_cselect_b32 s45, 1024, 0
    s_sub_u32 m0, m0, s45
    s_sub_u32 s38, s38, s45
    buffer_load_dwordx4 v254, s[24:27], s38 offen lds

    v_lshrrev_b32 v6, 4, v255
    v_and_b32 v8, 3, v255
    v_bfe_u32 v7, v255, 2, 2
    v_mul_u32_u24 v245, 24, v5
    s_movk_i32 s45, 400
    v_lshlrev_b32 v246, 2, v7
    v_mad_u32_u24 v246, v8, s45, v246
    s_lshl_b32 s72, s37, 7
    s_lshl_b32 s73, s3, 5
    s_add_u32 s72, s72, s73
    s_mul_i32 s74, s72, 400
    s_add_u32 s58, s74, 12800
    s_mov_b32 s18, s58
    v_mul_u32_u24 v184, 12, v5
    s_movk_i32 s45, 200
    v_mad_u32_u24 v185, v6, s45, v184
    v_lshlrev_b32 v186, 1, v7
    v_mad_u32_u24 v186, v6, s45, v186
    v_mov_b32 v0, 0
    s_movk_i32 s45, 19200

    buffer_load_dwordx3 v[188:190], v185, s[24:27], s45 offen
    buffer_load_short_d16_hi v0, v186, s[24:27], s45 offen offset:192
    buffer_load_dwordx4 v[192:195], v245, s[16:19], s74 offen
    buffer_load_dwordx2 v[196:197], v245, s[16:19], s74 offen offset:16
    buffer_load_dword v236, v246, s[16:19], s74 offen offset:384
    buffer_load_dwordx4 v[218:221], v245, s[16:19], s74 offen offset:400
    buffer_load_dwordx2 v[222:223], v245, s[16:19], s74 offen offset:416
    buffer_load_dwordx4 v[224:227], v245, s[16:19], s74 offen offset:800
    buffer_load_dwordx2 v[228:229], v245, s[16:19], s74 offen offset:816
    buffer_load_dwordx4 v[230:233], v245, s[16:19], s74 offen offset:1200
    buffer_load_dwordx2 v[234:235], v245, s[16:19], s74 offen offset:1216
    buffer_load_dwordx4 v[212:215], v245, s[16:19], s74 offen offset:1600
    buffer_load_dwordx2 v[216:217], v245, s[16:19], s74 offen offset:1616
    s_load_dword s24, s[60:61], 0
    s_load_dword s25, s[60:61], 16
    s_load_dword s26, s[60:61], 32
    s_load_dword s27, s[60:61], 48
    s_load_dword s28, s[10:11], 0
    s_load_dword s29, s[10:11], 16
    s_load_dword s30, s[10:11], 32
    s_load_dword s31, s[10:11], 48

    v_add_u32 v40, -1, v5
    v_cmp_gt_u32 s[46:47], 8, v40
    s_lshl_b32 s76, s36, 14
    s_add_u32 s76, s76, s72
    s_lshl_b32 s76, s76, 2
    s_add_u32 s76, s76, 29360128
    v_lshlrev_b32 v40, 4, v40
    v_lshrrev_b32 v41, 5, v255
    v_lshl_add_u32 v40, v41, 2, v40
    v_bfe_u32 v41, v255, 4, 1
    v_lshl_add_u32 v94, v41, 3, v40
    s_lshl_b32 s45, s3, 7
    s_add_u32 s45, s45, 512
    s_min_u32 s45, s45, 880
    s_mul_i32 s44, s45, 144
    v_mul_u32_u24 v95, 144, v5
    v_lshl_add_u32 v95, v6, 4, v95
    v_add_u32 v95, s44, v95
    s_xor_b32 s44, s36, 1
    s_lshl_b32 s44, s44, 10
    s_add_u32 s44, s44, s45
    s_lshl_b32 s44, s44, 7
    s_add_u32 s44, s44, 15204352
    s_mov_b32 s64, 0x40000000
    v_add_u32 v184, 144144, v184
    s_movk_i32 s45, 4800
    v_mad_u32_u24 v184, v6, s45, v184
    v_mul_u32_u24 v186, 1200, v5
    v_add_u32 v186, 144144, v186
    v_mad_u32_u24 v185, v6, 48, v186
    v_lshl_add_u32 v186, v6, 1, v186
    v_and_b32 v244, 48, v255
    s_movk_i32 s57, 144
    v_cmp_eq_u32 s[60:61], 0, v8
    v_cmp_eq_u32 s[62:63], 1, v8
    v_cmp_eq_u32 s[66:67], 2, v8
    v_cmp_eq_u32 s[68:69], 3, v8
    s_mov_b32 s70, 0x00010001
    s_mov_b32 s71, 0x00010001

    s_lshr_b32 s79, s2, 1
    s_mul_i32 s77, s79, 102656
    s_lshl_b32 s85, s50, 11
    s_xor_b32 s78, s85, 2048
    s_add_u32 s78, s78, s77
    s_add_u32 s77, s77, s85
    s_and_b32 s79, s2, 1
    s_mul_i32 s79, s79, 1638400
    s_add_u32 s79, s79, 16777216
    s_lshl_b32 s85, s3, 13
    s_add_u32 s79, s79, s85
    s_xor_b32 s85, s3, 4
    s_lshl_b32 s85, s85, 10
    s_min_u32 s85, s85, 7040

    v_and_b32 v247, 1, v255
    v_mov_b32 v252, 0xdddd
    v_mul_u32_u24 v253, 0xaaaa, v247
    v_lshl_add_u32 v247, v247, 2, v244
    v_add_u32 v253, 0x4444, v253
    v_mov_b32 v203, 0x3f805555

    v_mov_b64 v[4:5], 0
    v_mov_b64 v[6:7], 0
    v_mov_b64 v[8:9], 0
    v_mov_b64 v[10:11], 0
    v_mov_b64 v[12:13], 0
    v_mov_b64 v[14:15], 0
    v_mov_b64 v[16:17], 0
    v_mov_b64 v[18:19], 0
    v_mov_b64 v[20:21], 0
    v_mov_b64 v[22:23], 0
    v_mov_b64 v[24:25], 0
    v_mov_b64 v[26:27], 0
    v_mov_b64 v[28:29], 0
    v_mov_b64 v[30:31], 0
    v_mov_b64 v[32:33], 0
    v_mov_b64 v[34:35], 0
    v_mov_b64 v[36:37], 0
    v_mov_b64 v[38:39], 0
    v_mov_b64 v[40:41], 0
    v_mov_b64 v[42:43], 0
    v_mov_b64 v[44:45], 0
    v_mov_b64 v[46:47], 0
    v_mov_b64 v[48:49], 0
    v_mov_b64 v[50:51], 0
    v_mov_b64 v[52:53], 0
    v_mov_b64 v[54:55], 0
    v_mov_b64 v[56:57], 0
    v_mov_b64 v[58:59], 0
    v_mov_b64 v[60:61], 0
    v_mov_b64 v[62:63], 0
    v_mov_b64 v[64:65], 0
    v_mov_b64 v[66:67], 0
    v_mov_b64 v[68:69], 0
    v_mov_b64 v[70:71], 0
    v_mov_b64 v[72:73], 0
    v_mov_b64 v[74:75], 0
    v_mov_b64 v[76:77], 0
    v_mov_b64 v[78:79], 0
    v_mov_b64 v[80:81], 0
    v_mov_b64 v[82:83], 0
    v_mov_b64 v[84:85], 0
    v_mov_b64 v[86:87], 0
    v_mov_b64 v[88:89], 0
    v_mov_b64 v[90:91], 0
    v_mov_b64 v[92:93], 0
    s_waitcnt vmcnt(13)
    s_barrier
    ds_read_b64 v[96:97], v185 offset:200
    ds_read_b64 v[98:99], v185 offset:208
    ds_read_b64 v[100:101], v185 offset:224
    ds_read_b64 v[102:103], v185 offset:232
    ds_read_b64 v[104:105], v185 offset:400
    ds_read_b64 v[106:107], v185 offset:408
    ds_read_b64 v[108:109], v185 offset:424
    ds_read_b64 v[110:111], v185 offset:432
    ds_read_b64 v[112:113], v185 offset:600
    ds_read_b64 v[114:115], v185 offset:608
    ds_read_b64 v[116:117], v185 offset:616
    ds_read_b64 v[118:119], v185 offset:624
    ds_read_b64 v[120:121], v185 offset:632
    ds_read_b64 v[122:123], v185 offset:640
    ds_read_b64 v[124:125], v185 offset:800
    ds_read_b64 v[126:127], v185 offset:808
    ds_read_b64 v[128:129], v185 offset:816
    ds_read_b64 v[130:131], v185 offset:824
    ds_read_b64 v[132:133], v185 offset:832
    ds_read_b64 v[134:135], v185 offset:840
    ds_read_b64 v[136:137], v185 offset:1000
    ds_read_b64 v[138:139], v185 offset:1008
    ds_read_b64 v[140:141], v185 offset:1016
    ds_read_b64 v[142:143], v185 offset:1024
    ds_read_b64 v[144:145], v185 offset:1032
    ds_read_b64 v[146:147], v185 offset:1040
    ds_read_u16_d16_hi v88, v186 offset:192
    ds_read_u16_d16_hi v89, v186 offset:392
    ds_read_u16_d16_hi v90, v186 offset:592
    ds_read_u16_d16_hi v91, v186 offset:792
    ds_read_u16_d16_hi v92, v186 offset:992
    ds_read_u16_d16_hi v93, v186 offset:1192
    ds_read_u16_d16_hi v4, v184 offset:4
    ds_read_u16_d16_hi v5, v184 offset:1204
    ds_read_u16_d16_hi v6, v184 offset:2404
    ds_read_u16_d16_hi v7, v184 offset:3604
    ds_read_u16_d16_hi v8, v184 offset:6
    ds_read_u16_d16_hi v9, v184 offset:1206
    ds_read_u16_d16_hi v10, v184 offset:2406
    ds_read_u16_d16_hi v11, v184 offset:3606
    ds_read_u16_d16_hi v12, v184 offset:8
    ds_read_u16_d16_hi v13, v184 offset:1208
    ds_read_u16_d16_hi v14, v184 offset:2408
    ds_read_u16_d16_hi v15, v184 offset:3608
    ds_read_u16_d16_hi v16, v184 offset:10
    ds_read_u16_d16_hi v17, v184 offset:1210
    ds_read_u16_d16_hi v18, v184 offset:2410
    ds_read_u16_d16_hi v19, v184 offset:3610
    ds_read_u16_d16_hi v20, v184 offset:206
    ds_read_u16_d16_hi v21, v184 offset:1406
    ds_read_u16_d16_hi v22, v184 offset:2606
    ds_read_u16_d16_hi v23, v184 offset:3806
    ds_read_u16_d16_hi v24, v184 offset:208
    ds_read_u16_d16_hi v25, v184 offset:1408
    ds_read_u16_d16_hi v26, v184 offset:2608
    ds_read_u16_d16_hi v27, v184 offset:3808
    ds_read_u16_d16_hi v28, v184 offset:210
    ds_read_u16_d16_hi v29, v184 offset:1410
    ds_read_u16_d16_hi v30, v184 offset:2610
    ds_read_u16_d16_hi v31, v184 offset:3810
    ds_read_u16_d16_hi v32, v184 offset:408
    ds_read_u16_d16_hi v33, v184 offset:1608
    ds_read_u16_d16_hi v34, v184 offset:2808
    ds_read_u16_d16_hi v35, v184 offset:4008
    ds_read_u16_d16_hi v36, v184 offset:410
    ds_read_u16_d16_hi v37, v184 offset:1610
    ds_read_u16_d16_hi v38, v184 offset:2810
    ds_read_u16_d16_hi v39, v184 offset:4010
    ds_read_u16_d16_hi v40, v184 offset:610
    ds_read_u16_d16_hi v41, v184 offset:1810
    ds_read_u16_d16_hi v42, v184 offset:3010
    ds_read_u16_d16_hi v43, v184 offset:4210
    ds_read_u16_d16_hi v44, v184 offset:810
    ds_read_u16_d16_hi v45, v184 offset:2010
    ds_read_u16_d16_hi v46, v184 offset:3210
    ds_read_u16_d16_hi v47, v184 offset:4410
    ds_read_u16_d16_hi v52, v184 offset:2
    ds_read_u16_d16_hi v53, v184 offset:1202
    ds_read_u16_d16_hi v54, v184 offset:2402
    ds_read_u16_d16_hi v55, v184 offset:3602
    ds_read_u16_d16_hi v60, v184 offset:406
    ds_read_u16_d16_hi v61, v184 offset:1606
    ds_read_u16_d16_hi v62, v184 offset:2806
    ds_read_u16_d16_hi v63, v184 offset:4006
    ds_read_u16_d16_hi v68, v184 offset:204
    ds_read_u16_d16_hi v69, v184 offset:1404
    ds_read_u16_d16_hi v70, v184 offset:2604
    ds_read_u16_d16_hi v71, v184 offset:3804
    ds_read_u16_d16_hi v76, v184 offset:608
    ds_read_u16_d16_hi v77, v184 offset:1808
    ds_read_u16_d16_hi v78, v184 offset:3008
    ds_read_u16_d16_hi v79, v184 offset:4208
    ds_read_u16_d16_hi v48, v184 offset:0
    ds_read_u16_d16_hi v49, v184 offset:1200
    ds_read_u16_d16_hi v50, v184 offset:2400
    ds_read_u16_d16_hi v51, v184 offset:3600
    ds_read_u16_d16_hi v56, v184 offset:404
    ds_read_u16_d16_hi v57, v184 offset:1604
    ds_read_u16_d16_hi v58, v184 offset:2804
    ds_read_u16_d16_hi v59, v184 offset:4004
    ds_read_u16_d16_hi v64, v184 offset:202
    ds_read_u16_d16_hi v65, v184 offset:1402
    ds_read_u16_d16_hi v66, v184 offset:2602
    ds_read_u16_d16_hi v67, v184 offset:3802
    ds_read_u16_d16_hi v72, v184 offset:606
    ds_read_u16_d16_hi v73, v184 offset:1806
    ds_read_u16_d16_hi v74, v184 offset:3006
    ds_read_u16_d16_hi v75, v184 offset:4206
    ds_read_u16_d16_hi v80, v184 offset:808
    ds_read_u16_d16_hi v81, v184 offset:2008
    ds_read_u16_d16_hi v82, v184 offset:3208
    ds_read_u16_d16_hi v83, v184 offset:4408
    ds_read_u16_d16_hi v84, v184 offset:1010
    ds_read_u16_d16_hi v85, v184 offset:2210
    ds_read_u16_d16_hi v86, v184 offset:3410
    ds_read_u16_d16_hi v87, v184 offset:4610
    s_waitcnt vmcnt(8) lgkmcnt(15)
    v_lshlrev_b32 v200, 16, v104
    v_add_f32 v4, v4, v200
    v_lshlrev_b32 v201, 16, v107
    v_add_f32 v5, v5, v201
    v_lshlrev_b32 v200, 16, v108
    v_add_f32 v6, v6, v200
    v_lshlrev_b32 v201, 16, v111
    v_add_f32 v7, v7, v201
    v_lshlrev_b32 v200, 16, v112
    v_add_f32 v8, v8, v200
    v_lshlrev_b32 v201, 16, v115
    v_add_f32 v9, v9, v201
    v_lshlrev_b32 v200, 16, v118
    v_add_f32 v10, v10, v200
    v_lshlrev_b32 v201, 16, v121
    v_add_f32 v11, v11, v201
    v_lshlrev_b32 v200, 16, v124
    v_add_f32 v12, v12, v200
    v_lshlrev_b32 v201, 16, v127
    v_add_f32 v13, v13, v201
    v_lshlrev_b32 v200, 16, v130
    v_add_f32 v14, v14, v200
    v_lshlrev_b32 v201, 16, v133
    v_add_f32 v15, v15, v201
    v_lshlrev_b32 v200, 16, v136
    v_add_f32 v16, v16, v200
    v_lshlrev_b32 v201, 16, v139
    v_add_f32 v17, v17, v201
    v_lshlrev_b32 v200, 16, v142
    v_add_f32 v18, v18, v200
    v_lshlrev_b32 v201, 16, v145
    v_add_f32 v19, v19, v201
    v_and_b32 v200, 0xffff0000, v112
    v_add_f32 v20, v20, v200
    v_and_b32 v201, 0xffff0000, v115
    v_add_f32 v21, v21, v201
    v_and_b32 v200, 0xffff0000, v118
    v_add_f32 v22, v22, v200
    v_and_b32 v201, 0xffff0000, v121
    v_add_f32 v23, v23, v201
    v_and_b32 v200, 0xffff0000, v124
    v_add_f32 v24, v24, v200
    v_and_b32 v201, 0xffff0000, v127
    v_add_f32 v25, v25, v201
    v_and_b32 v200, 0xffff0000, v130
    v_add_f32 v26, v26, v200
    v_and_b32 v201, 0xffff0000, v133
    v_add_f32 v27, v27, v201
    v_and_b32 v200, 0xffff0000, v136
    v_add_f32 v28, v28, v200
    v_and_b32 v201, 0xffff0000, v139
    v_add_f32 v29, v29, v201
    v_and_b32 v200, 0xffff0000, v142
    v_add_f32 v30, v30, v200
    v_and_b32 v201, 0xffff0000, v145
    v_add_f32 v31, v31, v201
    v_lshlrev_b32 v200, 16, v125
    v_add_f32 v32, v32, v200
    v_lshlrev_b32 v201, 16, v128
    v_add_f32 v33, v33, v201
    v_lshlrev_b32 v200, 16, v131
    v_add_f32 v34, v34, v200
    v_lshlrev_b32 v201, 16, v134
    v_add_f32 v35, v35, v201
    v_lshlrev_b32 v200, 16, v137
    v_add_f32 v36, v36, v200
    v_lshlrev_b32 v201, 16, v140
    v_add_f32 v37, v37, v201
    v_lshlrev_b32 v200, 16, v143
    v_add_f32 v38, v38, v200
    v_lshlrev_b32 v201, 16, v146
    v_add_f32 v39, v39, v201
    v_and_b32 v200, 0xffff0000, v137
    v_add_f32 v40, v40, v200
    v_and_b32 v201, 0xffff0000, v140
    v_add_f32 v41, v41, v201
    v_and_b32 v200, 0xffff0000, v143
    v_add_f32 v42, v42, v200
    v_and_b32 v201, 0xffff0000, v146
    v_add_f32 v43, v43, v201
    v_lshlrev_b32 v200, 16, v138
    v_add_f32 v44, v44, v200
    v_lshlrev_b32 v201, 16, v141
    v_add_f32 v45, v45, v201
    v_lshlrev_b32 v200, 16, v144
    v_add_f32 v46, v46, v200
    v_lshlrev_b32 v201, 16, v147
    v_add_f32 v47, v47, v201
    v_lshlrev_b32 v200, 16, v96
    v_add_f32 v52, v52, v200
    v_lshlrev_b32 v201, 16, v99
    v_add_f32 v53, v53, v201
    v_lshlrev_b32 v200, 16, v100
    v_add_f32 v54, v54, v200
    v_lshlrev_b32 v201, 16, v103
    v_add_f32 v55, v55, v201
    v_lshlrev_b32 v200, 16, v113
    v_add_f32 v60, v60, v200
    v_lshlrev_b32 v201, 16, v116
    v_add_f32 v61, v61, v201
    v_lshlrev_b32 v200, 16, v119
    v_add_f32 v62, v62, v200
    v_lshlrev_b32 v201, 16, v122
    v_add_f32 v63, v63, v201
    v_and_b32 v200, 0xffff0000, v104
    v_add_f32 v68, v68, v200
    v_and_b32 v201, 0xffff0000, v107
    v_add_f32 v69, v69, v201
    v_and_b32 v200, 0xffff0000, v108
    v_add_f32 v70, v70, v200
    v_and_b32 v201, 0xffff0000, v111
    v_add_f32 v71, v71, v201
    v_and_b32 v200, 0xffff0000, v125
    v_add_f32 v76, v76, v200
    v_and_b32 v201, 0xffff0000, v128
    v_add_f32 v77, v77, v201
    v_and_b32 v200, 0xffff0000, v131
    v_add_f32 v78, v78, v200
    v_and_b32 v201, 0xffff0000, v134
    v_add_f32 v79, v79, v201
    v_lshlrev_b32 v200, 16, v188
    v_add_f32 v88, v88, v200
    v_and_b32 v201, 0xffff0000, v188
    v_add_f32 v89, v89, v201
    v_lshlrev_b32 v200, 16, v189
    v_add_f32 v90, v90, v200
    v_and_b32 v201, 0xffff0000, v189
    v_add_f32 v91, v91, v201
    v_lshlrev_b32 v200, 16, v190
    v_add_f32 v92, v92, v200
    v_and_b32 v201, 0xffff0000, v190
    v_add_f32 v93, v93, v201
    v_mad_u32_u24 v192, v192, s57, v244
    v_mad_u32_u24 v193, v193, s57, v244
    v_mad_u32_u24 v194, v194, s57, v244
    v_mad_u32_u24 v195, v195, s57, v244
    v_mad_u32_u24 v196, v196, s57, v244
    v_mad_u32_u24 v197, v197, s57, v244
    v_mad_u32_u24 v236, v236, s57, v244
    v_sub_f32 v88, v88, v90
    v_sub_f32 v90, v90, v89
    v_sub_f32 v89, v89, v91
    v_sub_f32 v91, v91, v92
    v_sub_f32 v92, v92, v93
    v_cndmask_b32 v3, 0, v0, s[68:69]
    v_cndmask_b32 v2, 0, v0, s[66:67]
    v_cndmask_b32 v1, 0, v0, s[62:63]
    v_cndmask_b32 v0, 0, v0, s[60:61]
    s_waitcnt lgkmcnt(0)
    v_cvt_pk_bf16_f32 v48, v48, v49
    v_cvt_pk_bf16_f32 v49, v50, v51
    v_cvt_pk_bf16_f32 v50, v52, v53
    v_cvt_pk_bf16_f32 v51, v54, v55
    v_cvt_pk_bf16_f32 v56, v56, v57
    v_cvt_pk_bf16_f32 v57, v58, v59
    v_cvt_pk_bf16_f32 v58, v60, v61
    v_cvt_pk_bf16_f32 v59, v62, v63
    v_cvt_pk_bf16_f32 v64, v64, v65
    v_cvt_pk_bf16_f32 v65, v66, v67
    v_cvt_pk_bf16_f32 v66, v68, v69
    v_cvt_pk_bf16_f32 v67, v70, v71
    v_cvt_pk_bf16_f32 v72, v72, v73
    v_cvt_pk_bf16_f32 v73, v74, v75
    v_cvt_pk_bf16_f32 v74, v76, v77
    v_cvt_pk_bf16_f32 v75, v78, v79
    v_cvt_pk_bf16_f32 v80, v80, v81
    v_cvt_pk_bf16_f32 v81, v82, v83
    v_cvt_pk_bf16_f32 v82, v84, v85
    v_cvt_pk_bf16_f32 v83, v86, v87
    v_permlane32_swap_b32 v48, v50
    v_permlane32_swap_b32 v49, v51
    v_permlane32_swap_b32 v56, v58
    v_permlane32_swap_b32 v57, v59
    v_permlane32_swap_b32 v64, v66
    v_permlane32_swap_b32 v65, v67
    v_permlane32_swap_b32 v72, v74
    v_permlane32_swap_b32 v73, v75
    v_permlane32_swap_b32 v80, v82
    v_permlane32_swap_b32 v81, v83
    v_permlane16_swap_b32 v48, v50
    v_permlane16_swap_b32 v49, v51
    v_permlane16_swap_b32 v56, v58
    v_permlane16_swap_b32 v57, v59
    v_permlane16_swap_b32 v64, v66
    v_permlane16_swap_b32 v65, v67
    v_permlane16_swap_b32 v72, v74
    v_permlane16_swap_b32 v73, v75
    v_permlane16_swap_b32 v80, v82
    v_permlane16_swap_b32 v81, v83
    s_mov_b32 s60, 0x100001
    s_mov_b32 s61, 0x10000100
    v_cndmask_b32 v60, 0, v203, s[60:61]
    s_mov_b32 s60, 0x200002
    s_mov_b32 s61, 0x20000200
    v_cndmask_b32 v61, 0, v203, s[60:61]
    s_mov_b32 s60, 0x400004
    s_mov_b32 s61, 0x40000400
    v_cndmask_b32 v62, 0, v203, s[60:61]
    s_mov_b32 s60, 0x800008
    s_mov_b32 s61, 0x80000800
    v_cndmask_b32 v63, 0, v203, s[60:61]
    v_mov_b64 v[52:53], 0
    v_mov_b64 v[54:55], 0
    v_mov_b64 v[68:69], 0
    v_mov_b64 v[70:71], 0
    v_mov_b64 v[248:249], 0
    v_mov_b64 v[250:251], 0
    v_add_u32_dpp v86, v236, v247 quad_perm:[0,0,1,1] row_mask:0xf bank_mask:0xf
    s_bitcmp1_b32 s2, 1
    s_cselect_b32 s83, 0, 16
    s_lshl_b32 s80, s24, s83
    s_lshl_b32 s81, s25, s83
    s_lshl_b32 s82, s26, s83
    s_lshl_b32 s83, s27, s83
    s_and_b32 s80, s80, 0xffff0000
    s_and_b32 s81, s81, 0xffff0000
    s_and_b32 s82, s82, 0xffff0000
    s_and_b32 s83, s83, 0xffff0000
    s_barrier
    s_setprio 0
    ds_read_b128 v[96:99], v192 offset:0
    ds_read_b128 v[100:103], v192 offset:64
    ds_read_b128 v[104:107], v193 offset:0
    ds_read_b128 v[108:111], v193 offset:64
    ds_read_b128 v[112:115], v194 offset:0
    ds_read_b128 v[116:119], v194 offset:64
    ds_read_b128 v[128:131], v195 offset:0
    ds_read_b128 v[132:135], v195 offset:64
    ds_read_b128 v[144:147], v196 offset:0
    ds_read_b128 v[148:151], v196 offset:64
    ds_read_b128 v[160:163], v197 offset:0
    ds_read_b128 v[164:167], v197 offset:64
    ds_read2_b32 v[84:85], v86 offset0:0 offset1:2
    ds_read2_b32 v[86:87], v86 offset0:4 offset1:6
    ds_read_b128 v[176:179], v236 offset:0
    ds_read_b128 v[180:183], v236 offset:64
    s_waitcnt vmcnt(6) lgkmcnt(0)
standalone__deep_cross_pnn__recsys_kernel_loop:
    v_mfma_f32_16x16x32_bf16 v[184:187], v[96:99], v[96:99], 0
    v_mad_u32_u24 v220, v220, s57, v244
    v_mad_u32_u24 v221, v221, s57, v244
    v_mfma_f32_16x16x32_bf16 v[184:187], v[100:103], v[100:103], v[184:187]
    v_fmac_f32 v240, v52, v60
    v_fmac_f32 v240, v53, v61
    v_mfma_f32_16x16x32_bf16 v[188:191], v[96:99], v[104:107], 0
    v_fmac_f32 v240, v54, v62
    v_fmac_f32 v240, v55, v63
    v_mfma_f32_16x16x32_bf16 v[188:191], v[100:103], v[108:111], v[188:191]
    ds_read_b128 v[120:123], v220 offset:0
    ds_read_b128 v[124:127], v220 offset:64
    v_mfma_f32_16x16x32_bf16 v[192:195], v[96:99], v[112:115], 0
    v_fmac_f32 v240, v200, v36
    v_fmac_f32 v240, v201, v37
    v_mfma_f32_16x16x32_bf16 v[192:195], v[100:103], v[116:119], v[192:195]
    v_fmac_f32 v240, v202, v38
    v_fmac_f32 v240, v203, v39
    v_smfmac_f32_16x16x64_bf16 v[68:71], v[84:87], v[96:103], v253
    v_fmac_f32 v240, v204, v40
    v_mfma_f32_16x16x32_bf16 v[196:199], v[96:99], v[128:131], 0
    v_fmac_f32 v240, v205, v41
    v_fmac_f32 v240, v206, v42
    v_mfma_f32_16x16x32_bf16 v[196:199], v[100:103], v[132:135], v[196:199]
    v_mul_f32 v237, v192, v4
    v_fmac_f32 v240, v207, v43
    v_smfmac_f32_16x16x64_bf16 v[248:251], v[48:51], v[184:191], v252
    v_fmac_f32 v237, v68, v88
    v_mfma_f32_16x16x32_bf16 v[184:187], v[112:115], v[112:115], 0
    ds_read_b128 v[136:139], v221 offset:0
    ds_read_b128 v[140:143], v221 offset:64
    v_mfma_f32_16x16x32_bf16 v[184:187], v[116:119], v[116:119], v[184:187]
    v_fmac_f32 v237, v69, v88
    v_mad_u32_u24 v222, v222, s57, v244
    v_mfma_f32_16x16x32_bf16 v[188:191], v[112:115], v[128:131], 0
    v_mad_u32_u24 v218, v218, s57, v244
    v_fmac_f32 v240, v208, v44
    v_mfma_f32_16x16x32_bf16 v[188:191], v[116:119], v[132:135], v[188:191]
    v_fmac_f32 v240, v209, v45
    v_fmac_f32 v240, v210, v46
    v_smfmac_f32_16x16x64_bf16 v[68:71], v[84:87], v[112:119], v253
    v_fmac_f32 v240, v211, v47
    v_mfma_f32_16x16x32_bf16 v[200:203], v[96:99], v[144:147], 0
    v_fmac_f32 v237, v193, v5
    v_fmac_f32 v237, v194, v6
    v_mfma_f32_16x16x32_bf16 v[200:203], v[100:103], v[148:151], v[200:203]
    v_fmac_f32 v237, v195, v7
    v_mad_u32_u24 v223, v223, s57, v244
    v_mfma_f32_16x16x32_bf16 v[204:207], v[96:99], v[160:163], 0
    ds_read_b128 v[152:155], v222 offset:0
    ds_read_b128 v[156:159], v222 offset:64
    v_mfma_f32_16x16x32_bf16 v[204:207], v[100:103], v[164:167], v[204:207]
    ds_read_b128 v[96:99], v218 offset:0
    ds_read_b128 v[100:103], v218 offset:64
    v_smfmac_f32_16x16x64_bf16 v[248:251], v[56:59], v[184:191], v252
    v_fmac_f32 v237, v68, v90
    v_fmac_f32 v237, v69, v90
    v_smfmac_f32_16x16x64_bf16 v[68:71], v[84:87], v[104:111], v253
    v_permlane32_swap_b32 v239, v240
    v_mfma_f32_16x16x32_bf16 v[184:187], v[104:107], v[104:107], 0
    v_add_f32 v242, v239, v240
    v_fmac_f32 v237, v196, v8
    v_mfma_f32_16x16x32_bf16 v[184:187], v[108:111], v[108:111], v[184:187]
    v_permlane16_swap_b32 v241, v242
    v_mfma_f32_16x16x32_bf16 v[188:191], v[104:107], v[112:115], 0
    v_fmac_f32 v237, v197, v9
    v_fmac_f32 v237, v68, v89
    v_mfma_f32_16x16x32_bf16 v[188:191], v[108:111], v[116:119], v[188:191]
    v_fmac_f32 v237, v69, v89
    v_fmac_f32 v237, v198, v10
    v_mfma_f32_16x16x32_bf16 v[208:211], v[104:107], v[128:131], 0
    v_fmac_f32 v237, v199, v11
    v_add_f32 v241, v241, v242
    v_mfma_f32_16x16x32_bf16 v[208:211], v[108:111], v[132:135], v[208:211]
    v_mad_u32_u24 v219, v219, s57, v244
    v_fmac_f32 v237, v200, v12
    v_mfma_f32_16x16x32_bf16 v[192:195], v[104:107], v[144:147], 0
    v_fmac_f32 v237, v201, v13
    v_fmac_f32 v237, v202, v14
    v_mfma_f32_16x16x32_bf16 v[192:195], v[108:111], v[148:151], v[192:195]
    ds_read_b128 v[168:171], v223 offset:0
    ds_read_b128 v[172:175], v223 offset:64
    v_smfmac_f32_16x16x64_bf16 v[248:251], v[64:67], v[184:191], v252
    v_fmac_f32 v237, v203, v15
    v_smfmac_f32_16x16x64_bf16 v[68:71], v[84:87], v[128:135], v253
    v_add_f32_dpp v241, v241, v241 row_ror:8 row_mask:0xf bank_mask:0xf
    v_mfma_f32_16x16x32_bf16 v[184:187], v[128:131], v[128:131], 0
    v_add_u32_dpp v78, v236, v247 quad_perm:[2,2,3,3] row_mask:0xf bank_mask:0xf
    v_add_f32_dpp v241, v241, v241 row_ror:4 row_mask:0xf bank_mask:0xf
    v_mfma_f32_16x16x32_bf16 v[184:187], v[132:135], v[132:135], v[184:187]
    v_fmac_f32 v237, v204, v16
    v_add_f32_dpp v241, v241, v241 row_ror:2 row_mask:0xf bank_mask:0xf
    v_mfma_f32_16x16x32_bf16 v[188:191], v[128:131], v[144:147], 0
    v_fmac_f32 v237, v68, v91
    v_fmac_f32 v237, v69, v91
    v_mfma_f32_16x16x32_bf16 v[188:191], v[132:135], v[148:151], v[188:191]
    v_add_f32_dpp v241, v241, v241 row_ror:1 row_mask:0xf bank_mask:0xf
    v_fmac_f32 v237, v205, v17
    v_mfma_f32_16x16x32_bf16 v[196:199], v[104:107], v[160:163], 0
    v_fmac_f32 v237, v206, v18
    v_fmac_f32 v237, v207, v19
    v_mfma_f32_16x16x32_bf16 v[196:199], v[108:111], v[164:167], v[196:199]
    ds_read_b128 v[104:107], v219 offset:0
    ds_read_b128 v[108:111], v219 offset:64
    v_mfma_f32_16x16x32_bf16 v[200:203], v[112:115], v[144:147], 0
    v_cndmask_b32 v243, v243, v241, s[70:71]
    v_fmac_f32 v237, v208, v20
    v_mfma_f32_16x16x32_bf16 v[200:203], v[116:119], v[148:151], v[200:203]
    v_fmac_f32 v237, v209, v21
    v_fmac_f32 v237, v210, v22
    v_smfmac_f32_16x16x64_bf16 v[248:251], v[72:75], v[184:191], v252
    v_fmac_f32 v237, v211, v23
    v_smfmac_f32_16x16x64_bf16 v[68:71], v[84:87], v[144:151], v253
    s_lshl_b64 s[70:71], s[70:71], 1
    v_mfma_f32_16x16x32_bf16 v[184:187], v[144:147], v[144:147], 0
    v_fmac_f32 v237, v192, v24
    v_fmac_f32 v237, v193, v25
    v_mfma_f32_16x16x32_bf16 v[184:187], v[148:151], v[148:151], v[184:187]
    ds_read2_b32 v[76:77], v78 offset0:0 offset1:2
    ds_read2_b32 v[78:79], v78 offset0:4 offset1:6
    v_mfma_f32_16x16x32_bf16 v[188:191], v[160:163], v[160:163], 0
    v_fmac_f32 v237, v68, v92
    v_fmac_f32 v237, v69, v92
    v_mfma_f32_16x16x32_bf16 v[188:191], v[164:167], v[164:167], v[188:191]
    buffer_load_dword v236, v246, s[16:19], s74 offen offset:1984
    buffer_load_dwordx4 v[218:221], v245, s[16:19], s74 offen offset:2000
    buffer_load_dwordx2 v[222:223], v245, s[16:19], s74 offen offset:2016
    v_mfma_f32_16x16x32_bf16 v[204:207], v[112:115], v[160:163], 0
    v_fmac_f32 v237, v194, v26
    v_fmac_f32 v237, v195, v27
    v_mfma_f32_16x16x32_bf16 v[204:207], v[116:119], v[164:167], v[204:207]
    v_fmac_f32 v237, v196, v28
    v_fmac_f32 v237, v197, v29
    v_smfmac_f32_16x16x64_bf16 v[68:71], v[84:87], v[160:167], v253
    v_fmac_f32 v237, v198, v30
    v_mfma_f32_16x16x32_bf16 v[208:211], v[128:131], v[160:163], 0
    v_fmac_f32 v237, v199, v31
    v_fmac_f32 v237, v200, v32
    v_mfma_f32_16x16x32_bf16 v[208:211], v[132:135], v[164:167], v[208:211]
    v_fmac_f32 v237, v201, v33
    v_fmac_f32 v237, v202, v34
    v_smfmac_f32_16x16x64_bf16 v[248:251], v[80:83], v[184:191], v252
    v_mov_b64 v[70:71], 0
    v_mfma_f32_16x16x32_bf16 v[192:195], v[144:147], v[160:163], 0
    v_fmac_f32 v237, v68, v93
    v_fmac_f32 v237, v69, v93
    v_mfma_f32_16x16x32_bf16 v[192:195], v[148:151], v[164:167], v[192:195]
    v_fmac_f32 v237, v203, v35
    s_waitcnt vmcnt(7) lgkmcnt(0)
    v_mfma_f32_16x16x32_bf16 v[184:187], v[96:99], v[96:99], 0
    v_mad_u32_u24 v226, v226, s57, v244
    v_mov_b64 v[52:53], 0
    v_mfma_f32_16x16x32_bf16 v[184:187], v[100:103], v[100:103], v[184:187]
    v_mov_b64 v[54:55], 0
    v_mad_u32_u24 v227, v227, s57, v244
    v_mfma_f32_16x16x32_bf16 v[188:191], v[96:99], v[104:107], 0
    v_fmac_f32 v237, v248, v60
    v_fmac_f32 v237, v249, v61
    v_mfma_f32_16x16x32_bf16 v[188:191], v[100:103], v[108:111], v[188:191]
    ds_read_b128 v[112:115], v226 offset:0
    ds_read_b128 v[116:119], v226 offset:64
    v_mfma_f32_16x16x32_bf16 v[196:199], v[96:99], v[120:123], 0
    v_fmac_f32 v237, v250, v62
    v_fmac_f32 v237, v251, v63
    v_mfma_f32_16x16x32_bf16 v[196:199], v[100:103], v[124:127], v[196:199]
    v_fmac_f32 v237, v204, v36
    v_fmac_f32 v237, v205, v37
    v_smfmac_f32_16x16x64_bf16 v[68:71], v[84:87], v[96:103], v253
    v_fmac_f32 v237, v206, v38
    v_mfma_f32_16x16x32_bf16 v[200:203], v[96:99], v[136:139], 0
    v_fmac_f32 v237, v207, v39
    v_mad_u32_u24 v228, v228, s57, v244
    v_mfma_f32_16x16x32_bf16 v[200:203], v[100:103], v[140:143], v[200:203]
    v_mul_f32 v238, v196, v4
    v_mad_u32_u24 v224, v224, s57, v244
    v_smfmac_f32_16x16x64_bf16 v[52:55], v[48:51], v[184:191], v252
    v_fmac_f32 v238, v70, v88
    v_mfma_f32_16x16x32_bf16 v[184:187], v[120:123], v[120:123], 0
    ds_read_b128 v[128:131], v227 offset:0
    ds_read_b128 v[132:135], v227 offset:64
    v_mfma_f32_16x16x32_bf16 v[184:187], v[124:127], v[124:127], v[184:187]
    v_fmac_f32 v238, v71, v88
    v_fmac_f32 v237, v208, v40
    v_mfma_f32_16x16x32_bf16 v[188:191], v[120:123], v[136:139], 0
    v_fmac_f32 v237, v209, v41
    v_fmac_f32 v237, v210, v42
    v_mfma_f32_16x16x32_bf16 v[188:191], v[124:127], v[140:143], v[188:191]
    v_fmac_f32 v237, v211, v43
    v_fmac_f32 v237, v192, v44
    v_smfmac_f32_16x16x64_bf16 v[68:71], v[84:87], v[120:127], v253
    v_fmac_f32 v237, v193, v45
    v_mfma_f32_16x16x32_bf16 v[204:207], v[96:99], v[152:155], 0
    v_fmac_f32 v237, v194, v46
    v_fmac_f32 v237, v195, v47
    v_mfma_f32_16x16x32_bf16 v[204:207], v[100:103], v[156:159], v[204:207]
    v_fmac_f32 v238, v197, v5
    v_fmac_f32 v238, v198, v6
    v_mfma_f32_16x16x32_bf16 v[208:211], v[96:99], v[168:171], 0
    ds_read_b128 v[144:147], v228 offset:0
    ds_read_b128 v[148:151], v228 offset:64
    v_mfma_f32_16x16x32_bf16 v[208:211], v[100:103], v[172:175], v[208:211]
    ds_read_b128 v[96:99], v224 offset:0
    ds_read_b128 v[100:103], v224 offset:64
    v_smfmac_f32_16x16x64_bf16 v[52:55], v[56:59], v[184:191], v252
    v_fmac_f32 v238, v70, v90
    v_fmac_f32 v238, v71, v90
    v_smfmac_f32_16x16x64_bf16 v[68:71], v[84:87], v[104:111], v253
    v_fmac_f32 v238, v199, v7
    v_mfma_f32_16x16x32_bf16 v[184:187], v[104:107], v[104:107], 0
    v_mad_u32_u24 v229, v229, s57, v244
    v_fmac_f32 v238, v200, v8
    v_mfma_f32_16x16x32_bf16 v[184:187], v[108:111], v[108:111], v[184:187]
    v_fmac_f32 v238, v201, v9
    v_fmac_f32 v238, v202, v10
    v_mfma_f32_16x16x32_bf16 v[188:191], v[104:107], v[120:123], 0
    v_fmac_f32 v238, v70, v89
    v_fmac_f32 v238, v71, v89
    v_mfma_f32_16x16x32_bf16 v[188:191], v[108:111], v[124:127], v[188:191]
    v_fmac_f32 v238, v203, v11
    v_fmac_f32 v238, v204, v12
    v_mfma_f32_16x16x32_bf16 v[192:195], v[104:107], v[136:139], 0
    v_fmac_f32 v238, v205, v13
    v_fmac_f32 v238, v206, v14
    v_mfma_f32_16x16x32_bf16 v[192:195], v[108:111], v[140:143], v[192:195]
    v_fmac_f32 v238, v207, v15
    v_mad_u32_u24 v225, v225, s57, v244
    v_mfma_f32_16x16x32_bf16 v[196:199], v[104:107], v[152:155], 0
    v_fmac_f32 v238, v208, v16
    v_fmac_f32 v238, v209, v17
    v_mfma_f32_16x16x32_bf16 v[196:199], v[108:111], v[156:159], v[196:199]
    ds_read_b128 v[160:163], v229 offset:0
    ds_read_b128 v[164:167], v229 offset:64
    v_smfmac_f32_16x16x64_bf16 v[52:55], v[64:67], v[184:191], v252
    v_fmac_f32 v238, v210, v18
    v_smfmac_f32_16x16x64_bf16 v[68:71], v[84:87], v[136:143], v253
    v_fmac_f32 v238, v211, v19
    v_mfma_f32_16x16x32_bf16 v[184:187], v[136:139], v[136:139], 0
    v_fmac_f32 v238, v192, v20
    v_fmac_f32 v238, v193, v21
    v_mfma_f32_16x16x32_bf16 v[184:187], v[140:143], v[140:143], v[184:187]
    v_fmac_f32 v238, v194, v22
    v_fmac_f32 v238, v195, v23
    v_mfma_f32_16x16x32_bf16 v[188:191], v[136:139], v[152:155], 0
    v_fmac_f32 v238, v70, v91
    v_fmac_f32 v238, v71, v91
    v_mfma_f32_16x16x32_bf16 v[188:191], v[140:143], v[156:159], v[188:191]
    v_fmac_f32 v238, v196, v24
    v_fmac_f32 v238, v197, v25
    v_mfma_f32_16x16x32_bf16 v[200:203], v[176:179], v[176:179], 0
    v_fmac_f32 v238, v198, v26
    v_fmac_f32 v238, v199, v27
    v_mfma_f32_16x16x32_bf16 v[200:203], v[180:183], v[180:183], v[200:203]
    v_mov_b64 v[248:249], 0
    v_mov_b64 v[250:251], 0
    v_mfma_f32_16x16x32_bf16 v[204:207], v[104:107], v[168:171], 0
    v_mfma_f32_16x16x32_bf16 v[204:207], v[108:111], v[172:175], v[204:207]
    ds_read_b128 v[104:107], v225 offset:0
    ds_read_b128 v[108:111], v225 offset:64
    v_mfma_f32_16x16x32_bf16 v[208:211], v[120:123], v[152:155], 0
    v_mfma_f32_16x16x32_bf16 v[208:211], v[124:127], v[156:159], v[208:211]
    buffer_load_dwordx4 v[224:227], v245, s[16:19], s74 offen offset:2400
    buffer_load_dwordx2 v[228:229], v245, s[16:19], s74 offen offset:2416
    v_smfmac_f32_16x16x64_bf16 v[52:55], v[72:75], v[184:191], v252
    v_fmac_f32 v237, v200, v0
    v_smfmac_f32_16x16x64_bf16 v[68:71], v[84:87], v[152:159], v253
    v_fmac_f32 v238, v201, v1
    v_mfma_f32_16x16x32_bf16 v[184:187], v[152:155], v[152:155], 0
    v_mul_f32 v239, v202, v2
    v_mul_f32 v240, v203, v3
    v_mfma_f32_16x16x32_bf16 v[184:187], v[156:159], v[156:159], v[184:187]
    v_fmac_f32 v238, v204, v28
    v_fmac_f32 v238, v205, v29
    v_mfma_f32_16x16x32_bf16 v[188:191], v[168:171], v[168:171], 0
    v_fmac_f32 v238, v70, v92
    v_fmac_f32 v238, v71, v92
    v_mfma_f32_16x16x32_bf16 v[188:191], v[172:175], v[172:175], v[188:191]
    v_fmac_f32 v238, v206, v30
    v_fmac_f32 v238, v207, v31
    v_mfma_f32_16x16x32_bf16 v[192:195], v[120:123], v[168:171], 0
    v_fmac_f32 v238, v208, v32
    v_fmac_f32 v238, v209, v33
    v_mfma_f32_16x16x32_bf16 v[192:195], v[124:127], v[172:175], v[192:195]
    v_fmac_f32 v238, v210, v34
    v_fmac_f32 v238, v211, v35
    v_smfmac_f32_16x16x64_bf16 v[68:71], v[84:87], v[168:175], v253
    v_mfma_f32_16x16x32_bf16 v[196:199], v[136:139], v[168:171], 0
    v_mfma_f32_16x16x32_bf16 v[196:199], v[140:143], v[172:175], v[196:199]
    v_smfmac_f32_16x16x64_bf16 v[52:55], v[80:83], v[184:191], v252
    v_mfma_f32_16x16x32_bf16 v[200:203], v[152:155], v[168:171], 0
    v_mfma_f32_16x16x32_bf16 v[200:203], v[156:159], v[172:175], v[200:203]
    v_fmac_f32 v238, v192, v36
    s_waitcnt vmcnt(7) lgkmcnt(0)
    v_mfma_f32_16x16x32_bf16 v[184:187], v[96:99], v[96:99], 0
    v_mad_u32_u24 v232, v232, s57, v244
    v_mov_b64 v[68:69], 0
    v_mfma_f32_16x16x32_bf16 v[184:187], v[100:103], v[100:103], v[184:187]
    v_fmac_f32 v238, v70, v93
    v_fmac_f32 v238, v71, v93
    v_mfma_f32_16x16x32_bf16 v[188:191], v[96:99], v[104:107], 0
    v_mad_u32_u24 v233, v233, s57, v244
    v_fmac_f32 v238, v52, v60
    v_mfma_f32_16x16x32_bf16 v[188:191], v[100:103], v[108:111], v[188:191]
    ds_read_b128 v[120:123], v232 offset:0
    ds_read_b128 v[124:127], v232 offset:64
    v_mfma_f32_16x16x32_bf16 v[204:207], v[96:99], v[112:115], 0
    v_fmac_f32 v238, v53, v61
    v_fmac_f32 v238, v54, v62
    v_mfma_f32_16x16x32_bf16 v[204:207], v[100:103], v[116:119], v[204:207]
    v_fmac_f32 v238, v55, v63
    v_fmac_f32 v238, v193, v37
    v_smfmac_f32_16x16x64_bf16 v[68:71], v[76:79], v[96:103], v253
    v_fmac_f32 v238, v194, v38
    v_mfma_f32_16x16x32_bf16 v[208:211], v[96:99], v[128:131], 0
    v_fmac_f32 v238, v195, v39
    v_mad_u32_u24 v234, v234, s57, v244
    v_mfma_f32_16x16x32_bf16 v[208:211], v[100:103], v[132:135], v[208:211]
    v_mad_u32_u24 v230, v230, s57, v244
    v_fmac_f32 v238, v196, v40
    v_smfmac_f32_16x16x64_bf16 v[248:251], v[48:51], v[184:191], v252
    v_fmac_f32 v239, v68, v88
    v_mfma_f32_16x16x32_bf16 v[184:187], v[112:115], v[112:115], 0
    ds_read_b128 v[136:139], v233 offset:0
    ds_read_b128 v[140:143], v233 offset:64
    v_mfma_f32_16x16x32_bf16 v[184:187], v[116:119], v[116:119], v[184:187]
    v_fmac_f32 v239, v69, v88
    v_fmac_f32 v238, v197, v41
    v_mfma_f32_16x16x32_bf16 v[188:191], v[112:115], v[128:131], 0
    v_fmac_f32 v238, v198, v42
    v_fmac_f32 v238, v199, v43
    v_mfma_f32_16x16x32_bf16 v[188:191], v[116:119], v[132:135], v[188:191]
    v_fmac_f32 v238, v200, v44
    v_fmac_f32 v238, v201, v45
    v_smfmac_f32_16x16x64_bf16 v[68:71], v[76:79], v[112:119], v253
    v_fmac_f32 v238, v202, v46
    v_mfma_f32_16x16x32_bf16 v[192:195], v[96:99], v[144:147], 0
    v_fmac_f32 v238, v203, v47
    v_fmac_f32 v239, v204, v4
    v_mfma_f32_16x16x32_bf16 v[192:195], v[100:103], v[148:151], v[192:195]
    v_fmac_f32 v239, v205, v5
    v_fmac_f32 v239, v206, v6
    v_mfma_f32_16x16x32_bf16 v[196:199], v[96:99], v[160:163], 0
    ds_read_b128 v[152:155], v234 offset:0
    ds_read_b128 v[156:159], v234 offset:64
    v_mfma_f32_16x16x32_bf16 v[196:199], v[100:103], v[164:167], v[196:199]
    ds_read_b128 v[96:99], v230 offset:0
    ds_read_b128 v[100:103], v230 offset:64
    v_smfmac_f32_16x16x64_bf16 v[248:251], v[56:59], v[184:191], v252
    v_fmac_f32 v239, v68, v90
    v_fmac_f32 v239, v69, v90
    v_smfmac_f32_16x16x64_bf16 v[68:71], v[76:79], v[104:111], v253
    v_fmac_f32 v239, v207, v7
    v_mfma_f32_16x16x32_bf16 v[184:187], v[104:107], v[104:107], 0
    v_mad_u32_u24 v235, v235, s57, v244
    v_fmac_f32 v239, v208, v8
    v_mfma_f32_16x16x32_bf16 v[184:187], v[108:111], v[108:111], v[184:187]
    v_fmac_f32 v239, v209, v9
    v_fmac_f32 v239, v210, v10
    v_mfma_f32_16x16x32_bf16 v[188:191], v[104:107], v[112:115], 0
    v_fmac_f32 v239, v68, v89
    v_fmac_f32 v239, v69, v89
    v_mfma_f32_16x16x32_bf16 v[188:191], v[108:111], v[116:119], v[188:191]
    v_fmac_f32 v239, v211, v11
    v_mad_u32_u24 v231, v231, s57, v244
    v_mfma_f32_16x16x32_bf16 v[200:203], v[104:107], v[128:131], 0
    v_fmac_f32 v239, v192, v12
    v_fmac_f32 v239, v193, v13
    v_mfma_f32_16x16x32_bf16 v[200:203], v[108:111], v[132:135], v[200:203]
    v_fmac_f32 v239, v194, v14
    v_fmac_f32 v239, v195, v15
    v_mfma_f32_16x16x32_bf16 v[204:207], v[104:107], v[144:147], 0
    v_fmac_f32 v239, v196, v16
    v_fmac_f32 v239, v197, v17
    v_mfma_f32_16x16x32_bf16 v[204:207], v[108:111], v[148:151], v[204:207]
    ds_read_b128 v[168:171], v235 offset:0
    ds_read_b128 v[172:175], v235 offset:64
    v_smfmac_f32_16x16x64_bf16 v[248:251], v[64:67], v[184:191], v252
    v_fmac_f32 v239, v198, v18
    v_smfmac_f32_16x16x64_bf16 v[68:71], v[76:79], v[128:135], v253
    v_fmac_f32 v239, v199, v19
    v_mfma_f32_16x16x32_bf16 v[184:187], v[128:131], v[128:131], 0
    v_fmac_f32 v239, v200, v20
    v_fmac_f32 v239, v201, v21
    v_mfma_f32_16x16x32_bf16 v[184:187], v[132:135], v[132:135], v[184:187]
    v_fmac_f32 v239, v202, v22
    v_fmac_f32 v239, v203, v23
    v_mfma_f32_16x16x32_bf16 v[188:191], v[128:131], v[144:147], 0
    v_fmac_f32 v239, v68, v91
    v_fmac_f32 v239, v69, v91
    v_mfma_f32_16x16x32_bf16 v[188:191], v[132:135], v[148:151], v[188:191]
    v_fmac_f32 v239, v204, v24
    v_fmac_f32 v239, v205, v25
    v_mfma_f32_16x16x32_bf16 v[208:211], v[104:107], v[160:163], 0
    v_fmac_f32 v239, v206, v26
    v_fmac_f32 v239, v207, v27
    v_mfma_f32_16x16x32_bf16 v[208:211], v[108:111], v[164:167], v[208:211]
    ds_read_b128 v[104:107], v231 offset:0
    ds_read_b128 v[108:111], v231 offset:64
    v_mfma_f32_16x16x32_bf16 v[192:195], v[112:115], v[144:147], 0
    v_mov_b64 v[52:53], 0
    v_mov_b64 v[54:55], 0
    v_mfma_f32_16x16x32_bf16 v[192:195], v[116:119], v[148:151], v[192:195]
    buffer_load_dwordx4 v[230:233], v245, s[16:19], s74 offen offset:2800
    buffer_load_dwordx2 v[234:235], v245, s[16:19], s74 offen offset:2816
    v_smfmac_f32_16x16x64_bf16 v[248:251], v[72:75], v[184:191], v252
    v_fmac_f32 v239, v208, v28
    v_smfmac_f32_16x16x64_bf16 v[68:71], v[76:79], v[144:151], v253
    v_fmac_f32 v239, v209, v29
    v_mfma_f32_16x16x32_bf16 v[184:187], v[144:147], v[144:147], 0
    v_fmac_f32 v239, v210, v30
    v_fmac_f32 v239, v211, v31
    v_mfma_f32_16x16x32_bf16 v[184:187], v[148:151], v[148:151], v[184:187]
    v_fmac_f32 v239, v192, v32
    v_fmac_f32 v239, v193, v33
    v_mfma_f32_16x16x32_bf16 v[188:191], v[160:163], v[160:163], 0
    v_fmac_f32 v239, v68, v92
    v_fmac_f32 v239, v69, v92
    v_mfma_f32_16x16x32_bf16 v[188:191], v[164:167], v[164:167], v[188:191]
    v_fmac_f32 v239, v194, v34
    v_fmac_f32 v239, v195, v35
    v_mfma_f32_16x16x32_bf16 v[196:199], v[112:115], v[160:163], 0
    v_permlane32_swap_b32 v237, v238
    v_mfma_f32_16x16x32_bf16 v[196:199], v[116:119], v[164:167], v[196:199]
    v_add_f32 v241, v237, v238
    v_smfmac_f32_16x16x64_bf16 v[68:71], v[76:79], v[160:167], v253
    v_mfma_f32_16x16x32_bf16 v[200:203], v[128:131], v[160:163], 0
    v_mfma_f32_16x16x32_bf16 v[200:203], v[132:135], v[164:167], v[200:203]
    v_smfmac_f32_16x16x64_bf16 v[248:251], v[80:83], v[184:191], v252
    v_mfma_f32_16x16x32_bf16 v[204:207], v[144:147], v[160:163], 0
    v_mfma_f32_16x16x32_bf16 v[204:207], v[148:151], v[164:167], v[204:207]
    s_waitcnt vmcnt(6) lgkmcnt(0)
    v_mfma_f32_16x16x32_bf16 v[184:187], v[96:99], v[96:99], 0
    v_mad_u32_u24 v214, v214, s57, v244
    v_mov_b64 v[70:71], 0
    v_mfma_f32_16x16x32_bf16 v[184:187], v[100:103], v[100:103], v[184:187]
    v_fmac_f32 v239, v68, v93
    v_fmac_f32 v239, v69, v93
    v_mfma_f32_16x16x32_bf16 v[188:191], v[96:99], v[104:107], 0
    v_mad_u32_u24 v215, v215, s57, v244
    v_fmac_f32 v239, v248, v60
    v_mfma_f32_16x16x32_bf16 v[188:191], v[100:103], v[108:111], v[188:191]
    ds_read_b128 v[112:115], v214 offset:0
    ds_read_b128 v[116:119], v214 offset:64
    v_mfma_f32_16x16x32_bf16 v[208:211], v[96:99], v[120:123], 0
    v_fmac_f32 v239, v249, v61
    v_fmac_f32 v239, v250, v62
    v_mfma_f32_16x16x32_bf16 v[208:211], v[100:103], v[124:127], v[208:211]
    v_fmac_f32 v239, v251, v63
    v_fmac_f32 v239, v196, v36
    v_smfmac_f32_16x16x64_bf16 v[68:71], v[76:79], v[96:103], v253
    v_fmac_f32 v239, v197, v37
    v_mfma_f32_16x16x32_bf16 v[192:195], v[96:99], v[136:139], 0
    v_fmac_f32 v239, v198, v38
    v_fmac_f32 v239, v199, v39
    v_mfma_f32_16x16x32_bf16 v[192:195], v[100:103], v[140:143], v[192:195]
    v_mad_u32_u24 v216, v216, s57, v244
    v_mad_u32_u24 v212, v212, s57, v244
    v_smfmac_f32_16x16x64_bf16 v[52:55], v[48:51], v[184:191], v252
    v_fmac_f32 v240, v70, v88
    v_mfma_f32_16x16x32_bf16 v[184:187], v[120:123], v[120:123], 0
    ds_read_b128 v[128:131], v215 offset:0
    ds_read_b128 v[132:135], v215 offset:64
    v_mfma_f32_16x16x32_bf16 v[184:187], v[124:127], v[124:127], v[184:187]
    v_fmac_f32 v240, v71, v88
    v_fmac_f32 v239, v200, v40
    v_mfma_f32_16x16x32_bf16 v[188:191], v[120:123], v[136:139], 0
    v_fmac_f32 v239, v201, v41
    v_fmac_f32 v239, v202, v42
    v_mfma_f32_16x16x32_bf16 v[188:191], v[124:127], v[140:143], v[188:191]
    v_fmac_f32 v239, v203, v43
    v_fmac_f32 v239, v204, v44
    v_smfmac_f32_16x16x64_bf16 v[68:71], v[76:79], v[120:127], v253
    v_fmac_f32 v239, v205, v45
    v_mfma_f32_16x16x32_bf16 v[196:199], v[96:99], v[152:155], 0
    v_fmac_f32 v239, v206, v46
    v_fmac_f32 v239, v207, v47
    v_mfma_f32_16x16x32_bf16 v[196:199], v[100:103], v[156:159], v[196:199]
    v_fmac_f32 v240, v208, v4
    v_fmac_f32 v240, v209, v5
    v_mfma_f32_16x16x32_bf16 v[200:203], v[96:99], v[168:171], 0
    ds_read_b128 v[144:147], v216 offset:0
    ds_read_b128 v[148:151], v216 offset:64
    v_mfma_f32_16x16x32_bf16 v[200:203], v[100:103], v[172:175], v[200:203]
    ds_read_b128 v[96:99], v212 offset:0
    ds_read_b128 v[100:103], v212 offset:64
    v_smfmac_f32_16x16x64_bf16 v[52:55], v[56:59], v[184:191], v252
    v_fmac_f32 v240, v70, v90
    v_fmac_f32 v240, v71, v90
    v_smfmac_f32_16x16x64_bf16 v[68:71], v[76:79], v[104:111], v253
    v_fmac_f32 v240, v210, v6
    v_mfma_f32_16x16x32_bf16 v[184:187], v[104:107], v[104:107], 0
    v_fmac_f32 v240, v211, v7
    v_mad_u32_u24 v217, v217, s57, v244
    v_mfma_f32_16x16x32_bf16 v[184:187], v[108:111], v[108:111], v[184:187]
    v_fmac_f32 v240, v192, v8
    v_fmac_f32 v240, v193, v9
    v_mfma_f32_16x16x32_bf16 v[188:191], v[104:107], v[120:123], 0
    v_fmac_f32 v240, v70, v89
    v_fmac_f32 v240, v71, v89
    v_mfma_f32_16x16x32_bf16 v[188:191], v[108:111], v[124:127], v[188:191]
    v_fmac_f32 v240, v194, v10
    v_fmac_f32 v240, v195, v11
    v_mfma_f32_16x16x32_bf16 v[204:207], v[104:107], v[136:139], 0
    v_mad_u32_u24 v213, v213, s57, v244
    v_fmac_f32 v240, v196, v12
    v_mfma_f32_16x16x32_bf16 v[204:207], v[108:111], v[140:143], v[204:207]
    v_fmac_f32 v240, v197, v13
    v_fmac_f32 v240, v198, v14
    v_mfma_f32_16x16x32_bf16 v[208:211], v[104:107], v[152:155], 0
    v_fmac_f32 v240, v199, v15
    v_mad_u32_u24 v236, v236, s57, v244
    v_mfma_f32_16x16x32_bf16 v[208:211], v[108:111], v[156:159], v[208:211]
    ds_read_b128 v[160:163], v217 offset:0
    ds_read_b128 v[164:167], v217 offset:64
    v_smfmac_f32_16x16x64_bf16 v[52:55], v[64:67], v[184:191], v252
    v_add_u32_dpp v86, v236, v247 quad_perm:[0,0,1,1] row_mask:0xf bank_mask:0xf
    v_smfmac_f32_16x16x64_bf16 v[68:71], v[76:79], v[136:143], v253
    v_fmac_f32 v240, v200, v16
    v_mfma_f32_16x16x32_bf16 v[184:187], v[136:139], v[136:139], 0
    v_fmac_f32 v240, v201, v17
    v_fmac_f32 v240, v202, v18
    v_mfma_f32_16x16x32_bf16 v[184:187], v[140:143], v[140:143], v[184:187]
    v_fmac_f32 v240, v203, v19
    v_fmac_f32 v240, v204, v20
    v_mfma_f32_16x16x32_bf16 v[188:191], v[136:139], v[152:155], 0
    v_fmac_f32 v240, v70, v91
    v_fmac_f32 v240, v71, v91
    v_mfma_f32_16x16x32_bf16 v[188:191], v[140:143], v[156:159], v[188:191]
    v_fmac_f32 v240, v205, v21
    v_fmac_f32 v240, v206, v22
    v_mfma_f32_16x16x32_bf16 v[192:195], v[104:107], v[168:171], 0
    v_fmac_f32 v240, v207, v23
    v_fmac_f32 v240, v208, v24
    v_mfma_f32_16x16x32_bf16 v[192:195], v[108:111], v[172:175], v[192:195]
    ds_read_b128 v[104:107], v213 offset:0
    ds_read_b128 v[108:111], v213 offset:64
    v_mfma_f32_16x16x32_bf16 v[196:199], v[120:123], v[152:155], 0
    v_fmac_f32 v240, v209, v25
    v_fmac_f32 v240, v210, v26
    v_mfma_f32_16x16x32_bf16 v[196:199], v[124:127], v[156:159], v[196:199]
    v_fmac_f32 v240, v211, v27
    v_mov_b64 v[248:249], 0
    v_smfmac_f32_16x16x64_bf16 v[52:55], v[72:75], v[184:191], v252
    v_fmac_f32 v240, v192, v28
    v_smfmac_f32_16x16x64_bf16 v[68:71], v[76:79], v[152:159], v253
    v_fmac_f32 v240, v193, v29
    v_mfma_f32_16x16x32_bf16 v[184:187], v[152:155], v[152:155], 0
    ds_read_b128 v[176:179], v236 offset:0
    ds_read_b128 v[180:183], v236 offset:64
    v_mfma_f32_16x16x32_bf16 v[184:187], v[156:159], v[156:159], v[184:187]
    v_fmac_f32 v240, v194, v30
    v_fmac_f32 v240, v195, v31
    v_mfma_f32_16x16x32_bf16 v[188:191], v[168:171], v[168:171], 0
    v_fmac_f32 v240, v70, v92
    v_fmac_f32 v240, v71, v92
    v_mfma_f32_16x16x32_bf16 v[188:191], v[172:175], v[172:175], v[188:191]
    ds_read2_b32 v[84:85], v86 offset0:0 offset1:2
    ds_read2_b32 v[86:87], v86 offset0:4 offset1:6
    v_mfma_f32_16x16x32_bf16 v[200:203], v[120:123], v[168:171], 0
    v_fmac_f32 v240, v196, v32
    v_fmac_f32 v240, v197, v33
    v_mfma_f32_16x16x32_bf16 v[200:203], v[124:127], v[172:175], v[200:203]
    buffer_load_dwordx4 v[212:215], v245, s[16:19], s74 offen offset:3200
    buffer_load_dwordx2 v[216:217], v245, s[16:19], s74 offen offset:3216
    v_smfmac_f32_16x16x64_bf16 v[68:71], v[76:79], v[168:175], v253
    s_add_u32 s74, s74, 1600
    v_mfma_f32_16x16x32_bf16 v[204:207], v[136:139], v[168:171], 0
    s_cmp_lt_u32 s74, s58
    v_fmac_f32 v240, v198, v34
    v_mfma_f32_16x16x32_bf16 v[204:207], v[140:143], v[172:175], v[204:207]
    v_fmac_f32 v240, v199, v35
    v_mov_b64 v[250:251], 0
    v_smfmac_f32_16x16x64_bf16 v[52:55], v[80:83], v[184:191], v252
    v_mov_b64 v[68:69], 0
    v_mfma_f32_16x16x32_bf16 v[208:211], v[152:155], v[168:171], 0
    v_fmac_f32 v240, v70, v93
    v_fmac_f32 v240, v71, v93
    v_mfma_f32_16x16x32_bf16 v[208:211], v[156:159], v[172:175], v[208:211]
    s_waitcnt vmcnt(6) lgkmcnt(0)
    s_cbranch_scc1 standalone__deep_cross_pnn__recsys_kernel_loop
    s_branch standalone__deep_cross_pnn__recsys_kernel_k2m
standalone__deep_cross_pnn__recsys_kernel_aux:

    s_setprio 0
    s_load_dword s24, s[60:61], 0
    s_load_dword s25, s[60:61], 16
    s_load_dword s26, s[60:61], 32
    s_load_dword s27, s[60:61], 48
    v_mov_b32 v8, v255
    v_mov_b32 v9, v254
    v_mov_b32 v10, v253
    v_mov_b32 v11, v252
    s_mov_b32 s51, s2
    s_mov_b32 s64, 0
    s_mov_b32 s65, 0

    v_mov_b32 v35, v83
    s_lshr_b32 s72, s2, 3
    s_mul_i32 s72, s72, 36
    s_lshr_b32 s72, s72, 5
    s_lshl_b32 s75, s36, 7
    s_add_u32 s75, s75, 254464
    s_mov_b32 s76, 143136
    s_lshl_b32 s6, s2, 15
    s_lshl_b32 s7, s56, 13
    s_add_u32 s6, s6, s7
    s_add_u32 s6, s6, 20971520
    s_add_u32 s7, s6, 4096
    s_lshl_b32 s8, s36, 7
    s_add_u32 s8, s8, s37
    s_lshl_b32 s8, s8, 9
    s_add_u32 s8, s8, 29360128
    s_and_b32 s9, s2, 63
    s_lshl_b32 s9, s9, 5
    s_lshr_b32 s38, s2, 6
    s_add_u32 s9, s9, s38
    s_lshl_b32 s9, s9, 2
    s_add_u32 s9, s9, 14680064
    v_mov_b32 v112, 0

standalone__deep_cross_pnn__recsys_kernel_unit:

    s_bfe_u32 s36, s51, 0x10003

    s_lshr_b32 s38, s51, 4
    s_and_b32 s39, s51, 7
    s_sub_u32 s57, 2, s36
    s_lshl_b32 s57, s39, s57
    s_lshl_b32 s37, s36, 5
    s_add_u32 s57, s57, s37
    s_add_u32 s57, s57, s56
    s_mul_i32 s37, s38, 48
    s_add_u32 s37, s37, s57
    s_lshl_b32 s38, s38, 1
    s_lshr_b32 s39, s39, 2
    s_add_u32 s38, s38, s39
    s_add_u32 s38, s38, 768
    s_and_b32 s57, s57, 7
    s_cmp_eq_u32 s57, 2
    s_cselect_b32 s38, s38, 1000
    s_lshl_b32 s39, s36, 1
    s_and_b32 s39, s39, s56
    s_cselect_b32 s57, s38, s37

    s_lshr_b32 s37, s51, 4
    s_lshl_b32 s37, s37, 3
    s_and_b32 s38, s51, 7
    s_or_b32 s37, s37, s38
    s_and_b32 s58, s56, 1
    s_lshl_b32 s59, s37, 1
    s_add_u32 s58, s58, s59
    s_lshr_b32 s59, s56, 1
    s_xor_b32 s60, s36, 1
    s_mul_i32 s46, s60, 13
    s_lshl_b32 s60, s60, 1
    s_add_u32 s59, s59, s60
    s_add_u32 s61, s46, 6
    s_add_u32 s60, s46, 12
    s_bitcmp1_b32 s59, 0
    s_cselect_b32 s46, s60, s46
    s_cselect_b32 s63, -1, 1
    s_cselect_b32 s61, 24, s61
    v_lshrrev_b32 v1, 3, v8
    v_and_b32 v2, 7, v8
    v_mul_i32_i24 v7, s63, v2
    v_add_u32 v7, s46, v7
    v_cmp_ge_u32 s[48:49], s61, v7
    s_mul_i32 s60, s58, 25600
    s_movk_i32 s61, 400
    s_lshl_b32 s63, s63, 16
    v_mul_u32_u24 v0, s61, v1
    v_lshl_add_u32 v0, v7, 4, v0
    v_and_b32 v5, 15, v8
    v_and_b32 v6, 48, v8
    v_lshl_add_u32 v56, v5, 8, v6
    s_lshr_b32 s44, s37, 1
    s_lshl_b32 s44, s44, 12
    s_lshl_b32 s38, s36, 1
    s_and_b32 s39, s37, 1
    s_add_u32 s38, s38, s39
    s_lshl_b32 s38, s38, 6
    s_add_u32 s44, s44, s38
    s_lshl_b32 s47, s36, 7
    s_add_u32 s47, s47, s37
    s_lshl_b32 s47, s47, 10
    s_add_u32 s47, s47, 15204352

    s_cmp_eq_u32 s56, 0
    s_cselect_b64 s[4:5], -1, 0
    s_cmp_lg_u32 s64, 0
    s_cbranch_scc1 standalone__deep_cross_pnn__recsys_kernel_nd1
    s_mov_b64 exec, s[40:41]

    s_mul_i32 s73, s72, 4032
    s_mul_i32 s74, s72, 7168
    s_add_u32 s73, s73, s43
    s_add_u32 s74, s74, s42
    s_min_u32 m0, s73, s76
    s_min_u32 s74, s74, s75
    s_add_u32 s72, s72, 1

    buffer_load_dwordx4 v35, s[20:23], s74 offen lds
    s_cmp_eq_u32 s72, 36
    s_cselect_b32 s72, 0, s72

    s_mul_i32 s73, s72, 4032
    s_mul_i32 s74, s72, 7168
    s_add_u32 s73, s73, s43
    s_add_u32 s74, s74, s42
    s_min_u32 m0, s73, s76
    s_min_u32 s74, s74, s75
    s_add_u32 s72, s72, 1

    buffer_load_dwordx4 v35, s[20:23], s74 offen lds
    s_cmp_eq_u32 s72, 36
    s_cselect_b32 s72, 0, s72

    s_mul_i32 s73, s72, 4032
    s_mul_i32 s74, s72, 7168
    s_add_u32 s73, s73, s43
    s_add_u32 s74, s74, s42
    s_min_u32 m0, s73, s76
    s_min_u32 s74, s74, s75
    s_add_u32 s72, s72, 1

    buffer_load_dwordx4 v35, s[20:23], s74 offen lds
    s_cmp_eq_u32 s72, 36
    s_cselect_b32 s72, 0, s72

    s_mul_i32 s73, s72, 4032
    s_mul_i32 s74, s72, 7168
    s_add_u32 s73, s73, s43
    s_add_u32 s74, s74, s42
    s_min_u32 m0, s73, s76
    s_min_u32 s74, s74, s75
    s_add_u32 s72, s72, 1

    buffer_load_dwordx4 v35, s[20:23], s74 offen lds
    s_cmp_eq_u32 s72, 36
    s_cselect_b32 s72, 0, s72

    s_mul_i32 s73, s72, 4032
    s_mul_i32 s74, s72, 7168
    s_add_u32 s73, s73, s43
    s_add_u32 s74, s74, s42
    s_min_u32 m0, s73, s76
    s_min_u32 s74, s74, s75
    s_add_u32 s72, s72, 1

    buffer_load_dwordx4 v35, s[20:23], s74 offen lds
    s_cmp_eq_u32 s72, 36
    s_cselect_b32 s72, 0, s72

    s_mul_i32 s73, s72, 4032
    s_mul_i32 s74, s72, 7168
    s_add_u32 s73, s73, s43
    s_add_u32 s74, s74, s42
    s_min_u32 m0, s73, s76
    s_min_u32 s74, s74, s75
    s_add_u32 s72, s72, 1

    buffer_load_dwordx4 v35, s[20:23], s74 offen lds
    s_cmp_eq_u32 s72, 36
    s_cselect_b32 s72, 0, s72

    s_mul_i32 s73, s72, 4032
    s_mul_i32 s74, s72, 7168
    s_add_u32 s73, s73, s43
    s_add_u32 s74, s74, s42
    s_min_u32 m0, s73, s76
    s_min_u32 s74, s74, s75
    s_add_u32 s72, s72, 1

    buffer_load_dwordx4 v35, s[20:23], s74 offen lds
    s_cmp_eq_u32 s72, 36
    s_cselect_b32 s72, 0, s72

    s_mul_i32 s73, s72, 4032
    s_mul_i32 s74, s72, 7168
    s_add_u32 s73, s73, s43
    s_add_u32 s74, s74, s42
    s_min_u32 m0, s73, s76
    s_min_u32 s74, s74, s75
    s_add_u32 s72, s72, 1

    buffer_load_dwordx4 v35, s[20:23], s74 offen lds
    s_cmp_eq_u32 s72, 36
    s_cselect_b32 s72, 0, s72

    s_mul_i32 s73, s72, 4032
    s_mul_i32 s74, s72, 7168
    s_add_u32 s73, s73, s43
    s_add_u32 s74, s74, s42
    s_min_u32 m0, s73, s76
    s_min_u32 s74, s74, s75
    s_add_u32 s72, s72, 1
    s_barrier

    buffer_load_dwordx4 v35, s[20:23], s74 offen lds
    s_cmp_eq_u32 s72, 36
    s_cselect_b32 s72, 0, s72

    s_mul_i32 s73, s72, 4032
    s_mul_i32 s74, s72, 7168
    s_add_u32 s73, s73, s43
    s_add_u32 s74, s74, s42
    s_min_u32 m0, s73, s76
    s_min_u32 s74, s74, s75
    s_add_u32 s72, s72, 1

    buffer_load_dwordx4 v35, s[20:23], s74 offen lds
    s_cmp_eq_u32 s72, 36
    s_cselect_b32 s72, 0, s72

    s_mul_i32 s73, s72, 4032
    s_mul_i32 s74, s72, 7168
    s_add_u32 s73, s73, s43
    s_add_u32 s74, s74, s42
    s_min_u32 m0, s73, s76
    s_min_u32 s74, s74, s75
    s_add_u32 s72, s72, 1

    buffer_load_dwordx4 v35, s[20:23], s74 offen lds
    s_cmp_eq_u32 s72, 36
    s_cselect_b32 s72, 0, s72

    s_mul_i32 s73, s72, 4032
    s_mul_i32 s74, s72, 7168
    s_add_u32 s73, s73, s43
    s_add_u32 s74, s74, s42
    s_min_u32 m0, s73, s76
    s_min_u32 s74, s74, s75
    s_add_u32 s72, s72, 1

    buffer_load_dwordx4 v35, s[20:23], s74 offen lds
    s_cmp_eq_u32 s72, 36
    s_cselect_b32 s72, 0, s72

    s_mov_b64 exec, -1
standalone__deep_cross_pnn__recsys_kernel_nd1:

    s_lshr_b32 s78, s57, 5
    s_bfe_u32 s79, s57, 0x20003
    s_bfe_u32 s80, s57, 0x20001
    s_and_b32 s81, s57, 1
    s_lshl_b32 s77, s78, 2
    s_lshl_b32 s83, s81, 1
    s_add_u32 s77, s77, s83
    s_lshl_b32 s77, s77, 7
    s_lshl_b32 s83, s79, 5
    s_add_u32 s77, s77, s83
    s_lshl_b32 s83, s80, 3
    s_add_u32 s77, s77, s83
    s_lshl_b32 s77, s77, 10
    s_lshl_b32 s82, s78, 12
    s_lshl_b32 s83, s79, 10
    s_add_u32 s82, s82, s83
    s_lshl_b32 s83, s80, 8
    s_add_u32 s82, s82, s83
    s_lshl_b32 s83, s81, 7
    s_add_u32 s82, s82, s83
    s_mov_b32 s84, 821248
    v_mul_lo_u32 v14, v1, s84
    v_lshl_add_u32 v14, v2, 4, v14
    s_cmp_ge_u32 s57, 800
    s_cselect_b32 s83, 0x40000000, 0
    v_or_b32 v14, s83, v14
    v_and_b32 v3, 3, v8
    v_lshlrev_b32 v3, 4, v3
    v_lshl_or_b32 v3, v1, 6, v3
    v_and_b32 v4, 4, v8
    v_lshl_or_b32 v15, v4, 15, v3
    s_mov_b32 s84, 0x05040100
    s_mov_b32 s85, 0x07060302

    s_cmp_lg_u32 s64, 0
    s_cbranch_scc1 standalone__deep_cross_pnn__recsys_kernel_nd2
    s_mov_b64 exec, s[40:41]

    s_mul_i32 s73, s72, 4032
    s_mul_i32 s74, s72, 7168
    s_add_u32 s73, s73, s43
    s_add_u32 s74, s74, s42
    s_min_u32 m0, s73, s76
    s_min_u32 s74, s74, s75
    s_add_u32 s72, s72, 1

    buffer_load_dwordx4 v35, s[20:23], s74 offen lds
    s_cmp_eq_u32 s72, 36
    s_cselect_b32 s72, 0, s72

    s_mul_i32 s73, s72, 4032
    s_mul_i32 s74, s72, 7168
    s_add_u32 s73, s73, s43
    s_add_u32 s74, s74, s42
    s_min_u32 m0, s73, s76
    s_min_u32 s74, s74, s75
    s_add_u32 s72, s72, 1

    buffer_load_dwordx4 v35, s[20:23], s74 offen lds
    s_cmp_eq_u32 s72, 36
    s_cselect_b32 s72, 0, s72

    s_mul_i32 s73, s72, 4032
    s_mul_i32 s74, s72, 7168
    s_add_u32 s73, s73, s43
    s_add_u32 s74, s74, s42
    s_min_u32 m0, s73, s76
    s_min_u32 s74, s74, s75
    s_add_u32 s72, s72, 1

    buffer_load_dwordx4 v35, s[20:23], s74 offen lds
    s_cmp_eq_u32 s72, 36
    s_cselect_b32 s72, 0, s72

    s_mul_i32 s73, s72, 4032
    s_mul_i32 s74, s72, 7168
    s_add_u32 s73, s73, s43
    s_add_u32 s74, s74, s42
    s_min_u32 m0, s73, s76
    s_min_u32 s74, s74, s75
    s_add_u32 s72, s72, 1

    buffer_load_dwordx4 v35, s[20:23], s74 offen lds
    s_cmp_eq_u32 s72, 36
    s_cselect_b32 s72, 0, s72

    s_mul_i32 s73, s72, 4032
    s_mul_i32 s74, s72, 7168
    s_add_u32 s73, s73, s43
    s_add_u32 s74, s74, s42
    s_min_u32 m0, s73, s76
    s_min_u32 s74, s74, s75
    s_add_u32 s72, s72, 1

    buffer_load_dwordx4 v35, s[20:23], s74 offen lds
    s_cmp_eq_u32 s72, 36
    s_cselect_b32 s72, 0, s72

    s_mul_i32 s73, s72, 4032
    s_mul_i32 s74, s72, 7168
    s_add_u32 s73, s73, s43
    s_add_u32 s74, s74, s42
    s_min_u32 m0, s73, s76
    s_min_u32 s74, s74, s75
    s_add_u32 s72, s72, 1

    buffer_load_dwordx4 v35, s[20:23], s74 offen lds
    s_cmp_eq_u32 s72, 36
    s_cselect_b32 s72, 0, s72

    s_mul_i32 s73, s72, 4032
    s_mul_i32 s74, s72, 7168
    s_add_u32 s73, s73, s43
    s_add_u32 s74, s74, s42
    s_min_u32 m0, s73, s76
    s_min_u32 s74, s74, s75
    s_add_u32 s72, s72, 1

    buffer_load_dwordx4 v35, s[20:23], s74 offen lds
    s_cmp_eq_u32 s72, 36
    s_cselect_b32 s72, 0, s72

    s_mul_i32 s73, s72, 4032
    s_mul_i32 s74, s72, 7168
    s_add_u32 s73, s73, s43
    s_add_u32 s74, s74, s42
    s_min_u32 m0, s73, s76
    s_min_u32 s74, s74, s75
    s_add_u32 s72, s72, 1

    buffer_load_dwordx4 v35, s[20:23], s74 offen lds
    s_cmp_eq_u32 s72, 36
    s_cselect_b32 s72, 0, s72

    s_mul_i32 s73, s72, 4032
    s_mul_i32 s74, s72, 7168
    s_add_u32 s73, s73, s43
    s_add_u32 s74, s74, s42
    s_min_u32 m0, s73, s76
    s_min_u32 s74, s74, s75
    s_add_u32 s72, s72, 1

    buffer_load_dwordx4 v35, s[20:23], s74 offen lds
    s_cmp_eq_u32 s72, 36
    s_cselect_b32 s72, 0, s72

    s_mul_i32 s73, s72, 4032
    s_mul_i32 s74, s72, 7168
    s_add_u32 s73, s73, s43
    s_add_u32 s74, s74, s42
    s_min_u32 m0, s73, s76
    s_min_u32 s74, s74, s75
    s_add_u32 s72, s72, 1

    buffer_load_dwordx4 v35, s[20:23], s74 offen lds
    s_cmp_eq_u32 s72, 36
    s_cselect_b32 s72, 0, s72

    s_mul_i32 s73, s72, 4032
    s_mul_i32 s74, s72, 7168
    s_add_u32 s73, s73, s43
    s_add_u32 s74, s74, s42
    s_min_u32 m0, s73, s76
    s_min_u32 s74, s74, s75
    s_add_u32 s72, s72, 1

    buffer_load_dwordx4 v35, s[20:23], s74 offen lds
    s_cmp_eq_u32 s72, 36
    s_cselect_b32 s72, 0, s72

    s_mul_i32 s73, s72, 4032
    s_mul_i32 s74, s72, 7168
    s_add_u32 s73, s73, s43
    s_add_u32 s74, s74, s42
    s_min_u32 m0, s73, s76
    s_min_u32 s74, s74, s75
    s_add_u32 s72, s72, 1

    buffer_load_dwordx4 v35, s[20:23], s74 offen lds
    s_cmp_eq_u32 s72, 36
    s_cselect_b32 s72, 0, s72

    s_mul_i32 s73, s72, 4032
    s_mul_i32 s74, s72, 7168
    s_add_u32 s73, s73, s43
    s_add_u32 s74, s74, s42
    s_min_u32 m0, s73, s76
    s_min_u32 s74, s74, s75
    s_add_u32 s72, s72, 1

    buffer_load_dwordx4 v35, s[20:23], s74 offen lds
    s_cmp_eq_u32 s72, 36
    s_cselect_b32 s72, 0, s72

    s_mul_i32 s73, s72, 4032
    s_mul_i32 s74, s72, 7168
    s_add_u32 s73, s73, s43
    s_add_u32 s74, s74, s42
    s_min_u32 m0, s73, s76
    s_min_u32 s74, s74, s75
    s_add_u32 s72, s72, 1

    buffer_load_dwordx4 v35, s[20:23], s74 offen lds
    s_cmp_eq_u32 s72, 36
    s_cselect_b32 s72, 0, s72

    s_mul_i32 s73, s72, 4032
    s_mul_i32 s74, s72, 7168
    s_add_u32 s73, s73, s43
    s_add_u32 s74, s74, s42
    s_min_u32 m0, s73, s76
    s_min_u32 s74, s74, s75
    s_add_u32 s72, s72, 1

    buffer_load_dwordx4 v35, s[20:23], s74 offen lds
    s_cmp_eq_u32 s72, 36
    s_cselect_b32 s72, 0, s72

    s_mul_i32 s73, s72, 4032
    s_mul_i32 s74, s72, 7168
    s_add_u32 s73, s73, s43
    s_add_u32 s74, s74, s42
    s_min_u32 m0, s73, s76
    s_min_u32 s74, s74, s75
    s_add_u32 s72, s72, 1

    buffer_load_dwordx4 v35, s[20:23], s74 offen lds
    s_cmp_eq_u32 s72, 36
    s_cselect_b32 s72, 0, s72

    s_mul_i32 s73, s72, 4032
    s_mul_i32 s74, s72, 7168
    s_add_u32 s73, s73, s43
    s_add_u32 s74, s74, s42
    s_min_u32 m0, s73, s76
    s_min_u32 s74, s74, s75
    s_add_u32 s72, s72, 1

    buffer_load_dwordx4 v35, s[20:23], s74 offen lds
    s_cmp_eq_u32 s72, 36
    s_cselect_b32 s72, 0, s72

    s_mul_i32 s73, s72, 4032
    s_mul_i32 s74, s72, 7168
    s_add_u32 s73, s73, s43
    s_add_u32 s74, s74, s42
    s_min_u32 m0, s73, s76
    s_min_u32 s74, s74, s75
    s_add_u32 s72, s72, 1

    buffer_load_dwordx4 v35, s[20:23], s74 offen lds
    s_cmp_eq_u32 s72, 36
    s_cselect_b32 s72, 0, s72

    s_mul_i32 s73, s72, 4032
    s_mul_i32 s74, s72, 7168
    s_add_u32 s73, s73, s43
    s_add_u32 s74, s74, s42
    s_min_u32 m0, s73, s76
    s_min_u32 s74, s74, s75
    s_add_u32 s72, s72, 1

    buffer_load_dwordx4 v35, s[20:23], s74 offen lds
    s_cmp_eq_u32 s72, 36
    s_cselect_b32 s72, 0, s72

    s_mul_i32 s73, s72, 4032
    s_mul_i32 s74, s72, 7168
    s_add_u32 s73, s73, s43
    s_add_u32 s74, s74, s42
    s_min_u32 m0, s73, s76
    s_min_u32 s74, s74, s75
    s_add_u32 s72, s72, 1

    buffer_load_dwordx4 v35, s[20:23], s74 offen lds
    s_cmp_eq_u32 s72, 36
    s_cselect_b32 s72, 0, s72

    s_mul_i32 s73, s72, 4032
    s_mul_i32 s74, s72, 7168
    s_add_u32 s73, s73, s43
    s_add_u32 s74, s74, s42
    s_min_u32 m0, s73, s76
    s_min_u32 s74, s74, s75
    s_add_u32 s72, s72, 1

    buffer_load_dwordx4 v35, s[20:23], s74 offen lds
    s_cmp_eq_u32 s72, 36
    s_cselect_b32 s72, 0, s72

    s_mul_i32 s73, s72, 4032
    s_mul_i32 s74, s72, 7168
    s_add_u32 s73, s73, s43
    s_add_u32 s74, s74, s42
    s_min_u32 m0, s73, s76
    s_min_u32 s74, s74, s75
    s_add_u32 s72, s72, 1

    buffer_load_dwordx4 v35, s[20:23], s74 offen lds
    s_cmp_eq_u32 s72, 36
    s_cselect_b32 s72, 0, s72

    s_mul_i32 s73, s72, 4032
    s_mul_i32 s74, s72, 7168
    s_add_u32 s73, s73, s43
    s_add_u32 s74, s74, s42
    s_min_u32 m0, s73, s76
    s_min_u32 s74, s74, s75
    s_add_u32 s72, s72, 1

    buffer_load_dwordx4 v35, s[20:23], s74 offen lds
    s_cmp_eq_u32 s72, 36
    s_cselect_b32 s72, 0, s72

    s_mul_i32 s73, s72, 4032
    s_mul_i32 s74, s72, 7168
    s_add_u32 s73, s73, s43
    s_add_u32 s74, s74, s42
    s_min_u32 m0, s73, s76
    s_min_u32 s74, s74, s75
    s_add_u32 s72, s72, 1

    buffer_load_dwordx4 v35, s[20:23], s74 offen lds
    s_cmp_eq_u32 s72, 36
    s_cselect_b32 s72, 0, s72

    s_mov_b64 exec, -1
standalone__deep_cross_pnn__recsys_kernel_nd2:

    s_cmp_lg_u32 s64, 0
    s_cbranch_scc1 standalone__deep_cross_pnn__recsys_kernel_nsig
    s_waitcnt vmcnt(0)
    s_barrier

standalone__deep_cross_pnn__recsys_kernel_nsig:
    s_setprio 1
    s_mov_b64 exec, s[48:49]
    buffer_load_dwordx4 v[224:227], v0, s[16:19], s60 offen
    s_add_u32 s60, s60, 3200
    buffer_load_dwordx4 v[228:231], v0, s[16:19], s60 offen
    s_add_u32 s60, s60, 3200
    buffer_load_dwordx4 v[232:235], v0, s[16:19], s60 offen
    s_add_u32 s60, s60, 3200
    buffer_load_dwordx4 v[236:239], v0, s[16:19], s60 offen
    s_add_u32 s60, s60, 3200
    buffer_load_dwordx4 v[240:243], v0, s[16:19], s60 offen
    s_add_u32 s60, s60, 3200
    buffer_load_dwordx4 v[244:247], v0, s[16:19], s60 offen
    s_add_u32 s60, s60, 3200
    buffer_load_dwordx4 v[248:251], v0, s[16:19], s60 offen
    s_add_u32 s60, s60, 3200
    buffer_load_dwordx4 v[252:255], v0, s[16:19], s60 offen
    s_add_u32 s60, s60, 3200
    s_mov_b64 exec, -1

    s_lshl_b32 s61, s56, 8
    s_add_u32 s61, s61, 162688
    v_lshlrev_b32 v86, 2, v8
    v_add_u32 v86, s61, v86
    v_and_b32 v85, 0xffffff80, v86
    v_lshrrev_b32 v27, 5, v8
    v_mul_u32_u24 v27, 0x40404, v27
    v_lshl_or_b32 v27, v27, 8, v27
    s_mul_i32 s61, s56, 4608
    s_add_u32 s61, s61, 144256
    v_mul_u32_u24 v31, 72, v8
    v_add3_u32 v31, s61, v31, -8
    v_mul_u32_u24 v34, 72, v1
    v_lshl_add_u32 v34, v2, 3, v34
    v_add_u32 v34, s61, v34
    v_mul_u32_u24 v3, 52, v7
    v_lshrrev_b32 v3, 8, v3
    v_mad_i32_i24 v2, v3, -5, v7
    v_mov_b32 v13, 0
    v_mul_u32_u24 v2, 0x10001, v2
    v_lshlrev_b32 v2, 12, v2
    v_add_u32 v32, 67108864, v2
    v_add_u32 v33, 201328640, v2
    s_cmp_eq_u32 s59, 3
    s_cselect_b32 s61, 0x0fffff00, -16
    s_cmp_eq_u32 s59, 1
    s_cselect_b32 s61, 0x0ffffff0, s61
    v_mov_b32 v59, s61
    s_lshr_b32 s62, s58, 7
    s_mul_i32 s62, s62, 25
    s_min_u32 s46, s46, 24
    s_add_u32 s62, s62, s46
    s_lshl_b32 s62, s62, 3
    s_bfe_u32 s61, s58, 0x30004
    s_add_u32 s62, s62, s61
    s_lshl_b32 s62, s62, 13
    s_bfe_u32 s61, s58, 0x30001
    s_lshl_b32 s61, s61, 10
    s_add_u32 s62, s62, s61
    s_and_b32 s61, s58, 1
    s_lshl_b32 s46, s61, 2
    s_add_u32 s46, s46, 163712
    s_lshl_b32 s61, s61, 9
    s_add_u32 s62, s62, s61
    s_add_u32 s62, s62, 16777216
    v_and_b32 v30, 31, v8
    v_lshrrev_b32 v3, 5, v8
    v_lshlrev_b32 v30, 4, v30
    v_lshl_add_u32 v30, v3, 3, v30
    s_movk_i32 s66, 0x7c
    s_mov_b32 s67, 0x03030303
    s_mov_b32 s75, 0x06040200
    v_mov_b32 v57, 0x08040201
    v_mov_b32 v58, 0x80402010
    v_mov_b32 v108, 0xff800001
    v_mov_b32 v109, 0xff800001
    v_mov_b32 v110, 0xff800001
    v_mov_b32 v111, 0xff800001

    s_mov_b64 exec, s[48:49]

    s_waitcnt vmcnt(7)
    v_lshl_or_b32 v224, v225, 16, v224
    v_lshl_or_b32 v225, v227, 16, v226
    v_add_u32 v224, v32, v224
    v_add_u32 v225, v33, v225

    ds_write_b64 v34, v[224:225] offset:0

    s_waitcnt vmcnt(6)
    v_lshl_or_b32 v228, v229, 16, v228
    v_lshl_or_b32 v229, v231, 16, v230
    v_add_u32 v228, v32, v228
    v_add_u32 v229, v33, v229

    ds_write_b64 v34, v[228:229] offset:576

    s_waitcnt vmcnt(5)
    v_lshl_or_b32 v232, v233, 16, v232
    v_lshl_or_b32 v233, v235, 16, v234
    v_add_u32 v232, v32, v232
    v_add_u32 v233, v33, v233

    ds_write_b64 v34, v[232:233] offset:1152

    s_waitcnt vmcnt(4)
    v_lshl_or_b32 v236, v237, 16, v236
    v_lshl_or_b32 v237, v239, 16, v238
    v_add_u32 v236, v32, v236
    v_add_u32 v237, v33, v237

    ds_write_b64 v34, v[236:237] offset:1728

    s_waitcnt vmcnt(3)
    v_lshl_or_b32 v240, v241, 16, v240
    v_lshl_or_b32 v241, v243, 16, v242
    v_add_u32 v240, v32, v240
    v_add_u32 v241, v33, v241

    ds_write_b64 v34, v[240:241] offset:2304

    s_waitcnt vmcnt(2)
    v_lshl_or_b32 v244, v245, 16, v244
    v_lshl_or_b32 v245, v247, 16, v246
    v_add_u32 v244, v32, v244
    v_add_u32 v245, v33, v245

    ds_write_b64 v34, v[244:245] offset:2880

    s_waitcnt vmcnt(1)
    v_lshl_or_b32 v248, v249, 16, v248
    v_lshl_or_b32 v249, v251, 16, v250
    v_add_u32 v248, v32, v248
    v_add_u32 v249, v33, v249

    ds_write_b64 v34, v[248:249] offset:3456

    s_waitcnt vmcnt(0)
    v_lshl_or_b32 v252, v253, 16, v252
    v_lshl_or_b32 v253, v255, 16, v254
    v_add_u32 v252, v32, v252
    v_add_u32 v253, v33, v253

    ds_write_b64 v34, v[252:253] offset:4032
    s_mov_b64 exec, -1
    ds_read_b64 v[40:41], v31 offset:8
    ds_read_b64 v[42:43], v31 offset:16
    ds_read_b64 v[44:45], v31 offset:24
    ds_read_b64 v[46:47], v31 offset:32
    ds_read_b64 v[48:49], v31 offset:40
    ds_read_b64 v[50:51], v31 offset:48
    ds_read_b64 v[52:53], v31 offset:56
    ds_read_b64 v[54:55], v31 offset:64

    s_waitcnt lgkmcnt(7)
    v_perm_b32 v60, v41, v40, s75
    v_lshlrev_b32 v72, 2, v60

    v_lshrrev_b32 v61, 3, v60
    v_and_b32 v60, 0x07070707, v60
    v_and_or_b32 v0, v61, s67, v27
    v_perm_b32 v16, v58, v57, v60
    v_add_u32 v64, v57, v16

    s_waitcnt lgkmcnt(6)
    v_perm_b32 v60, v43, v42, s75
    v_lshlrev_b32 v73, 2, v60

    v_lshrrev_b32 v61, 3, v60
    v_and_b32 v60, 0x07070707, v60
    v_and_or_b32 v1, v61, s67, v27
    v_perm_b32 v17, v58, v57, v60
    v_add_u32 v65, v57, v17

    s_waitcnt lgkmcnt(5)
    v_perm_b32 v60, v45, v44, s75
    v_lshlrev_b32 v74, 2, v60

    v_lshrrev_b32 v61, 3, v60
    v_and_b32 v60, 0x07070707, v60
    v_and_or_b32 v2, v61, s67, v27
    v_perm_b32 v18, v58, v57, v60
    v_add_u32 v66, v57, v18

    s_waitcnt lgkmcnt(4)
    v_perm_b32 v60, v47, v46, s75
    v_lshlrev_b32 v75, 2, v60

    v_lshrrev_b32 v61, 3, v60
    v_and_b32 v60, 0x07070707, v60
    v_and_or_b32 v3, v61, s67, v27
    v_perm_b32 v19, v58, v57, v60
    v_add_u32 v67, v57, v19

    s_waitcnt lgkmcnt(3)
    v_perm_b32 v60, v49, v48, s75
    v_lshlrev_b32 v76, 2, v60

    v_lshrrev_b32 v61, 3, v60
    v_and_b32 v60, 0x07070707, v60
    v_and_or_b32 v4, v61, s67, v27
    v_perm_b32 v20, v58, v57, v60
    v_add_u32 v68, v57, v20

    s_waitcnt lgkmcnt(2)
    v_perm_b32 v60, v51, v50, s75
    v_lshlrev_b32 v77, 2, v60

    v_lshrrev_b32 v61, 3, v60
    v_and_b32 v60, 0x07070707, v60
    v_and_or_b32 v5, v61, s67, v27
    v_perm_b32 v21, v58, v57, v60
    v_add_u32 v69, v57, v21

    s_waitcnt lgkmcnt(1)
    v_perm_b32 v60, v53, v52, s75
    v_lshlrev_b32 v78, 2, v60

    v_lshrrev_b32 v61, 3, v60
    v_and_b32 v60, 0x07070707, v60
    v_and_or_b32 v6, v61, s67, v27
    v_perm_b32 v22, v58, v57, v60
    v_add_u32 v70, v57, v22

    s_waitcnt lgkmcnt(0)
    v_perm_b32 v60, v55, v54, s75
    v_lshlrev_b32 v79, 2, v60

    v_lshrrev_b32 v61, 3, v60
    v_and_b32 v60, 0x07070707, v60
    v_and_or_b32 v7, v61, s67, v27
    v_perm_b32 v23, v58, v57, v60
    v_add_u32 v71, v57, v23

    ds_write_b32 v86, v13
    s_cmp_eq_u32 s59, 3
    s_cbranch_scc1 standalone__deep_cross_pnn__recsys_kernel_sk1
    v_add_u32 v63, v58, v16
    s_bitcmp0_b32 s59, 0
    s_cbranch_scc1 standalone__deep_cross_pnn__recsys_kernel_pq3
    s_setprio 0
standalone__deep_cross_pnn__recsys_kernel_pq3:
    v_ffbl_b32 v84, v59
    v_perm_b32 v60, v72, v72, v84
    v_and_or_b32 v60, v60, s66, v85
    ds_add_rtn_u32 v87, v60, v10
    ds_wrxchg_rtn_b32 v116, v86, v13

    s_waitcnt lgkmcnt(0)
    v_cmp_gt_u32 s[68:69], 2, v116

    v_cmp_eq_u32 s[72:73], 0, v116
    s_nop 0
    v_cmpx_le_u32 vcc, 2, v87
    v_mov_b32 v62, s69
    v_mov_b32 v123, s73
    v_perm_b32 v121, v62, s68, v1
    v_perm_b32 v122, v123, s72, v0
    v_and_b32 v121, v121, v17
    v_and_b32 v122, v122, v16
    v_msad_u8 v120, v65, v121, 0
    v_lshlrev_b32 v120, 8, v120
    v_msad_u8 v120, v63, v122, v120
    v_and_b32 v120, v120, v59

    v_ffbl_b32 v120, v120
    v_max_i32 v84, v84, v120
    s_mov_b64 exec, -1
    v_lshl_add_u32 v59, -1, v84, v59

    v_lshl_add_u32 v61, v84, 1, v31
    ds_read_u16 v80, v61 offset:0
    s_setprio 0
    v_ffbl_b32 v84, v59
    v_perm_b32 v60, v72, v72, v84
    v_and_or_b32 v60, v60, s66, v85
    ds_add_rtn_u32 v87, v60, v10
    ds_wrxchg_rtn_b32 v116, v86, v13

    s_waitcnt lgkmcnt(0)
    v_cmp_gt_u32 s[68:69], 2, v116

    v_cmp_eq_u32 s[72:73], 0, v116
    s_nop 0
    v_cmpx_le_u32 vcc, 2, v87
    v_mov_b32 v62, s69
    v_mov_b32 v123, s73
    v_perm_b32 v121, v62, s68, v1
    v_perm_b32 v122, v123, s72, v0
    v_and_b32 v121, v121, v17
    v_and_b32 v122, v122, v16
    v_msad_u8 v120, v65, v121, 0
    v_lshlrev_b32 v120, 8, v120
    v_msad_u8 v120, v63, v122, v120
    v_and_b32 v120, v120, v59

    v_ffbl_b32 v120, v120
    v_max_i32 v84, v84, v120
    s_mov_b64 exec, -1
    v_lshl_add_u32 v59, -1, v84, v59

    v_lshl_add_u32 v61, v84, 1, v31
    ds_read_u16 v81, v61 offset:0
    v_ffbl_b32 v84, v59
    v_perm_b32 v60, v72, v72, v84
    v_and_or_b32 v60, v60, s66, v85
    ds_add_rtn_u32 v87, v60, v10
    ds_wrxchg_rtn_b32 v116, v86, v13

    s_waitcnt lgkmcnt(0)
    v_cmp_gt_u32 s[68:69], 2, v116

    v_cmp_eq_u32 s[72:73], 0, v116
    s_nop 0
    v_cmpx_le_u32 vcc, 2, v87
    v_mov_b32 v62, s69
    v_mov_b32 v123, s73
    v_perm_b32 v121, v62, s68, v1
    v_perm_b32 v122, v123, s72, v0
    v_and_b32 v121, v121, v17
    v_and_b32 v122, v122, v16
    v_msad_u8 v120, v65, v121, 0
    v_lshlrev_b32 v120, 8, v120
    v_msad_u8 v120, v63, v122, v120
    v_and_b32 v120, v120, v59

    v_ffbl_b32 v120, v120
    v_max_i32 v84, v84, v120
    s_mov_b64 exec, -1
    v_lshl_add_u32 v59, -1, v84, v59

    v_lshl_add_u32 v61, v84, 1, v31
    ds_read_u16 v82, v61 offset:0
    s_bitcmp1_b32 s59, 0
    s_cbranch_scc1 standalone__deep_cross_pnn__recsys_kernel_pq4
    s_setprio 1
standalone__deep_cross_pnn__recsys_kernel_pq4:
    v_ffbl_b32 v84, v59
    v_perm_b32 v60, v72, v72, v84
    v_and_or_b32 v60, v60, s66, v85
    ds_add_rtn_u32 v87, v60, v10
    ds_wrxchg_rtn_b32 v116, v86, v13

    s_waitcnt lgkmcnt(0)
    v_cmp_gt_u32 s[68:69], 2, v116

    s_nop 0
    v_cmpx_le_u32 vcc, 2, v87
    v_mov_b32 v62, s69
    v_perm_b32 v121, v62, s68, v1
    v_and_b32 v121, v121, v17
    v_msad_u8 v120, v65, v121, 0
    v_and_b32_sdwa v120, v120, v59 dst_sel:BYTE_1 dst_unused:UNUSED_PAD src0_sel:DWORD src1_sel:BYTE_1
    s_nop 0

    v_ffbl_b32 v120, v120
    v_max_i32 v84, v84, v120
    s_mov_b64 exec, -1
    v_lshl_add_u32 v59, -1, v84, v59

    v_lshl_add_u32 v61, v84, 1, v31
    ds_read_u16 v83, v61 offset:0
standalone__deep_cross_pnn__recsys_kernel_sk1:
    v_lshrrev_b32 v59, 4, v59
    v_add_u32 v63, v58, v17
    s_setprio 0
    v_ffbl_b32 v84, v59
    v_perm_b32 v60, v73, v72, v84
    v_and_or_b32 v60, v60, s66, v85

    v_cmpx_ge_u32 vcc, 0, v84
    ds_add_u32 v60, v10
    s_not_b64 s[70:71], vcc
    s_mov_b64 exec, s[70:71]
    ds_add_rtn_u32 v87, v60, v10
    s_mov_b64 exec, -1

    ds_wrxchg_rtn_b32 v116, v86, v13
    s_and_b32 s45, s2, 63
    s_mul_i32 s45, s45, 4224
    s_add_u32 s45, s45, 8192
    v_mul_u32_u24 v104, s45, v8
    s_cmp_eq_u32 s64, 0
    s_cselect_b32 s45, s4, 0
    s_and_b32 exec_lo, s45, 3
    s_mov_b32 exec_hi, 0
    buffer_store_dword v13, v104, s[12:15], s9 offen sc1
    s_mov_b64 exec, -1
    buffer_load_dwordx4 v[128:131], v15, s[28:31], s77 offen offset:0
    buffer_load_dwordx4 v[160:163], v15, s[28:31], s77 offen offset:512

    s_waitcnt lgkmcnt(0)
    v_cmp_gt_u32 s[68:69], 2, v116

    v_cmp_eq_u32 s[72:73], 0, v116
    s_cmp_eq_u32 s59, 3
    s_cbranch_scc1 standalone__deep_cross_pnn__recsys_kernel_nf1
    v_lshl_or_b32 v24, v81, 16, v80
    v_lshl_or_b32 v25, v83, 16, v82
    buffer_store_dwordx2 v[24:25], v30, s[32:35], s62 offen sc1
    s_add_u32 s62, s62, s63
standalone__deep_cross_pnn__recsys_kernel_nf1:
    s_mov_b64 exec, s[70:71]
    v_cmpx_le_u32 vcc, 2, v87
    v_mov_b32 v62, s69
    v_mov_b32 v123, s73
    v_perm_b32 v121, v62, s68, v2
    v_perm_b32 v122, v123, s72, v1
    v_and_b32 v121, v121, v18
    v_and_b32 v122, v122, v17
    v_msad_u8 v120, v66, v121, 0
    v_lshlrev_b32 v120, 8, v120
    v_msad_u8 v120, v63, v122, v120
    v_and_b32 v120, v120, v59

    v_ffbl_b32 v120, v120
    v_max_i32 v84, v84, v120
    s_mov_b64 exec, -1
    v_lshl_add_u32 v59, -1, v84, v59

    v_lshl_add_u32 v61, v84, 1, v31
    ds_read_u16 v80, v61 offset:8
    v_ffbl_b32 v84, v59
    v_perm_b32 v60, v73, v72, v84
    v_and_or_b32 v60, v60, s66, v85

    v_cmpx_ge_u32 vcc, 1, v84
    ds_add_u32 v60, v10
    s_not_b64 s[70:71], vcc
    s_mov_b64 exec, s[70:71]
    ds_add_rtn_u32 v87, v60, v10
    s_mov_b64 exec, -1

    ds_wrxchg_rtn_b32 v116, v86, v13
    s_mov_b64 exec, s[4:5]
    buffer_load_dwordx4 v[104:107], v56, s[20:23], s44 offen
    s_mov_b64 exec, -1
    buffer_load_dwordx4 v[132:135], v15, s[28:31], s77 offen offset:1024
    buffer_load_dwordx4 v[164:167], v15, s[28:31], s77 offen offset:1536

    s_waitcnt lgkmcnt(0)
    v_cmp_gt_u32 s[68:69], 2, v116

    v_cmp_eq_u32 s[72:73], 0, v116
    s_mov_b64 exec, s[70:71]
    v_cmpx_le_u32 vcc, 2, v87
    v_mov_b32 v62, s69
    v_mov_b32 v123, s73
    v_perm_b32 v121, v62, s68, v2
    v_perm_b32 v122, v123, s72, v1
    v_and_b32 v121, v121, v18
    v_and_b32 v122, v122, v17
    v_msad_u8 v120, v66, v121, 0
    v_lshlrev_b32 v120, 8, v120
    v_msad_u8 v120, v63, v122, v120
    v_and_b32 v120, v120, v59

    v_ffbl_b32 v120, v120
    v_max_i32 v84, v84, v120
    s_mov_b64 exec, -1
    v_lshl_add_u32 v59, -1, v84, v59

    v_lshl_add_u32 v61, v84, 1, v31
    ds_read_u16 v81, v61 offset:8
    s_bitcmp1_b32 s59, 0
    s_cbranch_scc1 standalone__deep_cross_pnn__recsys_kernel_pq5
    s_setprio 1
standalone__deep_cross_pnn__recsys_kernel_pq5:
    v_ffbl_b32 v84, v59
    v_perm_b32 v60, v73, v72, v84
    v_and_or_b32 v60, v60, s66, v85

    v_cmpx_ge_u32 vcc, 2, v84
    ds_add_u32 v60, v10
    s_not_b64 s[70:71], vcc
    s_mov_b64 exec, s[70:71]
    ds_add_rtn_u32 v87, v60, v10
    s_mov_b64 exec, -1

    ds_wrxchg_rtn_b32 v116, v86, v13
    buffer_load_dwordx4 v[136:139], v15, s[28:31], s77 offen offset:2048
    buffer_load_dwordx4 v[168:171], v15, s[28:31], s77 offen offset:2560

    s_waitcnt lgkmcnt(0)
    v_cmp_gt_u32 s[68:69], 2, v116

    v_cmp_eq_u32 s[72:73], 0, v116
    s_mov_b64 exec, s[70:71]
    v_cmpx_le_u32 vcc, 2, v87
    v_mov_b32 v62, s69
    v_mov_b32 v123, s73
    v_perm_b32 v121, v62, s68, v2
    v_perm_b32 v122, v123, s72, v1
    v_and_b32 v121, v121, v18
    v_and_b32 v122, v122, v17
    v_msad_u8 v120, v66, v121, 0
    v_lshlrev_b32 v120, 8, v120
    v_msad_u8 v120, v63, v122, v120
    v_and_b32 v120, v120, v59

    v_ffbl_b32 v120, v120
    v_max_i32 v84, v84, v120
    s_mov_b64 exec, -1
    v_lshl_add_u32 v59, -1, v84, v59

    v_lshl_add_u32 v61, v84, 1, v31
    ds_read_u16 v82, v61 offset:8
    s_setprio 0
    v_ffbl_b32 v84, v59
    v_perm_b32 v60, v73, v72, v84
    v_and_or_b32 v60, v60, s66, v85

    v_cmpx_ge_u32 vcc, 3, v84
    ds_add_u32 v60, v10
    s_not_b64 s[70:71], vcc
    s_mov_b64 exec, s[70:71]
    ds_add_rtn_u32 v87, v60, v10
    s_mov_b64 exec, -1

    ds_wrxchg_rtn_b32 v116, v86, v13
    buffer_load_dwordx4 v[140:143], v15, s[28:31], s77 offen offset:3072
    buffer_load_dwordx4 v[172:175], v15, s[28:31], s77 offen offset:3584
    s_add_u32 s77, s77, 4096

    s_waitcnt lgkmcnt(0)
    v_cmp_gt_u32 s[68:69], 2, v116

    s_mov_b64 exec, s[70:71]
    v_cmpx_le_u32 vcc, 2, v87
    v_mov_b32 v62, s69
    v_perm_b32 v121, v62, s68, v2
    v_and_b32 v121, v121, v18
    v_msad_u8 v120, v66, v121, 0
    v_and_b32_sdwa v120, v120, v59 dst_sel:BYTE_1 dst_unused:UNUSED_PAD src0_sel:DWORD src1_sel:BYTE_1
    s_nop 0

    v_ffbl_b32 v120, v120
    v_max_i32 v84, v84, v120
    s_mov_b64 exec, -1
    v_lshl_add_u32 v59, -1, v84, v59

    v_lshl_add_u32 v61, v84, 1, v31
    ds_read_u16 v83, v61 offset:8
    v_lshrrev_b32 v59, 4, v59
    v_add_u32 v63, v58, v18
    v_ffbl_b32 v84, v59
    v_perm_b32 v60, v74, v73, v84
    v_and_or_b32 v60, v60, s66, v85

    v_cmpx_ge_u32 vcc, 0, v84
    ds_add_u32 v60, v10
    s_not_b64 s[70:71], vcc
    s_mov_b64 exec, s[70:71]
    ds_add_rtn_u32 v87, v60, v10
    s_mov_b64 exec, -1

    ds_wrxchg_rtn_b32 v116, v86, v13
    buffer_load_dwordx4 v[144:147], v15, s[28:31], s77 offen offset:0
    buffer_load_dwordx4 v[176:179], v15, s[28:31], s77 offen offset:512

    s_waitcnt lgkmcnt(0)
    v_cmp_gt_u32 s[68:69], 2, v116

    v_cmp_eq_u32 s[72:73], 0, v116
    v_lshl_or_b32 v24, v81, 16, v80
    v_lshl_or_b32 v25, v83, 16, v82
    buffer_store_dwordx2 v[24:25], v30, s[32:35], s62 offen sc1
    s_add_u32 s62, s62, s63
    s_mov_b64 exec, s[70:71]
    v_cmpx_le_u32 vcc, 2, v87
    v_mov_b32 v62, s69
    v_mov_b32 v123, s73
    v_perm_b32 v121, v62, s68, v3
    v_perm_b32 v122, v123, s72, v2
    v_and_b32 v121, v121, v19
    v_and_b32 v122, v122, v18
    v_msad_u8 v120, v67, v121, 0
    v_lshlrev_b32 v120, 8, v120
    v_msad_u8 v120, v63, v122, v120
    v_and_b32 v120, v120, v59

    v_ffbl_b32 v120, v120
    v_max_i32 v84, v84, v120
    s_mov_b64 exec, -1
    v_lshl_add_u32 v59, -1, v84, v59

    v_lshl_add_u32 v61, v84, 1, v31
    ds_read_u16 v80, v61 offset:16
    s_bitcmp1_b32 s59, 0
    s_cbranch_scc1 standalone__deep_cross_pnn__recsys_kernel_pq6
    s_setprio 1
standalone__deep_cross_pnn__recsys_kernel_pq6:
    v_ffbl_b32 v84, v59
    v_perm_b32 v60, v74, v73, v84
    v_and_or_b32 v60, v60, s66, v85

    v_cmpx_ge_u32 vcc, 1, v84
    ds_add_u32 v60, v10
    s_not_b64 s[70:71], vcc
    s_mov_b64 exec, s[70:71]
    ds_add_rtn_u32 v87, v60, v10
    s_mov_b64 exec, -1

    ds_wrxchg_rtn_b32 v116, v86, v13
    buffer_load_dwordx4 v[148:151], v15, s[28:31], s77 offen offset:1024
    buffer_load_dwordx4 v[180:183], v15, s[28:31], s77 offen offset:1536

    s_waitcnt lgkmcnt(0)
    v_cmp_gt_u32 s[68:69], 2, v116

    v_cmp_eq_u32 s[72:73], 0, v116
    s_mov_b64 exec, s[70:71]
    v_cmpx_le_u32 vcc, 2, v87
    v_mov_b32 v62, s69
    v_mov_b32 v123, s73
    v_perm_b32 v121, v62, s68, v3
    v_perm_b32 v122, v123, s72, v2
    v_and_b32 v121, v121, v19
    v_and_b32 v122, v122, v18
    v_msad_u8 v120, v67, v121, 0
    v_lshlrev_b32 v120, 8, v120
    v_msad_u8 v120, v63, v122, v120
    v_and_b32 v120, v120, v59

    v_ffbl_b32 v120, v120
    v_max_i32 v84, v84, v120
    s_mov_b64 exec, -1
    v_lshl_add_u32 v59, -1, v84, v59

    v_lshl_add_u32 v61, v84, 1, v31
    ds_read_u16 v81, v61 offset:16
    s_setprio 0
    v_ffbl_b32 v84, v59
    v_perm_b32 v60, v74, v73, v84
    v_and_or_b32 v60, v60, s66, v85

    v_cmpx_ge_u32 vcc, 2, v84
    ds_add_u32 v60, v10
    s_not_b64 s[70:71], vcc
    s_mov_b64 exec, s[70:71]
    ds_add_rtn_u32 v87, v60, v10
    s_mov_b64 exec, -1

    ds_wrxchg_rtn_b32 v116, v86, v13
    s_waitcnt vmcnt(11)
    s_mov_b64 exec, s[4:5]
    buffer_store_dwordx4 v[104:107], v9, s[32:35], s47 offen sc1
    s_mov_b64 exec, -1
    buffer_load_dwordx4 v[152:155], v15, s[28:31], s77 offen offset:2048
    buffer_load_dwordx4 v[184:187], v15, s[28:31], s77 offen offset:2560

    s_waitcnt lgkmcnt(0)
    v_cmp_gt_u32 s[68:69], 2, v116

    v_cmp_eq_u32 s[72:73], 0, v116
    s_mov_b64 exec, s[70:71]
    v_cmpx_le_u32 vcc, 2, v87
    v_mov_b32 v62, s69
    v_mov_b32 v123, s73
    v_perm_b32 v121, v62, s68, v3
    v_perm_b32 v122, v123, s72, v2
    v_and_b32 v121, v121, v19
    v_and_b32 v122, v122, v18
    v_msad_u8 v120, v67, v121, 0
    v_lshlrev_b32 v120, 8, v120
    v_msad_u8 v120, v63, v122, v120
    v_and_b32 v120, v120, v59

    v_ffbl_b32 v120, v120
    v_max_i32 v84, v84, v120
    s_mov_b64 exec, -1
    v_lshl_add_u32 v59, -1, v84, v59

    v_lshl_add_u32 v61, v84, 1, v31
    ds_read_u16 v82, v61 offset:16
    v_ffbl_b32 v84, v59
    v_perm_b32 v60, v74, v73, v84
    v_and_or_b32 v60, v60, s66, v85

    v_cmpx_ge_u32 vcc, 3, v84
    ds_add_u32 v60, v10
    s_not_b64 s[70:71], vcc
    s_mov_b64 exec, s[70:71]
    ds_add_rtn_u32 v87, v60, v10
    s_mov_b64 exec, -1

    ds_wrxchg_rtn_b32 v116, v86, v13
    buffer_load_dwordx4 v[156:159], v15, s[28:31], s77 offen offset:3072
    buffer_load_dwordx4 v[188:191], v15, s[28:31], s77 offen offset:3584

    s_waitcnt lgkmcnt(0)
    v_cmp_gt_u32 s[68:69], 2, v116

    s_mov_b64 exec, s[70:71]
    v_cmpx_le_u32 vcc, 2, v87
    v_mov_b32 v62, s69
    v_perm_b32 v121, v62, s68, v3
    v_and_b32 v121, v121, v19
    v_msad_u8 v120, v67, v121, 0
    v_and_b32_sdwa v120, v120, v59 dst_sel:BYTE_1 dst_unused:UNUSED_PAD src0_sel:DWORD src1_sel:BYTE_1
    s_nop 0

    v_ffbl_b32 v120, v120
    v_max_i32 v84, v84, v120
    s_mov_b64 exec, -1
    v_lshl_add_u32 v59, -1, v84, v59

    v_lshl_add_u32 v61, v84, 1, v31
    ds_read_u16 v83, v61 offset:16
    v_lshrrev_b32 v59, 4, v59
    v_add_u32 v63, v58, v19
    s_bitcmp1_b32 s59, 0
    s_cbranch_scc1 standalone__deep_cross_pnn__recsys_kernel_pq7
    s_setprio 1
standalone__deep_cross_pnn__recsys_kernel_pq7:
    v_ffbl_b32 v84, v59
    v_perm_b32 v60, v75, v74, v84
    v_and_or_b32 v60, v60, s66, v85

    v_cmpx_ge_u32 vcc, 0, v84
    ds_add_u32 v60, v10
    s_not_b64 s[70:71], vcc
    s_mov_b64 exec, s[70:71]
    ds_add_rtn_u32 v87, v60, v10
    s_mov_b64 exec, -1

    ds_wrxchg_rtn_b32 v116, v86, v13

    s_waitcnt lgkmcnt(0)
    v_cmp_gt_u32 s[68:69], 2, v116

    v_cmp_eq_u32 s[72:73], 0, v116
    v_lshl_or_b32 v24, v81, 16, v80
    v_lshl_or_b32 v25, v83, 16, v82
    buffer_store_dwordx2 v[24:25], v30, s[32:35], s62 offen sc1
    s_add_u32 s62, s62, s63
    s_mov_b64 exec, s[70:71]
    v_cmpx_le_u32 vcc, 2, v87
    v_mov_b32 v62, s69
    v_mov_b32 v123, s73
    v_perm_b32 v121, v62, s68, v4
    v_perm_b32 v122, v123, s72, v3
    v_and_b32 v121, v121, v20
    v_and_b32 v122, v122, v19
    v_msad_u8 v120, v68, v121, 0
    v_lshlrev_b32 v120, 8, v120
    v_msad_u8 v120, v63, v122, v120
    v_and_b32 v120, v120, v59

    v_ffbl_b32 v120, v120
    v_max_i32 v84, v84, v120
    s_mov_b64 exec, -1
    v_lshl_add_u32 v59, -1, v84, v59

    v_lshl_add_u32 v61, v84, 1, v31
    ds_read_u16 v80, v61 offset:24
    s_setprio 0
    v_ffbl_b32 v84, v59
    v_perm_b32 v60, v75, v74, v84
    v_and_or_b32 v60, v60, s66, v85

    v_cmpx_ge_u32 vcc, 1, v84
    ds_add_u32 v60, v10
    s_not_b64 s[70:71], vcc
    s_mov_b64 exec, s[70:71]
    ds_add_rtn_u32 v87, v60, v10
    s_mov_b64 exec, -1

    ds_wrxchg_rtn_b32 v116, v86, v13

    s_waitcnt lgkmcnt(0)
    v_cmp_gt_u32 s[68:69], 2, v116

    v_cmp_eq_u32 s[72:73], 0, v116
    s_mov_b64 exec, s[70:71]
    v_cmpx_le_u32 vcc, 2, v87
    v_mov_b32 v62, s69
    v_mov_b32 v123, s73
    v_perm_b32 v121, v62, s68, v4
    v_perm_b32 v122, v123, s72, v3
    v_and_b32 v121, v121, v20
    v_and_b32 v122, v122, v19
    v_msad_u8 v120, v68, v121, 0
    v_lshlrev_b32 v120, 8, v120
    v_msad_u8 v120, v63, v122, v120
    v_and_b32 v120, v120, v59

    v_ffbl_b32 v120, v120
    v_max_i32 v84, v84, v120
    s_mov_b64 exec, -1
    v_lshl_add_u32 v59, -1, v84, v59

    v_lshl_add_u32 v61, v84, 1, v31
    ds_read_u16 v81, v61 offset:24

    s_cmp_ge_u32 s57, 800
    s_cbranch_scc1 standalone__deep_cross_pnn__recsys_kernel_norl
    s_waitcnt vmcnt(0)

    s_lshl_b32 s39, 1, s2
    s_cmp_eq_u32 s64, 0
    s_cselect_b32 s39, s39, 0

    s_lshr_b32 s38, s2, 5
    v_mov_b32 v60, s39
    s_lshl_b32 s38, s38, 4
    s_and_b64 exec, s[4:5], 1
    buffer_atomic_or v60, v13, s[52:55], s38 offen offset:128
    s_mov_b64 exec, -1

standalone__deep_cross_pnn__recsys_kernel_norl:
standalone__deep_cross_pnn__recsys_kernel_rld:
    v_ffbl_b32 v84, v59
    v_perm_b32 v60, v75, v74, v84
    v_and_or_b32 v60, v60, s66, v85

    v_cmpx_ge_u32 vcc, 2, v84
    ds_add_u32 v60, v10
    s_not_b64 s[70:71], vcc
    s_mov_b64 exec, s[70:71]
    ds_add_rtn_u32 v87, v60, v10
    s_mov_b64 exec, -1

    ds_wrxchg_rtn_b32 v116, v86, v13
    s_cmp_ge_u32 s57, 800
    s_cbranch_scc1 standalone__deep_cross_pnn__recsys_kernel_nr14
    v_perm_b32 v192, v132, v128, s84
    v_perm_b32 v193, v140, v136, s84
    v_perm_b32 v194, v148, v144, s84
    v_perm_b32 v195, v156, v152, s84
    s_add_u32 s83, s82, 0
    buffer_store_dwordx4 v[192:195], v14, s[32:35], s83 offen sc1
    v_perm_b32 v196, v132, v128, s85
    v_perm_b32 v197, v140, v136, s85
    v_perm_b32 v198, v148, v144, s85
    v_perm_b32 v199, v156, v152, s85
    s_add_u32 s83, s82, 102656
    buffer_store_dwordx4 v[196:199], v14, s[32:35], s83 offen sc1
standalone__deep_cross_pnn__recsys_kernel_nr14:

    s_waitcnt lgkmcnt(0)
    v_cmp_gt_u32 s[68:69], 2, v116

    v_cmp_eq_u32 s[72:73], 0, v116
    s_mov_b64 exec, s[70:71]
    v_cmpx_le_u32 vcc, 2, v87
    v_mov_b32 v62, s69
    v_mov_b32 v123, s73
    v_perm_b32 v121, v62, s68, v4
    v_perm_b32 v122, v123, s72, v3
    v_and_b32 v121, v121, v20
    v_and_b32 v122, v122, v19
    v_msad_u8 v120, v68, v121, 0
    v_lshlrev_b32 v120, 8, v120
    v_msad_u8 v120, v63, v122, v120
    v_and_b32 v120, v120, v59

    v_ffbl_b32 v120, v120
    v_max_i32 v84, v84, v120
    s_mov_b64 exec, -1
    v_lshl_add_u32 v59, -1, v84, v59

    v_lshl_add_u32 v61, v84, 1, v31
    ds_read_u16 v82, v61 offset:24
    s_bitcmp1_b32 s59, 0
    s_cbranch_scc1 standalone__deep_cross_pnn__recsys_kernel_pq8
    s_setprio 1
standalone__deep_cross_pnn__recsys_kernel_pq8:
    v_ffbl_b32 v84, v59
    v_perm_b32 v60, v75, v74, v84
    v_and_or_b32 v60, v60, s66, v85

    v_cmpx_ge_u32 vcc, 3, v84
    ds_add_u32 v60, v10
    s_not_b64 s[70:71], vcc
    s_mov_b64 exec, s[70:71]
    ds_add_rtn_u32 v87, v60, v10
    s_mov_b64 exec, -1

    ds_wrxchg_rtn_b32 v116, v86, v13
    s_cmp_ge_u32 s57, 800
    s_cbranch_scc1 standalone__deep_cross_pnn__recsys_kernel_nr15
    v_perm_b32 v200, v133, v129, s84
    v_perm_b32 v201, v141, v137, s84
    v_perm_b32 v202, v149, v145, s84
    v_perm_b32 v203, v157, v153, s84
    s_add_u32 s83, s82, 205312
    buffer_store_dwordx4 v[200:203], v14, s[32:35], s83 offen sc1
    v_perm_b32 v204, v133, v129, s85
    v_perm_b32 v205, v141, v137, s85
    v_perm_b32 v206, v149, v145, s85
    v_perm_b32 v207, v157, v153, s85
    s_add_u32 s83, s82, 307968
    buffer_store_dwordx4 v[204:207], v14, s[32:35], s83 offen sc1
standalone__deep_cross_pnn__recsys_kernel_nr15:

    s_waitcnt lgkmcnt(0)
    v_cmp_gt_u32 s[68:69], 2, v116

    s_mov_b64 exec, s[70:71]
    v_cmpx_le_u32 vcc, 2, v87
    v_mov_b32 v62, s69
    v_perm_b32 v121, v62, s68, v4
    v_and_b32 v121, v121, v20
    v_msad_u8 v120, v68, v121, 0
    v_and_b32_sdwa v120, v120, v59 dst_sel:BYTE_1 dst_unused:UNUSED_PAD src0_sel:DWORD src1_sel:BYTE_1
    s_nop 0

    v_ffbl_b32 v120, v120
    v_max_i32 v84, v84, v120
    s_mov_b64 exec, -1
    v_lshl_add_u32 v59, -1, v84, v59

    v_lshl_add_u32 v61, v84, 1, v31
    ds_read_u16 v83, v61 offset:24
    v_lshrrev_b32 v59, 4, v59
    v_add_u32 v63, v58, v20
    s_setprio 0
    v_ffbl_b32 v84, v59
    v_perm_b32 v60, v76, v75, v84
    v_and_or_b32 v60, v60, s66, v85

    v_cmpx_ge_u32 vcc, 0, v84
    ds_add_u32 v60, v10
    s_not_b64 s[70:71], vcc
    s_mov_b64 exec, s[70:71]
    ds_add_rtn_u32 v87, v60, v10
    s_mov_b64 exec, -1

    ds_wrxchg_rtn_b32 v116, v86, v13
    s_cmp_ge_u32 s57, 800
    s_cbranch_scc1 standalone__deep_cross_pnn__recsys_kernel_nr16
    v_perm_b32 v208, v134, v130, s84
    v_perm_b32 v209, v142, v138, s84
    v_perm_b32 v210, v150, v146, s84
    v_perm_b32 v211, v158, v154, s84
    s_add_u32 s83, s82, 410624
    buffer_store_dwordx4 v[208:211], v14, s[32:35], s83 offen sc1
    v_perm_b32 v212, v134, v130, s85
    v_perm_b32 v213, v142, v138, s85
    v_perm_b32 v214, v150, v146, s85
    v_perm_b32 v215, v158, v154, s85
    s_add_u32 s83, s82, 513280
    buffer_store_dwordx4 v[212:215], v14, s[32:35], s83 offen sc1
standalone__deep_cross_pnn__recsys_kernel_nr16:

    s_waitcnt lgkmcnt(0)
    v_cmp_gt_u32 s[68:69], 2, v116

    v_cmp_eq_u32 s[72:73], 0, v116
    v_lshl_or_b32 v24, v81, 16, v80
    v_lshl_or_b32 v25, v83, 16, v82
    buffer_store_dwordx2 v[24:25], v30, s[32:35], s62 offen sc1
    s_add_u32 s62, s62, s63
    s_mov_b64 exec, s[70:71]
    v_cmpx_le_u32 vcc, 2, v87
    v_mov_b32 v62, s69
    v_mov_b32 v123, s73
    v_perm_b32 v121, v62, s68, v5
    v_perm_b32 v122, v123, s72, v4
    v_and_b32 v121, v121, v21
    v_and_b32 v122, v122, v20
    v_msad_u8 v120, v69, v121, 0
    v_lshlrev_b32 v120, 8, v120
    v_msad_u8 v120, v63, v122, v120
    v_and_b32 v120, v120, v59

    v_ffbl_b32 v120, v120
    v_max_i32 v84, v84, v120
    s_mov_b64 exec, -1
    v_lshl_add_u32 v59, -1, v84, v59

    v_lshl_add_u32 v61, v84, 1, v31
    ds_read_u16 v80, v61 offset:32
    v_ffbl_b32 v84, v59
    v_perm_b32 v60, v76, v75, v84
    v_and_or_b32 v60, v60, s66, v85

    v_cmpx_ge_u32 vcc, 1, v84
    ds_add_u32 v60, v10
    s_not_b64 s[70:71], vcc
    s_mov_b64 exec, s[70:71]
    ds_add_rtn_u32 v87, v60, v10
    s_mov_b64 exec, -1

    ds_wrxchg_rtn_b32 v116, v86, v13
    s_cmp_ge_u32 s57, 800
    s_cbranch_scc1 standalone__deep_cross_pnn__recsys_kernel_nr17
    v_perm_b32 v216, v135, v131, s84
    v_perm_b32 v217, v143, v139, s84
    v_perm_b32 v218, v151, v147, s84
    v_perm_b32 v219, v159, v155, s84
    s_add_u32 s83, s82, 615936
    buffer_store_dwordx4 v[216:219], v14, s[32:35], s83 offen sc1
    v_perm_b32 v220, v135, v131, s85
    v_perm_b32 v221, v143, v139, s85
    v_perm_b32 v222, v151, v147, s85
    v_perm_b32 v223, v159, v155, s85
    s_add_u32 s83, s82, 718592
    buffer_store_dwordx4 v[220:223], v14, s[32:35], s83 offen sc1
standalone__deep_cross_pnn__recsys_kernel_nr17:

    s_waitcnt lgkmcnt(0)
    v_cmp_gt_u32 s[68:69], 2, v116

    v_cmp_eq_u32 s[72:73], 0, v116
    s_mov_b64 exec, s[70:71]
    v_cmpx_le_u32 vcc, 2, v87
    v_mov_b32 v62, s69
    v_mov_b32 v123, s73
    v_perm_b32 v121, v62, s68, v5
    v_perm_b32 v122, v123, s72, v4
    v_and_b32 v121, v121, v21
    v_and_b32 v122, v122, v20
    v_msad_u8 v120, v69, v121, 0
    v_lshlrev_b32 v120, 8, v120
    v_msad_u8 v120, v63, v122, v120
    v_and_b32 v120, v120, v59

    v_ffbl_b32 v120, v120
    v_max_i32 v84, v84, v120
    s_mov_b64 exec, -1
    v_lshl_add_u32 v59, -1, v84, v59

    v_lshl_add_u32 v61, v84, 1, v31
    ds_read_u16 v81, v61 offset:32
    s_bitcmp1_b32 s59, 0
    s_cbranch_scc1 standalone__deep_cross_pnn__recsys_kernel_pq9
    s_setprio 1
standalone__deep_cross_pnn__recsys_kernel_pq9:
    v_ffbl_b32 v84, v59
    v_perm_b32 v60, v76, v75, v84
    v_and_or_b32 v60, v60, s66, v85

    v_cmpx_ge_u32 vcc, 2, v84
    ds_add_u32 v60, v10
    s_not_b64 s[70:71], vcc
    s_mov_b64 exec, s[70:71]
    ds_add_rtn_u32 v87, v60, v10
    s_mov_b64 exec, -1

    ds_wrxchg_rtn_b32 v116, v86, v13
    s_cmp_ge_u32 s57, 800
    s_cbranch_scc1 standalone__deep_cross_pnn__recsys_kernel_nr18
    v_perm_b32 v224, v164, v160, s84
    v_perm_b32 v225, v172, v168, s84
    v_perm_b32 v226, v180, v176, s84
    v_perm_b32 v227, v188, v184, s84
    s_add_u32 s83, s82, 6569984
    buffer_store_dwordx4 v[224:227], v14, s[32:35], s83 offen sc1
    v_perm_b32 v228, v164, v160, s85
    v_perm_b32 v229, v172, v168, s85
    v_perm_b32 v230, v180, v176, s85
    v_perm_b32 v231, v188, v184, s85
    s_add_u32 s83, s82, 6672640
    buffer_store_dwordx4 v[228:231], v14, s[32:35], s83 offen sc1
standalone__deep_cross_pnn__recsys_kernel_nr18:

    s_waitcnt lgkmcnt(0)
    v_cmp_gt_u32 s[68:69], 2, v116

    v_cmp_eq_u32 s[72:73], 0, v116
    s_mov_b64 exec, s[70:71]
    v_cmpx_le_u32 vcc, 2, v87
    v_mov_b32 v62, s69
    v_mov_b32 v123, s73
    v_perm_b32 v121, v62, s68, v5
    v_perm_b32 v122, v123, s72, v4
    v_and_b32 v121, v121, v21
    v_and_b32 v122, v122, v20
    v_msad_u8 v120, v69, v121, 0
    v_lshlrev_b32 v120, 8, v120
    v_msad_u8 v120, v63, v122, v120
    v_and_b32 v120, v120, v59

    v_ffbl_b32 v120, v120
    v_max_i32 v84, v84, v120
    s_mov_b64 exec, -1
    v_lshl_add_u32 v59, -1, v84, v59

    v_lshl_add_u32 v61, v84, 1, v31
    ds_read_u16 v82, v61 offset:32
    s_setprio 0
    v_ffbl_b32 v84, v59
    v_perm_b32 v60, v76, v75, v84
    v_and_or_b32 v60, v60, s66, v85

    v_cmpx_ge_u32 vcc, 3, v84
    ds_add_u32 v60, v10
    s_not_b64 s[70:71], vcc
    s_mov_b64 exec, s[70:71]
    ds_add_rtn_u32 v87, v60, v10
    s_mov_b64 exec, -1

    ds_wrxchg_rtn_b32 v116, v86, v13
    s_cmp_ge_u32 s57, 800
    s_cbranch_scc1 standalone__deep_cross_pnn__recsys_kernel_nr19
    v_perm_b32 v232, v165, v161, s84
    v_perm_b32 v233, v173, v169, s84
    v_perm_b32 v234, v181, v177, s84
    v_perm_b32 v235, v189, v185, s84
    s_add_u32 s83, s82, 6775296
    buffer_store_dwordx4 v[232:235], v14, s[32:35], s83 offen sc1
    v_perm_b32 v236, v165, v161, s85
    v_perm_b32 v237, v173, v169, s85
    v_perm_b32 v238, v181, v177, s85
    v_perm_b32 v239, v189, v185, s85
    s_add_u32 s83, s82, 6877952
    buffer_store_dwordx4 v[236:239], v14, s[32:35], s83 offen sc1
standalone__deep_cross_pnn__recsys_kernel_nr19:

    s_waitcnt lgkmcnt(0)
    v_cmp_gt_u32 s[68:69], 2, v116

    s_mov_b64 exec, s[70:71]
    v_cmpx_le_u32 vcc, 2, v87
    v_mov_b32 v62, s69
    v_perm_b32 v121, v62, s68, v5
    v_and_b32 v121, v121, v21
    v_msad_u8 v120, v69, v121, 0
    v_and_b32_sdwa v120, v120, v59 dst_sel:BYTE_1 dst_unused:UNUSED_PAD src0_sel:DWORD src1_sel:BYTE_1
    s_nop 0

    v_ffbl_b32 v120, v120
    v_max_i32 v84, v84, v120
    s_mov_b64 exec, -1
    v_lshl_add_u32 v59, -1, v84, v59

    v_lshl_add_u32 v61, v84, 1, v31
    ds_read_u16 v83, v61 offset:32
    v_lshrrev_b32 v59, 4, v59
    v_add_u32 v63, v58, v21

    s_bitcmp0_b32 s59, 0
    s_cbranch_scc1 standalone__deep_cross_pnn__recsys_kernel_mg2
    v_mov_b32 v60, s46
    v_subrev_u32 v61, 512, v86

standalone__deep_cross_pnn__recsys_kernel_mg1:

    ds_read_b32 v12, v60
    ds_read_b32 v120, v61
    s_waitcnt lgkmcnt(0)
    v_readfirstlane_b32 s45, v12
    s_cmp_lg_u32 s45, 0
    s_cbranch_scc1 standalone__deep_cross_pnn__recsys_kernel_mg3
    s_sleep 2
    s_branch standalone__deep_cross_pnn__recsys_kernel_mg1

standalone__deep_cross_pnn__recsys_kernel_mg3:

    ds_write_b32 v60, v13
    s_mov_b32 s45, 0xff00
    v_lshl_or_b32 v120, v120, 8, v120
    v_and_or_b32 v59, v120, s45, v59

standalone__deep_cross_pnn__recsys_kernel_mg2:
    s_bitcmp0_b32 s59, 0
    s_cbranch_scc1 standalone__deep_cross_pnn__recsys_kernel_pq10
    s_setprio 1
standalone__deep_cross_pnn__recsys_kernel_pq10:
    v_ffbl_b32 v84, v59
    v_perm_b32 v60, v77, v76, v84
    v_and_or_b32 v60, v60, s66, v85

    v_cmpx_ge_u32 vcc, 0, v84
    ds_add_u32 v60, v10
    s_not_b64 s[70:71], vcc
    s_mov_b64 exec, s[70:71]
    ds_add_rtn_u32 v87, v60, v10
    s_mov_b64 exec, -1

    ds_wrxchg_rtn_b32 v116, v86, v13
    s_cmp_ge_u32 s57, 800
    s_cbranch_scc1 standalone__deep_cross_pnn__recsys_kernel_nr20
    v_perm_b32 v240, v166, v162, s84
    v_perm_b32 v241, v174, v170, s84
    v_perm_b32 v242, v182, v178, s84
    v_perm_b32 v243, v190, v186, s84
    s_add_u32 s83, s82, 6980608
    buffer_store_dwordx4 v[240:243], v14, s[32:35], s83 offen sc1
    v_perm_b32 v244, v166, v162, s85
    v_perm_b32 v245, v174, v170, s85
    v_perm_b32 v246, v182, v178, s85
    v_perm_b32 v247, v190, v186, s85
    s_add_u32 s83, s82, 7083264
    buffer_store_dwordx4 v[244:247], v14, s[32:35], s83 offen sc1
standalone__deep_cross_pnn__recsys_kernel_nr20:
    buffer_store_dwordx4 v[108:111], v9, s[12:15], s6 offen offset:0 sc1
    buffer_store_dwordx4 v[108:111], v9, s[12:15], s6 offen offset:1024 sc1

    s_waitcnt lgkmcnt(0)
    v_cmp_gt_u32 s[68:69], 2, v116

    v_cmp_eq_u32 s[72:73], 0, v116
    v_lshl_or_b32 v24, v81, 16, v80
    v_lshl_or_b32 v25, v83, 16, v82
    buffer_store_dwordx2 v[24:25], v30, s[32:35], s62 offen sc1
    s_add_u32 s62, s62, s63
    s_mov_b64 exec, s[70:71]
    v_cmpx_le_u32 vcc, 2, v87
    v_mov_b32 v62, s69
    v_mov_b32 v123, s73
    v_perm_b32 v121, v62, s68, v6
    v_perm_b32 v122, v123, s72, v5
    v_and_b32 v121, v121, v22
    v_and_b32 v122, v122, v21
    v_msad_u8 v120, v70, v121, 0
    v_lshlrev_b32 v120, 8, v120
    v_msad_u8 v120, v63, v122, v120
    v_and_b32 v120, v120, v59

    v_ffbl_b32 v120, v120
    v_max_i32 v84, v84, v120
    s_mov_b64 exec, -1
    v_lshl_add_u32 v59, -1, v84, v59

    v_lshl_add_u32 v61, v84, 1, v31
    ds_read_u16 v80, v61 offset:40
    s_setprio 1
    v_ffbl_b32 v84, v59
    v_perm_b32 v60, v77, v76, v84
    v_and_or_b32 v60, v60, s66, v85

    v_cmpx_ge_u32 vcc, 1, v84
    ds_add_u32 v60, v10
    s_not_b64 s[70:71], vcc
    s_mov_b64 exec, s[70:71]
    ds_add_rtn_u32 v87, v60, v10
    s_mov_b64 exec, -1

    ds_wrxchg_rtn_b32 v116, v86, v13
    s_cmp_ge_u32 s57, 800
    s_cbranch_scc1 standalone__deep_cross_pnn__recsys_kernel_nr21
    v_perm_b32 v248, v167, v163, s84
    v_perm_b32 v249, v175, v171, s84
    v_perm_b32 v250, v183, v179, s84
    v_perm_b32 v251, v191, v187, s84
    s_add_u32 s83, s82, 7185920
    buffer_store_dwordx4 v[248:251], v14, s[32:35], s83 offen sc1
    v_perm_b32 v252, v167, v163, s85
    v_perm_b32 v253, v175, v171, s85
    v_perm_b32 v254, v183, v179, s85
    v_perm_b32 v255, v191, v187, s85
    s_add_u32 s83, s82, 7288576
    buffer_store_dwordx4 v[252:255], v14, s[32:35], s83 offen sc1
standalone__deep_cross_pnn__recsys_kernel_nr21:
    buffer_store_dwordx4 v[108:111], v9, s[12:15], s6 offen offset:2048 sc1
    buffer_store_dwordx4 v[108:111], v9, s[12:15], s6 offen offset:3072 sc1

    s_waitcnt lgkmcnt(0)
    v_cmp_gt_u32 s[68:69], 2, v116

    v_cmp_eq_u32 s[72:73], 0, v116
    s_mov_b64 exec, s[70:71]
    v_cmpx_le_u32 vcc, 2, v87
    v_mov_b32 v62, s69
    v_mov_b32 v123, s73
    v_perm_b32 v121, v62, s68, v6
    v_perm_b32 v122, v123, s72, v5
    v_and_b32 v121, v121, v22
    v_and_b32 v122, v122, v21
    v_msad_u8 v120, v70, v121, 0
    v_lshlrev_b32 v120, 8, v120
    v_msad_u8 v120, v63, v122, v120
    v_and_b32 v120, v120, v59

    v_ffbl_b32 v120, v120
    v_max_i32 v84, v84, v120
    s_mov_b64 exec, -1
    v_lshl_add_u32 v59, -1, v84, v59

    v_lshl_add_u32 v61, v84, 1, v31
    ds_read_u16 v81, v61 offset:40
    s_bitcmp1_b32 s59, 0
    s_cbranch_scc1 standalone__deep_cross_pnn__recsys_kernel_pq11
    s_setprio 0
standalone__deep_cross_pnn__recsys_kernel_pq11:
    v_ffbl_b32 v84, v59
    v_perm_b32 v60, v77, v76, v84
    v_and_or_b32 v60, v60, s66, v85

    v_cmpx_ge_u32 vcc, 2, v84
    ds_add_u32 v60, v10
    s_not_b64 s[70:71], vcc
    s_mov_b64 exec, s[70:71]
    ds_add_rtn_u32 v87, v60, v10
    s_mov_b64 exec, -1

    ds_wrxchg_rtn_b32 v116, v86, v13
    buffer_store_dwordx4 v[108:111], v9, s[12:15], s7 offen offset:0 sc1
    buffer_store_dwordx4 v[108:111], v9, s[12:15], s7 offen offset:1024 sc1

    s_waitcnt lgkmcnt(0)
    v_cmp_gt_u32 s[68:69], 2, v116

    v_cmp_eq_u32 s[72:73], 0, v116
    s_mov_b64 exec, s[70:71]
    v_cmpx_le_u32 vcc, 2, v87
    v_mov_b32 v62, s69
    v_mov_b32 v123, s73
    v_perm_b32 v121, v62, s68, v6
    v_perm_b32 v122, v123, s72, v5
    v_and_b32 v121, v121, v22
    v_and_b32 v122, v122, v21
    v_msad_u8 v120, v70, v121, 0
    v_lshlrev_b32 v120, 8, v120
    v_msad_u8 v120, v63, v122, v120
    v_and_b32 v120, v120, v59

    v_ffbl_b32 v120, v120
    v_max_i32 v84, v84, v120
    s_mov_b64 exec, -1
    v_lshl_add_u32 v59, -1, v84, v59

    v_lshl_add_u32 v61, v84, 1, v31
    ds_read_u16 v82, v61 offset:40
    v_ffbl_b32 v84, v59
    v_perm_b32 v60, v77, v76, v84
    v_and_or_b32 v60, v60, s66, v85

    v_cmpx_ge_u32 vcc, 3, v84
    ds_add_u32 v60, v10
    s_not_b64 s[70:71], vcc
    s_mov_b64 exec, s[70:71]
    ds_add_rtn_u32 v87, v60, v10
    s_mov_b64 exec, -1

    ds_wrxchg_rtn_b32 v116, v86, v13
    buffer_store_dwordx4 v[108:111], v9, s[12:15], s7 offen offset:2048 sc1
    buffer_store_dwordx4 v[108:111], v9, s[12:15], s7 offen offset:3072 sc1
    buffer_store_dwordx2 v[108:109], v30, s[12:15], s8 offen sc1
    s_mov_b64 exec, 0xff
    buffer_load_dword v104, v9, s[52:55], 0 offen offset:128 sc1
    s_mov_b64 exec, -1

    s_waitcnt lgkmcnt(0)
    v_cmp_gt_u32 s[68:69], 2, v116

    s_mov_b64 exec, s[70:71]
    v_cmpx_le_u32 vcc, 2, v87
    v_mov_b32 v62, s69
    v_perm_b32 v121, v62, s68, v6
    v_and_b32 v121, v121, v22
    v_msad_u8 v120, v70, v121, 0
    v_and_b32_sdwa v120, v120, v59 dst_sel:BYTE_1 dst_unused:UNUSED_PAD src0_sel:DWORD src1_sel:BYTE_1
    s_nop 0

    v_ffbl_b32 v120, v120
    v_max_i32 v84, v84, v120
    s_mov_b64 exec, -1
    v_lshl_add_u32 v59, -1, v84, v59

    v_lshl_add_u32 v61, v84, 1, v31
    ds_read_u16 v83, v61 offset:40

    s_bitcmp1_b32 s59, 0
    s_cbranch_scc1 standalone__deep_cross_pnn__recsys_kernel_sk6
    v_mov_b32 v60, s46
    ds_write_b32 v86, v59
    ds_write_b32 v60, v10
    s_branch standalone__deep_cross_pnn__recsys_kernel_sdone

standalone__deep_cross_pnn__recsys_kernel_sk6:
    v_lshrrev_b32 v59, 4, v59
    v_add_u32 v63, v58, v22
    s_setprio 1
    v_ffbl_b32 v84, v59
    v_perm_b32 v60, v78, v77, v84

    v_cmp_lt_u32 vcc, 7, v84
    v_alignbyte_b32 v61, v79, v79, v84
    s_nop 0
    v_cndmask_b32 v60, v60, v61, vcc

    v_and_or_b32 v60, v60, s66, v85
    ds_add_rtn_u32 v87, v60, v10
    ds_wrxchg_rtn_b32 v116, v86, v13

    s_waitcnt lgkmcnt(0)
    v_cmp_gt_u32 s[68:69], 2, v116

    v_lshl_or_b32 v24, v81, 16, v80
    v_lshl_or_b32 v25, v83, 16, v82
    buffer_store_dwordx2 v[24:25], v30, s[32:35], s62 offen sc1
    s_add_u32 s62, s62, s63
    s_nop 0
    v_cmpx_le_u32 vcc, 2, v87
    v_mov_b32 v62, s69
    v_perm_b32 v121, v62, s68, v7
    v_perm_b32 v122, v62, s68, v6
    v_perm_b32 v123, v62, s68, v5
    v_and_b32 v121, v121, v23
    v_and_b32 v122, v122, v22
    v_and_b32 v123, v123, v21
    v_msad_u8 v120, v71, v121, 0
    v_lshlrev_b32 v120, 8, v120
    v_msad_u8 v120, v63, v122, v120
    v_msad_u8 v120, v69, v123, v120
    v_and_b32 v120, v120, v59

    v_ffbl_b32 v120, v120
    v_max_i32 v84, v84, v120
    s_mov_b64 exec, -1
    v_lshl_add_u32 v59, -1, v84, v59

    v_lshl_add_u32 v61, v84, 1, v31
    ds_read_u16 v80, v61 offset:48
    v_ffbl_b32 v84, v59
    v_perm_b32 v60, v78, v77, v84

    v_cmp_lt_u32 vcc, 7, v84
    v_alignbyte_b32 v61, v79, v79, v84
    s_nop 0
    v_cndmask_b32 v60, v60, v61, vcc

    v_and_or_b32 v60, v60, s66, v85
    ds_add_rtn_u32 v87, v60, v10
    ds_wrxchg_rtn_b32 v116, v86, v13

    s_waitcnt lgkmcnt(0)
    v_cmp_gt_u32 s[68:69], 2, v116

    s_nop 0
    v_cmpx_le_u32 vcc, 2, v87
    v_mov_b32 v62, s69
    v_perm_b32 v121, v62, s68, v7
    v_perm_b32 v122, v62, s68, v6
    v_perm_b32 v123, v62, s68, v5
    v_and_b32 v121, v121, v23
    v_and_b32 v122, v122, v22
    v_and_b32 v123, v123, v21
    v_msad_u8 v120, v71, v121, 0
    v_lshlrev_b32 v120, 8, v120
    v_msad_u8 v120, v63, v122, v120
    v_msad_u8 v120, v69, v123, v120
    v_and_b32 v120, v120, v59

    v_ffbl_b32 v120, v120
    v_max_i32 v84, v84, v120
    s_mov_b64 exec, -1
    v_lshl_add_u32 v59, -1, v84, v59

    v_lshl_add_u32 v61, v84, 1, v31
    ds_read_u16 v81, v61 offset:48
    v_ffbl_b32 v84, v59
    v_perm_b32 v60, v78, v77, v84

    v_cmp_lt_u32 vcc, 7, v84
    v_alignbyte_b32 v61, v79, v79, v84
    s_nop 0
    v_cndmask_b32 v60, v60, v61, vcc

    v_and_or_b32 v60, v60, s66, v85
    ds_add_rtn_u32 v87, v60, v10
    ds_wrxchg_rtn_b32 v116, v86, v13

    s_waitcnt lgkmcnt(0)
    v_cmp_gt_u32 s[68:69], 2, v116

    s_nop 0
    v_cmpx_le_u32 vcc, 2, v87
    v_mov_b32 v62, s69
    v_perm_b32 v121, v62, s68, v7
    v_perm_b32 v122, v62, s68, v6
    v_perm_b32 v123, v62, s68, v5
    v_and_b32 v121, v121, v23
    v_and_b32 v122, v122, v22
    v_and_b32 v123, v123, v21
    v_msad_u8 v120, v71, v121, 0
    v_lshlrev_b32 v120, 8, v120
    v_msad_u8 v120, v63, v122, v120
    v_msad_u8 v120, v69, v123, v120
    v_and_b32 v120, v120, v59

    v_ffbl_b32 v120, v120
    v_max_i32 v84, v84, v120
    s_mov_b64 exec, -1
    v_lshl_add_u32 v59, -1, v84, v59

    v_lshl_add_u32 v61, v84, 1, v31
    ds_read_u16 v82, v61 offset:48
    v_ffbl_b32 v84, v59
    v_lshl_add_u32 v61, v84, 1, v31
    ds_read_u16 v83, v61 offset:48
standalone__deep_cross_pnn__recsys_kernel_sdone:
    s_waitcnt lgkmcnt(0)
    v_lshl_or_b32 v24, v81, 16, v80
    v_lshl_or_b32 v25, v83, 16, v82
    buffer_store_dwordx2 v[24:25], v30, s[32:35], s62 offen sc1
    s_add_u32 s62, s62, s63
standalone__deep_cross_pnn__recsys_kernel_udone:
    s_setprio 0

    v_mul_u32_u24 v0, 4352, v8
    v_mov_b32 v1, 1
    s_and_b32 s47, s2, 3
    s_mul_i32 s46, s47, 4352
    s_add_u32 s46, s46, 14688256
    s_lshl_b32 s47, s47, 2
    s_add_u32 s39, s47, 14827520

    s_waitcnt vmcnt(0)

    s_mov_b64 exec, 1
    ds_add_rtn_u32 v12, v11, v10 offset:20
    s_mov_b32 s49, 0
    s_waitcnt lgkmcnt(0)
    v_readfirstlane_b32 s48, v12
    s_and_b32 s48, s48, 3

    s_mov_b64 exec, 0xff
standalone__deep_cross_pnn__recsys_kernel_ec1:

    v_cmp_ne_u32 vcc, -1, v104
    s_cbranch_vccz standalone__deep_cross_pnn__recsys_kernel_tbl
    buffer_load_dword v104, v9, s[52:55], 0 offen offset:128 sc1
    s_add_u32 s49, s49, 1
    s_waitcnt vmcnt(0)
    s_cmp_lt_u32 s49, 12
    s_cbranch_scc1 standalone__deep_cross_pnn__recsys_kernel_ec1
    s_branch standalone__deep_cross_pnn__recsys_kernel_enx

standalone__deep_cross_pnn__recsys_kernel_hset:

    s_lshl_b32 s39, 1, s51
    s_lshr_b32 s38, s51, 5
    v_mov_b32 v1, s39
    s_lshl_b32 s38, s38, 4
    s_mov_b64 exec, 1
    buffer_atomic_or v1, v13, s[52:55], s38 offen offset:132
    s_mov_b64 exec, -1
    s_waitcnt vmcnt(0)
    s_branch standalone__deep_cross_pnn__recsys_kernel_slow

standalone__deep_cross_pnn__recsys_kernel_tbl:

    s_cmp_eq_u32 s48, 3
    s_cselect_b32 s45, s64, 1
    s_cmp_lg_u32 s45, 0
    s_cbranch_scc1 standalone__deep_cross_pnn__recsys_kernel_nat
    s_mov_b64 exec, 1
    buffer_atomic_add v1, v13, s[12:15], s46 offen sc0

standalone__deep_cross_pnn__recsys_kernel_nat:
    s_mov_b64 exec, -1
    s_mov_b32 s49, -1

    s_xor_b32 s44, s50, 1
    s_lshl_b32 s44, s44, 3
    s_lshl1_add_u32 s47, s48, s44
    s_add_u32 s44, s44, s56
    s_lshl_b32 s44, s44, 14
    s_add_u32 s44, s44, 15204352
    s_lshl_b32 s47, s47, 14
    s_add_u32 s47, s47, 15269888

    buffer_load_dwordx4 v[136:139], v9, s[12:15], s44 offen offset:0 sc1
    buffer_load_dwordx4 v[140:143], v9, s[12:15], s44 offen offset:1024 sc1
    buffer_load_dwordx4 v[152:155], v9, s[12:15], s44 offen offset:2048 sc1
    buffer_load_dwordx4 v[156:159], v9, s[12:15], s44 offen offset:3072 sc1
    s_add_u32 s44, s44, 4096
    buffer_load_dwordx4 v[168:171], v9, s[12:15], s44 offen offset:0 sc1
    buffer_load_dwordx4 v[172:175], v9, s[12:15], s44 offen offset:1024 sc1
    buffer_load_dwordx4 v[184:187], v9, s[12:15], s44 offen offset:2048 sc1
    buffer_load_dwordx4 v[188:191], v9, s[12:15], s44 offen offset:3072 sc1
    s_add_u32 s44, s44, 4096

    s_waitcnt vmcnt(8)
    v_cmp_eq_u32 vcc, 63, v1

    s_cbranch_vccz standalone__deep_cross_pnn__recsys_kernel_nsg
    s_mov_b64 exec, 0xff
    buffer_store_dword v10, v0, s[12:15], s39 offen sc1
    s_mov_b64 exec, -1

standalone__deep_cross_pnn__recsys_kernel_nsg:
    s_waitcnt vmcnt(7)
    buffer_load_dwordx4 v[200:203], v9, s[12:15], s44 offen offset:0 sc1
    s_waitcnt vmcnt(7)
    buffer_load_dwordx4 v[204:207], v9, s[12:15], s44 offen offset:1024 sc1
    s_waitcnt vmcnt(7)
    buffer_load_dwordx4 v[216:219], v9, s[12:15], s44 offen offset:2048 sc1
    s_waitcnt vmcnt(7)
    buffer_load_dwordx4 v[220:223], v9, s[12:15], s44 offen offset:3072 sc1
    s_add_u32 s44, s44, 4096
    s_waitcnt vmcnt(7)
    buffer_load_dwordx4 v[232:235], v9, s[12:15], s44 offen offset:0 sc1
    s_waitcnt vmcnt(7)
    buffer_load_dwordx4 v[236:239], v9, s[12:15], s44 offen offset:1024 sc1
    s_waitcnt vmcnt(7)
    buffer_load_dwordx4 v[248:251], v9, s[12:15], s44 offen offset:2048 sc1
    s_waitcnt vmcnt(7)
    buffer_load_dwordx4 v[252:255], v9, s[12:15], s44 offen offset:3072 sc1
    s_add_u32 s44, s44, 4096
standalone__deep_cross_pnn__recsys_kernel_enx:

    s_mov_b64 exec, -1
    s_mul_i32 s85, s56, 18432
    v_and_b32 v25, 15, v8
    v_lshrrev_b32 v26, 4, v8
    v_mul_u32_u24 v24, 144, v25
    v_lshl_add_u32 v24, v26, 4, v24
    v_add_u32 v24, s85, v24

    s_lshr_b32 s79, s2, 1
    s_mul_i32 s77, s79, 102656
    s_lshl_b32 s85, s50, 11
    s_xor_b32 s78, s85, 2048
    s_add_u32 s78, s78, s77
    s_add_u32 s77, s77, s85
    s_and_b32 s79, s2, 1
    s_mul_i32 s79, s79, 1638400
    s_add_u32 s79, s79, 16777216
    s_lshl_b32 s85, s3, 13
    s_add_u32 s79, s79, s85
    s_xor_b32 s85, s3, 4
    s_lshl_b32 s85, s85, 10
    s_min_u32 s85, s85, 7040
    s_bitcmp1_b32 s2, 1
    s_cselect_b32 s83, 0, 16
    s_lshl_b32 s80, s24, s83
    s_lshl_b32 s81, s25, s83
    s_lshl_b32 s82, s26, s83
    s_lshl_b32 s83, s27, s83
    s_and_b32 s80, s80, 0xffff0000
    s_and_b32 s81, s81, 0xffff0000
    s_and_b32 s82, s82, 0xffff0000
    s_and_b32 s83, s83, 0xffff0000
    ds_read_b128 v[128:131], v24 offset:0
    ds_read_b128 v[132:135], v24 offset:64
    v_lshlrev_b32 v69, 4, v8
    v_lshlrev_b32 v70, 13, v26
    v_lshl_add_u32 v70, v25, 3, v70
    v_add_u32 v70, s85, v70
    ds_read_b128 v[144:147], v24 offset:2304
    ds_read_b128 v[148:151], v24 offset:2368
    v_lshrrev_b32 v28, 3, v8
    v_xor_b32 v28, v28, v26
    v_and_b32 v28, 1, v28
    v_bfe_u32 v29, v8, 2, 1
    ds_read_b128 v[160:163], v24 offset:4608
    ds_read_b128 v[164:167], v24 offset:4672
    v_lshl_or_b32 v28, v28, 1, v29
    v_mov_b32 v30, 0x3f80
    v_cmp_eq_u32 vcc, 0, v28
    v_cmp_eq_u32 s[68:69], 1, v28
    ds_read_b128 v[176:179], v24 offset:6912
    ds_read_b128 v[180:183], v24 offset:6976
    v_and_b32 v29, 3, v8
    v_mul_u32_u24 v68, 0x5555, v29
    v_cndmask_b32 v64, 0, v30, vcc
    v_cndmask_b32 v65, 0, v30, vcc
    ds_read_b128 v[192:195], v24 offset:9216
    ds_read_b128 v[196:199], v24 offset:9280
    v_cndmask_b32 v66, 0, v30, s[68:69]
    v_cndmask_b32 v67, 0, v30, s[68:69]
    v_add_u32 v114, 144256, v69
    v_add_u32 v71, 0x10000, v70
    ds_read_b128 v[208:211], v24 offset:11520
    ds_read_b128 v[212:215], v24 offset:11584
    v_mov_b64 v[32:33], s[80:81]
    v_mov_b64 v[34:35], s[82:83]
    v_mov_b64 v[36:37], s[80:81]
    v_mov_b64 v[38:39], s[82:83]
    ds_read_b128 v[224:227], v24 offset:13824
    ds_read_b128 v[228:231], v24 offset:13888
    v_mov_b64 v[40:41], s[80:81]
    v_mov_b64 v[42:43], s[82:83]
    v_mov_b64 v[44:45], s[80:81]
    v_mov_b64 v[46:47], s[82:83]
    ds_read_b128 v[240:243], v24 offset:16128
    ds_read_b128 v[244:247], v24 offset:16192
    v_mov_b64 v[48:49], s[80:81]
    v_mov_b64 v[50:51], s[82:83]
    v_mov_b64 v[52:53], s[80:81]
    v_mov_b64 v[54:55], s[82:83]
    v_mov_b64 v[56:57], s[80:81]
    v_mov_b64 v[58:59], s[82:83]
    v_mov_b64 v[60:61], s[80:81]
    v_mov_b64 v[62:63], s[82:83]

    s_bitcmp1_b32 s56, 1
    s_cselect_b32 s84, s78, s77
    s_lshl_b32 s85, s56, 10
    s_add_u32 m0, s85, 144256
    s_and_b32 s85, s85, 1024
    s_add_u32 s84, s84, s85

    s_add_u32 s85, s84, 0
    buffer_load_dwordx4 v[88:91], v69, s[12:15], s85 offen sc1
    s_add_u32 s85, s84, 4096
    buffer_load_dwordx4 v[88:91], v69, s[12:15], s85 offen sc1
    s_add_u32 s85, s84, 8192
    buffer_load_dwordx4 v[88:91], v69, s[12:15], s85 offen sc1
    s_add_u32 s85, s84, 12288
    buffer_load_dwordx4 v[88:91], v69, s[12:15], s85 offen sc1

    s_cmp_lg_u32 s48, 0
    s_cbranch_scc1 standalone__deep_cross_pnn__recsys_kernel_wdec
    s_mov_b64 exec, -1
    v_lshlrev_b32 v0, 7, v8
    v_lshrrev_b32 v2, 5, v8
    v_lshlrev_b32 v2, 4, v2
    v_mul_u32_u24 v3, 4, v8
    s_mov_b32 s44, 14680064
    s_bfe_u32 s46, s2, 196608
    s_mul_i32 s47, s46, 4352
    s_add_u32 s47, s47, 14827520
    s_lshl_b32 s46, s46, 2
    s_mov_b32 s38, 3221225472

standalone__deep_cross_pnn__recsys_kernel_p0:

    ds_read_b32 v12, v11 offset:20
    s_waitcnt lgkmcnt(0)
    v_readfirstlane_b32 s45, v12
    s_and_b32 s45, s45, 3
    s_cbranch_scc0 standalone__deep_cross_pnn__recsys_kernel_p1s
    s_sleep 1
    s_branch standalone__deep_cross_pnn__recsys_kernel_p0

standalone__deep_cross_pnn__recsys_kernel_p1s:

    s_cmp_lg_u32 s64, 0
    s_cbranch_scc1 standalone__deep_cross_pnn__recsys_kernel_hset

    s_mov_b64 exec, 1
    s_cmp_lg_u32 s49, -1
    s_cbranch_scc1 standalone__deep_cross_pnn__recsys_kernel_nfp

    buffer_store_dword v10, v13, s[12:15], s9 offen sc1
    s_mov_b64 exec, 0xf
standalone__deep_cross_pnn__recsys_kernel_p1:

    buffer_load_dword v1, v3, s[12:15], s47 offen sc1
    s_add_u32 s65, s65, 1
    s_waitcnt vmcnt(0)
    v_cmp_eq_u32 vcc, 0, v1
    s_cbranch_vccz standalone__deep_cross_pnn__recsys_kernel_dec
    s_sleep 2
    s_cmp_lt_u32 s65, 200
    s_cbranch_scc1 standalone__deep_cross_pnn__recsys_kernel_p1
    s_mov_b64 exec, 1

standalone__deep_cross_pnn__recsys_kernel_nfp:

    buffer_store_dword v10, v13, s[12:15], s9 offen sc1
    s_mov_b64 exec, -1

standalone__deep_cross_pnn__recsys_kernel_slow:
    buffer_load_dwordx2 v[16:17], v2, s[52:55], 0 offen offset:128 sc1
    buffer_load_dwordx2 v[18:19], v2, s[52:55], 0 offen offset:160 sc1
    buffer_load_dwordx2 v[20:21], v2, s[52:55], 0 offen offset:192 sc1
    buffer_load_dwordx2 v[22:23], v2, s[52:55], 0 offen offset:224 sc1

    s_waitcnt vmcnt(0)
    buffer_load_dwordx4 v[4:7], v0, s[12:15], s44 offen sc1
    s_add_u32 s65, s65, 1
    s_waitcnt vmcnt(0)

    v_bfe_u32 v16, v16, v8, 1
    v_bfe_u32 v17, v17, v8, 1
    v_and_b32 v4, v4, v16
    v_or_b32 v17, v17, v4

    v_bfe_u32 v18, v18, v8, 1
    v_bfe_u32 v19, v19, v8, 1
    v_and_b32 v5, v5, v18
    v_or_b32 v19, v19, v5

    v_bfe_u32 v20, v20, v8, 1
    v_bfe_u32 v21, v21, v8, 1
    v_and_b32 v6, v6, v20
    v_or_b32 v21, v21, v6

    v_bfe_u32 v22, v22, v8, 1
    v_bfe_u32 v23, v23, v8, 1
    v_and_b32 v7, v7, v22
    v_or_b32 v23, v23, v7

    v_min3_u32 v1, v4, v5, v6
    v_min_u32 v1, v1, v7
    v_cmp_eq_u32 vcc, 0, v1
    s_mov_b32 s38, 3221225472
    s_cbranch_vccz standalone__deep_cross_pnn__recsys_kernel_dec
    v_min3_u32 v1, v17, v19, v21
    v_min_u32 v1, v1, v23
    v_cmp_eq_u32 vcc, 0, v1
    s_mov_b32 s38, 2147483648
    s_cbranch_vccz standalone__deep_cross_pnn__recsys_kernel_dec
    s_cmp_lt_u32 s65, 200
    s_cbranch_scc1 standalone__deep_cross_pnn__recsys_kernel_slow

    v_cmp_eq_u32 vcc, 0, v17
    s_movk_i32 s38, 0
    s_cbranch_vccnz standalone__deep_cross_pnn__recsys_kernel_fnd
    v_cmp_eq_u32 vcc, 0, v19
    s_movk_i32 s38, 64
    s_cbranch_vccnz standalone__deep_cross_pnn__recsys_kernel_fnd
    v_cmp_eq_u32 vcc, 0, v21
    s_movk_i32 s38, 128
    s_cbranch_vccnz standalone__deep_cross_pnn__recsys_kernel_fnd
    v_cmp_eq_u32 vcc, 0, v23
    s_movk_i32 s38, 192
standalone__deep_cross_pnn__recsys_kernel_fnd:

    s_ff1_i32_b64 s39, vcc
    s_add_u32 s38, s38, s39
    s_andn2_b32 s39, s64, 255
    s_add_u32 s39, s39, 256
    s_or_b32 s38, s38, s39

standalone__deep_cross_pnn__recsys_kernel_dec:

    s_mov_b64 exec, 1
    v_mov_b32 v1, s38
    ds_write_b32 v11, v1 offset:24

standalone__deep_cross_pnn__recsys_kernel_wdec:

    s_mov_b64 exec, -1
    ds_read_b32 v12, v11 offset:24
    s_waitcnt lgkmcnt(0)
    v_readfirstlane_b32 s45, v12
    s_cmp_lg_u32 s45, s64
    s_cbranch_scc1 standalone__deep_cross_pnn__recsys_kernel_gotd
    s_sleep 2
    s_branch standalone__deep_cross_pnn__recsys_kernel_wdec

standalone__deep_cross_pnn__recsys_kernel_hlp:
    s_waitcnt vmcnt(0)
    s_branch standalone__deep_cross_pnn__recsys_kernel_unit
standalone__deep_cross_pnn__recsys_kernel_gotd:

    s_mov_b32 s64, s45
    s_and_b32 s51, s45, 255

    s_mov_b32 s65, 200
    s_bitcmp0_b32 s45, 31
    s_cbranch_scc1 standalone__deep_cross_pnn__recsys_kernel_hlp

    s_cmp_eq_u32 s49, -1
    s_cbranch_scc1 standalone__deep_cross_pnn__recsys_kernel_k2

    s_xor_b32 s44, s50, 1
    s_lshl_b32 s44, s44, 3
    s_lshl1_add_u32 s47, s48, s44
    s_add_u32 s44, s44, s56
    s_lshl_b32 s44, s44, 14
    s_add_u32 s44, s44, 15204352
    s_lshl_b32 s47, s47, 14
    s_add_u32 s47, s47, 15269888

    buffer_load_dwordx4 v[136:139], v9, s[12:15], s44 offen offset:0 sc1
    buffer_load_dwordx4 v[140:143], v9, s[12:15], s44 offen offset:1024 sc1
    buffer_load_dwordx4 v[152:155], v9, s[12:15], s44 offen offset:2048 sc1
    buffer_load_dwordx4 v[156:159], v9, s[12:15], s44 offen offset:3072 sc1
    s_add_u32 s44, s44, 4096
    buffer_load_dwordx4 v[168:171], v9, s[12:15], s44 offen offset:0 sc1
    buffer_load_dwordx4 v[172:175], v9, s[12:15], s44 offen offset:1024 sc1
    buffer_load_dwordx4 v[184:187], v9, s[12:15], s44 offen offset:2048 sc1
    buffer_load_dwordx4 v[188:191], v9, s[12:15], s44 offen offset:3072 sc1
    s_add_u32 s44, s44, 4096
    s_waitcnt vmcnt(7)
    buffer_load_dwordx4 v[200:203], v9, s[12:15], s44 offen offset:0 sc1
    s_waitcnt vmcnt(7)
    buffer_load_dwordx4 v[204:207], v9, s[12:15], s44 offen offset:1024 sc1
    s_waitcnt vmcnt(7)
    buffer_load_dwordx4 v[216:219], v9, s[12:15], s44 offen offset:2048 sc1
    s_waitcnt vmcnt(7)
    buffer_load_dwordx4 v[220:223], v9, s[12:15], s44 offen offset:3072 sc1
    s_add_u32 s44, s44, 4096
    s_waitcnt vmcnt(7)
    buffer_load_dwordx4 v[232:235], v9, s[12:15], s44 offen offset:0 sc1
    s_waitcnt vmcnt(7)
    buffer_load_dwordx4 v[236:239], v9, s[12:15], s44 offen offset:1024 sc1
    s_waitcnt vmcnt(7)
    buffer_load_dwordx4 v[248:251], v9, s[12:15], s44 offen offset:2048 sc1
    s_waitcnt vmcnt(7)
    buffer_load_dwordx4 v[252:255], v9, s[12:15], s44 offen offset:3072 sc1
    s_add_u32 s44, s44, 4096
standalone__deep_cross_pnn__recsys_kernel_k2:
    s_setprio 1
    buffer_load_dwordx4 v[0:3], v69, s[12:15], s77 offen offset:0 sc1
    buffer_load_dwordx4 v[4:7], v69, s[12:15], s77 offen offset:1024 sc1
    buffer_load_dwordx4 v[8:11], v69, s[12:15], s78 offen offset:0 sc1
    buffer_load_dwordx4 v[12:15], v69, s[12:15], s78 offen offset:1024 sc1
    buffer_load_dwordx4 v69, s[12:15], s84 offen sc1 lds
    s_add_u32 m0, m0, 4096
    s_add_u32 s84, s84, 4096
    buffer_load_dwordx4 v69, s[12:15], s84 offen sc1 lds
    s_add_u32 m0, m0, 4096
    s_add_u32 s84, s84, 4096
    buffer_load_dwordx4 v69, s[12:15], s84 offen sc1 lds
    s_add_u32 s44, s77, 4096
    s_add_u32 s45, s78, 4096
    buffer_load_dwordx4 v[16:19], v69, s[12:15], s44 offen offset:0 sc1
    buffer_load_dwordx4 v[20:23], v69, s[12:15], s44 offen offset:1024 sc1
    buffer_load_dwordx4 v[24:27], v69, s[12:15], s45 offen offset:0 sc1
    buffer_load_dwordx4 v[28:31], v69, s[12:15], s45 offen offset:1024 sc1
    s_barrier
    s_waitcnt vmcnt(7)
    v_mfma_f32_16x16x32_bf16 v[88:91], v[0:3], v[128:131], 0
    v_mfma_f32_16x16x32_bf16 v[92:95], v[0:3], v[144:147], 0
    s_add_u32 s21, s77, 12288
    v_mfma_f32_16x16x32_bf16 v[88:91], v[4:7], v[132:135], v[88:91]
    s_add_u32 s19, s78, 12288
    v_mfma_f32_16x16x32_bf16 v[92:95], v[4:7], v[148:151], v[92:95]
    s_mov_b32 s20, s79
    v_mfma_f32_16x16x32_bf16 v[88:91], v[8:11], v[136:139], v[88:91]
    s_lshr_b32 s33, s2, 1
    v_mfma_f32_16x16x32_bf16 v[92:95], v[8:11], v[152:155], v[92:95]
    s_and_b32 s34, s2, 1
    v_mfma_f32_16x16x32_bf16 v[88:91], v[12:15], v[140:143], v[88:91]
    s_load_dwordx4 s[56:59], s[0:1], 48
    s_load_dword s28, s[10:11], 0
    s_load_dword s29, s[10:11], 16
    s_load_dword s30, s[10:11], 32
    s_load_dword s31, s[10:11], 48
    v_mfma_f32_16x16x32_bf16 v[92:95], v[12:15], v[156:159], v[92:95]
    v_mfma_f32_16x16x32_bf16 v[96:99], v[0:3], v[160:163], 0
    v_mfma_f32_16x16x32_bf16 v[100:103], v[0:3], v[176:179], 0
    v_mfma_f32_16x16x32_bf16 v[96:99], v[4:7], v[164:167], v[96:99]
    v_cvt_pk_bf16_f32 v116, v88, v89
    v_mfma_f32_16x16x32_bf16 v[100:103], v[4:7], v[180:183], v[100:103]
    v_cvt_pk_bf16_f32 v117, v90, v91
    v_mfma_f32_16x16x32_bf16 v[96:99], v[8:11], v[168:171], v[96:99]
    v_mfma_f32_16x16x32_bf16 v[100:103], v[8:11], v[184:187], v[100:103]
    v_cvt_pk_bf16_f32 v118, v92, v93
    v_mfma_f32_16x16x32_bf16 v[96:99], v[12:15], v[172:175], v[96:99]
    v_cvt_pk_bf16_f32 v119, v94, v95
    v_mfma_f32_16x16x32_bf16 v[100:103], v[12:15], v[188:191], v[100:103]
    v_mfma_f32_16x16x32_bf16 v[104:107], v[0:3], v[192:195], 0
    v_mfma_f32_16x16x32_bf16 v[108:111], v[0:3], v[208:211], 0
    v_mfma_f32_16x16x32_bf16 v[104:107], v[4:7], v[196:199], v[104:107]
    v_cvt_pk_bf16_f32 v120, v96, v97
    v_mfma_f32_16x16x32_bf16 v[108:111], v[4:7], v[212:215], v[108:111]
    v_cvt_pk_bf16_f32 v121, v98, v99
    v_mfma_f32_16x16x32_bf16 v[104:107], v[8:11], v[200:203], v[104:107]
    v_mfma_f32_16x16x32_bf16 v[108:111], v[8:11], v[216:219], v[108:111]
    v_cvt_pk_bf16_f32 v122, v100, v101
    v_mfma_f32_16x16x32_bf16 v[104:107], v[12:15], v[204:207], v[104:107]
    v_cvt_pk_bf16_f32 v123, v102, v103
    v_mfma_f32_16x16x32_bf16 v[108:111], v[12:15], v[220:223], v[108:111]
    v_mfma_f32_16x16x32_bf16 v[88:91], v[0:3], v[224:227], 0
    v_mfma_f32_16x16x32_bf16 v[92:95], v[0:3], v[240:243], 0
    v_mfma_f32_16x16x32_bf16 v[88:91], v[4:7], v[228:231], v[88:91]
    v_cvt_pk_bf16_f32 v124, v104, v105
    v_mfma_f32_16x16x32_bf16 v[92:95], v[4:7], v[244:247], v[92:95]
    v_cvt_pk_bf16_f32 v125, v106, v107
    v_mfma_f32_16x16x32_bf16 v[88:91], v[8:11], v[232:235], v[88:91]
    v_mfma_f32_16x16x32_bf16 v[92:95], v[8:11], v[248:251], v[92:95]
    v_cvt_pk_bf16_f32 v126, v108, v109
    v_mfma_f32_16x16x32_bf16 v[88:91], v[12:15], v[236:239], v[88:91]
    v_cvt_pk_bf16_f32 v127, v110, v111
    v_mfma_f32_16x16x32_bf16 v[92:95], v[12:15], v[252:255], v[92:95]
    s_waitcnt vmcnt(0)
    v_mfma_f32_16x16x32_bf16 v[96:99], v[16:19], v[128:131], 0
    v_mfma_f32_16x16x32_bf16 v[100:103], v[16:19], v[144:147], 0
    v_mfma_f32_16x16x32_bf16 v[96:99], v[20:23], v[132:135], v[96:99]
    v_cvt_pk_bf16_f32 v72, v88, v89
    v_mfma_f32_16x16x32_bf16 v[100:103], v[20:23], v[148:151], v[100:103]
    v_cvt_pk_bf16_f32 v73, v90, v91
    s_waitcnt vmcnt(4)
    s_barrier
    v_mfma_f32_16x16x32_bf16 v[96:99], v[24:27], v[136:139], v[96:99]
    v_mfma_f32_16x16x32_bf16 v[100:103], v[24:27], v[152:155], v[100:103]
    v_cvt_pk_bf16_f32 v74, v92, v93
    v_mfma_f32_16x16x32_bf16 v[96:99], v[28:31], v[140:143], v[96:99]
    v_cvt_pk_bf16_f32 v75, v94, v95
    v_mfma_f32_16x16x32_bf16 v[100:103], v[28:31], v[156:159], v[100:103]
    v_mfma_f32_16x16x32_bf16 v[104:107], v[16:19], v[160:163], 0
    v_mfma_f32_16x16x32_bf16 v[108:111], v[16:19], v[176:179], 0
    v_mfma_f32_16x16x32_bf16 v[104:107], v[20:23], v[164:167], v[104:107]
    v_cvt_pk_bf16_f32 v76, v96, v97
    v_mfma_f32_16x16x32_bf16 v[108:111], v[20:23], v[180:183], v[108:111]
    v_cvt_pk_bf16_f32 v77, v98, v99
    v_mfma_f32_16x16x32_bf16 v[104:107], v[24:27], v[168:171], v[104:107]
    v_mfma_f32_16x16x32_bf16 v[108:111], v[24:27], v[184:187], v[108:111]
    v_cvt_pk_bf16_f32 v78, v100, v101
    v_mfma_f32_16x16x32_bf16 v[104:107], v[28:31], v[172:175], v[104:107]
    v_cvt_pk_bf16_f32 v79, v102, v103
    v_mfma_f32_16x16x32_bf16 v[108:111], v[28:31], v[188:191], v[108:111]
    v_mfma_f32_16x16x32_bf16 v[88:91], v[16:19], v[192:195], 0
    v_mfma_f32_16x16x32_bf16 v[92:95], v[16:19], v[208:211], 0
    v_mfma_f32_16x16x32_bf16 v[88:91], v[20:23], v[196:199], v[88:91]
    v_cvt_pk_bf16_f32 v80, v104, v105
    v_mfma_f32_16x16x32_bf16 v[92:95], v[20:23], v[212:215], v[92:95]
    v_cvt_pk_bf16_f32 v81, v106, v107
    v_mfma_f32_16x16x32_bf16 v[88:91], v[24:27], v[200:203], v[88:91]
    v_mfma_f32_16x16x32_bf16 v[92:95], v[24:27], v[216:219], v[92:95]
    v_cvt_pk_bf16_f32 v82, v108, v109
    v_mfma_f32_16x16x32_bf16 v[88:91], v[28:31], v[204:207], v[88:91]
    v_cvt_pk_bf16_f32 v83, v110, v111
    ds_write_b64 v70, v[116:117] offset:0
    v_mfma_f32_16x16x32_bf16 v[92:95], v[28:31], v[220:223], v[92:95]
    ds_read_b128 v[0:3], v114 offset:8192
    ds_read_b128 v[4:7], v114 offset:9216
    ds_read_b128 v[8:11], v114 offset:10240
    ds_read_b128 v[12:15], v114 offset:11264
    v_mfma_f32_16x16x32_bf16 v[96:99], v[16:19], v[224:227], 0
    ds_write_b64 v70, v[118:119] offset:128
    v_mfma_f32_16x16x32_bf16 v[100:103], v[16:19], v[240:243], 0
    v_mfma_f32_16x16x32_bf16 v[96:99], v[20:23], v[228:231], v[96:99]
    v_cvt_pk_bf16_f32 v88, v88, v89
    ds_write_b64 v70, v[120:121] offset:256
    v_mfma_f32_16x16x32_bf16 v[100:103], v[20:23], v[244:247], v[100:103]
    v_cvt_pk_bf16_f32 v89, v90, v91
    v_mfma_f32_16x16x32_bf16 v[96:99], v[24:27], v[232:235], v[96:99]
    ds_write_b64 v70, v[88:89] offset:33280
    ds_write_b64 v70, v[122:123] offset:384
    v_mfma_f32_16x16x32_bf16 v[100:103], v[24:27], v[248:251], v[100:103]
    v_cvt_pk_bf16_f32 v92, v92, v93
    v_mfma_f32_16x16x32_bf16 v[96:99], v[28:31], v[236:239], v[96:99]
    v_cvt_pk_bf16_f32 v93, v94, v95
    ds_write_b64 v70, v[124:125] offset:512
    v_mfma_f32_16x16x32_bf16 v[100:103], v[28:31], v[252:255], v[100:103]
    ds_write_b64 v70, v[92:93] offset:33408
    s_waitcnt lgkmcnt(6)
    v_mfma_f32_16x16x32_bf16 v[104:107], v[0:3], v[128:131], 0
    buffer_load_dwordx4 v[116:119], v69, s[12:15], s20 offen offset:0 sc1
    ds_write_b64 v70, v[126:127] offset:640
    v_mfma_f32_16x16x32_bf16 v[108:111], v[0:3], v[144:147], 0
    v_mfma_f32_16x16x32_bf16 v[104:107], v[4:7], v[132:135], v[104:107]
    v_cvt_pk_bf16_f32 v96, v96, v97
    ds_write_b64 v70, v[72:73] offset:768
    v_mfma_f32_16x16x32_bf16 v[108:111], v[4:7], v[148:151], v[108:111]
    v_cvt_pk_bf16_f32 v97, v98, v99
    v_mfma_f32_16x16x32_bf16 v[104:107], v[8:11], v[136:139], v[104:107]
    ds_write_b64 v70, v[96:97] offset:33536
    buffer_load_dwordx4 v[120:123], v69, s[12:15], s20 offen offset:1024 sc1
    v_mfma_f32_16x16x32_bf16 v[108:111], v[8:11], v[152:155], v[108:111]
    v_cvt_pk_bf16_f32 v100, v100, v101
    ds_write_b64 v70, v[74:75] offset:896
    v_mfma_f32_16x16x32_bf16 v[104:107], v[12:15], v[140:143], v[104:107]
    v_cvt_pk_bf16_f32 v101, v102, v103
    v_mov_b64 v[16:17], s[80:81]
    v_mfma_f32_16x16x32_bf16 v[108:111], v[12:15], v[156:159], v[108:111]
    ds_write_b64 v70, v[100:101] offset:33664
    v_mov_b64 v[18:19], s[82:83]
    v_mfma_f32_16x16x32_bf16 v[88:91], v[0:3], v[160:163], 0
    v_mov_b64 v[20:21], s[80:81]
    v_mov_b64 v[22:23], s[82:83]
    v_mfma_f32_16x16x32_bf16 v[92:95], v[0:3], v[176:179], 0
    v_mov_b64 v[24:25], s[80:81]
    v_mov_b64 v[26:27], s[82:83]
    v_mfma_f32_16x16x32_bf16 v[88:91], v[4:7], v[164:167], v[88:91]
    v_cvt_pk_bf16_f32 v104, v104, v105
    v_mov_b64 v[28:29], s[80:81]
    v_mfma_f32_16x16x32_bf16 v[92:95], v[4:7], v[180:183], v[92:95]
    v_cvt_pk_bf16_f32 v105, v106, v107
    v_mov_b64 v[30:31], s[82:83]
    v_mfma_f32_16x16x32_bf16 v[88:91], v[8:11], v[168:171], v[88:91]
    ds_write_b64 v71, v[104:105] offset:0
    ds_write_b64 v70, v[76:77] offset:32768
    v_mfma_f32_16x16x32_bf16 v[92:95], v[8:11], v[184:187], v[92:95]
    v_cvt_pk_bf16_f32 v108, v108, v109
    buffer_load_dwordx4 v[124:127], v69, s[12:15], s20 offen offset:2048 sc1
    v_mfma_f32_16x16x32_bf16 v[88:91], v[12:15], v[172:175], v[88:91]
    v_cvt_pk_bf16_f32 v109, v110, v111
    ds_write_b64 v70, v[78:79] offset:32896
    v_mfma_f32_16x16x32_bf16 v[92:95], v[12:15], v[188:191], v[92:95]
    ds_write_b64 v71, v[108:109] offset:128
    ds_write_b64 v70, v[80:81] offset:33024
    v_mfma_f32_16x16x32_bf16 v[96:99], v[0:3], v[192:195], 0
    buffer_load_dwordx4 v[72:75], v69, s[12:15], s21 offen offset:0 sc1
    ds_write_b64 v70, v[82:83] offset:33152
    v_mfma_f32_16x16x32_bf16 v[100:103], v[0:3], v[208:211], 0
    buffer_load_dwordx4 v[76:79], v69, s[12:15], s21 offen offset:1024 sc1
    v_mfma_f32_16x16x32_bf16 v[96:99], v[4:7], v[196:199], v[96:99]
    v_cvt_pk_bf16_f32 v88, v88, v89
    v_mfma_f32_16x16x32_bf16 v[100:103], v[4:7], v[212:215], v[100:103]
    v_cvt_pk_bf16_f32 v89, v90, v91
    v_mfma_f32_16x16x32_bf16 v[96:99], v[8:11], v[200:203], v[96:99]
    ds_write_b64 v71, v[88:89] offset:256
    buffer_load_dwordx4 v[80:83], v69, s[12:15], s19 offen offset:0 sc1
    v_mfma_f32_16x16x32_bf16 v[100:103], v[8:11], v[216:219], v[100:103]
    v_cvt_pk_bf16_f32 v92, v92, v93
    v_mfma_f32_16x16x32_bf16 v[96:99], v[12:15], v[204:207], v[96:99]
    v_cvt_pk_bf16_f32 v93, v94, v95
    v_mfma_f32_16x16x32_bf16 v[100:103], v[12:15], v[220:223], v[100:103]
    ds_write_b64 v71, v[92:93] offset:384
    v_mfma_f32_16x16x32_bf16 v[104:107], v[0:3], v[224:227], 0
    buffer_load_dwordx4 v[84:87], v69, s[12:15], s19 offen offset:1024 sc1
    s_add_u32 s21, s21, 4096
    s_add_u32 s19, s19, 4096
    v_mfma_f32_16x16x32_bf16 v[108:111], v[0:3], v[240:243], 0
    v_mfma_f32_16x16x32_bf16 v[104:107], v[4:7], v[228:231], v[104:107]
    v_cvt_pk_bf16_f32 v96, v96, v97
    v_mfma_f32_16x16x32_bf16 v[108:111], v[4:7], v[244:247], v[108:111]
    v_cvt_pk_bf16_f32 v97, v98, v99
    v_mfma_f32_16x16x32_bf16 v[104:107], v[8:11], v[232:235], v[104:107]
    ds_write_b64 v71, v[96:97] offset:512
    v_mfma_f32_16x16x32_bf16 v[108:111], v[8:11], v[248:251], v[108:111]
    v_cvt_pk_bf16_f32 v100, v100, v101
    v_mov_b64 v[0:1], s[80:81]
    v_mfma_f32_16x16x32_bf16 v[104:107], v[12:15], v[236:239], v[104:107]
    v_cvt_pk_bf16_f32 v101, v102, v103
    v_mov_b64 v[2:3], s[82:83]
    v_mfma_f32_16x16x32_bf16 v[108:111], v[12:15], v[252:255], v[108:111]
    ds_write_b64 v71, v[100:101] offset:640
    v_mov_b64 v[4:5], s[80:81]
    s_nop 1
    v_mov_b64 v[6:7], s[82:83]
    v_mov_b64 v[8:9], s[80:81]
    v_mov_b64 v[10:11], s[82:83]
    v_mov_b64 v[12:13], s[80:81]
    v_mov_b64 v[14:15], s[82:83]
    s_nop 4
    v_cvt_pk_bf16_f32 v104, v104, v105
    v_cvt_pk_bf16_f32 v105, v106, v107
    ds_write_b64 v71, v[104:105] offset:768
    v_cvt_pk_bf16_f32 v108, v108, v109
    v_cvt_pk_bf16_f32 v109, v110, v111
    ds_write_b64 v71, v[108:109] offset:896
    v_add_u32 v70, 0x18000, v70
    s_branch standalone__deep_cross_pnn__recsys_kernel_k2j
standalone__deep_cross_pnn__recsys_kernel_k2m:
    s_barrier

    s_setprio 0
    s_waitcnt vmcnt(0)

    buffer_load_dwordx4 v[136:139], v254, s[12:15], s44 offen offset:0 sc1
    ds_read_b128 v[128:131], v95 offset:0
    ds_read_b128 v[132:135], v95 offset:64
    ds_read_b128 v[144:147], v95 offset:2304
    ds_read_b128 v[148:151], v95 offset:2368
    v_fma_f32 v85, v208, v44, v240
    v_mov_b32 v84, v239
    v_mov_b32 v86, v241
    v_mov_b32 v113, v243
    v_mov_b32 v112, v94
    v_add_u32 v114, 144256, v254
    v_fmac_f32 v85, v209, v45
    v_fmac_f32 v85, v210, v46
    v_fmac_f32 v85, v211, v47
    v_fmac_f32 v85, v52, v60
    buffer_load_dwordx4 v[140:143], v254, s[12:15], s44 offen offset:1024 sc1
    ds_read_b128 v[160:163], v95 offset:4608
    ds_read_b128 v[164:167], v95 offset:4672
    ds_read_b128 v[176:179], v95 offset:6912
    ds_read_b128 v[180:183], v95 offset:6976
    v_fmac_f32 v85, v53, v61
    v_fmac_f32 v85, v54, v62
    v_fmac_f32 v85, v55, v63
    v_fmac_f32 v85, v200, v36
    v_fmac_f32 v85, v201, v37
    buffer_load_dwordx4 v[152:155], v254, s[12:15], s44 offen offset:2048 sc1
    ds_read_b128 v[208:211], v95 offset:11520
    ds_read_b128 v[212:215], v95 offset:11584
    ds_read_b128 v[224:227], v95 offset:13824
    ds_read_b128 v[228:231], v95 offset:13888
    v_fmac_f32 v85, v202, v38
    v_fmac_f32 v85, v203, v39
    v_fmac_f32 v85, v204, v40
    v_fmac_f32 v85, v205, v41
    v_fmac_f32 v85, v206, v42
    buffer_load_dwordx4 v[156:159], v254, s[12:15], s44 offen offset:3072 sc1
    s_add_u32 s44, s44, 4096
    ds_read_b128 v[240:243], v95 offset:16128
    ds_read_b128 v[244:247], v95 offset:16192
    ds_read_b128 v[192:195], v95 offset:9216
    ds_read_b128 v[196:199], v95 offset:9280
    v_fmac_f32 v85, v207, v43

    buffer_load_dwordx4 v[168:171], v254, s[12:15], s44 offen offset:0 sc1
    v_and_b32 v49, 15, v255
    v_lshrrev_b32 v50, 4, v255
    v_lshlrev_b32 v69, 4, v255
    v_lshlrev_b32 v70, 13, v50
    buffer_load_dwordx4 v[172:175], v254, s[12:15], s44 offen offset:1024 sc1
    v_lshl_add_u32 v70, v49, 3, v70
    v_add_u32 v70, s85, v70
    v_add_u32 v71, 0x10000, v70
    s_waitcnt lgkmcnt(0)
    s_barrier
    s_setprio 2
    ds_read_b128 v[0:3], v114 offset:0
    ds_read_b128 v[4:7], v114 offset:1024
    ds_read_b128 v[8:11], v114 offset:2048
    ds_read_b128 v[12:15], v114 offset:3072
    s_add_u32 s21, s77, 12288
    s_add_u32 s19, s78, 12288
    s_mov_b32 s20, s79
    s_lshr_b32 s33, s2, 1
    s_and_b32 s34, s2, 1
    v_lshrrev_b32 v52, 3, v255
    v_xor_b32 v52, v52, v50
    v_and_b32 v52, 1, v52
    v_bfe_u32 v53, v255, 2, 1
    v_lshl_or_b32 v52, v52, 1, v53
    v_mov_b32 v54, 0x3f80
    s_waitcnt lgkmcnt(0)
    v_mfma_f32_16x16x32_bf16 v[88:91], v[0:3], v[128:131], 0
    buffer_load_dwordx4 v[184:187], v69, s[12:15], s44 offen offset:2048 sc1
    v_cmp_eq_u32 vcc, 0, v52
    ds_read_b128 v[16:19], v114 offset:4096
    ds_read_b128 v[20:23], v114 offset:5120
    ds_read_b128 v[24:27], v114 offset:6144
    ds_read_b128 v[28:31], v114 offset:7168
    v_mfma_f32_16x16x32_bf16 v[92:95], v[0:3], v[144:147], 0
    v_permlane32_swap_b32 v84, v85
    v_mfma_f32_16x16x32_bf16 v[88:91], v[4:7], v[132:135], v[88:91]
    v_cmp_eq_u32 s[68:69], 1, v52
    v_mfma_f32_16x16x32_bf16 v[92:95], v[4:7], v[148:151], v[92:95]
    v_add_f32 v87, v84, v85
    buffer_load_dwordx4 v[188:191], v69, s[12:15], s44 offen offset:3072 sc1
    s_add_u32 s44, s44, 4096
    s_waitcnt vmcnt(4)
    v_mfma_f32_16x16x32_bf16 v[88:91], v[8:11], v[136:139], v[88:91]
    v_and_b32 v53, 3, v255
    v_mfma_f32_16x16x32_bf16 v[92:95], v[8:11], v[152:155], v[92:95]
    v_permlane16_swap_b32 v86, v87
    v_mfma_f32_16x16x32_bf16 v[88:91], v[12:15], v[140:143], v[88:91]
    buffer_load_dwordx4 v[200:203], v69, s[12:15], s44 offen offset:0 sc1
    v_mul_u32_u24 v68, 0x5555, v53
    ds_read_b128 v[32:35], v114 offset:8192
    ds_read_b128 v[36:39], v114 offset:9216
    ds_read_b128 v[40:43], v114 offset:10240
    ds_read_b128 v[44:47], v114 offset:11264
    v_mfma_f32_16x16x32_bf16 v[92:95], v[12:15], v[156:159], v[92:95]
    v_add_f32 v86, v86, v87
    s_waitcnt lgkmcnt(4)
    v_mfma_f32_16x16x32_bf16 v[96:99], v[16:19], v[128:131], 0
    v_cndmask_b32 v64, 0, v54, vcc
    v_mfma_f32_16x16x32_bf16 v[100:103], v[16:19], v[144:147], 0
    v_add_f32_dpp v86, v86, v86 row_ror:8 row_mask:0xf bank_mask:0xf
    buffer_load_dwordx4 v[204:207], v69, s[12:15], s44 offen offset:1024 sc1
    v_mfma_f32_16x16x32_bf16 v[96:99], v[20:23], v[132:135], v[96:99]
    v_cvt_pk_bf16_f32 v88, v88, v89
    v_cndmask_b32 v65, 0, v54, vcc
    v_mfma_f32_16x16x32_bf16 v[100:103], v[20:23], v[148:151], v[100:103]
    v_cvt_pk_bf16_f32 v89, v90, v91
    v_add_f32_dpp v86, v86, v86 row_ror:4 row_mask:0xf bank_mask:0xf
    v_mfma_f32_16x16x32_bf16 v[96:99], v[24:27], v[136:139], v[96:99]
    ds_write_b64 v70, v[88:89] offset:0
    buffer_load_dwordx4 v[216:219], v69, s[12:15], s44 offen offset:2048 sc1
    v_mfma_f32_16x16x32_bf16 v[100:103], v[24:27], v[152:155], v[100:103]
    v_cvt_pk_bf16_f32 v92, v92, v93
    v_cndmask_b32 v66, 0, v54, s[68:69]
    v_mfma_f32_16x16x32_bf16 v[96:99], v[28:31], v[140:143], v[96:99]
    v_cvt_pk_bf16_f32 v93, v94, v95
    v_add_f32_dpp v86, v86, v86 row_ror:2 row_mask:0xf bank_mask:0xf
    v_mfma_f32_16x16x32_bf16 v[100:103], v[28:31], v[156:159], v[100:103]
    ds_write_b64 v70, v[92:93] offset:128
    v_cndmask_b32 v67, 0, v54, s[68:69]
    s_waitcnt lgkmcnt(2)
    v_mfma_f32_16x16x32_bf16 v[104:107], v[32:35], v[128:131], 0
    v_add_f32_dpp v86, v86, v86 row_ror:1 row_mask:0xf bank_mask:0xf
    buffer_load_dwordx4 v[220:223], v69, s[12:15], s44 offen offset:3072 sc1
    s_add_u32 s44, s44, 4096
    v_mfma_f32_16x16x32_bf16 v[108:111], v[32:35], v[144:147], 0
    v_cndmask_b32 v113, v113, v86, s[70:71]
    v_mfma_f32_16x16x32_bf16 v[104:107], v[36:39], v[132:135], v[104:107]
    v_cvt_pk_bf16_f32 v96, v96, v97
    buffer_load_dwordx4 v[232:235], v69, s[12:15], s44 offen offset:0 sc1
    v_mfma_f32_16x16x32_bf16 v[108:111], v[36:39], v[148:151], v[108:111]
    v_cvt_pk_bf16_f32 v97, v98, v99
    v_mfma_f32_16x16x32_bf16 v[104:107], v[40:43], v[136:139], v[104:107]
    ds_write_b64 v70, v[96:97] offset:32768
    v_mfma_f32_16x16x32_bf16 v[108:111], v[40:43], v[152:155], v[108:111]
    v_cvt_pk_bf16_f32 v100, v100, v101
    buffer_load_dwordx4 v[236:239], v69, s[12:15], s44 offen offset:1024 sc1
    v_mfma_f32_16x16x32_bf16 v[104:107], v[44:47], v[140:143], v[104:107]
    v_cvt_pk_bf16_f32 v101, v102, v103
    s_mov_b64 exec, s[46:47]
    buffer_store_dword v113, v112, s[12:15], s76 offen sc1
    s_mov_b64 exec, -1
    v_mfma_f32_16x16x32_bf16 v[108:111], v[44:47], v[156:159], v[108:111]
    ds_write_b64 v70, v[100:101] offset:32896
    v_mov_b64 v[48:49], s[80:81]
    v_mfma_f32_16x16x32_bf16 v[88:91], v[0:3], v[160:163], 0
    buffer_load_dwordx4 v[248:251], v69, s[12:15], s44 offen offset:2048 sc1
    v_mov_b64 v[50:51], s[82:83]
    v_mfma_f32_16x16x32_bf16 v[92:95], v[0:3], v[176:179], 0
    v_mov_b64 v[52:53], s[80:81]
    v_mfma_f32_16x16x32_bf16 v[88:91], v[4:7], v[164:167], v[88:91]
    v_cvt_pk_bf16_f32 v104, v104, v105
    v_mov_b64 v[54:55], s[82:83]
    v_mfma_f32_16x16x32_bf16 v[92:95], v[4:7], v[180:183], v[92:95]
    v_cvt_pk_bf16_f32 v105, v106, v107
    buffer_load_dwordx4 v[252:255], v69, s[12:15], s44 offen offset:3072 sc1
    s_add_u32 s44, s44, 4096
    s_waitcnt vmcnt(9)
    v_mfma_f32_16x16x32_bf16 v[88:91], v[8:11], v[168:171], v[88:91]
    ds_write_b64 v71, v[104:105] offset:0
    v_mov_b64 v[56:57], s[80:81]
    v_mfma_f32_16x16x32_bf16 v[92:95], v[8:11], v[184:187], v[92:95]
    v_cvt_pk_bf16_f32 v108, v108, v109
    v_mov_b64 v[58:59], s[82:83]
    v_mfma_f32_16x16x32_bf16 v[88:91], v[12:15], v[172:175], v[88:91]
    v_cvt_pk_bf16_f32 v109, v110, v111
    v_mov_b64 v[60:61], s[80:81]
    v_mfma_f32_16x16x32_bf16 v[92:95], v[12:15], v[188:191], v[92:95]
    ds_write_b64 v71, v[108:109] offset:128
    buffer_load_dwordx4 v[116:119], v69, s[12:15], s20 offen offset:0 sc1
    v_mfma_f32_16x16x32_bf16 v[96:99], v[16:19], v[160:163], 0
    v_mov_b64 v[62:63], s[82:83]
    v_mfma_f32_16x16x32_bf16 v[100:103], v[16:19], v[176:179], 0
    buffer_load_dwordx4 v[120:123], v69, s[12:15], s20 offen offset:1024 sc1
    v_mfma_f32_16x16x32_bf16 v[96:99], v[20:23], v[164:167], v[96:99]
    v_cvt_pk_bf16_f32 v88, v88, v89
    v_mfma_f32_16x16x32_bf16 v[100:103], v[20:23], v[180:183], v[100:103]
    v_cvt_pk_bf16_f32 v89, v90, v91
    v_mfma_f32_16x16x32_bf16 v[96:99], v[24:27], v[168:171], v[96:99]
    ds_write_b64 v70, v[88:89] offset:256
    buffer_load_dwordx4 v[124:127], v69, s[12:15], s20 offen offset:2048 sc1
    v_mfma_f32_16x16x32_bf16 v[100:103], v[24:27], v[184:187], v[100:103]
    v_cvt_pk_bf16_f32 v92, v92, v93
    v_mfma_f32_16x16x32_bf16 v[96:99], v[28:31], v[172:175], v[96:99]
    v_cvt_pk_bf16_f32 v93, v94, v95
    v_mfma_f32_16x16x32_bf16 v[100:103], v[28:31], v[188:191], v[100:103]
    ds_write_b64 v70, v[92:93] offset:384
    buffer_load_dwordx4 v[72:75], v69, s[12:15], s21 offen offset:0 sc1
    v_mfma_f32_16x16x32_bf16 v[104:107], v[32:35], v[160:163], 0
    v_mfma_f32_16x16x32_bf16 v[108:111], v[32:35], v[176:179], 0
    s_load_dwordx4 s[56:59], s[0:1], 48
    v_mfma_f32_16x16x32_bf16 v[104:107], v[36:39], v[164:167], v[104:107]
    v_cvt_pk_bf16_f32 v96, v96, v97
    buffer_load_dwordx4 v[76:79], v69, s[12:15], s21 offen offset:1024 sc1
    v_mfma_f32_16x16x32_bf16 v[108:111], v[36:39], v[180:183], v[108:111]
    v_cvt_pk_bf16_f32 v97, v98, v99
    v_mfma_f32_16x16x32_bf16 v[104:107], v[40:43], v[168:171], v[104:107]
    ds_write_b64 v70, v[96:97] offset:33024
    v_mfma_f32_16x16x32_bf16 v[108:111], v[40:43], v[184:187], v[108:111]
    v_cvt_pk_bf16_f32 v100, v100, v101
    buffer_load_dwordx4 v[80:83], v69, s[12:15], s19 offen offset:0 sc1
    v_mfma_f32_16x16x32_bf16 v[104:107], v[44:47], v[172:175], v[104:107]
    v_cvt_pk_bf16_f32 v101, v102, v103
    v_mfma_f32_16x16x32_bf16 v[108:111], v[44:47], v[188:191], v[108:111]
    ds_write_b64 v70, v[100:101] offset:33152
    v_mfma_f32_16x16x32_bf16 v[88:91], v[0:3], v[192:195], 0
    buffer_load_dwordx4 v[84:87], v69, s[12:15], s19 offen offset:1024 sc1
    s_add_u32 s21, s21, 4096
    s_add_u32 s19, s19, 4096
    v_mfma_f32_16x16x32_bf16 v[92:95], v[0:3], v[208:211], 0
    v_mfma_f32_16x16x32_bf16 v[88:91], v[4:7], v[196:199], v[88:91]
    v_cvt_pk_bf16_f32 v104, v104, v105
    v_mfma_f32_16x16x32_bf16 v[92:95], v[4:7], v[212:215], v[92:95]
    v_cvt_pk_bf16_f32 v105, v106, v107
    s_waitcnt vmcnt(12)
    v_mfma_f32_16x16x32_bf16 v[88:91], v[8:11], v[200:203], v[88:91]
    ds_write_b64 v71, v[104:105] offset:256
    v_mfma_f32_16x16x32_bf16 v[92:95], v[8:11], v[216:219], v[92:95]
    v_cvt_pk_bf16_f32 v108, v108, v109
    v_mfma_f32_16x16x32_bf16 v[88:91], v[12:15], v[204:207], v[88:91]
    v_cvt_pk_bf16_f32 v109, v110, v111
    v_mfma_f32_16x16x32_bf16 v[92:95], v[12:15], v[220:223], v[92:95]
    ds_write_b64 v71, v[108:109] offset:384
    v_mfma_f32_16x16x32_bf16 v[96:99], v[16:19], v[192:195], 0
    v_mfma_f32_16x16x32_bf16 v[100:103], v[16:19], v[208:211], 0
    v_mfma_f32_16x16x32_bf16 v[96:99], v[20:23], v[196:199], v[96:99]
    v_cvt_pk_bf16_f32 v88, v88, v89
    v_mfma_f32_16x16x32_bf16 v[100:103], v[20:23], v[212:215], v[100:103]
    v_cvt_pk_bf16_f32 v89, v90, v91
    v_mfma_f32_16x16x32_bf16 v[96:99], v[24:27], v[200:203], v[96:99]
    ds_write_b64 v70, v[88:89] offset:512
    v_mfma_f32_16x16x32_bf16 v[100:103], v[24:27], v[216:219], v[100:103]
    v_cvt_pk_bf16_f32 v92, v92, v93
    v_mfma_f32_16x16x32_bf16 v[96:99], v[28:31], v[204:207], v[96:99]
    v_cvt_pk_bf16_f32 v93, v94, v95
    v_mfma_f32_16x16x32_bf16 v[100:103], v[28:31], v[220:223], v[100:103]
    ds_write_b64 v70, v[92:93] offset:640
    v_mfma_f32_16x16x32_bf16 v[104:107], v[32:35], v[192:195], 0
    v_mfma_f32_16x16x32_bf16 v[108:111], v[32:35], v[208:211], 0
    v_mfma_f32_16x16x32_bf16 v[104:107], v[36:39], v[196:199], v[104:107]
    v_cvt_pk_bf16_f32 v96, v96, v97
    v_mfma_f32_16x16x32_bf16 v[108:111], v[36:39], v[212:215], v[108:111]
    v_cvt_pk_bf16_f32 v97, v98, v99
    v_mfma_f32_16x16x32_bf16 v[104:107], v[40:43], v[200:203], v[104:107]
    ds_write_b64 v70, v[96:97] offset:33280
    v_mfma_f32_16x16x32_bf16 v[108:111], v[40:43], v[216:219], v[108:111]
    v_cvt_pk_bf16_f32 v100, v100, v101
    v_mfma_f32_16x16x32_bf16 v[104:107], v[44:47], v[204:207], v[104:107]
    v_cvt_pk_bf16_f32 v101, v102, v103
    v_mfma_f32_16x16x32_bf16 v[108:111], v[44:47], v[220:223], v[108:111]
    ds_write_b64 v70, v[100:101] offset:33408
    v_mfma_f32_16x16x32_bf16 v[88:91], v[0:3], v[224:227], 0
    v_mfma_f32_16x16x32_bf16 v[92:95], v[0:3], v[240:243], 0
    v_mfma_f32_16x16x32_bf16 v[88:91], v[4:7], v[228:231], v[88:91]
    v_cvt_pk_bf16_f32 v104, v104, v105
    v_mfma_f32_16x16x32_bf16 v[92:95], v[4:7], v[244:247], v[92:95]
    v_cvt_pk_bf16_f32 v105, v106, v107
    s_waitcnt vmcnt(7)
    v_mfma_f32_16x16x32_bf16 v[88:91], v[8:11], v[232:235], v[88:91]
    ds_write_b64 v71, v[104:105] offset:512
    v_mfma_f32_16x16x32_bf16 v[92:95], v[8:11], v[248:251], v[92:95]
    v_cvt_pk_bf16_f32 v108, v108, v109
    v_mov_b64 v[0:1], s[80:81]
    v_mfma_f32_16x16x32_bf16 v[88:91], v[12:15], v[236:239], v[88:91]
    v_cvt_pk_bf16_f32 v109, v110, v111
    v_mov_b64 v[2:3], s[82:83]
    v_mfma_f32_16x16x32_bf16 v[92:95], v[12:15], v[252:255], v[92:95]
    ds_write_b64 v71, v[108:109] offset:640
    v_mov_b64 v[4:5], s[80:81]
    v_mfma_f32_16x16x32_bf16 v[96:99], v[16:19], v[224:227], 0
    v_mov_b64 v[6:7], s[82:83]
    v_mfma_f32_16x16x32_bf16 v[100:103], v[16:19], v[240:243], 0
    v_mov_b64 v[8:9], s[80:81]
    v_mov_b64 v[10:11], s[82:83]
    v_mfma_f32_16x16x32_bf16 v[96:99], v[20:23], v[228:231], v[96:99]
    v_cvt_pk_bf16_f32 v88, v88, v89
    v_mfma_f32_16x16x32_bf16 v[100:103], v[20:23], v[244:247], v[100:103]
    v_cvt_pk_bf16_f32 v89, v90, v91
    v_mov_b64 v[12:13], s[80:81]
    v_mfma_f32_16x16x32_bf16 v[96:99], v[24:27], v[232:235], v[96:99]
    ds_write_b64 v70, v[88:89] offset:768
    v_mov_b64 v[14:15], s[82:83]
    v_mfma_f32_16x16x32_bf16 v[100:103], v[24:27], v[248:251], v[100:103]
    v_cvt_pk_bf16_f32 v92, v92, v93
    v_mov_b64 v[16:17], s[80:81]
    v_mfma_f32_16x16x32_bf16 v[96:99], v[28:31], v[236:239], v[96:99]
    v_cvt_pk_bf16_f32 v93, v94, v95
    v_mov_b64 v[18:19], s[82:83]
    v_mfma_f32_16x16x32_bf16 v[100:103], v[28:31], v[252:255], v[100:103]
    ds_write_b64 v70, v[92:93] offset:896
    v_mov_b64 v[20:21], s[80:81]
    v_mfma_f32_16x16x32_bf16 v[104:107], v[32:35], v[224:227], 0
    v_mov_b64 v[22:23], s[82:83]
    v_mfma_f32_16x16x32_bf16 v[108:111], v[32:35], v[240:243], 0
    v_mov_b64 v[24:25], s[80:81]
    v_mov_b64 v[26:27], s[82:83]
    v_mfma_f32_16x16x32_bf16 v[104:107], v[36:39], v[228:231], v[104:107]
    v_cvt_pk_bf16_f32 v96, v96, v97
    v_mfma_f32_16x16x32_bf16 v[108:111], v[36:39], v[244:247], v[108:111]
    v_cvt_pk_bf16_f32 v97, v98, v99
    v_mov_b64 v[28:29], s[80:81]
    v_mfma_f32_16x16x32_bf16 v[104:107], v[40:43], v[232:235], v[104:107]
    ds_write_b64 v70, v[96:97] offset:33536
    v_mov_b64 v[30:31], s[82:83]
    v_mfma_f32_16x16x32_bf16 v[108:111], v[40:43], v[248:251], v[108:111]
    v_cvt_pk_bf16_f32 v100, v100, v101
    v_mov_b64 v[32:33], s[80:81]
    v_mfma_f32_16x16x32_bf16 v[104:107], v[44:47], v[236:239], v[104:107]
    v_cvt_pk_bf16_f32 v101, v102, v103
    v_mov_b64 v[34:35], s[82:83]
    v_mfma_f32_16x16x32_bf16 v[108:111], v[44:47], v[252:255], v[108:111]
    ds_write_b64 v70, v[100:101] offset:33664
    v_mov_b64 v[36:37], s[80:81]
    s_nop 1
    v_mov_b64 v[38:39], s[82:83]
    v_mov_b64 v[40:41], s[80:81]
    v_mov_b64 v[42:43], s[82:83]
    v_mov_b64 v[44:45], s[80:81]
    v_mov_b64 v[46:47], s[82:83]
    s_nop 4
    v_cvt_pk_bf16_f32 v104, v104, v105
    v_cvt_pk_bf16_f32 v105, v106, v107
    ds_write_b64 v71, v[104:105] offset:768
    v_cvt_pk_bf16_f32 v108, v108, v109
    v_cvt_pk_bf16_f32 v109, v110, v111
    ds_write_b64 v71, v[108:109] offset:896
    v_add_u32 v70, 0x18000, v70
standalone__deep_cross_pnn__recsys_kernel_k2j:

    s_mov_b32 s22, 0
    s_mov_b32 s32, 0x8000
    s_mov_b32 s23, 1108378657
    s_mov_b64 exec, 2
    ds_write_b64 v69, v[66:67] offset:8064
    s_mov_b64 exec, -1
    s_mov_b32 s37, 0

    s_mov_b32 m0, 0
    s_waitcnt vmcnt(0) lgkmcnt(0)
    s_barrier

    v_lshlrev_b32_sdwa v88, 3, v116 dst_sel:DWORD dst_unused:UNUSED_PAD src0_sel:DWORD src1_sel:WORD_0
    v_lshlrev_b32_sdwa v90, 3, v116 dst_sel:DWORD dst_unused:UNUSED_PAD src0_sel:DWORD src1_sel:WORD_1
    v_lshlrev_b32_sdwa v92, 3, v117 dst_sel:DWORD dst_unused:UNUSED_PAD src0_sel:DWORD src1_sel:WORD_0
    v_lshlrev_b32_sdwa v94, 3, v117 dst_sel:DWORD dst_unused:UNUSED_PAD src0_sel:DWORD src1_sel:WORD_1
    ds_read_b64 v[88:89], v88
    ds_read_b64 v[90:91], v90
    ds_read_b64 v[92:93], v92
    ds_read_b64 v[94:95], v94
    v_lshlrev_b32_sdwa v96, 3, v118 dst_sel:DWORD dst_unused:UNUSED_PAD src0_sel:DWORD src1_sel:WORD_0
    v_lshlrev_b32_sdwa v98, 3, v118 dst_sel:DWORD dst_unused:UNUSED_PAD src0_sel:DWORD src1_sel:WORD_1
    v_lshlrev_b32_sdwa v100, 3, v119 dst_sel:DWORD dst_unused:UNUSED_PAD src0_sel:DWORD src1_sel:WORD_0
    v_lshlrev_b32_sdwa v102, 3, v119 dst_sel:DWORD dst_unused:UNUSED_PAD src0_sel:DWORD src1_sel:WORD_1
    ds_read_b64 v[96:97], v96
    ds_read_b64 v[98:99], v98
    ds_read_b64 v[100:101], v100
    ds_read_b64 v[102:103], v102
    buffer_load_dwordx4 v[116:119], v69, s[12:15], s20 offen offset:3072 sc1
    s_add_u32 s20, s20, 4096
    s_bitcmp1_b32 s2, 1
    s_cselect_b32 s35, 0, 16
    s_lshl_b32 s28, s28, s35
    s_lshl_b32 s29, s29, s35
    s_lshl_b32 s30, s30, s35
    s_lshl_b32 s31, s31, s35
    s_and_b32 s28, s28, 0xffff0000
    s_and_b32 s29, s29, 0xffff0000
    s_and_b32 s30, s30, 0xffff0000
    s_and_b32 s31, s31, 0xffff0000
    s_cmp_ge_u32 s3, 4
    s_cbranch_scc1 standalone__deep_cross_pnn__recsys_kernel_k2x
    s_waitcnt lgkmcnt(0)
standalone__deep_cross_pnn__recsys_kernel_gloop:
    s_waitcnt vmcnt(6)
    v_lshlrev_b32_sdwa v104, 3, v120 dst_sel:DWORD dst_unused:UNUSED_PAD src0_sel:DWORD src1_sel:WORD_0
    v_lshlrev_b32_sdwa v106, 3, v120 dst_sel:DWORD dst_unused:UNUSED_PAD src0_sel:DWORD src1_sel:WORD_1
    ds_read_b64 v[104:105], v104
    ds_read_b64 v[106:107], v106
    v_lshlrev_b32_sdwa v108, 3, v121 dst_sel:DWORD dst_unused:UNUSED_PAD src0_sel:DWORD src1_sel:WORD_0
    v_lshlrev_b32_sdwa v110, 3, v121 dst_sel:DWORD dst_unused:UNUSED_PAD src0_sel:DWORD src1_sel:WORD_1
    ds_read_b64 v[108:109], v108
    ds_read_b64 v[110:111], v110
    s_waitcnt lgkmcnt(10)
    v_smfmac_f32_16x16x64_bf16 v[0:3], v[64:67], v[88:95], v68
    v_lshlrev_b32_sdwa v88, 3, v122 dst_sel:DWORD dst_unused:UNUSED_PAD src0_sel:DWORD src1_sel:WORD_0
    v_lshlrev_b32_sdwa v90, 3, v122 dst_sel:DWORD dst_unused:UNUSED_PAD src0_sel:DWORD src1_sel:WORD_1
    ds_read_b64 v[88:89], v88
    ds_read_b64 v[90:91], v90
    v_lshlrev_b32_sdwa v92, 3, v123 dst_sel:DWORD dst_unused:UNUSED_PAD src0_sel:DWORD src1_sel:WORD_0
    v_lshlrev_b32_sdwa v94, 3, v123 dst_sel:DWORD dst_unused:UNUSED_PAD src0_sel:DWORD src1_sel:WORD_1
    ds_read_b64 v[92:93], v92
    ds_read_addtid_b32 v71 offset:8080
    ds_read_b64 v[94:95], v94
    s_waitcnt lgkmcnt(9)
    v_smfmac_f32_16x16x64_bf16 v[4:7], v[64:67], v[96:103], v68
    buffer_load_dwordx4 v[120:123], v69, s[12:15], s20 offen offset:0 sc1
    s_waitcnt vmcnt(6)
    v_mfma_f32_16x16x32_bf16 v[112:115], v[72:75], v[128:131], 0
    s_waitcnt vmcnt(5)
    v_lshlrev_b32_sdwa v96, 3, v124 dst_sel:DWORD dst_unused:UNUSED_PAD src0_sel:DWORD src1_sel:WORD_0
    v_lshlrev_b32_sdwa v98, 3, v124 dst_sel:DWORD dst_unused:UNUSED_PAD src0_sel:DWORD src1_sel:WORD_1
    ds_read_b64 v[96:97], v96
    ds_read_b64 v[98:99], v98
    s_waitcnt vmcnt(4)
    v_mfma_f32_16x16x32_bf16 v[112:115], v[76:79], v[132:135], v[112:115]
    v_lshlrev_b32_sdwa v100, 3, v125 dst_sel:DWORD dst_unused:UNUSED_PAD src0_sel:DWORD src1_sel:WORD_0
    v_lshlrev_b32_sdwa v102, 3, v125 dst_sel:DWORD dst_unused:UNUSED_PAD src0_sel:DWORD src1_sel:WORD_1
    ds_read_b64 v[100:101], v100
    ds_read_b64 v[102:103], v102
    s_waitcnt lgkmcnt(9)
    v_smfmac_f32_16x16x64_bf16 v[8:11], v[64:67], v[104:111], v68
    s_waitcnt vmcnt(3)
    v_mfma_f32_16x16x32_bf16 v[112:115], v[80:83], v[136:139], v[112:115]
    v_lshlrev_b32_sdwa v104, 3, v126 dst_sel:DWORD dst_unused:UNUSED_PAD src0_sel:DWORD src1_sel:WORD_0
    v_lshlrev_b32_sdwa v106, 3, v126 dst_sel:DWORD dst_unused:UNUSED_PAD src0_sel:DWORD src1_sel:WORD_1
    ds_read_b64 v[104:105], v104
    ds_read_b64 v[106:107], v106
    s_waitcnt vmcnt(2)
    v_mfma_f32_16x16x32_bf16 v[112:115], v[84:87], v[140:143], v[112:115]
    v_lshlrev_b32_sdwa v108, 3, v127 dst_sel:DWORD dst_unused:UNUSED_PAD src0_sel:DWORD src1_sel:WORD_0
    v_lshlrev_b32_sdwa v110, 3, v127 dst_sel:DWORD dst_unused:UNUSED_PAD src0_sel:DWORD src1_sel:WORD_1
    ds_read_b64 v[108:109], v108
    ds_read_b64 v[110:111], v110
    s_waitcnt lgkmcnt(8)
    v_smfmac_f32_16x16x64_bf16 v[12:15], v[64:67], v[88:95], v68
    buffer_load_dwordx4 v[124:127], v69, s[12:15], s20 offen offset:1024 sc1
    v_readfirstlane_b32 s36, v71
    v_cvt_pk_bf16_f32 v112, v112, v113
    v_cvt_pk_bf16_f32 v113, v114, v115
    s_cmp_lt_u32 s36, s37
    s_cbranch_scc1 standalone__deep_cross_pnn__recsys_kernel_sp0
standalone__deep_cross_pnn__recsys_kernel_sr0:
    s_add_u32 s37, s37, 512
    ds_write_b64 v70, v[112:113] offset:0
    v_mfma_f32_16x16x32_bf16 v[112:115], v[72:75], v[144:147], 0
    v_mfma_f32_16x16x32_bf16 v[112:115], v[76:79], v[148:151], v[112:115]
    s_waitcnt vmcnt(2)
    v_lshlrev_b32_sdwa v88, 3, v116 dst_sel:DWORD dst_unused:UNUSED_PAD src0_sel:DWORD src1_sel:WORD_0
    v_lshlrev_b32_sdwa v90, 3, v116 dst_sel:DWORD dst_unused:UNUSED_PAD src0_sel:DWORD src1_sel:WORD_1
    ds_read_b64 v[88:89], v88
    ds_read_b64 v[90:91], v90
    v_mfma_f32_16x16x32_bf16 v[112:115], v[80:83], v[152:155], v[112:115]
    v_mfma_f32_16x16x32_bf16 v[112:115], v[84:87], v[156:159], v[112:115]
    v_lshlrev_b32_sdwa v92, 3, v117 dst_sel:DWORD dst_unused:UNUSED_PAD src0_sel:DWORD src1_sel:WORD_0
    v_lshlrev_b32_sdwa v94, 3, v117 dst_sel:DWORD dst_unused:UNUSED_PAD src0_sel:DWORD src1_sel:WORD_1
    ds_read_b64 v[92:93], v92
    ds_read_b64 v[94:95], v94
    s_waitcnt lgkmcnt(9)
    v_smfmac_f32_16x16x64_bf16 v[16:19], v[64:67], v[96:103], v68
    s_nop 1
    v_cvt_pk_bf16_f32 v112, v112, v113
    v_cvt_pk_bf16_f32 v113, v114, v115
    ds_write_b64 v70, v[112:113] offset:128
    v_mfma_f32_16x16x32_bf16 v[112:115], v[72:75], v[160:163], 0
    v_lshlrev_b32_sdwa v96, 3, v118 dst_sel:DWORD dst_unused:UNUSED_PAD src0_sel:DWORD src1_sel:WORD_0
    v_lshlrev_b32_sdwa v98, 3, v118 dst_sel:DWORD dst_unused:UNUSED_PAD src0_sel:DWORD src1_sel:WORD_1
    ds_read_b64 v[96:97], v96
    ds_read_b64 v[98:99], v98
    v_mfma_f32_16x16x32_bf16 v[112:115], v[76:79], v[164:167], v[112:115]
    v_lshlrev_b32_sdwa v100, 3, v119 dst_sel:DWORD dst_unused:UNUSED_PAD src0_sel:DWORD src1_sel:WORD_0
    v_lshlrev_b32_sdwa v102, 3, v119 dst_sel:DWORD dst_unused:UNUSED_PAD src0_sel:DWORD src1_sel:WORD_1
    ds_read_b64 v[100:101], v100
    ds_read_b64 v[102:103], v102
    s_waitcnt lgkmcnt(10)
    v_smfmac_f32_16x16x64_bf16 v[20:23], v[64:67], v[104:111], v68
    buffer_load_dwordx4 v[116:119], v69, s[12:15], s20 offen offset:2048 sc1
    s_setprio 2
    v_mfma_f32_16x16x32_bf16 v[112:115], v[80:83], v[168:171], v[112:115]
    s_waitcnt vmcnt(2)
    v_lshlrev_b32_sdwa v104, 3, v120 dst_sel:DWORD dst_unused:UNUSED_PAD src0_sel:DWORD src1_sel:WORD_0
    v_lshlrev_b32_sdwa v106, 3, v120 dst_sel:DWORD dst_unused:UNUSED_PAD src0_sel:DWORD src1_sel:WORD_1
    ds_read_b64 v[104:105], v104
    ds_read_b64 v[106:107], v106
    v_mfma_f32_16x16x32_bf16 v[112:115], v[84:87], v[172:175], v[112:115]
    v_lshlrev_b32_sdwa v108, 3, v121 dst_sel:DWORD dst_unused:UNUSED_PAD src0_sel:DWORD src1_sel:WORD_0
    v_lshlrev_b32_sdwa v110, 3, v121 dst_sel:DWORD dst_unused:UNUSED_PAD src0_sel:DWORD src1_sel:WORD_1
    ds_read_b64 v[108:109], v108
    ds_read_b64 v[110:111], v110
    s_waitcnt lgkmcnt(9)
    v_smfmac_f32_16x16x64_bf16 v[24:27], v[64:67], v[88:95], v68
    s_nop 1
    v_cvt_pk_bf16_f32 v112, v112, v113
    v_cvt_pk_bf16_f32 v113, v114, v115
    ds_write_b64 v70, v[112:113] offset:256
    v_mfma_f32_16x16x32_bf16 v[112:115], v[72:75], v[176:179], 0
    v_mfma_f32_16x16x32_bf16 v[112:115], v[76:79], v[180:183], v[112:115]
    v_lshlrev_b32_sdwa v88, 3, v122 dst_sel:DWORD dst_unused:UNUSED_PAD src0_sel:DWORD src1_sel:WORD_0
    v_lshlrev_b32_sdwa v90, 3, v122 dst_sel:DWORD dst_unused:UNUSED_PAD src0_sel:DWORD src1_sel:WORD_1
    ds_read_b64 v[88:89], v88
    ds_read_b64 v[90:91], v90
    v_mfma_f32_16x16x32_bf16 v[112:115], v[80:83], v[184:187], v[112:115]
    v_mfma_f32_16x16x32_bf16 v[112:115], v[84:87], v[188:191], v[112:115]
    v_lshlrev_b32_sdwa v92, 3, v123 dst_sel:DWORD dst_unused:UNUSED_PAD src0_sel:DWORD src1_sel:WORD_0
    v_lshlrev_b32_sdwa v94, 3, v123 dst_sel:DWORD dst_unused:UNUSED_PAD src0_sel:DWORD src1_sel:WORD_1
    ds_read_b64 v[92:93], v92
    ds_read_b64 v[94:95], v94
    s_waitcnt lgkmcnt(9)
    v_smfmac_f32_16x16x64_bf16 v[28:31], v[64:67], v[96:103], v68
    buffer_load_dwordx4 v[120:123], v69, s[12:15], s20 offen offset:3072 sc1
    s_add_u32 s20, s20, 61440
    v_cvt_pk_bf16_f32 v112, v112, v113
    v_cvt_pk_bf16_f32 v113, v114, v115
    ds_write_b64 v70, v[112:113] offset:384
    v_mfma_f32_16x16x32_bf16 v[112:115], v[72:75], v[192:195], 0
    s_waitcnt vmcnt(2)
    v_lshlrev_b32_sdwa v96, 3, v124 dst_sel:DWORD dst_unused:UNUSED_PAD src0_sel:DWORD src1_sel:WORD_0
    v_lshlrev_b32_sdwa v98, 3, v124 dst_sel:DWORD dst_unused:UNUSED_PAD src0_sel:DWORD src1_sel:WORD_1
    ds_read_b64 v[96:97], v96
    ds_read_b64 v[98:99], v98
    v_mfma_f32_16x16x32_bf16 v[112:115], v[76:79], v[196:199], v[112:115]
    v_lshlrev_b32_sdwa v100, 3, v125 dst_sel:DWORD dst_unused:UNUSED_PAD src0_sel:DWORD src1_sel:WORD_0
    v_lshlrev_b32_sdwa v102, 3, v125 dst_sel:DWORD dst_unused:UNUSED_PAD src0_sel:DWORD src1_sel:WORD_1
    ds_read_b64 v[100:101], v100
    ds_read_b64 v[102:103], v102
    s_waitcnt lgkmcnt(10)
    v_smfmac_f32_16x16x64_bf16 v[32:35], v[64:67], v[104:111], v68
    s_setprio 3
    v_lshlrev_b32_sdwa v104, 3, v126 dst_sel:DWORD dst_unused:UNUSED_PAD src0_sel:DWORD src1_sel:WORD_0
    v_lshlrev_b32_sdwa v106, 3, v126 dst_sel:DWORD dst_unused:UNUSED_PAD src0_sel:DWORD src1_sel:WORD_1
    v_mfma_f32_16x16x32_bf16 v[112:115], v[80:83], v[200:203], v[112:115]
    ds_read_b64 v[104:105], v104
    ds_read_b64 v[106:107], v106
    v_mfma_f32_16x16x32_bf16 v[112:115], v[84:87], v[204:207], v[112:115]
    v_lshlrev_b32_sdwa v108, 3, v127 dst_sel:DWORD dst_unused:UNUSED_PAD src0_sel:DWORD src1_sel:WORD_0
    v_lshlrev_b32_sdwa v110, 3, v127 dst_sel:DWORD dst_unused:UNUSED_PAD src0_sel:DWORD src1_sel:WORD_1
    buffer_load_dwordx4 v[124:127], v69, s[12:15], s20 offen offset:0 sc1
    ds_read_b64 v[108:109], v108
    ds_read_b64 v[110:111], v110
    s_waitcnt lgkmcnt(9)
    v_smfmac_f32_16x16x64_bf16 v[36:39], v[64:67], v[88:95], v68
    s_nop 0
    v_cvt_pk_bf16_f32 v112, v112, v113
    v_cvt_pk_bf16_f32 v113, v114, v115
    ds_write_b64 v70, v[112:113] offset:512
    v_mfma_f32_16x16x32_bf16 v[112:115], v[72:75], v[208:211], 0
    v_mfma_f32_16x16x32_bf16 v[112:115], v[76:79], v[212:215], v[112:115]
    s_waitcnt vmcnt(2)
    v_lshlrev_b32_sdwa v88, 3, v116 dst_sel:DWORD dst_unused:UNUSED_PAD src0_sel:DWORD src1_sel:WORD_0
    v_lshlrev_b32_sdwa v90, 3, v116 dst_sel:DWORD dst_unused:UNUSED_PAD src0_sel:DWORD src1_sel:WORD_1
    ds_read_b64 v[88:89], v88
    ds_read_b64 v[90:91], v90
    v_mfma_f32_16x16x32_bf16 v[112:115], v[80:83], v[216:219], v[112:115]
    v_mfma_f32_16x16x32_bf16 v[112:115], v[84:87], v[220:223], v[112:115]
    v_lshlrev_b32_sdwa v92, 3, v117 dst_sel:DWORD dst_unused:UNUSED_PAD src0_sel:DWORD src1_sel:WORD_0
    v_lshlrev_b32_sdwa v94, 3, v117 dst_sel:DWORD dst_unused:UNUSED_PAD src0_sel:DWORD src1_sel:WORD_1
    ds_read_b64 v[92:93], v92
    ds_read_b64 v[94:95], v94
    s_waitcnt lgkmcnt(9)
    v_smfmac_f32_16x16x64_bf16 v[40:43], v[64:67], v[96:103], v68
    s_nop 1
    v_cvt_pk_bf16_f32 v112, v112, v113
    v_cvt_pk_bf16_f32 v113, v114, v115
    ds_write_b64 v70, v[112:113] offset:640
    v_mfma_f32_16x16x32_bf16 v[112:115], v[72:75], v[224:227], 0
    v_lshlrev_b32_sdwa v96, 3, v118 dst_sel:DWORD dst_unused:UNUSED_PAD src0_sel:DWORD src1_sel:WORD_0
    v_lshlrev_b32_sdwa v98, 3, v118 dst_sel:DWORD dst_unused:UNUSED_PAD src0_sel:DWORD src1_sel:WORD_1
    ds_read_b64 v[96:97], v96
    ds_read_b64 v[98:99], v98
    v_mfma_f32_16x16x32_bf16 v[112:115], v[76:79], v[228:231], v[112:115]
    v_lshlrev_b32_sdwa v100, 3, v119 dst_sel:DWORD dst_unused:UNUSED_PAD src0_sel:DWORD src1_sel:WORD_0
    v_lshlrev_b32_sdwa v102, 3, v119 dst_sel:DWORD dst_unused:UNUSED_PAD src0_sel:DWORD src1_sel:WORD_1
    ds_read_b64 v[100:101], v100
    ds_read_b64 v[102:103], v102
    s_waitcnt lgkmcnt(10)
    v_smfmac_f32_16x16x64_bf16 v[44:47], v[64:67], v[104:111], v68
    buffer_load_dwordx4 v[116:119], v69, s[12:15], s20 offen offset:1024 sc1
    s_setprio 1
    s_waitcnt vmcnt(2)
    v_lshlrev_b32_sdwa v104, 3, v120 dst_sel:DWORD dst_unused:UNUSED_PAD src0_sel:DWORD src1_sel:WORD_0
    v_lshlrev_b32_sdwa v106, 3, v120 dst_sel:DWORD dst_unused:UNUSED_PAD src0_sel:DWORD src1_sel:WORD_1
    v_mfma_f32_16x16x32_bf16 v[112:115], v[80:83], v[232:235], v[112:115]
    ds_read_b64 v[104:105], v104
    ds_read_b64 v[106:107], v106
    v_lshlrev_b32_sdwa v108, 3, v121 dst_sel:DWORD dst_unused:UNUSED_PAD src0_sel:DWORD src1_sel:WORD_0
    v_lshlrev_b32_sdwa v110, 3, v121 dst_sel:DWORD dst_unused:UNUSED_PAD src0_sel:DWORD src1_sel:WORD_1
    v_mfma_f32_16x16x32_bf16 v[112:115], v[84:87], v[236:239], v[112:115]
    ds_read_b64 v[108:109], v108
    ds_read_b64 v[110:111], v110
    s_waitcnt lgkmcnt(9)
    v_smfmac_f32_16x16x64_bf16 v[48:51], v[64:67], v[88:95], v68
    v_lshlrev_b32_sdwa v88, 3, v122 dst_sel:DWORD dst_unused:UNUSED_PAD src0_sel:DWORD src1_sel:WORD_0
    v_lshlrev_b32_sdwa v90, 3, v122 dst_sel:DWORD dst_unused:UNUSED_PAD src0_sel:DWORD src1_sel:WORD_1
    s_nop 1
    v_cvt_pk_bf16_f32 v112, v112, v113
    v_cvt_pk_bf16_f32 v113, v114, v115
    ds_write_b64 v70, v[112:113] offset:768
    v_mfma_f32_16x16x32_bf16 v[112:115], v[72:75], v[240:243], 0
    buffer_load_dwordx4 v[72:75], v69, s[12:15], s21 offen offset:0
    ds_read_b64 v[88:89], v88
    ds_read_b64 v[90:91], v90
    v_lshlrev_b32_sdwa v92, 3, v123 dst_sel:DWORD dst_unused:UNUSED_PAD src0_sel:DWORD src1_sel:WORD_0
    v_lshlrev_b32_sdwa v94, 3, v123 dst_sel:DWORD dst_unused:UNUSED_PAD src0_sel:DWORD src1_sel:WORD_1
    buffer_load_dwordx4 v[120:123], v69, s[12:15], s20 offen offset:2048 sc1
    ds_read_b64 v[92:93], v92
    ds_read_b64 v[94:95], v94
    v_mfma_f32_16x16x32_bf16 v[112:115], v[76:79], v[244:247], v[112:115]
    buffer_load_dwordx4 v[76:79], v69, s[12:15], s21 offen offset:1024
    s_waitcnt lgkmcnt(9)
    v_smfmac_f32_16x16x64_bf16 v[52:55], v[64:67], v[96:103], v68
    s_waitcnt vmcnt(4)
    v_lshlrev_b32_sdwa v96, 3, v124 dst_sel:DWORD dst_unused:UNUSED_PAD src0_sel:DWORD src1_sel:WORD_0
    v_lshlrev_b32_sdwa v98, 3, v124 dst_sel:DWORD dst_unused:UNUSED_PAD src0_sel:DWORD src1_sel:WORD_1
    ds_read_b64 v[96:97], v96
    ds_read_b64 v[98:99], v98
    v_mfma_f32_16x16x32_bf16 v[112:115], v[80:83], v[248:251], v[112:115]
    buffer_load_dwordx4 v[80:83], v69, s[12:15], s19 offen offset:0
    v_lshlrev_b32_sdwa v100, 3, v125 dst_sel:DWORD dst_unused:UNUSED_PAD src0_sel:DWORD src1_sel:WORD_0
    v_lshlrev_b32_sdwa v102, 3, v125 dst_sel:DWORD dst_unused:UNUSED_PAD src0_sel:DWORD src1_sel:WORD_1
    v_mfma_f32_16x16x32_bf16 v[112:115], v[84:87], v[252:255], v[112:115]
    buffer_load_dwordx4 v[84:87], v69, s[12:15], s19 offen offset:1024
    s_add_u32 s21, s21, 4096
    s_add_u32 s19, s19, 4096
    ds_read_b64 v[100:101], v100
    ds_read_b64 v[102:103], v102
    s_waitcnt lgkmcnt(9)
    v_smfmac_f32_16x16x64_bf16 v[56:59], v[64:67], v[104:111], v68
    s_setprio 0
    v_cvt_pk_bf16_f32 v112, v112, v113
    v_cvt_pk_bf16_f32 v113, v114, v115
    ds_write_b64 v70, v[112:113] offset:896
    ds_append v71 offset:8080
    s_add_u32 s23, s23, s23
    s_cselect_b32 s35, 4294836224, s32
    v_add_u32 v70, s35, v70
    v_lshlrev_b32_sdwa v104, 3, v126 dst_sel:DWORD dst_unused:UNUSED_PAD src0_sel:DWORD src1_sel:WORD_0
    v_lshlrev_b32_sdwa v106, 3, v126 dst_sel:DWORD dst_unused:UNUSED_PAD src0_sel:DWORD src1_sel:WORD_1
    ds_read_b64 v[104:105], v104
    ds_read_b64 v[106:107], v106
    v_lshlrev_b32_sdwa v108, 3, v127 dst_sel:DWORD dst_unused:UNUSED_PAD src0_sel:DWORD src1_sel:WORD_0
    v_lshlrev_b32_sdwa v110, 3, v127 dst_sel:DWORD dst_unused:UNUSED_PAD src0_sel:DWORD src1_sel:WORD_1
    buffer_load_dwordx4 v[124:127], v69, s[12:15], s20 offen offset:3072 sc1
    s_add_u32 s20, s20, 4096
    ds_read_b64 v[108:109], v108
    ds_read_b64 v[110:111], v110
    s_waitcnt lgkmcnt(10)
    v_smfmac_f32_16x16x64_bf16 v[60:63], v[64:67], v[88:95], v68

    s_cmpk_eq_u32 s37, 11264
    s_cbranch_scc1 standalone__deep_cross_pnn__recsys_kernel_fin

    s_waitcnt vmcnt(6)
    v_lshlrev_b32_sdwa v88, 3, v116 dst_sel:DWORD dst_unused:UNUSED_PAD src0_sel:DWORD src1_sel:WORD_0
    v_lshlrev_b32_sdwa v90, 3, v116 dst_sel:DWORD dst_unused:UNUSED_PAD src0_sel:DWORD src1_sel:WORD_1
    ds_read_b64 v[88:89], v88
    ds_read_b64 v[90:91], v90
    v_lshlrev_b32_sdwa v92, 3, v117 dst_sel:DWORD dst_unused:UNUSED_PAD src0_sel:DWORD src1_sel:WORD_0
    v_lshlrev_b32_sdwa v94, 3, v117 dst_sel:DWORD dst_unused:UNUSED_PAD src0_sel:DWORD src1_sel:WORD_1
    ds_read_b64 v[92:93], v92
    ds_read_b64 v[94:95], v94
    s_waitcnt lgkmcnt(10)
    v_smfmac_f32_16x16x64_bf16 v[0:3], v[64:67], v[96:103], v68
    v_lshlrev_b32_sdwa v96, 3, v118 dst_sel:DWORD dst_unused:UNUSED_PAD src0_sel:DWORD src1_sel:WORD_0
    v_lshlrev_b32_sdwa v98, 3, v118 dst_sel:DWORD dst_unused:UNUSED_PAD src0_sel:DWORD src1_sel:WORD_1
    ds_read_b64 v[96:97], v96
    ds_read_b64 v[98:99], v98
    v_lshlrev_b32_sdwa v100, 3, v119 dst_sel:DWORD dst_unused:UNUSED_PAD src0_sel:DWORD src1_sel:WORD_0
    v_lshlrev_b32_sdwa v102, 3, v119 dst_sel:DWORD dst_unused:UNUSED_PAD src0_sel:DWORD src1_sel:WORD_1
    ds_read_b64 v[100:101], v100
    ds_read_addtid_b32 v71 offset:8080
    ds_read_b64 v[102:103], v102
    s_waitcnt lgkmcnt(9)
    v_smfmac_f32_16x16x64_bf16 v[4:7], v[64:67], v[104:111], v68
    buffer_load_dwordx4 v[116:119], v69, s[12:15], s20 offen offset:0 sc1
    s_waitcnt vmcnt(6)
    v_mfma_f32_16x16x32_bf16 v[112:115], v[72:75], v[128:131], 0
    s_waitcnt vmcnt(5)
    v_lshlrev_b32_sdwa v104, 3, v120 dst_sel:DWORD dst_unused:UNUSED_PAD src0_sel:DWORD src1_sel:WORD_0
    v_lshlrev_b32_sdwa v106, 3, v120 dst_sel:DWORD dst_unused:UNUSED_PAD src0_sel:DWORD src1_sel:WORD_1
    ds_read_b64 v[104:105], v104
    ds_read_b64 v[106:107], v106
    s_waitcnt vmcnt(4)
    v_mfma_f32_16x16x32_bf16 v[112:115], v[76:79], v[132:135], v[112:115]
    v_lshlrev_b32_sdwa v108, 3, v121 dst_sel:DWORD dst_unused:UNUSED_PAD src0_sel:DWORD src1_sel:WORD_0
    v_lshlrev_b32_sdwa v110, 3, v121 dst_sel:DWORD dst_unused:UNUSED_PAD src0_sel:DWORD src1_sel:WORD_1
    ds_read_b64 v[108:109], v108
    ds_read_b64 v[110:111], v110
    s_waitcnt lgkmcnt(9)
    v_smfmac_f32_16x16x64_bf16 v[8:11], v[64:67], v[88:95], v68
    s_waitcnt vmcnt(3)
    v_mfma_f32_16x16x32_bf16 v[112:115], v[80:83], v[136:139], v[112:115]
    v_lshlrev_b32_sdwa v88, 3, v122 dst_sel:DWORD dst_unused:UNUSED_PAD src0_sel:DWORD src1_sel:WORD_0
    v_lshlrev_b32_sdwa v90, 3, v122 dst_sel:DWORD dst_unused:UNUSED_PAD src0_sel:DWORD src1_sel:WORD_1
    ds_read_b64 v[88:89], v88
    ds_read_b64 v[90:91], v90
    s_waitcnt vmcnt(2)
    v_mfma_f32_16x16x32_bf16 v[112:115], v[84:87], v[140:143], v[112:115]
    v_lshlrev_b32_sdwa v92, 3, v123 dst_sel:DWORD dst_unused:UNUSED_PAD src0_sel:DWORD src1_sel:WORD_0
    v_lshlrev_b32_sdwa v94, 3, v123 dst_sel:DWORD dst_unused:UNUSED_PAD src0_sel:DWORD src1_sel:WORD_1
    ds_read_b64 v[92:93], v92
    ds_read_b64 v[94:95], v94
    s_waitcnt lgkmcnt(8)
    v_smfmac_f32_16x16x64_bf16 v[12:15], v[64:67], v[96:103], v68
    buffer_load_dwordx4 v[120:123], v69, s[12:15], s20 offen offset:1024 sc1
    v_readfirstlane_b32 s36, v71
    v_cvt_pk_bf16_f32 v112, v112, v113
    v_cvt_pk_bf16_f32 v113, v114, v115
    s_cmp_lt_u32 s36, s37
    s_cbranch_scc1 standalone__deep_cross_pnn__recsys_kernel_sp1
standalone__deep_cross_pnn__recsys_kernel_sr1:
    s_add_u32 s37, s37, 512
    ds_write_b64 v70, v[112:113] offset:0
    v_mfma_f32_16x16x32_bf16 v[112:115], v[72:75], v[144:147], 0
    v_mfma_f32_16x16x32_bf16 v[112:115], v[76:79], v[148:151], v[112:115]
    s_waitcnt vmcnt(2)
    v_lshlrev_b32_sdwa v96, 3, v124 dst_sel:DWORD dst_unused:UNUSED_PAD src0_sel:DWORD src1_sel:WORD_0
    v_lshlrev_b32_sdwa v98, 3, v124 dst_sel:DWORD dst_unused:UNUSED_PAD src0_sel:DWORD src1_sel:WORD_1
    ds_read_b64 v[96:97], v96
    ds_read_b64 v[98:99], v98
    v_mfma_f32_16x16x32_bf16 v[112:115], v[80:83], v[152:155], v[112:115]
    v_mfma_f32_16x16x32_bf16 v[112:115], v[84:87], v[156:159], v[112:115]
    v_lshlrev_b32_sdwa v100, 3, v125 dst_sel:DWORD dst_unused:UNUSED_PAD src0_sel:DWORD src1_sel:WORD_0
    v_lshlrev_b32_sdwa v102, 3, v125 dst_sel:DWORD dst_unused:UNUSED_PAD src0_sel:DWORD src1_sel:WORD_1
    ds_read_b64 v[100:101], v100
    ds_read_b64 v[102:103], v102
    s_waitcnt lgkmcnt(9)
    v_smfmac_f32_16x16x64_bf16 v[16:19], v[64:67], v[104:111], v68
    s_nop 1
    v_cvt_pk_bf16_f32 v112, v112, v113
    v_cvt_pk_bf16_f32 v113, v114, v115
    ds_write_b64 v70, v[112:113] offset:128
    v_mfma_f32_16x16x32_bf16 v[112:115], v[72:75], v[160:163], 0
    v_lshlrev_b32_sdwa v104, 3, v126 dst_sel:DWORD dst_unused:UNUSED_PAD src0_sel:DWORD src1_sel:WORD_0
    v_lshlrev_b32_sdwa v106, 3, v126 dst_sel:DWORD dst_unused:UNUSED_PAD src0_sel:DWORD src1_sel:WORD_1
    ds_read_b64 v[104:105], v104
    ds_read_b64 v[106:107], v106
    v_mfma_f32_16x16x32_bf16 v[112:115], v[76:79], v[164:167], v[112:115]
    v_lshlrev_b32_sdwa v108, 3, v127 dst_sel:DWORD dst_unused:UNUSED_PAD src0_sel:DWORD src1_sel:WORD_0
    v_lshlrev_b32_sdwa v110, 3, v127 dst_sel:DWORD dst_unused:UNUSED_PAD src0_sel:DWORD src1_sel:WORD_1
    ds_read_b64 v[108:109], v108
    ds_read_b64 v[110:111], v110
    s_waitcnt lgkmcnt(10)
    v_smfmac_f32_16x16x64_bf16 v[20:23], v[64:67], v[88:95], v68
    buffer_load_dwordx4 v[124:127], v69, s[12:15], s20 offen offset:2048 sc1
    s_setprio 2
    v_mfma_f32_16x16x32_bf16 v[112:115], v[80:83], v[168:171], v[112:115]
    s_waitcnt vmcnt(2)
    v_lshlrev_b32_sdwa v88, 3, v116 dst_sel:DWORD dst_unused:UNUSED_PAD src0_sel:DWORD src1_sel:WORD_0
    v_lshlrev_b32_sdwa v90, 3, v116 dst_sel:DWORD dst_unused:UNUSED_PAD src0_sel:DWORD src1_sel:WORD_1
    ds_read_b64 v[88:89], v88
    ds_read_b64 v[90:91], v90
    v_mfma_f32_16x16x32_bf16 v[112:115], v[84:87], v[172:175], v[112:115]
    v_lshlrev_b32_sdwa v92, 3, v117 dst_sel:DWORD dst_unused:UNUSED_PAD src0_sel:DWORD src1_sel:WORD_0
    v_lshlrev_b32_sdwa v94, 3, v117 dst_sel:DWORD dst_unused:UNUSED_PAD src0_sel:DWORD src1_sel:WORD_1
    ds_read_b64 v[92:93], v92
    ds_read_b64 v[94:95], v94
    s_waitcnt lgkmcnt(9)
    v_smfmac_f32_16x16x64_bf16 v[24:27], v[64:67], v[96:103], v68
    s_nop 1
    v_cvt_pk_bf16_f32 v112, v112, v113
    v_cvt_pk_bf16_f32 v113, v114, v115
    ds_write_b64 v70, v[112:113] offset:256
    v_mfma_f32_16x16x32_bf16 v[112:115], v[72:75], v[176:179], 0
    v_mfma_f32_16x16x32_bf16 v[112:115], v[76:79], v[180:183], v[112:115]
    v_lshlrev_b32_sdwa v96, 3, v118 dst_sel:DWORD dst_unused:UNUSED_PAD src0_sel:DWORD src1_sel:WORD_0
    v_lshlrev_b32_sdwa v98, 3, v118 dst_sel:DWORD dst_unused:UNUSED_PAD src0_sel:DWORD src1_sel:WORD_1
    ds_read_b64 v[96:97], v96
    ds_read_b64 v[98:99], v98
    v_mfma_f32_16x16x32_bf16 v[112:115], v[80:83], v[184:187], v[112:115]
    v_mfma_f32_16x16x32_bf16 v[112:115], v[84:87], v[188:191], v[112:115]
    v_lshlrev_b32_sdwa v100, 3, v119 dst_sel:DWORD dst_unused:UNUSED_PAD src0_sel:DWORD src1_sel:WORD_0
    v_lshlrev_b32_sdwa v102, 3, v119 dst_sel:DWORD dst_unused:UNUSED_PAD src0_sel:DWORD src1_sel:WORD_1
    ds_read_b64 v[100:101], v100
    ds_read_b64 v[102:103], v102
    s_waitcnt lgkmcnt(9)
    v_smfmac_f32_16x16x64_bf16 v[28:31], v[64:67], v[104:111], v68
    buffer_load_dwordx4 v[116:119], v69, s[12:15], s20 offen offset:3072 sc1
    s_add_u32 s20, s20, 61440
    v_cvt_pk_bf16_f32 v112, v112, v113
    v_cvt_pk_bf16_f32 v113, v114, v115
    ds_write_b64 v70, v[112:113] offset:384
    v_mfma_f32_16x16x32_bf16 v[112:115], v[72:75], v[192:195], 0
    s_waitcnt vmcnt(2)
    v_lshlrev_b32_sdwa v104, 3, v120 dst_sel:DWORD dst_unused:UNUSED_PAD src0_sel:DWORD src1_sel:WORD_0
    v_lshlrev_b32_sdwa v106, 3, v120 dst_sel:DWORD dst_unused:UNUSED_PAD src0_sel:DWORD src1_sel:WORD_1
    ds_read_b64 v[104:105], v104
    ds_read_b64 v[106:107], v106
    v_mfma_f32_16x16x32_bf16 v[112:115], v[76:79], v[196:199], v[112:115]
    v_lshlrev_b32_sdwa v108, 3, v121 dst_sel:DWORD dst_unused:UNUSED_PAD src0_sel:DWORD src1_sel:WORD_0
    v_lshlrev_b32_sdwa v110, 3, v121 dst_sel:DWORD dst_unused:UNUSED_PAD src0_sel:DWORD src1_sel:WORD_1
    ds_read_b64 v[108:109], v108
    ds_read_b64 v[110:111], v110
    s_waitcnt lgkmcnt(10)
    v_smfmac_f32_16x16x64_bf16 v[32:35], v[64:67], v[88:95], v68
    s_setprio 3
    v_lshlrev_b32_sdwa v88, 3, v122 dst_sel:DWORD dst_unused:UNUSED_PAD src0_sel:DWORD src1_sel:WORD_0
    v_lshlrev_b32_sdwa v90, 3, v122 dst_sel:DWORD dst_unused:UNUSED_PAD src0_sel:DWORD src1_sel:WORD_1
    v_mfma_f32_16x16x32_bf16 v[112:115], v[80:83], v[200:203], v[112:115]
    ds_read_b64 v[88:89], v88
    ds_read_b64 v[90:91], v90
    v_mfma_f32_16x16x32_bf16 v[112:115], v[84:87], v[204:207], v[112:115]
    v_lshlrev_b32_sdwa v92, 3, v123 dst_sel:DWORD dst_unused:UNUSED_PAD src0_sel:DWORD src1_sel:WORD_0
    v_lshlrev_b32_sdwa v94, 3, v123 dst_sel:DWORD dst_unused:UNUSED_PAD src0_sel:DWORD src1_sel:WORD_1
    buffer_load_dwordx4 v[120:123], v69, s[12:15], s20 offen offset:0 sc1
    ds_read_b64 v[92:93], v92
    ds_read_b64 v[94:95], v94
    s_waitcnt lgkmcnt(9)
    v_smfmac_f32_16x16x64_bf16 v[36:39], v[64:67], v[96:103], v68
    s_nop 0
    v_cvt_pk_bf16_f32 v112, v112, v113
    v_cvt_pk_bf16_f32 v113, v114, v115
    ds_write_b64 v70, v[112:113] offset:512
    v_mfma_f32_16x16x32_bf16 v[112:115], v[72:75], v[208:211], 0
    v_mfma_f32_16x16x32_bf16 v[112:115], v[76:79], v[212:215], v[112:115]
    s_waitcnt vmcnt(2)
    v_lshlrev_b32_sdwa v96, 3, v124 dst_sel:DWORD dst_unused:UNUSED_PAD src0_sel:DWORD src1_sel:WORD_0
    v_lshlrev_b32_sdwa v98, 3, v124 dst_sel:DWORD dst_unused:UNUSED_PAD src0_sel:DWORD src1_sel:WORD_1
    ds_read_b64 v[96:97], v96
    ds_read_b64 v[98:99], v98
    v_mfma_f32_16x16x32_bf16 v[112:115], v[80:83], v[216:219], v[112:115]
    v_mfma_f32_16x16x32_bf16 v[112:115], v[84:87], v[220:223], v[112:115]
    v_lshlrev_b32_sdwa v100, 3, v125 dst_sel:DWORD dst_unused:UNUSED_PAD src0_sel:DWORD src1_sel:WORD_0
    v_lshlrev_b32_sdwa v102, 3, v125 dst_sel:DWORD dst_unused:UNUSED_PAD src0_sel:DWORD src1_sel:WORD_1
    ds_read_b64 v[100:101], v100
    ds_read_b64 v[102:103], v102
    s_waitcnt lgkmcnt(9)
    v_smfmac_f32_16x16x64_bf16 v[40:43], v[64:67], v[104:111], v68
    s_nop 1
    v_cvt_pk_bf16_f32 v112, v112, v113
    v_cvt_pk_bf16_f32 v113, v114, v115
    ds_write_b64 v70, v[112:113] offset:640
    v_mfma_f32_16x16x32_bf16 v[112:115], v[72:75], v[224:227], 0
    v_lshlrev_b32_sdwa v104, 3, v126 dst_sel:DWORD dst_unused:UNUSED_PAD src0_sel:DWORD src1_sel:WORD_0
    v_lshlrev_b32_sdwa v106, 3, v126 dst_sel:DWORD dst_unused:UNUSED_PAD src0_sel:DWORD src1_sel:WORD_1
    ds_read_b64 v[104:105], v104
    ds_read_b64 v[106:107], v106
    v_mfma_f32_16x16x32_bf16 v[112:115], v[76:79], v[228:231], v[112:115]
    v_lshlrev_b32_sdwa v108, 3, v127 dst_sel:DWORD dst_unused:UNUSED_PAD src0_sel:DWORD src1_sel:WORD_0
    v_lshlrev_b32_sdwa v110, 3, v127 dst_sel:DWORD dst_unused:UNUSED_PAD src0_sel:DWORD src1_sel:WORD_1
    ds_read_b64 v[108:109], v108
    ds_read_b64 v[110:111], v110
    s_waitcnt lgkmcnt(10)
    v_smfmac_f32_16x16x64_bf16 v[44:47], v[64:67], v[88:95], v68
    buffer_load_dwordx4 v[124:127], v69, s[12:15], s20 offen offset:1024 sc1
    s_setprio 1
    s_waitcnt vmcnt(2)
    v_lshlrev_b32_sdwa v88, 3, v116 dst_sel:DWORD dst_unused:UNUSED_PAD src0_sel:DWORD src1_sel:WORD_0
    v_lshlrev_b32_sdwa v90, 3, v116 dst_sel:DWORD dst_unused:UNUSED_PAD src0_sel:DWORD src1_sel:WORD_1
    v_mfma_f32_16x16x32_bf16 v[112:115], v[80:83], v[232:235], v[112:115]
    ds_read_b64 v[88:89], v88
    ds_read_b64 v[90:91], v90
    v_lshlrev_b32_sdwa v92, 3, v117 dst_sel:DWORD dst_unused:UNUSED_PAD src0_sel:DWORD src1_sel:WORD_0
    v_lshlrev_b32_sdwa v94, 3, v117 dst_sel:DWORD dst_unused:UNUSED_PAD src0_sel:DWORD src1_sel:WORD_1
    v_mfma_f32_16x16x32_bf16 v[112:115], v[84:87], v[236:239], v[112:115]
    ds_read_b64 v[92:93], v92
    ds_read_b64 v[94:95], v94
    s_waitcnt lgkmcnt(9)
    v_smfmac_f32_16x16x64_bf16 v[48:51], v[64:67], v[96:103], v68
    v_lshlrev_b32_sdwa v96, 3, v118 dst_sel:DWORD dst_unused:UNUSED_PAD src0_sel:DWORD src1_sel:WORD_0
    v_lshlrev_b32_sdwa v98, 3, v118 dst_sel:DWORD dst_unused:UNUSED_PAD src0_sel:DWORD src1_sel:WORD_1
    s_nop 1
    v_cvt_pk_bf16_f32 v112, v112, v113
    v_cvt_pk_bf16_f32 v113, v114, v115
    ds_write_b64 v70, v[112:113] offset:768
    v_mfma_f32_16x16x32_bf16 v[112:115], v[72:75], v[240:243], 0
    buffer_load_dwordx4 v[72:75], v69, s[12:15], s21 offen offset:0
    ds_read_b64 v[96:97], v96
    ds_read_b64 v[98:99], v98
    v_lshlrev_b32_sdwa v100, 3, v119 dst_sel:DWORD dst_unused:UNUSED_PAD src0_sel:DWORD src1_sel:WORD_0
    v_lshlrev_b32_sdwa v102, 3, v119 dst_sel:DWORD dst_unused:UNUSED_PAD src0_sel:DWORD src1_sel:WORD_1
    buffer_load_dwordx4 v[116:119], v69, s[12:15], s20 offen offset:2048 sc1
    ds_read_b64 v[100:101], v100
    ds_read_b64 v[102:103], v102
    v_mfma_f32_16x16x32_bf16 v[112:115], v[76:79], v[244:247], v[112:115]
    buffer_load_dwordx4 v[76:79], v69, s[12:15], s21 offen offset:1024
    s_waitcnt lgkmcnt(9)
    v_smfmac_f32_16x16x64_bf16 v[52:55], v[64:67], v[104:111], v68
    s_waitcnt vmcnt(4)
    v_lshlrev_b32_sdwa v104, 3, v120 dst_sel:DWORD dst_unused:UNUSED_PAD src0_sel:DWORD src1_sel:WORD_0
    v_lshlrev_b32_sdwa v106, 3, v120 dst_sel:DWORD dst_unused:UNUSED_PAD src0_sel:DWORD src1_sel:WORD_1
    ds_read_b64 v[104:105], v104
    ds_read_b64 v[106:107], v106
    v_mfma_f32_16x16x32_bf16 v[112:115], v[80:83], v[248:251], v[112:115]
    buffer_load_dwordx4 v[80:83], v69, s[12:15], s19 offen offset:0
    v_lshlrev_b32_sdwa v108, 3, v121 dst_sel:DWORD dst_unused:UNUSED_PAD src0_sel:DWORD src1_sel:WORD_0
    v_lshlrev_b32_sdwa v110, 3, v121 dst_sel:DWORD dst_unused:UNUSED_PAD src0_sel:DWORD src1_sel:WORD_1
    v_mfma_f32_16x16x32_bf16 v[112:115], v[84:87], v[252:255], v[112:115]
    buffer_load_dwordx4 v[84:87], v69, s[12:15], s19 offen offset:1024
    s_add_u32 s21, s21, 4096
    s_add_u32 s19, s19, 4096
    ds_read_b64 v[108:109], v108
    ds_read_b64 v[110:111], v110
    s_waitcnt lgkmcnt(9)
    v_smfmac_f32_16x16x64_bf16 v[56:59], v[64:67], v[88:95], v68
    s_setprio 0
    v_cvt_pk_bf16_f32 v112, v112, v113
    v_cvt_pk_bf16_f32 v113, v114, v115
    ds_write_b64 v70, v[112:113] offset:896
    ds_append v71 offset:8080
    s_add_u32 s23, s23, s23
    s_cselect_b32 s35, 4294836224, s32
    v_add_u32 v70, s35, v70
    v_lshlrev_b32_sdwa v88, 3, v122 dst_sel:DWORD dst_unused:UNUSED_PAD src0_sel:DWORD src1_sel:WORD_0
    v_lshlrev_b32_sdwa v90, 3, v122 dst_sel:DWORD dst_unused:UNUSED_PAD src0_sel:DWORD src1_sel:WORD_1
    ds_read_b64 v[88:89], v88
    ds_read_b64 v[90:91], v90
    v_lshlrev_b32_sdwa v92, 3, v123 dst_sel:DWORD dst_unused:UNUSED_PAD src0_sel:DWORD src1_sel:WORD_0
    v_lshlrev_b32_sdwa v94, 3, v123 dst_sel:DWORD dst_unused:UNUSED_PAD src0_sel:DWORD src1_sel:WORD_1
    buffer_load_dwordx4 v[120:123], v69, s[12:15], s20 offen offset:3072 sc1
    s_add_u32 s20, s20, 4096
    ds_read_b64 v[92:93], v92
    ds_read_b64 v[94:95], v94
    s_waitcnt lgkmcnt(10)
    v_smfmac_f32_16x16x64_bf16 v[60:63], v[64:67], v[96:103], v68
    s_waitcnt vmcnt(6)
    v_lshlrev_b32_sdwa v96, 3, v124 dst_sel:DWORD dst_unused:UNUSED_PAD src0_sel:DWORD src1_sel:WORD_0
    v_lshlrev_b32_sdwa v98, 3, v124 dst_sel:DWORD dst_unused:UNUSED_PAD src0_sel:DWORD src1_sel:WORD_1
    ds_read_b64 v[96:97], v96
    ds_read_b64 v[98:99], v98
    v_lshlrev_b32_sdwa v100, 3, v125 dst_sel:DWORD dst_unused:UNUSED_PAD src0_sel:DWORD src1_sel:WORD_0
    v_lshlrev_b32_sdwa v102, 3, v125 dst_sel:DWORD dst_unused:UNUSED_PAD src0_sel:DWORD src1_sel:WORD_1
    ds_read_b64 v[100:101], v100
    ds_read_b64 v[102:103], v102
    s_waitcnt lgkmcnt(10)
    v_smfmac_f32_16x16x64_bf16 v[0:3], v[64:67], v[104:111], v68
    v_lshlrev_b32_sdwa v104, 3, v126 dst_sel:DWORD dst_unused:UNUSED_PAD src0_sel:DWORD src1_sel:WORD_0
    v_lshlrev_b32_sdwa v106, 3, v126 dst_sel:DWORD dst_unused:UNUSED_PAD src0_sel:DWORD src1_sel:WORD_1
    ds_read_b64 v[104:105], v104
    ds_read_b64 v[106:107], v106
    v_lshlrev_b32_sdwa v108, 3, v127 dst_sel:DWORD dst_unused:UNUSED_PAD src0_sel:DWORD src1_sel:WORD_0
    v_lshlrev_b32_sdwa v110, 3, v127 dst_sel:DWORD dst_unused:UNUSED_PAD src0_sel:DWORD src1_sel:WORD_1
    ds_read_b64 v[108:109], v108
    ds_read_addtid_b32 v71 offset:8080
    ds_read_b64 v[110:111], v110
    s_waitcnt lgkmcnt(9)
    v_smfmac_f32_16x16x64_bf16 v[4:7], v[64:67], v[88:95], v68
    buffer_load_dwordx4 v[124:127], v69, s[12:15], s20 offen offset:0 sc1
    s_waitcnt vmcnt(6)
    v_mfma_f32_16x16x32_bf16 v[112:115], v[72:75], v[128:131], 0
    s_waitcnt vmcnt(5)
    v_lshlrev_b32_sdwa v88, 3, v116 dst_sel:DWORD dst_unused:UNUSED_PAD src0_sel:DWORD src1_sel:WORD_0
    v_lshlrev_b32_sdwa v90, 3, v116 dst_sel:DWORD dst_unused:UNUSED_PAD src0_sel:DWORD src1_sel:WORD_1
    ds_read_b64 v[88:89], v88
    ds_read_b64 v[90:91], v90
    s_waitcnt vmcnt(4)
    v_mfma_f32_16x16x32_bf16 v[112:115], v[76:79], v[132:135], v[112:115]
    v_lshlrev_b32_sdwa v92, 3, v117 dst_sel:DWORD dst_unused:UNUSED_PAD src0_sel:DWORD src1_sel:WORD_0
    v_lshlrev_b32_sdwa v94, 3, v117 dst_sel:DWORD dst_unused:UNUSED_PAD src0_sel:DWORD src1_sel:WORD_1
    ds_read_b64 v[92:93], v92
    ds_read_b64 v[94:95], v94
    s_waitcnt lgkmcnt(9)
    v_smfmac_f32_16x16x64_bf16 v[8:11], v[64:67], v[96:103], v68
    s_waitcnt vmcnt(3)
    v_mfma_f32_16x16x32_bf16 v[112:115], v[80:83], v[136:139], v[112:115]
    v_lshlrev_b32_sdwa v96, 3, v118 dst_sel:DWORD dst_unused:UNUSED_PAD src0_sel:DWORD src1_sel:WORD_0
    v_lshlrev_b32_sdwa v98, 3, v118 dst_sel:DWORD dst_unused:UNUSED_PAD src0_sel:DWORD src1_sel:WORD_1
    ds_read_b64 v[96:97], v96
    ds_read_b64 v[98:99], v98
    s_waitcnt vmcnt(2)
    v_mfma_f32_16x16x32_bf16 v[112:115], v[84:87], v[140:143], v[112:115]
    v_lshlrev_b32_sdwa v100, 3, v119 dst_sel:DWORD dst_unused:UNUSED_PAD src0_sel:DWORD src1_sel:WORD_0
    v_lshlrev_b32_sdwa v102, 3, v119 dst_sel:DWORD dst_unused:UNUSED_PAD src0_sel:DWORD src1_sel:WORD_1
    ds_read_b64 v[100:101], v100
    ds_read_b64 v[102:103], v102
    s_waitcnt lgkmcnt(8)
    v_smfmac_f32_16x16x64_bf16 v[12:15], v[64:67], v[104:111], v68
    buffer_load_dwordx4 v[116:119], v69, s[12:15], s20 offen offset:1024 sc1
    v_readfirstlane_b32 s36, v71
    v_cvt_pk_bf16_f32 v112, v112, v113
    v_cvt_pk_bf16_f32 v113, v114, v115
    s_cmp_lt_u32 s36, s37
    s_cbranch_scc1 standalone__deep_cross_pnn__recsys_kernel_sp2
standalone__deep_cross_pnn__recsys_kernel_sr2:
    s_add_u32 s37, s37, 512
    ds_write_b64 v70, v[112:113] offset:0
    v_mfma_f32_16x16x32_bf16 v[112:115], v[72:75], v[144:147], 0
    v_mfma_f32_16x16x32_bf16 v[112:115], v[76:79], v[148:151], v[112:115]
    s_waitcnt vmcnt(2)
    v_lshlrev_b32_sdwa v104, 3, v120 dst_sel:DWORD dst_unused:UNUSED_PAD src0_sel:DWORD src1_sel:WORD_0
    v_lshlrev_b32_sdwa v106, 3, v120 dst_sel:DWORD dst_unused:UNUSED_PAD src0_sel:DWORD src1_sel:WORD_1
    ds_read_b64 v[104:105], v104
    ds_read_b64 v[106:107], v106
    v_mfma_f32_16x16x32_bf16 v[112:115], v[80:83], v[152:155], v[112:115]
    v_mfma_f32_16x16x32_bf16 v[112:115], v[84:87], v[156:159], v[112:115]
    v_lshlrev_b32_sdwa v108, 3, v121 dst_sel:DWORD dst_unused:UNUSED_PAD src0_sel:DWORD src1_sel:WORD_0
    v_lshlrev_b32_sdwa v110, 3, v121 dst_sel:DWORD dst_unused:UNUSED_PAD src0_sel:DWORD src1_sel:WORD_1
    ds_read_b64 v[108:109], v108
    ds_read_b64 v[110:111], v110
    s_waitcnt lgkmcnt(9)
    v_smfmac_f32_16x16x64_bf16 v[16:19], v[64:67], v[88:95], v68
    s_nop 1
    v_cvt_pk_bf16_f32 v112, v112, v113
    v_cvt_pk_bf16_f32 v113, v114, v115
    ds_write_b64 v70, v[112:113] offset:128
    v_mfma_f32_16x16x32_bf16 v[112:115], v[72:75], v[160:163], 0
    v_lshlrev_b32_sdwa v88, 3, v122 dst_sel:DWORD dst_unused:UNUSED_PAD src0_sel:DWORD src1_sel:WORD_0
    v_lshlrev_b32_sdwa v90, 3, v122 dst_sel:DWORD dst_unused:UNUSED_PAD src0_sel:DWORD src1_sel:WORD_1
    ds_read_b64 v[88:89], v88
    ds_read_b64 v[90:91], v90
    v_mfma_f32_16x16x32_bf16 v[112:115], v[76:79], v[164:167], v[112:115]
    v_lshlrev_b32_sdwa v92, 3, v123 dst_sel:DWORD dst_unused:UNUSED_PAD src0_sel:DWORD src1_sel:WORD_0
    v_lshlrev_b32_sdwa v94, 3, v123 dst_sel:DWORD dst_unused:UNUSED_PAD src0_sel:DWORD src1_sel:WORD_1
    ds_read_b64 v[92:93], v92
    ds_read_b64 v[94:95], v94
    s_waitcnt lgkmcnt(10)
    v_smfmac_f32_16x16x64_bf16 v[20:23], v[64:67], v[96:103], v68
    buffer_load_dwordx4 v[120:123], v69, s[12:15], s20 offen offset:2048 sc1
    s_setprio 2
    v_mfma_f32_16x16x32_bf16 v[112:115], v[80:83], v[168:171], v[112:115]
    s_waitcnt vmcnt(2)
    v_lshlrev_b32_sdwa v96, 3, v124 dst_sel:DWORD dst_unused:UNUSED_PAD src0_sel:DWORD src1_sel:WORD_0
    v_lshlrev_b32_sdwa v98, 3, v124 dst_sel:DWORD dst_unused:UNUSED_PAD src0_sel:DWORD src1_sel:WORD_1
    ds_read_b64 v[96:97], v96
    ds_read_b64 v[98:99], v98
    v_mfma_f32_16x16x32_bf16 v[112:115], v[84:87], v[172:175], v[112:115]
    v_lshlrev_b32_sdwa v100, 3, v125 dst_sel:DWORD dst_unused:UNUSED_PAD src0_sel:DWORD src1_sel:WORD_0
    v_lshlrev_b32_sdwa v102, 3, v125 dst_sel:DWORD dst_unused:UNUSED_PAD src0_sel:DWORD src1_sel:WORD_1
    ds_read_b64 v[100:101], v100
    ds_read_b64 v[102:103], v102
    s_waitcnt lgkmcnt(9)
    v_smfmac_f32_16x16x64_bf16 v[24:27], v[64:67], v[104:111], v68
    s_nop 1
    v_cvt_pk_bf16_f32 v112, v112, v113
    v_cvt_pk_bf16_f32 v113, v114, v115
    ds_write_b64 v70, v[112:113] offset:256
    v_mfma_f32_16x16x32_bf16 v[112:115], v[72:75], v[176:179], 0
    v_mfma_f32_16x16x32_bf16 v[112:115], v[76:79], v[180:183], v[112:115]
    v_lshlrev_b32_sdwa v104, 3, v126 dst_sel:DWORD dst_unused:UNUSED_PAD src0_sel:DWORD src1_sel:WORD_0
    v_lshlrev_b32_sdwa v106, 3, v126 dst_sel:DWORD dst_unused:UNUSED_PAD src0_sel:DWORD src1_sel:WORD_1
    ds_read_b64 v[104:105], v104
    ds_read_b64 v[106:107], v106
    v_mfma_f32_16x16x32_bf16 v[112:115], v[80:83], v[184:187], v[112:115]
    v_mfma_f32_16x16x32_bf16 v[112:115], v[84:87], v[188:191], v[112:115]
    v_lshlrev_b32_sdwa v108, 3, v127 dst_sel:DWORD dst_unused:UNUSED_PAD src0_sel:DWORD src1_sel:WORD_0
    v_lshlrev_b32_sdwa v110, 3, v127 dst_sel:DWORD dst_unused:UNUSED_PAD src0_sel:DWORD src1_sel:WORD_1
    ds_read_b64 v[108:109], v108
    ds_read_b64 v[110:111], v110
    s_waitcnt lgkmcnt(9)
    v_smfmac_f32_16x16x64_bf16 v[28:31], v[64:67], v[88:95], v68
    buffer_load_dwordx4 v[124:127], v69, s[12:15], s20 offen offset:3072 sc1
    s_add_u32 s20, s20, 61440
    v_cvt_pk_bf16_f32 v112, v112, v113
    v_cvt_pk_bf16_f32 v113, v114, v115
    ds_write_b64 v70, v[112:113] offset:384
    v_mfma_f32_16x16x32_bf16 v[112:115], v[72:75], v[192:195], 0
    s_waitcnt vmcnt(2)
    v_lshlrev_b32_sdwa v88, 3, v116 dst_sel:DWORD dst_unused:UNUSED_PAD src0_sel:DWORD src1_sel:WORD_0
    v_lshlrev_b32_sdwa v90, 3, v116 dst_sel:DWORD dst_unused:UNUSED_PAD src0_sel:DWORD src1_sel:WORD_1
    ds_read_b64 v[88:89], v88
    ds_read_b64 v[90:91], v90
    v_mfma_f32_16x16x32_bf16 v[112:115], v[76:79], v[196:199], v[112:115]
    v_lshlrev_b32_sdwa v92, 3, v117 dst_sel:DWORD dst_unused:UNUSED_PAD src0_sel:DWORD src1_sel:WORD_0
    v_lshlrev_b32_sdwa v94, 3, v117 dst_sel:DWORD dst_unused:UNUSED_PAD src0_sel:DWORD src1_sel:WORD_1
    ds_read_b64 v[92:93], v92
    ds_read_b64 v[94:95], v94
    s_waitcnt lgkmcnt(10)
    v_smfmac_f32_16x16x64_bf16 v[32:35], v[64:67], v[96:103], v68
    s_setprio 3
    v_lshlrev_b32_sdwa v96, 3, v118 dst_sel:DWORD dst_unused:UNUSED_PAD src0_sel:DWORD src1_sel:WORD_0
    v_lshlrev_b32_sdwa v98, 3, v118 dst_sel:DWORD dst_unused:UNUSED_PAD src0_sel:DWORD src1_sel:WORD_1
    v_mfma_f32_16x16x32_bf16 v[112:115], v[80:83], v[200:203], v[112:115]
    ds_read_b64 v[96:97], v96
    ds_read_b64 v[98:99], v98
    v_mfma_f32_16x16x32_bf16 v[112:115], v[84:87], v[204:207], v[112:115]
    v_lshlrev_b32_sdwa v100, 3, v119 dst_sel:DWORD dst_unused:UNUSED_PAD src0_sel:DWORD src1_sel:WORD_0
    v_lshlrev_b32_sdwa v102, 3, v119 dst_sel:DWORD dst_unused:UNUSED_PAD src0_sel:DWORD src1_sel:WORD_1
    buffer_load_dwordx4 v[116:119], v69, s[12:15], s20 offen offset:0 sc1
    ds_read_b64 v[100:101], v100
    ds_read_b64 v[102:103], v102
    s_waitcnt lgkmcnt(9)
    v_smfmac_f32_16x16x64_bf16 v[36:39], v[64:67], v[104:111], v68
    s_nop 0
    v_cvt_pk_bf16_f32 v112, v112, v113
    v_cvt_pk_bf16_f32 v113, v114, v115
    ds_write_b64 v70, v[112:113] offset:512
    v_mfma_f32_16x16x32_bf16 v[112:115], v[72:75], v[208:211], 0
    v_mfma_f32_16x16x32_bf16 v[112:115], v[76:79], v[212:215], v[112:115]
    s_waitcnt vmcnt(2)
    v_lshlrev_b32_sdwa v104, 3, v120 dst_sel:DWORD dst_unused:UNUSED_PAD src0_sel:DWORD src1_sel:WORD_0
    v_lshlrev_b32_sdwa v106, 3, v120 dst_sel:DWORD dst_unused:UNUSED_PAD src0_sel:DWORD src1_sel:WORD_1
    ds_read_b64 v[104:105], v104
    ds_read_b64 v[106:107], v106
    v_mfma_f32_16x16x32_bf16 v[112:115], v[80:83], v[216:219], v[112:115]
    v_mfma_f32_16x16x32_bf16 v[112:115], v[84:87], v[220:223], v[112:115]
    v_lshlrev_b32_sdwa v108, 3, v121 dst_sel:DWORD dst_unused:UNUSED_PAD src0_sel:DWORD src1_sel:WORD_0
    v_lshlrev_b32_sdwa v110, 3, v121 dst_sel:DWORD dst_unused:UNUSED_PAD src0_sel:DWORD src1_sel:WORD_1
    ds_read_b64 v[108:109], v108
    ds_read_b64 v[110:111], v110
    s_waitcnt lgkmcnt(9)
    v_smfmac_f32_16x16x64_bf16 v[40:43], v[64:67], v[88:95], v68
    s_nop 1
    v_cvt_pk_bf16_f32 v112, v112, v113
    v_cvt_pk_bf16_f32 v113, v114, v115
    ds_write_b64 v70, v[112:113] offset:640
    v_mfma_f32_16x16x32_bf16 v[112:115], v[72:75], v[224:227], 0
    v_lshlrev_b32_sdwa v88, 3, v122 dst_sel:DWORD dst_unused:UNUSED_PAD src0_sel:DWORD src1_sel:WORD_0
    v_lshlrev_b32_sdwa v90, 3, v122 dst_sel:DWORD dst_unused:UNUSED_PAD src0_sel:DWORD src1_sel:WORD_1
    ds_read_b64 v[88:89], v88
    ds_read_b64 v[90:91], v90
    v_mfma_f32_16x16x32_bf16 v[112:115], v[76:79], v[228:231], v[112:115]
    v_lshlrev_b32_sdwa v92, 3, v123 dst_sel:DWORD dst_unused:UNUSED_PAD src0_sel:DWORD src1_sel:WORD_0
    v_lshlrev_b32_sdwa v94, 3, v123 dst_sel:DWORD dst_unused:UNUSED_PAD src0_sel:DWORD src1_sel:WORD_1
    ds_read_b64 v[92:93], v92
    ds_read_b64 v[94:95], v94
    s_waitcnt lgkmcnt(10)
    v_smfmac_f32_16x16x64_bf16 v[44:47], v[64:67], v[96:103], v68
    buffer_load_dwordx4 v[120:123], v69, s[12:15], s20 offen offset:1024 sc1
    s_setprio 1
    s_waitcnt vmcnt(2)
    v_lshlrev_b32_sdwa v96, 3, v124 dst_sel:DWORD dst_unused:UNUSED_PAD src0_sel:DWORD src1_sel:WORD_0
    v_lshlrev_b32_sdwa v98, 3, v124 dst_sel:DWORD dst_unused:UNUSED_PAD src0_sel:DWORD src1_sel:WORD_1
    v_mfma_f32_16x16x32_bf16 v[112:115], v[80:83], v[232:235], v[112:115]
    ds_read_b64 v[96:97], v96
    ds_read_b64 v[98:99], v98
    v_lshlrev_b32_sdwa v100, 3, v125 dst_sel:DWORD dst_unused:UNUSED_PAD src0_sel:DWORD src1_sel:WORD_0
    v_lshlrev_b32_sdwa v102, 3, v125 dst_sel:DWORD dst_unused:UNUSED_PAD src0_sel:DWORD src1_sel:WORD_1
    v_mfma_f32_16x16x32_bf16 v[112:115], v[84:87], v[236:239], v[112:115]
    ds_read_b64 v[100:101], v100
    ds_read_b64 v[102:103], v102
    s_waitcnt lgkmcnt(9)
    v_smfmac_f32_16x16x64_bf16 v[48:51], v[64:67], v[104:111], v68
    v_lshlrev_b32_sdwa v104, 3, v126 dst_sel:DWORD dst_unused:UNUSED_PAD src0_sel:DWORD src1_sel:WORD_0
    v_lshlrev_b32_sdwa v106, 3, v126 dst_sel:DWORD dst_unused:UNUSED_PAD src0_sel:DWORD src1_sel:WORD_1
    s_nop 1
    v_cvt_pk_bf16_f32 v112, v112, v113
    v_cvt_pk_bf16_f32 v113, v114, v115
    ds_write_b64 v70, v[112:113] offset:768
    v_mfma_f32_16x16x32_bf16 v[112:115], v[72:75], v[240:243], 0
    buffer_load_dwordx4 v[72:75], v69, s[12:15], s21 offen offset:0
    ds_read_b64 v[104:105], v104
    ds_read_b64 v[106:107], v106
    v_lshlrev_b32_sdwa v108, 3, v127 dst_sel:DWORD dst_unused:UNUSED_PAD src0_sel:DWORD src1_sel:WORD_0
    v_lshlrev_b32_sdwa v110, 3, v127 dst_sel:DWORD dst_unused:UNUSED_PAD src0_sel:DWORD src1_sel:WORD_1
    buffer_load_dwordx4 v[124:127], v69, s[12:15], s20 offen offset:2048 sc1
    ds_read_b64 v[108:109], v108
    ds_read_b64 v[110:111], v110
    v_mfma_f32_16x16x32_bf16 v[112:115], v[76:79], v[244:247], v[112:115]
    buffer_load_dwordx4 v[76:79], v69, s[12:15], s21 offen offset:1024
    s_waitcnt lgkmcnt(9)
    v_smfmac_f32_16x16x64_bf16 v[52:55], v[64:67], v[88:95], v68
    s_waitcnt vmcnt(4)
    v_lshlrev_b32_sdwa v88, 3, v116 dst_sel:DWORD dst_unused:UNUSED_PAD src0_sel:DWORD src1_sel:WORD_0
    v_lshlrev_b32_sdwa v90, 3, v116 dst_sel:DWORD dst_unused:UNUSED_PAD src0_sel:DWORD src1_sel:WORD_1
    ds_read_b64 v[88:89], v88
    ds_read_b64 v[90:91], v90
    v_mfma_f32_16x16x32_bf16 v[112:115], v[80:83], v[248:251], v[112:115]
    buffer_load_dwordx4 v[80:83], v69, s[12:15], s19 offen offset:0
    v_lshlrev_b32_sdwa v92, 3, v117 dst_sel:DWORD dst_unused:UNUSED_PAD src0_sel:DWORD src1_sel:WORD_0
    v_lshlrev_b32_sdwa v94, 3, v117 dst_sel:DWORD dst_unused:UNUSED_PAD src0_sel:DWORD src1_sel:WORD_1
    v_mfma_f32_16x16x32_bf16 v[112:115], v[84:87], v[252:255], v[112:115]
    buffer_load_dwordx4 v[84:87], v69, s[12:15], s19 offen offset:1024
    s_add_u32 s21, s21, 4096
    s_add_u32 s19, s19, 4096
    ds_read_b64 v[92:93], v92
    ds_read_b64 v[94:95], v94
    s_waitcnt lgkmcnt(9)
    v_smfmac_f32_16x16x64_bf16 v[56:59], v[64:67], v[96:103], v68
    s_setprio 0
    v_cvt_pk_bf16_f32 v112, v112, v113
    v_cvt_pk_bf16_f32 v113, v114, v115
    ds_write_b64 v70, v[112:113] offset:896
    ds_append v71 offset:8080
    s_add_u32 s23, s23, s23
    s_cselect_b32 s35, 4294836224, s32
    v_add_u32 v70, s35, v70
    v_lshlrev_b32_sdwa v96, 3, v118 dst_sel:DWORD dst_unused:UNUSED_PAD src0_sel:DWORD src1_sel:WORD_0
    v_lshlrev_b32_sdwa v98, 3, v118 dst_sel:DWORD dst_unused:UNUSED_PAD src0_sel:DWORD src1_sel:WORD_1
    ds_read_b64 v[96:97], v96
    ds_read_b64 v[98:99], v98
    v_lshlrev_b32_sdwa v100, 3, v119 dst_sel:DWORD dst_unused:UNUSED_PAD src0_sel:DWORD src1_sel:WORD_0
    v_lshlrev_b32_sdwa v102, 3, v119 dst_sel:DWORD dst_unused:UNUSED_PAD src0_sel:DWORD src1_sel:WORD_1
    buffer_load_dwordx4 v[116:119], v69, s[12:15], s20 offen offset:3072 sc1
    s_add_u32 s20, s20, 4096
    ds_read_b64 v[100:101], v100
    ds_read_b64 v[102:103], v102
    s_waitcnt lgkmcnt(10)
    v_smfmac_f32_16x16x64_bf16 v[60:63], v[64:67], v[104:111], v68

    s_branch standalone__deep_cross_pnn__recsys_kernel_gloop

standalone__deep_cross_pnn__recsys_kernel_sp0:
    s_sleep 1
    ds_read_addtid_b32 v71 offset:8080
    s_waitcnt lgkmcnt(0)
    v_readfirstlane_b32 s36, v71

    s_cmp_lt_u32 s36, s37
    s_cbranch_scc1 standalone__deep_cross_pnn__recsys_kernel_sp0
    s_branch standalone__deep_cross_pnn__recsys_kernel_sr0
standalone__deep_cross_pnn__recsys_kernel_sp1:
    s_sleep 1
    ds_read_addtid_b32 v71 offset:8080
    s_waitcnt lgkmcnt(0)
    v_readfirstlane_b32 s36, v71

    s_cmp_lt_u32 s36, s37
    s_cbranch_scc1 standalone__deep_cross_pnn__recsys_kernel_sp1
    s_branch standalone__deep_cross_pnn__recsys_kernel_sr1
standalone__deep_cross_pnn__recsys_kernel_sp2:
    s_sleep 1
    ds_read_addtid_b32 v71 offset:8080
    s_waitcnt lgkmcnt(0)
    v_readfirstlane_b32 s36, v71

    s_cmp_lt_u32 s36, s37
    s_cbranch_scc1 standalone__deep_cross_pnn__recsys_kernel_sp2
    s_branch standalone__deep_cross_pnn__recsys_kernel_sr2
standalone__deep_cross_pnn__recsys_kernel_sp3:
    s_sleep 1
    ds_read_addtid_b32 v71 offset:8080
    s_waitcnt lgkmcnt(0)
    v_readfirstlane_b32 s36, v71

    s_cmp_lt_u32 s36, s37
    s_cbranch_scc1 standalone__deep_cross_pnn__recsys_kernel_sp3
    s_branch standalone__deep_cross_pnn__recsys_kernel_sr3
standalone__deep_cross_pnn__recsys_kernel_fin:

    s_add_u32 s40, s20, 61440
    s_add_u32 s41, s20, 65536
    s_add_u32 s44, s20, 126976
    s_add_u32 s45, s20, 131072

    s_lshl_b32 s35, s33, 16
    s_lshl_b32 s42, s34, 15
    s_add_u32 s35, s35, s42
    s_lshl_b32 s42, s3, 12
    s_add_u32 s35, s35, s42
    s_add_u32 s35, s35, 20971520

    v_mov_b32 v128, 0xbdd2d3e8
    v_mov_b32 v129, 0xbdd2d3e8
    v_mov_b32 v130, 0xc0135761
    v_mov_b32 v131, 0xc0135761
    v_mov_b32 v132, 1.0
    v_mov_b32 v133, 1.0
    v_mov_b32 v134, s28
    v_mov_b32 v135, s29
    s_waitcnt vmcnt(6)
    v_lshlrev_b32_sdwa v88, 3, v116 dst_sel:DWORD dst_unused:UNUSED_PAD src0_sel:DWORD src1_sel:WORD_0
    v_lshlrev_b32_sdwa v90, 3, v116 dst_sel:DWORD dst_unused:UNUSED_PAD src0_sel:DWORD src1_sel:WORD_1
    ds_read_b64 v[88:89], v88
    ds_read_b64 v[90:91], v90
    v_lshlrev_b32_sdwa v92, 3, v117 dst_sel:DWORD dst_unused:UNUSED_PAD src0_sel:DWORD src1_sel:WORD_0
    v_lshlrev_b32_sdwa v94, 3, v117 dst_sel:DWORD dst_unused:UNUSED_PAD src0_sel:DWORD src1_sel:WORD_1
    ds_read_b64 v[92:93], v92
    ds_read_b64 v[94:95], v94
    s_waitcnt lgkmcnt(10)
    v_smfmac_f32_16x16x64_bf16 v[0:3], v[64:67], v[96:103], v68
    v_mov_b32 v136, s30
    v_mov_b32 v137, s31
    v_lshrrev_b32 v70, 2, v69
    v_and_b32 v138, 128, v70
    v_add_u32 v70, v70, v138
    v_rcp_f32 v134, v134
    v_rcp_f32 v135, v135
    v_rcp_f32 v136, v136
    v_lshlrev_b32_sdwa v96, 3, v118 dst_sel:DWORD dst_unused:UNUSED_PAD src0_sel:DWORD src1_sel:WORD_0
    v_lshlrev_b32_sdwa v98, 3, v118 dst_sel:DWORD dst_unused:UNUSED_PAD src0_sel:DWORD src1_sel:WORD_1
    ds_read_b64 v[96:97], v96
    ds_read_b64 v[98:99], v98
    v_lshlrev_b32_sdwa v100, 3, v119 dst_sel:DWORD dst_unused:UNUSED_PAD src0_sel:DWORD src1_sel:WORD_0
    v_lshlrev_b32_sdwa v102, 3, v119 dst_sel:DWORD dst_unused:UNUSED_PAD src0_sel:DWORD src1_sel:WORD_1
    ds_read_b64 v[100:101], v100
    ds_read_b64 v[102:103], v102
    buffer_load_dwordx4 v[116:119], v69, s[12:15], s40 offen offset:0 sc1
    s_waitcnt lgkmcnt(8)
    v_smfmac_f32_16x16x64_bf16 v[4:7], v[64:67], v[104:111], v68
    v_rcp_f32 v137, v137
    v_mov_b32 v132, 0x7f7fffff
    v_mov_b32 v133, 0xff7fffff
    v_med3_f32 v134, v134, v132, v133
    v_med3_f32 v135, v135, v132, v133
    v_med3_f32 v136, v136, v132, v133
    v_med3_f32 v137, v137, v132, v133
    s_waitcnt vmcnt(5)
    v_lshlrev_b32_sdwa v104, 3, v120 dst_sel:DWORD dst_unused:UNUSED_PAD src0_sel:DWORD src1_sel:WORD_0
    v_lshlrev_b32_sdwa v106, 3, v120 dst_sel:DWORD dst_unused:UNUSED_PAD src0_sel:DWORD src1_sel:WORD_1
    ds_read_b64 v[104:105], v104
    ds_read_b64 v[106:107], v106
    v_lshlrev_b32_sdwa v108, 3, v121 dst_sel:DWORD dst_unused:UNUSED_PAD src0_sel:DWORD src1_sel:WORD_0
    v_lshlrev_b32_sdwa v110, 3, v121 dst_sel:DWORD dst_unused:UNUSED_PAD src0_sel:DWORD src1_sel:WORD_1
    ds_read_b64 v[108:109], v108
    ds_read_b64 v[110:111], v110
    s_waitcnt lgkmcnt(8)
    v_smfmac_f32_16x16x64_bf16 v[8:11], v[64:67], v[88:95], v68
    v_lshlrev_b32_sdwa v88, 3, v122 dst_sel:DWORD dst_unused:UNUSED_PAD src0_sel:DWORD src1_sel:WORD_0
    v_lshlrev_b32_sdwa v90, 3, v122 dst_sel:DWORD dst_unused:UNUSED_PAD src0_sel:DWORD src1_sel:WORD_1
    ds_read_b64 v[88:89], v88
    ds_read_b64 v[90:91], v90
    ds_read_addtid_b32 v71 offset:8080
    v_lshlrev_b32_sdwa v92, 3, v123 dst_sel:DWORD dst_unused:UNUSED_PAD src0_sel:DWORD src1_sel:WORD_0
    v_lshlrev_b32_sdwa v94, 3, v123 dst_sel:DWORD dst_unused:UNUSED_PAD src0_sel:DWORD src1_sel:WORD_1
    ds_read_b64 v[92:93], v92
    ds_read_b64 v[94:95], v94
    buffer_load_dwordx4 v[120:123], v69, s[12:15], s44 offen offset:0 sc1
    s_waitcnt lgkmcnt(9)
    v_smfmac_f32_16x16x64_bf16 v[12:15], v[64:67], v[96:103], v68
    s_waitcnt vmcnt(2)
    v_lshlrev_b32_sdwa v96, 3, v124 dst_sel:DWORD dst_unused:UNUSED_PAD src0_sel:DWORD src1_sel:WORD_0
    v_lshlrev_b32_sdwa v98, 3, v124 dst_sel:DWORD dst_unused:UNUSED_PAD src0_sel:DWORD src1_sel:WORD_1
    ds_read_b64 v[96:97], v96
    ds_read_b64 v[98:99], v98
    v_lshlrev_b32_sdwa v100, 3, v125 dst_sel:DWORD dst_unused:UNUSED_PAD src0_sel:DWORD src1_sel:WORD_0
    v_lshlrev_b32_sdwa v102, 3, v125 dst_sel:DWORD dst_unused:UNUSED_PAD src0_sel:DWORD src1_sel:WORD_1
    ds_read_b64 v[100:101], v100
    ds_read_b64 v[102:103], v102
    s_waitcnt lgkmcnt(9)
    v_smfmac_f32_16x16x64_bf16 v[16:19], v[64:67], v[104:111], v68
    v_lshlrev_b32_sdwa v104, 3, v126 dst_sel:DWORD dst_unused:UNUSED_PAD src0_sel:DWORD src1_sel:WORD_0
    v_lshlrev_b32_sdwa v106, 3, v126 dst_sel:DWORD dst_unused:UNUSED_PAD src0_sel:DWORD src1_sel:WORD_1
    ds_read_b64 v[104:105], v104
    ds_read_b64 v[106:107], v106
    v_lshlrev_b32_sdwa v108, 3, v127 dst_sel:DWORD dst_unused:UNUSED_PAD src0_sel:DWORD src1_sel:WORD_0
    v_lshlrev_b32_sdwa v110, 3, v127 dst_sel:DWORD dst_unused:UNUSED_PAD src0_sel:DWORD src1_sel:WORD_1
    ds_read_b64 v[108:109], v108
    ds_read_b64 v[110:111], v110
    buffer_load_dwordx4 v[124:127], v69, s[12:15], s40 offen offset:1024 sc1
    s_waitcnt lgkmcnt(8)
    v_smfmac_f32_16x16x64_bf16 v[20:23], v[64:67], v[88:95], v68
    v_readfirstlane_b32 s36, v71
    s_waitcnt vmcnt(2)
    s_cmp_lt_u32 s36, s37
    s_cbranch_scc1 standalone__deep_cross_pnn__recsys_kernel_sp3
standalone__deep_cross_pnn__recsys_kernel_sr3:
    v_lshlrev_b32_sdwa v88, 3, v116 dst_sel:DWORD dst_unused:UNUSED_PAD src0_sel:DWORD src1_sel:WORD_0
    v_lshlrev_b32_sdwa v90, 3, v116 dst_sel:DWORD dst_unused:UNUSED_PAD src0_sel:DWORD src1_sel:WORD_1
    ds_read_b64 v[88:89], v88
    ds_read_b64 v[90:91], v90
    v_lshlrev_b32_sdwa v92, 3, v117 dst_sel:DWORD dst_unused:UNUSED_PAD src0_sel:DWORD src1_sel:WORD_0
    v_lshlrev_b32_sdwa v94, 3, v117 dst_sel:DWORD dst_unused:UNUSED_PAD src0_sel:DWORD src1_sel:WORD_1
    ds_read_b64 v[92:93], v92
    ds_read_b64 v[94:95], v94
    s_waitcnt lgkmcnt(8)
    v_smfmac_f32_16x16x64_bf16 v[24:27], v[64:67], v[96:103], v68
    v_lshlrev_b32_sdwa v96, 3, v118 dst_sel:DWORD dst_unused:UNUSED_PAD src0_sel:DWORD src1_sel:WORD_0
    v_lshlrev_b32_sdwa v98, 3, v118 dst_sel:DWORD dst_unused:UNUSED_PAD src0_sel:DWORD src1_sel:WORD_1
    ds_read_b64 v[96:97], v96
    ds_read_b64 v[98:99], v98
    v_lshlrev_b32_sdwa v100, 3, v119 dst_sel:DWORD dst_unused:UNUSED_PAD src0_sel:DWORD src1_sel:WORD_0
    v_lshlrev_b32_sdwa v102, 3, v119 dst_sel:DWORD dst_unused:UNUSED_PAD src0_sel:DWORD src1_sel:WORD_1
    ds_read_b64 v[100:101], v100
    ds_read_b64 v[102:103], v102
    buffer_load_dwordx4 v[116:119], v69, s[12:15], s44 offen offset:1024 sc1
    s_waitcnt lgkmcnt(8)
    v_smfmac_f32_16x16x64_bf16 v[28:31], v[64:67], v[104:111], v68
    s_waitcnt vmcnt(2)
    v_lshlrev_b32_sdwa v104, 3, v120 dst_sel:DWORD dst_unused:UNUSED_PAD src0_sel:DWORD src1_sel:WORD_0
    v_lshlrev_b32_sdwa v106, 3, v120 dst_sel:DWORD dst_unused:UNUSED_PAD src0_sel:DWORD src1_sel:WORD_1
    ds_read_b64 v[104:105], v104
    ds_read_b64 v[106:107], v106
    v_lshlrev_b32_sdwa v108, 3, v121 dst_sel:DWORD dst_unused:UNUSED_PAD src0_sel:DWORD src1_sel:WORD_0
    v_lshlrev_b32_sdwa v110, 3, v121 dst_sel:DWORD dst_unused:UNUSED_PAD src0_sel:DWORD src1_sel:WORD_1
    ds_read_b64 v[108:109], v108
    ds_read_b64 v[110:111], v110
    s_waitcnt lgkmcnt(8)
    v_smfmac_f32_16x16x64_bf16 v[0:3], v[64:67], v[88:95], v68
    v_lshlrev_b32_sdwa v88, 3, v122 dst_sel:DWORD dst_unused:UNUSED_PAD src0_sel:DWORD src1_sel:WORD_0
    v_lshlrev_b32_sdwa v90, 3, v122 dst_sel:DWORD dst_unused:UNUSED_PAD src0_sel:DWORD src1_sel:WORD_1
    ds_read_b64 v[88:89], v88
    ds_read_b64 v[90:91], v90
    v_lshlrev_b32_sdwa v92, 3, v123 dst_sel:DWORD dst_unused:UNUSED_PAD src0_sel:DWORD src1_sel:WORD_0
    v_lshlrev_b32_sdwa v94, 3, v123 dst_sel:DWORD dst_unused:UNUSED_PAD src0_sel:DWORD src1_sel:WORD_1
    ds_read_b64 v[92:93], v92
    ds_read_b64 v[94:95], v94
    buffer_load_dwordx4 v[120:123], v69, s[12:15], s40 offen offset:2048 sc1
    s_waitcnt lgkmcnt(8)
    v_smfmac_f32_16x16x64_bf16 v[4:7], v[64:67], v[96:103], v68
    s_waitcnt vmcnt(2)
    v_lshlrev_b32_sdwa v96, 3, v124 dst_sel:DWORD dst_unused:UNUSED_PAD src0_sel:DWORD src1_sel:WORD_0
    v_lshlrev_b32_sdwa v98, 3, v124 dst_sel:DWORD dst_unused:UNUSED_PAD src0_sel:DWORD src1_sel:WORD_1
    ds_read_b64 v[96:97], v96
    ds_read_b64 v[98:99], v98
    v_lshlrev_b32_sdwa v100, 3, v125 dst_sel:DWORD dst_unused:UNUSED_PAD src0_sel:DWORD src1_sel:WORD_0
    v_lshlrev_b32_sdwa v102, 3, v125 dst_sel:DWORD dst_unused:UNUSED_PAD src0_sel:DWORD src1_sel:WORD_1
    ds_read_b64 v[100:101], v100
    ds_read_b64 v[102:103], v102
    s_waitcnt lgkmcnt(8)
    v_smfmac_f32_16x16x64_bf16 v[0:3], v[64:67], v[104:111], v68
    v_lshlrev_b32_sdwa v104, 3, v126 dst_sel:DWORD dst_unused:UNUSED_PAD src0_sel:DWORD src1_sel:WORD_0
    v_lshlrev_b32_sdwa v106, 3, v126 dst_sel:DWORD dst_unused:UNUSED_PAD src0_sel:DWORD src1_sel:WORD_1
    ds_read_b64 v[104:105], v104
    ds_read_b64 v[106:107], v106
    v_lshlrev_b32_sdwa v108, 3, v127 dst_sel:DWORD dst_unused:UNUSED_PAD src0_sel:DWORD src1_sel:WORD_0
    v_lshlrev_b32_sdwa v110, 3, v127 dst_sel:DWORD dst_unused:UNUSED_PAD src0_sel:DWORD src1_sel:WORD_1
    ds_read_b64 v[108:109], v108
    ds_read_b64 v[110:111], v110
    buffer_load_dwordx4 v[124:127], v69, s[12:15], s44 offen offset:2048 sc1
    s_waitcnt lgkmcnt(8)
    v_smfmac_f32_16x16x64_bf16 v[4:7], v[64:67], v[88:95], v68
    s_waitcnt vmcnt(2)
    v_lshlrev_b32_sdwa v88, 3, v116 dst_sel:DWORD dst_unused:UNUSED_PAD src0_sel:DWORD src1_sel:WORD_0
    v_lshlrev_b32_sdwa v90, 3, v116 dst_sel:DWORD dst_unused:UNUSED_PAD src0_sel:DWORD src1_sel:WORD_1
    ds_read_b64 v[88:89], v88
    ds_read_b64 v[90:91], v90
    v_lshlrev_b32_sdwa v92, 3, v117 dst_sel:DWORD dst_unused:UNUSED_PAD src0_sel:DWORD src1_sel:WORD_0
    v_lshlrev_b32_sdwa v94, 3, v117 dst_sel:DWORD dst_unused:UNUSED_PAD src0_sel:DWORD src1_sel:WORD_1
    ds_read_b64 v[92:93], v92
    ds_read_b64 v[94:95], v94
    s_waitcnt lgkmcnt(8)
    v_smfmac_f32_16x16x64_bf16 v[8:11], v[64:67], v[96:103], v68
    v_pk_mul_f32 v[140:141], v[0:1], v[0:1]
    v_pk_mul_f32 v[142:143], v[2:3], v[2:3]
    v_pk_fma_f32 v[140:141], v[140:141], v[128:129], v[130:131]
    v_pk_fma_f32 v[142:143], v[142:143], v[128:129], v[130:131]
    v_pk_mul_f32 v[140:141], v[140:141], v[0:1]
    v_pk_mul_f32 v[142:143], v[142:143], v[2:3]
    v_exp_f32 v140, v140
    v_pk_mul_f32 v[146:147], v[4:5], v[4:5]
    v_lshlrev_b32_sdwa v96, 3, v118 dst_sel:DWORD dst_unused:UNUSED_PAD src0_sel:DWORD src1_sel:WORD_0
    v_lshlrev_b32_sdwa v98, 3, v118 dst_sel:DWORD dst_unused:UNUSED_PAD src0_sel:DWORD src1_sel:WORD_1
    ds_read_b64 v[96:97], v96
    ds_read_b64 v[98:99], v98
    v_lshlrev_b32_sdwa v100, 3, v119 dst_sel:DWORD dst_unused:UNUSED_PAD src0_sel:DWORD src1_sel:WORD_0
    v_lshlrev_b32_sdwa v102, 3, v119 dst_sel:DWORD dst_unused:UNUSED_PAD src0_sel:DWORD src1_sel:WORD_1
    ds_read_b64 v[100:101], v100
    ds_read_b64 v[102:103], v102
    buffer_load_dwordx4 v[116:119], v69, s[12:15], s40 offen offset:3072 sc1
    s_waitcnt lgkmcnt(8)
    v_smfmac_f32_16x16x64_bf16 v[12:15], v[64:67], v[104:111], v68
    v_exp_f32 v141, v141
    v_pk_fma_f32 v[146:147], v[146:147], v[128:129], v[130:131]
    v_pk_mul_f32 v[148:149], v[6:7], v[6:7]
    v_exp_f32 v142, v142
    v_pk_fma_f32 v[140:141], v[140:141], v[134:135], v[134:135]
    v_pk_mul_f32 v[146:147], v[146:147], v[4:5]
    v_rcp_f32 v140, v140
    v_pk_fma_f32 v[148:149], v[148:149], v[128:129], v[130:131]
    s_waitcnt vmcnt(2)
    v_lshlrev_b32_sdwa v104, 3, v120 dst_sel:DWORD dst_unused:UNUSED_PAD src0_sel:DWORD src1_sel:WORD_0
    v_lshlrev_b32_sdwa v106, 3, v120 dst_sel:DWORD dst_unused:UNUSED_PAD src0_sel:DWORD src1_sel:WORD_1
    ds_read_b64 v[104:105], v104
    ds_read_b64 v[106:107], v106
    v_lshlrev_b32_sdwa v108, 3, v121 dst_sel:DWORD dst_unused:UNUSED_PAD src0_sel:DWORD src1_sel:WORD_0
    v_lshlrev_b32_sdwa v110, 3, v121 dst_sel:DWORD dst_unused:UNUSED_PAD src0_sel:DWORD src1_sel:WORD_1
    ds_read_b64 v[108:109], v108
    ds_read_b64 v[110:111], v110
    s_waitcnt lgkmcnt(8)
    v_smfmac_f32_16x16x64_bf16 v[8:11], v[64:67], v[88:95], v68
    v_rcp_f32 v141, v141
    v_pk_mul_f32 v[148:149], v[148:149], v[6:7]
    v_exp_f32 v143, v143
    v_pk_mul_f32 v[144:145], v[0:1], v[140:141]
    v_exp_f32 v146, v146
    v_pk_fma_f32 v[142:143], v[142:143], v[136:137], v[136:137]
    v_exp_f32 v147, v147
    v_rcp_f32 v142, v142
    v_lshlrev_b32_sdwa v88, 3, v122 dst_sel:DWORD dst_unused:UNUSED_PAD src0_sel:DWORD src1_sel:WORD_0
    v_lshlrev_b32_sdwa v90, 3, v122 dst_sel:DWORD dst_unused:UNUSED_PAD src0_sel:DWORD src1_sel:WORD_1
    ds_read_b64 v[88:89], v88
    ds_read_b64 v[90:91], v90
    v_lshlrev_b32_sdwa v92, 3, v123 dst_sel:DWORD dst_unused:UNUSED_PAD src0_sel:DWORD src1_sel:WORD_0
    v_lshlrev_b32_sdwa v94, 3, v123 dst_sel:DWORD dst_unused:UNUSED_PAD src0_sel:DWORD src1_sel:WORD_1
    ds_read_b64 v[92:93], v92
    ds_read_b64 v[94:95], v94
    buffer_load_dwordx4 v[120:123], v69, s[12:15], s44 offen offset:3072 sc1
    s_waitcnt lgkmcnt(8)
    v_smfmac_f32_16x16x64_bf16 v[12:15], v[64:67], v[96:103], v68
    v_rcp_f32 v143, v143
    v_pk_fma_f32 v[146:147], v[146:147], v[134:135], v[134:135]
    v_pk_mul_f32 v[152:153], v[8:9], v[8:9]
    v_rcp_f32 v146, v146
    v_pk_fma_f32 v[144:145], v[2:3], v[142:143], v[144:145]
    v_pk_fma_f32 v[152:153], v[152:153], v[128:129], v[130:131]
    v_rcp_f32 v147, v147
    v_add_f32 v144, v144, v145
    s_waitcnt vmcnt(2)
    v_lshlrev_b32_sdwa v96, 3, v124 dst_sel:DWORD dst_unused:UNUSED_PAD src0_sel:DWORD src1_sel:WORD_0
    v_lshlrev_b32_sdwa v98, 3, v124 dst_sel:DWORD dst_unused:UNUSED_PAD src0_sel:DWORD src1_sel:WORD_1
    ds_read_b64 v[96:97], v96
    ds_read_b64 v[98:99], v98
    v_lshlrev_b32_sdwa v100, 3, v125 dst_sel:DWORD dst_unused:UNUSED_PAD src0_sel:DWORD src1_sel:WORD_0
    v_lshlrev_b32_sdwa v102, 3, v125 dst_sel:DWORD dst_unused:UNUSED_PAD src0_sel:DWORD src1_sel:WORD_1
    ds_read_b64 v[100:101], v100
    ds_read_b64 v[102:103], v102
    s_waitcnt lgkmcnt(8)
    v_smfmac_f32_16x16x64_bf16 v[16:19], v[64:67], v[104:111], v68
    v_exp_f32 v148, v148
    buffer_store_dword v144, v70, s[12:15], s35 offen offset:0 sc1
    v_pk_mul_f32 v[150:151], v[4:5], v[146:147]
    v_exp_f32 v149, v149
    v_pk_mul_f32 v[152:153], v[152:153], v[8:9]
    v_pk_mul_f32 v[154:155], v[10:11], v[10:11]
    v_exp_f32 v152, v152
    v_pk_fma_f32 v[148:149], v[148:149], v[136:137], v[136:137]
    v_lshlrev_b32_sdwa v104, 3, v126 dst_sel:DWORD dst_unused:UNUSED_PAD src0_sel:DWORD src1_sel:WORD_0
    v_lshlrev_b32_sdwa v106, 3, v126 dst_sel:DWORD dst_unused:UNUSED_PAD src0_sel:DWORD src1_sel:WORD_1
    ds_read_b64 v[104:105], v104
    ds_read_b64 v[106:107], v106
    v_lshlrev_b32_sdwa v108, 3, v127 dst_sel:DWORD dst_unused:UNUSED_PAD src0_sel:DWORD src1_sel:WORD_0
    v_lshlrev_b32_sdwa v110, 3, v127 dst_sel:DWORD dst_unused:UNUSED_PAD src0_sel:DWORD src1_sel:WORD_1
    ds_read_b64 v[108:109], v108
    ds_read_b64 v[110:111], v110
    buffer_load_dwordx4 v[124:127], v69, s[12:15], s20 offen offset:0 sc1
    s_waitcnt lgkmcnt(8)
    v_smfmac_f32_16x16x64_bf16 v[20:23], v[64:67], v[88:95], v68
    v_rcp_f32 v148, v148
    v_pk_fma_f32 v[154:155], v[154:155], v[128:129], v[130:131]
    v_pk_mul_f32 v[158:159], v[12:13], v[12:13]
    v_rcp_f32 v149, v149
    v_pk_mul_f32 v[154:155], v[154:155], v[10:11]
    v_pk_fma_f32 v[158:159], v[158:159], v[128:129], v[130:131]
    v_exp_f32 v153, v153
    v_pk_fma_f32 v[150:151], v[6:7], v[148:149], v[150:151]
    s_waitcnt vmcnt(3)
    v_lshlrev_b32_sdwa v88, 3, v116 dst_sel:DWORD dst_unused:UNUSED_PAD src0_sel:DWORD src1_sel:WORD_0
    v_lshlrev_b32_sdwa v90, 3, v116 dst_sel:DWORD dst_unused:UNUSED_PAD src0_sel:DWORD src1_sel:WORD_1
    ds_read_b64 v[88:89], v88
    ds_read_b64 v[90:91], v90
    v_lshlrev_b32_sdwa v92, 3, v117 dst_sel:DWORD dst_unused:UNUSED_PAD src0_sel:DWORD src1_sel:WORD_0
    v_lshlrev_b32_sdwa v94, 3, v117 dst_sel:DWORD dst_unused:UNUSED_PAD src0_sel:DWORD src1_sel:WORD_1
    ds_read_b64 v[92:93], v92
    ds_read_b64 v[94:95], v94
    s_waitcnt lgkmcnt(8)
    v_smfmac_f32_16x16x64_bf16 v[16:19], v[64:67], v[96:103], v68
    v_exp_f32 v154, v154
    v_add_f32 v150, v150, v151
    v_pk_fma_f32 v[152:153], v[152:153], v[134:135], v[134:135]
    v_exp_f32 v155, v155
    buffer_store_dword v150, v70, s[12:15], s35 offen offset:128 sc1
    v_pk_mul_f32 v[158:159], v[158:159], v[12:13]
    v_rcp_f32 v152, v152
    v_pk_fma_f32 v[154:155], v[154:155], v[136:137], v[136:137]
    v_lshlrev_b32_sdwa v96, 3, v118 dst_sel:DWORD dst_unused:UNUSED_PAD src0_sel:DWORD src1_sel:WORD_0
    v_lshlrev_b32_sdwa v98, 3, v118 dst_sel:DWORD dst_unused:UNUSED_PAD src0_sel:DWORD src1_sel:WORD_1
    ds_read_b64 v[96:97], v96
    ds_read_b64 v[98:99], v98
    v_lshlrev_b32_sdwa v100, 3, v119 dst_sel:DWORD dst_unused:UNUSED_PAD src0_sel:DWORD src1_sel:WORD_0
    v_lshlrev_b32_sdwa v102, 3, v119 dst_sel:DWORD dst_unused:UNUSED_PAD src0_sel:DWORD src1_sel:WORD_1
    ds_read_b64 v[100:101], v100
    ds_read_b64 v[102:103], v102
    buffer_load_dwordx4 v[116:119], v69, s[12:15], s41 offen offset:0 sc1
    s_waitcnt lgkmcnt(8)
    v_smfmac_f32_16x16x64_bf16 v[20:23], v[64:67], v[104:111], v68
    v_rcp_f32 v153, v153
    v_pk_mul_f32 v[160:161], v[14:15], v[14:15]
    v_pk_mul_f32 v[164:165], v[16:17], v[16:17]
    v_rcp_f32 v154, v154
    v_pk_mul_f32 v[156:157], v[8:9], v[152:153]
    v_pk_fma_f32 v[160:161], v[160:161], v[128:129], v[130:131]
    v_rcp_f32 v155, v155
    v_pk_mul_f32 v[160:161], v[160:161], v[14:15]
    s_waitcnt vmcnt(4)
    v_lshlrev_b32_sdwa v104, 3, v120 dst_sel:DWORD dst_unused:UNUSED_PAD src0_sel:DWORD src1_sel:WORD_0
    v_lshlrev_b32_sdwa v106, 3, v120 dst_sel:DWORD dst_unused:UNUSED_PAD src0_sel:DWORD src1_sel:WORD_1
    ds_read_b64 v[104:105], v104
    ds_read_b64 v[106:107], v106
    v_lshlrev_b32_sdwa v108, 3, v121 dst_sel:DWORD dst_unused:UNUSED_PAD src0_sel:DWORD src1_sel:WORD_0
    v_lshlrev_b32_sdwa v110, 3, v121 dst_sel:DWORD dst_unused:UNUSED_PAD src0_sel:DWORD src1_sel:WORD_1
    ds_read_b64 v[108:109], v108
    ds_read_b64 v[110:111], v110
    s_waitcnt lgkmcnt(8)
    v_smfmac_f32_16x16x64_bf16 v[24:27], v[64:67], v[88:95], v68
    v_exp_f32 v158, v158
    v_pk_fma_f32 v[156:157], v[10:11], v[154:155], v[156:157]
    v_pk_fma_f32 v[164:165], v[164:165], v[128:129], v[130:131]
    v_exp_f32 v159, v159
    v_add_f32 v156, v156, v157
    v_pk_mul_f32 v[164:165], v[164:165], v[16:17]
    v_exp_f32 v160, v160
    buffer_store_dword v156, v70, s[12:15], s35 offen offset:512 sc1
    v_lshlrev_b32_sdwa v88, 3, v122 dst_sel:DWORD dst_unused:UNUSED_PAD src0_sel:DWORD src1_sel:WORD_0
    v_lshlrev_b32_sdwa v90, 3, v122 dst_sel:DWORD dst_unused:UNUSED_PAD src0_sel:DWORD src1_sel:WORD_1
    ds_read_b64 v[88:89], v88
    ds_read_b64 v[90:91], v90
    v_lshlrev_b32_sdwa v92, 3, v123 dst_sel:DWORD dst_unused:UNUSED_PAD src0_sel:DWORD src1_sel:WORD_0
    v_lshlrev_b32_sdwa v94, 3, v123 dst_sel:DWORD dst_unused:UNUSED_PAD src0_sel:DWORD src1_sel:WORD_1
    ds_read_b64 v[92:93], v92
    ds_read_b64 v[94:95], v94
    buffer_load_dwordx4 v[120:123], v69, s[12:15], s45 offen offset:0 sc1
    s_waitcnt lgkmcnt(8)
    v_smfmac_f32_16x16x64_bf16 v[28:31], v[64:67], v[96:103], v68
    v_exp_f32 v161, v161
    v_pk_fma_f32 v[158:159], v[158:159], v[134:135], v[134:135]
    v_pk_mul_f32 v[166:167], v[18:19], v[18:19]
    v_rcp_f32 v158, v158
    v_pk_fma_f32 v[160:161], v[160:161], v[136:137], v[136:137]
    v_pk_fma_f32 v[166:167], v[166:167], v[128:129], v[130:131]
    v_rcp_f32 v159, v159
    v_pk_mul_f32 v[166:167], v[166:167], v[18:19]
    s_waitcnt vmcnt(4)
    v_lshlrev_b32_sdwa v96, 3, v124 dst_sel:DWORD dst_unused:UNUSED_PAD src0_sel:DWORD src1_sel:WORD_0
    v_lshlrev_b32_sdwa v98, 3, v124 dst_sel:DWORD dst_unused:UNUSED_PAD src0_sel:DWORD src1_sel:WORD_1
    ds_read_b64 v[96:97], v96
    ds_read_b64 v[98:99], v98
    v_lshlrev_b32_sdwa v100, 3, v125 dst_sel:DWORD dst_unused:UNUSED_PAD src0_sel:DWORD src1_sel:WORD_0
    v_lshlrev_b32_sdwa v102, 3, v125 dst_sel:DWORD dst_unused:UNUSED_PAD src0_sel:DWORD src1_sel:WORD_1
    ds_read_b64 v[100:101], v100
    ds_read_b64 v[102:103], v102
    s_waitcnt lgkmcnt(8)
    v_smfmac_f32_16x16x64_bf16 v[24:27], v[64:67], v[104:111], v68
    v_rcp_f32 v160, v160
    v_pk_mul_f32 v[162:163], v[12:13], v[158:159]
    v_pk_mul_f32 v[170:171], v[20:21], v[20:21]
    v_rcp_f32 v161, v161
    v_pk_fma_f32 v[170:171], v[170:171], v[128:129], v[130:131]
    v_pk_mul_f32 v[172:173], v[22:23], v[22:23]
    v_exp_f32 v164, v164
    v_pk_fma_f32 v[162:163], v[14:15], v[160:161], v[162:163]
    v_lshlrev_b32_sdwa v104, 3, v126 dst_sel:DWORD dst_unused:UNUSED_PAD src0_sel:DWORD src1_sel:WORD_0
    v_lshlrev_b32_sdwa v106, 3, v126 dst_sel:DWORD dst_unused:UNUSED_PAD src0_sel:DWORD src1_sel:WORD_1
    ds_read_b64 v[104:105], v104
    ds_read_b64 v[106:107], v106
    v_lshlrev_b32_sdwa v108, 3, v127 dst_sel:DWORD dst_unused:UNUSED_PAD src0_sel:DWORD src1_sel:WORD_0
    v_lshlrev_b32_sdwa v110, 3, v127 dst_sel:DWORD dst_unused:UNUSED_PAD src0_sel:DWORD src1_sel:WORD_1
    ds_read_b64 v[108:109], v108
    ds_read_b64 v[110:111], v110
    buffer_load_dwordx4 v[124:127], v69, s[12:15], s20 offen offset:1024 sc1
    s_waitcnt lgkmcnt(8)
    v_smfmac_f32_16x16x64_bf16 v[28:31], v[64:67], v[88:95], v68
    s_setprio 2
    v_exp_f32 v165, v165
    v_add_f32 v162, v162, v163
    v_pk_mul_f32 v[170:171], v[170:171], v[20:21]
    v_exp_f32 v166, v166
    buffer_store_dword v162, v70, s[12:15], s35 offen offset:640 sc1
    v_pk_fma_f32 v[164:165], v[164:165], v[134:135], v[134:135]
    v_exp_f32 v167, v167
    v_pk_fma_f32 v[172:173], v[172:173], v[128:129], v[130:131]
    s_waitcnt vmcnt(4)
    v_lshlrev_b32_sdwa v88, 3, v116 dst_sel:DWORD dst_unused:UNUSED_PAD src0_sel:DWORD src1_sel:WORD_0
    v_lshlrev_b32_sdwa v90, 3, v116 dst_sel:DWORD dst_unused:UNUSED_PAD src0_sel:DWORD src1_sel:WORD_1
    ds_read_b64 v[88:89], v88
    ds_read_b64 v[90:91], v90
    v_lshlrev_b32_sdwa v92, 3, v117 dst_sel:DWORD dst_unused:UNUSED_PAD src0_sel:DWORD src1_sel:WORD_0
    v_lshlrev_b32_sdwa v94, 3, v117 dst_sel:DWORD dst_unused:UNUSED_PAD src0_sel:DWORD src1_sel:WORD_1
    ds_read_b64 v[92:93], v92
    ds_read_b64 v[94:95], v94
    s_waitcnt lgkmcnt(8)
    v_smfmac_f32_16x16x64_bf16 v[32:35], v[64:67], v[96:103], v68
    v_rcp_f32 v164, v164
    v_pk_fma_f32 v[166:167], v[166:167], v[136:137], v[136:137]
    v_pk_mul_f32 v[172:173], v[172:173], v[22:23]
    v_rcp_f32 v165, v165
    v_pk_mul_f32 v[140:141], v[24:25], v[24:25]
    v_pk_mul_f32 v[142:143], v[26:27], v[26:27]
    v_rcp_f32 v166, v166
    v_pk_mul_f32 v[168:169], v[16:17], v[164:165]
    v_lshlrev_b32_sdwa v96, 3, v118 dst_sel:DWORD dst_unused:UNUSED_PAD src0_sel:DWORD src1_sel:WORD_0
    v_lshlrev_b32_sdwa v98, 3, v118 dst_sel:DWORD dst_unused:UNUSED_PAD src0_sel:DWORD src1_sel:WORD_1
    ds_read_b64 v[96:97], v96
    ds_read_b64 v[98:99], v98
    v_lshlrev_b32_sdwa v100, 3, v119 dst_sel:DWORD dst_unused:UNUSED_PAD src0_sel:DWORD src1_sel:WORD_0
    v_lshlrev_b32_sdwa v102, 3, v119 dst_sel:DWORD dst_unused:UNUSED_PAD src0_sel:DWORD src1_sel:WORD_1
    ds_read_b64 v[100:101], v100
    ds_read_b64 v[102:103], v102
    buffer_load_dwordx4 v[116:119], v69, s[12:15], s41 offen offset:1024 sc1
    s_waitcnt lgkmcnt(8)
    v_smfmac_f32_16x16x64_bf16 v[36:39], v[64:67], v[104:111], v68
    v_rcp_f32 v167, v167
    v_pk_fma_f32 v[140:141], v[140:141], v[128:129], v[130:131]
    v_pk_fma_f32 v[142:143], v[142:143], v[128:129], v[130:131]
    v_exp_f32 v170, v170
    v_pk_fma_f32 v[168:169], v[18:19], v[166:167], v[168:169]
    v_pk_mul_f32 v[140:141], v[140:141], v[24:25]
    v_exp_f32 v171, v171
    v_add_f32 v168, v168, v169
    s_waitcnt vmcnt(3)
    v_lshlrev_b32_sdwa v104, 3, v120 dst_sel:DWORD dst_unused:UNUSED_PAD src0_sel:DWORD src1_sel:WORD_0
    v_lshlrev_b32_sdwa v106, 3, v120 dst_sel:DWORD dst_unused:UNUSED_PAD src0_sel:DWORD src1_sel:WORD_1
    ds_read_b64 v[104:105], v104
    ds_read_b64 v[106:107], v106
    v_lshlrev_b32_sdwa v108, 3, v121 dst_sel:DWORD dst_unused:UNUSED_PAD src0_sel:DWORD src1_sel:WORD_0
    v_lshlrev_b32_sdwa v110, 3, v121 dst_sel:DWORD dst_unused:UNUSED_PAD src0_sel:DWORD src1_sel:WORD_1
    ds_read_b64 v[108:109], v108
    ds_read_b64 v[110:111], v110
    s_waitcnt lgkmcnt(8)
    v_smfmac_f32_16x16x64_bf16 v[32:35], v[64:67], v[88:95], v68
    v_exp_f32 v172, v172
    buffer_store_dword v168, v70, s[12:15], s35 offen offset:1024 sc1
    v_pk_fma_f32 v[170:171], v[170:171], v[134:135], v[134:135]
    v_exp_f32 v173, v173
    v_pk_mul_f32 v[142:143], v[142:143], v[26:27]
    v_pk_mul_f32 v[146:147], v[28:29], v[28:29]
    v_rcp_f32 v170, v170
    v_pk_fma_f32 v[172:173], v[172:173], v[136:137], v[136:137]
    v_lshlrev_b32_sdwa v88, 3, v122 dst_sel:DWORD dst_unused:UNUSED_PAD src0_sel:DWORD src1_sel:WORD_0
    v_lshlrev_b32_sdwa v90, 3, v122 dst_sel:DWORD dst_unused:UNUSED_PAD src0_sel:DWORD src1_sel:WORD_1
    ds_read_b64 v[88:89], v88
    ds_read_b64 v[90:91], v90
    v_lshlrev_b32_sdwa v92, 3, v123 dst_sel:DWORD dst_unused:UNUSED_PAD src0_sel:DWORD src1_sel:WORD_0
    v_lshlrev_b32_sdwa v94, 3, v123 dst_sel:DWORD dst_unused:UNUSED_PAD src0_sel:DWORD src1_sel:WORD_1
    ds_read_b64 v[92:93], v92
    ds_read_b64 v[94:95], v94
    buffer_load_dwordx4 v[120:123], v69, s[12:15], s45 offen offset:1024 sc1
    s_waitcnt lgkmcnt(8)
    v_smfmac_f32_16x16x64_bf16 v[36:39], v[64:67], v[96:103], v68
    v_rcp_f32 v171, v171
    v_pk_fma_f32 v[146:147], v[146:147], v[128:129], v[130:131]
    v_pk_mul_f32 v[148:149], v[30:31], v[30:31]
    v_rcp_f32 v172, v172
    v_pk_mul_f32 v[174:175], v[20:21], v[170:171]
    v_pk_mul_f32 v[146:147], v[146:147], v[28:29]
    v_rcp_f32 v173, v173
    v_pk_fma_f32 v[148:149], v[148:149], v[128:129], v[130:131]
    s_waitcnt vmcnt(4)
    v_lshlrev_b32_sdwa v96, 3, v124 dst_sel:DWORD dst_unused:UNUSED_PAD src0_sel:DWORD src1_sel:WORD_0
    v_lshlrev_b32_sdwa v98, 3, v124 dst_sel:DWORD dst_unused:UNUSED_PAD src0_sel:DWORD src1_sel:WORD_1
    ds_read_b64 v[96:97], v96
    ds_read_b64 v[98:99], v98
    v_lshlrev_b32_sdwa v100, 3, v125 dst_sel:DWORD dst_unused:UNUSED_PAD src0_sel:DWORD src1_sel:WORD_0
    v_lshlrev_b32_sdwa v102, 3, v125 dst_sel:DWORD dst_unused:UNUSED_PAD src0_sel:DWORD src1_sel:WORD_1
    ds_read_b64 v[100:101], v100
    ds_read_b64 v[102:103], v102
    s_waitcnt lgkmcnt(8)
    v_smfmac_f32_16x16x64_bf16 v[32:35], v[64:67], v[104:111], v68
    v_exp_f32 v140, v140
    v_pk_fma_f32 v[174:175], v[22:23], v[172:173], v[174:175]
    v_pk_mul_f32 v[148:149], v[148:149], v[30:31]
    v_exp_f32 v141, v141
    v_add_f32 v174, v174, v175
    v_exp_f32 v142, v142
    buffer_store_dword v174, v70, s[12:15], s35 offen offset:1152 sc1
    v_pk_fma_f32 v[140:141], v[140:141], v[134:135], v[134:135]
    v_lshlrev_b32_sdwa v104, 3, v126 dst_sel:DWORD dst_unused:UNUSED_PAD src0_sel:DWORD src1_sel:WORD_0
    v_lshlrev_b32_sdwa v106, 3, v126 dst_sel:DWORD dst_unused:UNUSED_PAD src0_sel:DWORD src1_sel:WORD_1
    ds_read_b64 v[104:105], v104
    ds_read_b64 v[106:107], v106
    v_lshlrev_b32_sdwa v108, 3, v127 dst_sel:DWORD dst_unused:UNUSED_PAD src0_sel:DWORD src1_sel:WORD_0
    v_lshlrev_b32_sdwa v110, 3, v127 dst_sel:DWORD dst_unused:UNUSED_PAD src0_sel:DWORD src1_sel:WORD_1
    ds_read_b64 v[108:109], v108
    ds_read_b64 v[110:111], v110
    buffer_load_dwordx4 v[124:127], v69, s[12:15], s20 offen offset:2048 sc1
    s_waitcnt lgkmcnt(8)
    v_smfmac_f32_16x16x64_bf16 v[36:39], v[64:67], v[88:95], v68
    v_rcp_f32 v140, v140
    v_pk_mul_f32 v[152:153], v[32:33], v[32:33]
    v_pk_mul_f32 v[154:155], v[34:35], v[34:35]
    v_rcp_f32 v141, v141
    v_pk_fma_f32 v[152:153], v[152:153], v[128:129], v[130:131]
    v_pk_fma_f32 v[154:155], v[154:155], v[128:129], v[130:131]
    v_exp_f32 v143, v143
    v_pk_mul_f32 v[144:145], v[24:25], v[140:141]
    s_waitcnt vmcnt(4)
    v_lshlrev_b32_sdwa v88, 3, v116 dst_sel:DWORD dst_unused:UNUSED_PAD src0_sel:DWORD src1_sel:WORD_0
    v_lshlrev_b32_sdwa v90, 3, v116 dst_sel:DWORD dst_unused:UNUSED_PAD src0_sel:DWORD src1_sel:WORD_1
    ds_read_b64 v[88:89], v88
    ds_read_b64 v[90:91], v90
    v_lshlrev_b32_sdwa v92, 3, v117 dst_sel:DWORD dst_unused:UNUSED_PAD src0_sel:DWORD src1_sel:WORD_0
    v_lshlrev_b32_sdwa v94, 3, v117 dst_sel:DWORD dst_unused:UNUSED_PAD src0_sel:DWORD src1_sel:WORD_1
    ds_read_b64 v[92:93], v92
    ds_read_b64 v[94:95], v94
    s_waitcnt lgkmcnt(8)
    v_smfmac_f32_16x16x64_bf16 v[40:43], v[64:67], v[96:103], v68
    v_exp_f32 v146, v146
    v_pk_fma_f32 v[142:143], v[142:143], v[136:137], v[136:137]
    v_pk_mul_f32 v[152:153], v[152:153], v[32:33]
    v_rcp_f32 v142, v142
    v_pk_mul_f32 v[154:155], v[154:155], v[34:35]
    v_pk_mul_f32 v[158:159], v[36:37], v[36:37]
    v_rcp_f32 v143, v143
    v_pk_fma_f32 v[158:159], v[158:159], v[128:129], v[130:131]
    v_lshlrev_b32_sdwa v96, 3, v118 dst_sel:DWORD dst_unused:UNUSED_PAD src0_sel:DWORD src1_sel:WORD_0
    v_lshlrev_b32_sdwa v98, 3, v118 dst_sel:DWORD dst_unused:UNUSED_PAD src0_sel:DWORD src1_sel:WORD_1
    ds_read_b64 v[96:97], v96
    ds_read_b64 v[98:99], v98
    v_lshlrev_b32_sdwa v100, 3, v119 dst_sel:DWORD dst_unused:UNUSED_PAD src0_sel:DWORD src1_sel:WORD_0
    v_lshlrev_b32_sdwa v102, 3, v119 dst_sel:DWORD dst_unused:UNUSED_PAD src0_sel:DWORD src1_sel:WORD_1
    ds_read_b64 v[100:101], v100
    ds_read_b64 v[102:103], v102
    buffer_load_dwordx4 v[116:119], v69, s[12:15], s41 offen offset:2048 sc1
    s_waitcnt lgkmcnt(8)
    v_smfmac_f32_16x16x64_bf16 v[44:47], v[64:67], v[104:111], v68
    v_exp_f32 v147, v147
    v_pk_fma_f32 v[144:145], v[26:27], v[142:143], v[144:145]
    v_pk_mul_f32 v[158:159], v[158:159], v[36:37]
    v_exp_f32 v148, v148
    v_add_f32 v144, v144, v145
    v_pk_fma_f32 v[146:147], v[146:147], v[134:135], v[134:135]
    v_exp_f32 v149, v149
    buffer_store_dword v144, v70, s[12:15], s35 offen offset:1536 sc1
    s_waitcnt vmcnt(4)
    v_lshlrev_b32_sdwa v104, 3, v120 dst_sel:DWORD dst_unused:UNUSED_PAD src0_sel:DWORD src1_sel:WORD_0
    v_lshlrev_b32_sdwa v106, 3, v120 dst_sel:DWORD dst_unused:UNUSED_PAD src0_sel:DWORD src1_sel:WORD_1
    ds_read_b64 v[104:105], v104
    ds_read_b64 v[106:107], v106
    v_lshlrev_b32_sdwa v108, 3, v121 dst_sel:DWORD dst_unused:UNUSED_PAD src0_sel:DWORD src1_sel:WORD_0
    v_lshlrev_b32_sdwa v110, 3, v121 dst_sel:DWORD dst_unused:UNUSED_PAD src0_sel:DWORD src1_sel:WORD_1
    ds_read_b64 v[108:109], v108
    ds_read_b64 v[110:111], v110
    s_waitcnt lgkmcnt(8)
    v_smfmac_f32_16x16x64_bf16 v[40:43], v[64:67], v[88:95], v68
    v_rcp_f32 v146, v146
    v_pk_fma_f32 v[148:149], v[148:149], v[136:137], v[136:137]
    v_pk_mul_f32 v[160:161], v[38:39], v[38:39]
    v_rcp_f32 v147, v147
    v_pk_fma_f32 v[160:161], v[160:161], v[128:129], v[130:131]
    v_rcp_f32 v148, v148
    v_pk_mul_f32 v[150:151], v[28:29], v[146:147]
    v_pk_mul_f32 v[160:161], v[160:161], v[38:39]
    v_lshlrev_b32_sdwa v88, 3, v122 dst_sel:DWORD dst_unused:UNUSED_PAD src0_sel:DWORD src1_sel:WORD_0
    v_lshlrev_b32_sdwa v90, 3, v122 dst_sel:DWORD dst_unused:UNUSED_PAD src0_sel:DWORD src1_sel:WORD_1
    ds_read_b64 v[88:89], v88
    ds_read_b64 v[90:91], v90
    v_lshlrev_b32_sdwa v92, 3, v123 dst_sel:DWORD dst_unused:UNUSED_PAD src0_sel:DWORD src1_sel:WORD_0
    v_lshlrev_b32_sdwa v94, 3, v123 dst_sel:DWORD dst_unused:UNUSED_PAD src0_sel:DWORD src1_sel:WORD_1
    ds_read_b64 v[92:93], v92
    ds_read_b64 v[94:95], v94
    buffer_load_dwordx4 v[120:123], v69, s[12:15], s45 offen offset:2048 sc1
    s_waitcnt lgkmcnt(8)
    v_smfmac_f32_16x16x64_bf16 v[44:47], v[64:67], v[96:103], v68
    s_setprio 1
    v_rcp_f32 v149, v149
    v_exp_f32 v152, v152
    v_exp_f32 v153, v153
    v_pk_fma_f32 v[150:151], v[30:31], v[148:149], v[150:151]
    v_exp_f32 v154, v154
    v_add_f32 v150, v150, v151
    v_pk_fma_f32 v[152:153], v[152:153], v[134:135], v[134:135]
    v_exp_f32 v155, v155
    s_waitcnt vmcnt(3)
    v_lshlrev_b32_sdwa v96, 3, v124 dst_sel:DWORD dst_unused:UNUSED_PAD src0_sel:DWORD src1_sel:WORD_0
    v_lshlrev_b32_sdwa v98, 3, v124 dst_sel:DWORD dst_unused:UNUSED_PAD src0_sel:DWORD src1_sel:WORD_1
    ds_read_b64 v[96:97], v96
    ds_read_b64 v[98:99], v98
    v_lshlrev_b32_sdwa v100, 3, v125 dst_sel:DWORD dst_unused:UNUSED_PAD src0_sel:DWORD src1_sel:WORD_0
    v_lshlrev_b32_sdwa v102, 3, v125 dst_sel:DWORD dst_unused:UNUSED_PAD src0_sel:DWORD src1_sel:WORD_1
    ds_read_b64 v[100:101], v100
    ds_read_b64 v[102:103], v102
    s_waitcnt lgkmcnt(8)
    v_smfmac_f32_16x16x64_bf16 v[40:43], v[64:67], v[104:111], v68
    v_rcp_f32 v152, v152
    buffer_store_dword v150, v70, s[12:15], s35 offen offset:1664 sc1
    v_pk_fma_f32 v[154:155], v[154:155], v[136:137], v[136:137]
    v_rcp_f32 v153, v153
    v_rcp_f32 v154, v154
    v_rcp_f32 v155, v155
    v_pk_mul_f32 v[156:157], v[32:33], v[152:153]
    v_exp_f32 v158, v158
    v_lshlrev_b32_sdwa v104, 3, v126 dst_sel:DWORD dst_unused:UNUSED_PAD src0_sel:DWORD src1_sel:WORD_0
    v_lshlrev_b32_sdwa v106, 3, v126 dst_sel:DWORD dst_unused:UNUSED_PAD src0_sel:DWORD src1_sel:WORD_1
    ds_read_b64 v[104:105], v104
    ds_read_b64 v[106:107], v106
    v_lshlrev_b32_sdwa v108, 3, v127 dst_sel:DWORD dst_unused:UNUSED_PAD src0_sel:DWORD src1_sel:WORD_0
    v_lshlrev_b32_sdwa v110, 3, v127 dst_sel:DWORD dst_unused:UNUSED_PAD src0_sel:DWORD src1_sel:WORD_1
    ds_read_b64 v[108:109], v108
    ds_read_b64 v[110:111], v110
    buffer_load_dwordx4 v[124:127], v69, s[12:15], s20 offen offset:3072 sc1
    s_waitcnt lgkmcnt(8)
    v_smfmac_f32_16x16x64_bf16 v[44:47], v[64:67], v[88:95], v68
    v_exp_f32 v159, v159
    v_pk_fma_f32 v[156:157], v[34:35], v[154:155], v[156:157]
    v_pk_mul_f32 v[164:165], v[40:41], v[40:41]
    v_exp_f32 v160, v160
    v_add_f32 v156, v156, v157
    v_pk_fma_f32 v[158:159], v[158:159], v[134:135], v[134:135]
    v_exp_f32 v161, v161
    buffer_store_dword v156, v70, s[12:15], s35 offen offset:2048 sc1
    s_waitcnt vmcnt(5)
    v_lshlrev_b32_sdwa v88, 3, v116 dst_sel:DWORD dst_unused:UNUSED_PAD src0_sel:DWORD src1_sel:WORD_0
    v_lshlrev_b32_sdwa v90, 3, v116 dst_sel:DWORD dst_unused:UNUSED_PAD src0_sel:DWORD src1_sel:WORD_1
    ds_read_b64 v[88:89], v88
    ds_read_b64 v[90:91], v90
    v_lshlrev_b32_sdwa v92, 3, v117 dst_sel:DWORD dst_unused:UNUSED_PAD src0_sel:DWORD src1_sel:WORD_0
    v_lshlrev_b32_sdwa v94, 3, v117 dst_sel:DWORD dst_unused:UNUSED_PAD src0_sel:DWORD src1_sel:WORD_1
    ds_read_b64 v[92:93], v92
    ds_read_b64 v[94:95], v94
    s_waitcnt lgkmcnt(8)
    v_smfmac_f32_16x16x64_bf16 v[48:51], v[64:67], v[96:103], v68
    v_rcp_f32 v158, v158
    v_pk_fma_f32 v[160:161], v[160:161], v[136:137], v[136:137]
    v_pk_fma_f32 v[164:165], v[164:165], v[128:129], v[130:131]
    v_rcp_f32 v159, v159
    v_pk_mul_f32 v[164:165], v[164:165], v[40:41]
    v_pk_mul_f32 v[166:167], v[42:43], v[42:43]
    v_rcp_f32 v160, v160
    v_pk_mul_f32 v[162:163], v[36:37], v[158:159]
    v_lshlrev_b32_sdwa v96, 3, v118 dst_sel:DWORD dst_unused:UNUSED_PAD src0_sel:DWORD src1_sel:WORD_0
    v_lshlrev_b32_sdwa v98, 3, v118 dst_sel:DWORD dst_unused:UNUSED_PAD src0_sel:DWORD src1_sel:WORD_1
    ds_read_b64 v[96:97], v96
    ds_read_b64 v[98:99], v98
    v_lshlrev_b32_sdwa v100, 3, v119 dst_sel:DWORD dst_unused:UNUSED_PAD src0_sel:DWORD src1_sel:WORD_0
    v_lshlrev_b32_sdwa v102, 3, v119 dst_sel:DWORD dst_unused:UNUSED_PAD src0_sel:DWORD src1_sel:WORD_1
    ds_read_b64 v[100:101], v100
    ds_read_b64 v[102:103], v102
    buffer_load_dwordx4 v[116:119], v69, s[12:15], s41 offen offset:3072 sc1
    s_waitcnt lgkmcnt(8)
    v_smfmac_f32_16x16x64_bf16 v[52:55], v[64:67], v[104:111], v68
    v_rcp_f32 v161, v161
    v_pk_fma_f32 v[166:167], v[166:167], v[128:129], v[130:131]
    v_pk_mul_f32 v[170:171], v[44:45], v[44:45]
    v_exp_f32 v164, v164
    v_pk_fma_f32 v[162:163], v[38:39], v[160:161], v[162:163]
    v_pk_mul_f32 v[166:167], v[166:167], v[42:43]
    v_exp_f32 v165, v165
    v_add_f32 v162, v162, v163
    s_waitcnt vmcnt(4)
    v_lshlrev_b32_sdwa v104, 3, v120 dst_sel:DWORD dst_unused:UNUSED_PAD src0_sel:DWORD src1_sel:WORD_0
    v_lshlrev_b32_sdwa v106, 3, v120 dst_sel:DWORD dst_unused:UNUSED_PAD src0_sel:DWORD src1_sel:WORD_1
    ds_read_b64 v[104:105], v104
    ds_read_b64 v[106:107], v106
    v_lshlrev_b32_sdwa v108, 3, v121 dst_sel:DWORD dst_unused:UNUSED_PAD src0_sel:DWORD src1_sel:WORD_0
    v_lshlrev_b32_sdwa v110, 3, v121 dst_sel:DWORD dst_unused:UNUSED_PAD src0_sel:DWORD src1_sel:WORD_1
    ds_read_b64 v[108:109], v108
    ds_read_b64 v[110:111], v110
    s_waitcnt lgkmcnt(8)
    v_smfmac_f32_16x16x64_bf16 v[48:51], v[64:67], v[88:95], v68
    v_exp_f32 v166, v166
    buffer_store_dword v162, v70, s[12:15], s35 offen offset:2176 sc1
    v_pk_fma_f32 v[164:165], v[164:165], v[134:135], v[134:135]
    v_exp_f32 v167, v167
    v_pk_fma_f32 v[170:171], v[170:171], v[128:129], v[130:131]
    v_pk_mul_f32 v[172:173], v[46:47], v[46:47]
    v_rcp_f32 v164, v164
    v_pk_fma_f32 v[166:167], v[166:167], v[136:137], v[136:137]
    v_lshlrev_b32_sdwa v88, 3, v122 dst_sel:DWORD dst_unused:UNUSED_PAD src0_sel:DWORD src1_sel:WORD_0
    v_lshlrev_b32_sdwa v90, 3, v122 dst_sel:DWORD dst_unused:UNUSED_PAD src0_sel:DWORD src1_sel:WORD_1
    ds_read_b64 v[88:89], v88
    ds_read_b64 v[90:91], v90
    v_lshlrev_b32_sdwa v92, 3, v123 dst_sel:DWORD dst_unused:UNUSED_PAD src0_sel:DWORD src1_sel:WORD_0
    v_lshlrev_b32_sdwa v94, 3, v123 dst_sel:DWORD dst_unused:UNUSED_PAD src0_sel:DWORD src1_sel:WORD_1
    ds_read_b64 v[92:93], v92
    ds_read_b64 v[94:95], v94
    buffer_load_dwordx4 v[120:123], v69, s[12:15], s45 offen offset:3072 sc1
    s_waitcnt lgkmcnt(8)
    v_smfmac_f32_16x16x64_bf16 v[52:55], v[64:67], v[96:103], v68
    v_rcp_f32 v165, v165
    v_pk_mul_f32 v[170:171], v[170:171], v[44:45]
    v_pk_fma_f32 v[172:173], v[172:173], v[128:129], v[130:131]
    v_rcp_f32 v166, v166
    v_pk_mul_f32 v[168:169], v[40:41], v[164:165]
    v_pk_mul_f32 v[172:173], v[172:173], v[46:47]
    v_rcp_f32 v167, v167
    v_exp_f32 v170, v170
    s_waitcnt vmcnt(4)
    v_lshlrev_b32_sdwa v96, 3, v124 dst_sel:DWORD dst_unused:UNUSED_PAD src0_sel:DWORD src1_sel:WORD_0
    v_lshlrev_b32_sdwa v98, 3, v124 dst_sel:DWORD dst_unused:UNUSED_PAD src0_sel:DWORD src1_sel:WORD_1
    ds_read_b64 v[96:97], v96
    ds_read_b64 v[98:99], v98
    v_lshlrev_b32_sdwa v100, 3, v125 dst_sel:DWORD dst_unused:UNUSED_PAD src0_sel:DWORD src1_sel:WORD_0
    v_lshlrev_b32_sdwa v102, 3, v125 dst_sel:DWORD dst_unused:UNUSED_PAD src0_sel:DWORD src1_sel:WORD_1
    ds_read_b64 v[100:101], v100
    ds_read_b64 v[102:103], v102
    s_waitcnt lgkmcnt(8)
    v_smfmac_f32_16x16x64_bf16 v[48:51], v[64:67], v[104:111], v68
    v_exp_f32 v171, v171
    v_pk_fma_f32 v[168:169], v[42:43], v[166:167], v[168:169]
    v_exp_f32 v172, v172
    v_add_f32 v168, v168, v169
    v_pk_fma_f32 v[170:171], v[170:171], v[134:135], v[134:135]
    v_exp_f32 v173, v173
    buffer_store_dword v168, v70, s[12:15], s35 offen offset:2560 sc1
    v_rcp_f32 v170, v170
    v_lshlrev_b32_sdwa v104, 3, v126 dst_sel:DWORD dst_unused:UNUSED_PAD src0_sel:DWORD src1_sel:WORD_0
    v_lshlrev_b32_sdwa v106, 3, v126 dst_sel:DWORD dst_unused:UNUSED_PAD src0_sel:DWORD src1_sel:WORD_1
    ds_read_b64 v[104:105], v104
    ds_read_b64 v[106:107], v106
    v_lshlrev_b32_sdwa v108, 3, v127 dst_sel:DWORD dst_unused:UNUSED_PAD src0_sel:DWORD src1_sel:WORD_0
    v_lshlrev_b32_sdwa v110, 3, v127 dst_sel:DWORD dst_unused:UNUSED_PAD src0_sel:DWORD src1_sel:WORD_1
    ds_read_b64 v[108:109], v108
    ds_read_b64 v[110:111], v110
    s_waitcnt lgkmcnt(8)
    v_smfmac_f32_16x16x64_bf16 v[52:55], v[64:67], v[88:95], v68
    s_setprio 0
    v_rcp_f32 v171, v171
    v_pk_fma_f32 v[172:173], v[172:173], v[136:137], v[136:137]
    v_pk_mul_f32 v[140:141], v[48:49], v[48:49]
    v_rcp_f32 v172, v172
    v_pk_mul_f32 v[174:175], v[44:45], v[170:171]
    v_pk_fma_f32 v[140:141], v[140:141], v[128:129], v[130:131]
    v_rcp_f32 v173, v173
    v_pk_mul_f32 v[140:141], v[140:141], v[48:49]
    s_waitcnt vmcnt(3)
    v_lshlrev_b32_sdwa v88, 3, v116 dst_sel:DWORD dst_unused:UNUSED_PAD src0_sel:DWORD src1_sel:WORD_0
    v_lshlrev_b32_sdwa v90, 3, v116 dst_sel:DWORD dst_unused:UNUSED_PAD src0_sel:DWORD src1_sel:WORD_1
    ds_read_b64 v[88:89], v88
    ds_read_b64 v[90:91], v90
    v_lshlrev_b32_sdwa v92, 3, v117 dst_sel:DWORD dst_unused:UNUSED_PAD src0_sel:DWORD src1_sel:WORD_0
    v_lshlrev_b32_sdwa v94, 3, v117 dst_sel:DWORD dst_unused:UNUSED_PAD src0_sel:DWORD src1_sel:WORD_1
    ds_read_b64 v[92:93], v92
    ds_read_b64 v[94:95], v94
    s_waitcnt lgkmcnt(8)
    v_smfmac_f32_16x16x64_bf16 v[56:59], v[64:67], v[96:103], v68
    v_exp_f32 v140, v140
    v_pk_fma_f32 v[174:175], v[46:47], v[172:173], v[174:175]
    v_pk_mul_f32 v[142:143], v[50:51], v[50:51]
    v_exp_f32 v141, v141
    v_add_f32 v174, v174, v175
    v_pk_fma_f32 v[142:143], v[142:143], v[128:129], v[130:131]
    buffer_store_dword v174, v70, s[12:15], s35 offen offset:2688 sc1
    v_pk_fma_f32 v[140:141], v[140:141], v[134:135], v[134:135]
    v_lshlrev_b32_sdwa v96, 3, v118 dst_sel:DWORD dst_unused:UNUSED_PAD src0_sel:DWORD src1_sel:WORD_0
    v_lshlrev_b32_sdwa v98, 3, v118 dst_sel:DWORD dst_unused:UNUSED_PAD src0_sel:DWORD src1_sel:WORD_1
    ds_read_b64 v[96:97], v96
    ds_read_b64 v[98:99], v98
    v_lshlrev_b32_sdwa v100, 3, v119 dst_sel:DWORD dst_unused:UNUSED_PAD src0_sel:DWORD src1_sel:WORD_0
    v_lshlrev_b32_sdwa v102, 3, v119 dst_sel:DWORD dst_unused:UNUSED_PAD src0_sel:DWORD src1_sel:WORD_1
    ds_read_b64 v[100:101], v100
    ds_read_b64 v[102:103], v102
    s_waitcnt lgkmcnt(8)
    v_smfmac_f32_16x16x64_bf16 v[60:63], v[64:67], v[104:111], v68
    v_rcp_f32 v140, v140
    v_pk_mul_f32 v[142:143], v[142:143], v[50:51]
    v_pk_mul_f32 v[146:147], v[52:53], v[52:53]
    v_rcp_f32 v141, v141
    v_pk_fma_f32 v[146:147], v[146:147], v[128:129], v[130:131]
    v_pk_mul_f32 v[148:149], v[54:55], v[54:55]
    v_exp_f32 v142, v142
    v_pk_mul_f32 v[144:145], v[48:49], v[140:141]
    s_waitcnt vmcnt(2)
    v_lshlrev_b32_sdwa v104, 3, v120 dst_sel:DWORD dst_unused:UNUSED_PAD src0_sel:DWORD src1_sel:WORD_0
    v_lshlrev_b32_sdwa v106, 3, v120 dst_sel:DWORD dst_unused:UNUSED_PAD src0_sel:DWORD src1_sel:WORD_1
    ds_read_b64 v[104:105], v104
    ds_read_b64 v[106:107], v106
    v_lshlrev_b32_sdwa v108, 3, v121 dst_sel:DWORD dst_unused:UNUSED_PAD src0_sel:DWORD src1_sel:WORD_0
    v_lshlrev_b32_sdwa v110, 3, v121 dst_sel:DWORD dst_unused:UNUSED_PAD src0_sel:DWORD src1_sel:WORD_1
    ds_read_b64 v[108:109], v108
    ds_read_b64 v[110:111], v110
    s_waitcnt lgkmcnt(8)
    v_smfmac_f32_16x16x64_bf16 v[56:59], v[64:67], v[88:95], v68
    v_exp_f32 v143, v143
    v_pk_mul_f32 v[146:147], v[146:147], v[52:53]
    v_pk_fma_f32 v[148:149], v[148:149], v[128:129], v[130:131]
    v_exp_f32 v146, v146
    v_pk_fma_f32 v[142:143], v[142:143], v[136:137], v[136:137]
    v_pk_mul_f32 v[148:149], v[148:149], v[54:55]
    v_rcp_f32 v142, v142
    v_rcp_f32 v143, v143
    v_lshlrev_b32_sdwa v88, 3, v122 dst_sel:DWORD dst_unused:UNUSED_PAD src0_sel:DWORD src1_sel:WORD_0
    v_lshlrev_b32_sdwa v90, 3, v122 dst_sel:DWORD dst_unused:UNUSED_PAD src0_sel:DWORD src1_sel:WORD_1
    ds_read_b64 v[88:89], v88
    ds_read_b64 v[90:91], v90
    v_lshlrev_b32_sdwa v92, 3, v123 dst_sel:DWORD dst_unused:UNUSED_PAD src0_sel:DWORD src1_sel:WORD_0
    v_lshlrev_b32_sdwa v94, 3, v123 dst_sel:DWORD dst_unused:UNUSED_PAD src0_sel:DWORD src1_sel:WORD_1
    ds_read_b64 v[92:93], v92
    ds_read_b64 v[94:95], v94
    s_waitcnt lgkmcnt(8)
    v_smfmac_f32_16x16x64_bf16 v[60:63], v[64:67], v[96:103], v68
    v_exp_f32 v147, v147
    v_pk_fma_f32 v[144:145], v[50:51], v[142:143], v[144:145]
    v_exp_f32 v148, v148
    v_add_f32 v144, v144, v145
    v_pk_fma_f32 v[146:147], v[146:147], v[134:135], v[134:135]
    v_exp_f32 v149, v149
    buffer_store_dword v144, v70, s[12:15], s35 offen offset:3072 sc1
    v_rcp_f32 v146, v146
    s_waitcnt lgkmcnt(4)
    v_smfmac_f32_16x16x64_bf16 v[56:59], v[64:67], v[104:111], v68
    s_setprio 3
    v_rcp_f32 v147, v147
    v_pk_fma_f32 v[148:149], v[148:149], v[136:137], v[136:137]
    s_waitcnt lgkmcnt(0)
    v_smfmac_f32_16x16x64_bf16 v[60:63], v[64:67], v[88:95], v68
    v_rcp_f32 v148, v148
    v_pk_mul_f32 v[150:151], v[52:53], v[146:147]
    v_rcp_f32 v149, v149
    s_nop 0
    s_nop 0
    v_pk_fma_f32 v[150:151], v[54:55], v[148:149], v[150:151]
    s_nop 0
    v_add_f32 v150, v150, v151
    v_pk_mul_f32 v[152:153], v[56:57], v[56:57]
    buffer_store_dword v150, v70, s[12:15], s35 offen offset:3200 sc1
    v_pk_fma_f32 v[152:153], v[152:153], v[128:129], v[130:131]
    v_pk_mul_f32 v[154:155], v[58:59], v[58:59]
    v_pk_mul_f32 v[152:153], v[152:153], v[56:57]
    v_pk_fma_f32 v[154:155], v[154:155], v[128:129], v[130:131]
    v_exp_f32 v152, v152
    v_pk_mul_f32 v[154:155], v[154:155], v[58:59]
    v_pk_mul_f32 v[158:159], v[60:61], v[60:61]
    v_exp_f32 v153, v153
    v_pk_fma_f32 v[158:159], v[158:159], v[128:129], v[130:131]
    v_pk_mul_f32 v[160:161], v[62:63], v[62:63]
    v_exp_f32 v154, v154
    v_pk_fma_f32 v[152:153], v[152:153], v[134:135], v[134:135]
    v_pk_mul_f32 v[158:159], v[158:159], v[60:61]
    v_rcp_f32 v152, v152
    v_pk_fma_f32 v[160:161], v[160:161], v[128:129], v[130:131]
    v_rcp_f32 v153, v153
    v_pk_mul_f32 v[160:161], v[160:161], v[62:63]
    v_exp_f32 v155, v155
    v_pk_mul_f32 v[156:157], v[56:57], v[152:153]
    v_exp_f32 v158, v158
    v_pk_fma_f32 v[154:155], v[154:155], v[136:137], v[136:137]
    v_exp_f32 v159, v159
    v_rcp_f32 v154, v154
    v_rcp_f32 v155, v155
    v_pk_fma_f32 v[158:159], v[158:159], v[134:135], v[134:135]
    v_exp_f32 v160, v160
    v_pk_fma_f32 v[156:157], v[58:59], v[154:155], v[156:157]
    v_rcp_f32 v158, v158
    v_add_f32 v156, v156, v157
    v_rcp_f32 v159, v159
    buffer_store_dword v156, v70, s[12:15], s35 offen offset:3584 sc1
    v_exp_f32 v161, v161
    v_pk_mul_f32 v[162:163], v[60:61], v[158:159]
    s_nop 0
    v_pk_fma_f32 v[160:161], v[160:161], v[136:137], v[136:137]
    s_nop 0
    v_rcp_f32 v160, v160
    v_rcp_f32 v161, v161
    s_nop 0
    s_nop 0
    v_pk_fma_f32 v[162:163], v[62:63], v[160:161], v[162:163]
    s_nop 0
    v_add_f32 v162, v162, v163
    s_nop 0
    buffer_store_dword v162, v70, s[12:15], s35 offen offset:3712 sc1
standalone__deep_cross_pnn__recsys_kernel_red:

    v_and_b32 v193, 0xf0, v69
    v_lshrrev_b32 v197, 8, v69
    v_lshl_or_b32 v192, v197, 16, v193
    v_lshrrev_b32 v198, 1, v197
    v_and_b32 v197, 1, v197
    v_lshl_or_b32 v193, v198, 2, v193
    v_lshl_or_b32 v193, v197, 3, v193
    v_mov_b32 v196, 0
    s_mov_b32 s65, 0

    s_lshl_b32 s68, s2, 8
    s_add_u32 s66, s68, 29360128
    s_add_u32 s67, s66, 65536
    s_add_u32 s60, s68, 20971520
    s_lshr_b32 s68, s68, 1

    s_lshl_b32 s61, s3, 20
    s_add_u32 s60, s60, s61

    s_add_u32 s61, s60, 262144
    s_add_u32 s62, s60, 524288
    s_add_u32 s63, s60, 786432

    s_mov_b32 s76, s56
    s_and_b32 s77, s57, 0xffff
    s_mov_b32 s78, 2
    s_mov_b32 s79, 0x00020000
    s_mov_b32 s72, s58
    s_and_b32 s73, s59, 0xffff
    s_mov_b32 s74, 32768
    s_mov_b32 s75, 0x00020000
    s_mov_b64 s[20:21], -1
    s_mov_b64 s[22:23], -1
    s_mov_b64 s[24:25], -1
    s_mov_b64 s[26:27], -1
    s_mov_b64 s[28:29], -1

    v_mov_b32 v216, -1
    buffer_load_short_d16_hi v196, v196, s[76:79], 0 offen
    s_bitcmp1_b32 s64, 30
    s_cbranch_scc0 standalone__deep_cross_pnn__recsys_kernel_rd

standalone__deep_cross_pnn__recsys_kernel_rp:
    s_mov_b64 exec, s[20:21]
    buffer_load_dwordx4 v[176:179], v192, s[12:15], s60 offen sc1
    s_mov_b64 exec, s[22:23]
    buffer_load_dwordx4 v[180:183], v192, s[12:15], s61 offen sc1
    s_mov_b64 exec, s[24:25]
    buffer_load_dwordx4 v[184:187], v192, s[12:15], s62 offen sc1
    s_mov_b64 exec, s[26:27]
    buffer_load_dwordx4 v[188:191], v192, s[12:15], s63 offen sc1
    s_mov_b64 exec, s[28:29]
    buffer_load_dword v194, v193, s[12:15], s66 offen sc1
    buffer_load_dword v195, v193, s[12:15], s67 offen sc1
    s_mov_b64 exec, -1
    s_waitcnt vmcnt(4)
    v_add_f32 v216, v176, v180
    v_add_f32 v217, v177, v181
    v_add_f32 v218, v178, v182
    v_add_f32 v219, v179, v183
    s_waitcnt vmcnt(2)
    v_add_f32 v220, v184, v188
    v_add_f32 v221, v185, v189
    v_add_f32 v222, v186, v190
    v_add_f32 v223, v187, v191
    v_add_f32 v216, v216, v220
    v_add_f32 v217, v217, v221
    v_add_f32 v218, v218, v222
    v_add_f32 v219, v219, v223

    s_nop 0
    v_permlane32_swap_b32 v216, v217
    v_permlane32_swap_b32 v218, v219
    v_add_f32 v216, v216, v217
    v_add_f32 v218, v218, v219
    s_nop 1
    v_permlane16_swap_b32 v216, v218
    s_nop 0
    v_add_f32 v216, v216, v218

    s_waitcnt vmcnt(0)
    v_add_f32 v201, v194, v195
    s_add_u32 s65, s65, 1
    v_add_f32 v197, v201, v216
    v_cmp_u_f32 vcc, v197, v197
    s_cbranch_vccz standalone__deep_cross_pnn__recsys_kernel_rd

    v_cmp_u_f32 s[20:21], v176, v177
    v_cmp_u_f32 vcc, v178, v179
    s_or_b64 s[20:21], s[20:21], vcc

    v_cmp_u_f32 s[22:23], v180, v181
    v_cmp_u_f32 vcc, v182, v183
    s_or_b64 s[22:23], s[22:23], vcc

    v_cmp_u_f32 s[24:25], v184, v185
    v_cmp_u_f32 vcc, v186, v187
    s_or_b64 s[24:25], s[24:25], vcc

    v_cmp_u_f32 s[26:27], v188, v189
    v_cmp_u_f32 vcc, v190, v191
    s_or_b64 s[26:27], s[26:27], vcc

    v_cmp_u_f32 s[28:29], v194, v195

    s_cmp_lt_u32 s65, 300
    s_cbranch_scc1 standalone__deep_cross_pnn__recsys_kernel_rp
    v_mov_b32 v216, -1

standalone__deep_cross_pnn__recsys_kernel_rd:

    v_lshrrev_b32 v197, 2, v69
    s_lshl_b32 s69, s3, 8
    v_add_u32 v198, s69, v197
    ds_write_b32 v198, v216
    v_mov_b32 v199, 0
    s_waitcnt vmcnt(0) lgkmcnt(0)

    s_barrier
    s_cmp_eq_u32 s3, 1
    s_cbranch_scc1 standalone__deep_cross_pnn__recsys_kernel_rc
    s_cmp_lg_u32 s3, 0
    s_cbranch_scc1 standalone__deep_cross_pnn__recsys_kernel_end

    ds_read_b32 v208, v197 offset:0
    ds_read_b32 v209, v197 offset:256
    ds_read_b32 v210, v197 offset:512
    ds_read_b32 v211, v197 offset:768
    ds_read_b32 v212, v197 offset:1024
    ds_read_b32 v213, v197 offset:1280
    ds_read_b32 v214, v197 offset:1536
    ds_read_b32 v215, v197 offset:1792
    s_waitcnt lgkmcnt(6)
    v_add_f32 v200, v208, v209
    s_waitcnt lgkmcnt(5)
    v_add_f32 v200, v200, v210
    s_waitcnt lgkmcnt(4)
    v_add_f32 v200, v200, v211
    s_waitcnt lgkmcnt(3)
    v_add_f32 v200, v200, v212
    s_waitcnt lgkmcnt(2)
    v_add_f32 v200, v200, v213
    s_waitcnt lgkmcnt(1)
    v_add_f32 v200, v200, v214
    s_waitcnt lgkmcnt(0)
    v_add_f32 v200, v200, v215

    v_cmp_u_f32 vcc, v200, v200
    s_cbranch_vccnz standalone__deep_cross_pnn__recsys_kernel_rf

    v_cvt_pk_bf16_f32 v197, v200, v201
    v_lshlrev_b32 v198, 16, v197
    v_and_b32 v197, 0xffff0000, v197
    v_add_f32 v198, v198, v196
    v_cvt_pk_bf16_f32 v198, v198, v198
    v_lshlrev_b32 v198, 16, v198
    v_add_f32 v198, v198, v197
    v_cvt_pk_bf16_f32 v198, v198, v198
    v_lshrrev_b32 v197, 1, v193
    buffer_store_short v198, v197, s[72:75], s68 offen

    s_endpgm
standalone__deep_cross_pnn__recsys_kernel_rf:

    s_lshr_b32 s69, s2, 5
    s_lshl_b32 s69, s69, 4
    s_lshl_b32 s70, 1, s2
    v_mov_b32 v198, s70
    s_mov_b64 exec, 1
    buffer_atomic_or v198, v199, s[52:55], s69 offen offset:136 sc0
    s_waitcnt vmcnt(0)

standalone__deep_cross_pnn__recsys_kernel_rc:

    s_mov_b64 exec, 0xff
    buffer_load_dwordx4 v[176:179], v69, s[52:55], 0 offen offset:128 sc1
    s_waitcnt vmcnt(0)
    v_cmp_ne_u32 vcc, 0, v178
    s_cbranch_vccz standalone__deep_cross_pnn__recsys_kernel_end
    v_cmp_ne_u32 vcc, -1, v176
    s_cbranch_vccnz standalone__deep_cross_pnn__recsys_kernel_end
    v_mov_b32 v199, v178
    s_mov_b64 exec, -1
    v_lshlrev_b32 v198, 3, v69
    s_mov_b32 s69, 14680064
    buffer_load_dwordx4 v[176:179], v198, s[12:15], s69 offen sc1
    s_waitcnt vmcnt(0)
    v_min3_u32 v198, v176, v177, v178
    v_min_u32 v198, v198, v179
    v_cmp_eq_u32 vcc, 0, v198
    s_cbranch_vccnz standalone__deep_cross_pnn__recsys_kernel_end

standalone__deep_cross_pnn__recsys_kernel_rn:

    v_cmp_ne_u32 vcc, 0, v199
    s_cbranch_vccz standalone__deep_cross_pnn__recsys_kernel_end
    s_ff1_i32_b64 s69, vcc
    s_mov_b32 m0, s69
    s_nop 3
    v_readlane_b32 s70, v199, s69
    s_ff1_i32_b32 s71, s70
    s_bitset0_b32 s70, s71
    s_nop 3
    v_writelane_b32 v199, s70, m0
    s_lshl_b32 s69, s69, 5
    s_add_u32 s69, s69, s71

    s_lshl_b32 s68, s69, 8
    s_add_u32 s66, s68, 29360128
    s_add_u32 s67, s66, 65536
    s_add_u32 s60, s68, 20971520
    s_lshr_b32 s68, s68, 1

    s_add_u32 s61, s60, 262144
    s_add_u32 s62, s60, 524288
    s_add_u32 s63, s60, 786432

    buffer_load_dword v194, v193, s[12:15], s66 offen sc1
    buffer_load_dword v195, v193, s[12:15], s67 offen sc1
    s_mov_b32 s65, 0
standalone__deep_cross_pnn__recsys_kernel_rw:
    buffer_load_dwordx4 v[176:179], v192, s[12:15], s60 offen sc1
    buffer_load_dwordx4 v[180:183], v192, s[12:15], s61 offen sc1
    buffer_load_dwordx4 v[184:187], v192, s[12:15], s62 offen sc1
    buffer_load_dwordx4 v[188:191], v192, s[12:15], s63 offen sc1
    s_waitcnt vmcnt(2)
    v_add_f32 v216, v176, v180
    v_add_f32 v217, v177, v181
    v_add_f32 v218, v178, v182
    v_add_f32 v219, v179, v183
    s_waitcnt vmcnt(0)
    v_add_f32 v220, v184, v188
    v_add_f32 v221, v185, v189
    v_add_f32 v222, v186, v190
    v_add_f32 v223, v187, v191
    v_add_f32 v216, v216, v220
    v_add_f32 v217, v217, v221
    v_add_f32 v218, v218, v222
    v_add_f32 v219, v219, v223

    s_nop 0
    v_permlane32_swap_b32 v216, v217
    v_permlane32_swap_b32 v218, v219
    v_add_f32 v216, v216, v217
    v_add_f32 v218, v218, v219
    s_nop 1
    v_permlane16_swap_b32 v216, v218
    s_nop 0
    v_add_f32 v216, v216, v218

    s_mov_b32 s70, 0xff800001
    s_mov_b64 s[20:21], 0
    v_cmp_eq_u32 vcc, s70, v194
    s_or_b64 s[20:21], s[20:21], vcc
    v_cmp_eq_u32 vcc, s70, v195
    s_or_b64 s[20:21], s[20:21], vcc
    v_cmp_eq_u32 vcc, s70, v176
    s_or_b64 s[20:21], s[20:21], vcc
    v_cmp_eq_u32 vcc, s70, v177
    s_or_b64 s[20:21], s[20:21], vcc
    v_cmp_eq_u32 vcc, s70, v178
    s_or_b64 s[20:21], s[20:21], vcc
    v_cmp_eq_u32 vcc, s70, v179
    s_or_b64 s[20:21], s[20:21], vcc
    v_cmp_eq_u32 vcc, s70, v180
    s_or_b64 s[20:21], s[20:21], vcc
    v_cmp_eq_u32 vcc, s70, v181
    s_or_b64 s[20:21], s[20:21], vcc
    v_cmp_eq_u32 vcc, s70, v182
    s_or_b64 s[20:21], s[20:21], vcc
    v_cmp_eq_u32 vcc, s70, v183
    s_or_b64 s[20:21], s[20:21], vcc
    v_cmp_eq_u32 vcc, s70, v184
    s_or_b64 s[20:21], s[20:21], vcc
    v_cmp_eq_u32 vcc, s70, v185
    s_or_b64 s[20:21], s[20:21], vcc
    v_cmp_eq_u32 vcc, s70, v186
    s_or_b64 s[20:21], s[20:21], vcc
    v_cmp_eq_u32 vcc, s70, v187
    s_or_b64 s[20:21], s[20:21], vcc
    v_cmp_eq_u32 vcc, s70, v188
    s_or_b64 s[20:21], s[20:21], vcc
    v_cmp_eq_u32 vcc, s70, v189
    s_or_b64 s[20:21], s[20:21], vcc
    v_cmp_eq_u32 vcc, s70, v190
    s_or_b64 s[20:21], s[20:21], vcc
    v_cmp_eq_u32 vcc, s70, v191
    s_or_b64 s[20:21], s[20:21], vcc

    s_cbranch_scc1 standalone__deep_cross_pnn__recsys_kernel_end
    s_cmp_eq_u32 s65, 0
    s_cselect_b64 vcc, -1, 0
    v_add_f32 v200, v200, v216
    v_cndmask_b32 v200, v200, v216, vcc
    s_add_u32 s60, s60, 1048576
    s_add_u32 s61, s61, 1048576
    s_add_u32 s62, s62, 1048576
    s_add_u32 s63, s63, 1048576
    s_add_u32 s65, s65, 1
    s_cmp_lt_u32 s65, 8
    s_cbranch_scc1 standalone__deep_cross_pnn__recsys_kernel_rw
    v_add_f32 v201, v194, v195

    v_cvt_pk_bf16_f32 v197, v200, v201
    v_lshlrev_b32 v198, 16, v197
    v_and_b32 v197, 0xffff0000, v197
    v_add_f32 v198, v198, v196
    v_cvt_pk_bf16_f32 v198, v198, v198
    v_lshlrev_b32 v198, 16, v198
    v_add_f32 v198, v198, v197
    v_cvt_pk_bf16_f32 v198, v198, v198
    v_lshrrev_b32 v197, 1, v193
    buffer_store_short v198, v197, s[72:75], s68 offen

    s_nop 1
    s_branch standalone__deep_cross_pnn__recsys_kernel_rn
standalone__deep_cross_pnn__recsys_kernel_k2x:
    s_waitcnt lgkmcnt(0)
standalone__deep_cross_pnn__recsys_kernelx_gloop:
    s_waitcnt vmcnt(6)
    v_lshlrev_b32_sdwa v104, 3, v120 dst_sel:DWORD dst_unused:UNUSED_PAD src0_sel:DWORD src1_sel:WORD_0
    v_lshlrev_b32_sdwa v106, 3, v120 dst_sel:DWORD dst_unused:UNUSED_PAD src0_sel:DWORD src1_sel:WORD_1
    ds_read_b64 v[104:105], v104
    ds_read_b64 v[106:107], v106
    v_lshlrev_b32_sdwa v108, 3, v121 dst_sel:DWORD dst_unused:UNUSED_PAD src0_sel:DWORD src1_sel:WORD_0
    v_lshlrev_b32_sdwa v110, 3, v121 dst_sel:DWORD dst_unused:UNUSED_PAD src0_sel:DWORD src1_sel:WORD_1
    ds_read_b64 v[108:109], v108
    ds_read_b64 v[110:111], v110
    s_waitcnt lgkmcnt(10)
    v_smfmac_f32_16x16x64_bf16 v[0:3], v[64:67], v[88:95], v68
    v_lshlrev_b32_sdwa v88, 3, v122 dst_sel:DWORD dst_unused:UNUSED_PAD src0_sel:DWORD src1_sel:WORD_0
    v_lshlrev_b32_sdwa v90, 3, v122 dst_sel:DWORD dst_unused:UNUSED_PAD src0_sel:DWORD src1_sel:WORD_1
    ds_read_b64 v[88:89], v88
    ds_read_b64 v[90:91], v90
    v_lshlrev_b32_sdwa v92, 3, v123 dst_sel:DWORD dst_unused:UNUSED_PAD src0_sel:DWORD src1_sel:WORD_0
    v_lshlrev_b32_sdwa v94, 3, v123 dst_sel:DWORD dst_unused:UNUSED_PAD src0_sel:DWORD src1_sel:WORD_1
    ds_read_b64 v[92:93], v92
    ds_read_addtid_b32 v71 offset:8080
    ds_read_b64 v[94:95], v94
    s_waitcnt lgkmcnt(9)
    v_smfmac_f32_16x16x64_bf16 v[4:7], v[64:67], v[96:103], v68
    buffer_load_dwordx4 v[120:123], v69, s[12:15], s20 offen offset:0 sc1
    s_waitcnt vmcnt(6)
    v_mfma_f32_16x16x32_bf16 v[112:115], v[72:75], v[128:131], 0
    s_waitcnt vmcnt(5)
    v_lshlrev_b32_sdwa v96, 3, v124 dst_sel:DWORD dst_unused:UNUSED_PAD src0_sel:DWORD src1_sel:WORD_0
    v_lshlrev_b32_sdwa v98, 3, v124 dst_sel:DWORD dst_unused:UNUSED_PAD src0_sel:DWORD src1_sel:WORD_1
    ds_read_b64 v[96:97], v96
    ds_read_b64 v[98:99], v98
    s_waitcnt vmcnt(4)
    v_mfma_f32_16x16x32_bf16 v[112:115], v[76:79], v[132:135], v[112:115]
    v_lshlrev_b32_sdwa v100, 3, v125 dst_sel:DWORD dst_unused:UNUSED_PAD src0_sel:DWORD src1_sel:WORD_0
    v_lshlrev_b32_sdwa v102, 3, v125 dst_sel:DWORD dst_unused:UNUSED_PAD src0_sel:DWORD src1_sel:WORD_1
    ds_read_b64 v[100:101], v100
    ds_read_b64 v[102:103], v102
    s_waitcnt lgkmcnt(9)
    v_smfmac_f32_16x16x64_bf16 v[8:11], v[64:67], v[104:111], v68
    s_waitcnt vmcnt(3)
    v_mfma_f32_16x16x32_bf16 v[112:115], v[80:83], v[136:139], v[112:115]
    v_lshlrev_b32_sdwa v104, 3, v126 dst_sel:DWORD dst_unused:UNUSED_PAD src0_sel:DWORD src1_sel:WORD_0
    v_lshlrev_b32_sdwa v106, 3, v126 dst_sel:DWORD dst_unused:UNUSED_PAD src0_sel:DWORD src1_sel:WORD_1
    ds_read_b64 v[104:105], v104
    ds_read_b64 v[106:107], v106
    s_waitcnt vmcnt(2)
    v_mfma_f32_16x16x32_bf16 v[112:115], v[84:87], v[140:143], v[112:115]
    v_lshlrev_b32_sdwa v108, 3, v127 dst_sel:DWORD dst_unused:UNUSED_PAD src0_sel:DWORD src1_sel:WORD_0
    v_lshlrev_b32_sdwa v110, 3, v127 dst_sel:DWORD dst_unused:UNUSED_PAD src0_sel:DWORD src1_sel:WORD_1
    ds_read_b64 v[108:109], v108
    ds_read_b64 v[110:111], v110
    s_waitcnt lgkmcnt(8)
    v_smfmac_f32_16x16x64_bf16 v[12:15], v[64:67], v[88:95], v68
    buffer_load_dwordx4 v[124:127], v69, s[12:15], s20 offen offset:1024 sc1
    v_readfirstlane_b32 s36, v71
    v_cvt_pk_bf16_f32 v112, v112, v113
    v_cvt_pk_bf16_f32 v113, v114, v115
    s_cmp_lt_u32 s36, s37
    s_cbranch_scc1 standalone__deep_cross_pnn__recsys_kernelx_sp0
standalone__deep_cross_pnn__recsys_kernelx_sr0:
    s_add_u32 s37, s37, 512
    ds_write_b64 v70, v[112:113] offset:0
    v_mfma_f32_16x16x32_bf16 v[112:115], v[72:75], v[144:147], 0
    v_mfma_f32_16x16x32_bf16 v[112:115], v[76:79], v[148:151], v[112:115]
    s_waitcnt vmcnt(2)
    v_lshlrev_b32_sdwa v88, 3, v116 dst_sel:DWORD dst_unused:UNUSED_PAD src0_sel:DWORD src1_sel:WORD_0
    v_lshlrev_b32_sdwa v90, 3, v116 dst_sel:DWORD dst_unused:UNUSED_PAD src0_sel:DWORD src1_sel:WORD_1
    ds_read_b64 v[88:89], v88
    ds_read_b64 v[90:91], v90
    v_mfma_f32_16x16x32_bf16 v[112:115], v[80:83], v[152:155], v[112:115]
    v_mfma_f32_16x16x32_bf16 v[112:115], v[84:87], v[156:159], v[112:115]
    v_lshlrev_b32_sdwa v92, 3, v117 dst_sel:DWORD dst_unused:UNUSED_PAD src0_sel:DWORD src1_sel:WORD_0
    v_lshlrev_b32_sdwa v94, 3, v117 dst_sel:DWORD dst_unused:UNUSED_PAD src0_sel:DWORD src1_sel:WORD_1
    ds_read_b64 v[92:93], v92
    ds_read_b64 v[94:95], v94
    s_waitcnt lgkmcnt(9)
    v_smfmac_f32_16x16x64_bf16 v[16:19], v[64:67], v[96:103], v68
    s_nop 1
    v_cvt_pk_bf16_f32 v112, v112, v113
    v_cvt_pk_bf16_f32 v113, v114, v115
    ds_write_b64 v70, v[112:113] offset:128
    v_mfma_f32_16x16x32_bf16 v[112:115], v[72:75], v[160:163], 0
    v_lshlrev_b32_sdwa v96, 3, v118 dst_sel:DWORD dst_unused:UNUSED_PAD src0_sel:DWORD src1_sel:WORD_0
    v_lshlrev_b32_sdwa v98, 3, v118 dst_sel:DWORD dst_unused:UNUSED_PAD src0_sel:DWORD src1_sel:WORD_1
    ds_read_b64 v[96:97], v96
    ds_read_b64 v[98:99], v98
    v_mfma_f32_16x16x32_bf16 v[112:115], v[76:79], v[164:167], v[112:115]
    v_lshlrev_b32_sdwa v100, 3, v119 dst_sel:DWORD dst_unused:UNUSED_PAD src0_sel:DWORD src1_sel:WORD_0
    v_lshlrev_b32_sdwa v102, 3, v119 dst_sel:DWORD dst_unused:UNUSED_PAD src0_sel:DWORD src1_sel:WORD_1
    ds_read_b64 v[100:101], v100
    ds_read_b64 v[102:103], v102
    s_waitcnt lgkmcnt(10)
    v_smfmac_f32_16x16x64_bf16 v[20:23], v[64:67], v[104:111], v68
    buffer_load_dwordx4 v[116:119], v69, s[12:15], s20 offen offset:2048 sc1
    s_setprio 2
    v_mfma_f32_16x16x32_bf16 v[112:115], v[80:83], v[168:171], v[112:115]
    s_waitcnt vmcnt(2)
    v_lshlrev_b32_sdwa v104, 3, v120 dst_sel:DWORD dst_unused:UNUSED_PAD src0_sel:DWORD src1_sel:WORD_0
    v_lshlrev_b32_sdwa v106, 3, v120 dst_sel:DWORD dst_unused:UNUSED_PAD src0_sel:DWORD src1_sel:WORD_1
    ds_read_b64 v[104:105], v104
    ds_read_b64 v[106:107], v106
    v_mfma_f32_16x16x32_bf16 v[112:115], v[84:87], v[172:175], v[112:115]
    v_lshlrev_b32_sdwa v108, 3, v121 dst_sel:DWORD dst_unused:UNUSED_PAD src0_sel:DWORD src1_sel:WORD_0
    v_lshlrev_b32_sdwa v110, 3, v121 dst_sel:DWORD dst_unused:UNUSED_PAD src0_sel:DWORD src1_sel:WORD_1
    ds_read_b64 v[108:109], v108
    ds_read_b64 v[110:111], v110
    s_waitcnt lgkmcnt(9)
    v_smfmac_f32_16x16x64_bf16 v[24:27], v[64:67], v[88:95], v68
    s_nop 1
    v_cvt_pk_bf16_f32 v112, v112, v113
    v_cvt_pk_bf16_f32 v113, v114, v115
    ds_write_b64 v70, v[112:113] offset:256
    v_mfma_f32_16x16x32_bf16 v[112:115], v[72:75], v[176:179], 0
    v_mfma_f32_16x16x32_bf16 v[112:115], v[76:79], v[180:183], v[112:115]
    v_lshlrev_b32_sdwa v88, 3, v122 dst_sel:DWORD dst_unused:UNUSED_PAD src0_sel:DWORD src1_sel:WORD_0
    v_lshlrev_b32_sdwa v90, 3, v122 dst_sel:DWORD dst_unused:UNUSED_PAD src0_sel:DWORD src1_sel:WORD_1
    ds_read_b64 v[88:89], v88
    ds_read_b64 v[90:91], v90
    v_mfma_f32_16x16x32_bf16 v[112:115], v[80:83], v[184:187], v[112:115]
    v_mfma_f32_16x16x32_bf16 v[112:115], v[84:87], v[188:191], v[112:115]
    v_lshlrev_b32_sdwa v92, 3, v123 dst_sel:DWORD dst_unused:UNUSED_PAD src0_sel:DWORD src1_sel:WORD_0
    v_lshlrev_b32_sdwa v94, 3, v123 dst_sel:DWORD dst_unused:UNUSED_PAD src0_sel:DWORD src1_sel:WORD_1
    ds_read_b64 v[92:93], v92
    ds_read_b64 v[94:95], v94
    s_waitcnt lgkmcnt(9) vmcnt(1)
    v_smfmac_f32_16x16x64_bf16 v[28:31], v[64:67], v[96:103], v68
    buffer_load_dwordx4 v[120:123], v69, s[12:15], s20 offen offset:3072 sc1
    s_add_u32 s20, s20, 61440
    v_cvt_pk_bf16_f32 v112, v112, v113
    v_cvt_pk_bf16_f32 v113, v114, v115
    ds_write_b64 v70, v[112:113] offset:384
    v_mfma_f32_16x16x32_bf16 v[112:115], v[72:75], v[192:195], 0
    v_lshlrev_b32_sdwa v96, 3, v124 dst_sel:DWORD dst_unused:UNUSED_PAD src0_sel:DWORD src1_sel:WORD_0
    v_lshlrev_b32_sdwa v98, 3, v124 dst_sel:DWORD dst_unused:UNUSED_PAD src0_sel:DWORD src1_sel:WORD_1
    ds_read_b64 v[96:97], v96
    ds_read_b64 v[98:99], v98
    v_mfma_f32_16x16x32_bf16 v[112:115], v[76:79], v[196:199], v[112:115]
    v_lshlrev_b32_sdwa v100, 3, v125 dst_sel:DWORD dst_unused:UNUSED_PAD src0_sel:DWORD src1_sel:WORD_0
    v_lshlrev_b32_sdwa v102, 3, v125 dst_sel:DWORD dst_unused:UNUSED_PAD src0_sel:DWORD src1_sel:WORD_1
    ds_read_b64 v[100:101], v100
    ds_read_b64 v[102:103], v102
    s_waitcnt lgkmcnt(10)
    v_smfmac_f32_16x16x64_bf16 v[32:35], v[64:67], v[104:111], v68
    v_lshlrev_b32_sdwa v104, 3, v126 dst_sel:DWORD dst_unused:UNUSED_PAD src0_sel:DWORD src1_sel:WORD_0
    v_lshlrev_b32_sdwa v106, 3, v126 dst_sel:DWORD dst_unused:UNUSED_PAD src0_sel:DWORD src1_sel:WORD_1
    v_mfma_f32_16x16x32_bf16 v[112:115], v[80:83], v[200:203], v[112:115]
    ds_read_b64 v[104:105], v104
    ds_read_b64 v[106:107], v106
    v_mfma_f32_16x16x32_bf16 v[112:115], v[84:87], v[204:207], v[112:115]
    v_lshlrev_b32_sdwa v108, 3, v127 dst_sel:DWORD dst_unused:UNUSED_PAD src0_sel:DWORD src1_sel:WORD_0
    v_lshlrev_b32_sdwa v110, 3, v127 dst_sel:DWORD dst_unused:UNUSED_PAD src0_sel:DWORD src1_sel:WORD_1
    buffer_load_dwordx4 v[124:127], v69, s[12:15], s20 offen offset:0 sc1
    ds_read_b64 v[108:109], v108
    ds_read_b64 v[110:111], v110
    s_waitcnt lgkmcnt(9) vmcnt(2)
    v_smfmac_f32_16x16x64_bf16 v[36:39], v[64:67], v[88:95], v68
    s_setprio 1
    v_cvt_pk_bf16_f32 v112, v112, v113
    v_cvt_pk_bf16_f32 v113, v114, v115
    ds_write_b64 v70, v[112:113] offset:512
    v_mfma_f32_16x16x32_bf16 v[112:115], v[72:75], v[208:211], 0
    v_mfma_f32_16x16x32_bf16 v[112:115], v[76:79], v[212:215], v[112:115]
    v_lshlrev_b32_sdwa v88, 3, v116 dst_sel:DWORD dst_unused:UNUSED_PAD src0_sel:DWORD src1_sel:WORD_0
    v_lshlrev_b32_sdwa v90, 3, v116 dst_sel:DWORD dst_unused:UNUSED_PAD src0_sel:DWORD src1_sel:WORD_1
    ds_read_b64 v[88:89], v88
    ds_read_b64 v[90:91], v90
    v_mfma_f32_16x16x32_bf16 v[112:115], v[80:83], v[216:219], v[112:115]
    v_mfma_f32_16x16x32_bf16 v[112:115], v[84:87], v[220:223], v[112:115]
    v_lshlrev_b32_sdwa v92, 3, v117 dst_sel:DWORD dst_unused:UNUSED_PAD src0_sel:DWORD src1_sel:WORD_0
    v_lshlrev_b32_sdwa v94, 3, v117 dst_sel:DWORD dst_unused:UNUSED_PAD src0_sel:DWORD src1_sel:WORD_1
    ds_read_b64 v[92:93], v92
    ds_read_b64 v[94:95], v94
    s_waitcnt lgkmcnt(9)
    v_smfmac_f32_16x16x64_bf16 v[40:43], v[64:67], v[96:103], v68
    v_lshlrev_b32_sdwa v96, 3, v118 dst_sel:DWORD dst_unused:UNUSED_PAD src0_sel:DWORD src1_sel:WORD_0
    v_lshlrev_b32_sdwa v98, 3, v118 dst_sel:DWORD dst_unused:UNUSED_PAD src0_sel:DWORD src1_sel:WORD_1
    v_cvt_pk_bf16_f32 v112, v112, v113
    v_cvt_pk_bf16_f32 v113, v114, v115
    ds_write_b64 v70, v[112:113] offset:640
    v_mfma_f32_16x16x32_bf16 v[112:115], v[72:75], v[224:227], 0
    ds_read_b64 v[96:97], v96
    ds_read_b64 v[98:99], v98
    v_lshlrev_b32_sdwa v100, 3, v119 dst_sel:DWORD dst_unused:UNUSED_PAD src0_sel:DWORD src1_sel:WORD_0
    v_lshlrev_b32_sdwa v102, 3, v119 dst_sel:DWORD dst_unused:UNUSED_PAD src0_sel:DWORD src1_sel:WORD_1
    v_mfma_f32_16x16x32_bf16 v[112:115], v[76:79], v[228:231], v[112:115]
    ds_read_b64 v[100:101], v100
    ds_read_b64 v[102:103], v102
    s_waitcnt lgkmcnt(10)
    v_smfmac_f32_16x16x64_bf16 v[44:47], v[64:67], v[104:111], v68
    buffer_load_dwordx4 v[116:119], v69, s[12:15], s20 offen offset:1024 sc1
    s_waitcnt vmcnt(2)
    v_lshlrev_b32_sdwa v104, 3, v120 dst_sel:DWORD dst_unused:UNUSED_PAD src0_sel:DWORD src1_sel:WORD_0
    v_lshlrev_b32_sdwa v106, 3, v120 dst_sel:DWORD dst_unused:UNUSED_PAD src0_sel:DWORD src1_sel:WORD_1
    v_mfma_f32_16x16x32_bf16 v[112:115], v[80:83], v[232:235], v[112:115]
    ds_read_b64 v[104:105], v104
    ds_read_b64 v[106:107], v106
    v_lshlrev_b32_sdwa v108, 3, v121 dst_sel:DWORD dst_unused:UNUSED_PAD src0_sel:DWORD src1_sel:WORD_0
    v_lshlrev_b32_sdwa v110, 3, v121 dst_sel:DWORD dst_unused:UNUSED_PAD src0_sel:DWORD src1_sel:WORD_1
    v_mfma_f32_16x16x32_bf16 v[112:115], v[84:87], v[236:239], v[112:115]
    ds_read_b64 v[108:109], v108
    ds_read_b64 v[110:111], v110
    s_waitcnt lgkmcnt(9)
    v_smfmac_f32_16x16x64_bf16 v[48:51], v[64:67], v[88:95], v68
    v_lshlrev_b32_sdwa v88, 3, v122 dst_sel:DWORD dst_unused:UNUSED_PAD src0_sel:DWORD src1_sel:WORD_0
    v_lshlrev_b32_sdwa v90, 3, v122 dst_sel:DWORD dst_unused:UNUSED_PAD src0_sel:DWORD src1_sel:WORD_1
    s_nop 1
    v_cvt_pk_bf16_f32 v112, v112, v113
    v_cvt_pk_bf16_f32 v113, v114, v115
    ds_write_b64 v70, v[112:113] offset:768
    v_mfma_f32_16x16x32_bf16 v[112:115], v[72:75], v[240:243], 0
    buffer_load_dwordx4 v[72:75], v69, s[12:15], s21 offen offset:0
    ds_read_b64 v[88:89], v88
    ds_read_b64 v[90:91], v90
    v_lshlrev_b32_sdwa v92, 3, v123 dst_sel:DWORD dst_unused:UNUSED_PAD src0_sel:DWORD src1_sel:WORD_0
    v_lshlrev_b32_sdwa v94, 3, v123 dst_sel:DWORD dst_unused:UNUSED_PAD src0_sel:DWORD src1_sel:WORD_1
    buffer_load_dwordx4 v[120:123], v69, s[12:15], s20 offen offset:2048 sc1
    ds_read_b64 v[92:93], v92
    ds_read_b64 v[94:95], v94
    v_mfma_f32_16x16x32_bf16 v[112:115], v[76:79], v[244:247], v[112:115]
    buffer_load_dwordx4 v[76:79], v69, s[12:15], s21 offen offset:1024
    s_waitcnt lgkmcnt(9)
    v_smfmac_f32_16x16x64_bf16 v[52:55], v[64:67], v[96:103], v68
    s_waitcnt vmcnt(4)
    v_lshlrev_b32_sdwa v96, 3, v124 dst_sel:DWORD dst_unused:UNUSED_PAD src0_sel:DWORD src1_sel:WORD_0
    v_lshlrev_b32_sdwa v98, 3, v124 dst_sel:DWORD dst_unused:UNUSED_PAD src0_sel:DWORD src1_sel:WORD_1
    ds_read_b64 v[96:97], v96
    ds_read_b64 v[98:99], v98
    v_mfma_f32_16x16x32_bf16 v[112:115], v[80:83], v[248:251], v[112:115]
    buffer_load_dwordx4 v[80:83], v69, s[12:15], s19 offen offset:0
    v_lshlrev_b32_sdwa v100, 3, v125 dst_sel:DWORD dst_unused:UNUSED_PAD src0_sel:DWORD src1_sel:WORD_0
    v_lshlrev_b32_sdwa v102, 3, v125 dst_sel:DWORD dst_unused:UNUSED_PAD src0_sel:DWORD src1_sel:WORD_1
    v_mfma_f32_16x16x32_bf16 v[112:115], v[84:87], v[252:255], v[112:115]
    buffer_load_dwordx4 v[84:87], v69, s[12:15], s19 offen offset:1024
    s_add_u32 s21, s21, 4096
    s_add_u32 s19, s19, 4096
    ds_read_b64 v[100:101], v100
    ds_read_b64 v[102:103], v102
    s_nop 2
    v_cvt_pk_bf16_f32 v112, v112, v113
    v_cvt_pk_bf16_f32 v113, v114, v115
    ds_write_b64 v70, v[112:113] offset:896
    ds_append v71 offset:8080
    s_add_u32 s23, s23, s23
    s_cselect_b32 s35, 4294836224, s32
    v_add_u32 v70, s35, v70
    s_waitcnt lgkmcnt(11)
    v_smfmac_f32_16x16x64_bf16 v[56:59], v[64:67], v[104:111], v68
    s_setprio 0
    v_lshlrev_b32_sdwa v104, 3, v126 dst_sel:DWORD dst_unused:UNUSED_PAD src0_sel:DWORD src1_sel:WORD_0
    v_lshlrev_b32_sdwa v106, 3, v126 dst_sel:DWORD dst_unused:UNUSED_PAD src0_sel:DWORD src1_sel:WORD_1
    ds_read_b64 v[104:105], v104
    ds_read_b64 v[106:107], v106
    v_lshlrev_b32_sdwa v108, 3, v127 dst_sel:DWORD dst_unused:UNUSED_PAD src0_sel:DWORD src1_sel:WORD_0
    v_lshlrev_b32_sdwa v110, 3, v127 dst_sel:DWORD dst_unused:UNUSED_PAD src0_sel:DWORD src1_sel:WORD_1
    buffer_load_dwordx4 v[124:127], v69, s[12:15], s20 offen offset:3072 sc1
    s_add_u32 s20, s20, 4096
    ds_read_b64 v[108:109], v108
    ds_read_b64 v[110:111], v110
    s_waitcnt lgkmcnt(10)
    v_smfmac_f32_16x16x64_bf16 v[60:63], v[64:67], v[88:95], v68

    s_cmpk_eq_u32 s37, 11264
    s_cbranch_scc1 standalone__deep_cross_pnn__recsys_kernelx_fin

    s_waitcnt vmcnt(6)
    v_lshlrev_b32_sdwa v88, 3, v116 dst_sel:DWORD dst_unused:UNUSED_PAD src0_sel:DWORD src1_sel:WORD_0
    v_lshlrev_b32_sdwa v90, 3, v116 dst_sel:DWORD dst_unused:UNUSED_PAD src0_sel:DWORD src1_sel:WORD_1
    ds_read_b64 v[88:89], v88
    ds_read_b64 v[90:91], v90
    v_lshlrev_b32_sdwa v92, 3, v117 dst_sel:DWORD dst_unused:UNUSED_PAD src0_sel:DWORD src1_sel:WORD_0
    v_lshlrev_b32_sdwa v94, 3, v117 dst_sel:DWORD dst_unused:UNUSED_PAD src0_sel:DWORD src1_sel:WORD_1
    ds_read_b64 v[92:93], v92
    ds_read_b64 v[94:95], v94
    s_waitcnt lgkmcnt(10)
    v_smfmac_f32_16x16x64_bf16 v[0:3], v[64:67], v[96:103], v68
    v_lshlrev_b32_sdwa v96, 3, v118 dst_sel:DWORD dst_unused:UNUSED_PAD src0_sel:DWORD src1_sel:WORD_0
    v_lshlrev_b32_sdwa v98, 3, v118 dst_sel:DWORD dst_unused:UNUSED_PAD src0_sel:DWORD src1_sel:WORD_1
    ds_read_b64 v[96:97], v96
    ds_read_b64 v[98:99], v98
    v_lshlrev_b32_sdwa v100, 3, v119 dst_sel:DWORD dst_unused:UNUSED_PAD src0_sel:DWORD src1_sel:WORD_0
    v_lshlrev_b32_sdwa v102, 3, v119 dst_sel:DWORD dst_unused:UNUSED_PAD src0_sel:DWORD src1_sel:WORD_1
    ds_read_b64 v[100:101], v100
    ds_read_addtid_b32 v71 offset:8080
    ds_read_b64 v[102:103], v102
    s_waitcnt lgkmcnt(9)
    v_smfmac_f32_16x16x64_bf16 v[4:7], v[64:67], v[104:111], v68
    buffer_load_dwordx4 v[116:119], v69, s[12:15], s20 offen offset:0 sc1
    s_waitcnt vmcnt(6)
    v_mfma_f32_16x16x32_bf16 v[112:115], v[72:75], v[128:131], 0
    s_waitcnt vmcnt(5)
    v_lshlrev_b32_sdwa v104, 3, v120 dst_sel:DWORD dst_unused:UNUSED_PAD src0_sel:DWORD src1_sel:WORD_0
    v_lshlrev_b32_sdwa v106, 3, v120 dst_sel:DWORD dst_unused:UNUSED_PAD src0_sel:DWORD src1_sel:WORD_1
    ds_read_b64 v[104:105], v104
    ds_read_b64 v[106:107], v106
    s_waitcnt vmcnt(4)
    v_mfma_f32_16x16x32_bf16 v[112:115], v[76:79], v[132:135], v[112:115]
    v_lshlrev_b32_sdwa v108, 3, v121 dst_sel:DWORD dst_unused:UNUSED_PAD src0_sel:DWORD src1_sel:WORD_0
    v_lshlrev_b32_sdwa v110, 3, v121 dst_sel:DWORD dst_unused:UNUSED_PAD src0_sel:DWORD src1_sel:WORD_1
    ds_read_b64 v[108:109], v108
    ds_read_b64 v[110:111], v110
    s_waitcnt lgkmcnt(9)
    v_smfmac_f32_16x16x64_bf16 v[8:11], v[64:67], v[88:95], v68
    s_waitcnt vmcnt(3)
    v_mfma_f32_16x16x32_bf16 v[112:115], v[80:83], v[136:139], v[112:115]
    v_lshlrev_b32_sdwa v88, 3, v122 dst_sel:DWORD dst_unused:UNUSED_PAD src0_sel:DWORD src1_sel:WORD_0
    v_lshlrev_b32_sdwa v90, 3, v122 dst_sel:DWORD dst_unused:UNUSED_PAD src0_sel:DWORD src1_sel:WORD_1
    ds_read_b64 v[88:89], v88
    ds_read_b64 v[90:91], v90
    s_waitcnt vmcnt(2)
    v_mfma_f32_16x16x32_bf16 v[112:115], v[84:87], v[140:143], v[112:115]
    v_lshlrev_b32_sdwa v92, 3, v123 dst_sel:DWORD dst_unused:UNUSED_PAD src0_sel:DWORD src1_sel:WORD_0
    v_lshlrev_b32_sdwa v94, 3, v123 dst_sel:DWORD dst_unused:UNUSED_PAD src0_sel:DWORD src1_sel:WORD_1
    ds_read_b64 v[92:93], v92
    ds_read_b64 v[94:95], v94
    s_waitcnt lgkmcnt(8)
    v_smfmac_f32_16x16x64_bf16 v[12:15], v[64:67], v[96:103], v68
    buffer_load_dwordx4 v[120:123], v69, s[12:15], s20 offen offset:1024 sc1
    v_readfirstlane_b32 s36, v71
    v_cvt_pk_bf16_f32 v112, v112, v113
    v_cvt_pk_bf16_f32 v113, v114, v115
    s_cmp_lt_u32 s36, s37
    s_cbranch_scc1 standalone__deep_cross_pnn__recsys_kernelx_sp1
standalone__deep_cross_pnn__recsys_kernelx_sr1:
    s_add_u32 s37, s37, 512
    ds_write_b64 v70, v[112:113] offset:0
    v_mfma_f32_16x16x32_bf16 v[112:115], v[72:75], v[144:147], 0
    v_mfma_f32_16x16x32_bf16 v[112:115], v[76:79], v[148:151], v[112:115]
    s_waitcnt vmcnt(2)
    v_lshlrev_b32_sdwa v96, 3, v124 dst_sel:DWORD dst_unused:UNUSED_PAD src0_sel:DWORD src1_sel:WORD_0
    v_lshlrev_b32_sdwa v98, 3, v124 dst_sel:DWORD dst_unused:UNUSED_PAD src0_sel:DWORD src1_sel:WORD_1
    ds_read_b64 v[96:97], v96
    ds_read_b64 v[98:99], v98
    v_mfma_f32_16x16x32_bf16 v[112:115], v[80:83], v[152:155], v[112:115]
    v_mfma_f32_16x16x32_bf16 v[112:115], v[84:87], v[156:159], v[112:115]
    v_lshlrev_b32_sdwa v100, 3, v125 dst_sel:DWORD dst_unused:UNUSED_PAD src0_sel:DWORD src1_sel:WORD_0
    v_lshlrev_b32_sdwa v102, 3, v125 dst_sel:DWORD dst_unused:UNUSED_PAD src0_sel:DWORD src1_sel:WORD_1
    ds_read_b64 v[100:101], v100
    ds_read_b64 v[102:103], v102
    s_waitcnt lgkmcnt(9)
    v_smfmac_f32_16x16x64_bf16 v[16:19], v[64:67], v[104:111], v68
    s_nop 1
    v_cvt_pk_bf16_f32 v112, v112, v113
    v_cvt_pk_bf16_f32 v113, v114, v115
    ds_write_b64 v70, v[112:113] offset:128
    v_mfma_f32_16x16x32_bf16 v[112:115], v[72:75], v[160:163], 0
    v_lshlrev_b32_sdwa v104, 3, v126 dst_sel:DWORD dst_unused:UNUSED_PAD src0_sel:DWORD src1_sel:WORD_0
    v_lshlrev_b32_sdwa v106, 3, v126 dst_sel:DWORD dst_unused:UNUSED_PAD src0_sel:DWORD src1_sel:WORD_1
    ds_read_b64 v[104:105], v104
    ds_read_b64 v[106:107], v106
    v_mfma_f32_16x16x32_bf16 v[112:115], v[76:79], v[164:167], v[112:115]
    v_lshlrev_b32_sdwa v108, 3, v127 dst_sel:DWORD dst_unused:UNUSED_PAD src0_sel:DWORD src1_sel:WORD_0
    v_lshlrev_b32_sdwa v110, 3, v127 dst_sel:DWORD dst_unused:UNUSED_PAD src0_sel:DWORD src1_sel:WORD_1
    ds_read_b64 v[108:109], v108
    ds_read_b64 v[110:111], v110
    s_waitcnt lgkmcnt(10)
    v_smfmac_f32_16x16x64_bf16 v[20:23], v[64:67], v[88:95], v68
    buffer_load_dwordx4 v[124:127], v69, s[12:15], s20 offen offset:2048 sc1
    s_setprio 2
    v_mfma_f32_16x16x32_bf16 v[112:115], v[80:83], v[168:171], v[112:115]
    s_waitcnt vmcnt(2)
    v_lshlrev_b32_sdwa v88, 3, v116 dst_sel:DWORD dst_unused:UNUSED_PAD src0_sel:DWORD src1_sel:WORD_0
    v_lshlrev_b32_sdwa v90, 3, v116 dst_sel:DWORD dst_unused:UNUSED_PAD src0_sel:DWORD src1_sel:WORD_1
    ds_read_b64 v[88:89], v88
    ds_read_b64 v[90:91], v90
    v_mfma_f32_16x16x32_bf16 v[112:115], v[84:87], v[172:175], v[112:115]
    v_lshlrev_b32_sdwa v92, 3, v117 dst_sel:DWORD dst_unused:UNUSED_PAD src0_sel:DWORD src1_sel:WORD_0
    v_lshlrev_b32_sdwa v94, 3, v117 dst_sel:DWORD dst_unused:UNUSED_PAD src0_sel:DWORD src1_sel:WORD_1
    ds_read_b64 v[92:93], v92
    ds_read_b64 v[94:95], v94
    s_waitcnt lgkmcnt(9)
    v_smfmac_f32_16x16x64_bf16 v[24:27], v[64:67], v[96:103], v68
    s_nop 1
    v_cvt_pk_bf16_f32 v112, v112, v113
    v_cvt_pk_bf16_f32 v113, v114, v115
    ds_write_b64 v70, v[112:113] offset:256
    v_mfma_f32_16x16x32_bf16 v[112:115], v[72:75], v[176:179], 0
    v_mfma_f32_16x16x32_bf16 v[112:115], v[76:79], v[180:183], v[112:115]
    v_lshlrev_b32_sdwa v96, 3, v118 dst_sel:DWORD dst_unused:UNUSED_PAD src0_sel:DWORD src1_sel:WORD_0
    v_lshlrev_b32_sdwa v98, 3, v118 dst_sel:DWORD dst_unused:UNUSED_PAD src0_sel:DWORD src1_sel:WORD_1
    ds_read_b64 v[96:97], v96
    ds_read_b64 v[98:99], v98
    v_mfma_f32_16x16x32_bf16 v[112:115], v[80:83], v[184:187], v[112:115]
    v_mfma_f32_16x16x32_bf16 v[112:115], v[84:87], v[188:191], v[112:115]
    v_lshlrev_b32_sdwa v100, 3, v119 dst_sel:DWORD dst_unused:UNUSED_PAD src0_sel:DWORD src1_sel:WORD_0
    v_lshlrev_b32_sdwa v102, 3, v119 dst_sel:DWORD dst_unused:UNUSED_PAD src0_sel:DWORD src1_sel:WORD_1
    ds_read_b64 v[100:101], v100
    ds_read_b64 v[102:103], v102
    s_waitcnt lgkmcnt(9) vmcnt(1)
    v_smfmac_f32_16x16x64_bf16 v[28:31], v[64:67], v[104:111], v68
    buffer_load_dwordx4 v[116:119], v69, s[12:15], s20 offen offset:3072 sc1
    s_add_u32 s20, s20, 61440
    v_cvt_pk_bf16_f32 v112, v112, v113
    v_cvt_pk_bf16_f32 v113, v114, v115
    ds_write_b64 v70, v[112:113] offset:384
    v_mfma_f32_16x16x32_bf16 v[112:115], v[72:75], v[192:195], 0
    v_lshlrev_b32_sdwa v104, 3, v120 dst_sel:DWORD dst_unused:UNUSED_PAD src0_sel:DWORD src1_sel:WORD_0
    v_lshlrev_b32_sdwa v106, 3, v120 dst_sel:DWORD dst_unused:UNUSED_PAD src0_sel:DWORD src1_sel:WORD_1
    ds_read_b64 v[104:105], v104
    ds_read_b64 v[106:107], v106
    v_mfma_f32_16x16x32_bf16 v[112:115], v[76:79], v[196:199], v[112:115]
    v_lshlrev_b32_sdwa v108, 3, v121 dst_sel:DWORD dst_unused:UNUSED_PAD src0_sel:DWORD src1_sel:WORD_0
    v_lshlrev_b32_sdwa v110, 3, v121 dst_sel:DWORD dst_unused:UNUSED_PAD src0_sel:DWORD src1_sel:WORD_1
    ds_read_b64 v[108:109], v108
    ds_read_b64 v[110:111], v110
    s_waitcnt lgkmcnt(10)
    v_smfmac_f32_16x16x64_bf16 v[32:35], v[64:67], v[88:95], v68
    v_lshlrev_b32_sdwa v88, 3, v122 dst_sel:DWORD dst_unused:UNUSED_PAD src0_sel:DWORD src1_sel:WORD_0
    v_lshlrev_b32_sdwa v90, 3, v122 dst_sel:DWORD dst_unused:UNUSED_PAD src0_sel:DWORD src1_sel:WORD_1
    v_mfma_f32_16x16x32_bf16 v[112:115], v[80:83], v[200:203], v[112:115]
    ds_read_b64 v[88:89], v88
    ds_read_b64 v[90:91], v90
    v_mfma_f32_16x16x32_bf16 v[112:115], v[84:87], v[204:207], v[112:115]
    v_lshlrev_b32_sdwa v92, 3, v123 dst_sel:DWORD dst_unused:UNUSED_PAD src0_sel:DWORD src1_sel:WORD_0
    v_lshlrev_b32_sdwa v94, 3, v123 dst_sel:DWORD dst_unused:UNUSED_PAD src0_sel:DWORD src1_sel:WORD_1
    buffer_load_dwordx4 v[120:123], v69, s[12:15], s20 offen offset:0 sc1
    ds_read_b64 v[92:93], v92
    ds_read_b64 v[94:95], v94
    s_waitcnt lgkmcnt(9) vmcnt(2)
    v_smfmac_f32_16x16x64_bf16 v[36:39], v[64:67], v[96:103], v68
    s_setprio 1
    v_cvt_pk_bf16_f32 v112, v112, v113
    v_cvt_pk_bf16_f32 v113, v114, v115
    ds_write_b64 v70, v[112:113] offset:512
    v_mfma_f32_16x16x32_bf16 v[112:115], v[72:75], v[208:211], 0
    v_mfma_f32_16x16x32_bf16 v[112:115], v[76:79], v[212:215], v[112:115]
    v_lshlrev_b32_sdwa v96, 3, v124 dst_sel:DWORD dst_unused:UNUSED_PAD src0_sel:DWORD src1_sel:WORD_0
    v_lshlrev_b32_sdwa v98, 3, v124 dst_sel:DWORD dst_unused:UNUSED_PAD src0_sel:DWORD src1_sel:WORD_1
    ds_read_b64 v[96:97], v96
    ds_read_b64 v[98:99], v98
    v_mfma_f32_16x16x32_bf16 v[112:115], v[80:83], v[216:219], v[112:115]
    v_mfma_f32_16x16x32_bf16 v[112:115], v[84:87], v[220:223], v[112:115]
    v_lshlrev_b32_sdwa v100, 3, v125 dst_sel:DWORD dst_unused:UNUSED_PAD src0_sel:DWORD src1_sel:WORD_0
    v_lshlrev_b32_sdwa v102, 3, v125 dst_sel:DWORD dst_unused:UNUSED_PAD src0_sel:DWORD src1_sel:WORD_1
    ds_read_b64 v[100:101], v100
    ds_read_b64 v[102:103], v102
    s_waitcnt lgkmcnt(9)
    v_smfmac_f32_16x16x64_bf16 v[40:43], v[64:67], v[104:111], v68
    v_lshlrev_b32_sdwa v104, 3, v126 dst_sel:DWORD dst_unused:UNUSED_PAD src0_sel:DWORD src1_sel:WORD_0
    v_lshlrev_b32_sdwa v106, 3, v126 dst_sel:DWORD dst_unused:UNUSED_PAD src0_sel:DWORD src1_sel:WORD_1
    v_cvt_pk_bf16_f32 v112, v112, v113
    v_cvt_pk_bf16_f32 v113, v114, v115
    ds_write_b64 v70, v[112:113] offset:640
    v_mfma_f32_16x16x32_bf16 v[112:115], v[72:75], v[224:227], 0
    ds_read_b64 v[104:105], v104
    ds_read_b64 v[106:107], v106
    v_lshlrev_b32_sdwa v108, 3, v127 dst_sel:DWORD dst_unused:UNUSED_PAD src0_sel:DWORD src1_sel:WORD_0
    v_lshlrev_b32_sdwa v110, 3, v127 dst_sel:DWORD dst_unused:UNUSED_PAD src0_sel:DWORD src1_sel:WORD_1
    v_mfma_f32_16x16x32_bf16 v[112:115], v[76:79], v[228:231], v[112:115]
    ds_read_b64 v[108:109], v108
    ds_read_b64 v[110:111], v110
    s_waitcnt lgkmcnt(10)
    v_smfmac_f32_16x16x64_bf16 v[44:47], v[64:67], v[88:95], v68
    buffer_load_dwordx4 v[124:127], v69, s[12:15], s20 offen offset:1024 sc1
    s_waitcnt vmcnt(2)
    v_lshlrev_b32_sdwa v88, 3, v116 dst_sel:DWORD dst_unused:UNUSED_PAD src0_sel:DWORD src1_sel:WORD_0
    v_lshlrev_b32_sdwa v90, 3, v116 dst_sel:DWORD dst_unused:UNUSED_PAD src0_sel:DWORD src1_sel:WORD_1
    v_mfma_f32_16x16x32_bf16 v[112:115], v[80:83], v[232:235], v[112:115]
    ds_read_b64 v[88:89], v88
    ds_read_b64 v[90:91], v90
    v_lshlrev_b32_sdwa v92, 3, v117 dst_sel:DWORD dst_unused:UNUSED_PAD src0_sel:DWORD src1_sel:WORD_0
    v_lshlrev_b32_sdwa v94, 3, v117 dst_sel:DWORD dst_unused:UNUSED_PAD src0_sel:DWORD src1_sel:WORD_1
    v_mfma_f32_16x16x32_bf16 v[112:115], v[84:87], v[236:239], v[112:115]
    ds_read_b64 v[92:93], v92
    ds_read_b64 v[94:95], v94
    s_waitcnt lgkmcnt(9)
    v_smfmac_f32_16x16x64_bf16 v[48:51], v[64:67], v[96:103], v68
    v_lshlrev_b32_sdwa v96, 3, v118 dst_sel:DWORD dst_unused:UNUSED_PAD src0_sel:DWORD src1_sel:WORD_0
    v_lshlrev_b32_sdwa v98, 3, v118 dst_sel:DWORD dst_unused:UNUSED_PAD src0_sel:DWORD src1_sel:WORD_1
    s_nop 1
    v_cvt_pk_bf16_f32 v112, v112, v113
    v_cvt_pk_bf16_f32 v113, v114, v115
    ds_write_b64 v70, v[112:113] offset:768
    v_mfma_f32_16x16x32_bf16 v[112:115], v[72:75], v[240:243], 0
    buffer_load_dwordx4 v[72:75], v69, s[12:15], s21 offen offset:0
    ds_read_b64 v[96:97], v96
    ds_read_b64 v[98:99], v98
    v_lshlrev_b32_sdwa v100, 3, v119 dst_sel:DWORD dst_unused:UNUSED_PAD src0_sel:DWORD src1_sel:WORD_0
    v_lshlrev_b32_sdwa v102, 3, v119 dst_sel:DWORD dst_unused:UNUSED_PAD src0_sel:DWORD src1_sel:WORD_1
    buffer_load_dwordx4 v[116:119], v69, s[12:15], s20 offen offset:2048 sc1
    ds_read_b64 v[100:101], v100
    ds_read_b64 v[102:103], v102
    v_mfma_f32_16x16x32_bf16 v[112:115], v[76:79], v[244:247], v[112:115]
    buffer_load_dwordx4 v[76:79], v69, s[12:15], s21 offen offset:1024
    s_waitcnt lgkmcnt(9)
    v_smfmac_f32_16x16x64_bf16 v[52:55], v[64:67], v[104:111], v68
    s_waitcnt vmcnt(4)
    v_lshlrev_b32_sdwa v104, 3, v120 dst_sel:DWORD dst_unused:UNUSED_PAD src0_sel:DWORD src1_sel:WORD_0
    v_lshlrev_b32_sdwa v106, 3, v120 dst_sel:DWORD dst_unused:UNUSED_PAD src0_sel:DWORD src1_sel:WORD_1
    ds_read_b64 v[104:105], v104
    ds_read_b64 v[106:107], v106
    v_mfma_f32_16x16x32_bf16 v[112:115], v[80:83], v[248:251], v[112:115]
    buffer_load_dwordx4 v[80:83], v69, s[12:15], s19 offen offset:0
    v_lshlrev_b32_sdwa v108, 3, v121 dst_sel:DWORD dst_unused:UNUSED_PAD src0_sel:DWORD src1_sel:WORD_0
    v_lshlrev_b32_sdwa v110, 3, v121 dst_sel:DWORD dst_unused:UNUSED_PAD src0_sel:DWORD src1_sel:WORD_1
    v_mfma_f32_16x16x32_bf16 v[112:115], v[84:87], v[252:255], v[112:115]
    buffer_load_dwordx4 v[84:87], v69, s[12:15], s19 offen offset:1024
    s_add_u32 s21, s21, 4096
    s_add_u32 s19, s19, 4096
    ds_read_b64 v[108:109], v108
    ds_read_b64 v[110:111], v110
    s_nop 2
    v_cvt_pk_bf16_f32 v112, v112, v113
    v_cvt_pk_bf16_f32 v113, v114, v115
    ds_write_b64 v70, v[112:113] offset:896
    ds_append v71 offset:8080
    s_add_u32 s23, s23, s23
    s_cselect_b32 s35, 4294836224, s32
    v_add_u32 v70, s35, v70
    s_waitcnt lgkmcnt(11)
    v_smfmac_f32_16x16x64_bf16 v[56:59], v[64:67], v[88:95], v68
    s_setprio 0
    v_lshlrev_b32_sdwa v88, 3, v122 dst_sel:DWORD dst_unused:UNUSED_PAD src0_sel:DWORD src1_sel:WORD_0
    v_lshlrev_b32_sdwa v90, 3, v122 dst_sel:DWORD dst_unused:UNUSED_PAD src0_sel:DWORD src1_sel:WORD_1
    ds_read_b64 v[88:89], v88
    ds_read_b64 v[90:91], v90
    v_lshlrev_b32_sdwa v92, 3, v123 dst_sel:DWORD dst_unused:UNUSED_PAD src0_sel:DWORD src1_sel:WORD_0
    v_lshlrev_b32_sdwa v94, 3, v123 dst_sel:DWORD dst_unused:UNUSED_PAD src0_sel:DWORD src1_sel:WORD_1
    buffer_load_dwordx4 v[120:123], v69, s[12:15], s20 offen offset:3072 sc1
    s_add_u32 s20, s20, 4096
    ds_read_b64 v[92:93], v92
    ds_read_b64 v[94:95], v94
    s_waitcnt lgkmcnt(10)
    v_smfmac_f32_16x16x64_bf16 v[60:63], v[64:67], v[96:103], v68
    s_waitcnt vmcnt(6)
    v_lshlrev_b32_sdwa v96, 3, v124 dst_sel:DWORD dst_unused:UNUSED_PAD src0_sel:DWORD src1_sel:WORD_0
    v_lshlrev_b32_sdwa v98, 3, v124 dst_sel:DWORD dst_unused:UNUSED_PAD src0_sel:DWORD src1_sel:WORD_1
    ds_read_b64 v[96:97], v96
    ds_read_b64 v[98:99], v98
    v_lshlrev_b32_sdwa v100, 3, v125 dst_sel:DWORD dst_unused:UNUSED_PAD src0_sel:DWORD src1_sel:WORD_0
    v_lshlrev_b32_sdwa v102, 3, v125 dst_sel:DWORD dst_unused:UNUSED_PAD src0_sel:DWORD src1_sel:WORD_1
    ds_read_b64 v[100:101], v100
    ds_read_b64 v[102:103], v102
    s_waitcnt lgkmcnt(10)
    v_smfmac_f32_16x16x64_bf16 v[0:3], v[64:67], v[104:111], v68
    v_lshlrev_b32_sdwa v104, 3, v126 dst_sel:DWORD dst_unused:UNUSED_PAD src0_sel:DWORD src1_sel:WORD_0
    v_lshlrev_b32_sdwa v106, 3, v126 dst_sel:DWORD dst_unused:UNUSED_PAD src0_sel:DWORD src1_sel:WORD_1
    ds_read_b64 v[104:105], v104
    ds_read_b64 v[106:107], v106
    v_lshlrev_b32_sdwa v108, 3, v127 dst_sel:DWORD dst_unused:UNUSED_PAD src0_sel:DWORD src1_sel:WORD_0
    v_lshlrev_b32_sdwa v110, 3, v127 dst_sel:DWORD dst_unused:UNUSED_PAD src0_sel:DWORD src1_sel:WORD_1
    ds_read_b64 v[108:109], v108
    ds_read_addtid_b32 v71 offset:8080
    ds_read_b64 v[110:111], v110
    s_waitcnt lgkmcnt(9)
    v_smfmac_f32_16x16x64_bf16 v[4:7], v[64:67], v[88:95], v68
    buffer_load_dwordx4 v[124:127], v69, s[12:15], s20 offen offset:0 sc1
    s_waitcnt vmcnt(6)
    v_mfma_f32_16x16x32_bf16 v[112:115], v[72:75], v[128:131], 0
    s_waitcnt vmcnt(5)
    v_lshlrev_b32_sdwa v88, 3, v116 dst_sel:DWORD dst_unused:UNUSED_PAD src0_sel:DWORD src1_sel:WORD_0
    v_lshlrev_b32_sdwa v90, 3, v116 dst_sel:DWORD dst_unused:UNUSED_PAD src0_sel:DWORD src1_sel:WORD_1
    ds_read_b64 v[88:89], v88
    ds_read_b64 v[90:91], v90
    s_waitcnt vmcnt(4)
    v_mfma_f32_16x16x32_bf16 v[112:115], v[76:79], v[132:135], v[112:115]
    v_lshlrev_b32_sdwa v92, 3, v117 dst_sel:DWORD dst_unused:UNUSED_PAD src0_sel:DWORD src1_sel:WORD_0
    v_lshlrev_b32_sdwa v94, 3, v117 dst_sel:DWORD dst_unused:UNUSED_PAD src0_sel:DWORD src1_sel:WORD_1
    ds_read_b64 v[92:93], v92
    ds_read_b64 v[94:95], v94
    s_waitcnt lgkmcnt(9)
    v_smfmac_f32_16x16x64_bf16 v[8:11], v[64:67], v[96:103], v68
    s_waitcnt vmcnt(3)
    v_mfma_f32_16x16x32_bf16 v[112:115], v[80:83], v[136:139], v[112:115]
    v_lshlrev_b32_sdwa v96, 3, v118 dst_sel:DWORD dst_unused:UNUSED_PAD src0_sel:DWORD src1_sel:WORD_0
    v_lshlrev_b32_sdwa v98, 3, v118 dst_sel:DWORD dst_unused:UNUSED_PAD src0_sel:DWORD src1_sel:WORD_1
    ds_read_b64 v[96:97], v96
    ds_read_b64 v[98:99], v98
    s_waitcnt vmcnt(2)
    v_mfma_f32_16x16x32_bf16 v[112:115], v[84:87], v[140:143], v[112:115]
    v_lshlrev_b32_sdwa v100, 3, v119 dst_sel:DWORD dst_unused:UNUSED_PAD src0_sel:DWORD src1_sel:WORD_0
    v_lshlrev_b32_sdwa v102, 3, v119 dst_sel:DWORD dst_unused:UNUSED_PAD src0_sel:DWORD src1_sel:WORD_1
    ds_read_b64 v[100:101], v100
    ds_read_b64 v[102:103], v102
    s_waitcnt lgkmcnt(8)
    v_smfmac_f32_16x16x64_bf16 v[12:15], v[64:67], v[104:111], v68
    buffer_load_dwordx4 v[116:119], v69, s[12:15], s20 offen offset:1024 sc1
    v_readfirstlane_b32 s36, v71
    v_cvt_pk_bf16_f32 v112, v112, v113
    v_cvt_pk_bf16_f32 v113, v114, v115
    s_cmp_lt_u32 s36, s37
    s_cbranch_scc1 standalone__deep_cross_pnn__recsys_kernelx_sp2
standalone__deep_cross_pnn__recsys_kernelx_sr2:
    s_add_u32 s37, s37, 512
    ds_write_b64 v70, v[112:113] offset:0
    v_mfma_f32_16x16x32_bf16 v[112:115], v[72:75], v[144:147], 0
    v_mfma_f32_16x16x32_bf16 v[112:115], v[76:79], v[148:151], v[112:115]
    s_waitcnt vmcnt(2)
    v_lshlrev_b32_sdwa v104, 3, v120 dst_sel:DWORD dst_unused:UNUSED_PAD src0_sel:DWORD src1_sel:WORD_0
    v_lshlrev_b32_sdwa v106, 3, v120 dst_sel:DWORD dst_unused:UNUSED_PAD src0_sel:DWORD src1_sel:WORD_1
    ds_read_b64 v[104:105], v104
    ds_read_b64 v[106:107], v106
    v_mfma_f32_16x16x32_bf16 v[112:115], v[80:83], v[152:155], v[112:115]
    v_mfma_f32_16x16x32_bf16 v[112:115], v[84:87], v[156:159], v[112:115]
    v_lshlrev_b32_sdwa v108, 3, v121 dst_sel:DWORD dst_unused:UNUSED_PAD src0_sel:DWORD src1_sel:WORD_0
    v_lshlrev_b32_sdwa v110, 3, v121 dst_sel:DWORD dst_unused:UNUSED_PAD src0_sel:DWORD src1_sel:WORD_1
    ds_read_b64 v[108:109], v108
    ds_read_b64 v[110:111], v110
    s_waitcnt lgkmcnt(9)
    v_smfmac_f32_16x16x64_bf16 v[16:19], v[64:67], v[88:95], v68
    s_nop 1
    v_cvt_pk_bf16_f32 v112, v112, v113
    v_cvt_pk_bf16_f32 v113, v114, v115
    ds_write_b64 v70, v[112:113] offset:128
    v_mfma_f32_16x16x32_bf16 v[112:115], v[72:75], v[160:163], 0
    v_lshlrev_b32_sdwa v88, 3, v122 dst_sel:DWORD dst_unused:UNUSED_PAD src0_sel:DWORD src1_sel:WORD_0
    v_lshlrev_b32_sdwa v90, 3, v122 dst_sel:DWORD dst_unused:UNUSED_PAD src0_sel:DWORD src1_sel:WORD_1
    ds_read_b64 v[88:89], v88
    ds_read_b64 v[90:91], v90
    v_mfma_f32_16x16x32_bf16 v[112:115], v[76:79], v[164:167], v[112:115]
    v_lshlrev_b32_sdwa v92, 3, v123 dst_sel:DWORD dst_unused:UNUSED_PAD src0_sel:DWORD src1_sel:WORD_0
    v_lshlrev_b32_sdwa v94, 3, v123 dst_sel:DWORD dst_unused:UNUSED_PAD src0_sel:DWORD src1_sel:WORD_1
    ds_read_b64 v[92:93], v92
    ds_read_b64 v[94:95], v94
    s_waitcnt lgkmcnt(10)
    v_smfmac_f32_16x16x64_bf16 v[20:23], v[64:67], v[96:103], v68
    buffer_load_dwordx4 v[120:123], v69, s[12:15], s20 offen offset:2048 sc1
    s_setprio 2
    v_mfma_f32_16x16x32_bf16 v[112:115], v[80:83], v[168:171], v[112:115]
    s_waitcnt vmcnt(2)
    v_lshlrev_b32_sdwa v96, 3, v124 dst_sel:DWORD dst_unused:UNUSED_PAD src0_sel:DWORD src1_sel:WORD_0
    v_lshlrev_b32_sdwa v98, 3, v124 dst_sel:DWORD dst_unused:UNUSED_PAD src0_sel:DWORD src1_sel:WORD_1
    ds_read_b64 v[96:97], v96
    ds_read_b64 v[98:99], v98
    v_mfma_f32_16x16x32_bf16 v[112:115], v[84:87], v[172:175], v[112:115]
    v_lshlrev_b32_sdwa v100, 3, v125 dst_sel:DWORD dst_unused:UNUSED_PAD src0_sel:DWORD src1_sel:WORD_0
    v_lshlrev_b32_sdwa v102, 3, v125 dst_sel:DWORD dst_unused:UNUSED_PAD src0_sel:DWORD src1_sel:WORD_1
    ds_read_b64 v[100:101], v100
    ds_read_b64 v[102:103], v102
    s_waitcnt lgkmcnt(9)
    v_smfmac_f32_16x16x64_bf16 v[24:27], v[64:67], v[104:111], v68
    s_nop 1
    v_cvt_pk_bf16_f32 v112, v112, v113
    v_cvt_pk_bf16_f32 v113, v114, v115
    ds_write_b64 v70, v[112:113] offset:256
    v_mfma_f32_16x16x32_bf16 v[112:115], v[72:75], v[176:179], 0
    v_mfma_f32_16x16x32_bf16 v[112:115], v[76:79], v[180:183], v[112:115]
    v_lshlrev_b32_sdwa v104, 3, v126 dst_sel:DWORD dst_unused:UNUSED_PAD src0_sel:DWORD src1_sel:WORD_0
    v_lshlrev_b32_sdwa v106, 3, v126 dst_sel:DWORD dst_unused:UNUSED_PAD src0_sel:DWORD src1_sel:WORD_1
    ds_read_b64 v[104:105], v104
    ds_read_b64 v[106:107], v106
    v_mfma_f32_16x16x32_bf16 v[112:115], v[80:83], v[184:187], v[112:115]
    v_mfma_f32_16x16x32_bf16 v[112:115], v[84:87], v[188:191], v[112:115]
    v_lshlrev_b32_sdwa v108, 3, v127 dst_sel:DWORD dst_unused:UNUSED_PAD src0_sel:DWORD src1_sel:WORD_0
    v_lshlrev_b32_sdwa v110, 3, v127 dst_sel:DWORD dst_unused:UNUSED_PAD src0_sel:DWORD src1_sel:WORD_1
    ds_read_b64 v[108:109], v108
    ds_read_b64 v[110:111], v110
    s_waitcnt lgkmcnt(9) vmcnt(1)
    v_smfmac_f32_16x16x64_bf16 v[28:31], v[64:67], v[88:95], v68
    buffer_load_dwordx4 v[124:127], v69, s[12:15], s20 offen offset:3072 sc1
    s_add_u32 s20, s20, 61440
    v_cvt_pk_bf16_f32 v112, v112, v113
    v_cvt_pk_bf16_f32 v113, v114, v115
    ds_write_b64 v70, v[112:113] offset:384
    v_mfma_f32_16x16x32_bf16 v[112:115], v[72:75], v[192:195], 0
    v_lshlrev_b32_sdwa v88, 3, v116 dst_sel:DWORD dst_unused:UNUSED_PAD src0_sel:DWORD src1_sel:WORD_0
    v_lshlrev_b32_sdwa v90, 3, v116 dst_sel:DWORD dst_unused:UNUSED_PAD src0_sel:DWORD src1_sel:WORD_1
    ds_read_b64 v[88:89], v88
    ds_read_b64 v[90:91], v90
    v_mfma_f32_16x16x32_bf16 v[112:115], v[76:79], v[196:199], v[112:115]
    v_lshlrev_b32_sdwa v92, 3, v117 dst_sel:DWORD dst_unused:UNUSED_PAD src0_sel:DWORD src1_sel:WORD_0
    v_lshlrev_b32_sdwa v94, 3, v117 dst_sel:DWORD dst_unused:UNUSED_PAD src0_sel:DWORD src1_sel:WORD_1
    ds_read_b64 v[92:93], v92
    ds_read_b64 v[94:95], v94
    s_waitcnt lgkmcnt(10)
    v_smfmac_f32_16x16x64_bf16 v[32:35], v[64:67], v[96:103], v68
    v_lshlrev_b32_sdwa v96, 3, v118 dst_sel:DWORD dst_unused:UNUSED_PAD src0_sel:DWORD src1_sel:WORD_0
    v_lshlrev_b32_sdwa v98, 3, v118 dst_sel:DWORD dst_unused:UNUSED_PAD src0_sel:DWORD src1_sel:WORD_1
    v_mfma_f32_16x16x32_bf16 v[112:115], v[80:83], v[200:203], v[112:115]
    ds_read_b64 v[96:97], v96
    ds_read_b64 v[98:99], v98
    v_mfma_f32_16x16x32_bf16 v[112:115], v[84:87], v[204:207], v[112:115]
    v_lshlrev_b32_sdwa v100, 3, v119 dst_sel:DWORD dst_unused:UNUSED_PAD src0_sel:DWORD src1_sel:WORD_0
    v_lshlrev_b32_sdwa v102, 3, v119 dst_sel:DWORD dst_unused:UNUSED_PAD src0_sel:DWORD src1_sel:WORD_1
    buffer_load_dwordx4 v[116:119], v69, s[12:15], s20 offen offset:0 sc1
    ds_read_b64 v[100:101], v100
    ds_read_b64 v[102:103], v102
    s_waitcnt lgkmcnt(9) vmcnt(2)
    v_smfmac_f32_16x16x64_bf16 v[36:39], v[64:67], v[104:111], v68
    s_setprio 1
    v_cvt_pk_bf16_f32 v112, v112, v113
    v_cvt_pk_bf16_f32 v113, v114, v115
    ds_write_b64 v70, v[112:113] offset:512
    v_mfma_f32_16x16x32_bf16 v[112:115], v[72:75], v[208:211], 0
    v_mfma_f32_16x16x32_bf16 v[112:115], v[76:79], v[212:215], v[112:115]
    v_lshlrev_b32_sdwa v104, 3, v120 dst_sel:DWORD dst_unused:UNUSED_PAD src0_sel:DWORD src1_sel:WORD_0
    v_lshlrev_b32_sdwa v106, 3, v120 dst_sel:DWORD dst_unused:UNUSED_PAD src0_sel:DWORD src1_sel:WORD_1
    ds_read_b64 v[104:105], v104
    ds_read_b64 v[106:107], v106
    v_mfma_f32_16x16x32_bf16 v[112:115], v[80:83], v[216:219], v[112:115]
    v_mfma_f32_16x16x32_bf16 v[112:115], v[84:87], v[220:223], v[112:115]
    v_lshlrev_b32_sdwa v108, 3, v121 dst_sel:DWORD dst_unused:UNUSED_PAD src0_sel:DWORD src1_sel:WORD_0
    v_lshlrev_b32_sdwa v110, 3, v121 dst_sel:DWORD dst_unused:UNUSED_PAD src0_sel:DWORD src1_sel:WORD_1
    ds_read_b64 v[108:109], v108
    ds_read_b64 v[110:111], v110
    s_waitcnt lgkmcnt(9)
    v_smfmac_f32_16x16x64_bf16 v[40:43], v[64:67], v[88:95], v68
    v_lshlrev_b32_sdwa v88, 3, v122 dst_sel:DWORD dst_unused:UNUSED_PAD src0_sel:DWORD src1_sel:WORD_0
    v_lshlrev_b32_sdwa v90, 3, v122 dst_sel:DWORD dst_unused:UNUSED_PAD src0_sel:DWORD src1_sel:WORD_1
    v_cvt_pk_bf16_f32 v112, v112, v113
    v_cvt_pk_bf16_f32 v113, v114, v115
    ds_write_b64 v70, v[112:113] offset:640
    v_mfma_f32_16x16x32_bf16 v[112:115], v[72:75], v[224:227], 0
    ds_read_b64 v[88:89], v88
    ds_read_b64 v[90:91], v90
    v_lshlrev_b32_sdwa v92, 3, v123 dst_sel:DWORD dst_unused:UNUSED_PAD src0_sel:DWORD src1_sel:WORD_0
    v_lshlrev_b32_sdwa v94, 3, v123 dst_sel:DWORD dst_unused:UNUSED_PAD src0_sel:DWORD src1_sel:WORD_1
    v_mfma_f32_16x16x32_bf16 v[112:115], v[76:79], v[228:231], v[112:115]
    ds_read_b64 v[92:93], v92
    ds_read_b64 v[94:95], v94
    s_waitcnt lgkmcnt(10)
    v_smfmac_f32_16x16x64_bf16 v[44:47], v[64:67], v[96:103], v68
    buffer_load_dwordx4 v[120:123], v69, s[12:15], s20 offen offset:1024 sc1
    s_waitcnt vmcnt(2)
    v_lshlrev_b32_sdwa v96, 3, v124 dst_sel:DWORD dst_unused:UNUSED_PAD src0_sel:DWORD src1_sel:WORD_0
    v_lshlrev_b32_sdwa v98, 3, v124 dst_sel:DWORD dst_unused:UNUSED_PAD src0_sel:DWORD src1_sel:WORD_1
    v_mfma_f32_16x16x32_bf16 v[112:115], v[80:83], v[232:235], v[112:115]
    ds_read_b64 v[96:97], v96
    ds_read_b64 v[98:99], v98
    v_lshlrev_b32_sdwa v100, 3, v125 dst_sel:DWORD dst_unused:UNUSED_PAD src0_sel:DWORD src1_sel:WORD_0
    v_lshlrev_b32_sdwa v102, 3, v125 dst_sel:DWORD dst_unused:UNUSED_PAD src0_sel:DWORD src1_sel:WORD_1
    v_mfma_f32_16x16x32_bf16 v[112:115], v[84:87], v[236:239], v[112:115]
    ds_read_b64 v[100:101], v100
    ds_read_b64 v[102:103], v102
    s_waitcnt lgkmcnt(9)
    v_smfmac_f32_16x16x64_bf16 v[48:51], v[64:67], v[104:111], v68
    v_lshlrev_b32_sdwa v104, 3, v126 dst_sel:DWORD dst_unused:UNUSED_PAD src0_sel:DWORD src1_sel:WORD_0
    v_lshlrev_b32_sdwa v106, 3, v126 dst_sel:DWORD dst_unused:UNUSED_PAD src0_sel:DWORD src1_sel:WORD_1
    s_nop 1
    v_cvt_pk_bf16_f32 v112, v112, v113
    v_cvt_pk_bf16_f32 v113, v114, v115
    ds_write_b64 v70, v[112:113] offset:768
    v_mfma_f32_16x16x32_bf16 v[112:115], v[72:75], v[240:243], 0
    buffer_load_dwordx4 v[72:75], v69, s[12:15], s21 offen offset:0
    ds_read_b64 v[104:105], v104
    ds_read_b64 v[106:107], v106
    v_lshlrev_b32_sdwa v108, 3, v127 dst_sel:DWORD dst_unused:UNUSED_PAD src0_sel:DWORD src1_sel:WORD_0
    v_lshlrev_b32_sdwa v110, 3, v127 dst_sel:DWORD dst_unused:UNUSED_PAD src0_sel:DWORD src1_sel:WORD_1
    buffer_load_dwordx4 v[124:127], v69, s[12:15], s20 offen offset:2048 sc1
    ds_read_b64 v[108:109], v108
    ds_read_b64 v[110:111], v110
    v_mfma_f32_16x16x32_bf16 v[112:115], v[76:79], v[244:247], v[112:115]
    buffer_load_dwordx4 v[76:79], v69, s[12:15], s21 offen offset:1024
    s_waitcnt lgkmcnt(9)
    v_smfmac_f32_16x16x64_bf16 v[52:55], v[64:67], v[88:95], v68
    s_waitcnt vmcnt(4)
    v_lshlrev_b32_sdwa v88, 3, v116 dst_sel:DWORD dst_unused:UNUSED_PAD src0_sel:DWORD src1_sel:WORD_0
    v_lshlrev_b32_sdwa v90, 3, v116 dst_sel:DWORD dst_unused:UNUSED_PAD src0_sel:DWORD src1_sel:WORD_1
    ds_read_b64 v[88:89], v88
    ds_read_b64 v[90:91], v90
    v_mfma_f32_16x16x32_bf16 v[112:115], v[80:83], v[248:251], v[112:115]
    buffer_load_dwordx4 v[80:83], v69, s[12:15], s19 offen offset:0
    v_lshlrev_b32_sdwa v92, 3, v117 dst_sel:DWORD dst_unused:UNUSED_PAD src0_sel:DWORD src1_sel:WORD_0
    v_lshlrev_b32_sdwa v94, 3, v117 dst_sel:DWORD dst_unused:UNUSED_PAD src0_sel:DWORD src1_sel:WORD_1
    v_mfma_f32_16x16x32_bf16 v[112:115], v[84:87], v[252:255], v[112:115]
    buffer_load_dwordx4 v[84:87], v69, s[12:15], s19 offen offset:1024
    s_add_u32 s21, s21, 4096
    s_add_u32 s19, s19, 4096
    ds_read_b64 v[92:93], v92
    ds_read_b64 v[94:95], v94
    s_nop 2
    v_cvt_pk_bf16_f32 v112, v112, v113
    v_cvt_pk_bf16_f32 v113, v114, v115
    ds_write_b64 v70, v[112:113] offset:896
    ds_append v71 offset:8080
    s_add_u32 s23, s23, s23
    s_cselect_b32 s35, 4294836224, s32
    v_add_u32 v70, s35, v70
    s_waitcnt lgkmcnt(11)
    v_smfmac_f32_16x16x64_bf16 v[56:59], v[64:67], v[96:103], v68
    s_setprio 0
    v_lshlrev_b32_sdwa v96, 3, v118 dst_sel:DWORD dst_unused:UNUSED_PAD src0_sel:DWORD src1_sel:WORD_0
    v_lshlrev_b32_sdwa v98, 3, v118 dst_sel:DWORD dst_unused:UNUSED_PAD src0_sel:DWORD src1_sel:WORD_1
    ds_read_b64 v[96:97], v96
    ds_read_b64 v[98:99], v98
    v_lshlrev_b32_sdwa v100, 3, v119 dst_sel:DWORD dst_unused:UNUSED_PAD src0_sel:DWORD src1_sel:WORD_0
    v_lshlrev_b32_sdwa v102, 3, v119 dst_sel:DWORD dst_unused:UNUSED_PAD src0_sel:DWORD src1_sel:WORD_1
    buffer_load_dwordx4 v[116:119], v69, s[12:15], s20 offen offset:3072 sc1
    s_add_u32 s20, s20, 4096
    ds_read_b64 v[100:101], v100
    ds_read_b64 v[102:103], v102
    s_waitcnt lgkmcnt(10)
    v_smfmac_f32_16x16x64_bf16 v[60:63], v[64:67], v[104:111], v68

    s_branch standalone__deep_cross_pnn__recsys_kernelx_gloop

standalone__deep_cross_pnn__recsys_kernelx_sp0:
    s_sleep 1
    ds_read_addtid_b32 v71 offset:8080
    s_waitcnt lgkmcnt(0)
    v_readfirstlane_b32 s36, v71

    s_cmp_lt_u32 s36, s37
    s_cbranch_scc1 standalone__deep_cross_pnn__recsys_kernelx_sp0
    s_branch standalone__deep_cross_pnn__recsys_kernelx_sr0
standalone__deep_cross_pnn__recsys_kernelx_sp1:
    s_sleep 1
    ds_read_addtid_b32 v71 offset:8080
    s_waitcnt lgkmcnt(0)
    v_readfirstlane_b32 s36, v71

    s_cmp_lt_u32 s36, s37
    s_cbranch_scc1 standalone__deep_cross_pnn__recsys_kernelx_sp1
    s_branch standalone__deep_cross_pnn__recsys_kernelx_sr1
standalone__deep_cross_pnn__recsys_kernelx_sp2:
    s_sleep 1
    ds_read_addtid_b32 v71 offset:8080
    s_waitcnt lgkmcnt(0)
    v_readfirstlane_b32 s36, v71

    s_cmp_lt_u32 s36, s37
    s_cbranch_scc1 standalone__deep_cross_pnn__recsys_kernelx_sp2
    s_branch standalone__deep_cross_pnn__recsys_kernelx_sr2
standalone__deep_cross_pnn__recsys_kernelx_sp3:
    s_sleep 1
    ds_read_addtid_b32 v71 offset:8080
    s_waitcnt lgkmcnt(0)
    v_readfirstlane_b32 s36, v71

    s_cmp_lt_u32 s36, s37
    s_cbranch_scc1 standalone__deep_cross_pnn__recsys_kernelx_sp3
    s_branch standalone__deep_cross_pnn__recsys_kernelx_sr3
standalone__deep_cross_pnn__recsys_kernelx_fin:

    s_add_u32 s40, s20, 61440
    s_add_u32 s41, s20, 65536
    s_add_u32 s44, s20, 126976
    s_add_u32 s45, s20, 131072

    s_lshl_b32 s35, s33, 16
    s_lshl_b32 s42, s34, 15
    s_add_u32 s35, s35, s42
    s_lshl_b32 s42, s3, 12
    s_add_u32 s35, s35, s42
    s_add_u32 s35, s35, 20971520

    v_mov_b32 v128, 0xbdd2d3e8
    v_mov_b32 v129, 0xbdd2d3e8
    v_mov_b32 v130, 0xc0135761
    v_mov_b32 v131, 0xc0135761
    v_mov_b32 v132, 1.0
    v_mov_b32 v133, 1.0
    v_mov_b32 v134, s28
    v_mov_b32 v135, s29
    s_waitcnt vmcnt(6)
    v_lshlrev_b32_sdwa v88, 3, v116 dst_sel:DWORD dst_unused:UNUSED_PAD src0_sel:DWORD src1_sel:WORD_0
    v_lshlrev_b32_sdwa v90, 3, v116 dst_sel:DWORD dst_unused:UNUSED_PAD src0_sel:DWORD src1_sel:WORD_1
    ds_read_b64 v[88:89], v88
    ds_read_b64 v[90:91], v90
    v_lshlrev_b32_sdwa v92, 3, v117 dst_sel:DWORD dst_unused:UNUSED_PAD src0_sel:DWORD src1_sel:WORD_0
    v_lshlrev_b32_sdwa v94, 3, v117 dst_sel:DWORD dst_unused:UNUSED_PAD src0_sel:DWORD src1_sel:WORD_1
    ds_read_b64 v[92:93], v92
    ds_read_b64 v[94:95], v94
    s_waitcnt lgkmcnt(10)
    v_smfmac_f32_16x16x64_bf16 v[0:3], v[64:67], v[96:103], v68
    s_setprio 3
    v_mov_b32 v136, s30
    v_mov_b32 v137, s31
    v_lshrrev_b32 v70, 2, v69
    v_and_b32 v138, 128, v70
    v_add_u32 v70, v70, v138
    v_rcp_f32 v134, v134
    v_rcp_f32 v135, v135
    v_rcp_f32 v136, v136
    v_lshlrev_b32_sdwa v96, 3, v118 dst_sel:DWORD dst_unused:UNUSED_PAD src0_sel:DWORD src1_sel:WORD_0
    v_lshlrev_b32_sdwa v98, 3, v118 dst_sel:DWORD dst_unused:UNUSED_PAD src0_sel:DWORD src1_sel:WORD_1
    ds_read_b64 v[96:97], v96
    ds_read_b64 v[98:99], v98
    v_lshlrev_b32_sdwa v100, 3, v119 dst_sel:DWORD dst_unused:UNUSED_PAD src0_sel:DWORD src1_sel:WORD_0
    v_lshlrev_b32_sdwa v102, 3, v119 dst_sel:DWORD dst_unused:UNUSED_PAD src0_sel:DWORD src1_sel:WORD_1
    ds_read_b64 v[100:101], v100
    ds_read_b64 v[102:103], v102
    buffer_load_dwordx4 v[116:119], v69, s[12:15], s40 offen offset:0 sc1
    s_waitcnt lgkmcnt(8)
    v_smfmac_f32_16x16x64_bf16 v[4:7], v[64:67], v[104:111], v68
    v_rcp_f32 v137, v137
    v_mov_b32 v132, 0x7f7fffff
    v_mov_b32 v133, 0xff7fffff
    v_med3_f32 v134, v134, v132, v133
    v_med3_f32 v135, v135, v132, v133
    v_med3_f32 v136, v136, v132, v133
    v_med3_f32 v137, v137, v132, v133
    s_waitcnt vmcnt(5)
    v_lshlrev_b32_sdwa v104, 3, v120 dst_sel:DWORD dst_unused:UNUSED_PAD src0_sel:DWORD src1_sel:WORD_0
    v_lshlrev_b32_sdwa v106, 3, v120 dst_sel:DWORD dst_unused:UNUSED_PAD src0_sel:DWORD src1_sel:WORD_1
    ds_read_b64 v[104:105], v104
    ds_read_b64 v[106:107], v106
    v_lshlrev_b32_sdwa v108, 3, v121 dst_sel:DWORD dst_unused:UNUSED_PAD src0_sel:DWORD src1_sel:WORD_0
    v_lshlrev_b32_sdwa v110, 3, v121 dst_sel:DWORD dst_unused:UNUSED_PAD src0_sel:DWORD src1_sel:WORD_1
    ds_read_b64 v[108:109], v108
    ds_read_b64 v[110:111], v110
    s_waitcnt lgkmcnt(8)
    v_smfmac_f32_16x16x64_bf16 v[8:11], v[64:67], v[88:95], v68
    v_lshlrev_b32_sdwa v88, 3, v122 dst_sel:DWORD dst_unused:UNUSED_PAD src0_sel:DWORD src1_sel:WORD_0
    v_lshlrev_b32_sdwa v90, 3, v122 dst_sel:DWORD dst_unused:UNUSED_PAD src0_sel:DWORD src1_sel:WORD_1
    ds_read_b64 v[88:89], v88
    ds_read_b64 v[90:91], v90
    ds_read_addtid_b32 v71 offset:8080
    v_lshlrev_b32_sdwa v92, 3, v123 dst_sel:DWORD dst_unused:UNUSED_PAD src0_sel:DWORD src1_sel:WORD_0
    v_lshlrev_b32_sdwa v94, 3, v123 dst_sel:DWORD dst_unused:UNUSED_PAD src0_sel:DWORD src1_sel:WORD_1
    ds_read_b64 v[92:93], v92
    ds_read_b64 v[94:95], v94
    buffer_load_dwordx4 v[120:123], v69, s[12:15], s44 offen offset:0 sc1
    s_waitcnt lgkmcnt(9)
    v_smfmac_f32_16x16x64_bf16 v[12:15], v[64:67], v[96:103], v68
    s_waitcnt vmcnt(2)
    v_lshlrev_b32_sdwa v96, 3, v124 dst_sel:DWORD dst_unused:UNUSED_PAD src0_sel:DWORD src1_sel:WORD_0
    v_lshlrev_b32_sdwa v98, 3, v124 dst_sel:DWORD dst_unused:UNUSED_PAD src0_sel:DWORD src1_sel:WORD_1
    ds_read_b64 v[96:97], v96
    ds_read_b64 v[98:99], v98
    v_lshlrev_b32_sdwa v100, 3, v125 dst_sel:DWORD dst_unused:UNUSED_PAD src0_sel:DWORD src1_sel:WORD_0
    v_lshlrev_b32_sdwa v102, 3, v125 dst_sel:DWORD dst_unused:UNUSED_PAD src0_sel:DWORD src1_sel:WORD_1
    ds_read_b64 v[100:101], v100
    ds_read_b64 v[102:103], v102
    s_waitcnt lgkmcnt(9)
    v_smfmac_f32_16x16x64_bf16 v[16:19], v[64:67], v[104:111], v68
    v_lshlrev_b32_sdwa v104, 3, v126 dst_sel:DWORD dst_unused:UNUSED_PAD src0_sel:DWORD src1_sel:WORD_0
    v_lshlrev_b32_sdwa v106, 3, v126 dst_sel:DWORD dst_unused:UNUSED_PAD src0_sel:DWORD src1_sel:WORD_1
    ds_read_b64 v[104:105], v104
    ds_read_b64 v[106:107], v106
    v_lshlrev_b32_sdwa v108, 3, v127 dst_sel:DWORD dst_unused:UNUSED_PAD src0_sel:DWORD src1_sel:WORD_0
    v_lshlrev_b32_sdwa v110, 3, v127 dst_sel:DWORD dst_unused:UNUSED_PAD src0_sel:DWORD src1_sel:WORD_1
    ds_read_b64 v[108:109], v108
    ds_read_b64 v[110:111], v110
    buffer_load_dwordx4 v[124:127], v69, s[12:15], s40 offen offset:1024 sc1
    s_waitcnt lgkmcnt(8)
    v_smfmac_f32_16x16x64_bf16 v[20:23], v[64:67], v[88:95], v68
    v_readfirstlane_b32 s36, v71
    s_waitcnt vmcnt(2)
    s_cmp_lt_u32 s36, s37
    s_cbranch_scc1 standalone__deep_cross_pnn__recsys_kernelx_sp3
standalone__deep_cross_pnn__recsys_kernelx_sr3:
    v_lshlrev_b32_sdwa v88, 3, v116 dst_sel:DWORD dst_unused:UNUSED_PAD src0_sel:DWORD src1_sel:WORD_0
    v_lshlrev_b32_sdwa v90, 3, v116 dst_sel:DWORD dst_unused:UNUSED_PAD src0_sel:DWORD src1_sel:WORD_1
    ds_read_b64 v[88:89], v88
    ds_read_b64 v[90:91], v90
    v_lshlrev_b32_sdwa v92, 3, v117 dst_sel:DWORD dst_unused:UNUSED_PAD src0_sel:DWORD src1_sel:WORD_0
    v_lshlrev_b32_sdwa v94, 3, v117 dst_sel:DWORD dst_unused:UNUSED_PAD src0_sel:DWORD src1_sel:WORD_1
    ds_read_b64 v[92:93], v92
    ds_read_b64 v[94:95], v94
    s_waitcnt lgkmcnt(8)
    v_smfmac_f32_16x16x64_bf16 v[24:27], v[64:67], v[96:103], v68
    v_lshlrev_b32_sdwa v96, 3, v118 dst_sel:DWORD dst_unused:UNUSED_PAD src0_sel:DWORD src1_sel:WORD_0
    v_lshlrev_b32_sdwa v98, 3, v118 dst_sel:DWORD dst_unused:UNUSED_PAD src0_sel:DWORD src1_sel:WORD_1
    ds_read_b64 v[96:97], v96
    ds_read_b64 v[98:99], v98
    v_lshlrev_b32_sdwa v100, 3, v119 dst_sel:DWORD dst_unused:UNUSED_PAD src0_sel:DWORD src1_sel:WORD_0
    v_lshlrev_b32_sdwa v102, 3, v119 dst_sel:DWORD dst_unused:UNUSED_PAD src0_sel:DWORD src1_sel:WORD_1
    ds_read_b64 v[100:101], v100
    ds_read_b64 v[102:103], v102
    buffer_load_dwordx4 v[116:119], v69, s[12:15], s44 offen offset:1024 sc1
    s_waitcnt lgkmcnt(8)
    v_smfmac_f32_16x16x64_bf16 v[28:31], v[64:67], v[104:111], v68
    s_waitcnt vmcnt(2)
    v_lshlrev_b32_sdwa v104, 3, v120 dst_sel:DWORD dst_unused:UNUSED_PAD src0_sel:DWORD src1_sel:WORD_0
    v_lshlrev_b32_sdwa v106, 3, v120 dst_sel:DWORD dst_unused:UNUSED_PAD src0_sel:DWORD src1_sel:WORD_1
    ds_read_b64 v[104:105], v104
    ds_read_b64 v[106:107], v106
    v_lshlrev_b32_sdwa v108, 3, v121 dst_sel:DWORD dst_unused:UNUSED_PAD src0_sel:DWORD src1_sel:WORD_0
    v_lshlrev_b32_sdwa v110, 3, v121 dst_sel:DWORD dst_unused:UNUSED_PAD src0_sel:DWORD src1_sel:WORD_1
    ds_read_b64 v[108:109], v108
    ds_read_b64 v[110:111], v110
    s_waitcnt lgkmcnt(8)
    v_smfmac_f32_16x16x64_bf16 v[0:3], v[64:67], v[88:95], v68
    v_lshlrev_b32_sdwa v88, 3, v122 dst_sel:DWORD dst_unused:UNUSED_PAD src0_sel:DWORD src1_sel:WORD_0
    v_lshlrev_b32_sdwa v90, 3, v122 dst_sel:DWORD dst_unused:UNUSED_PAD src0_sel:DWORD src1_sel:WORD_1
    ds_read_b64 v[88:89], v88
    ds_read_b64 v[90:91], v90
    v_lshlrev_b32_sdwa v92, 3, v123 dst_sel:DWORD dst_unused:UNUSED_PAD src0_sel:DWORD src1_sel:WORD_0
    v_lshlrev_b32_sdwa v94, 3, v123 dst_sel:DWORD dst_unused:UNUSED_PAD src0_sel:DWORD src1_sel:WORD_1
    ds_read_b64 v[92:93], v92
    ds_read_b64 v[94:95], v94
    buffer_load_dwordx4 v[120:123], v69, s[12:15], s40 offen offset:2048 sc1
    s_waitcnt lgkmcnt(8)
    v_smfmac_f32_16x16x64_bf16 v[4:7], v[64:67], v[96:103], v68
    s_waitcnt vmcnt(2)
    v_lshlrev_b32_sdwa v96, 3, v124 dst_sel:DWORD dst_unused:UNUSED_PAD src0_sel:DWORD src1_sel:WORD_0
    v_lshlrev_b32_sdwa v98, 3, v124 dst_sel:DWORD dst_unused:UNUSED_PAD src0_sel:DWORD src1_sel:WORD_1
    ds_read_b64 v[96:97], v96
    ds_read_b64 v[98:99], v98
    v_lshlrev_b32_sdwa v100, 3, v125 dst_sel:DWORD dst_unused:UNUSED_PAD src0_sel:DWORD src1_sel:WORD_0
    v_lshlrev_b32_sdwa v102, 3, v125 dst_sel:DWORD dst_unused:UNUSED_PAD src0_sel:DWORD src1_sel:WORD_1
    ds_read_b64 v[100:101], v100
    ds_read_b64 v[102:103], v102
    s_waitcnt lgkmcnt(8)
    v_smfmac_f32_16x16x64_bf16 v[0:3], v[64:67], v[104:111], v68
    v_lshlrev_b32_sdwa v104, 3, v126 dst_sel:DWORD dst_unused:UNUSED_PAD src0_sel:DWORD src1_sel:WORD_0
    v_lshlrev_b32_sdwa v106, 3, v126 dst_sel:DWORD dst_unused:UNUSED_PAD src0_sel:DWORD src1_sel:WORD_1
    ds_read_b64 v[104:105], v104
    ds_read_b64 v[106:107], v106
    v_lshlrev_b32_sdwa v108, 3, v127 dst_sel:DWORD dst_unused:UNUSED_PAD src0_sel:DWORD src1_sel:WORD_0
    v_lshlrev_b32_sdwa v110, 3, v127 dst_sel:DWORD dst_unused:UNUSED_PAD src0_sel:DWORD src1_sel:WORD_1
    ds_read_b64 v[108:109], v108
    ds_read_b64 v[110:111], v110
    buffer_load_dwordx4 v[124:127], v69, s[12:15], s44 offen offset:2048 sc1
    s_waitcnt lgkmcnt(8)
    v_smfmac_f32_16x16x64_bf16 v[4:7], v[64:67], v[88:95], v68
    s_waitcnt vmcnt(2)
    v_lshlrev_b32_sdwa v88, 3, v116 dst_sel:DWORD dst_unused:UNUSED_PAD src0_sel:DWORD src1_sel:WORD_0
    v_lshlrev_b32_sdwa v90, 3, v116 dst_sel:DWORD dst_unused:UNUSED_PAD src0_sel:DWORD src1_sel:WORD_1
    ds_read_b64 v[88:89], v88
    ds_read_b64 v[90:91], v90
    v_lshlrev_b32_sdwa v92, 3, v117 dst_sel:DWORD dst_unused:UNUSED_PAD src0_sel:DWORD src1_sel:WORD_0
    v_lshlrev_b32_sdwa v94, 3, v117 dst_sel:DWORD dst_unused:UNUSED_PAD src0_sel:DWORD src1_sel:WORD_1
    ds_read_b64 v[92:93], v92
    ds_read_b64 v[94:95], v94
    s_waitcnt lgkmcnt(8)
    v_smfmac_f32_16x16x64_bf16 v[8:11], v[64:67], v[96:103], v68
    v_pk_mul_f32 v[140:141], v[0:1], v[0:1]
    v_pk_mul_f32 v[142:143], v[2:3], v[2:3]
    v_pk_fma_f32 v[140:141], v[140:141], v[128:129], v[130:131]
    v_pk_fma_f32 v[142:143], v[142:143], v[128:129], v[130:131]
    v_pk_mul_f32 v[140:141], v[140:141], v[0:1]
    v_pk_mul_f32 v[142:143], v[142:143], v[2:3]
    v_exp_f32 v140, v140
    v_pk_mul_f32 v[146:147], v[4:5], v[4:5]
    v_lshlrev_b32_sdwa v96, 3, v118 dst_sel:DWORD dst_unused:UNUSED_PAD src0_sel:DWORD src1_sel:WORD_0
    v_lshlrev_b32_sdwa v98, 3, v118 dst_sel:DWORD dst_unused:UNUSED_PAD src0_sel:DWORD src1_sel:WORD_1
    ds_read_b64 v[96:97], v96
    ds_read_b64 v[98:99], v98
    v_lshlrev_b32_sdwa v100, 3, v119 dst_sel:DWORD dst_unused:UNUSED_PAD src0_sel:DWORD src1_sel:WORD_0
    v_lshlrev_b32_sdwa v102, 3, v119 dst_sel:DWORD dst_unused:UNUSED_PAD src0_sel:DWORD src1_sel:WORD_1
    ds_read_b64 v[100:101], v100
    ds_read_b64 v[102:103], v102
    buffer_load_dwordx4 v[116:119], v69, s[12:15], s40 offen offset:3072 sc1
    s_waitcnt lgkmcnt(8)
    v_smfmac_f32_16x16x64_bf16 v[12:15], v[64:67], v[104:111], v68
    v_exp_f32 v141, v141
    v_pk_fma_f32 v[146:147], v[146:147], v[128:129], v[130:131]
    v_pk_mul_f32 v[148:149], v[6:7], v[6:7]
    v_exp_f32 v142, v142
    v_pk_fma_f32 v[140:141], v[140:141], v[134:135], v[134:135]
    v_pk_mul_f32 v[146:147], v[146:147], v[4:5]
    v_rcp_f32 v140, v140
    v_pk_fma_f32 v[148:149], v[148:149], v[128:129], v[130:131]
    s_waitcnt vmcnt(2)
    v_lshlrev_b32_sdwa v104, 3, v120 dst_sel:DWORD dst_unused:UNUSED_PAD src0_sel:DWORD src1_sel:WORD_0
    v_lshlrev_b32_sdwa v106, 3, v120 dst_sel:DWORD dst_unused:UNUSED_PAD src0_sel:DWORD src1_sel:WORD_1
    ds_read_b64 v[104:105], v104
    ds_read_b64 v[106:107], v106
    v_lshlrev_b32_sdwa v108, 3, v121 dst_sel:DWORD dst_unused:UNUSED_PAD src0_sel:DWORD src1_sel:WORD_0
    v_lshlrev_b32_sdwa v110, 3, v121 dst_sel:DWORD dst_unused:UNUSED_PAD src0_sel:DWORD src1_sel:WORD_1
    ds_read_b64 v[108:109], v108
    ds_read_b64 v[110:111], v110
    s_waitcnt lgkmcnt(8)
    v_smfmac_f32_16x16x64_bf16 v[8:11], v[64:67], v[88:95], v68
    v_rcp_f32 v141, v141
    v_pk_mul_f32 v[148:149], v[148:149], v[6:7]
    v_exp_f32 v143, v143
    v_pk_mul_f32 v[144:145], v[0:1], v[140:141]
    v_exp_f32 v146, v146
    v_pk_fma_f32 v[142:143], v[142:143], v[136:137], v[136:137]
    v_exp_f32 v147, v147
    v_rcp_f32 v142, v142
    v_lshlrev_b32_sdwa v88, 3, v122 dst_sel:DWORD dst_unused:UNUSED_PAD src0_sel:DWORD src1_sel:WORD_0
    v_lshlrev_b32_sdwa v90, 3, v122 dst_sel:DWORD dst_unused:UNUSED_PAD src0_sel:DWORD src1_sel:WORD_1
    ds_read_b64 v[88:89], v88
    ds_read_b64 v[90:91], v90
    v_lshlrev_b32_sdwa v92, 3, v123 dst_sel:DWORD dst_unused:UNUSED_PAD src0_sel:DWORD src1_sel:WORD_0
    v_lshlrev_b32_sdwa v94, 3, v123 dst_sel:DWORD dst_unused:UNUSED_PAD src0_sel:DWORD src1_sel:WORD_1
    ds_read_b64 v[92:93], v92
    ds_read_b64 v[94:95], v94
    buffer_load_dwordx4 v[120:123], v69, s[12:15], s44 offen offset:3072 sc1
    s_waitcnt lgkmcnt(8)
    v_smfmac_f32_16x16x64_bf16 v[12:15], v[64:67], v[96:103], v68
    v_rcp_f32 v143, v143
    v_pk_fma_f32 v[146:147], v[146:147], v[134:135], v[134:135]
    v_pk_mul_f32 v[152:153], v[8:9], v[8:9]
    v_rcp_f32 v146, v146
    v_pk_fma_f32 v[144:145], v[2:3], v[142:143], v[144:145]
    v_pk_fma_f32 v[152:153], v[152:153], v[128:129], v[130:131]
    v_rcp_f32 v147, v147
    v_add_f32 v144, v144, v145
    s_waitcnt vmcnt(2)
    v_lshlrev_b32_sdwa v96, 3, v124 dst_sel:DWORD dst_unused:UNUSED_PAD src0_sel:DWORD src1_sel:WORD_0
    v_lshlrev_b32_sdwa v98, 3, v124 dst_sel:DWORD dst_unused:UNUSED_PAD src0_sel:DWORD src1_sel:WORD_1
    ds_read_b64 v[96:97], v96
    ds_read_b64 v[98:99], v98
    v_lshlrev_b32_sdwa v100, 3, v125 dst_sel:DWORD dst_unused:UNUSED_PAD src0_sel:DWORD src1_sel:WORD_0
    v_lshlrev_b32_sdwa v102, 3, v125 dst_sel:DWORD dst_unused:UNUSED_PAD src0_sel:DWORD src1_sel:WORD_1
    ds_read_b64 v[100:101], v100
    ds_read_b64 v[102:103], v102
    s_waitcnt lgkmcnt(8)
    v_smfmac_f32_16x16x64_bf16 v[16:19], v[64:67], v[104:111], v68
    v_exp_f32 v148, v148
    buffer_store_dword v144, v70, s[12:15], s35 offen offset:0 sc1
    v_pk_mul_f32 v[150:151], v[4:5], v[146:147]
    v_exp_f32 v149, v149
    v_pk_mul_f32 v[152:153], v[152:153], v[8:9]
    v_pk_mul_f32 v[154:155], v[10:11], v[10:11]
    v_exp_f32 v152, v152
    v_pk_fma_f32 v[148:149], v[148:149], v[136:137], v[136:137]
    v_lshlrev_b32_sdwa v104, 3, v126 dst_sel:DWORD dst_unused:UNUSED_PAD src0_sel:DWORD src1_sel:WORD_0
    v_lshlrev_b32_sdwa v106, 3, v126 dst_sel:DWORD dst_unused:UNUSED_PAD src0_sel:DWORD src1_sel:WORD_1
    ds_read_b64 v[104:105], v104
    ds_read_b64 v[106:107], v106
    v_lshlrev_b32_sdwa v108, 3, v127 dst_sel:DWORD dst_unused:UNUSED_PAD src0_sel:DWORD src1_sel:WORD_0
    v_lshlrev_b32_sdwa v110, 3, v127 dst_sel:DWORD dst_unused:UNUSED_PAD src0_sel:DWORD src1_sel:WORD_1
    ds_read_b64 v[108:109], v108
    ds_read_b64 v[110:111], v110
    buffer_load_dwordx4 v[124:127], v69, s[12:15], s20 offen offset:0 sc1
    s_waitcnt lgkmcnt(8)
    v_smfmac_f32_16x16x64_bf16 v[20:23], v[64:67], v[88:95], v68
    v_rcp_f32 v148, v148
    v_pk_fma_f32 v[154:155], v[154:155], v[128:129], v[130:131]
    v_pk_mul_f32 v[158:159], v[12:13], v[12:13]
    v_rcp_f32 v149, v149
    v_pk_mul_f32 v[154:155], v[154:155], v[10:11]
    v_pk_fma_f32 v[158:159], v[158:159], v[128:129], v[130:131]
    v_exp_f32 v153, v153
    v_pk_fma_f32 v[150:151], v[6:7], v[148:149], v[150:151]
    s_waitcnt vmcnt(3)
    v_lshlrev_b32_sdwa v88, 3, v116 dst_sel:DWORD dst_unused:UNUSED_PAD src0_sel:DWORD src1_sel:WORD_0
    v_lshlrev_b32_sdwa v90, 3, v116 dst_sel:DWORD dst_unused:UNUSED_PAD src0_sel:DWORD src1_sel:WORD_1
    ds_read_b64 v[88:89], v88
    ds_read_b64 v[90:91], v90
    v_lshlrev_b32_sdwa v92, 3, v117 dst_sel:DWORD dst_unused:UNUSED_PAD src0_sel:DWORD src1_sel:WORD_0
    v_lshlrev_b32_sdwa v94, 3, v117 dst_sel:DWORD dst_unused:UNUSED_PAD src0_sel:DWORD src1_sel:WORD_1
    ds_read_b64 v[92:93], v92
    ds_read_b64 v[94:95], v94
    s_waitcnt lgkmcnt(8)
    v_smfmac_f32_16x16x64_bf16 v[16:19], v[64:67], v[96:103], v68
    v_exp_f32 v154, v154
    v_add_f32 v150, v150, v151
    v_pk_fma_f32 v[152:153], v[152:153], v[134:135], v[134:135]
    v_exp_f32 v155, v155
    buffer_store_dword v150, v70, s[12:15], s35 offen offset:128 sc1
    v_pk_mul_f32 v[158:159], v[158:159], v[12:13]
    v_rcp_f32 v152, v152
    v_pk_fma_f32 v[154:155], v[154:155], v[136:137], v[136:137]
    v_lshlrev_b32_sdwa v96, 3, v118 dst_sel:DWORD dst_unused:UNUSED_PAD src0_sel:DWORD src1_sel:WORD_0
    v_lshlrev_b32_sdwa v98, 3, v118 dst_sel:DWORD dst_unused:UNUSED_PAD src0_sel:DWORD src1_sel:WORD_1
    ds_read_b64 v[96:97], v96
    ds_read_b64 v[98:99], v98
    v_lshlrev_b32_sdwa v100, 3, v119 dst_sel:DWORD dst_unused:UNUSED_PAD src0_sel:DWORD src1_sel:WORD_0
    v_lshlrev_b32_sdwa v102, 3, v119 dst_sel:DWORD dst_unused:UNUSED_PAD src0_sel:DWORD src1_sel:WORD_1
    ds_read_b64 v[100:101], v100
    ds_read_b64 v[102:103], v102
    buffer_load_dwordx4 v[116:119], v69, s[12:15], s41 offen offset:0 sc1
    s_waitcnt lgkmcnt(8)
    v_smfmac_f32_16x16x64_bf16 v[20:23], v[64:67], v[104:111], v68
    v_rcp_f32 v153, v153
    v_pk_mul_f32 v[160:161], v[14:15], v[14:15]
    v_pk_mul_f32 v[164:165], v[16:17], v[16:17]
    v_rcp_f32 v154, v154
    v_pk_mul_f32 v[156:157], v[8:9], v[152:153]
    v_pk_fma_f32 v[160:161], v[160:161], v[128:129], v[130:131]
    v_rcp_f32 v155, v155
    v_pk_mul_f32 v[160:161], v[160:161], v[14:15]
    s_waitcnt vmcnt(4)
    v_lshlrev_b32_sdwa v104, 3, v120 dst_sel:DWORD dst_unused:UNUSED_PAD src0_sel:DWORD src1_sel:WORD_0
    v_lshlrev_b32_sdwa v106, 3, v120 dst_sel:DWORD dst_unused:UNUSED_PAD src0_sel:DWORD src1_sel:WORD_1
    ds_read_b64 v[104:105], v104
    ds_read_b64 v[106:107], v106
    v_lshlrev_b32_sdwa v108, 3, v121 dst_sel:DWORD dst_unused:UNUSED_PAD src0_sel:DWORD src1_sel:WORD_0
    v_lshlrev_b32_sdwa v110, 3, v121 dst_sel:DWORD dst_unused:UNUSED_PAD src0_sel:DWORD src1_sel:WORD_1
    ds_read_b64 v[108:109], v108
    ds_read_b64 v[110:111], v110
    s_waitcnt lgkmcnt(8)
    v_smfmac_f32_16x16x64_bf16 v[24:27], v[64:67], v[88:95], v68
    v_exp_f32 v158, v158
    v_pk_fma_f32 v[156:157], v[10:11], v[154:155], v[156:157]
    v_pk_fma_f32 v[164:165], v[164:165], v[128:129], v[130:131]
    v_exp_f32 v159, v159
    v_add_f32 v156, v156, v157
    v_pk_mul_f32 v[164:165], v[164:165], v[16:17]
    v_exp_f32 v160, v160
    buffer_store_dword v156, v70, s[12:15], s35 offen offset:512 sc1
    v_lshlrev_b32_sdwa v88, 3, v122 dst_sel:DWORD dst_unused:UNUSED_PAD src0_sel:DWORD src1_sel:WORD_0
    v_lshlrev_b32_sdwa v90, 3, v122 dst_sel:DWORD dst_unused:UNUSED_PAD src0_sel:DWORD src1_sel:WORD_1
    ds_read_b64 v[88:89], v88
    ds_read_b64 v[90:91], v90
    v_lshlrev_b32_sdwa v92, 3, v123 dst_sel:DWORD dst_unused:UNUSED_PAD src0_sel:DWORD src1_sel:WORD_0
    v_lshlrev_b32_sdwa v94, 3, v123 dst_sel:DWORD dst_unused:UNUSED_PAD src0_sel:DWORD src1_sel:WORD_1
    ds_read_b64 v[92:93], v92
    ds_read_b64 v[94:95], v94
    buffer_load_dwordx4 v[120:123], v69, s[12:15], s45 offen offset:0 sc1
    s_waitcnt lgkmcnt(8)
    v_smfmac_f32_16x16x64_bf16 v[28:31], v[64:67], v[96:103], v68
    v_exp_f32 v161, v161
    v_pk_fma_f32 v[158:159], v[158:159], v[134:135], v[134:135]
    v_pk_mul_f32 v[166:167], v[18:19], v[18:19]
    v_rcp_f32 v158, v158
    v_pk_fma_f32 v[160:161], v[160:161], v[136:137], v[136:137]
    v_pk_fma_f32 v[166:167], v[166:167], v[128:129], v[130:131]
    v_rcp_f32 v159, v159
    v_pk_mul_f32 v[166:167], v[166:167], v[18:19]
    s_waitcnt vmcnt(4)
    v_lshlrev_b32_sdwa v96, 3, v124 dst_sel:DWORD dst_unused:UNUSED_PAD src0_sel:DWORD src1_sel:WORD_0
    v_lshlrev_b32_sdwa v98, 3, v124 dst_sel:DWORD dst_unused:UNUSED_PAD src0_sel:DWORD src1_sel:WORD_1
    ds_read_b64 v[96:97], v96
    ds_read_b64 v[98:99], v98
    v_lshlrev_b32_sdwa v100, 3, v125 dst_sel:DWORD dst_unused:UNUSED_PAD src0_sel:DWORD src1_sel:WORD_0
    v_lshlrev_b32_sdwa v102, 3, v125 dst_sel:DWORD dst_unused:UNUSED_PAD src0_sel:DWORD src1_sel:WORD_1
    ds_read_b64 v[100:101], v100
    ds_read_b64 v[102:103], v102
    s_waitcnt lgkmcnt(8)
    v_smfmac_f32_16x16x64_bf16 v[24:27], v[64:67], v[104:111], v68
    v_rcp_f32 v160, v160
    v_pk_mul_f32 v[162:163], v[12:13], v[158:159]
    v_pk_mul_f32 v[170:171], v[20:21], v[20:21]
    v_rcp_f32 v161, v161
    v_pk_fma_f32 v[170:171], v[170:171], v[128:129], v[130:131]
    v_pk_mul_f32 v[172:173], v[22:23], v[22:23]
    v_exp_f32 v164, v164
    v_pk_fma_f32 v[162:163], v[14:15], v[160:161], v[162:163]
    v_lshlrev_b32_sdwa v104, 3, v126 dst_sel:DWORD dst_unused:UNUSED_PAD src0_sel:DWORD src1_sel:WORD_0
    v_lshlrev_b32_sdwa v106, 3, v126 dst_sel:DWORD dst_unused:UNUSED_PAD src0_sel:DWORD src1_sel:WORD_1
    ds_read_b64 v[104:105], v104
    ds_read_b64 v[106:107], v106
    v_lshlrev_b32_sdwa v108, 3, v127 dst_sel:DWORD dst_unused:UNUSED_PAD src0_sel:DWORD src1_sel:WORD_0
    v_lshlrev_b32_sdwa v110, 3, v127 dst_sel:DWORD dst_unused:UNUSED_PAD src0_sel:DWORD src1_sel:WORD_1
    ds_read_b64 v[108:109], v108
    ds_read_b64 v[110:111], v110
    buffer_load_dwordx4 v[124:127], v69, s[12:15], s20 offen offset:1024 sc1
    s_waitcnt lgkmcnt(8)
    v_smfmac_f32_16x16x64_bf16 v[28:31], v[64:67], v[88:95], v68
    s_setprio 2
    v_exp_f32 v165, v165
    v_add_f32 v162, v162, v163
    v_pk_mul_f32 v[170:171], v[170:171], v[20:21]
    v_exp_f32 v166, v166
    buffer_store_dword v162, v70, s[12:15], s35 offen offset:640 sc1
    v_pk_fma_f32 v[164:165], v[164:165], v[134:135], v[134:135]
    v_exp_f32 v167, v167
    v_pk_fma_f32 v[172:173], v[172:173], v[128:129], v[130:131]
    s_waitcnt vmcnt(4)
    v_lshlrev_b32_sdwa v88, 3, v116 dst_sel:DWORD dst_unused:UNUSED_PAD src0_sel:DWORD src1_sel:WORD_0
    v_lshlrev_b32_sdwa v90, 3, v116 dst_sel:DWORD dst_unused:UNUSED_PAD src0_sel:DWORD src1_sel:WORD_1
    ds_read_b64 v[88:89], v88
    ds_read_b64 v[90:91], v90
    v_lshlrev_b32_sdwa v92, 3, v117 dst_sel:DWORD dst_unused:UNUSED_PAD src0_sel:DWORD src1_sel:WORD_0
    v_lshlrev_b32_sdwa v94, 3, v117 dst_sel:DWORD dst_unused:UNUSED_PAD src0_sel:DWORD src1_sel:WORD_1
    ds_read_b64 v[92:93], v92
    ds_read_b64 v[94:95], v94
    s_waitcnt lgkmcnt(8)
    v_smfmac_f32_16x16x64_bf16 v[32:35], v[64:67], v[96:103], v68
    v_rcp_f32 v164, v164
    v_pk_fma_f32 v[166:167], v[166:167], v[136:137], v[136:137]
    v_pk_mul_f32 v[172:173], v[172:173], v[22:23]
    v_rcp_f32 v165, v165
    v_pk_mul_f32 v[140:141], v[24:25], v[24:25]
    v_pk_mul_f32 v[142:143], v[26:27], v[26:27]
    v_rcp_f32 v166, v166
    v_pk_mul_f32 v[168:169], v[16:17], v[164:165]
    v_lshlrev_b32_sdwa v96, 3, v118 dst_sel:DWORD dst_unused:UNUSED_PAD src0_sel:DWORD src1_sel:WORD_0
    v_lshlrev_b32_sdwa v98, 3, v118 dst_sel:DWORD dst_unused:UNUSED_PAD src0_sel:DWORD src1_sel:WORD_1
    ds_read_b64 v[96:97], v96
    ds_read_b64 v[98:99], v98
    v_lshlrev_b32_sdwa v100, 3, v119 dst_sel:DWORD dst_unused:UNUSED_PAD src0_sel:DWORD src1_sel:WORD_0
    v_lshlrev_b32_sdwa v102, 3, v119 dst_sel:DWORD dst_unused:UNUSED_PAD src0_sel:DWORD src1_sel:WORD_1
    ds_read_b64 v[100:101], v100
    ds_read_b64 v[102:103], v102
    buffer_load_dwordx4 v[116:119], v69, s[12:15], s41 offen offset:1024 sc1
    s_waitcnt lgkmcnt(8)
    v_smfmac_f32_16x16x64_bf16 v[36:39], v[64:67], v[104:111], v68
    v_rcp_f32 v167, v167
    v_pk_fma_f32 v[140:141], v[140:141], v[128:129], v[130:131]
    v_pk_fma_f32 v[142:143], v[142:143], v[128:129], v[130:131]
    v_exp_f32 v170, v170
    v_pk_fma_f32 v[168:169], v[18:19], v[166:167], v[168:169]
    v_pk_mul_f32 v[140:141], v[140:141], v[24:25]
    v_exp_f32 v171, v171
    v_add_f32 v168, v168, v169
    s_waitcnt vmcnt(3)
    v_lshlrev_b32_sdwa v104, 3, v120 dst_sel:DWORD dst_unused:UNUSED_PAD src0_sel:DWORD src1_sel:WORD_0
    v_lshlrev_b32_sdwa v106, 3, v120 dst_sel:DWORD dst_unused:UNUSED_PAD src0_sel:DWORD src1_sel:WORD_1
    ds_read_b64 v[104:105], v104
    ds_read_b64 v[106:107], v106
    v_lshlrev_b32_sdwa v108, 3, v121 dst_sel:DWORD dst_unused:UNUSED_PAD src0_sel:DWORD src1_sel:WORD_0
    v_lshlrev_b32_sdwa v110, 3, v121 dst_sel:DWORD dst_unused:UNUSED_PAD src0_sel:DWORD src1_sel:WORD_1
    ds_read_b64 v[108:109], v108
    ds_read_b64 v[110:111], v110
    s_waitcnt lgkmcnt(8)
    v_smfmac_f32_16x16x64_bf16 v[32:35], v[64:67], v[88:95], v68
    v_exp_f32 v172, v172
    buffer_store_dword v168, v70, s[12:15], s35 offen offset:1024 sc1
    v_pk_fma_f32 v[170:171], v[170:171], v[134:135], v[134:135]
    v_exp_f32 v173, v173
    v_pk_mul_f32 v[142:143], v[142:143], v[26:27]
    v_pk_mul_f32 v[146:147], v[28:29], v[28:29]
    v_rcp_f32 v170, v170
    v_pk_fma_f32 v[172:173], v[172:173], v[136:137], v[136:137]
    v_lshlrev_b32_sdwa v88, 3, v122 dst_sel:DWORD dst_unused:UNUSED_PAD src0_sel:DWORD src1_sel:WORD_0
    v_lshlrev_b32_sdwa v90, 3, v122 dst_sel:DWORD dst_unused:UNUSED_PAD src0_sel:DWORD src1_sel:WORD_1
    ds_read_b64 v[88:89], v88
    ds_read_b64 v[90:91], v90
    v_lshlrev_b32_sdwa v92, 3, v123 dst_sel:DWORD dst_unused:UNUSED_PAD src0_sel:DWORD src1_sel:WORD_0
    v_lshlrev_b32_sdwa v94, 3, v123 dst_sel:DWORD dst_unused:UNUSED_PAD src0_sel:DWORD src1_sel:WORD_1
    ds_read_b64 v[92:93], v92
    ds_read_b64 v[94:95], v94
    buffer_load_dwordx4 v[120:123], v69, s[12:15], s45 offen offset:1024 sc1
    s_waitcnt lgkmcnt(8)
    v_smfmac_f32_16x16x64_bf16 v[36:39], v[64:67], v[96:103], v68
    v_rcp_f32 v171, v171
    v_pk_fma_f32 v[146:147], v[146:147], v[128:129], v[130:131]
    v_pk_mul_f32 v[148:149], v[30:31], v[30:31]
    v_rcp_f32 v172, v172
    v_pk_mul_f32 v[174:175], v[20:21], v[170:171]
    v_pk_mul_f32 v[146:147], v[146:147], v[28:29]
    v_rcp_f32 v173, v173
    v_pk_fma_f32 v[148:149], v[148:149], v[128:129], v[130:131]
    s_waitcnt vmcnt(4)
    v_lshlrev_b32_sdwa v96, 3, v124 dst_sel:DWORD dst_unused:UNUSED_PAD src0_sel:DWORD src1_sel:WORD_0
    v_lshlrev_b32_sdwa v98, 3, v124 dst_sel:DWORD dst_unused:UNUSED_PAD src0_sel:DWORD src1_sel:WORD_1
    ds_read_b64 v[96:97], v96
    ds_read_b64 v[98:99], v98
    v_lshlrev_b32_sdwa v100, 3, v125 dst_sel:DWORD dst_unused:UNUSED_PAD src0_sel:DWORD src1_sel:WORD_0
    v_lshlrev_b32_sdwa v102, 3, v125 dst_sel:DWORD dst_unused:UNUSED_PAD src0_sel:DWORD src1_sel:WORD_1
    ds_read_b64 v[100:101], v100
    ds_read_b64 v[102:103], v102
    s_waitcnt lgkmcnt(8)
    v_smfmac_f32_16x16x64_bf16 v[32:35], v[64:67], v[104:111], v68
    v_exp_f32 v140, v140
    v_pk_fma_f32 v[174:175], v[22:23], v[172:173], v[174:175]
    v_pk_mul_f32 v[148:149], v[148:149], v[30:31]
    v_exp_f32 v141, v141
    v_add_f32 v174, v174, v175
    v_exp_f32 v142, v142
    buffer_store_dword v174, v70, s[12:15], s35 offen offset:1152 sc1
    v_pk_fma_f32 v[140:141], v[140:141], v[134:135], v[134:135]
    v_lshlrev_b32_sdwa v104, 3, v126 dst_sel:DWORD dst_unused:UNUSED_PAD src0_sel:DWORD src1_sel:WORD_0
    v_lshlrev_b32_sdwa v106, 3, v126 dst_sel:DWORD dst_unused:UNUSED_PAD src0_sel:DWORD src1_sel:WORD_1
    ds_read_b64 v[104:105], v104
    ds_read_b64 v[106:107], v106
    v_lshlrev_b32_sdwa v108, 3, v127 dst_sel:DWORD dst_unused:UNUSED_PAD src0_sel:DWORD src1_sel:WORD_0
    v_lshlrev_b32_sdwa v110, 3, v127 dst_sel:DWORD dst_unused:UNUSED_PAD src0_sel:DWORD src1_sel:WORD_1
    ds_read_b64 v[108:109], v108
    ds_read_b64 v[110:111], v110
    buffer_load_dwordx4 v[124:127], v69, s[12:15], s20 offen offset:2048 sc1
    s_waitcnt lgkmcnt(8)
    v_smfmac_f32_16x16x64_bf16 v[36:39], v[64:67], v[88:95], v68
    v_rcp_f32 v140, v140
    v_pk_mul_f32 v[152:153], v[32:33], v[32:33]
    v_pk_mul_f32 v[154:155], v[34:35], v[34:35]
    v_rcp_f32 v141, v141
    v_pk_fma_f32 v[152:153], v[152:153], v[128:129], v[130:131]
    v_pk_fma_f32 v[154:155], v[154:155], v[128:129], v[130:131]
    v_exp_f32 v143, v143
    v_pk_mul_f32 v[144:145], v[24:25], v[140:141]
    s_waitcnt vmcnt(4)
    v_lshlrev_b32_sdwa v88, 3, v116 dst_sel:DWORD dst_unused:UNUSED_PAD src0_sel:DWORD src1_sel:WORD_0
    v_lshlrev_b32_sdwa v90, 3, v116 dst_sel:DWORD dst_unused:UNUSED_PAD src0_sel:DWORD src1_sel:WORD_1
    ds_read_b64 v[88:89], v88
    ds_read_b64 v[90:91], v90
    v_lshlrev_b32_sdwa v92, 3, v117 dst_sel:DWORD dst_unused:UNUSED_PAD src0_sel:DWORD src1_sel:WORD_0
    v_lshlrev_b32_sdwa v94, 3, v117 dst_sel:DWORD dst_unused:UNUSED_PAD src0_sel:DWORD src1_sel:WORD_1
    ds_read_b64 v[92:93], v92
    ds_read_b64 v[94:95], v94
    s_waitcnt lgkmcnt(8)
    v_smfmac_f32_16x16x64_bf16 v[40:43], v[64:67], v[96:103], v68
    v_exp_f32 v146, v146
    v_pk_fma_f32 v[142:143], v[142:143], v[136:137], v[136:137]
    v_pk_mul_f32 v[152:153], v[152:153], v[32:33]
    v_rcp_f32 v142, v142
    v_pk_mul_f32 v[154:155], v[154:155], v[34:35]
    v_pk_mul_f32 v[158:159], v[36:37], v[36:37]
    v_rcp_f32 v143, v143
    v_pk_fma_f32 v[158:159], v[158:159], v[128:129], v[130:131]
    v_lshlrev_b32_sdwa v96, 3, v118 dst_sel:DWORD dst_unused:UNUSED_PAD src0_sel:DWORD src1_sel:WORD_0
    v_lshlrev_b32_sdwa v98, 3, v118 dst_sel:DWORD dst_unused:UNUSED_PAD src0_sel:DWORD src1_sel:WORD_1
    ds_read_b64 v[96:97], v96
    ds_read_b64 v[98:99], v98
    v_lshlrev_b32_sdwa v100, 3, v119 dst_sel:DWORD dst_unused:UNUSED_PAD src0_sel:DWORD src1_sel:WORD_0
    v_lshlrev_b32_sdwa v102, 3, v119 dst_sel:DWORD dst_unused:UNUSED_PAD src0_sel:DWORD src1_sel:WORD_1
    ds_read_b64 v[100:101], v100
    ds_read_b64 v[102:103], v102
    buffer_load_dwordx4 v[116:119], v69, s[12:15], s41 offen offset:2048 sc1
    s_waitcnt lgkmcnt(8)
    v_smfmac_f32_16x16x64_bf16 v[44:47], v[64:67], v[104:111], v68
    v_exp_f32 v147, v147
    v_pk_fma_f32 v[144:145], v[26:27], v[142:143], v[144:145]
    v_pk_mul_f32 v[158:159], v[158:159], v[36:37]
    v_exp_f32 v148, v148
    v_add_f32 v144, v144, v145
    v_pk_fma_f32 v[146:147], v[146:147], v[134:135], v[134:135]
    v_exp_f32 v149, v149
    buffer_store_dword v144, v70, s[12:15], s35 offen offset:1536 sc1
    s_waitcnt vmcnt(4)
    v_lshlrev_b32_sdwa v104, 3, v120 dst_sel:DWORD dst_unused:UNUSED_PAD src0_sel:DWORD src1_sel:WORD_0
    v_lshlrev_b32_sdwa v106, 3, v120 dst_sel:DWORD dst_unused:UNUSED_PAD src0_sel:DWORD src1_sel:WORD_1
    ds_read_b64 v[104:105], v104
    ds_read_b64 v[106:107], v106
    v_lshlrev_b32_sdwa v108, 3, v121 dst_sel:DWORD dst_unused:UNUSED_PAD src0_sel:DWORD src1_sel:WORD_0
    v_lshlrev_b32_sdwa v110, 3, v121 dst_sel:DWORD dst_unused:UNUSED_PAD src0_sel:DWORD src1_sel:WORD_1
    ds_read_b64 v[108:109], v108
    ds_read_b64 v[110:111], v110
    s_waitcnt lgkmcnt(8)
    v_smfmac_f32_16x16x64_bf16 v[40:43], v[64:67], v[88:95], v68
    v_rcp_f32 v146, v146
    v_pk_fma_f32 v[148:149], v[148:149], v[136:137], v[136:137]
    v_pk_mul_f32 v[160:161], v[38:39], v[38:39]
    v_rcp_f32 v147, v147
    v_pk_fma_f32 v[160:161], v[160:161], v[128:129], v[130:131]
    v_rcp_f32 v148, v148
    v_pk_mul_f32 v[150:151], v[28:29], v[146:147]
    v_pk_mul_f32 v[160:161], v[160:161], v[38:39]
    v_lshlrev_b32_sdwa v88, 3, v122 dst_sel:DWORD dst_unused:UNUSED_PAD src0_sel:DWORD src1_sel:WORD_0
    v_lshlrev_b32_sdwa v90, 3, v122 dst_sel:DWORD dst_unused:UNUSED_PAD src0_sel:DWORD src1_sel:WORD_1
    ds_read_b64 v[88:89], v88
    ds_read_b64 v[90:91], v90
    v_lshlrev_b32_sdwa v92, 3, v123 dst_sel:DWORD dst_unused:UNUSED_PAD src0_sel:DWORD src1_sel:WORD_0
    v_lshlrev_b32_sdwa v94, 3, v123 dst_sel:DWORD dst_unused:UNUSED_PAD src0_sel:DWORD src1_sel:WORD_1
    ds_read_b64 v[92:93], v92
    ds_read_b64 v[94:95], v94
    buffer_load_dwordx4 v[120:123], v69, s[12:15], s45 offen offset:2048 sc1
    s_waitcnt lgkmcnt(8)
    v_smfmac_f32_16x16x64_bf16 v[44:47], v[64:67], v[96:103], v68
    v_rcp_f32 v149, v149
    v_exp_f32 v152, v152
    v_exp_f32 v153, v153
    v_pk_fma_f32 v[150:151], v[30:31], v[148:149], v[150:151]
    v_exp_f32 v154, v154
    v_add_f32 v150, v150, v151
    v_pk_fma_f32 v[152:153], v[152:153], v[134:135], v[134:135]
    v_exp_f32 v155, v155
    s_waitcnt vmcnt(3)
    v_lshlrev_b32_sdwa v96, 3, v124 dst_sel:DWORD dst_unused:UNUSED_PAD src0_sel:DWORD src1_sel:WORD_0
    v_lshlrev_b32_sdwa v98, 3, v124 dst_sel:DWORD dst_unused:UNUSED_PAD src0_sel:DWORD src1_sel:WORD_1
    ds_read_b64 v[96:97], v96
    ds_read_b64 v[98:99], v98
    v_lshlrev_b32_sdwa v100, 3, v125 dst_sel:DWORD dst_unused:UNUSED_PAD src0_sel:DWORD src1_sel:WORD_0
    v_lshlrev_b32_sdwa v102, 3, v125 dst_sel:DWORD dst_unused:UNUSED_PAD src0_sel:DWORD src1_sel:WORD_1
    ds_read_b64 v[100:101], v100
    ds_read_b64 v[102:103], v102
    s_waitcnt lgkmcnt(8)
    v_smfmac_f32_16x16x64_bf16 v[40:43], v[64:67], v[104:111], v68
    v_rcp_f32 v152, v152
    buffer_store_dword v150, v70, s[12:15], s35 offen offset:1664 sc1
    v_pk_fma_f32 v[154:155], v[154:155], v[136:137], v[136:137]
    v_rcp_f32 v153, v153
    v_rcp_f32 v154, v154
    v_rcp_f32 v155, v155
    v_pk_mul_f32 v[156:157], v[32:33], v[152:153]
    v_exp_f32 v158, v158
    v_lshlrev_b32_sdwa v104, 3, v126 dst_sel:DWORD dst_unused:UNUSED_PAD src0_sel:DWORD src1_sel:WORD_0
    v_lshlrev_b32_sdwa v106, 3, v126 dst_sel:DWORD dst_unused:UNUSED_PAD src0_sel:DWORD src1_sel:WORD_1
    ds_read_b64 v[104:105], v104
    ds_read_b64 v[106:107], v106
    v_lshlrev_b32_sdwa v108, 3, v127 dst_sel:DWORD dst_unused:UNUSED_PAD src0_sel:DWORD src1_sel:WORD_0
    v_lshlrev_b32_sdwa v110, 3, v127 dst_sel:DWORD dst_unused:UNUSED_PAD src0_sel:DWORD src1_sel:WORD_1
    ds_read_b64 v[108:109], v108
    ds_read_b64 v[110:111], v110
    buffer_load_dwordx4 v[124:127], v69, s[12:15], s20 offen offset:3072 sc1
    s_waitcnt lgkmcnt(8)
    v_smfmac_f32_16x16x64_bf16 v[44:47], v[64:67], v[88:95], v68
    v_exp_f32 v159, v159
    v_pk_fma_f32 v[156:157], v[34:35], v[154:155], v[156:157]
    v_pk_mul_f32 v[164:165], v[40:41], v[40:41]
    v_exp_f32 v160, v160
    v_add_f32 v156, v156, v157
    v_pk_fma_f32 v[158:159], v[158:159], v[134:135], v[134:135]
    v_exp_f32 v161, v161
    buffer_store_dword v156, v70, s[12:15], s35 offen offset:2048 sc1
    s_waitcnt vmcnt(5)
    v_lshlrev_b32_sdwa v88, 3, v116 dst_sel:DWORD dst_unused:UNUSED_PAD src0_sel:DWORD src1_sel:WORD_0
    v_lshlrev_b32_sdwa v90, 3, v116 dst_sel:DWORD dst_unused:UNUSED_PAD src0_sel:DWORD src1_sel:WORD_1
    ds_read_b64 v[88:89], v88
    ds_read_b64 v[90:91], v90
    v_lshlrev_b32_sdwa v92, 3, v117 dst_sel:DWORD dst_unused:UNUSED_PAD src0_sel:DWORD src1_sel:WORD_0
    v_lshlrev_b32_sdwa v94, 3, v117 dst_sel:DWORD dst_unused:UNUSED_PAD src0_sel:DWORD src1_sel:WORD_1
    ds_read_b64 v[92:93], v92
    ds_read_b64 v[94:95], v94
    s_waitcnt lgkmcnt(8)
    v_smfmac_f32_16x16x64_bf16 v[48:51], v[64:67], v[96:103], v68
    v_rcp_f32 v158, v158
    v_pk_fma_f32 v[160:161], v[160:161], v[136:137], v[136:137]
    v_pk_fma_f32 v[164:165], v[164:165], v[128:129], v[130:131]
    v_rcp_f32 v159, v159
    v_pk_mul_f32 v[164:165], v[164:165], v[40:41]
    v_pk_mul_f32 v[166:167], v[42:43], v[42:43]
    v_rcp_f32 v160, v160
    v_pk_mul_f32 v[162:163], v[36:37], v[158:159]
    v_lshlrev_b32_sdwa v96, 3, v118 dst_sel:DWORD dst_unused:UNUSED_PAD src0_sel:DWORD src1_sel:WORD_0
    v_lshlrev_b32_sdwa v98, 3, v118 dst_sel:DWORD dst_unused:UNUSED_PAD src0_sel:DWORD src1_sel:WORD_1
    ds_read_b64 v[96:97], v96
    ds_read_b64 v[98:99], v98
    v_lshlrev_b32_sdwa v100, 3, v119 dst_sel:DWORD dst_unused:UNUSED_PAD src0_sel:DWORD src1_sel:WORD_0
    v_lshlrev_b32_sdwa v102, 3, v119 dst_sel:DWORD dst_unused:UNUSED_PAD src0_sel:DWORD src1_sel:WORD_1
    ds_read_b64 v[100:101], v100
    ds_read_b64 v[102:103], v102
    buffer_load_dwordx4 v[116:119], v69, s[12:15], s41 offen offset:3072 sc1
    s_waitcnt lgkmcnt(8)
    v_smfmac_f32_16x16x64_bf16 v[52:55], v[64:67], v[104:111], v68
    s_setprio 1
    v_rcp_f32 v161, v161
    v_pk_fma_f32 v[166:167], v[166:167], v[128:129], v[130:131]
    v_pk_mul_f32 v[170:171], v[44:45], v[44:45]
    v_exp_f32 v164, v164
    v_pk_fma_f32 v[162:163], v[38:39], v[160:161], v[162:163]
    v_pk_mul_f32 v[166:167], v[166:167], v[42:43]
    v_exp_f32 v165, v165
    v_add_f32 v162, v162, v163
    s_waitcnt vmcnt(4)
    v_lshlrev_b32_sdwa v104, 3, v120 dst_sel:DWORD dst_unused:UNUSED_PAD src0_sel:DWORD src1_sel:WORD_0
    v_lshlrev_b32_sdwa v106, 3, v120 dst_sel:DWORD dst_unused:UNUSED_PAD src0_sel:DWORD src1_sel:WORD_1
    ds_read_b64 v[104:105], v104
    ds_read_b64 v[106:107], v106
    v_lshlrev_b32_sdwa v108, 3, v121 dst_sel:DWORD dst_unused:UNUSED_PAD src0_sel:DWORD src1_sel:WORD_0
    v_lshlrev_b32_sdwa v110, 3, v121 dst_sel:DWORD dst_unused:UNUSED_PAD src0_sel:DWORD src1_sel:WORD_1
    ds_read_b64 v[108:109], v108
    ds_read_b64 v[110:111], v110
    s_waitcnt lgkmcnt(8)
    v_smfmac_f32_16x16x64_bf16 v[48:51], v[64:67], v[88:95], v68
    v_exp_f32 v166, v166
    buffer_store_dword v162, v70, s[12:15], s35 offen offset:2176 sc1
    v_pk_fma_f32 v[164:165], v[164:165], v[134:135], v[134:135]
    v_exp_f32 v167, v167
    v_pk_fma_f32 v[170:171], v[170:171], v[128:129], v[130:131]
    v_pk_mul_f32 v[172:173], v[46:47], v[46:47]
    v_rcp_f32 v164, v164
    v_pk_fma_f32 v[166:167], v[166:167], v[136:137], v[136:137]
    v_lshlrev_b32_sdwa v88, 3, v122 dst_sel:DWORD dst_unused:UNUSED_PAD src0_sel:DWORD src1_sel:WORD_0
    v_lshlrev_b32_sdwa v90, 3, v122 dst_sel:DWORD dst_unused:UNUSED_PAD src0_sel:DWORD src1_sel:WORD_1
    ds_read_b64 v[88:89], v88
    ds_read_b64 v[90:91], v90
    v_lshlrev_b32_sdwa v92, 3, v123 dst_sel:DWORD dst_unused:UNUSED_PAD src0_sel:DWORD src1_sel:WORD_0
    v_lshlrev_b32_sdwa v94, 3, v123 dst_sel:DWORD dst_unused:UNUSED_PAD src0_sel:DWORD src1_sel:WORD_1
    ds_read_b64 v[92:93], v92
    ds_read_b64 v[94:95], v94
    buffer_load_dwordx4 v[120:123], v69, s[12:15], s45 offen offset:3072 sc1
    s_waitcnt lgkmcnt(8)
    v_smfmac_f32_16x16x64_bf16 v[52:55], v[64:67], v[96:103], v68
    v_rcp_f32 v165, v165
    v_pk_mul_f32 v[170:171], v[170:171], v[44:45]
    v_pk_fma_f32 v[172:173], v[172:173], v[128:129], v[130:131]
    v_rcp_f32 v166, v166
    v_pk_mul_f32 v[168:169], v[40:41], v[164:165]
    v_pk_mul_f32 v[172:173], v[172:173], v[46:47]
    v_rcp_f32 v167, v167
    v_exp_f32 v170, v170
    s_waitcnt vmcnt(4)
    v_lshlrev_b32_sdwa v96, 3, v124 dst_sel:DWORD dst_unused:UNUSED_PAD src0_sel:DWORD src1_sel:WORD_0
    v_lshlrev_b32_sdwa v98, 3, v124 dst_sel:DWORD dst_unused:UNUSED_PAD src0_sel:DWORD src1_sel:WORD_1
    ds_read_b64 v[96:97], v96
    ds_read_b64 v[98:99], v98
    v_lshlrev_b32_sdwa v100, 3, v125 dst_sel:DWORD dst_unused:UNUSED_PAD src0_sel:DWORD src1_sel:WORD_0
    v_lshlrev_b32_sdwa v102, 3, v125 dst_sel:DWORD dst_unused:UNUSED_PAD src0_sel:DWORD src1_sel:WORD_1
    ds_read_b64 v[100:101], v100
    ds_read_b64 v[102:103], v102
    s_waitcnt lgkmcnt(8)
    v_smfmac_f32_16x16x64_bf16 v[48:51], v[64:67], v[104:111], v68
    v_exp_f32 v171, v171
    v_pk_fma_f32 v[168:169], v[42:43], v[166:167], v[168:169]
    v_exp_f32 v172, v172
    v_add_f32 v168, v168, v169
    v_pk_fma_f32 v[170:171], v[170:171], v[134:135], v[134:135]
    v_exp_f32 v173, v173
    buffer_store_dword v168, v70, s[12:15], s35 offen offset:2560 sc1
    v_rcp_f32 v170, v170
    v_lshlrev_b32_sdwa v104, 3, v126 dst_sel:DWORD dst_unused:UNUSED_PAD src0_sel:DWORD src1_sel:WORD_0
    v_lshlrev_b32_sdwa v106, 3, v126 dst_sel:DWORD dst_unused:UNUSED_PAD src0_sel:DWORD src1_sel:WORD_1
    ds_read_b64 v[104:105], v104
    ds_read_b64 v[106:107], v106
    v_lshlrev_b32_sdwa v108, 3, v127 dst_sel:DWORD dst_unused:UNUSED_PAD src0_sel:DWORD src1_sel:WORD_0
    v_lshlrev_b32_sdwa v110, 3, v127 dst_sel:DWORD dst_unused:UNUSED_PAD src0_sel:DWORD src1_sel:WORD_1
    ds_read_b64 v[108:109], v108
    ds_read_b64 v[110:111], v110
    s_waitcnt lgkmcnt(8)
    v_smfmac_f32_16x16x64_bf16 v[52:55], v[64:67], v[88:95], v68
    v_rcp_f32 v171, v171
    v_pk_fma_f32 v[172:173], v[172:173], v[136:137], v[136:137]
    v_pk_mul_f32 v[140:141], v[48:49], v[48:49]
    v_rcp_f32 v172, v172
    v_pk_mul_f32 v[174:175], v[44:45], v[170:171]
    v_pk_fma_f32 v[140:141], v[140:141], v[128:129], v[130:131]
    v_rcp_f32 v173, v173
    v_pk_mul_f32 v[140:141], v[140:141], v[48:49]
    s_waitcnt vmcnt(3)
    v_lshlrev_b32_sdwa v88, 3, v116 dst_sel:DWORD dst_unused:UNUSED_PAD src0_sel:DWORD src1_sel:WORD_0
    v_lshlrev_b32_sdwa v90, 3, v116 dst_sel:DWORD dst_unused:UNUSED_PAD src0_sel:DWORD src1_sel:WORD_1
    ds_read_b64 v[88:89], v88
    ds_read_b64 v[90:91], v90
    v_lshlrev_b32_sdwa v92, 3, v117 dst_sel:DWORD dst_unused:UNUSED_PAD src0_sel:DWORD src1_sel:WORD_0
    v_lshlrev_b32_sdwa v94, 3, v117 dst_sel:DWORD dst_unused:UNUSED_PAD src0_sel:DWORD src1_sel:WORD_1
    ds_read_b64 v[92:93], v92
    ds_read_b64 v[94:95], v94
    s_waitcnt lgkmcnt(8)
    v_smfmac_f32_16x16x64_bf16 v[56:59], v[64:67], v[96:103], v68
    v_exp_f32 v140, v140
    v_pk_fma_f32 v[174:175], v[46:47], v[172:173], v[174:175]
    v_pk_mul_f32 v[142:143], v[50:51], v[50:51]
    v_exp_f32 v141, v141
    v_add_f32 v174, v174, v175
    v_pk_fma_f32 v[142:143], v[142:143], v[128:129], v[130:131]
    buffer_store_dword v174, v70, s[12:15], s35 offen offset:2688 sc1
    v_pk_fma_f32 v[140:141], v[140:141], v[134:135], v[134:135]
    v_lshlrev_b32_sdwa v96, 3, v118 dst_sel:DWORD dst_unused:UNUSED_PAD src0_sel:DWORD src1_sel:WORD_0
    v_lshlrev_b32_sdwa v98, 3, v118 dst_sel:DWORD dst_unused:UNUSED_PAD src0_sel:DWORD src1_sel:WORD_1
    ds_read_b64 v[96:97], v96
    ds_read_b64 v[98:99], v98
    v_lshlrev_b32_sdwa v100, 3, v119 dst_sel:DWORD dst_unused:UNUSED_PAD src0_sel:DWORD src1_sel:WORD_0
    v_lshlrev_b32_sdwa v102, 3, v119 dst_sel:DWORD dst_unused:UNUSED_PAD src0_sel:DWORD src1_sel:WORD_1
    ds_read_b64 v[100:101], v100
    ds_read_b64 v[102:103], v102
    s_waitcnt lgkmcnt(8)
    v_smfmac_f32_16x16x64_bf16 v[60:63], v[64:67], v[104:111], v68
    v_rcp_f32 v140, v140
    v_pk_mul_f32 v[142:143], v[142:143], v[50:51]
    v_pk_mul_f32 v[146:147], v[52:53], v[52:53]
    v_rcp_f32 v141, v141
    v_pk_fma_f32 v[146:147], v[146:147], v[128:129], v[130:131]
    v_pk_mul_f32 v[148:149], v[54:55], v[54:55]
    v_exp_f32 v142, v142
    v_pk_mul_f32 v[144:145], v[48:49], v[140:141]
    s_waitcnt vmcnt(2)
    v_lshlrev_b32_sdwa v104, 3, v120 dst_sel:DWORD dst_unused:UNUSED_PAD src0_sel:DWORD src1_sel:WORD_0
    v_lshlrev_b32_sdwa v106, 3, v120 dst_sel:DWORD dst_unused:UNUSED_PAD src0_sel:DWORD src1_sel:WORD_1
    ds_read_b64 v[104:105], v104
    ds_read_b64 v[106:107], v106
    v_lshlrev_b32_sdwa v108, 3, v121 dst_sel:DWORD dst_unused:UNUSED_PAD src0_sel:DWORD src1_sel:WORD_0
    v_lshlrev_b32_sdwa v110, 3, v121 dst_sel:DWORD dst_unused:UNUSED_PAD src0_sel:DWORD src1_sel:WORD_1
    ds_read_b64 v[108:109], v108
    ds_read_b64 v[110:111], v110
    s_waitcnt lgkmcnt(8)
    v_smfmac_f32_16x16x64_bf16 v[56:59], v[64:67], v[88:95], v68
    v_exp_f32 v143, v143
    v_pk_mul_f32 v[146:147], v[146:147], v[52:53]
    v_pk_fma_f32 v[148:149], v[148:149], v[128:129], v[130:131]
    v_exp_f32 v146, v146
    v_pk_fma_f32 v[142:143], v[142:143], v[136:137], v[136:137]
    v_pk_mul_f32 v[148:149], v[148:149], v[54:55]
    v_rcp_f32 v142, v142
    v_rcp_f32 v143, v143
    v_lshlrev_b32_sdwa v88, 3, v122 dst_sel:DWORD dst_unused:UNUSED_PAD src0_sel:DWORD src1_sel:WORD_0
    v_lshlrev_b32_sdwa v90, 3, v122 dst_sel:DWORD dst_unused:UNUSED_PAD src0_sel:DWORD src1_sel:WORD_1
    ds_read_b64 v[88:89], v88
    ds_read_b64 v[90:91], v90
    v_lshlrev_b32_sdwa v92, 3, v123 dst_sel:DWORD dst_unused:UNUSED_PAD src0_sel:DWORD src1_sel:WORD_0
    v_lshlrev_b32_sdwa v94, 3, v123 dst_sel:DWORD dst_unused:UNUSED_PAD src0_sel:DWORD src1_sel:WORD_1
    ds_read_b64 v[92:93], v92
    ds_read_b64 v[94:95], v94
    s_waitcnt lgkmcnt(8)
    v_smfmac_f32_16x16x64_bf16 v[60:63], v[64:67], v[96:103], v68
    s_setprio 0
    v_exp_f32 v147, v147
    v_pk_fma_f32 v[144:145], v[50:51], v[142:143], v[144:145]
    v_exp_f32 v148, v148
    v_add_f32 v144, v144, v145
    v_pk_fma_f32 v[146:147], v[146:147], v[134:135], v[134:135]
    v_exp_f32 v149, v149
    buffer_store_dword v144, v70, s[12:15], s35 offen offset:3072 sc1
    v_rcp_f32 v146, v146
    s_waitcnt lgkmcnt(4)
    v_smfmac_f32_16x16x64_bf16 v[56:59], v[64:67], v[104:111], v68
    v_rcp_f32 v147, v147
    v_pk_fma_f32 v[148:149], v[148:149], v[136:137], v[136:137]
    s_waitcnt lgkmcnt(0)
    v_smfmac_f32_16x16x64_bf16 v[60:63], v[64:67], v[88:95], v68
    v_rcp_f32 v148, v148
    v_pk_mul_f32 v[150:151], v[52:53], v[146:147]
    v_rcp_f32 v149, v149
    s_nop 0
    s_nop 0
    v_pk_fma_f32 v[150:151], v[54:55], v[148:149], v[150:151]
    s_nop 0
    v_add_f32 v150, v150, v151
    v_pk_mul_f32 v[152:153], v[56:57], v[56:57]
    buffer_store_dword v150, v70, s[12:15], s35 offen offset:3200 sc1
    v_pk_fma_f32 v[152:153], v[152:153], v[128:129], v[130:131]
    v_pk_mul_f32 v[154:155], v[58:59], v[58:59]
    v_pk_mul_f32 v[152:153], v[152:153], v[56:57]
    v_pk_fma_f32 v[154:155], v[154:155], v[128:129], v[130:131]
    v_exp_f32 v152, v152
    v_pk_mul_f32 v[154:155], v[154:155], v[58:59]
    v_pk_mul_f32 v[158:159], v[60:61], v[60:61]
    v_exp_f32 v153, v153
    v_pk_fma_f32 v[158:159], v[158:159], v[128:129], v[130:131]
    v_pk_mul_f32 v[160:161], v[62:63], v[62:63]
    v_exp_f32 v154, v154
    v_pk_fma_f32 v[152:153], v[152:153], v[134:135], v[134:135]
    v_pk_mul_f32 v[158:159], v[158:159], v[60:61]
    v_rcp_f32 v152, v152
    v_pk_fma_f32 v[160:161], v[160:161], v[128:129], v[130:131]
    v_rcp_f32 v153, v153
    v_pk_mul_f32 v[160:161], v[160:161], v[62:63]
    v_exp_f32 v155, v155
    v_pk_mul_f32 v[156:157], v[56:57], v[152:153]
    v_exp_f32 v158, v158
    v_pk_fma_f32 v[154:155], v[154:155], v[136:137], v[136:137]
    v_exp_f32 v159, v159
    v_rcp_f32 v154, v154
    v_rcp_f32 v155, v155
    v_pk_fma_f32 v[158:159], v[158:159], v[134:135], v[134:135]
    v_exp_f32 v160, v160
    v_pk_fma_f32 v[156:157], v[58:59], v[154:155], v[156:157]
    v_rcp_f32 v158, v158
    v_add_f32 v156, v156, v157
    v_rcp_f32 v159, v159
    buffer_store_dword v156, v70, s[12:15], s35 offen offset:3584 sc1
    v_exp_f32 v161, v161
    v_pk_mul_f32 v[162:163], v[60:61], v[158:159]
    s_nop 0
    v_pk_fma_f32 v[160:161], v[160:161], v[136:137], v[136:137]
    s_nop 0
    v_rcp_f32 v160, v160
    v_rcp_f32 v161, v161
    s_nop 0
    s_nop 0
    v_pk_fma_f32 v[162:163], v[62:63], v[160:161], v[162:163]
    s_nop 0
    v_add_f32 v162, v162, v163
    s_nop 0
    buffer_store_dword v162, v70, s[12:15], s35 offen offset:3712 sc1
    s_branch standalone__deep_cross_pnn__recsys_kernel_red
standalone__deep_cross_pnn__recsys_kernel_end:
    s_endpgm
.section .rodata,"a"
.p2align 6
.amdhsa_kernel standalone__deep_cross_pnn__recsys_kernel
  .amdhsa_next_free_vgpr 256
  .amdhsa_next_free_sgpr 102
  .amdhsa_accum_offset 256
  .amdhsa_group_segment_fixed_size 0
  .amdhsa_kernarg_size 80
  .amdhsa_user_sgpr_count 2
  .amdhsa_user_sgpr_kernarg_segment_ptr 1
  .amdhsa_system_sgpr_workgroup_id_x 1
.end_amdhsa_kernel
```

```asm
; @launch grid=(256,1,1) block=(512,1,1) lds=163840
.amdgcn_target "amdgcn-amd-amdhsa--gfx950"
.text
.globl standalone__deep_cross_pnn__recsys_kernel
.p2align 8
.type standalone__deep_cross_pnn__recsys_kernel,@function
standalone__deep_cross_pnn__recsys_kernel:

    s_cmp_ge_u32 s2, 256
    s_cbranch_scc1 standalone__deep_cross_pnn__recsys_kernel_end
    s_load_dwordx8 s[4:11], s[0:1], 0
    s_load_dwordx2 s[12:13], s[0:1], 72
    s_load_dwordx2 s[52:53], s[0:1], 64
    s_load_dwordx4 s[60:63], s[0:1], 32

    s_getpc_b64 s[84:85]
standalone__deep_cross_pnn__recsys_kernel_pc0:
    s_lshr_b32 s44, s2, 3
    s_lshl_b32 s44, s44, 11
    v_lshl_add_u32 v2, v0, 2, s44
    v_min_u32 v2, standalone__deep_cross_pnn__recsys_kernel_end - standalone__deep_cross_pnn__recsys_kernel_pc0, v2
    global_load_dword v100, v2, s[84:85]

    v_lshrrev_b32 v1, 6, v0
    v_and_b32 v255, 63, v0
    s_bfe_u32 s36, s2, 0x10003
    v_readfirstlane_b32 s3, v1

    s_lshr_b32 s37, s2, 4
    s_lshl_b32 s37, s37, 3
    s_and_b32 s38, s2, 7
    s_or_b32 s37, s37, s38
    v_lshlrev_b32 v254, 4, v255
    v_mov_b32 v252, 163712
    v_mov_b32 v253, 1
    v_mov_b32 v40, 0
    v_cmp_gt_u32 vcc, 8, v0
    v_lshl_add_u32 v41, v0, 2, v252
    s_and_saveexec_b64 s[46:47], vcc
    ds_write_b32 v41, v40
    s_mov_b64 exec, s[46:47]
    v_mul_u32_u24 v6, 57, v255
    v_lshrrev_b32 v6, 9, v6
    v_mul_u32_u24 v5, 9, v6
    v_sub_u32 v5, v255, v5
    v_cmp_gt_u32 s[40:41], 8, v5
    v_lshlrev_b32 v5, 4, v5
    v_lshl_add_u32 v83, v6, 8, v5
    s_and_b32 s56, s3, 3
    s_mul_i32 s42, s56, 1792
    s_mul_i32 s43, s56, 1008
    s_lshl_b32 s38, s36, 7
    s_add_u32 s42, s42, s38
    s_bitset0_b32 s41, 31
    s_waitcnt lgkmcnt(0)

    s_mov_b32 s16, s4
    s_and_b32 s17, s5, 0xffff
    s_mov_b32 s18, 6553600
    s_mov_b32 s19, 0x00020000
    s_mov_b32 s20, s6
    s_and_b32 s21, s7, 0xffff
    s_mov_b32 s22, 256000
    s_mov_b32 s23, 0x00020000
    s_mov_b32 s24, s8
    s_and_b32 s25, s9, 0xffff
    s_mov_b32 s26, 20000
    s_mov_b32 s27, 0x00020000
    s_mov_b32 s28, s10
    s_and_b32 s29, s11, 0xffff
    s_mov_b32 s30, 13107200
    s_mov_b32 s31, 0x00020000
    s_mov_b32 s32, s12
    s_and_b32 s33, s13, 0xffff
    s_mov_b32 s34, 268435456
    s_mov_b32 s35, 0x00020000
    s_mov_b32 s12, s12
    s_and_b32 s13, s13, 0xffff
    s_mov_b32 s14, 268435456
    s_mov_b32 s15, 0x00020000
    s_mov_b32 s52, s52
    s_and_b32 s53, s53, 0xffff
    s_mov_b32 s54, 256
    s_mov_b32 s55, 0x00020000

    s_mov_b32 s50, s36
    s_lshr_b32 s44, s2, 4
    s_lshl_b32 s44, s44, 6
    s_and_b32 s45, s2, 12
    s_add_u32 s44, s44, s45
    s_add_u32 s60, s60, s44
    s_addc_u32 s61, s61, 0
    s_add_u32 s10, s62, s44
    s_addc_u32 s11, s63, 0

    s_cmp_ge_u32 s3, 4
    s_cbranch_scc1 standalone__deep_cross_pnn__recsys_kernel_aux

    s_setprio 3
    s_lshl_b32 s38, s3, 10
    s_add_u32 m0, s38, 144144
    v_and_b32 v5, 15, v255

    buffer_load_dwordx4 v254, s[24:27], s38 offen lds
    s_add_u32 m0, m0, 4096
    s_add_u32 s38, s38, 4096
    buffer_load_dwordx4 v254, s[24:27], s38 offen lds
    s_add_u32 m0, m0, 4096
    s_add_u32 s38, s38, 4096
    buffer_load_dwordx4 v254, s[24:27], s38 offen lds
    s_add_u32 m0, m0, 4096
    s_add_u32 s38, s38, 4096
    buffer_load_dwordx4 v254, s[24:27], s38 offen lds
    s_add_u32 m0, m0, 4096
    s_add_u32 s38, s38, 4096
    s_cmp_eq_u32 s3, 3
    s_cselect_b32 s45, 1024, 0
    s_sub_u32 m0, m0, s45
    s_sub_u32 s38, s38, s45
    buffer_load_dwordx4 v254, s[24:27], s38 offen lds

    v_lshrrev_b32 v6, 4, v255
    v_and_b32 v8, 3, v255
    v_bfe_u32 v7, v255, 2, 2
    v_mul_u32_u24 v245, 24, v5
    s_movk_i32 s45, 400
    v_lshlrev_b32 v246, 2, v7
    v_mad_u32_u24 v246, v8, s45, v246
    s_lshr_b32 s72, s37, 1
    s_lshl_b32 s72, s72, 8
    s_bitcmp1_b32 s37, 0
    s_cselect_b32 s75, 30, 34
    s_cselect_b32 s73, 136, 0
    s_add_u32 s72, s72, s73
    s_mul_i32 s73, s3, s75
    s_add_u32 s72, s72, s73
    s_mul_i32 s74, s72, 400
    s_mul_i32 s18, s75, 400
    s_add_u32 s18, s18, s74
    s_add_u32 s58, s18, 800
    v_and_b32 v198, 1, v8
    v_lshlrev_b32 v199, 2, v7
    v_mad_u32_u24 v199, v198, s45, v199
    v_mul_u32_u24 v184, 12, v5
    s_movk_i32 s45, 200
    v_mad_u32_u24 v185, v6, s45, v184
    v_lshlrev_b32 v186, 1, v7
    v_mad_u32_u24 v186, v6, s45, v186
    v_mov_b32 v0, 0
    s_movk_i32 s45, 19200

    buffer_load_dwordx3 v[188:190], v185, s[24:27], s45 offen
    buffer_load_short_d16_hi v0, v186, s[24:27], s45 offen offset:192
    buffer_load_dwordx4 v[192:195], v245, s[16:19], s74 offen
    buffer_load_dwordx2 v[196:197], v245, s[16:19], s74 offen offset:16
    buffer_load_dword v198, v199, s[16:19], s74 offen offset:384
    buffer_load_dwordx4 v[230:233], v245, s[16:19], s74 offen offset:400
    buffer_load_dwordx2 v[234:235], v245, s[16:19], s74 offen offset:416
    buffer_load_dwordx4 v[212:215], v245, s[16:19], s74 offen offset:800
    buffer_load_dwordx2 v[216:217], v245, s[16:19], s74 offen offset:816
    buffer_load_dword v236, v246, s[16:19], s74 offen offset:1184
    buffer_load_dwordx4 v[218:221], v245, s[16:19], s74 offen offset:1200
    buffer_load_dwordx2 v[222:223], v245, s[16:19], s74 offen offset:1216
    buffer_load_dwordx4 v[224:227], v245, s[16:19], s74 offen offset:1600
    buffer_load_dwordx2 v[228:229], v245, s[16:19], s74 offen offset:1616
    s_load_dword s24, s[60:61], 0
    s_load_dword s25, s[60:61], 16
    s_load_dword s26, s[60:61], 32
    s_load_dword s27, s[60:61], 48
    s_load_dword s28, s[10:11], 0
    s_load_dword s29, s[10:11], 16
    s_load_dword s30, s[10:11], 32
    s_load_dword s31, s[10:11], 48

    s_lshl_b32 s75, s75, 2

    s_lshl_b32 s76, s36, 14
    s_add_u32 s76, s76, s72
    s_lshl_b32 s76, s76, 2
    s_add_u32 s76, s76, 29360128
    v_lshl_add_u32 v40, v5, 4, -8
    v_lshrrev_b32 v41, 5, v255
    v_lshl_add_u32 v40, v41, 2, v40
    v_bfe_u32 v41, v255, 4, 1
    v_lshl_add_u32 v94, v41, 3, v40
    v_cmp_gt_u32 s[46:47], s75, v94
    s_lshl_b32 s45, s3, 7
    s_add_u32 s45, s45, 512
    s_min_u32 s45, s45, 880
    s_mul_i32 s44, s45, 144
    v_mul_u32_u24 v95, 144, v5
    v_lshl_add_u32 v95, v6, 4, v95
    v_add_u32 v95, s44, v95
    s_xor_b32 s44, s36, 1
    s_lshl_b32 s44, s44, 10
    s_add_u32 s44, s44, s45
    s_lshl_b32 s44, s44, 7
    s_add_u32 s44, s44, 15204352
    s_mov_b32 s64, 0x40000000
    v_add_u32 v184, 144144, v184
    s_movk_i32 s45, 4800
    v_mad_u32_u24 v184, v6, s45, v184
    v_mul_u32_u24 v186, 1200, v5
    v_add_u32 v186, 144144, v186
    v_mad_u32_u24 v185, v6, 48, v186
    v_lshl_add_u32 v186, v6, 1, v186
    v_and_b32 v244, 48, v255
    s_movk_i32 s57, 144
    v_cmp_eq_u32 s[60:61], 0, v8
    v_cmp_eq_u32 s[62:63], 1, v8
    v_cmp_eq_u32 s[66:67], 2, v8
    v_cmp_eq_u32 s[68:69], 3, v8
    s_mov_b32 s70, 0x00010001
    s_mov_b32 s71, 0x00010001

    s_lshr_b32 s79, s2, 1
    s_mul_i32 s77, s79, 102656
    s_lshl_b32 s85, s50, 11
    s_xor_b32 s78, s85, 2048
    s_add_u32 s78, s78, s77
    s_add_u32 s77, s77, s85
    s_and_b32 s79, s2, 1
    s_mul_i32 s79, s79, 1638400
    s_add_u32 s79, s79, 16777216
    s_lshl_b32 s85, s3, 13
    s_add_u32 s79, s79, s85
    s_xor_b32 s85, s3, 4
    s_lshl_b32 s85, s85, 10
    s_min_u32 s85, s85, 7040

    v_and_b32 v247, 1, v255
    v_mov_b32 v252, 0xdddd
    v_mul_u32_u24 v253, 0xaaaa, v247
    v_lshl_add_u32 v247, v247, 2, v244
    v_add_u32 v253, 0x4444, v253
    v_mov_b32 v203, 0x3f805555

    v_mov_b64 v[4:5], 0
    v_mov_b64 v[6:7], 0
    v_mov_b64 v[8:9], 0
    v_mov_b64 v[10:11], 0
    v_mov_b64 v[12:13], 0
    v_mov_b64 v[14:15], 0
    v_mov_b64 v[16:17], 0
    v_mov_b64 v[18:19], 0
    v_mov_b64 v[20:21], 0
    v_mov_b64 v[22:23], 0
    v_mov_b64 v[24:25], 0
    v_mov_b64 v[26:27], 0
    v_mov_b64 v[28:29], 0
    v_mov_b64 v[30:31], 0
    v_mov_b64 v[32:33], 0
    v_mov_b64 v[34:35], 0
    v_mov_b64 v[36:37], 0
    v_mov_b64 v[38:39], 0
    v_mov_b64 v[40:41], 0
    v_mov_b64 v[42:43], 0
    v_mov_b64 v[44:45], 0
    v_mov_b64 v[46:47], 0
    v_mov_b64 v[48:49], 0
    v_mov_b64 v[50:51], 0
    v_mov_b64 v[52:53], 0
    v_mov_b64 v[54:55], 0
    v_mov_b64 v[56:57], 0
    v_mov_b64 v[58:59], 0
    v_mov_b64 v[60:61], 0
    v_mov_b64 v[62:63], 0
    v_mov_b64 v[64:65], 0
    v_mov_b64 v[66:67], 0
    v_mov_b64 v[68:69], 0
    v_mov_b64 v[70:71], 0
    v_mov_b64 v[72:73], 0
    v_mov_b64 v[74:75], 0
    v_mov_b64 v[76:77], 0
    v_mov_b64 v[78:79], 0
    v_mov_b64 v[80:81], 0
    v_mov_b64 v[82:83], 0
    v_mov_b64 v[84:85], 0
    v_mov_b64 v[86:87], 0
    v_mov_b64 v[88:89], 0
    v_mov_b64 v[90:91], 0
    v_mov_b64 v[92:93], 0
    s_waitcnt vmcnt(14)
    s_barrier
    ds_read_b64 v[96:97], v185 offset:200
    ds_read_b64 v[98:99], v185 offset:208
    ds_read_b64 v[100:101], v185 offset:224
    ds_read_b64 v[102:103], v185 offset:232
    ds_read_b64 v[104:105], v185 offset:400
    ds_read_b64 v[106:107], v185 offset:408
    ds_read_b64 v[108:109], v185 offset:424
    ds_read_b64 v[110:111], v185 offset:432
    ds_read_b64 v[112:113], v185 offset:600
    ds_read_b64 v[114:115], v185 offset:608
    ds_read_b64 v[116:117], v185 offset:616
    ds_read_b64 v[118:119], v185 offset:624
    ds_read_b64 v[120:121], v185 offset:632
    ds_read_b64 v[122:123], v185 offset:640
    ds_read_b64 v[124:125], v185 offset:800
    ds_read_b64 v[126:127], v185 offset:808
    ds_read_b64 v[128:129], v185 offset:816
    ds_read_b64 v[130:131], v185 offset:824
    ds_read_b64 v[132:133], v185 offset:832
    ds_read_b64 v[134:135], v185 offset:840
    ds_read_b64 v[136:137], v185 offset:1000
    ds_read_b64 v[138:139], v185 offset:1008
    ds_read_b64 v[140:141], v185 offset:1016
    ds_read_b64 v[142:143], v185 offset:1024
    ds_read_b64 v[144:145], v185 offset:1032
    ds_read_b64 v[146:147], v185 offset:1040
    ds_read_u16_d16_hi v88, v186 offset:192
    ds_read_u16_d16_hi v89, v186 offset:392
    ds_read_u16_d16_hi v90, v186 offset:592
    ds_read_u16_d16_hi v91, v186 offset:792
    ds_read_u16_d16_hi v92, v186 offset:992
    ds_read_u16_d16_hi v93, v186 offset:1192
    ds_read_u16_d16_hi v4, v184 offset:4
    ds_read_u16_d16_hi v5, v184 offset:1204
    ds_read_u16_d16_hi v6, v184 offset:2404
    ds_read_u16_d16_hi v7, v184 offset:3604
    ds_read_u16_d16_hi v8, v184 offset:6
    ds_read_u16_d16_hi v9, v184 offset:1206
    ds_read_u16_d16_hi v10, v184 offset:2406
    ds_read_u16_d16_hi v11, v184 offset:3606
    ds_read_u16_d16_hi v12, v184 offset:8
    ds_read_u16_d16_hi v13, v184 offset:1208
    ds_read_u16_d16_hi v14, v184 offset:2408
    ds_read_u16_d16_hi v15, v184 offset:3608
    ds_read_u16_d16_hi v16, v184 offset:10
    ds_read_u16_d16_hi v17, v184 offset:1210
    ds_read_u16_d16_hi v18, v184 offset:2410
    ds_read_u16_d16_hi v19, v184 offset:3610
    ds_read_u16_d16_hi v20, v184 offset:206
    ds_read_u16_d16_hi v21, v184 offset:1406
    ds_read_u16_d16_hi v22, v184 offset:2606
    ds_read_u16_d16_hi v23, v184 offset:3806
    ds_read_u16_d16_hi v24, v184 offset:208
    ds_read_u16_d16_hi v25, v184 offset:1408
    ds_read_u16_d16_hi v26, v184 offset:2608
    ds_read_u16_d16_hi v27, v184 offset:3808
    ds_read_u16_d16_hi v28, v184 offset:210
    ds_read_u16_d16_hi v29, v184 offset:1410
    ds_read_u16_d16_hi v30, v184 offset:2610
    ds_read_u16_d16_hi v31, v184 offset:3810
    ds_read_u16_d16_hi v32, v184 offset:408
    ds_read_u16_d16_hi v33, v184 offset:1608
    ds_read_u16_d16_hi v34, v184 offset:2808
    ds_read_u16_d16_hi v35, v184 offset:4008
    ds_read_u16_d16_hi v36, v184 offset:410
    ds_read_u16_d16_hi v37, v184 offset:1610
    ds_read_u16_d16_hi v38, v184 offset:2810
    ds_read_u16_d16_hi v39, v184 offset:4010
    ds_read_u16_d16_hi v40, v184 offset:610
    ds_read_u16_d16_hi v41, v184 offset:1810
    ds_read_u16_d16_hi v42, v184 offset:3010
    ds_read_u16_d16_hi v43, v184 offset:4210
    ds_read_u16_d16_hi v44, v184 offset:810
    ds_read_u16_d16_hi v45, v184 offset:2010
    ds_read_u16_d16_hi v46, v184 offset:3210
    ds_read_u16_d16_hi v47, v184 offset:4410
    ds_read_u16_d16_hi v52, v184 offset:2
    ds_read_u16_d16_hi v53, v184 offset:1202
    ds_read_u16_d16_hi v54, v184 offset:2402
    ds_read_u16_d16_hi v55, v184 offset:3602
    ds_read_u16_d16_hi v60, v184 offset:406
    ds_read_u16_d16_hi v61, v184 offset:1606
    ds_read_u16_d16_hi v62, v184 offset:2806
    ds_read_u16_d16_hi v63, v184 offset:4006
    ds_read_u16_d16_hi v68, v184 offset:204
    ds_read_u16_d16_hi v69, v184 offset:1404
    ds_read_u16_d16_hi v70, v184 offset:2604
    ds_read_u16_d16_hi v71, v184 offset:3804
    ds_read_u16_d16_hi v76, v184 offset:608
    ds_read_u16_d16_hi v77, v184 offset:1808
    ds_read_u16_d16_hi v78, v184 offset:3008
    ds_read_u16_d16_hi v79, v184 offset:4208
    ds_read_u16_d16_hi v48, v184 offset:0
    ds_read_u16_d16_hi v49, v184 offset:1200
    ds_read_u16_d16_hi v50, v184 offset:2400
    ds_read_u16_d16_hi v51, v184 offset:3600
    ds_read_u16_d16_hi v56, v184 offset:404
    ds_read_u16_d16_hi v57, v184 offset:1604
    ds_read_u16_d16_hi v58, v184 offset:2804
    ds_read_u16_d16_hi v59, v184 offset:4004
    ds_read_u16_d16_hi v64, v184 offset:202
    ds_read_u16_d16_hi v65, v184 offset:1402
    ds_read_u16_d16_hi v66, v184 offset:2602
    ds_read_u16_d16_hi v67, v184 offset:3802
    ds_read_u16_d16_hi v72, v184 offset:606
    ds_read_u16_d16_hi v73, v184 offset:1806
    ds_read_u16_d16_hi v74, v184 offset:3006
    ds_read_u16_d16_hi v75, v184 offset:4206
    ds_read_u16_d16_hi v80, v184 offset:808
    ds_read_u16_d16_hi v81, v184 offset:2008
    ds_read_u16_d16_hi v82, v184 offset:3208
    ds_read_u16_d16_hi v83, v184 offset:4408
    ds_read_u16_d16_hi v84, v184 offset:1010
    ds_read_u16_d16_hi v85, v184 offset:2210
    ds_read_u16_d16_hi v86, v184 offset:3410
    ds_read_u16_d16_hi v87, v184 offset:4610
    s_waitcnt vmcnt(9) lgkmcnt(15)
    v_lshlrev_b32 v200, 16, v104
    v_add_f32 v4, v4, v200
    v_lshlrev_b32 v201, 16, v107
    v_add_f32 v5, v5, v201
    v_lshlrev_b32 v200, 16, v108
    v_add_f32 v6, v6, v200
    v_lshlrev_b32 v201, 16, v111
    v_add_f32 v7, v7, v201
    v_lshlrev_b32 v200, 16, v112
    v_add_f32 v8, v8, v200
    v_lshlrev_b32 v201, 16, v115
    v_add_f32 v9, v9, v201
    v_lshlrev_b32 v200, 16, v118
    v_add_f32 v10, v10, v200
    v_lshlrev_b32 v201, 16, v121
    v_add_f32 v11, v11, v201
    v_lshlrev_b32 v200, 16, v124
    v_add_f32 v12, v12, v200
    v_lshlrev_b32 v201, 16, v127
    v_add_f32 v13, v13, v201
    v_lshlrev_b32 v200, 16, v130
    v_add_f32 v14, v14, v200
    v_lshlrev_b32 v201, 16, v133
    v_add_f32 v15, v15, v201
    v_lshlrev_b32 v200, 16, v136
    v_add_f32 v16, v16, v200
    v_lshlrev_b32 v201, 16, v139
    v_add_f32 v17, v17, v201
    v_lshlrev_b32 v200, 16, v142
    v_add_f32 v18, v18, v200
    v_lshlrev_b32 v201, 16, v145
    v_add_f32 v19, v19, v201
    v_and_b32 v200, 0xffff0000, v112
    v_add_f32 v20, v20, v200
    v_and_b32 v201, 0xffff0000, v115
    v_add_f32 v21, v21, v201
    v_and_b32 v200, 0xffff0000, v118
    v_add_f32 v22, v22, v200
    v_and_b32 v201, 0xffff0000, v121
    v_add_f32 v23, v23, v201
    v_and_b32 v200, 0xffff0000, v124
    v_add_f32 v24, v24, v200
    v_and_b32 v201, 0xffff0000, v127
    v_add_f32 v25, v25, v201
    v_and_b32 v200, 0xffff0000, v130
    v_add_f32 v26, v26, v200
    v_and_b32 v201, 0xffff0000, v133
    v_add_f32 v27, v27, v201
    v_and_b32 v200, 0xffff0000, v136
    v_add_f32 v28, v28, v200
    v_and_b32 v201, 0xffff0000, v139
    v_add_f32 v29, v29, v201
    v_and_b32 v200, 0xffff0000, v142
    v_add_f32 v30, v30, v200
    v_and_b32 v201, 0xffff0000, v145
    v_add_f32 v31, v31, v201
    v_lshlrev_b32 v200, 16, v125
    v_add_f32 v32, v32, v200
    v_lshlrev_b32 v201, 16, v128
    v_add_f32 v33, v33, v201
    v_lshlrev_b32 v200, 16, v131
    v_add_f32 v34, v34, v200
    v_lshlrev_b32 v201, 16, v134
    v_add_f32 v35, v35, v201
    v_lshlrev_b32 v200, 16, v137
    v_add_f32 v36, v36, v200
    v_lshlrev_b32 v201, 16, v140
    v_add_f32 v37, v37, v201
    v_lshlrev_b32 v200, 16, v143
    v_add_f32 v38, v38, v200
    v_lshlrev_b32 v201, 16, v146
    v_add_f32 v39, v39, v201
    v_and_b32 v200, 0xffff0000, v137
    v_add_f32 v40, v40, v200
    v_and_b32 v201, 0xffff0000, v140
    v_add_f32 v41, v41, v201
    v_and_b32 v200, 0xffff0000, v143
    v_add_f32 v42, v42, v200
    v_and_b32 v201, 0xffff0000, v146
    v_add_f32 v43, v43, v201
    v_lshlrev_b32 v200, 16, v138
    v_add_f32 v44, v44, v200
    v_lshlrev_b32 v201, 16, v141
    v_add_f32 v45, v45, v201
    v_lshlrev_b32 v200, 16, v144
    v_add_f32 v46, v46, v200
    v_lshlrev_b32 v201, 16, v147
    v_add_f32 v47, v47, v201
    v_lshlrev_b32 v200, 16, v96
    v_add_f32 v52, v52, v200
    v_lshlrev_b32 v201, 16, v99
    v_add_f32 v53, v53, v201
    v_lshlrev_b32 v200, 16, v100
    v_add_f32 v54, v54, v200
    v_lshlrev_b32 v201, 16, v103
    v_add_f32 v55, v55, v201
    v_lshlrev_b32 v200, 16, v113
    v_add_f32 v60, v60, v200
    v_lshlrev_b32 v201, 16, v116
    v_add_f32 v61, v61, v201
    v_lshlrev_b32 v200, 16, v119
    v_add_f32 v62, v62, v200
    v_lshlrev_b32 v201, 16, v122
    v_add_f32 v63, v63, v201
    v_and_b32 v200, 0xffff0000, v104
    v_add_f32 v68, v68, v200
    v_and_b32 v201, 0xffff0000, v107
    v_add_f32 v69, v69, v201
    v_and_b32 v200, 0xffff0000, v108
    v_add_f32 v70, v70, v200
    v_and_b32 v201, 0xffff0000, v111
    v_add_f32 v71, v71, v201
    v_and_b32 v200, 0xffff0000, v125
    v_add_f32 v76, v76, v200
    v_and_b32 v201, 0xffff0000, v128
    v_add_f32 v77, v77, v201
    v_and_b32 v200, 0xffff0000, v131
    v_add_f32 v78, v78, v200
    v_and_b32 v201, 0xffff0000, v134
    v_add_f32 v79, v79, v201
    v_lshlrev_b32 v200, 16, v188
    v_add_f32 v88, v88, v200
    v_and_b32 v201, 0xffff0000, v188
    v_add_f32 v89, v89, v201
    v_lshlrev_b32 v200, 16, v189
    v_add_f32 v90, v90, v200
    v_and_b32 v201, 0xffff0000, v189
    v_add_f32 v91, v91, v201
    v_lshlrev_b32 v200, 16, v190
    v_add_f32 v92, v92, v200
    v_and_b32 v201, 0xffff0000, v190
    v_add_f32 v93, v93, v201
    v_mad_u32_u24 v192, v192, s57, v244
    v_mad_u32_u24 v193, v193, s57, v244
    v_mad_u32_u24 v194, v194, s57, v244
    v_mad_u32_u24 v195, v195, s57, v244
    v_mad_u32_u24 v196, v196, s57, v244
    v_mad_u32_u24 v197, v197, s57, v244
    v_mad_u32_u24 v198, v198, s57, v244
    v_sub_f32 v88, v88, v90
    v_sub_f32 v90, v90, v89
    v_sub_f32 v89, v89, v91
    v_sub_f32 v91, v91, v92
    v_sub_f32 v92, v92, v93
    v_cndmask_b32 v3, 0, v0, s[68:69]
    v_cndmask_b32 v2, 0, v0, s[66:67]
    v_cndmask_b32 v1, 0, v0, s[62:63]
    v_cndmask_b32 v0, 0, v0, s[60:61]
    s_waitcnt lgkmcnt(0)
    v_cvt_pk_bf16_f32 v48, v48, v49
    v_cvt_pk_bf16_f32 v49, v50, v51
    v_cvt_pk_bf16_f32 v50, v52, v53
    v_cvt_pk_bf16_f32 v51, v54, v55
    v_cvt_pk_bf16_f32 v56, v56, v57
    v_cvt_pk_bf16_f32 v57, v58, v59
    v_cvt_pk_bf16_f32 v58, v60, v61
    v_cvt_pk_bf16_f32 v59, v62, v63
    v_cvt_pk_bf16_f32 v64, v64, v65
    v_cvt_pk_bf16_f32 v65, v66, v67
    v_cvt_pk_bf16_f32 v66, v68, v69
    v_cvt_pk_bf16_f32 v67, v70, v71
    v_cvt_pk_bf16_f32 v72, v72, v73
    v_cvt_pk_bf16_f32 v73, v74, v75
    v_cvt_pk_bf16_f32 v74, v76, v77
    v_cvt_pk_bf16_f32 v75, v78, v79
    v_cvt_pk_bf16_f32 v80, v80, v81
    v_cvt_pk_bf16_f32 v81, v82, v83
    v_cvt_pk_bf16_f32 v82, v84, v85
    v_cvt_pk_bf16_f32 v83, v86, v87
    v_permlane32_swap_b32 v48, v50
    v_permlane32_swap_b32 v49, v51
    v_permlane32_swap_b32 v56, v58
    v_permlane32_swap_b32 v57, v59
    v_permlane32_swap_b32 v64, v66
    v_permlane32_swap_b32 v65, v67
    v_permlane32_swap_b32 v72, v74
    v_permlane32_swap_b32 v73, v75
    v_permlane32_swap_b32 v80, v82
    v_permlane32_swap_b32 v81, v83
    v_permlane16_swap_b32 v48, v50
    v_permlane16_swap_b32 v49, v51
    v_permlane16_swap_b32 v56, v58
    v_permlane16_swap_b32 v57, v59
    v_permlane16_swap_b32 v64, v66
    v_permlane16_swap_b32 v65, v67
    v_permlane16_swap_b32 v72, v74
    v_permlane16_swap_b32 v73, v75
    v_permlane16_swap_b32 v80, v82
    v_permlane16_swap_b32 v81, v83
    s_mov_b32 s60, 0x100001
    s_mov_b32 s61, 0x10000100
    v_cndmask_b32 v60, 0, v203, s[60:61]
    s_mov_b32 s60, 0x200002
    s_mov_b32 s61, 0x20000200
    v_cndmask_b32 v61, 0, v203, s[60:61]
    s_mov_b32 s60, 0x400004
    s_mov_b32 s61, 0x40000400
    v_cndmask_b32 v62, 0, v203, s[60:61]
    s_mov_b32 s60, 0x800008
    s_mov_b32 s61, 0x80000800
    v_cndmask_b32 v63, 0, v203, s[60:61]
    v_mov_b64 v[52:53], 0
    v_mov_b64 v[54:55], 0
    v_mov_b64 v[68:69], 0
    v_mov_b64 v[70:71], 0
    v_mov_b64 v[248:249], 0
    v_mov_b64 v[250:251], 0
    v_add_u32_dpp v78, v198, v247 quad_perm:[2,2,3,3] row_mask:0xf bank_mask:0xf
    s_bitcmp1_b32 s2, 1
    s_cselect_b32 s83, 0, 16
    s_lshl_b32 s80, s24, s83
    s_lshl_b32 s81, s25, s83
    s_lshl_b32 s82, s26, s83
    s_lshl_b32 s83, s27, s83
    s_and_b32 s80, s80, 0xffff0000
    s_and_b32 s81, s81, 0xffff0000
    s_and_b32 s82, s82, 0xffff0000
    s_and_b32 s83, s83, 0xffff0000
    s_barrier
    s_setprio 0
    ds_read_b128 v[96:99], v192 offset:0
    ds_read_b128 v[100:103], v192 offset:64
    ds_read_b128 v[104:107], v193 offset:0
    ds_read_b128 v[108:111], v193 offset:64
    ds_read_b128 v[112:115], v194 offset:0
    ds_read_b128 v[116:119], v194 offset:64
    ds_read_b128 v[128:131], v195 offset:0
    ds_read_b128 v[132:135], v195 offset:64
    ds_read_b128 v[144:147], v196 offset:0
    ds_read_b128 v[148:151], v196 offset:64
    ds_read_b128 v[160:163], v197 offset:0
    ds_read_b128 v[164:167], v197 offset:64
    ds_read2_b32 v[76:77], v78 offset0:0 offset1:2
    ds_read2_b32 v[78:79], v78 offset0:4 offset1:6
    ds_read_b128 v[176:179], v198 offset:0
    ds_read_b128 v[180:183], v198 offset:64
    s_waitcnt vmcnt(7) lgkmcnt(0)
    s_branch standalone__deep_cross_pnn__recsys_kernel_mid
standalone__deep_cross_pnn__recsys_kernel_loop:
    v_mfma_f32_16x16x32_bf16 v[184:187], v[96:99], v[96:99], 0
    v_mad_u32_u24 v220, v220, s57, v244
    v_fmac_f32 v240, v196, v32
    v_mfma_f32_16x16x32_bf16 v[184:187], v[100:103], v[100:103], v[184:187]
    v_fmac_f32 v240, v197, v33
    v_fmac_f32 v240, v198, v34
    v_mfma_f32_16x16x32_bf16 v[188:191], v[96:99], v[104:107], 0
    v_fmac_f32 v240, v199, v35
    v_mov_b64 v[248:249], 0
    v_mfma_f32_16x16x32_bf16 v[188:191], v[100:103], v[108:111], v[188:191]
    ds_read_b128 v[120:123], v220 offset:0
    ds_read_b128 v[124:127], v220 offset:64
    v_mfma_f32_16x16x32_bf16 v[192:195], v[96:99], v[112:115], 0
    v_mov_b64 v[250:251], 0
    v_mad_u32_u24 v221, v221, s57, v244
    v_mfma_f32_16x16x32_bf16 v[192:195], v[100:103], v[116:119], v[192:195]
    v_fmac_f32 v240, v52, v60
    v_fmac_f32 v240, v53, v61
    v_smfmac_f32_16x16x64_bf16 v[68:71], v[84:87], v[96:103], v253
    v_fmac_f32 v240, v54, v62
    v_mfma_f32_16x16x32_bf16 v[196:199], v[96:99], v[128:131], 0
    v_fmac_f32 v240, v55, v63
    v_fmac_f32 v240, v200, v36
    v_mfma_f32_16x16x32_bf16 v[196:199], v[100:103], v[132:135], v[196:199]
    v_mul_f32 v237, v192, v4
    v_fmac_f32 v240, v201, v37
    v_smfmac_f32_16x16x64_bf16 v[248:251], v[48:51], v[184:191], v252
    v_fmac_f32 v237, v68, v88
    v_mfma_f32_16x16x32_bf16 v[184:187], v[112:115], v[112:115], 0
    ds_read_b128 v[136:139], v221 offset:0
    ds_read_b128 v[140:143], v221 offset:64
    v_mfma_f32_16x16x32_bf16 v[184:187], v[116:119], v[116:119], v[184:187]
    v_fmac_f32 v237, v69, v88
    v_fmac_f32 v240, v202, v38
    v_mfma_f32_16x16x32_bf16 v[188:191], v[112:115], v[128:131], 0
    v_fmac_f32 v240, v203, v39
    v_fmac_f32 v240, v204, v40
    v_mfma_f32_16x16x32_bf16 v[188:191], v[116:119], v[132:135], v[188:191]
    v_fmac_f32 v240, v205, v41
    v_fmac_f32 v240, v206, v42
    v_smfmac_f32_16x16x64_bf16 v[68:71], v[84:87], v[112:119], v253
    v_fmac_f32 v240, v207, v43
    v_mfma_f32_16x16x32_bf16 v[200:203], v[96:99], v[144:147], 0
    v_mad_u32_u24 v222, v222, s57, v244
    v_mad_u32_u24 v218, v218, s57, v244
    v_mfma_f32_16x16x32_bf16 v[200:203], v[100:103], v[148:151], v[200:203]
    v_fmac_f32 v240, v208, v44
    v_fmac_f32 v240, v209, v45
    v_mfma_f32_16x16x32_bf16 v[204:207], v[96:99], v[160:163], 0
    ds_read_b128 v[152:155], v222 offset:0
    ds_read_b128 v[156:159], v222 offset:64
    v_mfma_f32_16x16x32_bf16 v[204:207], v[100:103], v[164:167], v[204:207]
    ds_read_b128 v[96:99], v218 offset:0
    ds_read_b128 v[100:103], v218 offset:64
    v_smfmac_f32_16x16x64_bf16 v[248:251], v[56:59], v[184:191], v252
    v_fmac_f32 v237, v68, v90
    v_fmac_f32 v237, v69, v90
    v_smfmac_f32_16x16x64_bf16 v[68:71], v[84:87], v[104:111], v253
    v_fmac_f32 v240, v210, v46
    v_mfma_f32_16x16x32_bf16 v[184:187], v[104:107], v[104:107], 0
    v_fmac_f32 v240, v211, v47
    v_fmac_f32 v237, v193, v5
    v_mfma_f32_16x16x32_bf16 v[184:187], v[108:111], v[108:111], v[184:187]
    v_fmac_f32 v237, v194, v6
    v_fmac_f32 v237, v195, v7
    v_mfma_f32_16x16x32_bf16 v[188:191], v[104:107], v[112:115], 0
    v_mad_u32_u24 v223, v223, s57, v244
    v_fmac_f32 v237, v68, v89
    v_mfma_f32_16x16x32_bf16 v[188:191], v[108:111], v[116:119], v[188:191]
    v_fmac_f32 v237, v69, v89
    v_permlane32_swap_b32 v239, v240
    v_mfma_f32_16x16x32_bf16 v[208:211], v[104:107], v[128:131], 0
    v_add_f32 v242, v239, v240
    v_fmac_f32 v237, v196, v8
    v_mfma_f32_16x16x32_bf16 v[208:211], v[108:111], v[132:135], v[208:211]
    v_permlane16_swap_b32 v241, v242
    v_mfma_f32_16x16x32_bf16 v[192:195], v[104:107], v[144:147], 0
    v_fmac_f32 v237, v197, v9
    v_fmac_f32 v237, v198, v10
    v_mfma_f32_16x16x32_bf16 v[192:195], v[108:111], v[148:151], v[192:195]
    ds_read_b128 v[168:171], v223 offset:0
    ds_read_b128 v[172:175], v223 offset:64
    v_smfmac_f32_16x16x64_bf16 v[248:251], v[64:67], v[184:191], v252
    v_fmac_f32 v237, v199, v11
    v_smfmac_f32_16x16x64_bf16 v[68:71], v[84:87], v[128:135], v253
    v_add_f32 v241, v241, v242
    v_mfma_f32_16x16x32_bf16 v[184:187], v[128:131], v[128:131], 0
    v_mad_u32_u24 v219, v219, s57, v244
    v_fmac_f32 v237, v200, v12
    v_mfma_f32_16x16x32_bf16 v[184:187], v[132:135], v[132:135], v[184:187]
    v_fmac_f32 v237, v201, v13
    v_fmac_f32 v237, v202, v14
    v_mfma_f32_16x16x32_bf16 v[188:191], v[128:131], v[144:147], 0
    v_fmac_f32 v237, v203, v15
    v_add_f32_dpp v241, v241, v241 row_ror:8 row_mask:0xf bank_mask:0xf
    v_mfma_f32_16x16x32_bf16 v[188:191], v[132:135], v[148:151], v[188:191]
    v_fmac_f32 v237, v68, v91
    v_fmac_f32 v237, v69, v91
    v_mfma_f32_16x16x32_bf16 v[196:199], v[104:107], v[160:163], 0
    v_add_f32_dpp v241, v241, v241 row_ror:4 row_mask:0xf bank_mask:0xf
    v_add_u32_dpp v78, v236, v247 quad_perm:[2,2,3,3] row_mask:0xf bank_mask:0xf
    v_mfma_f32_16x16x32_bf16 v[196:199], v[108:111], v[164:167], v[196:199]
    ds_read_b128 v[104:107], v219 offset:0
    ds_read_b128 v[108:111], v219 offset:64
    v_mfma_f32_16x16x32_bf16 v[200:203], v[112:115], v[144:147], 0
    v_add_f32_dpp v241, v241, v241 row_ror:2 row_mask:0xf bank_mask:0xf
    v_fmac_f32 v237, v204, v16
    v_mfma_f32_16x16x32_bf16 v[200:203], v[116:119], v[148:151], v[200:203]
    v_add_f32_dpp v241, v241, v241 row_ror:1 row_mask:0xf bank_mask:0xf
    v_fmac_f32 v237, v205, v17
    v_smfmac_f32_16x16x64_bf16 v[248:251], v[72:75], v[184:191], v252
    v_fmac_f32 v237, v206, v18
    v_smfmac_f32_16x16x64_bf16 v[68:71], v[84:87], v[144:151], v253
    v_fmac_f32 v237, v207, v19
    v_mfma_f32_16x16x32_bf16 v[184:187], v[144:147], v[144:147], 0
    v_cndmask_b32 v243, v243, v241, s[70:71]
    v_fmac_f32 v237, v208, v20
    v_mfma_f32_16x16x32_bf16 v[184:187], v[148:151], v[148:151], v[184:187]
    ds_read2_b32 v[76:77], v78 offset0:0 offset1:2
    ds_read2_b32 v[78:79], v78 offset0:4 offset1:6
    v_mfma_f32_16x16x32_bf16 v[188:191], v[160:163], v[160:163], 0
    v_fmac_f32 v237, v68, v92
    v_fmac_f32 v237, v69, v92
    v_mfma_f32_16x16x32_bf16 v[188:191], v[164:167], v[164:167], v[188:191]
    buffer_load_dword v236, v246, s[16:19], s74 offen offset:1184
    buffer_load_dwordx4 v[218:221], v245, s[16:19], s74 offen offset:1200
    buffer_load_dwordx2 v[222:223], v245, s[16:19], s74 offen offset:1216
    v_mfma_f32_16x16x32_bf16 v[204:207], v[112:115], v[160:163], 0
    v_fmac_f32 v237, v209, v21
    v_fmac_f32 v237, v210, v22
    v_mfma_f32_16x16x32_bf16 v[204:207], v[116:119], v[164:167], v[204:207]
    v_fmac_f32 v237, v211, v23
    s_lshl_b64 s[70:71], s[70:71], 1
    v_smfmac_f32_16x16x64_bf16 v[68:71], v[84:87], v[160:167], v253
    v_fmac_f32 v237, v192, v24
    v_mfma_f32_16x16x32_bf16 v[208:211], v[128:131], v[160:163], 0
    v_fmac_f32 v237, v193, v25
    v_fmac_f32 v237, v194, v26
    v_mfma_f32_16x16x32_bf16 v[208:211], v[132:135], v[164:167], v[208:211]
    v_fmac_f32 v237, v195, v27
    v_fmac_f32 v237, v196, v28
    v_smfmac_f32_16x16x64_bf16 v[248:251], v[80:83], v[184:191], v252
    v_fmac_f32 v237, v197, v29
    v_mfma_f32_16x16x32_bf16 v[192:195], v[144:147], v[160:163], 0
    v_fmac_f32 v237, v198, v30
    v_fmac_f32 v237, v199, v31
    v_mfma_f32_16x16x32_bf16 v[192:195], v[148:151], v[164:167], v[192:195]
    v_mov_b64 v[70:71], 0
    s_waitcnt vmcnt(7) lgkmcnt(0)
    v_mfma_f32_16x16x32_bf16 v[184:187], v[96:99], v[96:99], 0
    v_mad_u32_u24 v226, v226, s57, v244
    v_fmac_f32 v237, v68, v93
    v_mfma_f32_16x16x32_bf16 v[184:187], v[100:103], v[100:103], v[184:187]
    v_fmac_f32 v237, v69, v93
    v_fmac_f32 v237, v200, v32
    v_mfma_f32_16x16x32_bf16 v[188:191], v[96:99], v[104:107], 0
    v_fmac_f32 v237, v201, v33
    v_fmac_f32 v237, v202, v34
    v_mfma_f32_16x16x32_bf16 v[188:191], v[100:103], v[108:111], v[188:191]
    ds_read_b128 v[112:115], v226 offset:0
    ds_read_b128 v[116:119], v226 offset:64
    v_mfma_f32_16x16x32_bf16 v[196:199], v[96:99], v[120:123], 0
    v_fmac_f32 v237, v203, v35
    v_mov_b64 v[52:53], 0
    v_mfma_f32_16x16x32_bf16 v[196:199], v[100:103], v[124:127], v[196:199]
    v_mov_b64 v[54:55], 0
    v_mad_u32_u24 v227, v227, s57, v244
    v_smfmac_f32_16x16x64_bf16 v[68:71], v[84:87], v[96:103], v253
    v_fmac_f32 v237, v248, v60
    v_mfma_f32_16x16x32_bf16 v[200:203], v[96:99], v[136:139], 0
    v_fmac_f32 v237, v249, v61
    v_fmac_f32 v237, v250, v62
    v_mfma_f32_16x16x32_bf16 v[200:203], v[100:103], v[140:143], v[200:203]
    v_fmac_f32 v237, v251, v63
    v_mul_f32 v238, v196, v4
    v_smfmac_f32_16x16x64_bf16 v[52:55], v[48:51], v[184:191], v252
    v_fmac_f32 v238, v70, v88
    v_mfma_f32_16x16x32_bf16 v[184:187], v[120:123], v[120:123], 0
    ds_read_b128 v[128:131], v227 offset:0
    ds_read_b128 v[132:135], v227 offset:64
    v_mfma_f32_16x16x32_bf16 v[184:187], v[124:127], v[124:127], v[184:187]
    v_fmac_f32 v238, v71, v88
    v_fmac_f32 v237, v204, v36
    v_mfma_f32_16x16x32_bf16 v[188:191], v[120:123], v[136:139], 0
    v_fmac_f32 v237, v205, v37
    v_fmac_f32 v237, v206, v38
    v_mfma_f32_16x16x32_bf16 v[188:191], v[124:127], v[140:143], v[188:191]
    v_fmac_f32 v237, v207, v39
    v_mad_u32_u24 v228, v228, s57, v244
    v_smfmac_f32_16x16x64_bf16 v[68:71], v[84:87], v[120:127], v253
    v_mad_u32_u24 v224, v224, s57, v244
    v_mfma_f32_16x16x32_bf16 v[204:207], v[96:99], v[152:155], 0
    v_fmac_f32 v237, v208, v40
    v_fmac_f32 v237, v209, v41
    v_mfma_f32_16x16x32_bf16 v[204:207], v[100:103], v[156:159], v[204:207]
    v_fmac_f32 v237, v210, v42
    v_fmac_f32 v237, v211, v43
    v_mfma_f32_16x16x32_bf16 v[208:211], v[96:99], v[168:171], 0
    ds_read_b128 v[144:147], v228 offset:0
    ds_read_b128 v[148:151], v228 offset:64
    v_mfma_f32_16x16x32_bf16 v[208:211], v[100:103], v[172:175], v[208:211]
    ds_read_b128 v[96:99], v224 offset:0
    ds_read_b128 v[100:103], v224 offset:64
    v_smfmac_f32_16x16x64_bf16 v[52:55], v[56:59], v[184:191], v252
    v_fmac_f32 v238, v70, v90
    v_fmac_f32 v238, v71, v90
    v_smfmac_f32_16x16x64_bf16 v[68:71], v[84:87], v[104:111], v253
    v_fmac_f32 v237, v192, v44
    v_mfma_f32_16x16x32_bf16 v[184:187], v[104:107], v[104:107], 0
    v_fmac_f32 v237, v193, v45
    v_fmac_f32 v237, v194, v46
    v_mfma_f32_16x16x32_bf16 v[184:187], v[108:111], v[108:111], v[184:187]
    v_fmac_f32 v237, v195, v47
    v_fmac_f32 v238, v197, v5
    v_mfma_f32_16x16x32_bf16 v[188:191], v[104:107], v[120:123], 0
    v_fmac_f32 v238, v198, v6
    v_fmac_f32 v238, v199, v7
    v_mfma_f32_16x16x32_bf16 v[188:191], v[108:111], v[124:127], v[188:191]
    v_mad_u32_u24 v229, v229, s57, v244
    v_fmac_f32 v238, v70, v89
    v_mfma_f32_16x16x32_bf16 v[192:195], v[104:107], v[136:139], 0
    v_fmac_f32 v238, v71, v89
    v_fmac_f32 v238, v200, v8
    v_mfma_f32_16x16x32_bf16 v[192:195], v[108:111], v[140:143], v[192:195]
    v_fmac_f32 v238, v201, v9
    v_fmac_f32 v238, v202, v10
    v_mfma_f32_16x16x32_bf16 v[196:199], v[104:107], v[152:155], 0
    v_fmac_f32 v238, v203, v11
    v_mad_u32_u24 v225, v225, s57, v244
    v_mfma_f32_16x16x32_bf16 v[196:199], v[108:111], v[156:159], v[196:199]
    ds_read_b128 v[160:163], v229 offset:0
    ds_read_b128 v[164:167], v229 offset:64
    v_smfmac_f32_16x16x64_bf16 v[52:55], v[64:67], v[184:191], v252
    v_fmac_f32 v238, v204, v12
    v_smfmac_f32_16x16x64_bf16 v[68:71], v[84:87], v[136:143], v253
    v_fmac_f32 v238, v205, v13
    v_mfma_f32_16x16x32_bf16 v[184:187], v[136:139], v[136:139], 0
    v_fmac_f32 v238, v206, v14
    v_fmac_f32 v238, v207, v15
    v_mfma_f32_16x16x32_bf16 v[184:187], v[140:143], v[140:143], v[184:187]
    v_fmac_f32 v238, v208, v16
    v_fmac_f32 v238, v209, v17
    v_mfma_f32_16x16x32_bf16 v[188:191], v[136:139], v[152:155], 0
    v_fmac_f32 v238, v70, v91
    v_fmac_f32 v238, v71, v91
    v_mfma_f32_16x16x32_bf16 v[188:191], v[140:143], v[156:159], v[188:191]
    v_fmac_f32 v238, v210, v18
    v_fmac_f32 v238, v211, v19
    v_mfma_f32_16x16x32_bf16 v[200:203], v[104:107], v[168:171], 0
    v_fmac_f32 v238, v192, v20
    v_fmac_f32 v238, v193, v21
    v_mfma_f32_16x16x32_bf16 v[200:203], v[108:111], v[172:175], v[200:203]
    ds_read_b128 v[104:107], v225 offset:0
    ds_read_b128 v[108:111], v225 offset:64
    v_mfma_f32_16x16x32_bf16 v[204:207], v[120:123], v[152:155], 0
    v_fmac_f32 v238, v194, v22
    v_fmac_f32 v238, v195, v23
    v_mfma_f32_16x16x32_bf16 v[204:207], v[124:127], v[156:159], v[204:207]
    buffer_load_dwordx4 v[224:227], v245, s[16:19], s74 offen offset:1600
    buffer_load_dwordx2 v[228:229], v245, s[16:19], s74 offen offset:1616
    v_smfmac_f32_16x16x64_bf16 v[52:55], v[72:75], v[184:191], v252
    v_fmac_f32 v238, v196, v24
    v_smfmac_f32_16x16x64_bf16 v[68:71], v[84:87], v[152:159], v253
    v_fmac_f32 v238, v197, v25
    v_mfma_f32_16x16x32_bf16 v[184:187], v[152:155], v[152:155], 0
    v_fmac_f32 v238, v198, v26
    v_fmac_f32 v238, v199, v27
    v_mfma_f32_16x16x32_bf16 v[184:187], v[156:159], v[156:159], v[184:187]
    v_fmac_f32 v238, v200, v28
    v_fmac_f32 v238, v201, v29
    v_mfma_f32_16x16x32_bf16 v[188:191], v[168:171], v[168:171], 0
    v_fmac_f32 v238, v70, v92
    v_fmac_f32 v238, v71, v92
    v_mfma_f32_16x16x32_bf16 v[188:191], v[172:175], v[172:175], v[188:191]
    v_fmac_f32 v238, v202, v30
    v_fmac_f32 v238, v203, v31
    v_mfma_f32_16x16x32_bf16 v[208:211], v[120:123], v[168:171], 0
    v_fmac_f32 v238, v204, v32
    v_fmac_f32 v238, v205, v33
    v_mfma_f32_16x16x32_bf16 v[208:211], v[124:127], v[172:175], v[208:211]
    v_fmac_f32 v238, v206, v34
    v_fmac_f32 v238, v207, v35
    v_smfmac_f32_16x16x64_bf16 v[68:71], v[84:87], v[168:175], v253
    v_mov_b64 v[248:249], 0
    v_mfma_f32_16x16x32_bf16 v[192:195], v[136:139], v[168:171], 0
    v_mov_b64 v[250:251], 0
    v_mfma_f32_16x16x32_bf16 v[192:195], v[140:143], v[172:175], v[192:195]
    v_smfmac_f32_16x16x64_bf16 v[52:55], v[80:83], v[184:191], v252
    v_fmac_f32 v238, v208, v36
    v_mfma_f32_16x16x32_bf16 v[196:199], v[152:155], v[168:171], 0
    v_fmac_f32 v238, v209, v37
    v_mov_b64 v[68:69], 0
    v_mfma_f32_16x16x32_bf16 v[196:199], v[156:159], v[172:175], v[196:199]
    v_fmac_f32 v238, v70, v93
    s_waitcnt vmcnt(7) lgkmcnt(0)
standalone__deep_cross_pnn__recsys_kernel_mid:
    v_mfma_f32_16x16x32_bf16 v[184:187], v[96:99], v[96:99], 0
    v_mad_u32_u24 v232, v232, s57, v244
    v_fmac_f32 v238, v71, v93
    v_mfma_f32_16x16x32_bf16 v[184:187], v[100:103], v[100:103], v[184:187]
    v_mad_u32_u24 v233, v233, s57, v244
    v_fmac_f32 v238, v52, v60
    v_mfma_f32_16x16x32_bf16 v[188:191], v[96:99], v[104:107], 0
    v_fmac_f32 v238, v53, v61
    v_fmac_f32 v238, v54, v62
    v_mfma_f32_16x16x32_bf16 v[188:191], v[100:103], v[108:111], v[188:191]
    ds_read_b128 v[120:123], v232 offset:0
    ds_read_b128 v[124:127], v232 offset:64
    v_mfma_f32_16x16x32_bf16 v[200:203], v[96:99], v[112:115], 0
    v_fmac_f32 v238, v55, v63
    v_fmac_f32 v238, v210, v38
    v_mfma_f32_16x16x32_bf16 v[200:203], v[100:103], v[116:119], v[200:203]
    v_fmac_f32 v238, v211, v39
    v_mad_u32_u24 v234, v234, s57, v244
    v_smfmac_f32_16x16x64_bf16 v[68:71], v[76:79], v[96:103], v253
    v_mad_u32_u24 v230, v230, s57, v244
    v_mfma_f32_16x16x32_bf16 v[204:207], v[96:99], v[128:131], 0
    v_fmac_f32 v238, v192, v40
    v_fmac_f32 v238, v193, v41
    v_mfma_f32_16x16x32_bf16 v[204:207], v[100:103], v[132:135], v[204:207]
    v_mul_f32 v239, v200, v4
    v_fmac_f32 v238, v194, v42
    v_smfmac_f32_16x16x64_bf16 v[248:251], v[48:51], v[184:191], v252
    v_fmac_f32 v239, v68, v88
    v_mfma_f32_16x16x32_bf16 v[184:187], v[112:115], v[112:115], 0
    ds_read_b128 v[136:139], v233 offset:0
    ds_read_b128 v[140:143], v233 offset:64
    v_mfma_f32_16x16x32_bf16 v[184:187], v[116:119], v[116:119], v[184:187]
    v_fmac_f32 v239, v69, v88
    v_fmac_f32 v238, v195, v43
    v_mfma_f32_16x16x32_bf16 v[188:191], v[112:115], v[128:131], 0
    v_fmac_f32 v238, v196, v44
    v_fmac_f32 v238, v197, v45
    v_mfma_f32_16x16x32_bf16 v[188:191], v[116:119], v[132:135], v[188:191]
    v_fmac_f32 v238, v198, v46
    v_fmac_f32 v238, v199, v47
    v_smfmac_f32_16x16x64_bf16 v[68:71], v[76:79], v[112:119], v253
    v_fmac_f32 v239, v201, v5
    v_mfma_f32_16x16x32_bf16 v[208:211], v[96:99], v[144:147], 0
    v_fmac_f32 v239, v202, v6
    v_fmac_f32 v239, v203, v7
    v_mfma_f32_16x16x32_bf16 v[208:211], v[100:103], v[148:151], v[208:211]
    v_mad_u32_u24 v235, v235, s57, v244
    v_fmac_f32 v239, v204, v8
    v_mfma_f32_16x16x32_bf16 v[192:195], v[96:99], v[160:163], 0
    ds_read_b128 v[152:155], v234 offset:0
    ds_read_b128 v[156:159], v234 offset:64
    v_mfma_f32_16x16x32_bf16 v[192:195], v[100:103], v[164:167], v[192:195]
    ds_read_b128 v[96:99], v230 offset:0
    ds_read_b128 v[100:103], v230 offset:64
    v_smfmac_f32_16x16x64_bf16 v[248:251], v[56:59], v[184:191], v252
    v_fmac_f32 v239, v68, v90
    v_fmac_f32 v239, v69, v90
    v_smfmac_f32_16x16x64_bf16 v[68:71], v[76:79], v[104:111], v253
    v_fmac_f32 v239, v205, v9
    v_mfma_f32_16x16x32_bf16 v[184:187], v[104:107], v[104:107], 0
    v_fmac_f32 v239, v206, v10
    v_fmac_f32 v239, v207, v11
    v_mfma_f32_16x16x32_bf16 v[184:187], v[108:111], v[108:111], v[184:187]
    v_mad_u32_u24 v231, v231, s57, v244
    v_fmac_f32 v239, v208, v12
    v_mfma_f32_16x16x32_bf16 v[188:191], v[104:107], v[112:115], 0
    v_fmac_f32 v239, v68, v89
    v_fmac_f32 v239, v69, v89
    v_mfma_f32_16x16x32_bf16 v[188:191], v[108:111], v[116:119], v[188:191]
    v_fmac_f32 v239, v209, v13
    v_fmac_f32 v239, v210, v14
    v_mfma_f32_16x16x32_bf16 v[196:199], v[104:107], v[128:131], 0
    v_fmac_f32 v239, v211, v15
    v_fmac_f32 v239, v192, v16
    v_mfma_f32_16x16x32_bf16 v[196:199], v[108:111], v[132:135], v[196:199]
    v_fmac_f32 v239, v193, v17
    v_fmac_f32 v239, v194, v18
    v_mfma_f32_16x16x32_bf16 v[200:203], v[104:107], v[144:147], 0
    v_fmac_f32 v239, v195, v19
    v_mov_b64 v[52:53], 0
    v_mfma_f32_16x16x32_bf16 v[200:203], v[108:111], v[148:151], v[200:203]
    ds_read_b128 v[168:171], v235 offset:0
    ds_read_b128 v[172:175], v235 offset:64
    v_smfmac_f32_16x16x64_bf16 v[248:251], v[64:67], v[184:191], v252
    v_fmac_f32 v239, v196, v20
    v_smfmac_f32_16x16x64_bf16 v[68:71], v[76:79], v[128:135], v253
    v_fmac_f32 v239, v197, v21
    v_mfma_f32_16x16x32_bf16 v[184:187], v[128:131], v[128:131], 0
    v_fmac_f32 v239, v198, v22
    v_fmac_f32 v239, v199, v23
    v_mfma_f32_16x16x32_bf16 v[184:187], v[132:135], v[132:135], v[184:187]
    v_fmac_f32 v239, v200, v24
    v_fmac_f32 v239, v201, v25
    v_mfma_f32_16x16x32_bf16 v[188:191], v[128:131], v[144:147], 0
    v_fmac_f32 v239, v68, v91
    v_fmac_f32 v239, v69, v91
    v_mfma_f32_16x16x32_bf16 v[188:191], v[132:135], v[148:151], v[188:191]
    v_fmac_f32 v239, v202, v26
    v_fmac_f32 v239, v203, v27
    v_mfma_f32_16x16x32_bf16 v[204:207], v[104:107], v[160:163], 0
    v_mov_b64 v[54:55], 0
    v_mfma_f32_16x16x32_bf16 v[204:207], v[108:111], v[164:167], v[204:207]
    ds_read_b128 v[104:107], v231 offset:0
    ds_read_b128 v[108:111], v231 offset:64
    v_mfma_f32_16x16x32_bf16 v[208:211], v[112:115], v[144:147], 0
    v_mfma_f32_16x16x32_bf16 v[208:211], v[116:119], v[148:151], v[208:211]
    buffer_load_dwordx4 v[230:233], v245, s[16:19], s74 offen offset:2000
    buffer_load_dwordx2 v[234:235], v245, s[16:19], s74 offen offset:2016
    v_smfmac_f32_16x16x64_bf16 v[248:251], v[72:75], v[184:191], v252
    v_smfmac_f32_16x16x64_bf16 v[68:71], v[76:79], v[144:151], v253
    v_fmac_f32 v239, v204, v28
    v_mfma_f32_16x16x32_bf16 v[184:187], v[144:147], v[144:147], 0
    v_fmac_f32 v239, v205, v29
    v_fmac_f32 v239, v206, v30
    v_mfma_f32_16x16x32_bf16 v[184:187], v[148:151], v[148:151], v[184:187]
    v_fmac_f32 v239, v207, v31
    v_fmac_f32 v239, v208, v32
    v_mfma_f32_16x16x32_bf16 v[188:191], v[160:163], v[160:163], 0
    v_fmac_f32 v239, v68, v92
    v_fmac_f32 v239, v69, v92
    v_mfma_f32_16x16x32_bf16 v[188:191], v[164:167], v[164:167], v[188:191]
    v_fmac_f32 v239, v209, v33
    v_fmac_f32 v239, v210, v34
    v_mfma_f32_16x16x32_bf16 v[192:195], v[176:179], v[176:179], 0
    v_fmac_f32 v239, v211, v35
    v_mfma_f32_16x16x32_bf16 v[192:195], v[180:183], v[180:183], v[192:195]
    v_mfma_f32_16x16x32_bf16 v[196:199], v[112:115], v[160:163], 0
    v_mfma_f32_16x16x32_bf16 v[196:199], v[116:119], v[164:167], v[196:199]
    v_smfmac_f32_16x16x64_bf16 v[68:71], v[76:79], v[160:167], v253
    v_mfma_f32_16x16x32_bf16 v[200:203], v[128:131], v[160:163], 0
    v_mfma_f32_16x16x32_bf16 v[200:203], v[132:135], v[164:167], v[200:203]
    v_smfmac_f32_16x16x64_bf16 v[248:251], v[80:83], v[184:191], v252
    v_mfma_f32_16x16x32_bf16 v[204:207], v[144:147], v[160:163], 0
    v_mfma_f32_16x16x32_bf16 v[204:207], v[148:151], v[164:167], v[204:207]
    v_fmac_f32 v237, v192, v0
    s_waitcnt vmcnt(6) lgkmcnt(0)
    v_mfma_f32_16x16x32_bf16 v[184:187], v[96:99], v[96:99], 0
    v_mad_u32_u24 v214, v214, s57, v244
    v_mov_b64 v[70:71], 0
    v_mfma_f32_16x16x32_bf16 v[184:187], v[100:103], v[100:103], v[184:187]
    v_fmac_f32 v239, v68, v93
    v_fmac_f32 v239, v69, v93
    v_mfma_f32_16x16x32_bf16 v[188:191], v[96:99], v[104:107], 0
    v_fmac_f32 v238, v193, v1
    v_fmac_f32 v239, v194, v2
    v_mfma_f32_16x16x32_bf16 v[188:191], v[100:103], v[108:111], v[188:191]
    ds_read_b128 v[112:115], v214 offset:0
    ds_read_b128 v[116:119], v214 offset:64
    v_mfma_f32_16x16x32_bf16 v[208:211], v[96:99], v[120:123], 0
    v_mul_f32 v240, v195, v3
    v_mad_u32_u24 v215, v215, s57, v244
    v_mfma_f32_16x16x32_bf16 v[208:211], v[100:103], v[124:127], v[208:211]
    v_fmac_f32 v239, v248, v60
    v_fmac_f32 v239, v249, v61
    v_smfmac_f32_16x16x64_bf16 v[68:71], v[76:79], v[96:103], v253
    v_fmac_f32 v239, v250, v62
    v_mfma_f32_16x16x32_bf16 v[192:195], v[96:99], v[136:139], 0
    v_fmac_f32 v239, v251, v63
    v_fmac_f32 v239, v196, v36
    v_mfma_f32_16x16x32_bf16 v[192:195], v[100:103], v[140:143], v[192:195]
    v_fmac_f32 v239, v197, v37
    v_fmac_f32 v239, v198, v38
    v_smfmac_f32_16x16x64_bf16 v[52:55], v[48:51], v[184:191], v252
    v_fmac_f32 v240, v70, v88
    v_mfma_f32_16x16x32_bf16 v[184:187], v[120:123], v[120:123], 0
    ds_read_b128 v[128:131], v215 offset:0
    ds_read_b128 v[132:135], v215 offset:64
    v_mfma_f32_16x16x32_bf16 v[184:187], v[124:127], v[124:127], v[184:187]
    v_fmac_f32 v240, v71, v88
    v_fmac_f32 v239, v199, v39
    v_mfma_f32_16x16x32_bf16 v[188:191], v[120:123], v[136:139], 0
    v_mad_u32_u24 v216, v216, s57, v244
    v_mad_u32_u24 v212, v212, s57, v244
    v_mfma_f32_16x16x32_bf16 v[188:191], v[124:127], v[140:143], v[188:191]
    v_fmac_f32 v239, v200, v40
    v_fmac_f32 v239, v201, v41
    v_smfmac_f32_16x16x64_bf16 v[68:71], v[76:79], v[120:127], v253
    v_fmac_f32 v239, v202, v42
    v_mfma_f32_16x16x32_bf16 v[196:199], v[96:99], v[152:155], 0
    v_fmac_f32 v239, v203, v43
    v_fmac_f32 v239, v204, v44
    v_mfma_f32_16x16x32_bf16 v[196:199], v[100:103], v[156:159], v[196:199]
    v_fmac_f32 v239, v205, v45
    v_fmac_f32 v239, v206, v46
    v_mfma_f32_16x16x32_bf16 v[200:203], v[96:99], v[168:171], 0
    ds_read_b128 v[144:147], v216 offset:0
    ds_read_b128 v[148:151], v216 offset:64
    v_mfma_f32_16x16x32_bf16 v[200:203], v[100:103], v[172:175], v[200:203]
    ds_read_b128 v[96:99], v212 offset:0
    ds_read_b128 v[100:103], v212 offset:64
    v_smfmac_f32_16x16x64_bf16 v[52:55], v[56:59], v[184:191], v252
    v_fmac_f32 v240, v70, v90
    v_fmac_f32 v240, v71, v90
    v_smfmac_f32_16x16x64_bf16 v[68:71], v[76:79], v[104:111], v253
    v_fmac_f32 v239, v207, v47
    v_mfma_f32_16x16x32_bf16 v[184:187], v[104:107], v[104:107], 0
    v_fmac_f32 v240, v208, v4
    v_fmac_f32 v240, v209, v5
    v_mfma_f32_16x16x32_bf16 v[184:187], v[108:111], v[108:111], v[184:187]
    v_fmac_f32 v240, v210, v6
    v_fmac_f32 v240, v211, v7
    v_mfma_f32_16x16x32_bf16 v[188:191], v[104:107], v[120:123], 0
    v_mad_u32_u24 v217, v217, s57, v244
    v_fmac_f32 v240, v70, v89
    v_mfma_f32_16x16x32_bf16 v[188:191], v[108:111], v[124:127], v[188:191]
    v_fmac_f32 v240, v71, v89
    v_fmac_f32 v240, v192, v8
    v_mfma_f32_16x16x32_bf16 v[204:207], v[104:107], v[136:139], 0
    v_fmac_f32 v240, v193, v9
    v_fmac_f32 v240, v194, v10
    v_mfma_f32_16x16x32_bf16 v[204:207], v[108:111], v[140:143], v[204:207]
    v_fmac_f32 v240, v195, v11
    v_mad_u32_u24 v213, v213, s57, v244
    v_mfma_f32_16x16x32_bf16 v[208:211], v[104:107], v[152:155], 0
    v_fmac_f32 v240, v196, v12
    v_fmac_f32 v240, v197, v13
    v_mfma_f32_16x16x32_bf16 v[208:211], v[108:111], v[156:159], v[208:211]
    ds_read_b128 v[160:163], v217 offset:0
    ds_read_b128 v[164:167], v217 offset:64
    v_smfmac_f32_16x16x64_bf16 v[52:55], v[64:67], v[184:191], v252
    v_fmac_f32 v240, v198, v14
    v_smfmac_f32_16x16x64_bf16 v[68:71], v[76:79], v[136:143], v253
    v_fmac_f32 v240, v199, v15
    v_mfma_f32_16x16x32_bf16 v[184:187], v[136:139], v[136:139], 0
    v_mad_u32_u24 v236, v236, s57, v244
    v_fmac_f32 v240, v200, v16
    v_mfma_f32_16x16x32_bf16 v[184:187], v[140:143], v[140:143], v[184:187]
    v_add_u32_dpp v86, v236, v247 quad_perm:[0,0,1,1] row_mask:0xf bank_mask:0xf
    v_fmac_f32 v240, v201, v17
    v_mfma_f32_16x16x32_bf16 v[188:191], v[136:139], v[152:155], 0
    v_fmac_f32 v240, v70, v91
    v_fmac_f32 v240, v71, v91
    v_mfma_f32_16x16x32_bf16 v[188:191], v[140:143], v[156:159], v[188:191]
    v_fmac_f32 v240, v202, v18
    v_fmac_f32 v240, v203, v19
    v_mfma_f32_16x16x32_bf16 v[192:195], v[104:107], v[168:171], 0
    v_permlane32_swap_b32 v237, v238
    v_mfma_f32_16x16x32_bf16 v[192:195], v[108:111], v[172:175], v[192:195]
    ds_read_b128 v[104:107], v213 offset:0
    ds_read_b128 v[108:111], v213 offset:64
    v_mfma_f32_16x16x32_bf16 v[196:199], v[120:123], v[152:155], 0
    v_fmac_f32 v240, v204, v20
    v_fmac_f32 v240, v205, v21
    v_mfma_f32_16x16x32_bf16 v[196:199], v[124:127], v[156:159], v[196:199]
    v_fmac_f32 v240, v206, v22
    v_fmac_f32 v240, v207, v23
    v_smfmac_f32_16x16x64_bf16 v[52:55], v[72:75], v[184:191], v252
    v_add_f32 v241, v237, v238
    v_smfmac_f32_16x16x64_bf16 v[68:71], v[76:79], v[152:159], v253
    v_fmac_f32 v240, v208, v24
    v_mfma_f32_16x16x32_bf16 v[184:187], v[152:155], v[152:155], 0
    ds_read_b128 v[176:179], v236 offset:0
    ds_read_b128 v[180:183], v236 offset:64
    v_mfma_f32_16x16x32_bf16 v[184:187], v[156:159], v[156:159], v[184:187]
    v_fmac_f32 v240, v209, v25
    v_fmac_f32 v240, v210, v26
    v_mfma_f32_16x16x32_bf16 v[188:191], v[168:171], v[168:171], 0
    v_fmac_f32 v240, v70, v92
    v_fmac_f32 v240, v71, v92
    v_mfma_f32_16x16x32_bf16 v[188:191], v[172:175], v[172:175], v[188:191]
    ds_read2_b32 v[84:85], v86 offset0:0 offset1:2
    ds_read2_b32 v[86:87], v86 offset0:4 offset1:6
    v_mfma_f32_16x16x32_bf16 v[200:203], v[120:123], v[168:171], 0
    v_fmac_f32 v240, v211, v27
    v_fmac_f32 v240, v192, v28
    v_mfma_f32_16x16x32_bf16 v[200:203], v[124:127], v[172:175], v[200:203]
    buffer_load_dwordx4 v[212:215], v245, s[16:19], s74 offen offset:2400
    buffer_load_dwordx2 v[216:217], v245, s[16:19], s74 offen offset:2416
    v_smfmac_f32_16x16x64_bf16 v[68:71], v[76:79], v[168:175], v253
    s_add_u32 s74, s74, 1600
    v_mfma_f32_16x16x32_bf16 v[204:207], v[136:139], v[168:171], 0
    s_cmp_lt_u32 s74, s58
    v_fmac_f32 v240, v193, v29
    v_mfma_f32_16x16x32_bf16 v[204:207], v[140:143], v[172:175], v[204:207]
    v_fmac_f32 v240, v194, v30
    v_fmac_f32 v240, v195, v31
    v_smfmac_f32_16x16x64_bf16 v[52:55], v[80:83], v[184:191], v252
    v_mov_b64 v[68:69], 0
    v_mfma_f32_16x16x32_bf16 v[208:211], v[152:155], v[168:171], 0
    v_fmac_f32 v240, v70, v93
    v_fmac_f32 v240, v71, v93
    v_mfma_f32_16x16x32_bf16 v[208:211], v[156:159], v[172:175], v[208:211]
    s_waitcnt vmcnt(6) lgkmcnt(0)
    s_cbranch_scc1 standalone__deep_cross_pnn__recsys_kernel_loop
    s_branch standalone__deep_cross_pnn__recsys_kernel_k2m
standalone__deep_cross_pnn__recsys_kernel_aux:

    s_setprio 0
    s_load_dword s24, s[60:61], 0
    s_load_dword s25, s[60:61], 16
    s_load_dword s26, s[60:61], 32
    s_load_dword s27, s[60:61], 48
    v_mov_b32 v8, v255
    v_mov_b32 v9, v254
    v_mov_b32 v10, v253
    v_mov_b32 v11, v252
    s_mov_b32 s51, s2
    s_mov_b32 s64, 0
    s_mov_b32 s65, 0

    v_mov_b32 v35, v83
    s_lshr_b32 s72, s2, 3
    s_mul_i32 s72, s72, 36
    s_lshr_b32 s72, s72, 5
    s_lshl_b32 s75, s36, 7
    s_add_u32 s75, s75, 254464
    s_mov_b32 s76, 143136
    s_lshl_b32 s6, s2, 15
    s_lshl_b32 s7, s56, 13
    s_add_u32 s6, s6, s7
    s_add_u32 s6, s6, 20971520
    s_add_u32 s7, s6, 4096
    s_lshl_b32 s8, s36, 7
    s_add_u32 s8, s8, s37
    s_lshl_b32 s8, s8, 9
    s_bitcmp1_b32 s37, 0
    s_cselect_b32 s9, 32, 0
    s_add_u32 s8, s8, s9
    s_add_u32 s8, s8, 29360128
    s_and_b32 s9, s2, 63
    s_lshl_b32 s9, s9, 5
    s_lshr_b32 s38, s2, 6
    s_add_u32 s9, s9, s38
    s_lshl_b32 s9, s9, 2
    s_add_u32 s9, s9, 14680064
    v_mov_b32 v112, 0

standalone__deep_cross_pnn__recsys_kernel_unit:

    s_bfe_u32 s36, s51, 0x10003

    s_lshr_b32 s38, s51, 4
    s_and_b32 s39, s51, 7
    s_sub_u32 s57, 2, s36
    s_lshl_b32 s57, s39, s57
    s_lshl_b32 s37, s36, 5
    s_add_u32 s57, s57, s37
    s_add_u32 s57, s57, s56
    s_mul_i32 s37, s38, 48
    s_add_u32 s37, s37, s57
    s_lshl_b32 s38, s38, 1
    s_lshr_b32 s39, s39, 2
    s_add_u32 s38, s38, s39
    s_add_u32 s38, s38, 768
    s_and_b32 s57, s57, 7
    s_cmp_eq_u32 s57, 2
    s_cselect_b32 s38, s38, 1000
    s_lshl_b32 s39, s36, 1
    s_and_b32 s39, s39, s56
    s_cselect_b32 s57, s38, s37

    s_lshr_b32 s37, s51, 4
    s_lshl_b32 s37, s37, 3
    s_and_b32 s38, s51, 7
    s_or_b32 s37, s37, s38
    s_and_b32 s58, s56, 1
    s_lshl_b32 s59, s37, 1
    s_add_u32 s58, s58, s59
    s_lshr_b32 s59, s56, 1
    s_xor_b32 s60, s36, 1
    s_mul_i32 s46, s60, 13
    s_lshl_b32 s60, s60, 1
    s_add_u32 s59, s59, s60
    s_add_u32 s61, s46, 6
    s_add_u32 s60, s46, 12
    s_bitcmp1_b32 s59, 0
    s_cselect_b32 s46, s60, s46
    s_cselect_b32 s63, -1, 1
    s_cselect_b32 s61, 24, s61
    v_lshrrev_b32 v1, 3, v8
    v_and_b32 v2, 7, v8
    v_mul_i32_i24 v7, s63, v2
    v_add_u32 v7, s46, v7
    v_cmp_ge_u32 s[48:49], s61, v7
    s_mul_i32 s60, s58, 25600
    s_movk_i32 s61, 400
    s_lshl_b32 s63, s63, 16
    v_mul_u32_u24 v0, s61, v1
    v_lshl_add_u32 v0, v7, 4, v0
    v_and_b32 v5, 15, v8
    v_and_b32 v6, 48, v8
    v_lshl_add_u32 v56, v5, 8, v6
    s_lshr_b32 s44, s37, 1
    s_lshl_b32 s44, s44, 12
    s_lshl_b32 s38, s36, 1
    s_and_b32 s39, s37, 1
    s_add_u32 s38, s38, s39
    s_lshl_b32 s38, s38, 6
    s_add_u32 s44, s44, s38
    s_lshl_b32 s47, s36, 7
    s_add_u32 s47, s47, s37
    s_lshl_b32 s47, s47, 10
    s_add_u32 s47, s47, 15204352

    s_cmp_eq_u32 s56, 0
    s_cselect_b64 s[4:5], -1, 0
    s_cmp_lg_u32 s64, 0
    s_cbranch_scc1 standalone__deep_cross_pnn__recsys_kernel_nd1
    s_mov_b64 exec, s[40:41]

    s_mul_i32 s73, s72, 4032
    s_mul_i32 s74, s72, 7168
    s_add_u32 s73, s73, s43
    s_add_u32 s74, s74, s42
    s_min_u32 m0, s73, s76
    s_min_u32 s74, s74, s75
    s_add_u32 s72, s72, 1

    buffer_load_dwordx4 v35, s[20:23], s74 offen lds
    s_cmp_eq_u32 s72, 36
    s_cselect_b32 s72, 0, s72

    s_mul_i32 s73, s72, 4032
    s_mul_i32 s74, s72, 7168
    s_add_u32 s73, s73, s43
    s_add_u32 s74, s74, s42
    s_min_u32 m0, s73, s76
    s_min_u32 s74, s74, s75
    s_add_u32 s72, s72, 1

    buffer_load_dwordx4 v35, s[20:23], s74 offen lds
    s_cmp_eq_u32 s72, 36
    s_cselect_b32 s72, 0, s72

    s_mul_i32 s73, s72, 4032
    s_mul_i32 s74, s72, 7168
    s_add_u32 s73, s73, s43
    s_add_u32 s74, s74, s42
    s_min_u32 m0, s73, s76
    s_min_u32 s74, s74, s75
    s_add_u32 s72, s72, 1

    buffer_load_dwordx4 v35, s[20:23], s74 offen lds
    s_cmp_eq_u32 s72, 36
    s_cselect_b32 s72, 0, s72

    s_mul_i32 s73, s72, 4032
    s_mul_i32 s74, s72, 7168
    s_add_u32 s73, s73, s43
    s_add_u32 s74, s74, s42
    s_min_u32 m0, s73, s76
    s_min_u32 s74, s74, s75
    s_add_u32 s72, s72, 1

    buffer_load_dwordx4 v35, s[20:23], s74 offen lds
    s_cmp_eq_u32 s72, 36
    s_cselect_b32 s72, 0, s72

    s_mul_i32 s73, s72, 4032
    s_mul_i32 s74, s72, 7168
    s_add_u32 s73, s73, s43
    s_add_u32 s74, s74, s42
    s_min_u32 m0, s73, s76
    s_min_u32 s74, s74, s75
    s_add_u32 s72, s72, 1

    buffer_load_dwordx4 v35, s[20:23], s74 offen lds
    s_cmp_eq_u32 s72, 36
    s_cselect_b32 s72, 0, s72

    s_mul_i32 s73, s72, 4032
    s_mul_i32 s74, s72, 7168
    s_add_u32 s73, s73, s43
    s_add_u32 s74, s74, s42
    s_min_u32 m0, s73, s76
    s_min_u32 s74, s74, s75
    s_add_u32 s72, s72, 1

    buffer_load_dwordx4 v35, s[20:23], s74 offen lds
    s_cmp_eq_u32 s72, 36
    s_cselect_b32 s72, 0, s72

    s_mul_i32 s73, s72, 4032
    s_mul_i32 s74, s72, 7168
    s_add_u32 s73, s73, s43
    s_add_u32 s74, s74, s42
    s_min_u32 m0, s73, s76
    s_min_u32 s74, s74, s75
    s_add_u32 s72, s72, 1

    buffer_load_dwordx4 v35, s[20:23], s74 offen lds
    s_cmp_eq_u32 s72, 36
    s_cselect_b32 s72, 0, s72

    s_mul_i32 s73, s72, 4032
    s_mul_i32 s74, s72, 7168
    s_add_u32 s73, s73, s43
    s_add_u32 s74, s74, s42
    s_min_u32 m0, s73, s76
    s_min_u32 s74, s74, s75
    s_add_u32 s72, s72, 1

    buffer_load_dwordx4 v35, s[20:23], s74 offen lds
    s_cmp_eq_u32 s72, 36
    s_cselect_b32 s72, 0, s72

    s_mul_i32 s73, s72, 4032
    s_mul_i32 s74, s72, 7168
    s_add_u32 s73, s73, s43
    s_add_u32 s74, s74, s42
    s_min_u32 m0, s73, s76
    s_min_u32 s74, s74, s75
    s_add_u32 s72, s72, 1
    s_barrier

    buffer_load_dwordx4 v35, s[20:23], s74 offen lds
    s_cmp_eq_u32 s72, 36
    s_cselect_b32 s72, 0, s72

    s_mul_i32 s73, s72, 4032
    s_mul_i32 s74, s72, 7168
    s_add_u32 s73, s73, s43
    s_add_u32 s74, s74, s42
    s_min_u32 m0, s73, s76
    s_min_u32 s74, s74, s75
    s_add_u32 s72, s72, 1

    buffer_load_dwordx4 v35, s[20:23], s74 offen lds
    s_cmp_eq_u32 s72, 36
    s_cselect_b32 s72, 0, s72

    s_mul_i32 s73, s72, 4032
    s_mul_i32 s74, s72, 7168
    s_add_u32 s73, s73, s43
    s_add_u32 s74, s74, s42
    s_min_u32 m0, s73, s76
    s_min_u32 s74, s74, s75
    s_add_u32 s72, s72, 1

    buffer_load_dwordx4 v35, s[20:23], s74 offen lds
    s_cmp_eq_u32 s72, 36
    s_cselect_b32 s72, 0, s72

    s_mul_i32 s73, s72, 4032
    s_mul_i32 s74, s72, 7168
    s_add_u32 s73, s73, s43
    s_add_u32 s74, s74, s42
    s_min_u32 m0, s73, s76
    s_min_u32 s74, s74, s75
    s_add_u32 s72, s72, 1

    buffer_load_dwordx4 v35, s[20:23], s74 offen lds
    s_cmp_eq_u32 s72, 36
    s_cselect_b32 s72, 0, s72

    s_mov_b64 exec, -1
standalone__deep_cross_pnn__recsys_kernel_nd1:

    s_lshr_b32 s78, s57, 5
    s_bfe_u32 s79, s57, 0x20003
    s_bfe_u32 s80, s57, 0x20001
    s_and_b32 s81, s57, 1
    s_lshl_b32 s77, s78, 2
    s_lshl_b32 s83, s81, 1
    s_add_u32 s77, s77, s83
    s_lshl_b32 s77, s77, 7
    s_lshl_b32 s83, s79, 5
    s_add_u32 s77, s77, s83
    s_lshl_b32 s83, s80, 3
    s_add_u32 s77, s77, s83
    s_lshl_b32 s77, s77, 10
    s_lshl_b32 s82, s78, 12
    s_lshl_b32 s83, s79, 10
    s_add_u32 s82, s82, s83
    s_lshl_b32 s83, s80, 8
    s_add_u32 s82, s82, s83
    s_lshl_b32 s83, s81, 7
    s_add_u32 s82, s82, s83
    s_mov_b32 s84, 821248
    v_mul_lo_u32 v14, v1, s84
    v_lshl_add_u32 v14, v2, 4, v14
    s_cmp_ge_u32 s57, 800
    s_cselect_b32 s83, 0x40000000, 0
    v_or_b32 v14, s83, v14
    v_and_b32 v3, 3, v8
    v_lshlrev_b32 v3, 4, v3
    v_lshl_or_b32 v3, v1, 6, v3
    v_and_b32 v4, 4, v8
    v_lshl_or_b32 v15, v4, 15, v3
    s_mov_b32 s84, 0x05040100
    s_mov_b32 s85, 0x07060302

    s_cmp_lg_u32 s64, 0
    s_cbranch_scc1 standalone__deep_cross_pnn__recsys_kernel_nd2
    s_mov_b64 exec, s[40:41]

    s_mul_i32 s73, s72, 4032
    s_mul_i32 s74, s72, 7168
    s_add_u32 s73, s73, s43
    s_add_u32 s74, s74, s42
    s_min_u32 m0, s73, s76
    s_min_u32 s74, s74, s75
    s_add_u32 s72, s72, 1

    buffer_load_dwordx4 v35, s[20:23], s74 offen lds
    s_cmp_eq_u32 s72, 36
    s_cselect_b32 s72, 0, s72

    s_mul_i32 s73, s72, 4032
    s_mul_i32 s74, s72, 7168
    s_add_u32 s73, s73, s43
    s_add_u32 s74, s74, s42
    s_min_u32 m0, s73, s76
    s_min_u32 s74, s74, s75
    s_add_u32 s72, s72, 1

    buffer_load_dwordx4 v35, s[20:23], s74 offen lds
    s_cmp_eq_u32 s72, 36
    s_cselect_b32 s72, 0, s72

    s_mul_i32 s73, s72, 4032
    s_mul_i32 s74, s72, 7168
    s_add_u32 s73, s73, s43
    s_add_u32 s74, s74, s42
    s_min_u32 m0, s73, s76
    s_min_u32 s74, s74, s75
    s_add_u32 s72, s72, 1

    buffer_load_dwordx4 v35, s[20:23], s74 offen lds
    s_cmp_eq_u32 s72, 36
    s_cselect_b32 s72, 0, s72

    s_mul_i32 s73, s72, 4032
    s_mul_i32 s74, s72, 7168
    s_add_u32 s73, s73, s43
    s_add_u32 s74, s74, s42
    s_min_u32 m0, s73, s76
    s_min_u32 s74, s74, s75
    s_add_u32 s72, s72, 1

    buffer_load_dwordx4 v35, s[20:23], s74 offen lds
    s_cmp_eq_u32 s72, 36
    s_cselect_b32 s72, 0, s72

    s_mul_i32 s73, s72, 4032
    s_mul_i32 s74, s72, 7168
    s_add_u32 s73, s73, s43
    s_add_u32 s74, s74, s42
    s_min_u32 m0, s73, s76
    s_min_u32 s74, s74, s75
    s_add_u32 s72, s72, 1

    buffer_load_dwordx4 v35, s[20:23], s74 offen lds
    s_cmp_eq_u32 s72, 36
    s_cselect_b32 s72, 0, s72

    s_mul_i32 s73, s72, 4032
    s_mul_i32 s74, s72, 7168
    s_add_u32 s73, s73, s43
    s_add_u32 s74, s74, s42
    s_min_u32 m0, s73, s76
    s_min_u32 s74, s74, s75
    s_add_u32 s72, s72, 1

    buffer_load_dwordx4 v35, s[20:23], s74 offen lds
    s_cmp_eq_u32 s72, 36
    s_cselect_b32 s72, 0, s72

    s_mul_i32 s73, s72, 4032
    s_mul_i32 s74, s72, 7168
    s_add_u32 s73, s73, s43
    s_add_u32 s74, s74, s42
    s_min_u32 m0, s73, s76
    s_min_u32 s74, s74, s75
    s_add_u32 s72, s72, 1

    buffer_load_dwordx4 v35, s[20:23], s74 offen lds
    s_cmp_eq_u32 s72, 36
    s_cselect_b32 s72, 0, s72

    s_mul_i32 s73, s72, 4032
    s_mul_i32 s74, s72, 7168
    s_add_u32 s73, s73, s43
    s_add_u32 s74, s74, s42
    s_min_u32 m0, s73, s76
    s_min_u32 s74, s74, s75
    s_add_u32 s72, s72, 1

    buffer_load_dwordx4 v35, s[20:23], s74 offen lds
    s_cmp_eq_u32 s72, 36
    s_cselect_b32 s72, 0, s72

    s_mul_i32 s73, s72, 4032
    s_mul_i32 s74, s72, 7168
    s_add_u32 s73, s73, s43
    s_add_u32 s74, s74, s42
    s_min_u32 m0, s73, s76
    s_min_u32 s74, s74, s75
    s_add_u32 s72, s72, 1

    buffer_load_dwordx4 v35, s[20:23], s74 offen lds
    s_cmp_eq_u32 s72, 36
    s_cselect_b32 s72, 0, s72

    s_mul_i32 s73, s72, 4032
    s_mul_i32 s74, s72, 7168
    s_add_u32 s73, s73, s43
    s_add_u32 s74, s74, s42
    s_min_u32 m0, s73, s76
    s_min_u32 s74, s74, s75
    s_add_u32 s72, s72, 1

    buffer_load_dwordx4 v35, s[20:23], s74 offen lds
    s_cmp_eq_u32 s72, 36
    s_cselect_b32 s72, 0, s72

    s_mul_i32 s73, s72, 4032
    s_mul_i32 s74, s72, 7168
    s_add_u32 s73, s73, s43
    s_add_u32 s74, s74, s42
    s_min_u32 m0, s73, s76
    s_min_u32 s74, s74, s75
    s_add_u32 s72, s72, 1

    buffer_load_dwordx4 v35, s[20:23], s74 offen lds
    s_cmp_eq_u32 s72, 36
    s_cselect_b32 s72, 0, s72

    s_mul_i32 s73, s72, 4032
    s_mul_i32 s74, s72, 7168
    s_add_u32 s73, s73, s43
    s_add_u32 s74, s74, s42
    s_min_u32 m0, s73, s76
    s_min_u32 s74, s74, s75
    s_add_u32 s72, s72, 1

    buffer_load_dwordx4 v35, s[20:23], s74 offen lds
    s_cmp_eq_u32 s72, 36
    s_cselect_b32 s72, 0, s72

    s_mul_i32 s73, s72, 4032
    s_mul_i32 s74, s72, 7168
    s_add_u32 s73, s73, s43
    s_add_u32 s74, s74, s42
    s_min_u32 m0, s73, s76
    s_min_u32 s74, s74, s75
    s_add_u32 s72, s72, 1

    buffer_load_dwordx4 v35, s[20:23], s74 offen lds
    s_cmp_eq_u32 s72, 36
    s_cselect_b32 s72, 0, s72

    s_mul_i32 s73, s72, 4032
    s_mul_i32 s74, s72, 7168
    s_add_u32 s73, s73, s43
    s_add_u32 s74, s74, s42
    s_min_u32 m0, s73, s76
    s_min_u32 s74, s74, s75
    s_add_u32 s72, s72, 1

    buffer_load_dwordx4 v35, s[20:23], s74 offen lds
    s_cmp_eq_u32 s72, 36
    s_cselect_b32 s72, 0, s72

    s_mul_i32 s73, s72, 4032
    s_mul_i32 s74, s72, 7168
    s_add_u32 s73, s73, s43
    s_add_u32 s74, s74, s42
    s_min_u32 m0, s73, s76
    s_min_u32 s74, s74, s75
    s_add_u32 s72, s72, 1

    buffer_load_dwordx4 v35, s[20:23], s74 offen lds
    s_cmp_eq_u32 s72, 36
    s_cselect_b32 s72, 0, s72

    s_mul_i32 s73, s72, 4032
    s_mul_i32 s74, s72, 7168
    s_add_u32 s73, s73, s43
    s_add_u32 s74, s74, s42
    s_min_u32 m0, s73, s76
    s_min_u32 s74, s74, s75
    s_add_u32 s72, s72, 1

    buffer_load_dwordx4 v35, s[20:23], s74 offen lds
    s_cmp_eq_u32 s72, 36
    s_cselect_b32 s72, 0, s72

    s_mul_i32 s73, s72, 4032
    s_mul_i32 s74, s72, 7168
    s_add_u32 s73, s73, s43
    s_add_u32 s74, s74, s42
    s_min_u32 m0, s73, s76
    s_min_u32 s74, s74, s75
    s_add_u32 s72, s72, 1

    buffer_load_dwordx4 v35, s[20:23], s74 offen lds
    s_cmp_eq_u32 s72, 36
    s_cselect_b32 s72, 0, s72

    s_mul_i32 s73, s72, 4032
    s_mul_i32 s74, s72, 7168
    s_add_u32 s73, s73, s43
    s_add_u32 s74, s74, s42
    s_min_u32 m0, s73, s76
    s_min_u32 s74, s74, s75
    s_add_u32 s72, s72, 1

    buffer_load_dwordx4 v35, s[20:23], s74 offen lds
    s_cmp_eq_u32 s72, 36
    s_cselect_b32 s72, 0, s72

    s_mul_i32 s73, s72, 4032
    s_mul_i32 s74, s72, 7168
    s_add_u32 s73, s73, s43
    s_add_u32 s74, s74, s42
    s_min_u32 m0, s73, s76
    s_min_u32 s74, s74, s75
    s_add_u32 s72, s72, 1

    buffer_load_dwordx4 v35, s[20:23], s74 offen lds
    s_cmp_eq_u32 s72, 36
    s_cselect_b32 s72, 0, s72

    s_mul_i32 s73, s72, 4032
    s_mul_i32 s74, s72, 7168
    s_add_u32 s73, s73, s43
    s_add_u32 s74, s74, s42
    s_min_u32 m0, s73, s76
    s_min_u32 s74, s74, s75
    s_add_u32 s72, s72, 1

    buffer_load_dwordx4 v35, s[20:23], s74 offen lds
    s_cmp_eq_u32 s72, 36
    s_cselect_b32 s72, 0, s72

    s_mul_i32 s73, s72, 4032
    s_mul_i32 s74, s72, 7168
    s_add_u32 s73, s73, s43
    s_add_u32 s74, s74, s42
    s_min_u32 m0, s73, s76
    s_min_u32 s74, s74, s75
    s_add_u32 s72, s72, 1

    buffer_load_dwordx4 v35, s[20:23], s74 offen lds
    s_cmp_eq_u32 s72, 36
    s_cselect_b32 s72, 0, s72

    s_mul_i32 s73, s72, 4032
    s_mul_i32 s74, s72, 7168
    s_add_u32 s73, s73, s43
    s_add_u32 s74, s74, s42
    s_min_u32 m0, s73, s76
    s_min_u32 s74, s74, s75
    s_add_u32 s72, s72, 1

    buffer_load_dwordx4 v35, s[20:23], s74 offen lds
    s_cmp_eq_u32 s72, 36
    s_cselect_b32 s72, 0, s72

    s_mul_i32 s73, s72, 4032
    s_mul_i32 s74, s72, 7168
    s_add_u32 s73, s73, s43
    s_add_u32 s74, s74, s42
    s_min_u32 m0, s73, s76
    s_min_u32 s74, s74, s75
    s_add_u32 s72, s72, 1

    buffer_load_dwordx4 v35, s[20:23], s74 offen lds
    s_cmp_eq_u32 s72, 36
    s_cselect_b32 s72, 0, s72

    s_mul_i32 s73, s72, 4032
    s_mul_i32 s74, s72, 7168
    s_add_u32 s73, s73, s43
    s_add_u32 s74, s74, s42
    s_min_u32 m0, s73, s76
    s_min_u32 s74, s74, s75
    s_add_u32 s72, s72, 1

    buffer_load_dwordx4 v35, s[20:23], s74 offen lds
    s_cmp_eq_u32 s72, 36
    s_cselect_b32 s72, 0, s72

    s_mov_b64 exec, -1
standalone__deep_cross_pnn__recsys_kernel_nd2:

    s_cmp_lg_u32 s64, 0
    s_cbranch_scc1 standalone__deep_cross_pnn__recsys_kernel_nsig
    s_waitcnt vmcnt(0)
    s_barrier

standalone__deep_cross_pnn__recsys_kernel_nsig:
    s_setprio 1
    s_mov_b64 exec, s[48:49]
    buffer_load_dwordx4 v[224:227], v0, s[16:19], s60 offen
    s_add_u32 s60, s60, 3200
    buffer_load_dwordx4 v[228:231], v0, s[16:19], s60 offen
    s_add_u32 s60, s60, 3200
    buffer_load_dwordx4 v[232:235], v0, s[16:19], s60 offen
    s_add_u32 s60, s60, 3200
    buffer_load_dwordx4 v[236:239], v0, s[16:19], s60 offen
    s_add_u32 s60, s60, 3200
    buffer_load_dwordx4 v[240:243], v0, s[16:19], s60 offen
    s_add_u32 s60, s60, 3200
    buffer_load_dwordx4 v[244:247], v0, s[16:19], s60 offen
    s_add_u32 s60, s60, 3200
    buffer_load_dwordx4 v[248:251], v0, s[16:19], s60 offen
    s_add_u32 s60, s60, 3200
    buffer_load_dwordx4 v[252:255], v0, s[16:19], s60 offen
    s_add_u32 s60, s60, 3200
    s_mov_b64 exec, -1

    s_lshl_b32 s61, s56, 8
    s_add_u32 s61, s61, 162688
    v_lshlrev_b32 v86, 2, v8
    v_add_u32 v86, s61, v86
    v_and_b32 v85, 0xffffff80, v86
    v_lshrrev_b32 v27, 5, v8
    v_mul_u32_u24 v27, 0x40404, v27
    v_lshl_or_b32 v27, v27, 8, v27
    s_mul_i32 s61, s56, 4608
    s_add_u32 s61, s61, 144256
    v_mul_u32_u24 v31, 72, v8
    v_add3_u32 v31, s61, v31, -8
    v_mul_u32_u24 v34, 72, v1
    v_lshl_add_u32 v34, v2, 3, v34
    v_add_u32 v34, s61, v34
    v_mul_u32_u24 v3, 52, v7
    v_lshrrev_b32 v3, 8, v3
    v_mad_i32_i24 v2, v3, -5, v7
    v_mov_b32 v13, 0
    v_mul_u32_u24 v2, 0x10001, v2
    v_lshlrev_b32 v2, 12, v2
    v_add_u32 v32, 67108864, v2
    v_add_u32 v33, 201328640, v2
    s_cmp_eq_u32 s59, 3
    s_cselect_b32 s61, 0x0fffff00, -16
    s_cmp_eq_u32 s59, 1
    s_cselect_b32 s61, 0x0ffffff0, s61
    v_mov_b32 v59, s61
    s_lshr_b32 s62, s58, 7
    s_mul_i32 s62, s62, 25
    s_min_u32 s46, s46, 24
    s_add_u32 s62, s62, s46
    s_lshl_b32 s62, s62, 3
    s_bfe_u32 s61, s58, 0x30004
    s_add_u32 s62, s62, s61
    s_lshl_b32 s62, s62, 13
    s_bfe_u32 s61, s58, 0x30001
    s_lshl_b32 s61, s61, 10
    s_add_u32 s62, s62, s61
    s_and_b32 s61, s58, 1
    s_lshl_b32 s46, s61, 2
    s_add_u32 s46, s46, 163712
    s_lshl_b32 s61, s61, 9
    s_add_u32 s62, s62, s61
    s_add_u32 s62, s62, 16777216
    v_and_b32 v30, 31, v8
    v_lshrrev_b32 v3, 5, v8
    v_lshlrev_b32 v30, 4, v30
    v_lshl_add_u32 v30, v3, 3, v30
    s_movk_i32 s66, 0x7c
    s_mov_b32 s67, 0x03030303
    s_mov_b32 s75, 0x06040200
    v_mov_b32 v57, 0x08040201
    v_mov_b32 v58, 0x80402010
    v_mov_b32 v108, 0xff800001
    v_mov_b32 v109, 0xff800001
    v_mov_b32 v110, 0xff800001
    v_mov_b32 v111, 0xff800001

    s_mov_b64 exec, s[48:49]

    s_waitcnt vmcnt(7)
    v_lshl_or_b32 v224, v225, 16, v224
    v_lshl_or_b32 v225, v227, 16, v226
    v_add_u32 v224, v32, v224
    v_add_u32 v225, v33, v225

    ds_write_b64 v34, v[224:225] offset:0

    s_waitcnt vmcnt(6)
    v_lshl_or_b32 v228, v229, 16, v228
    v_lshl_or_b32 v229, v231, 16, v230
    v_add_u32 v228, v32, v228
    v_add_u32 v229, v33, v229

    ds_write_b64 v34, v[228:229] offset:576

    s_waitcnt vmcnt(5)
    v_lshl_or_b32 v232, v233, 16, v232
    v_lshl_or_b32 v233, v235, 16, v234
    v_add_u32 v232, v32, v232
    v_add_u32 v233, v33, v233

    ds_write_b64 v34, v[232:233] offset:1152

    s_waitcnt vmcnt(4)
    v_lshl_or_b32 v236, v237, 16, v236
    v_lshl_or_b32 v237, v239, 16, v238
    v_add_u32 v236, v32, v236
    v_add_u32 v237, v33, v237

    ds_write_b64 v34, v[236:237] offset:1728

    s_waitcnt vmcnt(3)
    v_lshl_or_b32 v240, v241, 16, v240
    v_lshl_or_b32 v241, v243, 16, v242
    v_add_u32 v240, v32, v240
    v_add_u32 v241, v33, v241

    ds_write_b64 v34, v[240:241] offset:2304

    s_waitcnt vmcnt(2)
    v_lshl_or_b32 v244, v245, 16, v244
    v_lshl_or_b32 v245, v247, 16, v246
    v_add_u32 v244, v32, v244
    v_add_u32 v245, v33, v245

    ds_write_b64 v34, v[244:245] offset:2880

    s_waitcnt vmcnt(1)
    v_lshl_or_b32 v248, v249, 16, v248
    v_lshl_or_b32 v249, v251, 16, v250
    v_add_u32 v248, v32, v248
    v_add_u32 v249, v33, v249

    ds_write_b64 v34, v[248:249] offset:3456

    s_waitcnt vmcnt(0)
    v_lshl_or_b32 v252, v253, 16, v252
    v_lshl_or_b32 v253, v255, 16, v254
    v_add_u32 v252, v32, v252
    v_add_u32 v253, v33, v253

    ds_write_b64 v34, v[252:253] offset:4032
    s_mov_b64 exec, -1
    ds_read_b64 v[40:41], v31 offset:8
    ds_read_b64 v[42:43], v31 offset:16
    ds_read_b64 v[44:45], v31 offset:24
    ds_read_b64 v[46:47], v31 offset:32
    ds_read_b64 v[48:49], v31 offset:40
    ds_read_b64 v[50:51], v31 offset:48
    ds_read_b64 v[52:53], v31 offset:56
    ds_read_b64 v[54:55], v31 offset:64

    s_waitcnt lgkmcnt(7)
    v_perm_b32 v60, v41, v40, s75
    v_lshlrev_b32 v72, 2, v60

    v_lshrrev_b32 v61, 3, v60
    v_and_b32 v60, 0x07070707, v60
    v_and_or_b32 v0, v61, s67, v27
    v_perm_b32 v16, v58, v57, v60
    v_add_u32 v64, v57, v16

    s_waitcnt lgkmcnt(6)
    v_perm_b32 v60, v43, v42, s75
    v_lshlrev_b32 v73, 2, v60

    v_lshrrev_b32 v61, 3, v60
    v_and_b32 v60, 0x07070707, v60
    v_and_or_b32 v1, v61, s67, v27
    v_perm_b32 v17, v58, v57, v60
    v_add_u32 v65, v57, v17

    s_waitcnt lgkmcnt(5)
    v_perm_b32 v60, v45, v44, s75
    v_lshlrev_b32 v74, 2, v60

    v_lshrrev_b32 v61, 3, v60
    v_and_b32 v60, 0x07070707, v60
    v_and_or_b32 v2, v61, s67, v27
    v_perm_b32 v18, v58, v57, v60
    v_add_u32 v66, v57, v18

    s_waitcnt lgkmcnt(4)
    v_perm_b32 v60, v47, v46, s75
    v_lshlrev_b32 v75, 2, v60

    v_lshrrev_b32 v61, 3, v60
    v_and_b32 v60, 0x07070707, v60
    v_and_or_b32 v3, v61, s67, v27
    v_perm_b32 v19, v58, v57, v60
    v_add_u32 v67, v57, v19

    s_waitcnt lgkmcnt(3)
    v_perm_b32 v60, v49, v48, s75
    v_lshlrev_b32 v76, 2, v60

    v_lshrrev_b32 v61, 3, v60
    v_and_b32 v60, 0x07070707, v60
    v_and_or_b32 v4, v61, s67, v27
    v_perm_b32 v20, v58, v57, v60
    v_add_u32 v68, v57, v20

    s_waitcnt lgkmcnt(2)
    v_perm_b32 v60, v51, v50, s75
    v_lshlrev_b32 v77, 2, v60

    v_lshrrev_b32 v61, 3, v60
    v_and_b32 v60, 0x07070707, v60
    v_and_or_b32 v5, v61, s67, v27
    v_perm_b32 v21, v58, v57, v60
    v_add_u32 v69, v57, v21

    s_waitcnt lgkmcnt(1)
    v_perm_b32 v60, v53, v52, s75
    v_lshlrev_b32 v78, 2, v60

    v_lshrrev_b32 v61, 3, v60
    v_and_b32 v60, 0x07070707, v60
    v_and_or_b32 v6, v61, s67, v27
    v_perm_b32 v22, v58, v57, v60
    v_add_u32 v70, v57, v22

    s_waitcnt lgkmcnt(0)
    v_perm_b32 v60, v55, v54, s75
    v_lshlrev_b32 v79, 2, v60

    v_lshrrev_b32 v61, 3, v60
    v_and_b32 v60, 0x07070707, v60
    v_and_or_b32 v7, v61, s67, v27
    v_perm_b32 v23, v58, v57, v60
    v_add_u32 v71, v57, v23

    ds_write_b32 v86, v13
    s_cmp_eq_u32 s59, 3
    s_cbranch_scc1 standalone__deep_cross_pnn__recsys_kernel_sk1
    v_add_u32 v63, v58, v16
    s_bitcmp0_b32 s59, 0
    s_cbranch_scc1 standalone__deep_cross_pnn__recsys_kernel_pq3
    s_setprio 0
standalone__deep_cross_pnn__recsys_kernel_pq3:
    v_ffbl_b32 v84, v59
    v_perm_b32 v60, v72, v72, v84
    v_and_or_b32 v60, v60, s66, v85
    ds_add_rtn_u32 v87, v60, v10
    ds_wrxchg_rtn_b32 v116, v86, v13

    s_waitcnt lgkmcnt(0)
    v_cmp_gt_u32 s[68:69], 2, v116

    v_cmp_eq_u32 s[72:73], 0, v116
    s_nop 0
    v_cmpx_le_u32 vcc, 2, v87
    v_mov_b32 v62, s69
    v_mov_b32 v123, s73
    v_perm_b32 v121, v62, s68, v1
    v_perm_b32 v122, v123, s72, v0
    v_and_b32 v121, v121, v17
    v_and_b32 v122, v122, v16
    v_msad_u8 v120, v65, v121, 0
    v_lshlrev_b32 v120, 8, v120
    v_msad_u8 v120, v63, v122, v120
    v_and_b32 v120, v120, v59

    v_ffbl_b32 v120, v120
    v_max_i32 v84, v84, v120
    s_mov_b64 exec, -1
    v_lshl_add_u32 v59, -1, v84, v59

    v_lshl_add_u32 v61, v84, 1, v31
    ds_read_u16 v80, v61 offset:0
    s_setprio 0
    v_ffbl_b32 v84, v59
    v_perm_b32 v60, v72, v72, v84
    v_and_or_b32 v60, v60, s66, v85
    ds_add_rtn_u32 v87, v60, v10
    ds_wrxchg_rtn_b32 v116, v86, v13

    s_waitcnt lgkmcnt(0)
    v_cmp_gt_u32 s[68:69], 2, v116

    v_cmp_eq_u32 s[72:73], 0, v116
    s_nop 0
    v_cmpx_le_u32 vcc, 2, v87
    v_mov_b32 v62, s69
    v_mov_b32 v123, s73
    v_perm_b32 v121, v62, s68, v1
    v_perm_b32 v122, v123, s72, v0
    v_and_b32 v121, v121, v17
    v_and_b32 v122, v122, v16
    v_msad_u8 v120, v65, v121, 0
    v_lshlrev_b32 v120, 8, v120
    v_msad_u8 v120, v63, v122, v120
    v_and_b32 v120, v120, v59

    v_ffbl_b32 v120, v120
    v_max_i32 v84, v84, v120
    s_mov_b64 exec, -1
    v_lshl_add_u32 v59, -1, v84, v59

    v_lshl_add_u32 v61, v84, 1, v31
    ds_read_u16 v81, v61 offset:0
    v_ffbl_b32 v84, v59
    v_perm_b32 v60, v72, v72, v84
    v_and_or_b32 v60, v60, s66, v85
    ds_add_rtn_u32 v87, v60, v10
    ds_wrxchg_rtn_b32 v116, v86, v13

    s_waitcnt lgkmcnt(0)
    v_cmp_gt_u32 s[68:69], 2, v116

    v_cmp_eq_u32 s[72:73], 0, v116
    s_nop 0
    v_cmpx_le_u32 vcc, 2, v87
    v_mov_b32 v62, s69
    v_mov_b32 v123, s73
    v_perm_b32 v121, v62, s68, v1
    v_perm_b32 v122, v123, s72, v0
    v_and_b32 v121, v121, v17
    v_and_b32 v122, v122, v16
    v_msad_u8 v120, v65, v121, 0
    v_lshlrev_b32 v120, 8, v120
    v_msad_u8 v120, v63, v122, v120
    v_and_b32 v120, v120, v59

    v_ffbl_b32 v120, v120
    v_max_i32 v84, v84, v120
    s_mov_b64 exec, -1
    v_lshl_add_u32 v59, -1, v84, v59

    v_lshl_add_u32 v61, v84, 1, v31
    ds_read_u16 v82, v61 offset:0
    s_bitcmp1_b32 s59, 0
    s_cbranch_scc1 standalone__deep_cross_pnn__recsys_kernel_pq4
    s_setprio 1
standalone__deep_cross_pnn__recsys_kernel_pq4:
    v_ffbl_b32 v84, v59
    v_perm_b32 v60, v72, v72, v84
    v_and_or_b32 v60, v60, s66, v85
    ds_add_rtn_u32 v87, v60, v10
    ds_wrxchg_rtn_b32 v116, v86, v13

    s_waitcnt lgkmcnt(0)
    v_cmp_gt_u32 s[68:69], 2, v116

    s_nop 0
    v_cmpx_le_u32 vcc, 2, v87
    v_mov_b32 v62, s69
    v_perm_b32 v121, v62, s68, v1
    v_and_b32 v121, v121, v17
    v_msad_u8 v120, v65, v121, 0
    v_and_b32_sdwa v120, v120, v59 dst_sel:BYTE_1 dst_unused:UNUSED_PAD src0_sel:DWORD src1_sel:BYTE_1
    s_nop 0

    v_ffbl_b32 v120, v120
    v_max_i32 v84, v84, v120
    s_mov_b64 exec, -1
    v_lshl_add_u32 v59, -1, v84, v59

    v_lshl_add_u32 v61, v84, 1, v31
    ds_read_u16 v83, v61 offset:0
standalone__deep_cross_pnn__recsys_kernel_sk1:
    v_lshrrev_b32 v59, 4, v59
    v_add_u32 v63, v58, v17
    s_setprio 0
    v_ffbl_b32 v84, v59
    v_perm_b32 v60, v73, v72, v84
    v_and_or_b32 v60, v60, s66, v85

    v_cmpx_ge_u32 vcc, 0, v84
    ds_add_u32 v60, v10
    s_not_b64 s[70:71], vcc
    s_mov_b64 exec, s[70:71]
    ds_add_rtn_u32 v87, v60, v10
    s_mov_b64 exec, -1

    ds_wrxchg_rtn_b32 v116, v86, v13
    s_and_b32 s45, s2, 63
    s_mul_i32 s45, s45, 4224
    s_add_u32 s45, s45, 8192
    v_mul_u32_u24 v104, s45, v8
    s_cmp_eq_u32 s64, 0
    s_cselect_b32 s45, s4, 0
    s_and_b32 exec_lo, s45, 3
    s_mov_b32 exec_hi, 0
    buffer_store_dword v13, v104, s[12:15], s9 offen sc1
    s_mov_b64 exec, -1
    buffer_load_dwordx4 v[128:131], v15, s[28:31], s77 offen offset:0
    buffer_load_dwordx4 v[160:163], v15, s[28:31], s77 offen offset:512

    s_waitcnt lgkmcnt(0)
    v_cmp_gt_u32 s[68:69], 2, v116

    v_cmp_eq_u32 s[72:73], 0, v116
    s_cmp_eq_u32 s59, 3
    s_cbranch_scc1 standalone__deep_cross_pnn__recsys_kernel_nf1
    v_lshl_or_b32 v24, v81, 16, v80
    v_lshl_or_b32 v25, v83, 16, v82
    buffer_store_dwordx2 v[24:25], v30, s[32:35], s62 offen sc1
    s_add_u32 s62, s62, s63
standalone__deep_cross_pnn__recsys_kernel_nf1:
    s_mov_b64 exec, s[70:71]
    v_cmpx_le_u32 vcc, 2, v87
    v_mov_b32 v62, s69
    v_mov_b32 v123, s73
    v_perm_b32 v121, v62, s68, v2
    v_perm_b32 v122, v123, s72, v1
    v_and_b32 v121, v121, v18
    v_and_b32 v122, v122, v17
    v_msad_u8 v120, v66, v121, 0
    v_lshlrev_b32 v120, 8, v120
    v_msad_u8 v120, v63, v122, v120
    v_and_b32 v120, v120, v59

    v_ffbl_b32 v120, v120
    v_max_i32 v84, v84, v120
    s_mov_b64 exec, -1
    v_lshl_add_u32 v59, -1, v84, v59

    v_lshl_add_u32 v61, v84, 1, v31
    ds_read_u16 v80, v61 offset:8
    v_ffbl_b32 v84, v59
    v_perm_b32 v60, v73, v72, v84
    v_and_or_b32 v60, v60, s66, v85

    v_cmpx_ge_u32 vcc, 1, v84
    ds_add_u32 v60, v10
    s_not_b64 s[70:71], vcc
    s_mov_b64 exec, s[70:71]
    ds_add_rtn_u32 v87, v60, v10
    s_mov_b64 exec, -1

    ds_wrxchg_rtn_b32 v116, v86, v13
    s_mov_b64 exec, s[4:5]
    buffer_load_dwordx4 v[104:107], v56, s[20:23], s44 offen
    s_mov_b64 exec, -1
    buffer_load_dwordx4 v[132:135], v15, s[28:31], s77 offen offset:1024
    buffer_load_dwordx4 v[164:167], v15, s[28:31], s77 offen offset:1536

    s_waitcnt lgkmcnt(0)
    v_cmp_gt_u32 s[68:69], 2, v116

    v_cmp_eq_u32 s[72:73], 0, v116
    s_mov_b64 exec, s[70:71]
    v_cmpx_le_u32 vcc, 2, v87
    v_mov_b32 v62, s69
    v_mov_b32 v123, s73
    v_perm_b32 v121, v62, s68, v2
    v_perm_b32 v122, v123, s72, v1
    v_and_b32 v121, v121, v18
    v_and_b32 v122, v122, v17
    v_msad_u8 v120, v66, v121, 0
    v_lshlrev_b32 v120, 8, v120
    v_msad_u8 v120, v63, v122, v120
    v_and_b32 v120, v120, v59

    v_ffbl_b32 v120, v120
    v_max_i32 v84, v84, v120
    s_mov_b64 exec, -1
    v_lshl_add_u32 v59, -1, v84, v59

    v_lshl_add_u32 v61, v84, 1, v31
    ds_read_u16 v81, v61 offset:8
    s_bitcmp1_b32 s59, 0
    s_cbranch_scc1 standalone__deep_cross_pnn__recsys_kernel_pq5
    s_setprio 1
standalone__deep_cross_pnn__recsys_kernel_pq5:
    v_ffbl_b32 v84, v59
    v_perm_b32 v60, v73, v72, v84
    v_and_or_b32 v60, v60, s66, v85

    v_cmpx_ge_u32 vcc, 2, v84
    ds_add_u32 v60, v10
    s_not_b64 s[70:71], vcc
    s_mov_b64 exec, s[70:71]
    ds_add_rtn_u32 v87, v60, v10
    s_mov_b64 exec, -1

    ds_wrxchg_rtn_b32 v116, v86, v13
    buffer_load_dwordx4 v[136:139], v15, s[28:31], s77 offen offset:2048
    buffer_load_dwordx4 v[168:171], v15, s[28:31], s77 offen offset:2560

    s_waitcnt lgkmcnt(0)
    v_cmp_gt_u32 s[68:69], 2, v116

    v_cmp_eq_u32 s[72:73], 0, v116
    s_mov_b64 exec, s[70:71]
    v_cmpx_le_u32 vcc, 2, v87
    v_mov_b32 v62, s69
    v_mov_b32 v123, s73
    v_perm_b32 v121, v62, s68, v2
    v_perm_b32 v122, v123, s72, v1
    v_and_b32 v121, v121, v18
    v_and_b32 v122, v122, v17
    v_msad_u8 v120, v66, v121, 0
    v_lshlrev_b32 v120, 8, v120
    v_msad_u8 v120, v63, v122, v120
    v_and_b32 v120, v120, v59

    v_ffbl_b32 v120, v120
    v_max_i32 v84, v84, v120
    s_mov_b64 exec, -1
    v_lshl_add_u32 v59, -1, v84, v59

    v_lshl_add_u32 v61, v84, 1, v31
    ds_read_u16 v82, v61 offset:8
    s_setprio 0
    v_ffbl_b32 v84, v59
    v_perm_b32 v60, v73, v72, v84
    v_and_or_b32 v60, v60, s66, v85

    v_cmpx_ge_u32 vcc, 3, v84
    ds_add_u32 v60, v10
    s_not_b64 s[70:71], vcc
    s_mov_b64 exec, s[70:71]
    ds_add_rtn_u32 v87, v60, v10
    s_mov_b64 exec, -1

    ds_wrxchg_rtn_b32 v116, v86, v13
    buffer_load_dwordx4 v[140:143], v15, s[28:31], s77 offen offset:3072
    buffer_load_dwordx4 v[172:175], v15, s[28:31], s77 offen offset:3584
    s_add_u32 s77, s77, 4096

    s_waitcnt lgkmcnt(0)
    v_cmp_gt_u32 s[68:69], 2, v116

    s_mov_b64 exec, s[70:71]
    v_cmpx_le_u32 vcc, 2, v87
    v_mov_b32 v62, s69
    v_perm_b32 v121, v62, s68, v2
    v_and_b32 v121, v121, v18
    v_msad_u8 v120, v66, v121, 0
    v_and_b32_sdwa v120, v120, v59 dst_sel:BYTE_1 dst_unused:UNUSED_PAD src0_sel:DWORD src1_sel:BYTE_1
    s_nop 0

    v_ffbl_b32 v120, v120
    v_max_i32 v84, v84, v120
    s_mov_b64 exec, -1
    v_lshl_add_u32 v59, -1, v84, v59

    v_lshl_add_u32 v61, v84, 1, v31
    ds_read_u16 v83, v61 offset:8
    v_lshrrev_b32 v59, 4, v59
    v_add_u32 v63, v58, v18
    v_ffbl_b32 v84, v59
    v_perm_b32 v60, v74, v73, v84
    v_and_or_b32 v60, v60, s66, v85

    v_cmpx_ge_u32 vcc, 0, v84
    ds_add_u32 v60, v10
    s_not_b64 s[70:71], vcc
    s_mov_b64 exec, s[70:71]
    ds_add_rtn_u32 v87, v60, v10
    s_mov_b64 exec, -1

    ds_wrxchg_rtn_b32 v116, v86, v13
    buffer_load_dwordx4 v[144:147], v15, s[28:31], s77 offen offset:0
    buffer_load_dwordx4 v[176:179], v15, s[28:31], s77 offen offset:512

    s_waitcnt lgkmcnt(0)
    v_cmp_gt_u32 s[68:69], 2, v116

    v_cmp_eq_u32 s[72:73], 0, v116
    v_lshl_or_b32 v24, v81, 16, v80
    v_lshl_or_b32 v25, v83, 16, v82
    buffer_store_dwordx2 v[24:25], v30, s[32:35], s62 offen sc1
    s_add_u32 s62, s62, s63
    s_mov_b64 exec, s[70:71]
    v_cmpx_le_u32 vcc, 2, v87
    v_mov_b32 v62, s69
    v_mov_b32 v123, s73
    v_perm_b32 v121, v62, s68, v3
    v_perm_b32 v122, v123, s72, v2
    v_and_b32 v121, v121, v19
    v_and_b32 v122, v122, v18
    v_msad_u8 v120, v67, v121, 0
    v_lshlrev_b32 v120, 8, v120
    v_msad_u8 v120, v63, v122, v120
    v_and_b32 v120, v120, v59

    v_ffbl_b32 v120, v120
    v_max_i32 v84, v84, v120
    s_mov_b64 exec, -1
    v_lshl_add_u32 v59, -1, v84, v59

    v_lshl_add_u32 v61, v84, 1, v31
    ds_read_u16 v80, v61 offset:16
    s_bitcmp1_b32 s59, 0
    s_cbranch_scc1 standalone__deep_cross_pnn__recsys_kernel_pq6
    s_setprio 1
standalone__deep_cross_pnn__recsys_kernel_pq6:
    v_ffbl_b32 v84, v59
    v_perm_b32 v60, v74, v73, v84
    v_and_or_b32 v60, v60, s66, v85

    v_cmpx_ge_u32 vcc, 1, v84
    ds_add_u32 v60, v10
    s_not_b64 s[70:71], vcc
    s_mov_b64 exec, s[70:71]
    ds_add_rtn_u32 v87, v60, v10
    s_mov_b64 exec, -1

    ds_wrxchg_rtn_b32 v116, v86, v13
    buffer_load_dwordx4 v[148:151], v15, s[28:31], s77 offen offset:1024
    buffer_load_dwordx4 v[180:183], v15, s[28:31], s77 offen offset:1536

    s_waitcnt lgkmcnt(0)
    v_cmp_gt_u32 s[68:69], 2, v116

    v_cmp_eq_u32 s[72:73], 0, v116
    s_mov_b64 exec, s[70:71]
    v_cmpx_le_u32 vcc, 2, v87
    v_mov_b32 v62, s69
    v_mov_b32 v123, s73
    v_perm_b32 v121, v62, s68, v3
    v_perm_b32 v122, v123, s72, v2
    v_and_b32 v121, v121, v19
    v_and_b32 v122, v122, v18
    v_msad_u8 v120, v67, v121, 0
    v_lshlrev_b32 v120, 8, v120
    v_msad_u8 v120, v63, v122, v120
    v_and_b32 v120, v120, v59

    v_ffbl_b32 v120, v120
    v_max_i32 v84, v84, v120
    s_mov_b64 exec, -1
    v_lshl_add_u32 v59, -1, v84, v59

    v_lshl_add_u32 v61, v84, 1, v31
    ds_read_u16 v81, v61 offset:16
    s_setprio 0
    v_ffbl_b32 v84, v59
    v_perm_b32 v60, v74, v73, v84
    v_and_or_b32 v60, v60, s66, v85

    v_cmpx_ge_u32 vcc, 2, v84
    ds_add_u32 v60, v10
    s_not_b64 s[70:71], vcc
    s_mov_b64 exec, s[70:71]
    ds_add_rtn_u32 v87, v60, v10
    s_mov_b64 exec, -1

    ds_wrxchg_rtn_b32 v116, v86, v13
    s_waitcnt vmcnt(11)
    s_mov_b64 exec, s[4:5]
    buffer_store_dwordx4 v[104:107], v9, s[32:35], s47 offen sc1
    s_mov_b64 exec, -1
    buffer_load_dwordx4 v[152:155], v15, s[28:31], s77 offen offset:2048
    buffer_load_dwordx4 v[184:187], v15, s[28:31], s77 offen offset:2560

    s_waitcnt lgkmcnt(0)
    v_cmp_gt_u32 s[68:69], 2, v116

    v_cmp_eq_u32 s[72:73], 0, v116
    s_mov_b64 exec, s[70:71]
    v_cmpx_le_u32 vcc, 2, v87
    v_mov_b32 v62, s69
    v_mov_b32 v123, s73
    v_perm_b32 v121, v62, s68, v3
    v_perm_b32 v122, v123, s72, v2
    v_and_b32 v121, v121, v19
    v_and_b32 v122, v122, v18
    v_msad_u8 v120, v67, v121, 0
    v_lshlrev_b32 v120, 8, v120
    v_msad_u8 v120, v63, v122, v120
    v_and_b32 v120, v120, v59

    v_ffbl_b32 v120, v120
    v_max_i32 v84, v84, v120
    s_mov_b64 exec, -1
    v_lshl_add_u32 v59, -1, v84, v59

    v_lshl_add_u32 v61, v84, 1, v31
    ds_read_u16 v82, v61 offset:16
    v_ffbl_b32 v84, v59
    v_perm_b32 v60, v74, v73, v84
    v_and_or_b32 v60, v60, s66, v85

    v_cmpx_ge_u32 vcc, 3, v84
    ds_add_u32 v60, v10
    s_not_b64 s[70:71], vcc
    s_mov_b64 exec, s[70:71]
    ds_add_rtn_u32 v87, v60, v10
    s_mov_b64 exec, -1

    ds_wrxchg_rtn_b32 v116, v86, v13
    buffer_load_dwordx4 v[156:159], v15, s[28:31], s77 offen offset:3072
    buffer_load_dwordx4 v[188:191], v15, s[28:31], s77 offen offset:3584

    s_waitcnt lgkmcnt(0)
    v_cmp_gt_u32 s[68:69], 2, v116

    s_mov_b64 exec, s[70:71]
    v_cmpx_le_u32 vcc, 2, v87
    v_mov_b32 v62, s69
    v_perm_b32 v121, v62, s68, v3
    v_and_b32 v121, v121, v19
    v_msad_u8 v120, v67, v121, 0
    v_and_b32_sdwa v120, v120, v59 dst_sel:BYTE_1 dst_unused:UNUSED_PAD src0_sel:DWORD src1_sel:BYTE_1
    s_nop 0

    v_ffbl_b32 v120, v120
    v_max_i32 v84, v84, v120
    s_mov_b64 exec, -1
    v_lshl_add_u32 v59, -1, v84, v59

    v_lshl_add_u32 v61, v84, 1, v31
    ds_read_u16 v83, v61 offset:16
    v_lshrrev_b32 v59, 4, v59
    v_add_u32 v63, v58, v19
    s_bitcmp1_b32 s59, 0
    s_cbranch_scc1 standalone__deep_cross_pnn__recsys_kernel_pq7
    s_setprio 1
standalone__deep_cross_pnn__recsys_kernel_pq7:
    v_ffbl_b32 v84, v59
    v_perm_b32 v60, v75, v74, v84
    v_and_or_b32 v60, v60, s66, v85

    v_cmpx_ge_u32 vcc, 0, v84
    ds_add_u32 v60, v10
    s_not_b64 s[70:71], vcc
    s_mov_b64 exec, s[70:71]
    ds_add_rtn_u32 v87, v60, v10
    s_mov_b64 exec, -1

    ds_wrxchg_rtn_b32 v116, v86, v13

    s_waitcnt lgkmcnt(0)
    v_cmp_gt_u32 s[68:69], 2, v116

    v_cmp_eq_u32 s[72:73], 0, v116
    v_lshl_or_b32 v24, v81, 16, v80
    v_lshl_or_b32 v25, v83, 16, v82
    buffer_store_dwordx2 v[24:25], v30, s[32:35], s62 offen sc1
    s_add_u32 s62, s62, s63
    s_mov_b64 exec, s[70:71]
    v_cmpx_le_u32 vcc, 2, v87
    v_mov_b32 v62, s69
    v_mov_b32 v123, s73
    v_perm_b32 v121, v62, s68, v4
    v_perm_b32 v122, v123, s72, v3
    v_and_b32 v121, v121, v20
    v_and_b32 v122, v122, v19
    v_msad_u8 v120, v68, v121, 0
    v_lshlrev_b32 v120, 8, v120
    v_msad_u8 v120, v63, v122, v120
    v_and_b32 v120, v120, v59

    v_ffbl_b32 v120, v120
    v_max_i32 v84, v84, v120
    s_mov_b64 exec, -1
    v_lshl_add_u32 v59, -1, v84, v59

    v_lshl_add_u32 v61, v84, 1, v31
    ds_read_u16 v80, v61 offset:24
    s_setprio 0
    v_ffbl_b32 v84, v59
    v_perm_b32 v60, v75, v74, v84
    v_and_or_b32 v60, v60, s66, v85

    v_cmpx_ge_u32 vcc, 1, v84
    ds_add_u32 v60, v10
    s_not_b64 s[70:71], vcc
    s_mov_b64 exec, s[70:71]
    ds_add_rtn_u32 v87, v60, v10
    s_mov_b64 exec, -1

    ds_wrxchg_rtn_b32 v116, v86, v13

    s_waitcnt lgkmcnt(0)
    v_cmp_gt_u32 s[68:69], 2, v116

    v_cmp_eq_u32 s[72:73], 0, v116
    s_mov_b64 exec, s[70:71]
    v_cmpx_le_u32 vcc, 2, v87
    v_mov_b32 v62, s69
    v_mov_b32 v123, s73
    v_perm_b32 v121, v62, s68, v4
    v_perm_b32 v122, v123, s72, v3
    v_and_b32 v121, v121, v20
    v_and_b32 v122, v122, v19
    v_msad_u8 v120, v68, v121, 0
    v_lshlrev_b32 v120, 8, v120
    v_msad_u8 v120, v63, v122, v120
    v_and_b32 v120, v120, v59

    v_ffbl_b32 v120, v120
    v_max_i32 v84, v84, v120
    s_mov_b64 exec, -1
    v_lshl_add_u32 v59, -1, v84, v59

    v_lshl_add_u32 v61, v84, 1, v31
    ds_read_u16 v81, v61 offset:24

    s_cmp_ge_u32 s57, 800
    s_cbranch_scc1 standalone__deep_cross_pnn__recsys_kernel_norl
    s_waitcnt vmcnt(0)

    s_lshl_b32 s39, 1, s2
    s_cmp_eq_u32 s64, 0
    s_cselect_b32 s39, s39, 0

    s_lshr_b32 s38, s2, 5
    v_mov_b32 v60, s39
    s_lshl_b32 s38, s38, 4
    s_and_b64 exec, s[4:5], 1
    buffer_atomic_or v60, v13, s[52:55], s38 offen offset:128
    s_mov_b64 exec, -1

standalone__deep_cross_pnn__recsys_kernel_norl:
standalone__deep_cross_pnn__recsys_kernel_rld:
    v_ffbl_b32 v84, v59
    v_perm_b32 v60, v75, v74, v84
    v_and_or_b32 v60, v60, s66, v85

    v_cmpx_ge_u32 vcc, 2, v84
    ds_add_u32 v60, v10
    s_not_b64 s[70:71], vcc
    s_mov_b64 exec, s[70:71]
    ds_add_rtn_u32 v87, v60, v10
    s_mov_b64 exec, -1

    ds_wrxchg_rtn_b32 v116, v86, v13
    s_cmp_ge_u32 s57, 800
    s_cbranch_scc1 standalone__deep_cross_pnn__recsys_kernel_nr14
    v_perm_b32 v192, v132, v128, s84
    v_perm_b32 v193, v140, v136, s84
    v_perm_b32 v194, v148, v144, s84
    v_perm_b32 v195, v156, v152, s84
    s_add_u32 s83, s82, 0
    buffer_store_dwordx4 v[192:195], v14, s[32:35], s83 offen sc1
    v_perm_b32 v196, v132, v128, s85
    v_perm_b32 v197, v140, v136, s85
    v_perm_b32 v198, v148, v144, s85
    v_perm_b32 v199, v156, v152, s85
    s_add_u32 s83, s82, 102656
    buffer_store_dwordx4 v[196:199], v14, s[32:35], s83 offen sc1
standalone__deep_cross_pnn__recsys_kernel_nr14:

    s_waitcnt lgkmcnt(0)
    v_cmp_gt_u32 s[68:69], 2, v116

    v_cmp_eq_u32 s[72:73], 0, v116
    s_mov_b64 exec, s[70:71]
    v_cmpx_le_u32 vcc, 2, v87
    v_mov_b32 v62, s69
    v_mov_b32 v123, s73
    v_perm_b32 v121, v62, s68, v4
    v_perm_b32 v122, v123, s72, v3
    v_and_b32 v121, v121, v20
    v_and_b32 v122, v122, v19
    v_msad_u8 v120, v68, v121, 0
    v_lshlrev_b32 v120, 8, v120
    v_msad_u8 v120, v63, v122, v120
    v_and_b32 v120, v120, v59

    v_ffbl_b32 v120, v120
    v_max_i32 v84, v84, v120
    s_mov_b64 exec, -1
    v_lshl_add_u32 v59, -1, v84, v59

    v_lshl_add_u32 v61, v84, 1, v31
    ds_read_u16 v82, v61 offset:24
    s_bitcmp1_b32 s59, 0
    s_cbranch_scc1 standalone__deep_cross_pnn__recsys_kernel_pq8
    s_setprio 1
standalone__deep_cross_pnn__recsys_kernel_pq8:
    v_ffbl_b32 v84, v59
    v_perm_b32 v60, v75, v74, v84
    v_and_or_b32 v60, v60, s66, v85

    v_cmpx_ge_u32 vcc, 3, v84
    ds_add_u32 v60, v10
    s_not_b64 s[70:71], vcc
    s_mov_b64 exec, s[70:71]
    ds_add_rtn_u32 v87, v60, v10
    s_mov_b64 exec, -1

    ds_wrxchg_rtn_b32 v116, v86, v13
    s_cmp_ge_u32 s57, 800
    s_cbranch_scc1 standalone__deep_cross_pnn__recsys_kernel_nr15
    v_perm_b32 v200, v133, v129, s84
    v_perm_b32 v201, v141, v137, s84
    v_perm_b32 v202, v149, v145, s84
    v_perm_b32 v203, v157, v153, s84
    s_add_u32 s83, s82, 205312
    buffer_store_dwordx4 v[200:203], v14, s[32:35], s83 offen sc1
    v_perm_b32 v204, v133, v129, s85
    v_perm_b32 v205, v141, v137, s85
    v_perm_b32 v206, v149, v145, s85
    v_perm_b32 v207, v157, v153, s85
    s_add_u32 s83, s82, 307968
    buffer_store_dwordx4 v[204:207], v14, s[32:35], s83 offen sc1
standalone__deep_cross_pnn__recsys_kernel_nr15:

    s_waitcnt lgkmcnt(0)
    v_cmp_gt_u32 s[68:69], 2, v116

    s_mov_b64 exec, s[70:71]
    v_cmpx_le_u32 vcc, 2, v87
    v_mov_b32 v62, s69
    v_perm_b32 v121, v62, s68, v4
    v_and_b32 v121, v121, v20
    v_msad_u8 v120, v68, v121, 0
    v_and_b32_sdwa v120, v120, v59 dst_sel:BYTE_1 dst_unused:UNUSED_PAD src0_sel:DWORD src1_sel:BYTE_1
    s_nop 0

    v_ffbl_b32 v120, v120
    v_max_i32 v84, v84, v120
    s_mov_b64 exec, -1
    v_lshl_add_u32 v59, -1, v84, v59

    v_lshl_add_u32 v61, v84, 1, v31
    ds_read_u16 v83, v61 offset:24
    v_lshrrev_b32 v59, 4, v59
    v_add_u32 v63, v58, v20
    s_setprio 0
    v_ffbl_b32 v84, v59
    v_perm_b32 v60, v76, v75, v84
    v_and_or_b32 v60, v60, s66, v85

    v_cmpx_ge_u32 vcc, 0, v84
    ds_add_u32 v60, v10
    s_not_b64 s[70:71], vcc
    s_mov_b64 exec, s[70:71]
    ds_add_rtn_u32 v87, v60, v10
    s_mov_b64 exec, -1

    ds_wrxchg_rtn_b32 v116, v86, v13
    s_cmp_ge_u32 s57, 800
    s_cbranch_scc1 standalone__deep_cross_pnn__recsys_kernel_nr16
    v_perm_b32 v208, v134, v130, s84
    v_perm_b32 v209, v142, v138, s84
    v_perm_b32 v210, v150, v146, s84
    v_perm_b32 v211, v158, v154, s84
    s_add_u32 s83, s82, 410624
    buffer_store_dwordx4 v[208:211], v14, s[32:35], s83 offen sc1
    v_perm_b32 v212, v134, v130, s85
    v_perm_b32 v213, v142, v138, s85
    v_perm_b32 v214, v150, v146, s85
    v_perm_b32 v215, v158, v154, s85
    s_add_u32 s83, s82, 513280
    buffer_store_dwordx4 v[212:215], v14, s[32:35], s83 offen sc1
standalone__deep_cross_pnn__recsys_kernel_nr16:

    s_waitcnt lgkmcnt(0)
    v_cmp_gt_u32 s[68:69], 2, v116

    v_cmp_eq_u32 s[72:73], 0, v116
    v_lshl_or_b32 v24, v81, 16, v80
    v_lshl_or_b32 v25, v83, 16, v82
    buffer_store_dwordx2 v[24:25], v30, s[32:35], s62 offen sc1
    s_add_u32 s62, s62, s63
    s_mov_b64 exec, s[70:71]
    v_cmpx_le_u32 vcc, 2, v87
    v_mov_b32 v62, s69
    v_mov_b32 v123, s73
    v_perm_b32 v121, v62, s68, v5
    v_perm_b32 v122, v123, s72, v4
    v_and_b32 v121, v121, v21
    v_and_b32 v122, v122, v20
    v_msad_u8 v120, v69, v121, 0
    v_lshlrev_b32 v120, 8, v120
    v_msad_u8 v120, v63, v122, v120
    v_and_b32 v120, v120, v59

    v_ffbl_b32 v120, v120
    v_max_i32 v84, v84, v120
    s_mov_b64 exec, -1
    v_lshl_add_u32 v59, -1, v84, v59

    v_lshl_add_u32 v61, v84, 1, v31
    ds_read_u16 v80, v61 offset:32
    v_ffbl_b32 v84, v59
    v_perm_b32 v60, v76, v75, v84
    v_and_or_b32 v60, v60, s66, v85

    v_cmpx_ge_u32 vcc, 1, v84
    ds_add_u32 v60, v10
    s_not_b64 s[70:71], vcc
    s_mov_b64 exec, s[70:71]
    ds_add_rtn_u32 v87, v60, v10
    s_mov_b64 exec, -1

    ds_wrxchg_rtn_b32 v116, v86, v13
    s_cmp_ge_u32 s57, 800
    s_cbranch_scc1 standalone__deep_cross_pnn__recsys_kernel_nr17
    v_perm_b32 v216, v135, v131, s84
    v_perm_b32 v217, v143, v139, s84
    v_perm_b32 v218, v151, v147, s84
    v_perm_b32 v219, v159, v155, s84
    s_add_u32 s83, s82, 615936
    buffer_store_dwordx4 v[216:219], v14, s[32:35], s83 offen sc1
    v_perm_b32 v220, v135, v131, s85
    v_perm_b32 v221, v143, v139, s85
    v_perm_b32 v222, v151, v147, s85
    v_perm_b32 v223, v159, v155, s85
    s_add_u32 s83, s82, 718592
    buffer_store_dwordx4 v[220:223], v14, s[32:35], s83 offen sc1
standalone__deep_cross_pnn__recsys_kernel_nr17:

    s_waitcnt lgkmcnt(0)
    v_cmp_gt_u32 s[68:69], 2, v116

    v_cmp_eq_u32 s[72:73], 0, v116
    s_mov_b64 exec, s[70:71]
    v_cmpx_le_u32 vcc, 2, v87
    v_mov_b32 v62, s69
    v_mov_b32 v123, s73
    v_perm_b32 v121, v62, s68, v5
    v_perm_b32 v122, v123, s72, v4
    v_and_b32 v121, v121, v21
    v_and_b32 v122, v122, v20
    v_msad_u8 v120, v69, v121, 0
    v_lshlrev_b32 v120, 8, v120
    v_msad_u8 v120, v63, v122, v120
    v_and_b32 v120, v120, v59

    v_ffbl_b32 v120, v120
    v_max_i32 v84, v84, v120
    s_mov_b64 exec, -1
    v_lshl_add_u32 v59, -1, v84, v59

    v_lshl_add_u32 v61, v84, 1, v31
    ds_read_u16 v81, v61 offset:32
    s_setprio 1
    v_ffbl_b32 v84, v59
    v_perm_b32 v60, v76, v75, v84
    v_and_or_b32 v60, v60, s66, v85

    v_cmpx_ge_u32 vcc, 2, v84
    ds_add_u32 v60, v10
    s_not_b64 s[70:71], vcc
    s_mov_b64 exec, s[70:71]
    ds_add_rtn_u32 v87, v60, v10
    s_mov_b64 exec, -1

    ds_wrxchg_rtn_b32 v116, v86, v13
    s_cmp_ge_u32 s57, 800
    s_cbranch_scc1 standalone__deep_cross_pnn__recsys_kernel_nr18
    v_perm_b32 v224, v164, v160, s84
    v_perm_b32 v225, v172, v168, s84
    v_perm_b32 v226, v180, v176, s84
    v_perm_b32 v227, v188, v184, s84
    s_add_u32 s83, s82, 6569984
    buffer_store_dwordx4 v[224:227], v14, s[32:35], s83 offen sc1
    v_perm_b32 v228, v164, v160, s85
    v_perm_b32 v229, v172, v168, s85
    v_perm_b32 v230, v180, v176, s85
    v_perm_b32 v231, v188, v184, s85
    s_add_u32 s83, s82, 6672640
    buffer_store_dwordx4 v[228:231], v14, s[32:35], s83 offen sc1
standalone__deep_cross_pnn__recsys_kernel_nr18:

    s_waitcnt lgkmcnt(0)
    v_cmp_gt_u32 s[68:69], 2, v116

    v_cmp_eq_u32 s[72:73], 0, v116
    s_mov_b64 exec, s[70:71]
    v_cmpx_le_u32 vcc, 2, v87
    v_mov_b32 v62, s69
    v_mov_b32 v123, s73
    v_perm_b32 v121, v62, s68, v5
    v_perm_b32 v122, v123, s72, v4
    v_and_b32 v121, v121, v21
    v_and_b32 v122, v122, v20
    v_msad_u8 v120, v69, v121, 0
    v_lshlrev_b32 v120, 8, v120
    v_msad_u8 v120, v63, v122, v120
    v_and_b32 v120, v120, v59

    v_ffbl_b32 v120, v120
    v_max_i32 v84, v84, v120
    s_mov_b64 exec, -1
    v_lshl_add_u32 v59, -1, v84, v59

    v_lshl_add_u32 v61, v84, 1, v31
    ds_read_u16 v82, v61 offset:32
    s_bitcmp1_b32 s59, 0
    s_cbranch_scc1 standalone__deep_cross_pnn__recsys_kernel_pq9
    s_setprio 0
standalone__deep_cross_pnn__recsys_kernel_pq9:
    v_ffbl_b32 v84, v59
    v_perm_b32 v60, v76, v75, v84
    v_and_or_b32 v60, v60, s66, v85

    v_cmpx_ge_u32 vcc, 3, v84
    ds_add_u32 v60, v10
    s_not_b64 s[70:71], vcc
    s_mov_b64 exec, s[70:71]
    ds_add_rtn_u32 v87, v60, v10
    s_mov_b64 exec, -1

    ds_wrxchg_rtn_b32 v116, v86, v13
    s_cmp_ge_u32 s57, 800
    s_cbranch_scc1 standalone__deep_cross_pnn__recsys_kernel_nr19
    v_perm_b32 v232, v165, v161, s84
    v_perm_b32 v233, v173, v169, s84
    v_perm_b32 v234, v181, v177, s84
    v_perm_b32 v235, v189, v185, s84
    s_add_u32 s83, s82, 6775296
    buffer_store_dwordx4 v[232:235], v14, s[32:35], s83 offen sc1
    v_perm_b32 v236, v165, v161, s85
    v_perm_b32 v237, v173, v169, s85
    v_perm_b32 v238, v181, v177, s85
    v_perm_b32 v239, v189, v185, s85
    s_add_u32 s83, s82, 6877952
    buffer_store_dwordx4 v[236:239], v14, s[32:35], s83 offen sc1
standalone__deep_cross_pnn__recsys_kernel_nr19:

    s_waitcnt lgkmcnt(0)
    v_cmp_gt_u32 s[68:69], 2, v116

    s_mov_b64 exec, s[70:71]
    v_cmpx_le_u32 vcc, 2, v87
    v_mov_b32 v62, s69
    v_perm_b32 v121, v62, s68, v5
    v_and_b32 v121, v121, v21
    v_msad_u8 v120, v69, v121, 0
    v_and_b32_sdwa v120, v120, v59 dst_sel:BYTE_1 dst_unused:UNUSED_PAD src0_sel:DWORD src1_sel:BYTE_1
    s_nop 0

    v_ffbl_b32 v120, v120
    v_max_i32 v84, v84, v120
    s_mov_b64 exec, -1
    v_lshl_add_u32 v59, -1, v84, v59

    v_lshl_add_u32 v61, v84, 1, v31
    ds_read_u16 v83, v61 offset:32
    v_lshrrev_b32 v59, 4, v59
    v_add_u32 v63, v58, v21

    s_bitcmp0_b32 s59, 0
    s_cbranch_scc1 standalone__deep_cross_pnn__recsys_kernel_mg2
    v_mov_b32 v60, s46
    v_subrev_u32 v61, 512, v86

standalone__deep_cross_pnn__recsys_kernel_mg1:

    ds_read_b32 v12, v60
    ds_read_b32 v120, v61
    s_waitcnt lgkmcnt(0)
    v_readfirstlane_b32 s45, v12
    s_cmp_lg_u32 s45, 0
    s_cbranch_scc1 standalone__deep_cross_pnn__recsys_kernel_mg3
    s_sleep 2
    s_branch standalone__deep_cross_pnn__recsys_kernel_mg1

standalone__deep_cross_pnn__recsys_kernel_mg3:

    ds_write_b32 v60, v13
    s_mov_b32 s45, 0xff00
    v_lshl_or_b32 v120, v120, 8, v120
    v_and_or_b32 v59, v120, s45, v59

standalone__deep_cross_pnn__recsys_kernel_mg2:
    v_ffbl_b32 v84, v59
    v_perm_b32 v60, v77, v76, v84
    v_and_or_b32 v60, v60, s66, v85

    v_cmpx_ge_u32 vcc, 0, v84
    ds_add_u32 v60, v10
    s_not_b64 s[70:71], vcc
    s_mov_b64 exec, s[70:71]
    ds_add_rtn_u32 v87, v60, v10
    s_mov_b64 exec, -1

    ds_wrxchg_rtn_b32 v116, v86, v13
    s_cmp_ge_u32 s57, 800
    s_cbranch_scc1 standalone__deep_cross_pnn__recsys_kernel_nr20
    v_perm_b32 v240, v166, v162, s84
    v_perm_b32 v241, v174, v170, s84
    v_perm_b32 v242, v182, v178, s84
    v_perm_b32 v243, v190, v186, s84
    s_add_u32 s83, s82, 6980608
    buffer_store_dwordx4 v[240:243], v14, s[32:35], s83 offen sc1
    v_perm_b32 v244, v166, v162, s85
    v_perm_b32 v245, v174, v170, s85
    v_perm_b32 v246, v182, v178, s85
    v_perm_b32 v247, v190, v186, s85
    s_add_u32 s83, s82, 7083264
    buffer_store_dwordx4 v[244:247], v14, s[32:35], s83 offen sc1
standalone__deep_cross_pnn__recsys_kernel_nr20:
    buffer_store_dwordx4 v[108:111], v9, s[12:15], s6 offen offset:0 sc1
    buffer_store_dwordx4 v[108:111], v9, s[12:15], s6 offen offset:1024 sc1

    s_waitcnt lgkmcnt(0)
    v_cmp_gt_u32 s[68:69], 2, v116

    v_cmp_eq_u32 s[72:73], 0, v116
    v_lshl_or_b32 v24, v81, 16, v80
    v_lshl_or_b32 v25, v83, 16, v82
    buffer_store_dwordx2 v[24:25], v30, s[32:35], s62 offen sc1
    s_add_u32 s62, s62, s63
    s_mov_b64 exec, s[70:71]
    v_cmpx_le_u32 vcc, 2, v87
    v_mov_b32 v62, s69
    v_mov_b32 v123, s73
    v_perm_b32 v121, v62, s68, v6
    v_perm_b32 v122, v123, s72, v5
    v_and_b32 v121, v121, v22
    v_and_b32 v122, v122, v21
    v_msad_u8 v120, v70, v121, 0
    v_lshlrev_b32 v120, 8, v120
    v_msad_u8 v120, v63, v122, v120
    v_and_b32 v120, v120, v59

    v_ffbl_b32 v120, v120
    v_max_i32 v84, v84, v120
    s_mov_b64 exec, -1
    v_lshl_add_u32 v59, -1, v84, v59

    v_lshl_add_u32 v61, v84, 1, v31
    ds_read_u16 v80, v61 offset:40
    s_setprio 1
    v_ffbl_b32 v84, v59
    v_perm_b32 v60, v77, v76, v84
    v_and_or_b32 v60, v60, s66, v85

    v_cmpx_ge_u32 vcc, 1, v84
    ds_add_u32 v60, v10
    s_not_b64 s[70:71], vcc
    s_mov_b64 exec, s[70:71]
    ds_add_rtn_u32 v87, v60, v10
    s_mov_b64 exec, -1

    ds_wrxchg_rtn_b32 v116, v86, v13
    s_cmp_ge_u32 s57, 800
    s_cbranch_scc1 standalone__deep_cross_pnn__recsys_kernel_nr21
    v_perm_b32 v248, v167, v163, s84
    v_perm_b32 v249, v175, v171, s84
    v_perm_b32 v250, v183, v179, s84
    v_perm_b32 v251, v191, v187, s84
    s_add_u32 s83, s82, 7185920
    buffer_store_dwordx4 v[248:251], v14, s[32:35], s83 offen sc1
    v_perm_b32 v252, v167, v163, s85
    v_perm_b32 v253, v175, v171, s85
    v_perm_b32 v254, v183, v179, s85
    v_perm_b32 v255, v191, v187, s85
    s_add_u32 s83, s82, 7288576
    buffer_store_dwordx4 v[252:255], v14, s[32:35], s83 offen sc1
standalone__deep_cross_pnn__recsys_kernel_nr21:
    buffer_store_dwordx4 v[108:111], v9, s[12:15], s6 offen offset:2048 sc1
    buffer_store_dwordx4 v[108:111], v9, s[12:15], s6 offen offset:3072 sc1

    s_waitcnt lgkmcnt(0)
    v_cmp_gt_u32 s[68:69], 2, v116

    v_cmp_eq_u32 s[72:73], 0, v116
    s_mov_b64 exec, s[70:71]
    v_cmpx_le_u32 vcc, 2, v87
    v_mov_b32 v62, s69
    v_mov_b32 v123, s73
    v_perm_b32 v121, v62, s68, v6
    v_perm_b32 v122, v123, s72, v5
    v_and_b32 v121, v121, v22
    v_and_b32 v122, v122, v21
    v_msad_u8 v120, v70, v121, 0
    v_lshlrev_b32 v120, 8, v120
    v_msad_u8 v120, v63, v122, v120
    v_and_b32 v120, v120, v59

    v_ffbl_b32 v120, v120
    v_max_i32 v84, v84, v120
    s_mov_b64 exec, -1
    v_lshl_add_u32 v59, -1, v84, v59

    v_lshl_add_u32 v61, v84, 1, v31
    ds_read_u16 v81, v61 offset:40
    v_ffbl_b32 v84, v59
    v_perm_b32 v60, v77, v76, v84
    v_and_or_b32 v60, v60, s66, v85

    v_cmpx_ge_u32 vcc, 2, v84
    ds_add_u32 v60, v10
    s_not_b64 s[70:71], vcc
    s_mov_b64 exec, s[70:71]
    ds_add_rtn_u32 v87, v60, v10
    s_mov_b64 exec, -1

    ds_wrxchg_rtn_b32 v116, v86, v13
    buffer_store_dwordx4 v[108:111], v9, s[12:15], s7 offen offset:0 sc1
    buffer_store_dwordx4 v[108:111], v9, s[12:15], s7 offen offset:1024 sc1

    s_waitcnt lgkmcnt(0)
    v_cmp_gt_u32 s[68:69], 2, v116

    v_cmp_eq_u32 s[72:73], 0, v116
    s_mov_b64 exec, s[70:71]
    v_cmpx_le_u32 vcc, 2, v87
    v_mov_b32 v62, s69
    v_mov_b32 v123, s73
    v_perm_b32 v121, v62, s68, v6
    v_perm_b32 v122, v123, s72, v5
    v_and_b32 v121, v121, v22
    v_and_b32 v122, v122, v21
    v_msad_u8 v120, v70, v121, 0
    v_lshlrev_b32 v120, 8, v120
    v_msad_u8 v120, v63, v122, v120
    v_and_b32 v120, v120, v59

    v_ffbl_b32 v120, v120
    v_max_i32 v84, v84, v120
    s_mov_b64 exec, -1
    v_lshl_add_u32 v59, -1, v84, v59

    v_lshl_add_u32 v61, v84, 1, v31
    ds_read_u16 v82, v61 offset:40
    v_ffbl_b32 v84, v59
    v_perm_b32 v60, v77, v76, v84
    v_and_or_b32 v60, v60, s66, v85

    v_cmpx_ge_u32 vcc, 3, v84
    ds_add_u32 v60, v10
    s_not_b64 s[70:71], vcc
    s_mov_b64 exec, s[70:71]
    ds_add_rtn_u32 v87, v60, v10
    s_mov_b64 exec, -1

    ds_wrxchg_rtn_b32 v116, v86, v13
    buffer_store_dwordx4 v[108:111], v9, s[12:15], s7 offen offset:2048 sc1
    buffer_store_dwordx4 v[108:111], v9, s[12:15], s7 offen offset:3072 sc1
    s_bitcmp1_b32 s2, 0
    s_cselect_b32 s45, 30, 34
    s_bfm_b64 exec, s45, 0
    buffer_store_dwordx4 v[108:111], v9, s[12:15], s8 offen sc1
    s_mov_b64 exec, -1
    s_mov_b64 exec, 0xff
    buffer_load_dword v104, v9, s[52:55], 0 offen offset:128 sc1
    s_mov_b64 exec, -1

    s_waitcnt lgkmcnt(0)
    v_cmp_gt_u32 s[68:69], 2, v116

    s_mov_b64 exec, s[70:71]
    v_cmpx_le_u32 vcc, 2, v87
    v_mov_b32 v62, s69
    v_perm_b32 v121, v62, s68, v6
    v_and_b32 v121, v121, v22
    v_msad_u8 v120, v70, v121, 0
    v_and_b32_sdwa v120, v120, v59 dst_sel:BYTE_1 dst_unused:UNUSED_PAD src0_sel:DWORD src1_sel:BYTE_1
    s_nop 0

    v_ffbl_b32 v120, v120
    v_max_i32 v84, v84, v120
    s_mov_b64 exec, -1
    v_lshl_add_u32 v59, -1, v84, v59

    v_lshl_add_u32 v61, v84, 1, v31
    ds_read_u16 v83, v61 offset:40

    s_bitcmp1_b32 s59, 0
    s_cbranch_scc1 standalone__deep_cross_pnn__recsys_kernel_sk6
    v_mov_b32 v60, s46
    ds_write_b32 v86, v59
    ds_write_b32 v60, v10
    s_branch standalone__deep_cross_pnn__recsys_kernel_sdone

standalone__deep_cross_pnn__recsys_kernel_sk6:
    v_lshrrev_b32 v59, 4, v59
    v_add_u32 v63, v58, v22
    v_ffbl_b32 v84, v59
    v_perm_b32 v60, v78, v77, v84

    v_cmp_lt_u32 vcc, 7, v84
    v_alignbyte_b32 v61, v79, v79, v84
    s_nop 0
    v_cndmask_b32 v60, v60, v61, vcc

    v_and_or_b32 v60, v60, s66, v85
    ds_add_rtn_u32 v87, v60, v10
    ds_wrxchg_rtn_b32 v116, v86, v13

    s_waitcnt lgkmcnt(0)
    v_cmp_gt_u32 s[68:69], 2, v116

    v_lshl_or_b32 v24, v81, 16, v80
    v_lshl_or_b32 v25, v83, 16, v82
    buffer_store_dwordx2 v[24:25], v30, s[32:35], s62 offen sc1
    s_add_u32 s62, s62, s63
    s_nop 0
    v_cmpx_le_u32 vcc, 2, v87
    v_mov_b32 v62, s69
    v_perm_b32 v121, v62, s68, v7
    v_perm_b32 v122, v62, s68, v6
    v_perm_b32 v123, v62, s68, v5
    v_and_b32 v121, v121, v23
    v_and_b32 v122, v122, v22
    v_and_b32 v123, v123, v21
    v_msad_u8 v120, v71, v121, 0
    v_lshlrev_b32 v120, 8, v120
    v_msad_u8 v120, v63, v122, v120
    v_msad_u8 v120, v69, v123, v120
    v_and_b32 v120, v120, v59

    v_ffbl_b32 v120, v120
    v_max_i32 v84, v84, v120
    s_mov_b64 exec, -1
    v_lshl_add_u32 v59, -1, v84, v59

    v_lshl_add_u32 v61, v84, 1, v31
    ds_read_u16 v80, v61 offset:48
    v_ffbl_b32 v84, v59
    v_perm_b32 v60, v78, v77, v84

    v_cmp_lt_u32 vcc, 7, v84
    v_alignbyte_b32 v61, v79, v79, v84
    s_nop 0
    v_cndmask_b32 v60, v60, v61, vcc

    v_and_or_b32 v60, v60, s66, v85
    ds_add_rtn_u32 v87, v60, v10
    ds_wrxchg_rtn_b32 v116, v86, v13

    s_waitcnt lgkmcnt(0)
    v_cmp_gt_u32 s[68:69], 2, v116

    s_nop 0
    v_cmpx_le_u32 vcc, 2, v87
    v_mov_b32 v62, s69
    v_perm_b32 v121, v62, s68, v7
    v_perm_b32 v122, v62, s68, v6
    v_perm_b32 v123, v62, s68, v5
    v_and_b32 v121, v121, v23
    v_and_b32 v122, v122, v22
    v_and_b32 v123, v123, v21
    v_msad_u8 v120, v71, v121, 0
    v_lshlrev_b32 v120, 8, v120
    v_msad_u8 v120, v63, v122, v120
    v_msad_u8 v120, v69, v123, v120
    v_and_b32 v120, v120, v59

    v_ffbl_b32 v120, v120
    v_max_i32 v84, v84, v120
    s_mov_b64 exec, -1
    v_lshl_add_u32 v59, -1, v84, v59

    v_lshl_add_u32 v61, v84, 1, v31
    ds_read_u16 v81, v61 offset:48
    v_ffbl_b32 v84, v59
    v_perm_b32 v60, v78, v77, v84

    v_cmp_lt_u32 vcc, 7, v84
    v_alignbyte_b32 v61, v79, v79, v84
    s_nop 0
    v_cndmask_b32 v60, v60, v61, vcc

    v_and_or_b32 v60, v60, s66, v85
    ds_add_rtn_u32 v87, v60, v10
    ds_wrxchg_rtn_b32 v116, v86, v13

    s_waitcnt lgkmcnt(0)
    v_cmp_gt_u32 s[68:69], 2, v116

    s_nop 0
    v_cmpx_le_u32 vcc, 2, v87
    v_mov_b32 v62, s69
    v_perm_b32 v121, v62, s68, v7
    v_perm_b32 v122, v62, s68, v6
    v_perm_b32 v123, v62, s68, v5
    v_and_b32 v121, v121, v23
    v_and_b32 v122, v122, v22
    v_and_b32 v123, v123, v21
    v_msad_u8 v120, v71, v121, 0
    v_lshlrev_b32 v120, 8, v120
    v_msad_u8 v120, v63, v122, v120
    v_msad_u8 v120, v69, v123, v120
    v_and_b32 v120, v120, v59

    v_ffbl_b32 v120, v120
    v_max_i32 v84, v84, v120
    s_mov_b64 exec, -1
    v_lshl_add_u32 v59, -1, v84, v59

    v_lshl_add_u32 v61, v84, 1, v31
    ds_read_u16 v82, v61 offset:48
    v_ffbl_b32 v84, v59
    v_lshl_add_u32 v61, v84, 1, v31
    ds_read_u16 v83, v61 offset:48
standalone__deep_cross_pnn__recsys_kernel_sdone:
    s_waitcnt lgkmcnt(0)
    v_lshl_or_b32 v24, v81, 16, v80
    v_lshl_or_b32 v25, v83, 16, v82
    buffer_store_dwordx2 v[24:25], v30, s[32:35], s62 offen sc1
    s_add_u32 s62, s62, s63
standalone__deep_cross_pnn__recsys_kernel_udone:
    s_setprio 0

    v_mul_u32_u24 v0, 4352, v8
    v_mov_b32 v1, 1
    s_and_b32 s47, s2, 3
    s_mul_i32 s46, s47, 4352
    s_add_u32 s46, s46, 14688256
    s_lshl_b32 s47, s47, 2
    s_add_u32 s39, s47, 14827520

    s_waitcnt vmcnt(0)

    s_mov_b64 exec, 1
    ds_add_rtn_u32 v12, v11, v10 offset:20
    s_mov_b32 s49, 0
    s_waitcnt lgkmcnt(0)
    v_readfirstlane_b32 s48, v12
    s_and_b32 s48, s48, 3

    s_mov_b64 exec, 0xff
standalone__deep_cross_pnn__recsys_kernel_ec1:

    v_cmp_ne_u32 vcc, -1, v104
    s_cbranch_vccz standalone__deep_cross_pnn__recsys_kernel_tbl
    buffer_load_dword v104, v9, s[52:55], 0 offen offset:128 sc1
    s_add_u32 s49, s49, 1
    s_waitcnt vmcnt(0)
    s_cmp_lt_u32 s49, 12
    s_cbranch_scc1 standalone__deep_cross_pnn__recsys_kernel_ec1
    s_branch standalone__deep_cross_pnn__recsys_kernel_enx

standalone__deep_cross_pnn__recsys_kernel_hset:

    s_lshl_b32 s39, 1, s51
    s_lshr_b32 s38, s51, 5
    v_mov_b32 v1, s39
    s_lshl_b32 s38, s38, 4
    s_mov_b64 exec, 1
    buffer_atomic_or v1, v13, s[52:55], s38 offen offset:132
    s_mov_b64 exec, -1
    s_waitcnt vmcnt(0)
    s_branch standalone__deep_cross_pnn__recsys_kernel_slow

standalone__deep_cross_pnn__recsys_kernel_tbl:

    s_cmp_eq_u32 s48, 3
    s_cselect_b32 s45, s64, 1
    s_cmp_lg_u32 s45, 0
    s_cbranch_scc1 standalone__deep_cross_pnn__recsys_kernel_nat
    s_mov_b64 exec, 1
    buffer_atomic_add v1, v13, s[12:15], s46 offen sc0

standalone__deep_cross_pnn__recsys_kernel_nat:
    s_mov_b64 exec, -1
    s_mov_b32 s49, -1

    s_xor_b32 s44, s50, 1
    s_lshl_b32 s44, s44, 3
    s_lshl1_add_u32 s47, s48, s44
    s_add_u32 s44, s44, s56
    s_lshl_b32 s44, s44, 14
    s_add_u32 s44, s44, 15204352
    s_lshl_b32 s47, s47, 14
    s_add_u32 s47, s47, 15269888

    buffer_load_dwordx4 v[136:139], v9, s[12:15], s44 offen offset:0 sc1
    buffer_load_dwordx4 v[140:143], v9, s[12:15], s44 offen offset:1024 sc1
    buffer_load_dwordx4 v[152:155], v9, s[12:15], s44 offen offset:2048 sc1
    buffer_load_dwordx4 v[156:159], v9, s[12:15], s44 offen offset:3072 sc1
    s_add_u32 s44, s44, 4096
    buffer_load_dwordx4 v[168:171], v9, s[12:15], s44 offen offset:0 sc1
    buffer_load_dwordx4 v[172:175], v9, s[12:15], s44 offen offset:1024 sc1
    buffer_load_dwordx4 v[184:187], v9, s[12:15], s44 offen offset:2048 sc1
    buffer_load_dwordx4 v[188:191], v9, s[12:15], s44 offen offset:3072 sc1
    s_add_u32 s44, s44, 4096

    s_waitcnt vmcnt(8)
    v_cmp_eq_u32 vcc, 63, v1

    s_cbranch_vccz standalone__deep_cross_pnn__recsys_kernel_nsg
    s_mov_b64 exec, 0xff
    buffer_store_dword v10, v0, s[12:15], s39 offen sc1
    s_mov_b64 exec, -1

standalone__deep_cross_pnn__recsys_kernel_nsg:
    s_waitcnt vmcnt(7)
    buffer_load_dwordx4 v[200:203], v9, s[12:15], s44 offen offset:0 sc1
    s_waitcnt vmcnt(7)
    buffer_load_dwordx4 v[204:207], v9, s[12:15], s44 offen offset:1024 sc1
    s_waitcnt vmcnt(7)
    buffer_load_dwordx4 v[216:219], v9, s[12:15], s44 offen offset:2048 sc1
    s_waitcnt vmcnt(7)
    buffer_load_dwordx4 v[220:223], v9, s[12:15], s44 offen offset:3072 sc1
    s_add_u32 s44, s44, 4096
    s_waitcnt vmcnt(7)
    buffer_load_dwordx4 v[232:235], v9, s[12:15], s44 offen offset:0 sc1
    s_waitcnt vmcnt(7)
    buffer_load_dwordx4 v[236:239], v9, s[12:15], s44 offen offset:1024 sc1
    s_waitcnt vmcnt(7)
    buffer_load_dwordx4 v[248:251], v9, s[12:15], s44 offen offset:2048 sc1
    s_waitcnt vmcnt(7)
    buffer_load_dwordx4 v[252:255], v9, s[12:15], s44 offen offset:3072 sc1
    s_add_u32 s44, s44, 4096
standalone__deep_cross_pnn__recsys_kernel_enx:

    s_mov_b64 exec, -1
    s_mul_i32 s85, s56, 18432
    v_and_b32 v25, 15, v8
    v_lshrrev_b32 v26, 4, v8
    v_mul_u32_u24 v24, 144, v25
    v_lshl_add_u32 v24, v26, 4, v24
    v_add_u32 v24, s85, v24

    s_lshr_b32 s79, s2, 1
    s_mul_i32 s77, s79, 102656
    s_lshl_b32 s85, s50, 11
    s_xor_b32 s78, s85, 2048
    s_add_u32 s78, s78, s77
    s_add_u32 s77, s77, s85
    s_and_b32 s79, s2, 1
    s_mul_i32 s79, s79, 1638400
    s_add_u32 s79, s79, 16777216
    s_lshl_b32 s85, s3, 13
    s_add_u32 s79, s79, s85
    s_xor_b32 s85, s3, 4
    s_lshl_b32 s85, s85, 10
    s_min_u32 s85, s85, 7040
    s_bitcmp1_b32 s2, 1
    s_cselect_b32 s83, 0, 16
    s_lshl_b32 s80, s24, s83
    s_lshl_b32 s81, s25, s83
    s_lshl_b32 s82, s26, s83
    s_lshl_b32 s83, s27, s83
    s_and_b32 s80, s80, 0xffff0000
    s_and_b32 s81, s81, 0xffff0000
    s_and_b32 s82, s82, 0xffff0000
    s_and_b32 s83, s83, 0xffff0000
    ds_read_b128 v[128:131], v24 offset:0
    ds_read_b128 v[132:135], v24 offset:64
    v_lshlrev_b32 v69, 4, v8
    v_lshlrev_b32 v70, 13, v26
    v_lshl_add_u32 v70, v25, 3, v70
    v_add_u32 v70, s85, v70
    ds_read_b128 v[144:147], v24 offset:2304
    ds_read_b128 v[148:151], v24 offset:2368
    v_lshrrev_b32 v28, 3, v8
    v_xor_b32 v28, v28, v26
    v_and_b32 v28, 1, v28
    v_bfe_u32 v29, v8, 2, 1
    ds_read_b128 v[160:163], v24 offset:4608
    ds_read_b128 v[164:167], v24 offset:4672
    v_lshl_or_b32 v28, v28, 1, v29
    v_mov_b32 v30, 0x3f80
    v_cmp_eq_u32 vcc, 0, v28
    v_cmp_eq_u32 s[68:69], 1, v28
    ds_read_b128 v[176:179], v24 offset:6912
    ds_read_b128 v[180:183], v24 offset:6976
    v_and_b32 v29, 3, v8
    v_mul_u32_u24 v68, 0x5555, v29
    v_cndmask_b32 v64, 0, v30, vcc
    v_cndmask_b32 v65, 0, v30, vcc
    ds_read_b128 v[192:195], v24 offset:9216
    ds_read_b128 v[196:199], v24 offset:9280
    v_cndmask_b32 v66, 0, v30, s[68:69]
    v_cndmask_b32 v67, 0, v30, s[68:69]
    v_add_u32 v114, 144256, v69
    v_add_u32 v71, 0x10000, v70
    ds_read_b128 v[208:211], v24 offset:11520
    ds_read_b128 v[212:215], v24 offset:11584
    v_mov_b64 v[32:33], s[80:81]
    v_mov_b64 v[34:35], s[82:83]
    v_mov_b64 v[36:37], s[80:81]
    v_mov_b64 v[38:39], s[82:83]
    ds_read_b128 v[224:227], v24 offset:13824
    ds_read_b128 v[228:231], v24 offset:13888
    v_mov_b64 v[40:41], s[80:81]
    v_mov_b64 v[42:43], s[82:83]
    v_mov_b64 v[44:45], s[80:81]
    v_mov_b64 v[46:47], s[82:83]
    ds_read_b128 v[240:243], v24 offset:16128
    ds_read_b128 v[244:247], v24 offset:16192
    v_mov_b64 v[48:49], s[80:81]
    v_mov_b64 v[50:51], s[82:83]
    v_mov_b64 v[52:53], s[80:81]
    v_mov_b64 v[54:55], s[82:83]
    v_mov_b64 v[56:57], s[80:81]
    v_mov_b64 v[58:59], s[82:83]
    v_mov_b64 v[60:61], s[80:81]
    v_mov_b64 v[62:63], s[82:83]

    s_bitcmp1_b32 s56, 1
    s_cselect_b32 s84, s78, s77
    s_lshl_b32 s85, s56, 10
    s_add_u32 m0, s85, 144256
    s_and_b32 s85, s85, 1024
    s_add_u32 s84, s84, s85

    s_add_u32 s85, s84, 0
    buffer_load_dwordx4 v[88:91], v69, s[12:15], s85 offen sc1
    s_add_u32 s85, s84, 4096
    buffer_load_dwordx4 v[88:91], v69, s[12:15], s85 offen sc1
    s_add_u32 s85, s84, 8192
    buffer_load_dwordx4 v[88:91], v69, s[12:15], s85 offen sc1
    s_add_u32 s85, s84, 12288
    buffer_load_dwordx4 v[88:91], v69, s[12:15], s85 offen sc1

    s_cmp_lg_u32 s48, 0
    s_cbranch_scc1 standalone__deep_cross_pnn__recsys_kernel_wdec
    s_mov_b64 exec, -1
    v_lshlrev_b32 v0, 7, v8
    v_lshrrev_b32 v2, 5, v8
    v_lshlrev_b32 v2, 4, v2
    v_mul_u32_u24 v3, 4, v8
    s_mov_b32 s44, 14680064
    s_bfe_u32 s46, s2, 196608
    s_mul_i32 s47, s46, 4352
    s_add_u32 s47, s47, 14827520
    s_lshl_b32 s46, s46, 2
    s_mov_b32 s38, 3221225472

standalone__deep_cross_pnn__recsys_kernel_p0:

    ds_read_b32 v12, v11 offset:20
    s_waitcnt lgkmcnt(0)
    v_readfirstlane_b32 s45, v12
    s_and_b32 s45, s45, 3
    s_cbranch_scc0 standalone__deep_cross_pnn__recsys_kernel_p1s
    s_sleep 1
    s_branch standalone__deep_cross_pnn__recsys_kernel_p0

standalone__deep_cross_pnn__recsys_kernel_p1s:

    s_cmp_lg_u32 s64, 0
    s_cbranch_scc1 standalone__deep_cross_pnn__recsys_kernel_hset

    s_mov_b64 exec, 1
    s_cmp_lg_u32 s49, -1
    s_cbranch_scc1 standalone__deep_cross_pnn__recsys_kernel_nfp

    buffer_store_dword v10, v13, s[12:15], s9 offen sc1
    s_mov_b64 exec, 0xf
standalone__deep_cross_pnn__recsys_kernel_p1:

    buffer_load_dword v1, v3, s[12:15], s47 offen sc1
    s_add_u32 s65, s65, 1
    s_waitcnt vmcnt(0)
    v_cmp_eq_u32 vcc, 0, v1
    s_cbranch_vccz standalone__deep_cross_pnn__recsys_kernel_dec
    s_sleep 2
    s_cmp_lt_u32 s65, 200
    s_cbranch_scc1 standalone__deep_cross_pnn__recsys_kernel_p1
    s_mov_b64 exec, 1

standalone__deep_cross_pnn__recsys_kernel_nfp:

    buffer_store_dword v10, v13, s[12:15], s9 offen sc1
    s_mov_b64 exec, -1

standalone__deep_cross_pnn__recsys_kernel_slow:
    buffer_load_dwordx2 v[16:17], v2, s[52:55], 0 offen offset:128 sc1
    buffer_load_dwordx2 v[18:19], v2, s[52:55], 0 offen offset:160 sc1
    buffer_load_dwordx2 v[20:21], v2, s[52:55], 0 offen offset:192 sc1
    buffer_load_dwordx2 v[22:23], v2, s[52:55], 0 offen offset:224 sc1

    s_waitcnt vmcnt(0)
    buffer_load_dwordx4 v[4:7], v0, s[12:15], s44 offen sc1
    s_add_u32 s65, s65, 1
    s_waitcnt vmcnt(0)

    v_bfe_u32 v16, v16, v8, 1
    v_bfe_u32 v17, v17, v8, 1
    v_and_b32 v4, v4, v16
    v_or_b32 v17, v17, v4

    v_bfe_u32 v18, v18, v8, 1
    v_bfe_u32 v19, v19, v8, 1
    v_and_b32 v5, v5, v18
    v_or_b32 v19, v19, v5

    v_bfe_u32 v20, v20, v8, 1
    v_bfe_u32 v21, v21, v8, 1
    v_and_b32 v6, v6, v20
    v_or_b32 v21, v21, v6

    v_bfe_u32 v22, v22, v8, 1
    v_bfe_u32 v23, v23, v8, 1
    v_and_b32 v7, v7, v22
    v_or_b32 v23, v23, v7

    v_min3_u32 v1, v4, v5, v6
    v_min_u32 v1, v1, v7
    v_cmp_eq_u32 vcc, 0, v1
    s_mov_b32 s38, 3221225472
    s_cbranch_vccz standalone__deep_cross_pnn__recsys_kernel_dec
    v_min3_u32 v1, v17, v19, v21
    v_min_u32 v1, v1, v23
    v_cmp_eq_u32 vcc, 0, v1
    s_mov_b32 s38, 2147483648
    s_cbranch_vccz standalone__deep_cross_pnn__recsys_kernel_dec
    s_cmp_lt_u32 s65, 200
    s_cbranch_scc1 standalone__deep_cross_pnn__recsys_kernel_slow

    v_cmp_eq_u32 vcc, 0, v17
    s_movk_i32 s38, 0
    s_cbranch_vccnz standalone__deep_cross_pnn__recsys_kernel_fnd
    v_cmp_eq_u32 vcc, 0, v19
    s_movk_i32 s38, 64
    s_cbranch_vccnz standalone__deep_cross_pnn__recsys_kernel_fnd
    v_cmp_eq_u32 vcc, 0, v21
    s_movk_i32 s38, 128
    s_cbranch_vccnz standalone__deep_cross_pnn__recsys_kernel_fnd
    v_cmp_eq_u32 vcc, 0, v23
    s_movk_i32 s38, 192
standalone__deep_cross_pnn__recsys_kernel_fnd:

    s_ff1_i32_b64 s39, vcc
    s_add_u32 s38, s38, s39
    s_andn2_b32 s39, s64, 255
    s_add_u32 s39, s39, 256
    s_or_b32 s38, s38, s39

standalone__deep_cross_pnn__recsys_kernel_dec:

    s_mov_b64 exec, 1
    v_mov_b32 v1, s38
    ds_write_b32 v11, v1 offset:24

standalone__deep_cross_pnn__recsys_kernel_wdec:

    s_mov_b64 exec, -1
    ds_read_b32 v12, v11 offset:24
    s_waitcnt lgkmcnt(0)
    v_readfirstlane_b32 s45, v12
    s_cmp_lg_u32 s45, s64
    s_cbranch_scc1 standalone__deep_cross_pnn__recsys_kernel_gotd
    s_sleep 2
    s_branch standalone__deep_cross_pnn__recsys_kernel_wdec

standalone__deep_cross_pnn__recsys_kernel_hlp:
    s_waitcnt vmcnt(0)
    s_branch standalone__deep_cross_pnn__recsys_kernel_unit
standalone__deep_cross_pnn__recsys_kernel_gotd:

    s_mov_b32 s64, s45
    s_and_b32 s51, s45, 255

    s_mov_b32 s65, 200
    s_bitcmp0_b32 s45, 31
    s_cbranch_scc1 standalone__deep_cross_pnn__recsys_kernel_hlp

    s_cmp_eq_u32 s49, -1
    s_cbranch_scc1 standalone__deep_cross_pnn__recsys_kernel_k2

    s_xor_b32 s44, s50, 1
    s_lshl_b32 s44, s44, 3
    s_lshl1_add_u32 s47, s48, s44
    s_add_u32 s44, s44, s56
    s_lshl_b32 s44, s44, 14
    s_add_u32 s44, s44, 15204352
    s_lshl_b32 s47, s47, 14
    s_add_u32 s47, s47, 15269888

    buffer_load_dwordx4 v[136:139], v9, s[12:15], s44 offen offset:0 sc1
    buffer_load_dwordx4 v[140:143], v9, s[12:15], s44 offen offset:1024 sc1
    buffer_load_dwordx4 v[152:155], v9, s[12:15], s44 offen offset:2048 sc1
    buffer_load_dwordx4 v[156:159], v9, s[12:15], s44 offen offset:3072 sc1
    s_add_u32 s44, s44, 4096
    buffer_load_dwordx4 v[168:171], v9, s[12:15], s44 offen offset:0 sc1
    buffer_load_dwordx4 v[172:175], v9, s[12:15], s44 offen offset:1024 sc1
    buffer_load_dwordx4 v[184:187], v9, s[12:15], s44 offen offset:2048 sc1
    buffer_load_dwordx4 v[188:191], v9, s[12:15], s44 offen offset:3072 sc1
    s_add_u32 s44, s44, 4096
    s_waitcnt vmcnt(7)
    buffer_load_dwordx4 v[200:203], v9, s[12:15], s44 offen offset:0 sc1
    s_waitcnt vmcnt(7)
    buffer_load_dwordx4 v[204:207], v9, s[12:15], s44 offen offset:1024 sc1
    s_waitcnt vmcnt(7)
    buffer_load_dwordx4 v[216:219], v9, s[12:15], s44 offen offset:2048 sc1
    s_waitcnt vmcnt(7)
    buffer_load_dwordx4 v[220:223], v9, s[12:15], s44 offen offset:3072 sc1
    s_add_u32 s44, s44, 4096
    s_waitcnt vmcnt(7)
    buffer_load_dwordx4 v[232:235], v9, s[12:15], s44 offen offset:0 sc1
    s_waitcnt vmcnt(7)
    buffer_load_dwordx4 v[236:239], v9, s[12:15], s44 offen offset:1024 sc1
    s_waitcnt vmcnt(7)
    buffer_load_dwordx4 v[248:251], v9, s[12:15], s44 offen offset:2048 sc1
    s_waitcnt vmcnt(7)
    buffer_load_dwordx4 v[252:255], v9, s[12:15], s44 offen offset:3072 sc1
    s_add_u32 s44, s44, 4096
standalone__deep_cross_pnn__recsys_kernel_k2:
    s_setprio 1
    buffer_load_dwordx4 v[0:3], v69, s[12:15], s77 offen offset:0 sc1
    buffer_load_dwordx4 v[4:7], v69, s[12:15], s77 offen offset:1024 sc1
    buffer_load_dwordx4 v[8:11], v69, s[12:15], s78 offen offset:0 sc1
    buffer_load_dwordx4 v[12:15], v69, s[12:15], s78 offen offset:1024 sc1
    buffer_load_dwordx4 v69, s[12:15], s84 offen sc1 lds
    s_add_u32 m0, m0, 4096
    s_add_u32 s84, s84, 4096
    buffer_load_dwordx4 v69, s[12:15], s84 offen sc1 lds
    s_add_u32 m0, m0, 4096
    s_add_u32 s84, s84, 4096
    buffer_load_dwordx4 v69, s[12:15], s84 offen sc1 lds
    s_add_u32 s44, s77, 4096
    s_add_u32 s45, s78, 4096
    buffer_load_dwordx4 v[16:19], v69, s[12:15], s44 offen offset:0 sc1
    buffer_load_dwordx4 v[20:23], v69, s[12:15], s44 offen offset:1024 sc1
    buffer_load_dwordx4 v[24:27], v69, s[12:15], s45 offen offset:0 sc1
    buffer_load_dwordx4 v[28:31], v69, s[12:15], s45 offen offset:1024 sc1
    s_barrier
    s_waitcnt vmcnt(7)
    v_mfma_f32_16x16x32_bf16 v[88:91], v[0:3], v[128:131], 0
    v_mfma_f32_16x16x32_bf16 v[92:95], v[0:3], v[144:147], 0
    s_add_u32 s21, s77, 12288
    v_mfma_f32_16x16x32_bf16 v[88:91], v[4:7], v[132:135], v[88:91]
    s_add_u32 s19, s78, 12288
    v_mfma_f32_16x16x32_bf16 v[92:95], v[4:7], v[148:151], v[92:95]
    s_mov_b32 s20, s79
    v_mfma_f32_16x16x32_bf16 v[88:91], v[8:11], v[136:139], v[88:91]
    s_lshr_b32 s33, s2, 1
    v_mfma_f32_16x16x32_bf16 v[92:95], v[8:11], v[152:155], v[92:95]
    s_and_b32 s34, s2, 1
    v_mfma_f32_16x16x32_bf16 v[88:91], v[12:15], v[140:143], v[88:91]
    s_load_dwordx4 s[56:59], s[0:1], 48
    s_load_dword s28, s[10:11], 0
    s_load_dword s29, s[10:11], 16
    s_load_dword s30, s[10:11], 32
    s_load_dword s31, s[10:11], 48
    v_mfma_f32_16x16x32_bf16 v[92:95], v[12:15], v[156:159], v[92:95]
    v_mfma_f32_16x16x32_bf16 v[96:99], v[0:3], v[160:163], 0
    v_mfma_f32_16x16x32_bf16 v[100:103], v[0:3], v[176:179], 0
    v_mfma_f32_16x16x32_bf16 v[96:99], v[4:7], v[164:167], v[96:99]
    v_cvt_pk_bf16_f32 v116, v88, v89
    v_mfma_f32_16x16x32_bf16 v[100:103], v[4:7], v[180:183], v[100:103]
    v_cvt_pk_bf16_f32 v117, v90, v91
    v_mfma_f32_16x16x32_bf16 v[96:99], v[8:11], v[168:171], v[96:99]
    v_mfma_f32_16x16x32_bf16 v[100:103], v[8:11], v[184:187], v[100:103]
    v_cvt_pk_bf16_f32 v118, v92, v93
    v_mfma_f32_16x16x32_bf16 v[96:99], v[12:15], v[172:175], v[96:99]
    v_cvt_pk_bf16_f32 v119, v94, v95
    v_mfma_f32_16x16x32_bf16 v[100:103], v[12:15], v[188:191], v[100:103]
    v_mfma_f32_16x16x32_bf16 v[104:107], v[0:3], v[192:195], 0
    v_mfma_f32_16x16x32_bf16 v[108:111], v[0:3], v[208:211], 0
    v_mfma_f32_16x16x32_bf16 v[104:107], v[4:7], v[196:199], v[104:107]
    v_cvt_pk_bf16_f32 v120, v96, v97
    v_mfma_f32_16x16x32_bf16 v[108:111], v[4:7], v[212:215], v[108:111]
    v_cvt_pk_bf16_f32 v121, v98, v99
    v_mfma_f32_16x16x32_bf16 v[104:107], v[8:11], v[200:203], v[104:107]
    v_mfma_f32_16x16x32_bf16 v[108:111], v[8:11], v[216:219], v[108:111]
    v_cvt_pk_bf16_f32 v122, v100, v101
    v_mfma_f32_16x16x32_bf16 v[104:107], v[12:15], v[204:207], v[104:107]
    v_cvt_pk_bf16_f32 v123, v102, v103
    v_mfma_f32_16x16x32_bf16 v[108:111], v[12:15], v[220:223], v[108:111]
    v_mfma_f32_16x16x32_bf16 v[88:91], v[0:3], v[224:227], 0
    v_mfma_f32_16x16x32_bf16 v[92:95], v[0:3], v[240:243], 0
    v_mfma_f32_16x16x32_bf16 v[88:91], v[4:7], v[228:231], v[88:91]
    v_cvt_pk_bf16_f32 v124, v104, v105
    v_mfma_f32_16x16x32_bf16 v[92:95], v[4:7], v[244:247], v[92:95]
    v_cvt_pk_bf16_f32 v125, v106, v107
    v_mfma_f32_16x16x32_bf16 v[88:91], v[8:11], v[232:235], v[88:91]
    v_mfma_f32_16x16x32_bf16 v[92:95], v[8:11], v[248:251], v[92:95]
    v_cvt_pk_bf16_f32 v126, v108, v109
    v_mfma_f32_16x16x32_bf16 v[88:91], v[12:15], v[236:239], v[88:91]
    v_cvt_pk_bf16_f32 v127, v110, v111
    v_mfma_f32_16x16x32_bf16 v[92:95], v[12:15], v[252:255], v[92:95]
    s_waitcnt vmcnt(0)
    v_mfma_f32_16x16x32_bf16 v[96:99], v[16:19], v[128:131], 0
    v_mfma_f32_16x16x32_bf16 v[100:103], v[16:19], v[144:147], 0
    v_mfma_f32_16x16x32_bf16 v[96:99], v[20:23], v[132:135], v[96:99]
    v_cvt_pk_bf16_f32 v72, v88, v89
    v_mfma_f32_16x16x32_bf16 v[100:103], v[20:23], v[148:151], v[100:103]
    v_cvt_pk_bf16_f32 v73, v90, v91
    s_waitcnt vmcnt(4)
    s_barrier
    v_mfma_f32_16x16x32_bf16 v[96:99], v[24:27], v[136:139], v[96:99]
    v_mfma_f32_16x16x32_bf16 v[100:103], v[24:27], v[152:155], v[100:103]
    v_cvt_pk_bf16_f32 v74, v92, v93
    v_mfma_f32_16x16x32_bf16 v[96:99], v[28:31], v[140:143], v[96:99]
    v_cvt_pk_bf16_f32 v75, v94, v95
    v_mfma_f32_16x16x32_bf16 v[100:103], v[28:31], v[156:159], v[100:103]
    v_mfma_f32_16x16x32_bf16 v[104:107], v[16:19], v[160:163], 0
    v_mfma_f32_16x16x32_bf16 v[108:111], v[16:19], v[176:179], 0
    v_mfma_f32_16x16x32_bf16 v[104:107], v[20:23], v[164:167], v[104:107]
    v_cvt_pk_bf16_f32 v76, v96, v97
    v_mfma_f32_16x16x32_bf16 v[108:111], v[20:23], v[180:183], v[108:111]
    v_cvt_pk_bf16_f32 v77, v98, v99
    v_mfma_f32_16x16x32_bf16 v[104:107], v[24:27], v[168:171], v[104:107]
    v_mfma_f32_16x16x32_bf16 v[108:111], v[24:27], v[184:187], v[108:111]
    v_cvt_pk_bf16_f32 v78, v100, v101
    v_mfma_f32_16x16x32_bf16 v[104:107], v[28:31], v[172:175], v[104:107]
    v_cvt_pk_bf16_f32 v79, v102, v103
    v_mfma_f32_16x16x32_bf16 v[108:111], v[28:31], v[188:191], v[108:111]
    v_mfma_f32_16x16x32_bf16 v[88:91], v[16:19], v[192:195], 0
    v_mfma_f32_16x16x32_bf16 v[92:95], v[16:19], v[208:211], 0
    v_mfma_f32_16x16x32_bf16 v[88:91], v[20:23], v[196:199], v[88:91]
    v_cvt_pk_bf16_f32 v80, v104, v105
    v_mfma_f32_16x16x32_bf16 v[92:95], v[20:23], v[212:215], v[92:95]
    v_cvt_pk_bf16_f32 v81, v106, v107
    v_mfma_f32_16x16x32_bf16 v[88:91], v[24:27], v[200:203], v[88:91]
    v_mfma_f32_16x16x32_bf16 v[92:95], v[24:27], v[216:219], v[92:95]
    v_cvt_pk_bf16_f32 v82, v108, v109
    v_mfma_f32_16x16x32_bf16 v[88:91], v[28:31], v[204:207], v[88:91]
    v_cvt_pk_bf16_f32 v83, v110, v111
    ds_write_b64 v70, v[116:117] offset:0
    v_mfma_f32_16x16x32_bf16 v[92:95], v[28:31], v[220:223], v[92:95]
    ds_read_b128 v[0:3], v114 offset:8192
    ds_read_b128 v[4:7], v114 offset:9216
    ds_read_b128 v[8:11], v114 offset:10240
    ds_read_b128 v[12:15], v114 offset:11264
    v_mfma_f32_16x16x32_bf16 v[96:99], v[16:19], v[224:227], 0
    ds_write_b64 v70, v[118:119] offset:128
    v_mfma_f32_16x16x32_bf16 v[100:103], v[16:19], v[240:243], 0
    v_mfma_f32_16x16x32_bf16 v[96:99], v[20:23], v[228:231], v[96:99]
    v_cvt_pk_bf16_f32 v88, v88, v89
    ds_write_b64 v70, v[120:121] offset:256
    v_mfma_f32_16x16x32_bf16 v[100:103], v[20:23], v[244:247], v[100:103]
    v_cvt_pk_bf16_f32 v89, v90, v91
    v_mfma_f32_16x16x32_bf16 v[96:99], v[24:27], v[232:235], v[96:99]
    ds_write_b64 v70, v[88:89] offset:33280
    ds_write_b64 v70, v[122:123] offset:384
    v_mfma_f32_16x16x32_bf16 v[100:103], v[24:27], v[248:251], v[100:103]
    v_cvt_pk_bf16_f32 v92, v92, v93
    v_mfma_f32_16x16x32_bf16 v[96:99], v[28:31], v[236:239], v[96:99]
    v_cvt_pk_bf16_f32 v93, v94, v95
    ds_write_b64 v70, v[124:125] offset:512
    v_mfma_f32_16x16x32_bf16 v[100:103], v[28:31], v[252:255], v[100:103]
    ds_write_b64 v70, v[92:93] offset:33408
    s_waitcnt lgkmcnt(6)
    v_mfma_f32_16x16x32_bf16 v[104:107], v[0:3], v[128:131], 0
    buffer_load_dwordx4 v[116:119], v69, s[12:15], s20 offen offset:0 sc1
    ds_write_b64 v70, v[126:127] offset:640
    v_mfma_f32_16x16x32_bf16 v[108:111], v[0:3], v[144:147], 0
    v_mfma_f32_16x16x32_bf16 v[104:107], v[4:7], v[132:135], v[104:107]
    v_cvt_pk_bf16_f32 v96, v96, v97
    ds_write_b64 v70, v[72:73] offset:768
    v_mfma_f32_16x16x32_bf16 v[108:111], v[4:7], v[148:151], v[108:111]
    v_cvt_pk_bf16_f32 v97, v98, v99
    v_mfma_f32_16x16x32_bf16 v[104:107], v[8:11], v[136:139], v[104:107]
    ds_write_b64 v70, v[96:97] offset:33536
    buffer_load_dwordx4 v[120:123], v69, s[12:15], s20 offen offset:1024 sc1
    v_mfma_f32_16x16x32_bf16 v[108:111], v[8:11], v[152:155], v[108:111]
    v_cvt_pk_bf16_f32 v100, v100, v101
    ds_write_b64 v70, v[74:75] offset:896
    v_mfma_f32_16x16x32_bf16 v[104:107], v[12:15], v[140:143], v[104:107]
    v_cvt_pk_bf16_f32 v101, v102, v103
    v_mov_b64 v[16:17], s[80:81]
    v_mfma_f32_16x16x32_bf16 v[108:111], v[12:15], v[156:159], v[108:111]
    ds_write_b64 v70, v[100:101] offset:33664
    v_mov_b64 v[18:19], s[82:83]
    v_mfma_f32_16x16x32_bf16 v[88:91], v[0:3], v[160:163], 0
    v_mov_b64 v[20:21], s[80:81]
    v_mov_b64 v[22:23], s[82:83]
    v_mfma_f32_16x16x32_bf16 v[92:95], v[0:3], v[176:179], 0
    v_mov_b64 v[24:25], s[80:81]
    v_mov_b64 v[26:27], s[82:83]
    v_mfma_f32_16x16x32_bf16 v[88:91], v[4:7], v[164:167], v[88:91]
    v_cvt_pk_bf16_f32 v104, v104, v105
    v_mov_b64 v[28:29], s[80:81]
    v_mfma_f32_16x16x32_bf16 v[92:95], v[4:7], v[180:183], v[92:95]
    v_cvt_pk_bf16_f32 v105, v106, v107
    v_mov_b64 v[30:31], s[82:83]
    v_mfma_f32_16x16x32_bf16 v[88:91], v[8:11], v[168:171], v[88:91]
    ds_write_b64 v71, v[104:105] offset:0
    ds_write_b64 v70, v[76:77] offset:32768
    v_mfma_f32_16x16x32_bf16 v[92:95], v[8:11], v[184:187], v[92:95]
    v_cvt_pk_bf16_f32 v108, v108, v109
    buffer_load_dwordx4 v[124:127], v69, s[12:15], s20 offen offset:2048 sc1
    v_mfma_f32_16x16x32_bf16 v[88:91], v[12:15], v[172:175], v[88:91]
    v_cvt_pk_bf16_f32 v109, v110, v111
    ds_write_b64 v70, v[78:79] offset:32896
    v_mfma_f32_16x16x32_bf16 v[92:95], v[12:15], v[188:191], v[92:95]
    ds_write_b64 v71, v[108:109] offset:128
    ds_write_b64 v70, v[80:81] offset:33024
    v_mfma_f32_16x16x32_bf16 v[96:99], v[0:3], v[192:195], 0
    buffer_load_dwordx4 v[72:75], v69, s[12:15], s21 offen offset:0 sc1
    ds_write_b64 v70, v[82:83] offset:33152
    v_mfma_f32_16x16x32_bf16 v[100:103], v[0:3], v[208:211], 0
    buffer_load_dwordx4 v[76:79], v69, s[12:15], s21 offen offset:1024 sc1
    v_mfma_f32_16x16x32_bf16 v[96:99], v[4:7], v[196:199], v[96:99]
    v_cvt_pk_bf16_f32 v88, v88, v89
    v_mfma_f32_16x16x32_bf16 v[100:103], v[4:7], v[212:215], v[100:103]
    v_cvt_pk_bf16_f32 v89, v90, v91
    v_mfma_f32_16x16x32_bf16 v[96:99], v[8:11], v[200:203], v[96:99]
    ds_write_b64 v71, v[88:89] offset:256
    buffer_load_dwordx4 v[80:83], v69, s[12:15], s19 offen offset:0 sc1
    v_mfma_f32_16x16x32_bf16 v[100:103], v[8:11], v[216:219], v[100:103]
    v_cvt_pk_bf16_f32 v92, v92, v93
    v_mfma_f32_16x16x32_bf16 v[96:99], v[12:15], v[204:207], v[96:99]
    v_cvt_pk_bf16_f32 v93, v94, v95
    v_mfma_f32_16x16x32_bf16 v[100:103], v[12:15], v[220:223], v[100:103]
    ds_write_b64 v71, v[92:93] offset:384
    v_mfma_f32_16x16x32_bf16 v[104:107], v[0:3], v[224:227], 0
    buffer_load_dwordx4 v[84:87], v69, s[12:15], s19 offen offset:1024 sc1
    s_add_u32 s21, s21, 4096
    s_add_u32 s19, s19, 4096
    v_mfma_f32_16x16x32_bf16 v[108:111], v[0:3], v[240:243], 0
    v_mfma_f32_16x16x32_bf16 v[104:107], v[4:7], v[228:231], v[104:107]
    v_cvt_pk_bf16_f32 v96, v96, v97
    v_mfma_f32_16x16x32_bf16 v[108:111], v[4:7], v[244:247], v[108:111]
    v_cvt_pk_bf16_f32 v97, v98, v99
    v_mfma_f32_16x16x32_bf16 v[104:107], v[8:11], v[232:235], v[104:107]
    ds_write_b64 v71, v[96:97] offset:512
    v_mfma_f32_16x16x32_bf16 v[108:111], v[8:11], v[248:251], v[108:111]
    v_cvt_pk_bf16_f32 v100, v100, v101
    v_mov_b64 v[0:1], s[80:81]
    v_mfma_f32_16x16x32_bf16 v[104:107], v[12:15], v[236:239], v[104:107]
    v_cvt_pk_bf16_f32 v101, v102, v103
    v_mov_b64 v[2:3], s[82:83]
    v_mfma_f32_16x16x32_bf16 v[108:111], v[12:15], v[252:255], v[108:111]
    ds_write_b64 v71, v[100:101] offset:640
    v_mov_b64 v[4:5], s[80:81]
    s_nop 1
    v_mov_b64 v[6:7], s[82:83]
    v_mov_b64 v[8:9], s[80:81]
    v_mov_b64 v[10:11], s[82:83]
    v_mov_b64 v[12:13], s[80:81]
    v_mov_b64 v[14:15], s[82:83]
    s_nop 4
    v_cvt_pk_bf16_f32 v104, v104, v105
    v_cvt_pk_bf16_f32 v105, v106, v107
    ds_write_b64 v71, v[104:105] offset:768
    v_cvt_pk_bf16_f32 v108, v108, v109
    v_cvt_pk_bf16_f32 v109, v110, v111
    ds_write_b64 v71, v[108:109] offset:896
    v_add_u32 v70, 0x18000, v70
    s_branch standalone__deep_cross_pnn__recsys_kernel_k2j
standalone__deep_cross_pnn__recsys_kernel_k2m:
    s_barrier

    s_setprio 0
    s_waitcnt vmcnt(0)

    buffer_load_dwordx4 v[136:139], v254, s[12:15], s44 offen offset:0 sc1
    ds_read_b128 v[128:131], v95 offset:0
    ds_read_b128 v[132:135], v95 offset:64
    ds_read_b128 v[144:147], v95 offset:2304
    ds_read_b128 v[148:151], v95 offset:2368
    v_fma_f32 v85, v208, v44, v240
    v_mov_b32 v84, v239
    v_mov_b32 v86, v241
    v_mov_b32 v113, v243
    v_mov_b32 v112, v94
    v_add_u32 v114, 144256, v254
    v_fmac_f32 v85, v209, v45
    v_fmac_f32 v85, v210, v46
    v_fmac_f32 v85, v211, v47
    v_fmac_f32 v85, v196, v32
    buffer_load_dwordx4 v[140:143], v254, s[12:15], s44 offen offset:1024 sc1
    ds_read_b128 v[160:163], v95 offset:4608
    ds_read_b128 v[164:167], v95 offset:4672
    ds_read_b128 v[176:179], v95 offset:6912
    ds_read_b128 v[180:183], v95 offset:6976
    v_fmac_f32 v85, v197, v33
    v_fmac_f32 v85, v198, v34
    v_fmac_f32 v85, v199, v35
    v_fmac_f32 v85, v52, v60
    v_fmac_f32 v85, v53, v61
    buffer_load_dwordx4 v[152:155], v254, s[12:15], s44 offen offset:2048 sc1
    ds_read_b128 v[208:211], v95 offset:11520
    ds_read_b128 v[212:215], v95 offset:11584
    ds_read_b128 v[224:227], v95 offset:13824
    ds_read_b128 v[228:231], v95 offset:13888
    v_fmac_f32 v85, v54, v62
    v_fmac_f32 v85, v55, v63
    v_fmac_f32 v85, v200, v36
    v_fmac_f32 v85, v201, v37
    v_fmac_f32 v85, v202, v38
    buffer_load_dwordx4 v[156:159], v254, s[12:15], s44 offen offset:3072 sc1
    s_add_u32 s44, s44, 4096
    ds_read_b128 v[240:243], v95 offset:16128
    ds_read_b128 v[244:247], v95 offset:16192
    ds_read_b128 v[192:195], v95 offset:9216
    ds_read_b128 v[196:199], v95 offset:9280
    v_fmac_f32 v85, v203, v39
    v_fmac_f32 v85, v204, v40
    v_fmac_f32 v85, v205, v41
    v_fmac_f32 v85, v206, v42
    v_fmac_f32 v85, v207, v43
    buffer_load_dwordx4 v[168:171], v254, s[12:15], s44 offen offset:0 sc1
    v_and_b32 v49, 15, v255
    v_lshrrev_b32 v50, 4, v255
    v_lshlrev_b32 v69, 4, v255
    v_lshlrev_b32 v70, 13, v50
    buffer_load_dwordx4 v[172:175], v254, s[12:15], s44 offen offset:1024 sc1
    v_lshl_add_u32 v70, v49, 3, v70
    v_add_u32 v70, s85, v70
    v_add_u32 v71, 0x10000, v70
    s_waitcnt lgkmcnt(0)
    s_barrier
    s_setprio 2
    ds_read_b128 v[0:3], v114 offset:0
    ds_read_b128 v[4:7], v114 offset:1024
    ds_read_b128 v[8:11], v114 offset:2048
    ds_read_b128 v[12:15], v114 offset:3072
    s_add_u32 s21, s77, 12288
    s_add_u32 s19, s78, 12288
    s_mov_b32 s20, s79
    s_lshr_b32 s33, s2, 1
    s_and_b32 s34, s2, 1
    v_lshrrev_b32 v52, 3, v255
    v_xor_b32 v52, v52, v50
    v_and_b32 v52, 1, v52
    v_bfe_u32 v53, v255, 2, 1
    v_lshl_or_b32 v52, v52, 1, v53
    v_mov_b32 v54, 0x3f80
    s_waitcnt lgkmcnt(0)
    v_mfma_f32_16x16x32_bf16 v[88:91], v[0:3], v[128:131], 0
    buffer_load_dwordx4 v[184:187], v69, s[12:15], s44 offen offset:2048 sc1
    v_cmp_eq_u32 vcc, 0, v52
    ds_read_b128 v[16:19], v114 offset:4096
    ds_read_b128 v[20:23], v114 offset:5120
    ds_read_b128 v[24:27], v114 offset:6144
    ds_read_b128 v[28:31], v114 offset:7168
    v_mfma_f32_16x16x32_bf16 v[92:95], v[0:3], v[144:147], 0
    v_permlane32_swap_b32 v84, v85
    v_mfma_f32_16x16x32_bf16 v[88:91], v[4:7], v[132:135], v[88:91]
    v_cmp_eq_u32 s[68:69], 1, v52
    v_mfma_f32_16x16x32_bf16 v[92:95], v[4:7], v[148:151], v[92:95]
    v_add_f32 v87, v84, v85
    buffer_load_dwordx4 v[188:191], v69, s[12:15], s44 offen offset:3072 sc1
    s_add_u32 s44, s44, 4096
    s_waitcnt vmcnt(4)
    v_mfma_f32_16x16x32_bf16 v[88:91], v[8:11], v[136:139], v[88:91]
    v_and_b32 v53, 3, v255
    v_mfma_f32_16x16x32_bf16 v[92:95], v[8:11], v[152:155], v[92:95]
    v_permlane16_swap_b32 v86, v87
    v_mfma_f32_16x16x32_bf16 v[88:91], v[12:15], v[140:143], v[88:91]
    buffer_load_dwordx4 v[200:203], v69, s[12:15], s44 offen offset:0 sc1
    v_mul_u32_u24 v68, 0x5555, v53
    ds_read_b128 v[32:35], v114 offset:8192
    ds_read_b128 v[36:39], v114 offset:9216
    ds_read_b128 v[40:43], v114 offset:10240
    ds_read_b128 v[44:47], v114 offset:11264
    v_mfma_f32_16x16x32_bf16 v[92:95], v[12:15], v[156:159], v[92:95]
    v_add_f32 v86, v86, v87
    s_waitcnt lgkmcnt(4)
    v_mfma_f32_16x16x32_bf16 v[96:99], v[16:19], v[128:131], 0
    v_cndmask_b32 v64, 0, v54, vcc
    v_mfma_f32_16x16x32_bf16 v[100:103], v[16:19], v[144:147], 0
    v_add_f32_dpp v86, v86, v86 row_ror:8 row_mask:0xf bank_mask:0xf
    buffer_load_dwordx4 v[204:207], v69, s[12:15], s44 offen offset:1024 sc1
    v_mfma_f32_16x16x32_bf16 v[96:99], v[20:23], v[132:135], v[96:99]
    v_cvt_pk_bf16_f32 v88, v88, v89
    v_cndmask_b32 v65, 0, v54, vcc
    v_mfma_f32_16x16x32_bf16 v[100:103], v[20:23], v[148:151], v[100:103]
    v_cvt_pk_bf16_f32 v89, v90, v91
    v_add_f32_dpp v86, v86, v86 row_ror:4 row_mask:0xf bank_mask:0xf
    v_mfma_f32_16x16x32_bf16 v[96:99], v[24:27], v[136:139], v[96:99]
    ds_write_b64 v70, v[88:89] offset:0
    buffer_load_dwordx4 v[216:219], v69, s[12:15], s44 offen offset:2048 sc1
    v_mfma_f32_16x16x32_bf16 v[100:103], v[24:27], v[152:155], v[100:103]
    v_cvt_pk_bf16_f32 v92, v92, v93
    v_cndmask_b32 v66, 0, v54, s[68:69]
    v_mfma_f32_16x16x32_bf16 v[96:99], v[28:31], v[140:143], v[96:99]
    v_cvt_pk_bf16_f32 v93, v94, v95
    v_add_f32_dpp v86, v86, v86 row_ror:2 row_mask:0xf bank_mask:0xf
    v_mfma_f32_16x16x32_bf16 v[100:103], v[28:31], v[156:159], v[100:103]
    ds_write_b64 v70, v[92:93] offset:128
    v_cndmask_b32 v67, 0, v54, s[68:69]
    s_waitcnt lgkmcnt(2)
    v_mfma_f32_16x16x32_bf16 v[104:107], v[32:35], v[128:131], 0
    v_add_f32_dpp v86, v86, v86 row_ror:1 row_mask:0xf bank_mask:0xf
    buffer_load_dwordx4 v[220:223], v69, s[12:15], s44 offen offset:3072 sc1
    s_add_u32 s44, s44, 4096
    v_mfma_f32_16x16x32_bf16 v[108:111], v[32:35], v[144:147], 0
    v_cndmask_b32 v113, v113, v86, s[70:71]
    v_mfma_f32_16x16x32_bf16 v[104:107], v[36:39], v[132:135], v[104:107]
    v_cvt_pk_bf16_f32 v96, v96, v97
    buffer_load_dwordx4 v[232:235], v69, s[12:15], s44 offen offset:0 sc1
    v_mfma_f32_16x16x32_bf16 v[108:111], v[36:39], v[148:151], v[108:111]
    v_cvt_pk_bf16_f32 v97, v98, v99
    v_mfma_f32_16x16x32_bf16 v[104:107], v[40:43], v[136:139], v[104:107]
    ds_write_b64 v70, v[96:97] offset:32768
    v_mfma_f32_16x16x32_bf16 v[108:111], v[40:43], v[152:155], v[108:111]
    v_cvt_pk_bf16_f32 v100, v100, v101
    buffer_load_dwordx4 v[236:239], v69, s[12:15], s44 offen offset:1024 sc1
    v_mfma_f32_16x16x32_bf16 v[104:107], v[44:47], v[140:143], v[104:107]
    v_cvt_pk_bf16_f32 v101, v102, v103
    s_mov_b64 exec, s[46:47]
    buffer_store_dword v113, v112, s[12:15], s76 offen sc1
    s_mov_b64 exec, -1
    v_mfma_f32_16x16x32_bf16 v[108:111], v[44:47], v[156:159], v[108:111]
    ds_write_b64 v70, v[100:101] offset:32896
    v_mov_b64 v[48:49], s[80:81]
    v_mfma_f32_16x16x32_bf16 v[88:91], v[0:3], v[160:163], 0
    buffer_load_dwordx4 v[248:251], v69, s[12:15], s44 offen offset:2048 sc1
    v_mov_b64 v[50:51], s[82:83]
    v_mfma_f32_16x16x32_bf16 v[92:95], v[0:3], v[176:179], 0
    v_mov_b64 v[52:53], s[80:81]
    v_mfma_f32_16x16x32_bf16 v[88:91], v[4:7], v[164:167], v[88:91]
    v_cvt_pk_bf16_f32 v104, v104, v105
    v_mov_b64 v[54:55], s[82:83]
    v_mfma_f32_16x16x32_bf16 v[92:95], v[4:7], v[180:183], v[92:95]
    v_cvt_pk_bf16_f32 v105, v106, v107
    buffer_load_dwordx4 v[252:255], v69, s[12:15], s44 offen offset:3072 sc1
    s_add_u32 s44, s44, 4096
    s_waitcnt vmcnt(9)
    v_mfma_f32_16x16x32_bf16 v[88:91], v[8:11], v[168:171], v[88:91]
    ds_write_b64 v71, v[104:105] offset:0
    v_mov_b64 v[56:57], s[80:81]
    v_mfma_f32_16x16x32_bf16 v[92:95], v[8:11], v[184:187], v[92:95]
    v_cvt_pk_bf16_f32 v108, v108, v109
    v_mov_b64 v[58:59], s[82:83]
    v_mfma_f32_16x16x32_bf16 v[88:91], v[12:15], v[172:175], v[88:91]
    v_cvt_pk_bf16_f32 v109, v110, v111
    v_mov_b64 v[60:61], s[80:81]
    v_mfma_f32_16x16x32_bf16 v[92:95], v[12:15], v[188:191], v[92:95]
    ds_write_b64 v71, v[108:109] offset:128
    buffer_load_dwordx4 v[116:119], v69, s[12:15], s20 offen offset:0 sc1
    v_mfma_f32_16x16x32_bf16 v[96:99], v[16:19], v[160:163], 0
    v_mov_b64 v[62:63], s[82:83]
    v_mfma_f32_16x16x32_bf16 v[100:103], v[16:19], v[176:179], 0
    buffer_load_dwordx4 v[120:123], v69, s[12:15], s20 offen offset:1024 sc1
    v_mfma_f32_16x16x32_bf16 v[96:99], v[20:23], v[164:167], v[96:99]
    v_cvt_pk_bf16_f32 v88, v88, v89
    v_mfma_f32_16x16x32_bf16 v[100:103], v[20:23], v[180:183], v[100:103]
    v_cvt_pk_bf16_f32 v89, v90, v91
    v_mfma_f32_16x16x32_bf16 v[96:99], v[24:27], v[168:171], v[96:99]
    ds_write_b64 v70, v[88:89] offset:256
    buffer_load_dwordx4 v[124:127], v69, s[12:15], s20 offen offset:2048 sc1
    v_mfma_f32_16x16x32_bf16 v[100:103], v[24:27], v[184:187], v[100:103]
    v_cvt_pk_bf16_f32 v92, v92, v93
    v_mfma_f32_16x16x32_bf16 v[96:99], v[28:31], v[172:175], v[96:99]
    v_cvt_pk_bf16_f32 v93, v94, v95
    v_mfma_f32_16x16x32_bf16 v[100:103], v[28:31], v[188:191], v[100:103]
    ds_write_b64 v70, v[92:93] offset:384
    buffer_load_dwordx4 v[72:75], v69, s[12:15], s21 offen offset:0 sc1
    v_mfma_f32_16x16x32_bf16 v[104:107], v[32:35], v[160:163], 0
    v_mfma_f32_16x16x32_bf16 v[108:111], v[32:35], v[176:179], 0
    s_load_dwordx4 s[56:59], s[0:1], 48
    v_mfma_f32_16x16x32_bf16 v[104:107], v[36:39], v[164:167], v[104:107]
    v_cvt_pk_bf16_f32 v96, v96, v97
    buffer_load_dwordx4 v[76:79], v69, s[12:15], s21 offen offset:1024 sc1
    v_mfma_f32_16x16x32_bf16 v[108:111], v[36:39], v[180:183], v[108:111]
    v_cvt_pk_bf16_f32 v97, v98, v99
    v_mfma_f32_16x16x32_bf16 v[104:107], v[40:43], v[168:171], v[104:107]
    ds_write_b64 v70, v[96:97] offset:33024
    v_mfma_f32_16x16x32_bf16 v[108:111], v[40:43], v[184:187], v[108:111]
    v_cvt_pk_bf16_f32 v100, v100, v101
    buffer_load_dwordx4 v[80:83], v69, s[12:15], s19 offen offset:0 sc1
    v_mfma_f32_16x16x32_bf16 v[104:107], v[44:47], v[172:175], v[104:107]
    v_cvt_pk_bf16_f32 v101, v102, v103
    v_mfma_f32_16x16x32_bf16 v[108:111], v[44:47], v[188:191], v[108:111]
    ds_write_b64 v70, v[100:101] offset:33152
    v_mfma_f32_16x16x32_bf16 v[88:91], v[0:3], v[192:195], 0
    buffer_load_dwordx4 v[84:87], v69, s[12:15], s19 offen offset:1024 sc1
    s_add_u32 s21, s21, 4096
    s_add_u32 s19, s19, 4096
    v_mfma_f32_16x16x32_bf16 v[92:95], v[0:3], v[208:211], 0
    v_mfma_f32_16x16x32_bf16 v[88:91], v[4:7], v[196:199], v[88:91]
    v_cvt_pk_bf16_f32 v104, v104, v105
    v_mfma_f32_16x16x32_bf16 v[92:95], v[4:7], v[212:215], v[92:95]
    v_cvt_pk_bf16_f32 v105, v106, v107
    s_waitcnt vmcnt(12)
    v_mfma_f32_16x16x32_bf16 v[88:91], v[8:11], v[200:203], v[88:91]
    ds_write_b64 v71, v[104:105] offset:256
    v_mfma_f32_16x16x32_bf16 v[92:95], v[8:11], v[216:219], v[92:95]
    v_cvt_pk_bf16_f32 v108, v108, v109
    v_mfma_f32_16x16x32_bf16 v[88:91], v[12:15], v[204:207], v[88:91]
    v_cvt_pk_bf16_f32 v109, v110, v111
    v_mfma_f32_16x16x32_bf16 v[92:95], v[12:15], v[220:223], v[92:95]
    ds_write_b64 v71, v[108:109] offset:384
    v_mfma_f32_16x16x32_bf16 v[96:99], v[16:19], v[192:195], 0
    v_mfma_f32_16x16x32_bf16 v[100:103], v[16:19], v[208:211], 0
    v_mfma_f32_16x16x32_bf16 v[96:99], v[20:23], v[196:199], v[96:99]
    v_cvt_pk_bf16_f32 v88, v88, v89
    v_mfma_f32_16x16x32_bf16 v[100:103], v[20:23], v[212:215], v[100:103]
    v_cvt_pk_bf16_f32 v89, v90, v91
    v_mfma_f32_16x16x32_bf16 v[96:99], v[24:27], v[200:203], v[96:99]
    ds_write_b64 v70, v[88:89] offset:512
    v_mfma_f32_16x16x32_bf16 v[100:103], v[24:27], v[216:219], v[100:103]
    v_cvt_pk_bf16_f32 v92, v92, v93
    v_mfma_f32_16x16x32_bf16 v[96:99], v[28:31], v[204:207], v[96:99]
    v_cvt_pk_bf16_f32 v93, v94, v95
    v_mfma_f32_16x16x32_bf16 v[100:103], v[28:31], v[220:223], v[100:103]
    ds_write_b64 v70, v[92:93] offset:640
    v_mfma_f32_16x16x32_bf16 v[104:107], v[32:35], v[192:195], 0
    v_mfma_f32_16x16x32_bf16 v[108:111], v[32:35], v[208:211], 0
    v_mfma_f32_16x16x32_bf16 v[104:107], v[36:39], v[196:199], v[104:107]
    v_cvt_pk_bf16_f32 v96, v96, v97
    v_mfma_f32_16x16x32_bf16 v[108:111], v[36:39], v[212:215], v[108:111]
    v_cvt_pk_bf16_f32 v97, v98, v99
    v_mfma_f32_16x16x32_bf16 v[104:107], v[40:43], v[200:203], v[104:107]
    ds_write_b64 v70, v[96:97] offset:33280
    v_mfma_f32_16x16x32_bf16 v[108:111], v[40:43], v[216:219], v[108:111]
    v_cvt_pk_bf16_f32 v100, v100, v101
    v_mfma_f32_16x16x32_bf16 v[104:107], v[44:47], v[204:207], v[104:107]
    v_cvt_pk_bf16_f32 v101, v102, v103
    v_mfma_f32_16x16x32_bf16 v[108:111], v[44:47], v[220:223], v[108:111]
    ds_write_b64 v70, v[100:101] offset:33408
    v_mfma_f32_16x16x32_bf16 v[88:91], v[0:3], v[224:227], 0
    v_mfma_f32_16x16x32_bf16 v[92:95], v[0:3], v[240:243], 0
    v_mfma_f32_16x16x32_bf16 v[88:91], v[4:7], v[228:231], v[88:91]
    v_cvt_pk_bf16_f32 v104, v104, v105
    v_mfma_f32_16x16x32_bf16 v[92:95], v[4:7], v[244:247], v[92:95]
    v_cvt_pk_bf16_f32 v105, v106, v107
    s_waitcnt vmcnt(7)
    v_mfma_f32_16x16x32_bf16 v[88:91], v[8:11], v[232:235], v[88:91]
    ds_write_b64 v71, v[104:105] offset:512
    v_mfma_f32_16x16x32_bf16 v[92:95], v[8:11], v[248:251], v[92:95]
    v_cvt_pk_bf16_f32 v108, v108, v109
    v_mov_b64 v[0:1], s[80:81]
    v_mfma_f32_16x16x32_bf16 v[88:91], v[12:15], v[236:239], v[88:91]
    v_cvt_pk_bf16_f32 v109, v110, v111
    v_mov_b64 v[2:3], s[82:83]
    v_mfma_f32_16x16x32_bf16 v[92:95], v[12:15], v[252:255], v[92:95]
    ds_write_b64 v71, v[108:109] offset:640
    v_mov_b64 v[4:5], s[80:81]
    v_mfma_f32_16x16x32_bf16 v[96:99], v[16:19], v[224:227], 0
    v_mov_b64 v[6:7], s[82:83]
    v_mfma_f32_16x16x32_bf16 v[100:103], v[16:19], v[240:243], 0
    v_mov_b64 v[8:9], s[80:81]
    v_mov_b64 v[10:11], s[82:83]
    v_mfma_f32_16x16x32_bf16 v[96:99], v[20:23], v[228:231], v[96:99]
    v_cvt_pk_bf16_f32 v88, v88, v89
    v_mfma_f32_16x16x32_bf16 v[100:103], v[20:23], v[244:247], v[100:103]
    v_cvt_pk_bf16_f32 v89, v90, v91
    v_mov_b64 v[12:13], s[80:81]
    v_mfma_f32_16x16x32_bf16 v[96:99], v[24:27], v[232:235], v[96:99]
    ds_write_b64 v70, v[88:89] offset:768
    v_mov_b64 v[14:15], s[82:83]
    v_mfma_f32_16x16x32_bf16 v[100:103], v[24:27], v[248:251], v[100:103]
    v_cvt_pk_bf16_f32 v92, v92, v93
    v_mov_b64 v[16:17], s[80:81]
    v_mfma_f32_16x16x32_bf16 v[96:99], v[28:31], v[236:239], v[96:99]
    v_cvt_pk_bf16_f32 v93, v94, v95
    v_mov_b64 v[18:19], s[82:83]
    v_mfma_f32_16x16x32_bf16 v[100:103], v[28:31], v[252:255], v[100:103]
    ds_write_b64 v70, v[92:93] offset:896
    v_mov_b64 v[20:21], s[80:81]
    v_mfma_f32_16x16x32_bf16 v[104:107], v[32:35], v[224:227], 0
    v_mov_b64 v[22:23], s[82:83]
    v_mfma_f32_16x16x32_bf16 v[108:111], v[32:35], v[240:243], 0
    v_mov_b64 v[24:25], s[80:81]
    v_mov_b64 v[26:27], s[82:83]
    v_mfma_f32_16x16x32_bf16 v[104:107], v[36:39], v[228:231], v[104:107]
    v_cvt_pk_bf16_f32 v96, v96, v97
    v_mfma_f32_16x16x32_bf16 v[108:111], v[36:39], v[244:247], v[108:111]
    v_cvt_pk_bf16_f32 v97, v98, v99
    v_mov_b64 v[28:29], s[80:81]
    v_mfma_f32_16x16x32_bf16 v[104:107], v[40:43], v[232:235], v[104:107]
    ds_write_b64 v70, v[96:97] offset:33536
    v_mov_b64 v[30:31], s[82:83]
    v_mfma_f32_16x16x32_bf16 v[108:111], v[40:43], v[248:251], v[108:111]
    v_cvt_pk_bf16_f32 v100, v100, v101
    v_mov_b64 v[32:33], s[80:81]
    v_mfma_f32_16x16x32_bf16 v[104:107], v[44:47], v[236:239], v[104:107]
    v_cvt_pk_bf16_f32 v101, v102, v103
    v_mov_b64 v[34:35], s[82:83]
    v_mfma_f32_16x16x32_bf16 v[108:111], v[44:47], v[252:255], v[108:111]
    ds_write_b64 v70, v[100:101] offset:33664
    v_mov_b64 v[36:37], s[80:81]
    s_nop 1
    v_mov_b64 v[38:39], s[82:83]
    v_mov_b64 v[40:41], s[80:81]
    v_mov_b64 v[42:43], s[82:83]
    v_mov_b64 v[44:45], s[80:81]
    v_mov_b64 v[46:47], s[82:83]
    s_nop 4
    v_cvt_pk_bf16_f32 v104, v104, v105
    v_cvt_pk_bf16_f32 v105, v106, v107
    ds_write_b64 v71, v[104:105] offset:768
    v_cvt_pk_bf16_f32 v108, v108, v109
    v_cvt_pk_bf16_f32 v109, v110, v111
    ds_write_b64 v71, v[108:109] offset:896
    v_add_u32 v70, 0x18000, v70
standalone__deep_cross_pnn__recsys_kernel_k2j:
    s_mov_b32 s48, s12
    s_or_b32 s49, s13, 0x100000
    s_mov_b32 s50, s14
    s_mov_b32 s51, 0x00800000

    s_mov_b32 s22, 0
    s_mov_b32 s32, 0x8000
    s_mov_b32 s23, 1108378657
    s_mov_b64 exec, 2
    ds_write_b64 v69, v[66:67] offset:8064
    s_mov_b64 exec, -1
    s_mov_b32 s37, 0

    s_mov_b32 m0, 0
    s_waitcnt vmcnt(0) lgkmcnt(0)
    s_barrier

    v_lshlrev_b32_sdwa v88, 3, v116 dst_sel:DWORD dst_unused:UNUSED_PAD src0_sel:DWORD src1_sel:WORD_0
    v_lshlrev_b32_sdwa v90, 3, v116 dst_sel:DWORD dst_unused:UNUSED_PAD src0_sel:DWORD src1_sel:WORD_1
    v_lshlrev_b32_sdwa v92, 3, v117 dst_sel:DWORD dst_unused:UNUSED_PAD src0_sel:DWORD src1_sel:WORD_0
    v_lshlrev_b32_sdwa v94, 3, v117 dst_sel:DWORD dst_unused:UNUSED_PAD src0_sel:DWORD src1_sel:WORD_1
    ds_read_b64 v[88:89], v88
    ds_read_b64 v[90:91], v90
    ds_read_b64 v[92:93], v92
    ds_read_b64 v[94:95], v94
    v_lshlrev_b32_sdwa v96, 3, v118 dst_sel:DWORD dst_unused:UNUSED_PAD src0_sel:DWORD src1_sel:WORD_0
    v_lshlrev_b32_sdwa v98, 3, v118 dst_sel:DWORD dst_unused:UNUSED_PAD src0_sel:DWORD src1_sel:WORD_1
    v_lshlrev_b32_sdwa v100, 3, v119 dst_sel:DWORD dst_unused:UNUSED_PAD src0_sel:DWORD src1_sel:WORD_0
    v_lshlrev_b32_sdwa v102, 3, v119 dst_sel:DWORD dst_unused:UNUSED_PAD src0_sel:DWORD src1_sel:WORD_1
    ds_read_b64 v[96:97], v96
    ds_read_b64 v[98:99], v98
    ds_read_b64 v[100:101], v100
    ds_read_b64 v[102:103], v102
    buffer_load_dwordx4 v[116:119], off, s[48:51], s20 offset:3072 sc1
    s_add_u32 s20, s20, 4096
    s_bitcmp1_b32 s2, 1
    s_cselect_b32 s35, 0, 16
    s_lshl_b32 s28, s28, s35
    s_lshl_b32 s29, s29, s35
    s_lshl_b32 s30, s30, s35
    s_lshl_b32 s31, s31, s35
    s_and_b32 s28, s28, 0xffff0000
    s_and_b32 s29, s29, 0xffff0000
    s_and_b32 s30, s30, 0xffff0000
    s_and_b32 s31, s31, 0xffff0000
    s_cmp_ge_u32 s3, 4
    s_cbranch_scc1 standalone__deep_cross_pnn__recsys_kernel_k2x
    s_waitcnt lgkmcnt(0)
standalone__deep_cross_pnn__recsys_kernel_gloop:
    s_waitcnt vmcnt(6)
    v_lshlrev_b32_sdwa v104, 3, v120 dst_sel:DWORD dst_unused:UNUSED_PAD src0_sel:DWORD src1_sel:WORD_0
    v_lshlrev_b32_sdwa v106, 3, v120 dst_sel:DWORD dst_unused:UNUSED_PAD src0_sel:DWORD src1_sel:WORD_1
    ds_read_b64 v[104:105], v104
    ds_read_b64 v[106:107], v106
    v_lshlrev_b32_sdwa v108, 3, v121 dst_sel:DWORD dst_unused:UNUSED_PAD src0_sel:DWORD src1_sel:WORD_0
    v_lshlrev_b32_sdwa v110, 3, v121 dst_sel:DWORD dst_unused:UNUSED_PAD src0_sel:DWORD src1_sel:WORD_1
    ds_read_b64 v[108:109], v108
    ds_read_b64 v[110:111], v110
    s_waitcnt lgkmcnt(10)
    v_smfmac_f32_16x16x64_bf16 v[0:3], v[64:67], v[88:95], v68
    v_lshlrev_b32_sdwa v88, 3, v122 dst_sel:DWORD dst_unused:UNUSED_PAD src0_sel:DWORD src1_sel:WORD_0
    v_lshlrev_b32_sdwa v90, 3, v122 dst_sel:DWORD dst_unused:UNUSED_PAD src0_sel:DWORD src1_sel:WORD_1
    ds_read_b64 v[88:89], v88
    ds_read_b64 v[90:91], v90
    v_lshlrev_b32_sdwa v92, 3, v123 dst_sel:DWORD dst_unused:UNUSED_PAD src0_sel:DWORD src1_sel:WORD_0
    v_lshlrev_b32_sdwa v94, 3, v123 dst_sel:DWORD dst_unused:UNUSED_PAD src0_sel:DWORD src1_sel:WORD_1
    ds_read_b64 v[92:93], v92
    ds_read_addtid_b32 v71 offset:8080
    ds_read_b64 v[94:95], v94
    s_waitcnt lgkmcnt(9)
    v_smfmac_f32_16x16x64_bf16 v[4:7], v[64:67], v[96:103], v68
    buffer_load_dwordx4 v[120:123], off, s[48:51], s20 offset:0 sc1
    s_waitcnt vmcnt(6)
    v_mfma_f32_16x16x32_bf16 v[112:115], v[72:75], v[128:131], 0
    s_waitcnt vmcnt(5)
    v_lshlrev_b32_sdwa v96, 3, v124 dst_sel:DWORD dst_unused:UNUSED_PAD src0_sel:DWORD src1_sel:WORD_0
    v_lshlrev_b32_sdwa v98, 3, v124 dst_sel:DWORD dst_unused:UNUSED_PAD src0_sel:DWORD src1_sel:WORD_1
    ds_read_b64 v[96:97], v96
    ds_read_b64 v[98:99], v98
    s_waitcnt vmcnt(4)
    v_mfma_f32_16x16x32_bf16 v[112:115], v[76:79], v[132:135], v[112:115]
    v_lshlrev_b32_sdwa v100, 3, v125 dst_sel:DWORD dst_unused:UNUSED_PAD src0_sel:DWORD src1_sel:WORD_0
    v_lshlrev_b32_sdwa v102, 3, v125 dst_sel:DWORD dst_unused:UNUSED_PAD src0_sel:DWORD src1_sel:WORD_1
    ds_read_b64 v[100:101], v100
    ds_read_b64 v[102:103], v102
    s_waitcnt lgkmcnt(9)
    v_smfmac_f32_16x16x64_bf16 v[8:11], v[64:67], v[104:111], v68
    s_waitcnt vmcnt(3)
    v_mfma_f32_16x16x32_bf16 v[112:115], v[80:83], v[136:139], v[112:115]
    v_lshlrev_b32_sdwa v104, 3, v126 dst_sel:DWORD dst_unused:UNUSED_PAD src0_sel:DWORD src1_sel:WORD_0
    v_lshlrev_b32_sdwa v106, 3, v126 dst_sel:DWORD dst_unused:UNUSED_PAD src0_sel:DWORD src1_sel:WORD_1
    ds_read_b64 v[104:105], v104
    ds_read_b64 v[106:107], v106
    s_waitcnt vmcnt(2)
    v_mfma_f32_16x16x32_bf16 v[112:115], v[84:87], v[140:143], v[112:115]
    v_lshlrev_b32_sdwa v108, 3, v127 dst_sel:DWORD dst_unused:UNUSED_PAD src0_sel:DWORD src1_sel:WORD_0
    v_lshlrev_b32_sdwa v110, 3, v127 dst_sel:DWORD dst_unused:UNUSED_PAD src0_sel:DWORD src1_sel:WORD_1
    ds_read_b64 v[108:109], v108
    ds_read_b64 v[110:111], v110
    s_waitcnt lgkmcnt(8)
    v_smfmac_f32_16x16x64_bf16 v[12:15], v[64:67], v[88:95], v68
    buffer_load_dwordx4 v[124:127], off, s[48:51], s20 offset:1024 sc1
    v_readfirstlane_b32 s36, v71
    v_cvt_pk_bf16_f32 v112, v112, v113
    v_cvt_pk_bf16_f32 v113, v114, v115
    s_cmp_lt_u32 s36, s37
    s_cbranch_scc1 standalone__deep_cross_pnn__recsys_kernel_sp0
standalone__deep_cross_pnn__recsys_kernel_sr0:
    s_add_u32 s37, s37, 512
    ds_write_b64 v70, v[112:113] offset:0
    v_mfma_f32_16x16x32_bf16 v[112:115], v[72:75], v[144:147], 0
    v_mfma_f32_16x16x32_bf16 v[112:115], v[76:79], v[148:151], v[112:115]
    s_waitcnt vmcnt(2)
    v_lshlrev_b32_sdwa v88, 3, v116 dst_sel:DWORD dst_unused:UNUSED_PAD src0_sel:DWORD src1_sel:WORD_0
    v_lshlrev_b32_sdwa v90, 3, v116 dst_sel:DWORD dst_unused:UNUSED_PAD src0_sel:DWORD src1_sel:WORD_1
    ds_read_b64 v[88:89], v88
    ds_read_b64 v[90:91], v90
    v_mfma_f32_16x16x32_bf16 v[112:115], v[80:83], v[152:155], v[112:115]
    v_mfma_f32_16x16x32_bf16 v[112:115], v[84:87], v[156:159], v[112:115]
    v_lshlrev_b32_sdwa v92, 3, v117 dst_sel:DWORD dst_unused:UNUSED_PAD src0_sel:DWORD src1_sel:WORD_0
    v_lshlrev_b32_sdwa v94, 3, v117 dst_sel:DWORD dst_unused:UNUSED_PAD src0_sel:DWORD src1_sel:WORD_1
    ds_read_b64 v[92:93], v92
    ds_read_b64 v[94:95], v94
    s_waitcnt lgkmcnt(9)
    v_smfmac_f32_16x16x64_bf16 v[16:19], v[64:67], v[96:103], v68
    s_nop 1
    v_cvt_pk_bf16_f32 v112, v112, v113
    v_cvt_pk_bf16_f32 v113, v114, v115
    ds_write_b64 v70, v[112:113] offset:128
    v_mfma_f32_16x16x32_bf16 v[112:115], v[72:75], v[160:163], 0
    v_lshlrev_b32_sdwa v96, 3, v118 dst_sel:DWORD dst_unused:UNUSED_PAD src0_sel:DWORD src1_sel:WORD_0
    v_lshlrev_b32_sdwa v98, 3, v118 dst_sel:DWORD dst_unused:UNUSED_PAD src0_sel:DWORD src1_sel:WORD_1
    ds_read_b64 v[96:97], v96
    ds_read_b64 v[98:99], v98
    v_mfma_f32_16x16x32_bf16 v[112:115], v[76:79], v[164:167], v[112:115]
    v_lshlrev_b32_sdwa v100, 3, v119 dst_sel:DWORD dst_unused:UNUSED_PAD src0_sel:DWORD src1_sel:WORD_0
    v_lshlrev_b32_sdwa v102, 3, v119 dst_sel:DWORD dst_unused:UNUSED_PAD src0_sel:DWORD src1_sel:WORD_1
    ds_read_b64 v[100:101], v100
    ds_read_b64 v[102:103], v102
    s_waitcnt lgkmcnt(10)
    v_smfmac_f32_16x16x64_bf16 v[20:23], v[64:67], v[104:111], v68
    buffer_load_dwordx4 v[116:119], off, s[48:51], s20 offset:2048 sc1
    s_setprio 2
    v_mfma_f32_16x16x32_bf16 v[112:115], v[80:83], v[168:171], v[112:115]
    s_waitcnt vmcnt(2)
    v_lshlrev_b32_sdwa v104, 3, v120 dst_sel:DWORD dst_unused:UNUSED_PAD src0_sel:DWORD src1_sel:WORD_0
    v_lshlrev_b32_sdwa v106, 3, v120 dst_sel:DWORD dst_unused:UNUSED_PAD src0_sel:DWORD src1_sel:WORD_1
    ds_read_b64 v[104:105], v104
    ds_read_b64 v[106:107], v106
    v_mfma_f32_16x16x32_bf16 v[112:115], v[84:87], v[172:175], v[112:115]
    v_lshlrev_b32_sdwa v108, 3, v121 dst_sel:DWORD dst_unused:UNUSED_PAD src0_sel:DWORD src1_sel:WORD_0
    v_lshlrev_b32_sdwa v110, 3, v121 dst_sel:DWORD dst_unused:UNUSED_PAD src0_sel:DWORD src1_sel:WORD_1
    ds_read_b64 v[108:109], v108
    ds_read_b64 v[110:111], v110
    s_waitcnt lgkmcnt(9)
    v_smfmac_f32_16x16x64_bf16 v[24:27], v[64:67], v[88:95], v68
    s_nop 1
    v_cvt_pk_bf16_f32 v112, v112, v113
    v_cvt_pk_bf16_f32 v113, v114, v115
    ds_write_b64 v70, v[112:113] offset:256
    v_mfma_f32_16x16x32_bf16 v[112:115], v[72:75], v[176:179], 0
    v_mfma_f32_16x16x32_bf16 v[112:115], v[76:79], v[180:183], v[112:115]
    v_lshlrev_b32_sdwa v88, 3, v122 dst_sel:DWORD dst_unused:UNUSED_PAD src0_sel:DWORD src1_sel:WORD_0
    v_lshlrev_b32_sdwa v90, 3, v122 dst_sel:DWORD dst_unused:UNUSED_PAD src0_sel:DWORD src1_sel:WORD_1
    ds_read_b64 v[88:89], v88
    ds_read_b64 v[90:91], v90
    v_mfma_f32_16x16x32_bf16 v[112:115], v[80:83], v[184:187], v[112:115]
    v_mfma_f32_16x16x32_bf16 v[112:115], v[84:87], v[188:191], v[112:115]
    v_lshlrev_b32_sdwa v92, 3, v123 dst_sel:DWORD dst_unused:UNUSED_PAD src0_sel:DWORD src1_sel:WORD_0
    v_lshlrev_b32_sdwa v94, 3, v123 dst_sel:DWORD dst_unused:UNUSED_PAD src0_sel:DWORD src1_sel:WORD_1
    ds_read_b64 v[92:93], v92
    ds_read_b64 v[94:95], v94
    s_waitcnt lgkmcnt(9)
    v_smfmac_f32_16x16x64_bf16 v[28:31], v[64:67], v[96:103], v68
    buffer_load_dwordx4 v[120:123], off, s[48:51], s20 offset:3072 sc1
    s_add_u32 s20, s20, 61440
    v_cvt_pk_bf16_f32 v112, v112, v113
    v_cvt_pk_bf16_f32 v113, v114, v115
    ds_write_b64 v70, v[112:113] offset:384
    v_mfma_f32_16x16x32_bf16 v[112:115], v[72:75], v[192:195], 0
    s_waitcnt vmcnt(2)
    v_lshlrev_b32_sdwa v96, 3, v124 dst_sel:DWORD dst_unused:UNUSED_PAD src0_sel:DWORD src1_sel:WORD_0
    v_lshlrev_b32_sdwa v98, 3, v124 dst_sel:DWORD dst_unused:UNUSED_PAD src0_sel:DWORD src1_sel:WORD_1
    ds_read_b64 v[96:97], v96
    ds_read_b64 v[98:99], v98
    v_mfma_f32_16x16x32_bf16 v[112:115], v[76:79], v[196:199], v[112:115]
    v_lshlrev_b32_sdwa v100, 3, v125 dst_sel:DWORD dst_unused:UNUSED_PAD src0_sel:DWORD src1_sel:WORD_0
    v_lshlrev_b32_sdwa v102, 3, v125 dst_sel:DWORD dst_unused:UNUSED_PAD src0_sel:DWORD src1_sel:WORD_1
    ds_read_b64 v[100:101], v100
    ds_read_b64 v[102:103], v102
    s_waitcnt lgkmcnt(10)
    v_smfmac_f32_16x16x64_bf16 v[32:35], v[64:67], v[104:111], v68
    s_setprio 3
    v_lshlrev_b32_sdwa v104, 3, v126 dst_sel:DWORD dst_unused:UNUSED_PAD src0_sel:DWORD src1_sel:WORD_0
    v_lshlrev_b32_sdwa v106, 3, v126 dst_sel:DWORD dst_unused:UNUSED_PAD src0_sel:DWORD src1_sel:WORD_1
    v_mfma_f32_16x16x32_bf16 v[112:115], v[80:83], v[200:203], v[112:115]
    ds_read_b64 v[104:105], v104
    ds_read_b64 v[106:107], v106
    v_mfma_f32_16x16x32_bf16 v[112:115], v[84:87], v[204:207], v[112:115]
    v_lshlrev_b32_sdwa v108, 3, v127 dst_sel:DWORD dst_unused:UNUSED_PAD src0_sel:DWORD src1_sel:WORD_0
    v_lshlrev_b32_sdwa v110, 3, v127 dst_sel:DWORD dst_unused:UNUSED_PAD src0_sel:DWORD src1_sel:WORD_1
    buffer_load_dwordx4 v[124:127], off, s[48:51], s20 offset:0 sc1
    ds_read_b64 v[108:109], v108
    ds_read_b64 v[110:111], v110
    s_waitcnt lgkmcnt(9)
    v_smfmac_f32_16x16x64_bf16 v[36:39], v[64:67], v[88:95], v68
    s_nop 0
    v_cvt_pk_bf16_f32 v112, v112, v113
    v_cvt_pk_bf16_f32 v113, v114, v115
    ds_write_b64 v70, v[112:113] offset:512
    v_mfma_f32_16x16x32_bf16 v[112:115], v[72:75], v[208:211], 0
    v_mfma_f32_16x16x32_bf16 v[112:115], v[76:79], v[212:215], v[112:115]
    s_waitcnt vmcnt(2)
    v_lshlrev_b32_sdwa v88, 3, v116 dst_sel:DWORD dst_unused:UNUSED_PAD src0_sel:DWORD src1_sel:WORD_0
    v_lshlrev_b32_sdwa v90, 3, v116 dst_sel:DWORD dst_unused:UNUSED_PAD src0_sel:DWORD src1_sel:WORD_1
    ds_read_b64 v[88:89], v88
    ds_read_b64 v[90:91], v90
    v_mfma_f32_16x16x32_bf16 v[112:115], v[80:83], v[216:219], v[112:115]
    v_mfma_f32_16x16x32_bf16 v[112:115], v[84:87], v[220:223], v[112:115]
    v_lshlrev_b32_sdwa v92, 3, v117 dst_sel:DWORD dst_unused:UNUSED_PAD src0_sel:DWORD src1_sel:WORD_0
    v_lshlrev_b32_sdwa v94, 3, v117 dst_sel:DWORD dst_unused:UNUSED_PAD src0_sel:DWORD src1_sel:WORD_1
    ds_read_b64 v[92:93], v92
    ds_read_b64 v[94:95], v94
    s_waitcnt lgkmcnt(9)
    v_smfmac_f32_16x16x64_bf16 v[40:43], v[64:67], v[96:103], v68
    s_nop 1
    v_cvt_pk_bf16_f32 v112, v112, v113
    v_cvt_pk_bf16_f32 v113, v114, v115
    ds_write_b64 v70, v[112:113] offset:640
    v_mfma_f32_16x16x32_bf16 v[112:115], v[72:75], v[224:227], 0
    v_lshlrev_b32_sdwa v96, 3, v118 dst_sel:DWORD dst_unused:UNUSED_PAD src0_sel:DWORD src1_sel:WORD_0
    v_lshlrev_b32_sdwa v98, 3, v118 dst_sel:DWORD dst_unused:UNUSED_PAD src0_sel:DWORD src1_sel:WORD_1
    ds_read_b64 v[96:97], v96
    ds_read_b64 v[98:99], v98
    v_mfma_f32_16x16x32_bf16 v[112:115], v[76:79], v[228:231], v[112:115]
    v_lshlrev_b32_sdwa v100, 3, v119 dst_sel:DWORD dst_unused:UNUSED_PAD src0_sel:DWORD src1_sel:WORD_0
    v_lshlrev_b32_sdwa v102, 3, v119 dst_sel:DWORD dst_unused:UNUSED_PAD src0_sel:DWORD src1_sel:WORD_1
    ds_read_b64 v[100:101], v100
    ds_read_b64 v[102:103], v102
    s_waitcnt lgkmcnt(10)
    v_smfmac_f32_16x16x64_bf16 v[44:47], v[64:67], v[104:111], v68
    buffer_load_dwordx4 v[116:119], off, s[48:51], s20 offset:1024 sc1
    s_setprio 1
    s_waitcnt vmcnt(2)
    v_lshlrev_b32_sdwa v104, 3, v120 dst_sel:DWORD dst_unused:UNUSED_PAD src0_sel:DWORD src1_sel:WORD_0
    v_lshlrev_b32_sdwa v106, 3, v120 dst_sel:DWORD dst_unused:UNUSED_PAD src0_sel:DWORD src1_sel:WORD_1
    v_mfma_f32_16x16x32_bf16 v[112:115], v[80:83], v[232:235], v[112:115]
    ds_read_b64 v[104:105], v104
    ds_read_b64 v[106:107], v106
    v_lshlrev_b32_sdwa v108, 3, v121 dst_sel:DWORD dst_unused:UNUSED_PAD src0_sel:DWORD src1_sel:WORD_0
    v_lshlrev_b32_sdwa v110, 3, v121 dst_sel:DWORD dst_unused:UNUSED_PAD src0_sel:DWORD src1_sel:WORD_1
    v_mfma_f32_16x16x32_bf16 v[112:115], v[84:87], v[236:239], v[112:115]
    ds_read_b64 v[108:109], v108
    ds_read_b64 v[110:111], v110
    s_waitcnt lgkmcnt(9)
    v_smfmac_f32_16x16x64_bf16 v[48:51], v[64:67], v[88:95], v68
    v_lshlrev_b32_sdwa v88, 3, v122 dst_sel:DWORD dst_unused:UNUSED_PAD src0_sel:DWORD src1_sel:WORD_0
    v_lshlrev_b32_sdwa v90, 3, v122 dst_sel:DWORD dst_unused:UNUSED_PAD src0_sel:DWORD src1_sel:WORD_1
    s_nop 1
    v_cvt_pk_bf16_f32 v112, v112, v113
    v_cvt_pk_bf16_f32 v113, v114, v115
    ds_write_b64 v70, v[112:113] offset:768
    v_mfma_f32_16x16x32_bf16 v[112:115], v[72:75], v[240:243], 0
    buffer_load_dwordx4 v[72:75], off, s[48:51], s21 offset:0
    ds_read_b64 v[88:89], v88
    ds_read_b64 v[90:91], v90
    v_lshlrev_b32_sdwa v92, 3, v123 dst_sel:DWORD dst_unused:UNUSED_PAD src0_sel:DWORD src1_sel:WORD_0
    v_lshlrev_b32_sdwa v94, 3, v123 dst_sel:DWORD dst_unused:UNUSED_PAD src0_sel:DWORD src1_sel:WORD_1
    buffer_load_dwordx4 v[120:123], off, s[48:51], s20 offset:2048 sc1
    ds_read_b64 v[92:93], v92
    ds_read_b64 v[94:95], v94
    v_mfma_f32_16x16x32_bf16 v[112:115], v[76:79], v[244:247], v[112:115]
    buffer_load_dwordx4 v[76:79], off, s[48:51], s21 offset:1024
    s_waitcnt lgkmcnt(9)
    v_smfmac_f32_16x16x64_bf16 v[52:55], v[64:67], v[96:103], v68
    s_waitcnt vmcnt(4)
    v_lshlrev_b32_sdwa v96, 3, v124 dst_sel:DWORD dst_unused:UNUSED_PAD src0_sel:DWORD src1_sel:WORD_0
    v_lshlrev_b32_sdwa v98, 3, v124 dst_sel:DWORD dst_unused:UNUSED_PAD src0_sel:DWORD src1_sel:WORD_1
    ds_read_b64 v[96:97], v96
    ds_read_b64 v[98:99], v98
    v_mfma_f32_16x16x32_bf16 v[112:115], v[80:83], v[248:251], v[112:115]
    buffer_load_dwordx4 v[80:83], off, s[48:51], s19 offset:0
    v_lshlrev_b32_sdwa v100, 3, v125 dst_sel:DWORD dst_unused:UNUSED_PAD src0_sel:DWORD src1_sel:WORD_0
    v_lshlrev_b32_sdwa v102, 3, v125 dst_sel:DWORD dst_unused:UNUSED_PAD src0_sel:DWORD src1_sel:WORD_1
    v_mfma_f32_16x16x32_bf16 v[112:115], v[84:87], v[252:255], v[112:115]
    buffer_load_dwordx4 v[84:87], off, s[48:51], s19 offset:1024
    s_add_u32 s21, s21, 4096
    s_add_u32 s19, s19, 4096
    ds_read_b64 v[100:101], v100
    ds_read_b64 v[102:103], v102
    s_waitcnt lgkmcnt(9)
    v_smfmac_f32_16x16x64_bf16 v[56:59], v[64:67], v[104:111], v68
    s_setprio 0
    v_cvt_pk_bf16_f32 v112, v112, v113
    v_cvt_pk_bf16_f32 v113, v114, v115
    ds_write_b64 v70, v[112:113] offset:896
    ds_append v71 offset:8080
    s_add_u32 s23, s23, s23
    s_cselect_b32 s35, 4294836224, s32
    v_add_u32 v70, s35, v70
    v_lshlrev_b32_sdwa v104, 3, v126 dst_sel:DWORD dst_unused:UNUSED_PAD src0_sel:DWORD src1_sel:WORD_0
    v_lshlrev_b32_sdwa v106, 3, v126 dst_sel:DWORD dst_unused:UNUSED_PAD src0_sel:DWORD src1_sel:WORD_1
    ds_read_b64 v[104:105], v104
    ds_read_b64 v[106:107], v106
    v_lshlrev_b32_sdwa v108, 3, v127 dst_sel:DWORD dst_unused:UNUSED_PAD src0_sel:DWORD src1_sel:WORD_0
    v_lshlrev_b32_sdwa v110, 3, v127 dst_sel:DWORD dst_unused:UNUSED_PAD src0_sel:DWORD src1_sel:WORD_1
    buffer_load_dwordx4 v[124:127], off, s[48:51], s20 offset:3072 sc1
    s_add_u32 s20, s20, 4096
    ds_read_b64 v[108:109], v108
    ds_read_b64 v[110:111], v110
    s_waitcnt lgkmcnt(10)
    v_smfmac_f32_16x16x64_bf16 v[60:63], v[64:67], v[88:95], v68

    s_cmpk_eq_u32 s37, 11264
    s_cbranch_scc1 standalone__deep_cross_pnn__recsys_kernel_fin

    s_waitcnt vmcnt(6)
    v_lshlrev_b32_sdwa v88, 3, v116 dst_sel:DWORD dst_unused:UNUSED_PAD src0_sel:DWORD src1_sel:WORD_0
    v_lshlrev_b32_sdwa v90, 3, v116 dst_sel:DWORD dst_unused:UNUSED_PAD src0_sel:DWORD src1_sel:WORD_1
    ds_read_b64 v[88:89], v88
    ds_read_b64 v[90:91], v90
    v_lshlrev_b32_sdwa v92, 3, v117 dst_sel:DWORD dst_unused:UNUSED_PAD src0_sel:DWORD src1_sel:WORD_0
    v_lshlrev_b32_sdwa v94, 3, v117 dst_sel:DWORD dst_unused:UNUSED_PAD src0_sel:DWORD src1_sel:WORD_1
    ds_read_b64 v[92:93], v92
    ds_read_b64 v[94:95], v94
    s_waitcnt lgkmcnt(10)
    v_smfmac_f32_16x16x64_bf16 v[0:3], v[64:67], v[96:103], v68
    v_lshlrev_b32_sdwa v96, 3, v118 dst_sel:DWORD dst_unused:UNUSED_PAD src0_sel:DWORD src1_sel:WORD_0
    v_lshlrev_b32_sdwa v98, 3, v118 dst_sel:DWORD dst_unused:UNUSED_PAD src0_sel:DWORD src1_sel:WORD_1
    ds_read_b64 v[96:97], v96
    ds_read_b64 v[98:99], v98
    v_lshlrev_b32_sdwa v100, 3, v119 dst_sel:DWORD dst_unused:UNUSED_PAD src0_sel:DWORD src1_sel:WORD_0
    v_lshlrev_b32_sdwa v102, 3, v119 dst_sel:DWORD dst_unused:UNUSED_PAD src0_sel:DWORD src1_sel:WORD_1
    ds_read_b64 v[100:101], v100
    ds_read_addtid_b32 v71 offset:8080
    ds_read_b64 v[102:103], v102
    s_waitcnt lgkmcnt(9)
    v_smfmac_f32_16x16x64_bf16 v[4:7], v[64:67], v[104:111], v68
    buffer_load_dwordx4 v[116:119], off, s[48:51], s20 offset:0 sc1
    s_waitcnt vmcnt(6)
    v_mfma_f32_16x16x32_bf16 v[112:115], v[72:75], v[128:131], 0
    s_waitcnt vmcnt(5)
    v_lshlrev_b32_sdwa v104, 3, v120 dst_sel:DWORD dst_unused:UNUSED_PAD src0_sel:DWORD src1_sel:WORD_0
    v_lshlrev_b32_sdwa v106, 3, v120 dst_sel:DWORD dst_unused:UNUSED_PAD src0_sel:DWORD src1_sel:WORD_1
    ds_read_b64 v[104:105], v104
    ds_read_b64 v[106:107], v106
    s_waitcnt vmcnt(4)
    v_mfma_f32_16x16x32_bf16 v[112:115], v[76:79], v[132:135], v[112:115]
    v_lshlrev_b32_sdwa v108, 3, v121 dst_sel:DWORD dst_unused:UNUSED_PAD src0_sel:DWORD src1_sel:WORD_0
    v_lshlrev_b32_sdwa v110, 3, v121 dst_sel:DWORD dst_unused:UNUSED_PAD src0_sel:DWORD src1_sel:WORD_1
    ds_read_b64 v[108:109], v108
    ds_read_b64 v[110:111], v110
    s_waitcnt lgkmcnt(9)
    v_smfmac_f32_16x16x64_bf16 v[8:11], v[64:67], v[88:95], v68
    s_waitcnt vmcnt(3)
    v_mfma_f32_16x16x32_bf16 v[112:115], v[80:83], v[136:139], v[112:115]
    v_lshlrev_b32_sdwa v88, 3, v122 dst_sel:DWORD dst_unused:UNUSED_PAD src0_sel:DWORD src1_sel:WORD_0
    v_lshlrev_b32_sdwa v90, 3, v122 dst_sel:DWORD dst_unused:UNUSED_PAD src0_sel:DWORD src1_sel:WORD_1
    ds_read_b64 v[88:89], v88
    ds_read_b64 v[90:91], v90
    s_waitcnt vmcnt(2)
    v_mfma_f32_16x16x32_bf16 v[112:115], v[84:87], v[140:143], v[112:115]
    v_lshlrev_b32_sdwa v92, 3, v123 dst_sel:DWORD dst_unused:UNUSED_PAD src0_sel:DWORD src1_sel:WORD_0
    v_lshlrev_b32_sdwa v94, 3, v123 dst_sel:DWORD dst_unused:UNUSED_PAD src0_sel:DWORD src1_sel:WORD_1
    ds_read_b64 v[92:93], v92
    ds_read_b64 v[94:95], v94
    s_waitcnt lgkmcnt(8)
    v_smfmac_f32_16x16x64_bf16 v[12:15], v[64:67], v[96:103], v68
    buffer_load_dwordx4 v[120:123], off, s[48:51], s20 offset:1024 sc1
    v_readfirstlane_b32 s36, v71
    v_cvt_pk_bf16_f32 v112, v112, v113
    v_cvt_pk_bf16_f32 v113, v114, v115
    s_cmp_lt_u32 s36, s37
    s_cbranch_scc1 standalone__deep_cross_pnn__recsys_kernel_sp1
standalone__deep_cross_pnn__recsys_kernel_sr1:
    s_add_u32 s37, s37, 512
    ds_write_b64 v70, v[112:113] offset:0
    v_mfma_f32_16x16x32_bf16 v[112:115], v[72:75], v[144:147], 0
    v_mfma_f32_16x16x32_bf16 v[112:115], v[76:79], v[148:151], v[112:115]
    s_waitcnt vmcnt(2)
    v_lshlrev_b32_sdwa v96, 3, v124 dst_sel:DWORD dst_unused:UNUSED_PAD src0_sel:DWORD src1_sel:WORD_0
    v_lshlrev_b32_sdwa v98, 3, v124 dst_sel:DWORD dst_unused:UNUSED_PAD src0_sel:DWORD src1_sel:WORD_1
    ds_read_b64 v[96:97], v96
    ds_read_b64 v[98:99], v98
    v_mfma_f32_16x16x32_bf16 v[112:115], v[80:83], v[152:155], v[112:115]
    v_mfma_f32_16x16x32_bf16 v[112:115], v[84:87], v[156:159], v[112:115]
    v_lshlrev_b32_sdwa v100, 3, v125 dst_sel:DWORD dst_unused:UNUSED_PAD src0_sel:DWORD src1_sel:WORD_0
    v_lshlrev_b32_sdwa v102, 3, v125 dst_sel:DWORD dst_unused:UNUSED_PAD src0_sel:DWORD src1_sel:WORD_1
    ds_read_b64 v[100:101], v100
    ds_read_b64 v[102:103], v102
    s_waitcnt lgkmcnt(9)
    v_smfmac_f32_16x16x64_bf16 v[16:19], v[64:67], v[104:111], v68
    s_nop 1
    v_cvt_pk_bf16_f32 v112, v112, v113
    v_cvt_pk_bf16_f32 v113, v114, v115
    ds_write_b64 v70, v[112:113] offset:128
    v_mfma_f32_16x16x32_bf16 v[112:115], v[72:75], v[160:163], 0
    v_lshlrev_b32_sdwa v104, 3, v126 dst_sel:DWORD dst_unused:UNUSED_PAD src0_sel:DWORD src1_sel:WORD_0
    v_lshlrev_b32_sdwa v106, 3, v126 dst_sel:DWORD dst_unused:UNUSED_PAD src0_sel:DWORD src1_sel:WORD_1
    ds_read_b64 v[104:105], v104
    ds_read_b64 v[106:107], v106
    v_mfma_f32_16x16x32_bf16 v[112:115], v[76:79], v[164:167], v[112:115]
    v_lshlrev_b32_sdwa v108, 3, v127 dst_sel:DWORD dst_unused:UNUSED_PAD src0_sel:DWORD src1_sel:WORD_0
    v_lshlrev_b32_sdwa v110, 3, v127 dst_sel:DWORD dst_unused:UNUSED_PAD src0_sel:DWORD src1_sel:WORD_1
    ds_read_b64 v[108:109], v108
    ds_read_b64 v[110:111], v110
    s_waitcnt lgkmcnt(10)
    v_smfmac_f32_16x16x64_bf16 v[20:23], v[64:67], v[88:95], v68
    buffer_load_dwordx4 v[124:127], off, s[48:51], s20 offset:2048 sc1
    s_setprio 2
    v_mfma_f32_16x16x32_bf16 v[112:115], v[80:83], v[168:171], v[112:115]
    s_waitcnt vmcnt(2)
    v_lshlrev_b32_sdwa v88, 3, v116 dst_sel:DWORD dst_unused:UNUSED_PAD src0_sel:DWORD src1_sel:WORD_0
    v_lshlrev_b32_sdwa v90, 3, v116 dst_sel:DWORD dst_unused:UNUSED_PAD src0_sel:DWORD src1_sel:WORD_1
    ds_read_b64 v[88:89], v88
    ds_read_b64 v[90:91], v90
    v_mfma_f32_16x16x32_bf16 v[112:115], v[84:87], v[172:175], v[112:115]
    v_lshlrev_b32_sdwa v92, 3, v117 dst_sel:DWORD dst_unused:UNUSED_PAD src0_sel:DWORD src1_sel:WORD_0
    v_lshlrev_b32_sdwa v94, 3, v117 dst_sel:DWORD dst_unused:UNUSED_PAD src0_sel:DWORD src1_sel:WORD_1
    ds_read_b64 v[92:93], v92
    ds_read_b64 v[94:95], v94
    s_waitcnt lgkmcnt(9)
    v_smfmac_f32_16x16x64_bf16 v[24:27], v[64:67], v[96:103], v68
    s_nop 1
    v_cvt_pk_bf16_f32 v112, v112, v113
    v_cvt_pk_bf16_f32 v113, v114, v115
    ds_write_b64 v70, v[112:113] offset:256
    v_mfma_f32_16x16x32_bf16 v[112:115], v[72:75], v[176:179], 0
    v_mfma_f32_16x16x32_bf16 v[112:115], v[76:79], v[180:183], v[112:115]
    v_lshlrev_b32_sdwa v96, 3, v118 dst_sel:DWORD dst_unused:UNUSED_PAD src0_sel:DWORD src1_sel:WORD_0
    v_lshlrev_b32_sdwa v98, 3, v118 dst_sel:DWORD dst_unused:UNUSED_PAD src0_sel:DWORD src1_sel:WORD_1
    ds_read_b64 v[96:97], v96
    ds_read_b64 v[98:99], v98
    v_mfma_f32_16x16x32_bf16 v[112:115], v[80:83], v[184:187], v[112:115]
    v_mfma_f32_16x16x32_bf16 v[112:115], v[84:87], v[188:191], v[112:115]
    v_lshlrev_b32_sdwa v100, 3, v119 dst_sel:DWORD dst_unused:UNUSED_PAD src0_sel:DWORD src1_sel:WORD_0
    v_lshlrev_b32_sdwa v102, 3, v119 dst_sel:DWORD dst_unused:UNUSED_PAD src0_sel:DWORD src1_sel:WORD_1
    ds_read_b64 v[100:101], v100
    ds_read_b64 v[102:103], v102
    s_waitcnt lgkmcnt(9)
    v_smfmac_f32_16x16x64_bf16 v[28:31], v[64:67], v[104:111], v68
    buffer_load_dwordx4 v[116:119], off, s[48:51], s20 offset:3072 sc1
    s_add_u32 s20, s20, 61440
    v_cvt_pk_bf16_f32 v112, v112, v113
    v_cvt_pk_bf16_f32 v113, v114, v115
    ds_write_b64 v70, v[112:113] offset:384
    v_mfma_f32_16x16x32_bf16 v[112:115], v[72:75], v[192:195], 0
    s_waitcnt vmcnt(2)
    v_lshlrev_b32_sdwa v104, 3, v120 dst_sel:DWORD dst_unused:UNUSED_PAD src0_sel:DWORD src1_sel:WORD_0
    v_lshlrev_b32_sdwa v106, 3, v120 dst_sel:DWORD dst_unused:UNUSED_PAD src0_sel:DWORD src1_sel:WORD_1
    ds_read_b64 v[104:105], v104
    ds_read_b64 v[106:107], v106
    v_mfma_f32_16x16x32_bf16 v[112:115], v[76:79], v[196:199], v[112:115]
    v_lshlrev_b32_sdwa v108, 3, v121 dst_sel:DWORD dst_unused:UNUSED_PAD src0_sel:DWORD src1_sel:WORD_0
    v_lshlrev_b32_sdwa v110, 3, v121 dst_sel:DWORD dst_unused:UNUSED_PAD src0_sel:DWORD src1_sel:WORD_1
    ds_read_b64 v[108:109], v108
    ds_read_b64 v[110:111], v110
    s_waitcnt lgkmcnt(10)
    v_smfmac_f32_16x16x64_bf16 v[32:35], v[64:67], v[88:95], v68
    s_setprio 3
    v_lshlrev_b32_sdwa v88, 3, v122 dst_sel:DWORD dst_unused:UNUSED_PAD src0_sel:DWORD src1_sel:WORD_0
    v_lshlrev_b32_sdwa v90, 3, v122 dst_sel:DWORD dst_unused:UNUSED_PAD src0_sel:DWORD src1_sel:WORD_1
    v_mfma_f32_16x16x32_bf16 v[112:115], v[80:83], v[200:203], v[112:115]
    ds_read_b64 v[88:89], v88
    ds_read_b64 v[90:91], v90
    v_mfma_f32_16x16x32_bf16 v[112:115], v[84:87], v[204:207], v[112:115]
    v_lshlrev_b32_sdwa v92, 3, v123 dst_sel:DWORD dst_unused:UNUSED_PAD src0_sel:DWORD src1_sel:WORD_0
    v_lshlrev_b32_sdwa v94, 3, v123 dst_sel:DWORD dst_unused:UNUSED_PAD src0_sel:DWORD src1_sel:WORD_1
    buffer_load_dwordx4 v[120:123], off, s[48:51], s20 offset:0 sc1
    ds_read_b64 v[92:93], v92
    ds_read_b64 v[94:95], v94
    s_waitcnt lgkmcnt(9)
    v_smfmac_f32_16x16x64_bf16 v[36:39], v[64:67], v[96:103], v68
    s_nop 0
    v_cvt_pk_bf16_f32 v112, v112, v113
    v_cvt_pk_bf16_f32 v113, v114, v115
    ds_write_b64 v70, v[112:113] offset:512
    v_mfma_f32_16x16x32_bf16 v[112:115], v[72:75], v[208:211], 0
    v_mfma_f32_16x16x32_bf16 v[112:115], v[76:79], v[212:215], v[112:115]
    s_waitcnt vmcnt(2)
    v_lshlrev_b32_sdwa v96, 3, v124 dst_sel:DWORD dst_unused:UNUSED_PAD src0_sel:DWORD src1_sel:WORD_0
    v_lshlrev_b32_sdwa v98, 3, v124 dst_sel:DWORD dst_unused:UNUSED_PAD src0_sel:DWORD src1_sel:WORD_1
    ds_read_b64 v[96:97], v96
    ds_read_b64 v[98:99], v98
    v_mfma_f32_16x16x32_bf16 v[112:115], v[80:83], v[216:219], v[112:115]
    v_mfma_f32_16x16x32_bf16 v[112:115], v[84:87], v[220:223], v[112:115]
    v_lshlrev_b32_sdwa v100, 3, v125 dst_sel:DWORD dst_unused:UNUSED_PAD src0_sel:DWORD src1_sel:WORD_0
    v_lshlrev_b32_sdwa v102, 3, v125 dst_sel:DWORD dst_unused:UNUSED_PAD src0_sel:DWORD src1_sel:WORD_1
    ds_read_b64 v[100:101], v100
    ds_read_b64 v[102:103], v102
    s_waitcnt lgkmcnt(9)
    v_smfmac_f32_16x16x64_bf16 v[40:43], v[64:67], v[104:111], v68
    s_nop 1
    v_cvt_pk_bf16_f32 v112, v112, v113
    v_cvt_pk_bf16_f32 v113, v114, v115
    ds_write_b64 v70, v[112:113] offset:640
    v_mfma_f32_16x16x32_bf16 v[112:115], v[72:75], v[224:227], 0
    v_lshlrev_b32_sdwa v104, 3, v126 dst_sel:DWORD dst_unused:UNUSED_PAD src0_sel:DWORD src1_sel:WORD_0
    v_lshlrev_b32_sdwa v106, 3, v126 dst_sel:DWORD dst_unused:UNUSED_PAD src0_sel:DWORD src1_sel:WORD_1
    ds_read_b64 v[104:105], v104
    ds_read_b64 v[106:107], v106
    v_mfma_f32_16x16x32_bf16 v[112:115], v[76:79], v[228:231], v[112:115]
    v_lshlrev_b32_sdwa v108, 3, v127 dst_sel:DWORD dst_unused:UNUSED_PAD src0_sel:DWORD src1_sel:WORD_0
    v_lshlrev_b32_sdwa v110, 3, v127 dst_sel:DWORD dst_unused:UNUSED_PAD src0_sel:DWORD src1_sel:WORD_1
    ds_read_b64 v[108:109], v108
    ds_read_b64 v[110:111], v110
    s_waitcnt lgkmcnt(10)
    v_smfmac_f32_16x16x64_bf16 v[44:47], v[64:67], v[88:95], v68
    buffer_load_dwordx4 v[124:127], off, s[48:51], s20 offset:1024 sc1
    s_setprio 1
    s_waitcnt vmcnt(2)
    v_lshlrev_b32_sdwa v88, 3, v116 dst_sel:DWORD dst_unused:UNUSED_PAD src0_sel:DWORD src1_sel:WORD_0
    v_lshlrev_b32_sdwa v90, 3, v116 dst_sel:DWORD dst_unused:UNUSED_PAD src0_sel:DWORD src1_sel:WORD_1
    v_mfma_f32_16x16x32_bf16 v[112:115], v[80:83], v[232:235], v[112:115]
    ds_read_b64 v[88:89], v88
    ds_read_b64 v[90:91], v90
    v_lshlrev_b32_sdwa v92, 3, v117 dst_sel:DWORD dst_unused:UNUSED_PAD src0_sel:DWORD src1_sel:WORD_0
    v_lshlrev_b32_sdwa v94, 3, v117 dst_sel:DWORD dst_unused:UNUSED_PAD src0_sel:DWORD src1_sel:WORD_1
    v_mfma_f32_16x16x32_bf16 v[112:115], v[84:87], v[236:239], v[112:115]
    ds_read_b64 v[92:93], v92
    ds_read_b64 v[94:95], v94
    s_waitcnt lgkmcnt(9)
    v_smfmac_f32_16x16x64_bf16 v[48:51], v[64:67], v[96:103], v68
    v_lshlrev_b32_sdwa v96, 3, v118 dst_sel:DWORD dst_unused:UNUSED_PAD src0_sel:DWORD src1_sel:WORD_0
    v_lshlrev_b32_sdwa v98, 3, v118 dst_sel:DWORD dst_unused:UNUSED_PAD src0_sel:DWORD src1_sel:WORD_1
    s_nop 1
    v_cvt_pk_bf16_f32 v112, v112, v113
    v_cvt_pk_bf16_f32 v113, v114, v115
    ds_write_b64 v70, v[112:113] offset:768
    v_mfma_f32_16x16x32_bf16 v[112:115], v[72:75], v[240:243], 0
    buffer_load_dwordx4 v[72:75], off, s[48:51], s21 offset:0
    ds_read_b64 v[96:97], v96
    ds_read_b64 v[98:99], v98
    v_lshlrev_b32_sdwa v100, 3, v119 dst_sel:DWORD dst_unused:UNUSED_PAD src0_sel:DWORD src1_sel:WORD_0
    v_lshlrev_b32_sdwa v102, 3, v119 dst_sel:DWORD dst_unused:UNUSED_PAD src0_sel:DWORD src1_sel:WORD_1
    buffer_load_dwordx4 v[116:119], off, s[48:51], s20 offset:2048 sc1
    ds_read_b64 v[100:101], v100
    ds_read_b64 v[102:103], v102
    v_mfma_f32_16x16x32_bf16 v[112:115], v[76:79], v[244:247], v[112:115]
    buffer_load_dwordx4 v[76:79], off, s[48:51], s21 offset:1024
    s_waitcnt lgkmcnt(9)
    v_smfmac_f32_16x16x64_bf16 v[52:55], v[64:67], v[104:111], v68
    s_waitcnt vmcnt(4)
    v_lshlrev_b32_sdwa v104, 3, v120 dst_sel:DWORD dst_unused:UNUSED_PAD src0_sel:DWORD src1_sel:WORD_0
    v_lshlrev_b32_sdwa v106, 3, v120 dst_sel:DWORD dst_unused:UNUSED_PAD src0_sel:DWORD src1_sel:WORD_1
    ds_read_b64 v[104:105], v104
    ds_read_b64 v[106:107], v106
    v_mfma_f32_16x16x32_bf16 v[112:115], v[80:83], v[248:251], v[112:115]
    buffer_load_dwordx4 v[80:83], off, s[48:51], s19 offset:0
    v_lshlrev_b32_sdwa v108, 3, v121 dst_sel:DWORD dst_unused:UNUSED_PAD src0_sel:DWORD src1_sel:WORD_0
    v_lshlrev_b32_sdwa v110, 3, v121 dst_sel:DWORD dst_unused:UNUSED_PAD src0_sel:DWORD src1_sel:WORD_1
    v_mfma_f32_16x16x32_bf16 v[112:115], v[84:87], v[252:255], v[112:115]
    buffer_load_dwordx4 v[84:87], off, s[48:51], s19 offset:1024
    s_add_u32 s21, s21, 4096
    s_add_u32 s19, s19, 4096
    ds_read_b64 v[108:109], v108
    ds_read_b64 v[110:111], v110
    s_waitcnt lgkmcnt(9)
    v_smfmac_f32_16x16x64_bf16 v[56:59], v[64:67], v[88:95], v68
    s_setprio 0
    v_cvt_pk_bf16_f32 v112, v112, v113
    v_cvt_pk_bf16_f32 v113, v114, v115
    ds_write_b64 v70, v[112:113] offset:896
    ds_append v71 offset:8080
    s_add_u32 s23, s23, s23
    s_cselect_b32 s35, 4294836224, s32
    v_add_u32 v70, s35, v70
    v_lshlrev_b32_sdwa v88, 3, v122 dst_sel:DWORD dst_unused:UNUSED_PAD src0_sel:DWORD src1_sel:WORD_0
    v_lshlrev_b32_sdwa v90, 3, v122 dst_sel:DWORD dst_unused:UNUSED_PAD src0_sel:DWORD src1_sel:WORD_1
    ds_read_b64 v[88:89], v88
    ds_read_b64 v[90:91], v90
    v_lshlrev_b32_sdwa v92, 3, v123 dst_sel:DWORD dst_unused:UNUSED_PAD src0_sel:DWORD src1_sel:WORD_0
    v_lshlrev_b32_sdwa v94, 3, v123 dst_sel:DWORD dst_unused:UNUSED_PAD src0_sel:DWORD src1_sel:WORD_1
    buffer_load_dwordx4 v[120:123], off, s[48:51], s20 offset:3072 sc1
    s_add_u32 s20, s20, 4096
    ds_read_b64 v[92:93], v92
    ds_read_b64 v[94:95], v94
    s_waitcnt lgkmcnt(10)
    v_smfmac_f32_16x16x64_bf16 v[60:63], v[64:67], v[96:103], v68
    s_waitcnt vmcnt(6)
    v_lshlrev_b32_sdwa v96, 3, v124 dst_sel:DWORD dst_unused:UNUSED_PAD src0_sel:DWORD src1_sel:WORD_0
    v_lshlrev_b32_sdwa v98, 3, v124 dst_sel:DWORD dst_unused:UNUSED_PAD src0_sel:DWORD src1_sel:WORD_1
    ds_read_b64 v[96:97], v96
    ds_read_b64 v[98:99], v98
    v_lshlrev_b32_sdwa v100, 3, v125 dst_sel:DWORD dst_unused:UNUSED_PAD src0_sel:DWORD src1_sel:WORD_0
    v_lshlrev_b32_sdwa v102, 3, v125 dst_sel:DWORD dst_unused:UNUSED_PAD src0_sel:DWORD src1_sel:WORD_1
    ds_read_b64 v[100:101], v100
    ds_read_b64 v[102:103], v102
    s_waitcnt lgkmcnt(10)
    v_smfmac_f32_16x16x64_bf16 v[0:3], v[64:67], v[104:111], v68
    v_lshlrev_b32_sdwa v104, 3, v126 dst_sel:DWORD dst_unused:UNUSED_PAD src0_sel:DWORD src1_sel:WORD_0
    v_lshlrev_b32_sdwa v106, 3, v126 dst_sel:DWORD dst_unused:UNUSED_PAD src0_sel:DWORD src1_sel:WORD_1
    ds_read_b64 v[104:105], v104
    ds_read_b64 v[106:107], v106
    v_lshlrev_b32_sdwa v108, 3, v127 dst_sel:DWORD dst_unused:UNUSED_PAD src0_sel:DWORD src1_sel:WORD_0
    v_lshlrev_b32_sdwa v110, 3, v127 dst_sel:DWORD dst_unused:UNUSED_PAD src0_sel:DWORD src1_sel:WORD_1
    ds_read_b64 v[108:109], v108
    ds_read_addtid_b32 v71 offset:8080
    ds_read_b64 v[110:111], v110
    s_waitcnt lgkmcnt(9)
    v_smfmac_f32_16x16x64_bf16 v[4:7], v[64:67], v[88:95], v68
    buffer_load_dwordx4 v[124:127], off, s[48:51], s20 offset:0 sc1
    s_waitcnt vmcnt(6)
    v_mfma_f32_16x16x32_bf16 v[112:115], v[72:75], v[128:131], 0
    s_waitcnt vmcnt(5)
    v_lshlrev_b32_sdwa v88, 3, v116 dst_sel:DWORD dst_unused:UNUSED_PAD src0_sel:DWORD src1_sel:WORD_0
    v_lshlrev_b32_sdwa v90, 3, v116 dst_sel:DWORD dst_unused:UNUSED_PAD src0_sel:DWORD src1_sel:WORD_1
    ds_read_b64 v[88:89], v88
    ds_read_b64 v[90:91], v90
    s_waitcnt vmcnt(4)
    v_mfma_f32_16x16x32_bf16 v[112:115], v[76:79], v[132:135], v[112:115]
    v_lshlrev_b32_sdwa v92, 3, v117 dst_sel:DWORD dst_unused:UNUSED_PAD src0_sel:DWORD src1_sel:WORD_0
    v_lshlrev_b32_sdwa v94, 3, v117 dst_sel:DWORD dst_unused:UNUSED_PAD src0_sel:DWORD src1_sel:WORD_1
    ds_read_b64 v[92:93], v92
    ds_read_b64 v[94:95], v94
    s_waitcnt lgkmcnt(9)
    v_smfmac_f32_16x16x64_bf16 v[8:11], v[64:67], v[96:103], v68
    s_waitcnt vmcnt(3)
    v_mfma_f32_16x16x32_bf16 v[112:115], v[80:83], v[136:139], v[112:115]
    v_lshlrev_b32_sdwa v96, 3, v118 dst_sel:DWORD dst_unused:UNUSED_PAD src0_sel:DWORD src1_sel:WORD_0
    v_lshlrev_b32_sdwa v98, 3, v118 dst_sel:DWORD dst_unused:UNUSED_PAD src0_sel:DWORD src1_sel:WORD_1
    ds_read_b64 v[96:97], v96
    ds_read_b64 v[98:99], v98
    s_waitcnt vmcnt(2)
    v_mfma_f32_16x16x32_bf16 v[112:115], v[84:87], v[140:143], v[112:115]
    v_lshlrev_b32_sdwa v100, 3, v119 dst_sel:DWORD dst_unused:UNUSED_PAD src0_sel:DWORD src1_sel:WORD_0
    v_lshlrev_b32_sdwa v102, 3, v119 dst_sel:DWORD dst_unused:UNUSED_PAD src0_sel:DWORD src1_sel:WORD_1
    ds_read_b64 v[100:101], v100
    ds_read_b64 v[102:103], v102
    s_waitcnt lgkmcnt(8)
    v_smfmac_f32_16x16x64_bf16 v[12:15], v[64:67], v[104:111], v68
    buffer_load_dwordx4 v[116:119], off, s[48:51], s20 offset:1024 sc1
    v_readfirstlane_b32 s36, v71
    v_cvt_pk_bf16_f32 v112, v112, v113
    v_cvt_pk_bf16_f32 v113, v114, v115
    s_cmp_lt_u32 s36, s37
    s_cbranch_scc1 standalone__deep_cross_pnn__recsys_kernel_sp2
standalone__deep_cross_pnn__recsys_kernel_sr2:
    s_add_u32 s37, s37, 512
    ds_write_b64 v70, v[112:113] offset:0
    v_mfma_f32_16x16x32_bf16 v[112:115], v[72:75], v[144:147], 0
    v_mfma_f32_16x16x32_bf16 v[112:115], v[76:79], v[148:151], v[112:115]
    s_waitcnt vmcnt(2)
    v_lshlrev_b32_sdwa v104, 3, v120 dst_sel:DWORD dst_unused:UNUSED_PAD src0_sel:DWORD src1_sel:WORD_0
    v_lshlrev_b32_sdwa v106, 3, v120 dst_sel:DWORD dst_unused:UNUSED_PAD src0_sel:DWORD src1_sel:WORD_1
    ds_read_b64 v[104:105], v104
    ds_read_b64 v[106:107], v106
    v_mfma_f32_16x16x32_bf16 v[112:115], v[80:83], v[152:155], v[112:115]
    v_mfma_f32_16x16x32_bf16 v[112:115], v[84:87], v[156:159], v[112:115]
    v_lshlrev_b32_sdwa v108, 3, v121 dst_sel:DWORD dst_unused:UNUSED_PAD src0_sel:DWORD src1_sel:WORD_0
    v_lshlrev_b32_sdwa v110, 3, v121 dst_sel:DWORD dst_unused:UNUSED_PAD src0_sel:DWORD src1_sel:WORD_1
    ds_read_b64 v[108:109], v108
    ds_read_b64 v[110:111], v110
    s_waitcnt lgkmcnt(9)
    v_smfmac_f32_16x16x64_bf16 v[16:19], v[64:67], v[88:95], v68
    s_nop 1
    v_cvt_pk_bf16_f32 v112, v112, v113
    v_cvt_pk_bf16_f32 v113, v114, v115
    ds_write_b64 v70, v[112:113] offset:128
    v_mfma_f32_16x16x32_bf16 v[112:115], v[72:75], v[160:163], 0
    v_lshlrev_b32_sdwa v88, 3, v122 dst_sel:DWORD dst_unused:UNUSED_PAD src0_sel:DWORD src1_sel:WORD_0
    v_lshlrev_b32_sdwa v90, 3, v122 dst_sel:DWORD dst_unused:UNUSED_PAD src0_sel:DWORD src1_sel:WORD_1
    ds_read_b64 v[88:89], v88
    ds_read_b64 v[90:91], v90
    v_mfma_f32_16x16x32_bf16 v[112:115], v[76:79], v[164:167], v[112:115]
    v_lshlrev_b32_sdwa v92, 3, v123 dst_sel:DWORD dst_unused:UNUSED_PAD src0_sel:DWORD src1_sel:WORD_0
    v_lshlrev_b32_sdwa v94, 3, v123 dst_sel:DWORD dst_unused:UNUSED_PAD src0_sel:DWORD src1_sel:WORD_1
    ds_read_b64 v[92:93], v92
    ds_read_b64 v[94:95], v94
    s_waitcnt lgkmcnt(10)
    v_smfmac_f32_16x16x64_bf16 v[20:23], v[64:67], v[96:103], v68
    buffer_load_dwordx4 v[120:123], off, s[48:51], s20 offset:2048 sc1
    s_setprio 2
    v_mfma_f32_16x16x32_bf16 v[112:115], v[80:83], v[168:171], v[112:115]
    s_waitcnt vmcnt(2)
    v_lshlrev_b32_sdwa v96, 3, v124 dst_sel:DWORD dst_unused:UNUSED_PAD src0_sel:DWORD src1_sel:WORD_0
    v_lshlrev_b32_sdwa v98, 3, v124 dst_sel:DWORD dst_unused:UNUSED_PAD src0_sel:DWORD src1_sel:WORD_1
    ds_read_b64 v[96:97], v96
    ds_read_b64 v[98:99], v98
    v_mfma_f32_16x16x32_bf16 v[112:115], v[84:87], v[172:175], v[112:115]
    v_lshlrev_b32_sdwa v100, 3, v125 dst_sel:DWORD dst_unused:UNUSED_PAD src0_sel:DWORD src1_sel:WORD_0
    v_lshlrev_b32_sdwa v102, 3, v125 dst_sel:DWORD dst_unused:UNUSED_PAD src0_sel:DWORD src1_sel:WORD_1
    ds_read_b64 v[100:101], v100
    ds_read_b64 v[102:103], v102
    s_waitcnt lgkmcnt(9)
    v_smfmac_f32_16x16x64_bf16 v[24:27], v[64:67], v[104:111], v68
    s_nop 1
    v_cvt_pk_bf16_f32 v112, v112, v113
    v_cvt_pk_bf16_f32 v113, v114, v115
    ds_write_b64 v70, v[112:113] offset:256
    v_mfma_f32_16x16x32_bf16 v[112:115], v[72:75], v[176:179], 0
    v_mfma_f32_16x16x32_bf16 v[112:115], v[76:79], v[180:183], v[112:115]
    v_lshlrev_b32_sdwa v104, 3, v126 dst_sel:DWORD dst_unused:UNUSED_PAD src0_sel:DWORD src1_sel:WORD_0
    v_lshlrev_b32_sdwa v106, 3, v126 dst_sel:DWORD dst_unused:UNUSED_PAD src0_sel:DWORD src1_sel:WORD_1
    ds_read_b64 v[104:105], v104
    ds_read_b64 v[106:107], v106
    v_mfma_f32_16x16x32_bf16 v[112:115], v[80:83], v[184:187], v[112:115]
    v_mfma_f32_16x16x32_bf16 v[112:115], v[84:87], v[188:191], v[112:115]
    v_lshlrev_b32_sdwa v108, 3, v127 dst_sel:DWORD dst_unused:UNUSED_PAD src0_sel:DWORD src1_sel:WORD_0
    v_lshlrev_b32_sdwa v110, 3, v127 dst_sel:DWORD dst_unused:UNUSED_PAD src0_sel:DWORD src1_sel:WORD_1
    ds_read_b64 v[108:109], v108
    ds_read_b64 v[110:111], v110
    s_waitcnt lgkmcnt(9)
    v_smfmac_f32_16x16x64_bf16 v[28:31], v[64:67], v[88:95], v68
    buffer_load_dwordx4 v[124:127], off, s[48:51], s20 offset:3072 sc1
    s_add_u32 s20, s20, 61440
    v_cvt_pk_bf16_f32 v112, v112, v113
    v_cvt_pk_bf16_f32 v113, v114, v115
    ds_write_b64 v70, v[112:113] offset:384
    v_mfma_f32_16x16x32_bf16 v[112:115], v[72:75], v[192:195], 0
    s_waitcnt vmcnt(2)
    v_lshlrev_b32_sdwa v88, 3, v116 dst_sel:DWORD dst_unused:UNUSED_PAD src0_sel:DWORD src1_sel:WORD_0
    v_lshlrev_b32_sdwa v90, 3, v116 dst_sel:DWORD dst_unused:UNUSED_PAD src0_sel:DWORD src1_sel:WORD_1
    ds_read_b64 v[88:89], v88
    ds_read_b64 v[90:91], v90
    v_mfma_f32_16x16x32_bf16 v[112:115], v[76:79], v[196:199], v[112:115]
    v_lshlrev_b32_sdwa v92, 3, v117 dst_sel:DWORD dst_unused:UNUSED_PAD src0_sel:DWORD src1_sel:WORD_0
    v_lshlrev_b32_sdwa v94, 3, v117 dst_sel:DWORD dst_unused:UNUSED_PAD src0_sel:DWORD src1_sel:WORD_1
    ds_read_b64 v[92:93], v92
    ds_read_b64 v[94:95], v94
    s_waitcnt lgkmcnt(10)
    v_smfmac_f32_16x16x64_bf16 v[32:35], v[64:67], v[96:103], v68
    s_setprio 3
    v_lshlrev_b32_sdwa v96, 3, v118 dst_sel:DWORD dst_unused:UNUSED_PAD src0_sel:DWORD src1_sel:WORD_0
    v_lshlrev_b32_sdwa v98, 3, v118 dst_sel:DWORD dst_unused:UNUSED_PAD src0_sel:DWORD src1_sel:WORD_1
    v_mfma_f32_16x16x32_bf16 v[112:115], v[80:83], v[200:203], v[112:115]
    ds_read_b64 v[96:97], v96
    ds_read_b64 v[98:99], v98
    v_mfma_f32_16x16x32_bf16 v[112:115], v[84:87], v[204:207], v[112:115]
    v_lshlrev_b32_sdwa v100, 3, v119 dst_sel:DWORD dst_unused:UNUSED_PAD src0_sel:DWORD src1_sel:WORD_0
    v_lshlrev_b32_sdwa v102, 3, v119 dst_sel:DWORD dst_unused:UNUSED_PAD src0_sel:DWORD src1_sel:WORD_1
    buffer_load_dwordx4 v[116:119], off, s[48:51], s20 offset:0 sc1
    ds_read_b64 v[100:101], v100
    ds_read_b64 v[102:103], v102
    s_waitcnt lgkmcnt(9)
    v_smfmac_f32_16x16x64_bf16 v[36:39], v[64:67], v[104:111], v68
    s_nop 0
    v_cvt_pk_bf16_f32 v112, v112, v113
    v_cvt_pk_bf16_f32 v113, v114, v115
    ds_write_b64 v70, v[112:113] offset:512
    v_mfma_f32_16x16x32_bf16 v[112:115], v[72:75], v[208:211], 0
    v_mfma_f32_16x16x32_bf16 v[112:115], v[76:79], v[212:215], v[112:115]
    s_waitcnt vmcnt(2)
    v_lshlrev_b32_sdwa v104, 3, v120 dst_sel:DWORD dst_unused:UNUSED_PAD src0_sel:DWORD src1_sel:WORD_0
    v_lshlrev_b32_sdwa v106, 3, v120 dst_sel:DWORD dst_unused:UNUSED_PAD src0_sel:DWORD src1_sel:WORD_1
    ds_read_b64 v[104:105], v104
    ds_read_b64 v[106:107], v106
    v_mfma_f32_16x16x32_bf16 v[112:115], v[80:83], v[216:219], v[112:115]
    v_mfma_f32_16x16x32_bf16 v[112:115], v[84:87], v[220:223], v[112:115]
    v_lshlrev_b32_sdwa v108, 3, v121 dst_sel:DWORD dst_unused:UNUSED_PAD src0_sel:DWORD src1_sel:WORD_0
    v_lshlrev_b32_sdwa v110, 3, v121 dst_sel:DWORD dst_unused:UNUSED_PAD src0_sel:DWORD src1_sel:WORD_1
    ds_read_b64 v[108:109], v108
    ds_read_b64 v[110:111], v110
    s_waitcnt lgkmcnt(9)
    v_smfmac_f32_16x16x64_bf16 v[40:43], v[64:67], v[88:95], v68
    s_nop 1
    v_cvt_pk_bf16_f32 v112, v112, v113
    v_cvt_pk_bf16_f32 v113, v114, v115
    ds_write_b64 v70, v[112:113] offset:640
    v_mfma_f32_16x16x32_bf16 v[112:115], v[72:75], v[224:227], 0
    v_lshlrev_b32_sdwa v88, 3, v122 dst_sel:DWORD dst_unused:UNUSED_PAD src0_sel:DWORD src1_sel:WORD_0
    v_lshlrev_b32_sdwa v90, 3, v122 dst_sel:DWORD dst_unused:UNUSED_PAD src0_sel:DWORD src1_sel:WORD_1
    ds_read_b64 v[88:89], v88
    ds_read_b64 v[90:91], v90
    v_mfma_f32_16x16x32_bf16 v[112:115], v[76:79], v[228:231], v[112:115]
    v_lshlrev_b32_sdwa v92, 3, v123 dst_sel:DWORD dst_unused:UNUSED_PAD src0_sel:DWORD src1_sel:WORD_0
    v_lshlrev_b32_sdwa v94, 3, v123 dst_sel:DWORD dst_unused:UNUSED_PAD src0_sel:DWORD src1_sel:WORD_1
    ds_read_b64 v[92:93], v92
    ds_read_b64 v[94:95], v94
    s_waitcnt lgkmcnt(10)
    v_smfmac_f32_16x16x64_bf16 v[44:47], v[64:67], v[96:103], v68
    buffer_load_dwordx4 v[120:123], off, s[48:51], s20 offset:1024 sc1
    s_setprio 1
    s_waitcnt vmcnt(2)
    v_lshlrev_b32_sdwa v96, 3, v124 dst_sel:DWORD dst_unused:UNUSED_PAD src0_sel:DWORD src1_sel:WORD_0
    v_lshlrev_b32_sdwa v98, 3, v124 dst_sel:DWORD dst_unused:UNUSED_PAD src0_sel:DWORD src1_sel:WORD_1
    v_mfma_f32_16x16x32_bf16 v[112:115], v[80:83], v[232:235], v[112:115]
    ds_read_b64 v[96:97], v96
    ds_read_b64 v[98:99], v98
    v_lshlrev_b32_sdwa v100, 3, v125 dst_sel:DWORD dst_unused:UNUSED_PAD src0_sel:DWORD src1_sel:WORD_0
    v_lshlrev_b32_sdwa v102, 3, v125 dst_sel:DWORD dst_unused:UNUSED_PAD src0_sel:DWORD src1_sel:WORD_1
    v_mfma_f32_16x16x32_bf16 v[112:115], v[84:87], v[236:239], v[112:115]
    ds_read_b64 v[100:101], v100
    ds_read_b64 v[102:103], v102
    s_waitcnt lgkmcnt(9)
    v_smfmac_f32_16x16x64_bf16 v[48:51], v[64:67], v[104:111], v68
    v_lshlrev_b32_sdwa v104, 3, v126 dst_sel:DWORD dst_unused:UNUSED_PAD src0_sel:DWORD src1_sel:WORD_0
    v_lshlrev_b32_sdwa v106, 3, v126 dst_sel:DWORD dst_unused:UNUSED_PAD src0_sel:DWORD src1_sel:WORD_1
    s_nop 1
    v_cvt_pk_bf16_f32 v112, v112, v113
    v_cvt_pk_bf16_f32 v113, v114, v115
    ds_write_b64 v70, v[112:113] offset:768
    v_mfma_f32_16x16x32_bf16 v[112:115], v[72:75], v[240:243], 0
    buffer_load_dwordx4 v[72:75], off, s[48:51], s21 offset:0
    ds_read_b64 v[104:105], v104
    ds_read_b64 v[106:107], v106
    v_lshlrev_b32_sdwa v108, 3, v127 dst_sel:DWORD dst_unused:UNUSED_PAD src0_sel:DWORD src1_sel:WORD_0
    v_lshlrev_b32_sdwa v110, 3, v127 dst_sel:DWORD dst_unused:UNUSED_PAD src0_sel:DWORD src1_sel:WORD_1
    buffer_load_dwordx4 v[124:127], off, s[48:51], s20 offset:2048 sc1
    ds_read_b64 v[108:109], v108
    ds_read_b64 v[110:111], v110
    v_mfma_f32_16x16x32_bf16 v[112:115], v[76:79], v[244:247], v[112:115]
    buffer_load_dwordx4 v[76:79], off, s[48:51], s21 offset:1024
    s_waitcnt lgkmcnt(9)
    v_smfmac_f32_16x16x64_bf16 v[52:55], v[64:67], v[88:95], v68
    s_waitcnt vmcnt(4)
    v_lshlrev_b32_sdwa v88, 3, v116 dst_sel:DWORD dst_unused:UNUSED_PAD src0_sel:DWORD src1_sel:WORD_0
    v_lshlrev_b32_sdwa v90, 3, v116 dst_sel:DWORD dst_unused:UNUSED_PAD src0_sel:DWORD src1_sel:WORD_1
    ds_read_b64 v[88:89], v88
    ds_read_b64 v[90:91], v90
    v_mfma_f32_16x16x32_bf16 v[112:115], v[80:83], v[248:251], v[112:115]
    buffer_load_dwordx4 v[80:83], off, s[48:51], s19 offset:0
    v_lshlrev_b32_sdwa v92, 3, v117 dst_sel:DWORD dst_unused:UNUSED_PAD src0_sel:DWORD src1_sel:WORD_0
    v_lshlrev_b32_sdwa v94, 3, v117 dst_sel:DWORD dst_unused:UNUSED_PAD src0_sel:DWORD src1_sel:WORD_1
    v_mfma_f32_16x16x32_bf16 v[112:115], v[84:87], v[252:255], v[112:115]
    buffer_load_dwordx4 v[84:87], off, s[48:51], s19 offset:1024
    s_add_u32 s21, s21, 4096
    s_add_u32 s19, s19, 4096
    ds_read_b64 v[92:93], v92
    ds_read_b64 v[94:95], v94
    s_waitcnt lgkmcnt(9)
    v_smfmac_f32_16x16x64_bf16 v[56:59], v[64:67], v[96:103], v68
    s_setprio 0
    v_cvt_pk_bf16_f32 v112, v112, v113
    v_cvt_pk_bf16_f32 v113, v114, v115
    ds_write_b64 v70, v[112:113] offset:896
    ds_append v71 offset:8080
    s_add_u32 s23, s23, s23
    s_cselect_b32 s35, 4294836224, s32
    v_add_u32 v70, s35, v70
    v_lshlrev_b32_sdwa v96, 3, v118 dst_sel:DWORD dst_unused:UNUSED_PAD src0_sel:DWORD src1_sel:WORD_0
    v_lshlrev_b32_sdwa v98, 3, v118 dst_sel:DWORD dst_unused:UNUSED_PAD src0_sel:DWORD src1_sel:WORD_1
    ds_read_b64 v[96:97], v96
    ds_read_b64 v[98:99], v98
    v_lshlrev_b32_sdwa v100, 3, v119 dst_sel:DWORD dst_unused:UNUSED_PAD src0_sel:DWORD src1_sel:WORD_0
    v_lshlrev_b32_sdwa v102, 3, v119 dst_sel:DWORD dst_unused:UNUSED_PAD src0_sel:DWORD src1_sel:WORD_1
    buffer_load_dwordx4 v[116:119], off, s[48:51], s20 offset:3072 sc1
    s_add_u32 s20, s20, 4096
    ds_read_b64 v[100:101], v100
    ds_read_b64 v[102:103], v102
    s_waitcnt lgkmcnt(10)
    v_smfmac_f32_16x16x64_bf16 v[60:63], v[64:67], v[104:111], v68

    s_branch standalone__deep_cross_pnn__recsys_kernel_gloop

standalone__deep_cross_pnn__recsys_kernel_sp0:
    s_sleep 1
    ds_read_addtid_b32 v71 offset:8080
    s_waitcnt lgkmcnt(0)
    v_readfirstlane_b32 s36, v71

    s_cmp_lt_u32 s36, s37
    s_cbranch_scc1 standalone__deep_cross_pnn__recsys_kernel_sp0
    s_branch standalone__deep_cross_pnn__recsys_kernel_sr0
standalone__deep_cross_pnn__recsys_kernel_sp1:
    s_sleep 1
    ds_read_addtid_b32 v71 offset:8080
    s_waitcnt lgkmcnt(0)
    v_readfirstlane_b32 s36, v71

    s_cmp_lt_u32 s36, s37
    s_cbranch_scc1 standalone__deep_cross_pnn__recsys_kernel_sp1
    s_branch standalone__deep_cross_pnn__recsys_kernel_sr1
standalone__deep_cross_pnn__recsys_kernel_sp2:
    s_sleep 1
    ds_read_addtid_b32 v71 offset:8080
    s_waitcnt lgkmcnt(0)
    v_readfirstlane_b32 s36, v71

    s_cmp_lt_u32 s36, s37
    s_cbranch_scc1 standalone__deep_cross_pnn__recsys_kernel_sp2
    s_branch standalone__deep_cross_pnn__recsys_kernel_sr2
standalone__deep_cross_pnn__recsys_kernel_sp3:
    s_sleep 1
    ds_read_addtid_b32 v71 offset:8080
    s_waitcnt lgkmcnt(0)
    v_readfirstlane_b32 s36, v71

    s_cmp_lt_u32 s36, s37
    s_cbranch_scc1 standalone__deep_cross_pnn__recsys_kernel_sp3
    s_branch standalone__deep_cross_pnn__recsys_kernel_sr3
standalone__deep_cross_pnn__recsys_kernel_fin:

    s_add_u32 s40, s20, 61440
    s_add_u32 s41, s20, 65536
    s_add_u32 s44, s20, 126976
    s_add_u32 s45, s20, 131072

    s_lshl_b32 s35, s33, 16
    s_lshl_b32 s42, s34, 15
    s_add_u32 s35, s35, s42
    s_lshl_b32 s42, s3, 12
    s_add_u32 s35, s35, s42
    s_add_u32 s35, s35, 20971520

    v_mov_b32 v128, 0xbdd2d3e8
    v_mov_b32 v129, 0xbdd2d3e8
    v_mov_b32 v130, 0xc0135761
    v_mov_b32 v131, 0xc0135761
    v_mov_b32 v132, 1.0
    v_mov_b32 v133, 1.0
    v_mov_b32 v134, s28
    v_mov_b32 v135, s29
    s_waitcnt vmcnt(6)
    v_lshlrev_b32_sdwa v88, 3, v116 dst_sel:DWORD dst_unused:UNUSED_PAD src0_sel:DWORD src1_sel:WORD_0
    v_lshlrev_b32_sdwa v90, 3, v116 dst_sel:DWORD dst_unused:UNUSED_PAD src0_sel:DWORD src1_sel:WORD_1
    ds_read_b64 v[88:89], v88
    ds_read_b64 v[90:91], v90
    v_lshlrev_b32_sdwa v92, 3, v117 dst_sel:DWORD dst_unused:UNUSED_PAD src0_sel:DWORD src1_sel:WORD_0
    v_lshlrev_b32_sdwa v94, 3, v117 dst_sel:DWORD dst_unused:UNUSED_PAD src0_sel:DWORD src1_sel:WORD_1
    ds_read_b64 v[92:93], v92
    ds_read_b64 v[94:95], v94
    s_waitcnt lgkmcnt(10)
    v_smfmac_f32_16x16x64_bf16 v[0:3], v[64:67], v[96:103], v68
    v_mov_b32 v136, s30
    v_mov_b32 v137, s31
    v_lshrrev_b32 v70, 2, v69
    v_and_b32 v138, 128, v70
    v_add_u32 v70, v70, v138
    v_rcp_f32 v134, v134
    v_rcp_f32 v135, v135
    v_rcp_f32 v136, v136
    v_lshlrev_b32_sdwa v96, 3, v118 dst_sel:DWORD dst_unused:UNUSED_PAD src0_sel:DWORD src1_sel:WORD_0
    v_lshlrev_b32_sdwa v98, 3, v118 dst_sel:DWORD dst_unused:UNUSED_PAD src0_sel:DWORD src1_sel:WORD_1
    ds_read_b64 v[96:97], v96
    ds_read_b64 v[98:99], v98
    v_lshlrev_b32_sdwa v100, 3, v119 dst_sel:DWORD dst_unused:UNUSED_PAD src0_sel:DWORD src1_sel:WORD_0
    v_lshlrev_b32_sdwa v102, 3, v119 dst_sel:DWORD dst_unused:UNUSED_PAD src0_sel:DWORD src1_sel:WORD_1
    ds_read_b64 v[100:101], v100
    ds_read_b64 v[102:103], v102
    buffer_load_dwordx4 v[116:119], off, s[48:51], s40 offset:0 sc1
    s_waitcnt lgkmcnt(8)
    v_smfmac_f32_16x16x64_bf16 v[4:7], v[64:67], v[104:111], v68
    v_rcp_f32 v137, v137
    v_mov_b32 v132, 0x7f7fffff
    v_mov_b32 v133, 0xff7fffff
    v_med3_f32 v134, v134, v132, v133
    v_med3_f32 v135, v135, v132, v133
    v_med3_f32 v136, v136, v132, v133
    v_med3_f32 v137, v137, v132, v133
    s_waitcnt vmcnt(5)
    v_lshlrev_b32_sdwa v104, 3, v120 dst_sel:DWORD dst_unused:UNUSED_PAD src0_sel:DWORD src1_sel:WORD_0
    v_lshlrev_b32_sdwa v106, 3, v120 dst_sel:DWORD dst_unused:UNUSED_PAD src0_sel:DWORD src1_sel:WORD_1
    ds_read_b64 v[104:105], v104
    ds_read_b64 v[106:107], v106
    v_lshlrev_b32_sdwa v108, 3, v121 dst_sel:DWORD dst_unused:UNUSED_PAD src0_sel:DWORD src1_sel:WORD_0
    v_lshlrev_b32_sdwa v110, 3, v121 dst_sel:DWORD dst_unused:UNUSED_PAD src0_sel:DWORD src1_sel:WORD_1
    ds_read_b64 v[108:109], v108
    ds_read_b64 v[110:111], v110
    s_waitcnt lgkmcnt(8)
    v_smfmac_f32_16x16x64_bf16 v[8:11], v[64:67], v[88:95], v68
    v_lshlrev_b32_sdwa v88, 3, v122 dst_sel:DWORD dst_unused:UNUSED_PAD src0_sel:DWORD src1_sel:WORD_0
    v_lshlrev_b32_sdwa v90, 3, v122 dst_sel:DWORD dst_unused:UNUSED_PAD src0_sel:DWORD src1_sel:WORD_1
    ds_read_b64 v[88:89], v88
    ds_read_b64 v[90:91], v90
    ds_read_addtid_b32 v71 offset:8080
    v_lshlrev_b32_sdwa v92, 3, v123 dst_sel:DWORD dst_unused:UNUSED_PAD src0_sel:DWORD src1_sel:WORD_0
    v_lshlrev_b32_sdwa v94, 3, v123 dst_sel:DWORD dst_unused:UNUSED_PAD src0_sel:DWORD src1_sel:WORD_1
    ds_read_b64 v[92:93], v92
    ds_read_b64 v[94:95], v94
    buffer_load_dwordx4 v[120:123], off, s[48:51], s44 offset:0 sc1
    s_waitcnt lgkmcnt(9)
    v_smfmac_f32_16x16x64_bf16 v[12:15], v[64:67], v[96:103], v68
    s_waitcnt vmcnt(2)
    v_lshlrev_b32_sdwa v96, 3, v124 dst_sel:DWORD dst_unused:UNUSED_PAD src0_sel:DWORD src1_sel:WORD_0
    v_lshlrev_b32_sdwa v98, 3, v124 dst_sel:DWORD dst_unused:UNUSED_PAD src0_sel:DWORD src1_sel:WORD_1
    ds_read_b64 v[96:97], v96
    ds_read_b64 v[98:99], v98
    v_lshlrev_b32_sdwa v100, 3, v125 dst_sel:DWORD dst_unused:UNUSED_PAD src0_sel:DWORD src1_sel:WORD_0
    v_lshlrev_b32_sdwa v102, 3, v125 dst_sel:DWORD dst_unused:UNUSED_PAD src0_sel:DWORD src1_sel:WORD_1
    ds_read_b64 v[100:101], v100
    ds_read_b64 v[102:103], v102
    s_waitcnt lgkmcnt(9)
    v_smfmac_f32_16x16x64_bf16 v[16:19], v[64:67], v[104:111], v68
    v_lshlrev_b32_sdwa v104, 3, v126 dst_sel:DWORD dst_unused:UNUSED_PAD src0_sel:DWORD src1_sel:WORD_0
    v_lshlrev_b32_sdwa v106, 3, v126 dst_sel:DWORD dst_unused:UNUSED_PAD src0_sel:DWORD src1_sel:WORD_1
    ds_read_b64 v[104:105], v104
    ds_read_b64 v[106:107], v106
    v_lshlrev_b32_sdwa v108, 3, v127 dst_sel:DWORD dst_unused:UNUSED_PAD src0_sel:DWORD src1_sel:WORD_0
    v_lshlrev_b32_sdwa v110, 3, v127 dst_sel:DWORD dst_unused:UNUSED_PAD src0_sel:DWORD src1_sel:WORD_1
    ds_read_b64 v[108:109], v108
    ds_read_b64 v[110:111], v110
    buffer_load_dwordx4 v[124:127], off, s[48:51], s40 offset:1024 sc1
    s_waitcnt lgkmcnt(8)
    v_smfmac_f32_16x16x64_bf16 v[20:23], v[64:67], v[88:95], v68
    v_readfirstlane_b32 s36, v71
    s_waitcnt vmcnt(2)
    s_cmp_lt_u32 s36, s37
    s_cbranch_scc1 standalone__deep_cross_pnn__recsys_kernel_sp3
standalone__deep_cross_pnn__recsys_kernel_sr3:
    v_lshlrev_b32_sdwa v88, 3, v116 dst_sel:DWORD dst_unused:UNUSED_PAD src0_sel:DWORD src1_sel:WORD_0
    v_lshlrev_b32_sdwa v90, 3, v116 dst_sel:DWORD dst_unused:UNUSED_PAD src0_sel:DWORD src1_sel:WORD_1
    ds_read_b64 v[88:89], v88
    ds_read_b64 v[90:91], v90
    v_lshlrev_b32_sdwa v92, 3, v117 dst_sel:DWORD dst_unused:UNUSED_PAD src0_sel:DWORD src1_sel:WORD_0
    v_lshlrev_b32_sdwa v94, 3, v117 dst_sel:DWORD dst_unused:UNUSED_PAD src0_sel:DWORD src1_sel:WORD_1
    ds_read_b64 v[92:93], v92
    ds_read_b64 v[94:95], v94
    s_waitcnt lgkmcnt(8)
    v_smfmac_f32_16x16x64_bf16 v[24:27], v[64:67], v[96:103], v68
    v_lshlrev_b32_sdwa v96, 3, v118 dst_sel:DWORD dst_unused:UNUSED_PAD src0_sel:DWORD src1_sel:WORD_0
    v_lshlrev_b32_sdwa v98, 3, v118 dst_sel:DWORD dst_unused:UNUSED_PAD src0_sel:DWORD src1_sel:WORD_1
    ds_read_b64 v[96:97], v96
    ds_read_b64 v[98:99], v98
    v_lshlrev_b32_sdwa v100, 3, v119 dst_sel:DWORD dst_unused:UNUSED_PAD src0_sel:DWORD src1_sel:WORD_0
    v_lshlrev_b32_sdwa v102, 3, v119 dst_sel:DWORD dst_unused:UNUSED_PAD src0_sel:DWORD src1_sel:WORD_1
    ds_read_b64 v[100:101], v100
    ds_read_b64 v[102:103], v102
    buffer_load_dwordx4 v[116:119], off, s[48:51], s44 offset:1024 sc1
    s_waitcnt lgkmcnt(8)
    v_smfmac_f32_16x16x64_bf16 v[28:31], v[64:67], v[104:111], v68
    s_waitcnt vmcnt(2)
    v_lshlrev_b32_sdwa v104, 3, v120 dst_sel:DWORD dst_unused:UNUSED_PAD src0_sel:DWORD src1_sel:WORD_0
    v_lshlrev_b32_sdwa v106, 3, v120 dst_sel:DWORD dst_unused:UNUSED_PAD src0_sel:DWORD src1_sel:WORD_1
    ds_read_b64 v[104:105], v104
    ds_read_b64 v[106:107], v106
    v_lshlrev_b32_sdwa v108, 3, v121 dst_sel:DWORD dst_unused:UNUSED_PAD src0_sel:DWORD src1_sel:WORD_0
    v_lshlrev_b32_sdwa v110, 3, v121 dst_sel:DWORD dst_unused:UNUSED_PAD src0_sel:DWORD src1_sel:WORD_1
    ds_read_b64 v[108:109], v108
    ds_read_b64 v[110:111], v110
    s_waitcnt lgkmcnt(8)
    v_smfmac_f32_16x16x64_bf16 v[0:3], v[64:67], v[88:95], v68
    v_lshlrev_b32_sdwa v88, 3, v122 dst_sel:DWORD dst_unused:UNUSED_PAD src0_sel:DWORD src1_sel:WORD_0
    v_lshlrev_b32_sdwa v90, 3, v122 dst_sel:DWORD dst_unused:UNUSED_PAD src0_sel:DWORD src1_sel:WORD_1
    ds_read_b64 v[88:89], v88
    ds_read_b64 v[90:91], v90
    v_lshlrev_b32_sdwa v92, 3, v123 dst_sel:DWORD dst_unused:UNUSED_PAD src0_sel:DWORD src1_sel:WORD_0
    v_lshlrev_b32_sdwa v94, 3, v123 dst_sel:DWORD dst_unused:UNUSED_PAD src0_sel:DWORD src1_sel:WORD_1
    ds_read_b64 v[92:93], v92
    ds_read_b64 v[94:95], v94
    buffer_load_dwordx4 v[120:123], off, s[48:51], s40 offset:2048 sc1
    s_waitcnt lgkmcnt(8)
    v_smfmac_f32_16x16x64_bf16 v[4:7], v[64:67], v[96:103], v68
    s_waitcnt vmcnt(2)
    v_lshlrev_b32_sdwa v96, 3, v124 dst_sel:DWORD dst_unused:UNUSED_PAD src0_sel:DWORD src1_sel:WORD_0
    v_lshlrev_b32_sdwa v98, 3, v124 dst_sel:DWORD dst_unused:UNUSED_PAD src0_sel:DWORD src1_sel:WORD_1
    ds_read_b64 v[96:97], v96
    ds_read_b64 v[98:99], v98
    v_lshlrev_b32_sdwa v100, 3, v125 dst_sel:DWORD dst_unused:UNUSED_PAD src0_sel:DWORD src1_sel:WORD_0
    v_lshlrev_b32_sdwa v102, 3, v125 dst_sel:DWORD dst_unused:UNUSED_PAD src0_sel:DWORD src1_sel:WORD_1
    ds_read_b64 v[100:101], v100
    ds_read_b64 v[102:103], v102
    s_waitcnt lgkmcnt(8)
    v_smfmac_f32_16x16x64_bf16 v[0:3], v[64:67], v[104:111], v68
    v_lshlrev_b32_sdwa v104, 3, v126 dst_sel:DWORD dst_unused:UNUSED_PAD src0_sel:DWORD src1_sel:WORD_0
    v_lshlrev_b32_sdwa v106, 3, v126 dst_sel:DWORD dst_unused:UNUSED_PAD src0_sel:DWORD src1_sel:WORD_1
    ds_read_b64 v[104:105], v104
    ds_read_b64 v[106:107], v106
    v_lshlrev_b32_sdwa v108, 3, v127 dst_sel:DWORD dst_unused:UNUSED_PAD src0_sel:DWORD src1_sel:WORD_0
    v_lshlrev_b32_sdwa v110, 3, v127 dst_sel:DWORD dst_unused:UNUSED_PAD src0_sel:DWORD src1_sel:WORD_1
    ds_read_b64 v[108:109], v108
    ds_read_b64 v[110:111], v110
    buffer_load_dwordx4 v[124:127], off, s[48:51], s44 offset:2048 sc1
    s_waitcnt lgkmcnt(8)
    v_smfmac_f32_16x16x64_bf16 v[4:7], v[64:67], v[88:95], v68
    s_waitcnt vmcnt(2)
    v_lshlrev_b32_sdwa v88, 3, v116 dst_sel:DWORD dst_unused:UNUSED_PAD src0_sel:DWORD src1_sel:WORD_0
    v_lshlrev_b32_sdwa v90, 3, v116 dst_sel:DWORD dst_unused:UNUSED_PAD src0_sel:DWORD src1_sel:WORD_1
    ds_read_b64 v[88:89], v88
    ds_read_b64 v[90:91], v90
    v_lshlrev_b32_sdwa v92, 3, v117 dst_sel:DWORD dst_unused:UNUSED_PAD src0_sel:DWORD src1_sel:WORD_0
    v_lshlrev_b32_sdwa v94, 3, v117 dst_sel:DWORD dst_unused:UNUSED_PAD src0_sel:DWORD src1_sel:WORD_1
    ds_read_b64 v[92:93], v92
    ds_read_b64 v[94:95], v94
    s_waitcnt lgkmcnt(8)
    v_smfmac_f32_16x16x64_bf16 v[8:11], v[64:67], v[96:103], v68
    v_pk_mul_f32 v[140:141], v[0:1], v[0:1]
    v_pk_mul_f32 v[142:143], v[2:3], v[2:3]
    v_pk_fma_f32 v[140:141], v[140:141], v[128:129], v[130:131]
    v_pk_fma_f32 v[142:143], v[142:143], v[128:129], v[130:131]
    v_pk_mul_f32 v[140:141], v[140:141], v[0:1]
    v_pk_mul_f32 v[142:143], v[142:143], v[2:3]
    v_exp_f32 v140, v140
    v_pk_mul_f32 v[146:147], v[4:5], v[4:5]
    v_lshlrev_b32_sdwa v96, 3, v118 dst_sel:DWORD dst_unused:UNUSED_PAD src0_sel:DWORD src1_sel:WORD_0
    v_lshlrev_b32_sdwa v98, 3, v118 dst_sel:DWORD dst_unused:UNUSED_PAD src0_sel:DWORD src1_sel:WORD_1
    ds_read_b64 v[96:97], v96
    ds_read_b64 v[98:99], v98
    v_lshlrev_b32_sdwa v100, 3, v119 dst_sel:DWORD dst_unused:UNUSED_PAD src0_sel:DWORD src1_sel:WORD_0
    v_lshlrev_b32_sdwa v102, 3, v119 dst_sel:DWORD dst_unused:UNUSED_PAD src0_sel:DWORD src1_sel:WORD_1
    ds_read_b64 v[100:101], v100
    ds_read_b64 v[102:103], v102
    buffer_load_dwordx4 v[116:119], off, s[48:51], s40 offset:3072 sc1
    s_waitcnt lgkmcnt(8)
    v_smfmac_f32_16x16x64_bf16 v[12:15], v[64:67], v[104:111], v68
    v_exp_f32 v141, v141
    v_pk_fma_f32 v[146:147], v[146:147], v[128:129], v[130:131]
    v_pk_mul_f32 v[148:149], v[6:7], v[6:7]
    v_exp_f32 v142, v142
    v_pk_fma_f32 v[140:141], v[140:141], v[134:135], v[134:135]
    v_pk_mul_f32 v[146:147], v[146:147], v[4:5]
    v_rcp_f32 v140, v140
    v_pk_fma_f32 v[148:149], v[148:149], v[128:129], v[130:131]
    s_waitcnt vmcnt(2)
    v_lshlrev_b32_sdwa v104, 3, v120 dst_sel:DWORD dst_unused:UNUSED_PAD src0_sel:DWORD src1_sel:WORD_0
    v_lshlrev_b32_sdwa v106, 3, v120 dst_sel:DWORD dst_unused:UNUSED_PAD src0_sel:DWORD src1_sel:WORD_1
    ds_read_b64 v[104:105], v104
    ds_read_b64 v[106:107], v106
    v_lshlrev_b32_sdwa v108, 3, v121 dst_sel:DWORD dst_unused:UNUSED_PAD src0_sel:DWORD src1_sel:WORD_0
    v_lshlrev_b32_sdwa v110, 3, v121 dst_sel:DWORD dst_unused:UNUSED_PAD src0_sel:DWORD src1_sel:WORD_1
    ds_read_b64 v[108:109], v108
    ds_read_b64 v[110:111], v110
    s_waitcnt lgkmcnt(8)
    v_smfmac_f32_16x16x64_bf16 v[8:11], v[64:67], v[88:95], v68
    v_rcp_f32 v141, v141
    v_pk_mul_f32 v[148:149], v[148:149], v[6:7]
    v_exp_f32 v143, v143
    v_pk_mul_f32 v[144:145], v[0:1], v[140:141]
    v_exp_f32 v146, v146
    v_pk_fma_f32 v[142:143], v[142:143], v[136:137], v[136:137]
    v_exp_f32 v147, v147
    v_rcp_f32 v142, v142
    v_lshlrev_b32_sdwa v88, 3, v122 dst_sel:DWORD dst_unused:UNUSED_PAD src0_sel:DWORD src1_sel:WORD_0
    v_lshlrev_b32_sdwa v90, 3, v122 dst_sel:DWORD dst_unused:UNUSED_PAD src0_sel:DWORD src1_sel:WORD_1
    ds_read_b64 v[88:89], v88
    ds_read_b64 v[90:91], v90
    v_lshlrev_b32_sdwa v92, 3, v123 dst_sel:DWORD dst_unused:UNUSED_PAD src0_sel:DWORD src1_sel:WORD_0
    v_lshlrev_b32_sdwa v94, 3, v123 dst_sel:DWORD dst_unused:UNUSED_PAD src0_sel:DWORD src1_sel:WORD_1
    ds_read_b64 v[92:93], v92
    ds_read_b64 v[94:95], v94
    buffer_load_dwordx4 v[120:123], off, s[48:51], s44 offset:3072 sc1
    s_waitcnt lgkmcnt(8)
    v_smfmac_f32_16x16x64_bf16 v[12:15], v[64:67], v[96:103], v68
    v_rcp_f32 v143, v143
    v_pk_fma_f32 v[146:147], v[146:147], v[134:135], v[134:135]
    v_pk_mul_f32 v[152:153], v[8:9], v[8:9]
    v_rcp_f32 v146, v146
    v_pk_fma_f32 v[144:145], v[2:3], v[142:143], v[144:145]
    v_pk_fma_f32 v[152:153], v[152:153], v[128:129], v[130:131]
    v_rcp_f32 v147, v147
    v_add_f32 v144, v144, v145
    s_waitcnt vmcnt(2)
    v_lshlrev_b32_sdwa v96, 3, v124 dst_sel:DWORD dst_unused:UNUSED_PAD src0_sel:DWORD src1_sel:WORD_0
    v_lshlrev_b32_sdwa v98, 3, v124 dst_sel:DWORD dst_unused:UNUSED_PAD src0_sel:DWORD src1_sel:WORD_1
    ds_read_b64 v[96:97], v96
    ds_read_b64 v[98:99], v98
    v_lshlrev_b32_sdwa v100, 3, v125 dst_sel:DWORD dst_unused:UNUSED_PAD src0_sel:DWORD src1_sel:WORD_0
    v_lshlrev_b32_sdwa v102, 3, v125 dst_sel:DWORD dst_unused:UNUSED_PAD src0_sel:DWORD src1_sel:WORD_1
    ds_read_b64 v[100:101], v100
    ds_read_b64 v[102:103], v102
    s_waitcnt lgkmcnt(8)
    v_smfmac_f32_16x16x64_bf16 v[16:19], v[64:67], v[104:111], v68
    v_exp_f32 v148, v148
    buffer_store_dword v144, v70, s[12:15], s35 offen offset:0 sc1
    v_pk_mul_f32 v[150:151], v[4:5], v[146:147]
    v_exp_f32 v149, v149
    v_pk_mul_f32 v[152:153], v[152:153], v[8:9]
    v_pk_mul_f32 v[154:155], v[10:11], v[10:11]
    v_exp_f32 v152, v152
    v_pk_fma_f32 v[148:149], v[148:149], v[136:137], v[136:137]
    v_lshlrev_b32_sdwa v104, 3, v126 dst_sel:DWORD dst_unused:UNUSED_PAD src0_sel:DWORD src1_sel:WORD_0
    v_lshlrev_b32_sdwa v106, 3, v126 dst_sel:DWORD dst_unused:UNUSED_PAD src0_sel:DWORD src1_sel:WORD_1
    ds_read_b64 v[104:105], v104
    ds_read_b64 v[106:107], v106
    v_lshlrev_b32_sdwa v108, 3, v127 dst_sel:DWORD dst_unused:UNUSED_PAD src0_sel:DWORD src1_sel:WORD_0
    v_lshlrev_b32_sdwa v110, 3, v127 dst_sel:DWORD dst_unused:UNUSED_PAD src0_sel:DWORD src1_sel:WORD_1
    ds_read_b64 v[108:109], v108
    ds_read_b64 v[110:111], v110
    buffer_load_dwordx4 v[124:127], off, s[48:51], s20 offset:0 sc1
    s_waitcnt lgkmcnt(8)
    v_smfmac_f32_16x16x64_bf16 v[20:23], v[64:67], v[88:95], v68
    v_rcp_f32 v148, v148
    v_pk_fma_f32 v[154:155], v[154:155], v[128:129], v[130:131]
    v_pk_mul_f32 v[158:159], v[12:13], v[12:13]
    v_rcp_f32 v149, v149
    v_pk_mul_f32 v[154:155], v[154:155], v[10:11]
    v_pk_fma_f32 v[158:159], v[158:159], v[128:129], v[130:131]
    v_exp_f32 v153, v153
    v_pk_fma_f32 v[150:151], v[6:7], v[148:149], v[150:151]
    s_waitcnt vmcnt(3)
    v_lshlrev_b32_sdwa v88, 3, v116 dst_sel:DWORD dst_unused:UNUSED_PAD src0_sel:DWORD src1_sel:WORD_0
    v_lshlrev_b32_sdwa v90, 3, v116 dst_sel:DWORD dst_unused:UNUSED_PAD src0_sel:DWORD src1_sel:WORD_1
    ds_read_b64 v[88:89], v88
    ds_read_b64 v[90:91], v90
    v_lshlrev_b32_sdwa v92, 3, v117 dst_sel:DWORD dst_unused:UNUSED_PAD src0_sel:DWORD src1_sel:WORD_0
    v_lshlrev_b32_sdwa v94, 3, v117 dst_sel:DWORD dst_unused:UNUSED_PAD src0_sel:DWORD src1_sel:WORD_1
    ds_read_b64 v[92:93], v92
    ds_read_b64 v[94:95], v94
    s_waitcnt lgkmcnt(8)
    v_smfmac_f32_16x16x64_bf16 v[16:19], v[64:67], v[96:103], v68
    v_exp_f32 v154, v154
    v_add_f32 v150, v150, v151
    v_pk_fma_f32 v[152:153], v[152:153], v[134:135], v[134:135]
    v_exp_f32 v155, v155
    buffer_store_dword v150, v70, s[12:15], s35 offen offset:128 sc1
    v_pk_mul_f32 v[158:159], v[158:159], v[12:13]
    v_rcp_f32 v152, v152
    v_pk_fma_f32 v[154:155], v[154:155], v[136:137], v[136:137]
    v_lshlrev_b32_sdwa v96, 3, v118 dst_sel:DWORD dst_unused:UNUSED_PAD src0_sel:DWORD src1_sel:WORD_0
    v_lshlrev_b32_sdwa v98, 3, v118 dst_sel:DWORD dst_unused:UNUSED_PAD src0_sel:DWORD src1_sel:WORD_1
    ds_read_b64 v[96:97], v96
    ds_read_b64 v[98:99], v98
    v_lshlrev_b32_sdwa v100, 3, v119 dst_sel:DWORD dst_unused:UNUSED_PAD src0_sel:DWORD src1_sel:WORD_0
    v_lshlrev_b32_sdwa v102, 3, v119 dst_sel:DWORD dst_unused:UNUSED_PAD src0_sel:DWORD src1_sel:WORD_1
    ds_read_b64 v[100:101], v100
    ds_read_b64 v[102:103], v102
    buffer_load_dwordx4 v[116:119], off, s[48:51], s41 offset:0 sc1
    s_waitcnt lgkmcnt(8)
    v_smfmac_f32_16x16x64_bf16 v[20:23], v[64:67], v[104:111], v68
    v_rcp_f32 v153, v153
    v_pk_mul_f32 v[160:161], v[14:15], v[14:15]
    v_pk_mul_f32 v[164:165], v[16:17], v[16:17]
    v_rcp_f32 v154, v154
    v_pk_mul_f32 v[156:157], v[8:9], v[152:153]
    v_pk_fma_f32 v[160:161], v[160:161], v[128:129], v[130:131]
    v_rcp_f32 v155, v155
    v_pk_mul_f32 v[160:161], v[160:161], v[14:15]
    s_waitcnt vmcnt(4)
    v_lshlrev_b32_sdwa v104, 3, v120 dst_sel:DWORD dst_unused:UNUSED_PAD src0_sel:DWORD src1_sel:WORD_0
    v_lshlrev_b32_sdwa v106, 3, v120 dst_sel:DWORD dst_unused:UNUSED_PAD src0_sel:DWORD src1_sel:WORD_1
    ds_read_b64 v[104:105], v104
    ds_read_b64 v[106:107], v106
    v_lshlrev_b32_sdwa v108, 3, v121 dst_sel:DWORD dst_unused:UNUSED_PAD src0_sel:DWORD src1_sel:WORD_0
    v_lshlrev_b32_sdwa v110, 3, v121 dst_sel:DWORD dst_unused:UNUSED_PAD src0_sel:DWORD src1_sel:WORD_1
    ds_read_b64 v[108:109], v108
    ds_read_b64 v[110:111], v110
    s_waitcnt lgkmcnt(8)
    v_smfmac_f32_16x16x64_bf16 v[24:27], v[64:67], v[88:95], v68
    v_exp_f32 v158, v158
    v_pk_fma_f32 v[156:157], v[10:11], v[154:155], v[156:157]
    v_pk_fma_f32 v[164:165], v[164:165], v[128:129], v[130:131]
    v_exp_f32 v159, v159
    v_add_f32 v156, v156, v157
    v_pk_mul_f32 v[164:165], v[164:165], v[16:17]
    v_exp_f32 v160, v160
    buffer_store_dword v156, v70, s[12:15], s35 offen offset:512 sc1
    v_lshlrev_b32_sdwa v88, 3, v122 dst_sel:DWORD dst_unused:UNUSED_PAD src0_sel:DWORD src1_sel:WORD_0
    v_lshlrev_b32_sdwa v90, 3, v122 dst_sel:DWORD dst_unused:UNUSED_PAD src0_sel:DWORD src1_sel:WORD_1
    ds_read_b64 v[88:89], v88
    ds_read_b64 v[90:91], v90
    v_lshlrev_b32_sdwa v92, 3, v123 dst_sel:DWORD dst_unused:UNUSED_PAD src0_sel:DWORD src1_sel:WORD_0
    v_lshlrev_b32_sdwa v94, 3, v123 dst_sel:DWORD dst_unused:UNUSED_PAD src0_sel:DWORD src1_sel:WORD_1
    ds_read_b64 v[92:93], v92
    ds_read_b64 v[94:95], v94
    buffer_load_dwordx4 v[120:123], off, s[48:51], s45 offset:0 sc1
    s_waitcnt lgkmcnt(8)
    v_smfmac_f32_16x16x64_bf16 v[28:31], v[64:67], v[96:103], v68
    v_exp_f32 v161, v161
    v_pk_fma_f32 v[158:159], v[158:159], v[134:135], v[134:135]
    v_pk_mul_f32 v[166:167], v[18:19], v[18:19]
    v_rcp_f32 v158, v158
    v_pk_fma_f32 v[160:161], v[160:161], v[136:137], v[136:137]
    v_pk_fma_f32 v[166:167], v[166:167], v[128:129], v[130:131]
    v_rcp_f32 v159, v159
    v_pk_mul_f32 v[166:167], v[166:167], v[18:19]
    s_waitcnt vmcnt(4)
    v_lshlrev_b32_sdwa v96, 3, v124 dst_sel:DWORD dst_unused:UNUSED_PAD src0_sel:DWORD src1_sel:WORD_0
    v_lshlrev_b32_sdwa v98, 3, v124 dst_sel:DWORD dst_unused:UNUSED_PAD src0_sel:DWORD src1_sel:WORD_1
    ds_read_b64 v[96:97], v96
    ds_read_b64 v[98:99], v98
    v_lshlrev_b32_sdwa v100, 3, v125 dst_sel:DWORD dst_unused:UNUSED_PAD src0_sel:DWORD src1_sel:WORD_0
    v_lshlrev_b32_sdwa v102, 3, v125 dst_sel:DWORD dst_unused:UNUSED_PAD src0_sel:DWORD src1_sel:WORD_1
    ds_read_b64 v[100:101], v100
    ds_read_b64 v[102:103], v102
    s_waitcnt lgkmcnt(8)
    v_smfmac_f32_16x16x64_bf16 v[24:27], v[64:67], v[104:111], v68
    v_rcp_f32 v160, v160
    v_pk_mul_f32 v[162:163], v[12:13], v[158:159]
    v_pk_mul_f32 v[170:171], v[20:21], v[20:21]
    v_rcp_f32 v161, v161
    v_pk_fma_f32 v[170:171], v[170:171], v[128:129], v[130:131]
    v_pk_mul_f32 v[172:173], v[22:23], v[22:23]
    v_exp_f32 v164, v164
    v_pk_fma_f32 v[162:163], v[14:15], v[160:161], v[162:163]
    v_lshlrev_b32_sdwa v104, 3, v126 dst_sel:DWORD dst_unused:UNUSED_PAD src0_sel:DWORD src1_sel:WORD_0
    v_lshlrev_b32_sdwa v106, 3, v126 dst_sel:DWORD dst_unused:UNUSED_PAD src0_sel:DWORD src1_sel:WORD_1
    ds_read_b64 v[104:105], v104
    ds_read_b64 v[106:107], v106
    v_lshlrev_b32_sdwa v108, 3, v127 dst_sel:DWORD dst_unused:UNUSED_PAD src0_sel:DWORD src1_sel:WORD_0
    v_lshlrev_b32_sdwa v110, 3, v127 dst_sel:DWORD dst_unused:UNUSED_PAD src0_sel:DWORD src1_sel:WORD_1
    ds_read_b64 v[108:109], v108
    ds_read_b64 v[110:111], v110
    buffer_load_dwordx4 v[124:127], off, s[48:51], s20 offset:1024 sc1
    s_waitcnt lgkmcnt(8)
    v_smfmac_f32_16x16x64_bf16 v[28:31], v[64:67], v[88:95], v68
    s_setprio 2
    v_exp_f32 v165, v165
    v_add_f32 v162, v162, v163
    v_pk_mul_f32 v[170:171], v[170:171], v[20:21]
    v_exp_f32 v166, v166
    buffer_store_dword v162, v70, s[12:15], s35 offen offset:640 sc1
    v_pk_fma_f32 v[164:165], v[164:165], v[134:135], v[134:135]
    v_exp_f32 v167, v167
    v_pk_fma_f32 v[172:173], v[172:173], v[128:129], v[130:131]
    s_waitcnt vmcnt(4)
    v_lshlrev_b32_sdwa v88, 3, v116 dst_sel:DWORD dst_unused:UNUSED_PAD src0_sel:DWORD src1_sel:WORD_0
    v_lshlrev_b32_sdwa v90, 3, v116 dst_sel:DWORD dst_unused:UNUSED_PAD src0_sel:DWORD src1_sel:WORD_1
    ds_read_b64 v[88:89], v88
    ds_read_b64 v[90:91], v90
    v_lshlrev_b32_sdwa v92, 3, v117 dst_sel:DWORD dst_unused:UNUSED_PAD src0_sel:DWORD src1_sel:WORD_0
    v_lshlrev_b32_sdwa v94, 3, v117 dst_sel:DWORD dst_unused:UNUSED_PAD src0_sel:DWORD src1_sel:WORD_1
    ds_read_b64 v[92:93], v92
    ds_read_b64 v[94:95], v94
    s_waitcnt lgkmcnt(8)
    v_smfmac_f32_16x16x64_bf16 v[32:35], v[64:67], v[96:103], v68
    v_rcp_f32 v164, v164
    v_pk_fma_f32 v[166:167], v[166:167], v[136:137], v[136:137]
    v_pk_mul_f32 v[172:173], v[172:173], v[22:23]
    v_rcp_f32 v165, v165
    v_pk_mul_f32 v[140:141], v[24:25], v[24:25]
    v_pk_mul_f32 v[142:143], v[26:27], v[26:27]
    v_rcp_f32 v166, v166
    v_pk_mul_f32 v[168:169], v[16:17], v[164:165]
    v_lshlrev_b32_sdwa v96, 3, v118 dst_sel:DWORD dst_unused:UNUSED_PAD src0_sel:DWORD src1_sel:WORD_0
    v_lshlrev_b32_sdwa v98, 3, v118 dst_sel:DWORD dst_unused:UNUSED_PAD src0_sel:DWORD src1_sel:WORD_1
    ds_read_b64 v[96:97], v96
    ds_read_b64 v[98:99], v98
    v_lshlrev_b32_sdwa v100, 3, v119 dst_sel:DWORD dst_unused:UNUSED_PAD src0_sel:DWORD src1_sel:WORD_0
    v_lshlrev_b32_sdwa v102, 3, v119 dst_sel:DWORD dst_unused:UNUSED_PAD src0_sel:DWORD src1_sel:WORD_1
    ds_read_b64 v[100:101], v100
    ds_read_b64 v[102:103], v102
    buffer_load_dwordx4 v[116:119], off, s[48:51], s41 offset:1024 sc1
    s_waitcnt lgkmcnt(8)
    v_smfmac_f32_16x16x64_bf16 v[36:39], v[64:67], v[104:111], v68
    v_rcp_f32 v167, v167
    v_pk_fma_f32 v[140:141], v[140:141], v[128:129], v[130:131]
    v_pk_fma_f32 v[142:143], v[142:143], v[128:129], v[130:131]
    v_exp_f32 v170, v170
    v_pk_fma_f32 v[168:169], v[18:19], v[166:167], v[168:169]
    v_pk_mul_f32 v[140:141], v[140:141], v[24:25]
    v_exp_f32 v171, v171
    v_add_f32 v168, v168, v169
    s_waitcnt vmcnt(3)
    v_lshlrev_b32_sdwa v104, 3, v120 dst_sel:DWORD dst_unused:UNUSED_PAD src0_sel:DWORD src1_sel:WORD_0
    v_lshlrev_b32_sdwa v106, 3, v120 dst_sel:DWORD dst_unused:UNUSED_PAD src0_sel:DWORD src1_sel:WORD_1
    ds_read_b64 v[104:105], v104
    ds_read_b64 v[106:107], v106
    v_lshlrev_b32_sdwa v108, 3, v121 dst_sel:DWORD dst_unused:UNUSED_PAD src0_sel:DWORD src1_sel:WORD_0
    v_lshlrev_b32_sdwa v110, 3, v121 dst_sel:DWORD dst_unused:UNUSED_PAD src0_sel:DWORD src1_sel:WORD_1
    ds_read_b64 v[108:109], v108
    ds_read_b64 v[110:111], v110
    s_waitcnt lgkmcnt(8)
    v_smfmac_f32_16x16x64_bf16 v[32:35], v[64:67], v[88:95], v68
    v_exp_f32 v172, v172
    buffer_store_dword v168, v70, s[12:15], s35 offen offset:1024 sc1
    v_pk_fma_f32 v[170:171], v[170:171], v[134:135], v[134:135]
    v_exp_f32 v173, v173
    v_pk_mul_f32 v[142:143], v[142:143], v[26:27]
    v_pk_mul_f32 v[146:147], v[28:29], v[28:29]
    v_rcp_f32 v170, v170
    v_pk_fma_f32 v[172:173], v[172:173], v[136:137], v[136:137]
    v_lshlrev_b32_sdwa v88, 3, v122 dst_sel:DWORD dst_unused:UNUSED_PAD src0_sel:DWORD src1_sel:WORD_0
    v_lshlrev_b32_sdwa v90, 3, v122 dst_sel:DWORD dst_unused:UNUSED_PAD src0_sel:DWORD src1_sel:WORD_1
    ds_read_b64 v[88:89], v88
    ds_read_b64 v[90:91], v90
    v_lshlrev_b32_sdwa v92, 3, v123 dst_sel:DWORD dst_unused:UNUSED_PAD src0_sel:DWORD src1_sel:WORD_0
    v_lshlrev_b32_sdwa v94, 3, v123 dst_sel:DWORD dst_unused:UNUSED_PAD src0_sel:DWORD src1_sel:WORD_1
    ds_read_b64 v[92:93], v92
    ds_read_b64 v[94:95], v94
    buffer_load_dwordx4 v[120:123], off, s[48:51], s45 offset:1024 sc1
    s_waitcnt lgkmcnt(8)
    v_smfmac_f32_16x16x64_bf16 v[36:39], v[64:67], v[96:103], v68
    v_rcp_f32 v171, v171
    v_pk_fma_f32 v[146:147], v[146:147], v[128:129], v[130:131]
    v_pk_mul_f32 v[148:149], v[30:31], v[30:31]
    v_rcp_f32 v172, v172
    v_pk_mul_f32 v[174:175], v[20:21], v[170:171]
    v_pk_mul_f32 v[146:147], v[146:147], v[28:29]
    v_rcp_f32 v173, v173
    v_pk_fma_f32 v[148:149], v[148:149], v[128:129], v[130:131]
    s_waitcnt vmcnt(4)
    v_lshlrev_b32_sdwa v96, 3, v124 dst_sel:DWORD dst_unused:UNUSED_PAD src0_sel:DWORD src1_sel:WORD_0
    v_lshlrev_b32_sdwa v98, 3, v124 dst_sel:DWORD dst_unused:UNUSED_PAD src0_sel:DWORD src1_sel:WORD_1
    ds_read_b64 v[96:97], v96
    ds_read_b64 v[98:99], v98
    v_lshlrev_b32_sdwa v100, 3, v125 dst_sel:DWORD dst_unused:UNUSED_PAD src0_sel:DWORD src1_sel:WORD_0
    v_lshlrev_b32_sdwa v102, 3, v125 dst_sel:DWORD dst_unused:UNUSED_PAD src0_sel:DWORD src1_sel:WORD_1
    ds_read_b64 v[100:101], v100
    ds_read_b64 v[102:103], v102
    s_waitcnt lgkmcnt(8)
    v_smfmac_f32_16x16x64_bf16 v[32:35], v[64:67], v[104:111], v68
    v_exp_f32 v140, v140
    v_pk_fma_f32 v[174:175], v[22:23], v[172:173], v[174:175]
    v_pk_mul_f32 v[148:149], v[148:149], v[30:31]
    v_exp_f32 v141, v141
    v_add_f32 v174, v174, v175
    v_exp_f32 v142, v142
    buffer_store_dword v174, v70, s[12:15], s35 offen offset:1152 sc1
    v_pk_fma_f32 v[140:141], v[140:141], v[134:135], v[134:135]
    v_lshlrev_b32_sdwa v104, 3, v126 dst_sel:DWORD dst_unused:UNUSED_PAD src0_sel:DWORD src1_sel:WORD_0
    v_lshlrev_b32_sdwa v106, 3, v126 dst_sel:DWORD dst_unused:UNUSED_PAD src0_sel:DWORD src1_sel:WORD_1
    ds_read_b64 v[104:105], v104
    ds_read_b64 v[106:107], v106
    v_lshlrev_b32_sdwa v108, 3, v127 dst_sel:DWORD dst_unused:UNUSED_PAD src0_sel:DWORD src1_sel:WORD_0
    v_lshlrev_b32_sdwa v110, 3, v127 dst_sel:DWORD dst_unused:UNUSED_PAD src0_sel:DWORD src1_sel:WORD_1
    ds_read_b64 v[108:109], v108
    ds_read_b64 v[110:111], v110
    buffer_load_dwordx4 v[124:127], off, s[48:51], s20 offset:2048 sc1
    s_waitcnt lgkmcnt(8)
    v_smfmac_f32_16x16x64_bf16 v[36:39], v[64:67], v[88:95], v68
    v_rcp_f32 v140, v140
    v_pk_mul_f32 v[152:153], v[32:33], v[32:33]
    v_pk_mul_f32 v[154:155], v[34:35], v[34:35]
    v_rcp_f32 v141, v141
    v_pk_fma_f32 v[152:153], v[152:153], v[128:129], v[130:131]
    v_pk_fma_f32 v[154:155], v[154:155], v[128:129], v[130:131]
    v_exp_f32 v143, v143
    v_pk_mul_f32 v[144:145], v[24:25], v[140:141]
    s_waitcnt vmcnt(4)
    v_lshlrev_b32_sdwa v88, 3, v116 dst_sel:DWORD dst_unused:UNUSED_PAD src0_sel:DWORD src1_sel:WORD_0
    v_lshlrev_b32_sdwa v90, 3, v116 dst_sel:DWORD dst_unused:UNUSED_PAD src0_sel:DWORD src1_sel:WORD_1
    ds_read_b64 v[88:89], v88
    ds_read_b64 v[90:91], v90
    v_lshlrev_b32_sdwa v92, 3, v117 dst_sel:DWORD dst_unused:UNUSED_PAD src0_sel:DWORD src1_sel:WORD_0
    v_lshlrev_b32_sdwa v94, 3, v117 dst_sel:DWORD dst_unused:UNUSED_PAD src0_sel:DWORD src1_sel:WORD_1
    ds_read_b64 v[92:93], v92
    ds_read_b64 v[94:95], v94
    s_waitcnt lgkmcnt(8)
    v_smfmac_f32_16x16x64_bf16 v[40:43], v[64:67], v[96:103], v68
    v_exp_f32 v146, v146
    v_pk_fma_f32 v[142:143], v[142:143], v[136:137], v[136:137]
    v_pk_mul_f32 v[152:153], v[152:153], v[32:33]
    v_rcp_f32 v142, v142
    v_pk_mul_f32 v[154:155], v[154:155], v[34:35]
    v_pk_mul_f32 v[158:159], v[36:37], v[36:37]
    v_rcp_f32 v143, v143
    v_pk_fma_f32 v[158:159], v[158:159], v[128:129], v[130:131]
    v_lshlrev_b32_sdwa v96, 3, v118 dst_sel:DWORD dst_unused:UNUSED_PAD src0_sel:DWORD src1_sel:WORD_0
    v_lshlrev_b32_sdwa v98, 3, v118 dst_sel:DWORD dst_unused:UNUSED_PAD src0_sel:DWORD src1_sel:WORD_1
    ds_read_b64 v[96:97], v96
    ds_read_b64 v[98:99], v98
    v_lshlrev_b32_sdwa v100, 3, v119 dst_sel:DWORD dst_unused:UNUSED_PAD src0_sel:DWORD src1_sel:WORD_0
    v_lshlrev_b32_sdwa v102, 3, v119 dst_sel:DWORD dst_unused:UNUSED_PAD src0_sel:DWORD src1_sel:WORD_1
    ds_read_b64 v[100:101], v100
    ds_read_b64 v[102:103], v102
    buffer_load_dwordx4 v[116:119], off, s[48:51], s41 offset:2048 sc1
    s_waitcnt lgkmcnt(8)
    v_smfmac_f32_16x16x64_bf16 v[44:47], v[64:67], v[104:111], v68
    v_exp_f32 v147, v147
    v_pk_fma_f32 v[144:145], v[26:27], v[142:143], v[144:145]
    v_pk_mul_f32 v[158:159], v[158:159], v[36:37]
    v_exp_f32 v148, v148
    v_add_f32 v144, v144, v145
    v_pk_fma_f32 v[146:147], v[146:147], v[134:135], v[134:135]
    v_exp_f32 v149, v149
    buffer_store_dword v144, v70, s[12:15], s35 offen offset:1536 sc1
    s_waitcnt vmcnt(4)
    v_lshlrev_b32_sdwa v104, 3, v120 dst_sel:DWORD dst_unused:UNUSED_PAD src0_sel:DWORD src1_sel:WORD_0
    v_lshlrev_b32_sdwa v106, 3, v120 dst_sel:DWORD dst_unused:UNUSED_PAD src0_sel:DWORD src1_sel:WORD_1
    ds_read_b64 v[104:105], v104
    ds_read_b64 v[106:107], v106
    v_lshlrev_b32_sdwa v108, 3, v121 dst_sel:DWORD dst_unused:UNUSED_PAD src0_sel:DWORD src1_sel:WORD_0
    v_lshlrev_b32_sdwa v110, 3, v121 dst_sel:DWORD dst_unused:UNUSED_PAD src0_sel:DWORD src1_sel:WORD_1
    ds_read_b64 v[108:109], v108
    ds_read_b64 v[110:111], v110
    s_waitcnt lgkmcnt(8)
    v_smfmac_f32_16x16x64_bf16 v[40:43], v[64:67], v[88:95], v68
    v_rcp_f32 v146, v146
    v_pk_fma_f32 v[148:149], v[148:149], v[136:137], v[136:137]
    v_pk_mul_f32 v[160:161], v[38:39], v[38:39]
    v_rcp_f32 v147, v147
    v_pk_fma_f32 v[160:161], v[160:161], v[128:129], v[130:131]
    v_rcp_f32 v148, v148
    v_pk_mul_f32 v[150:151], v[28:29], v[146:147]
    v_pk_mul_f32 v[160:161], v[160:161], v[38:39]
    v_lshlrev_b32_sdwa v88, 3, v122 dst_sel:DWORD dst_unused:UNUSED_PAD src0_sel:DWORD src1_sel:WORD_0
    v_lshlrev_b32_sdwa v90, 3, v122 dst_sel:DWORD dst_unused:UNUSED_PAD src0_sel:DWORD src1_sel:WORD_1
    ds_read_b64 v[88:89], v88
    ds_read_b64 v[90:91], v90
    v_lshlrev_b32_sdwa v92, 3, v123 dst_sel:DWORD dst_unused:UNUSED_PAD src0_sel:DWORD src1_sel:WORD_0
    v_lshlrev_b32_sdwa v94, 3, v123 dst_sel:DWORD dst_unused:UNUSED_PAD src0_sel:DWORD src1_sel:WORD_1
    ds_read_b64 v[92:93], v92
    ds_read_b64 v[94:95], v94
    buffer_load_dwordx4 v[120:123], off, s[48:51], s45 offset:2048 sc1
    s_waitcnt lgkmcnt(8)
    v_smfmac_f32_16x16x64_bf16 v[44:47], v[64:67], v[96:103], v68
    s_setprio 1
    v_rcp_f32 v149, v149
    v_exp_f32 v152, v152
    v_exp_f32 v153, v153
    v_pk_fma_f32 v[150:151], v[30:31], v[148:149], v[150:151]
    v_exp_f32 v154, v154
    v_add_f32 v150, v150, v151
    v_pk_fma_f32 v[152:153], v[152:153], v[134:135], v[134:135]
    v_exp_f32 v155, v155
    s_waitcnt vmcnt(3)
    v_lshlrev_b32_sdwa v96, 3, v124 dst_sel:DWORD dst_unused:UNUSED_PAD src0_sel:DWORD src1_sel:WORD_0
    v_lshlrev_b32_sdwa v98, 3, v124 dst_sel:DWORD dst_unused:UNUSED_PAD src0_sel:DWORD src1_sel:WORD_1
    ds_read_b64 v[96:97], v96
    ds_read_b64 v[98:99], v98
    v_lshlrev_b32_sdwa v100, 3, v125 dst_sel:DWORD dst_unused:UNUSED_PAD src0_sel:DWORD src1_sel:WORD_0
    v_lshlrev_b32_sdwa v102, 3, v125 dst_sel:DWORD dst_unused:UNUSED_PAD src0_sel:DWORD src1_sel:WORD_1
    ds_read_b64 v[100:101], v100
    ds_read_b64 v[102:103], v102
    s_waitcnt lgkmcnt(8)
    v_smfmac_f32_16x16x64_bf16 v[40:43], v[64:67], v[104:111], v68
    v_rcp_f32 v152, v152
    buffer_store_dword v150, v70, s[12:15], s35 offen offset:1664 sc1
    v_pk_fma_f32 v[154:155], v[154:155], v[136:137], v[136:137]
    v_rcp_f32 v153, v153
    v_rcp_f32 v154, v154
    v_rcp_f32 v155, v155
    v_pk_mul_f32 v[156:157], v[32:33], v[152:153]
    v_exp_f32 v158, v158
    v_lshlrev_b32_sdwa v104, 3, v126 dst_sel:DWORD dst_unused:UNUSED_PAD src0_sel:DWORD src1_sel:WORD_0
    v_lshlrev_b32_sdwa v106, 3, v126 dst_sel:DWORD dst_unused:UNUSED_PAD src0_sel:DWORD src1_sel:WORD_1
    ds_read_b64 v[104:105], v104
    ds_read_b64 v[106:107], v106
    v_lshlrev_b32_sdwa v108, 3, v127 dst_sel:DWORD dst_unused:UNUSED_PAD src0_sel:DWORD src1_sel:WORD_0
    v_lshlrev_b32_sdwa v110, 3, v127 dst_sel:DWORD dst_unused:UNUSED_PAD src0_sel:DWORD src1_sel:WORD_1
    ds_read_b64 v[108:109], v108
    ds_read_b64 v[110:111], v110
    buffer_load_dwordx4 v[124:127], off, s[48:51], s20 offset:3072 sc1
    s_waitcnt lgkmcnt(8)
    v_smfmac_f32_16x16x64_bf16 v[44:47], v[64:67], v[88:95], v68
    v_exp_f32 v159, v159
    v_pk_fma_f32 v[156:157], v[34:35], v[154:155], v[156:157]
    v_pk_mul_f32 v[164:165], v[40:41], v[40:41]
    v_exp_f32 v160, v160
    v_add_f32 v156, v156, v157
    v_pk_fma_f32 v[158:159], v[158:159], v[134:135], v[134:135]
    v_exp_f32 v161, v161
    buffer_store_dword v156, v70, s[12:15], s35 offen offset:2048 sc1
    s_waitcnt vmcnt(5)
    v_lshlrev_b32_sdwa v88, 3, v116 dst_sel:DWORD dst_unused:UNUSED_PAD src0_sel:DWORD src1_sel:WORD_0
    v_lshlrev_b32_sdwa v90, 3, v116 dst_sel:DWORD dst_unused:UNUSED_PAD src0_sel:DWORD src1_sel:WORD_1
    ds_read_b64 v[88:89], v88
    ds_read_b64 v[90:91], v90
    v_lshlrev_b32_sdwa v92, 3, v117 dst_sel:DWORD dst_unused:UNUSED_PAD src0_sel:DWORD src1_sel:WORD_0
    v_lshlrev_b32_sdwa v94, 3, v117 dst_sel:DWORD dst_unused:UNUSED_PAD src0_sel:DWORD src1_sel:WORD_1
    ds_read_b64 v[92:93], v92
    ds_read_b64 v[94:95], v94
    s_waitcnt lgkmcnt(8)
    v_smfmac_f32_16x16x64_bf16 v[48:51], v[64:67], v[96:103], v68
    v_rcp_f32 v158, v158
    v_pk_fma_f32 v[160:161], v[160:161], v[136:137], v[136:137]
    v_pk_fma_f32 v[164:165], v[164:165], v[128:129], v[130:131]
    v_rcp_f32 v159, v159
    v_pk_mul_f32 v[164:165], v[164:165], v[40:41]
    v_pk_mul_f32 v[166:167], v[42:43], v[42:43]
    v_rcp_f32 v160, v160
    v_pk_mul_f32 v[162:163], v[36:37], v[158:159]
    v_lshlrev_b32_sdwa v96, 3, v118 dst_sel:DWORD dst_unused:UNUSED_PAD src0_sel:DWORD src1_sel:WORD_0
    v_lshlrev_b32_sdwa v98, 3, v118 dst_sel:DWORD dst_unused:UNUSED_PAD src0_sel:DWORD src1_sel:WORD_1
    ds_read_b64 v[96:97], v96
    ds_read_b64 v[98:99], v98
    v_lshlrev_b32_sdwa v100, 3, v119 dst_sel:DWORD dst_unused:UNUSED_PAD src0_sel:DWORD src1_sel:WORD_0
    v_lshlrev_b32_sdwa v102, 3, v119 dst_sel:DWORD dst_unused:UNUSED_PAD src0_sel:DWORD src1_sel:WORD_1
    ds_read_b64 v[100:101], v100
    ds_read_b64 v[102:103], v102
    buffer_load_dwordx4 v[116:119], off, s[48:51], s41 offset:3072 sc1
    s_waitcnt lgkmcnt(8)
    v_smfmac_f32_16x16x64_bf16 v[52:55], v[64:67], v[104:111], v68
    v_rcp_f32 v161, v161
    v_pk_fma_f32 v[166:167], v[166:167], v[128:129], v[130:131]
    v_pk_mul_f32 v[170:171], v[44:45], v[44:45]
    v_exp_f32 v164, v164
    v_pk_fma_f32 v[162:163], v[38:39], v[160:161], v[162:163]
    v_pk_mul_f32 v[166:167], v[166:167], v[42:43]
    v_exp_f32 v165, v165
    v_add_f32 v162, v162, v163
    s_waitcnt vmcnt(4)
    v_lshlrev_b32_sdwa v104, 3, v120 dst_sel:DWORD dst_unused:UNUSED_PAD src0_sel:DWORD src1_sel:WORD_0
    v_lshlrev_b32_sdwa v106, 3, v120 dst_sel:DWORD dst_unused:UNUSED_PAD src0_sel:DWORD src1_sel:WORD_1
    ds_read_b64 v[104:105], v104
    ds_read_b64 v[106:107], v106
    v_lshlrev_b32_sdwa v108, 3, v121 dst_sel:DWORD dst_unused:UNUSED_PAD src0_sel:DWORD src1_sel:WORD_0
    v_lshlrev_b32_sdwa v110, 3, v121 dst_sel:DWORD dst_unused:UNUSED_PAD src0_sel:DWORD src1_sel:WORD_1
    ds_read_b64 v[108:109], v108
    ds_read_b64 v[110:111], v110
    s_waitcnt lgkmcnt(8)
    v_smfmac_f32_16x16x64_bf16 v[48:51], v[64:67], v[88:95], v68
    v_exp_f32 v166, v166
    buffer_store_dword v162, v70, s[12:15], s35 offen offset:2176 sc1
    v_pk_fma_f32 v[164:165], v[164:165], v[134:135], v[134:135]
    v_exp_f32 v167, v167
    v_pk_fma_f32 v[170:171], v[170:171], v[128:129], v[130:131]
    v_pk_mul_f32 v[172:173], v[46:47], v[46:47]
    v_rcp_f32 v164, v164
    v_pk_fma_f32 v[166:167], v[166:167], v[136:137], v[136:137]
    v_lshlrev_b32_sdwa v88, 3, v122 dst_sel:DWORD dst_unused:UNUSED_PAD src0_sel:DWORD src1_sel:WORD_0
    v_lshlrev_b32_sdwa v90, 3, v122 dst_sel:DWORD dst_unused:UNUSED_PAD src0_sel:DWORD src1_sel:WORD_1
    ds_read_b64 v[88:89], v88
    ds_read_b64 v[90:91], v90
    v_lshlrev_b32_sdwa v92, 3, v123 dst_sel:DWORD dst_unused:UNUSED_PAD src0_sel:DWORD src1_sel:WORD_0
    v_lshlrev_b32_sdwa v94, 3, v123 dst_sel:DWORD dst_unused:UNUSED_PAD src0_sel:DWORD src1_sel:WORD_1
    ds_read_b64 v[92:93], v92
    ds_read_b64 v[94:95], v94
    buffer_load_dwordx4 v[120:123], off, s[48:51], s45 offset:3072 sc1
    s_waitcnt lgkmcnt(8)
    v_smfmac_f32_16x16x64_bf16 v[52:55], v[64:67], v[96:103], v68
    v_rcp_f32 v165, v165
    v_pk_mul_f32 v[170:171], v[170:171], v[44:45]
    v_pk_fma_f32 v[172:173], v[172:173], v[128:129], v[130:131]
    v_rcp_f32 v166, v166
    v_pk_mul_f32 v[168:169], v[40:41], v[164:165]
    v_pk_mul_f32 v[172:173], v[172:173], v[46:47]
    v_rcp_f32 v167, v167
    v_exp_f32 v170, v170
    s_waitcnt vmcnt(4)
    v_lshlrev_b32_sdwa v96, 3, v124 dst_sel:DWORD dst_unused:UNUSED_PAD src0_sel:DWORD src1_sel:WORD_0
    v_lshlrev_b32_sdwa v98, 3, v124 dst_sel:DWORD dst_unused:UNUSED_PAD src0_sel:DWORD src1_sel:WORD_1
    ds_read_b64 v[96:97], v96
    ds_read_b64 v[98:99], v98
    v_lshlrev_b32_sdwa v100, 3, v125 dst_sel:DWORD dst_unused:UNUSED_PAD src0_sel:DWORD src1_sel:WORD_0
    v_lshlrev_b32_sdwa v102, 3, v125 dst_sel:DWORD dst_unused:UNUSED_PAD src0_sel:DWORD src1_sel:WORD_1
    ds_read_b64 v[100:101], v100
    ds_read_b64 v[102:103], v102
    s_waitcnt lgkmcnt(8)
    v_smfmac_f32_16x16x64_bf16 v[48:51], v[64:67], v[104:111], v68
    v_exp_f32 v171, v171
    v_pk_fma_f32 v[168:169], v[42:43], v[166:167], v[168:169]
    v_exp_f32 v172, v172
    v_add_f32 v168, v168, v169
    v_pk_fma_f32 v[170:171], v[170:171], v[134:135], v[134:135]
    v_exp_f32 v173, v173
    buffer_store_dword v168, v70, s[12:15], s35 offen offset:2560 sc1
    v_rcp_f32 v170, v170
    v_lshlrev_b32_sdwa v104, 3, v126 dst_sel:DWORD dst_unused:UNUSED_PAD src0_sel:DWORD src1_sel:WORD_0
    v_lshlrev_b32_sdwa v106, 3, v126 dst_sel:DWORD dst_unused:UNUSED_PAD src0_sel:DWORD src1_sel:WORD_1
    ds_read_b64 v[104:105], v104
    ds_read_b64 v[106:107], v106
    v_lshlrev_b32_sdwa v108, 3, v127 dst_sel:DWORD dst_unused:UNUSED_PAD src0_sel:DWORD src1_sel:WORD_0
    v_lshlrev_b32_sdwa v110, 3, v127 dst_sel:DWORD dst_unused:UNUSED_PAD src0_sel:DWORD src1_sel:WORD_1
    ds_read_b64 v[108:109], v108
    ds_read_b64 v[110:111], v110
    s_waitcnt lgkmcnt(8)
    v_smfmac_f32_16x16x64_bf16 v[52:55], v[64:67], v[88:95], v68
    s_setprio 0
    v_rcp_f32 v171, v171
    v_pk_fma_f32 v[172:173], v[172:173], v[136:137], v[136:137]
    v_pk_mul_f32 v[140:141], v[48:49], v[48:49]
    v_rcp_f32 v172, v172
    v_pk_mul_f32 v[174:175], v[44:45], v[170:171]
    v_pk_fma_f32 v[140:141], v[140:141], v[128:129], v[130:131]
    v_rcp_f32 v173, v173
    v_pk_mul_f32 v[140:141], v[140:141], v[48:49]
    s_waitcnt vmcnt(3)
    v_lshlrev_b32_sdwa v88, 3, v116 dst_sel:DWORD dst_unused:UNUSED_PAD src0_sel:DWORD src1_sel:WORD_0
    v_lshlrev_b32_sdwa v90, 3, v116 dst_sel:DWORD dst_unused:UNUSED_PAD src0_sel:DWORD src1_sel:WORD_1
    ds_read_b64 v[88:89], v88
    ds_read_b64 v[90:91], v90
    v_lshlrev_b32_sdwa v92, 3, v117 dst_sel:DWORD dst_unused:UNUSED_PAD src0_sel:DWORD src1_sel:WORD_0
    v_lshlrev_b32_sdwa v94, 3, v117 dst_sel:DWORD dst_unused:UNUSED_PAD src0_sel:DWORD src1_sel:WORD_1
    ds_read_b64 v[92:93], v92
    ds_read_b64 v[94:95], v94
    s_waitcnt lgkmcnt(8)
    v_smfmac_f32_16x16x64_bf16 v[56:59], v[64:67], v[96:103], v68
    v_exp_f32 v140, v140
    v_pk_fma_f32 v[174:175], v[46:47], v[172:173], v[174:175]
    v_pk_mul_f32 v[142:143], v[50:51], v[50:51]
    v_exp_f32 v141, v141
    v_add_f32 v174, v174, v175
    v_pk_fma_f32 v[142:143], v[142:143], v[128:129], v[130:131]
    buffer_store_dword v174, v70, s[12:15], s35 offen offset:2688 sc1
    v_pk_fma_f32 v[140:141], v[140:141], v[134:135], v[134:135]
    v_lshlrev_b32_sdwa v96, 3, v118 dst_sel:DWORD dst_unused:UNUSED_PAD src0_sel:DWORD src1_sel:WORD_0
    v_lshlrev_b32_sdwa v98, 3, v118 dst_sel:DWORD dst_unused:UNUSED_PAD src0_sel:DWORD src1_sel:WORD_1
    ds_read_b64 v[96:97], v96
    ds_read_b64 v[98:99], v98
    v_lshlrev_b32_sdwa v100, 3, v119 dst_sel:DWORD dst_unused:UNUSED_PAD src0_sel:DWORD src1_sel:WORD_0
    v_lshlrev_b32_sdwa v102, 3, v119 dst_sel:DWORD dst_unused:UNUSED_PAD src0_sel:DWORD src1_sel:WORD_1
    ds_read_b64 v[100:101], v100
    ds_read_b64 v[102:103], v102
    s_waitcnt lgkmcnt(8)
    v_smfmac_f32_16x16x64_bf16 v[60:63], v[64:67], v[104:111], v68
    v_rcp_f32 v140, v140
    v_pk_mul_f32 v[142:143], v[142:143], v[50:51]
    v_pk_mul_f32 v[146:147], v[52:53], v[52:53]
    v_rcp_f32 v141, v141
    v_pk_fma_f32 v[146:147], v[146:147], v[128:129], v[130:131]
    v_pk_mul_f32 v[148:149], v[54:55], v[54:55]
    v_exp_f32 v142, v142
    v_pk_mul_f32 v[144:145], v[48:49], v[140:141]
    s_waitcnt vmcnt(2)
    v_lshlrev_b32_sdwa v104, 3, v120 dst_sel:DWORD dst_unused:UNUSED_PAD src0_sel:DWORD src1_sel:WORD_0
    v_lshlrev_b32_sdwa v106, 3, v120 dst_sel:DWORD dst_unused:UNUSED_PAD src0_sel:DWORD src1_sel:WORD_1
    ds_read_b64 v[104:105], v104
    ds_read_b64 v[106:107], v106
    v_lshlrev_b32_sdwa v108, 3, v121 dst_sel:DWORD dst_unused:UNUSED_PAD src0_sel:DWORD src1_sel:WORD_0
    v_lshlrev_b32_sdwa v110, 3, v121 dst_sel:DWORD dst_unused:UNUSED_PAD src0_sel:DWORD src1_sel:WORD_1
    ds_read_b64 v[108:109], v108
    ds_read_b64 v[110:111], v110
    s_waitcnt lgkmcnt(8)
    v_smfmac_f32_16x16x64_bf16 v[56:59], v[64:67], v[88:95], v68
    v_exp_f32 v143, v143
    v_pk_mul_f32 v[146:147], v[146:147], v[52:53]
    v_pk_fma_f32 v[148:149], v[148:149], v[128:129], v[130:131]
    v_exp_f32 v146, v146
    v_pk_fma_f32 v[142:143], v[142:143], v[136:137], v[136:137]
    v_pk_mul_f32 v[148:149], v[148:149], v[54:55]
    v_rcp_f32 v142, v142
    v_rcp_f32 v143, v143
    v_lshlrev_b32_sdwa v88, 3, v122 dst_sel:DWORD dst_unused:UNUSED_PAD src0_sel:DWORD src1_sel:WORD_0
    v_lshlrev_b32_sdwa v90, 3, v122 dst_sel:DWORD dst_unused:UNUSED_PAD src0_sel:DWORD src1_sel:WORD_1
    ds_read_b64 v[88:89], v88
    ds_read_b64 v[90:91], v90
    v_lshlrev_b32_sdwa v92, 3, v123 dst_sel:DWORD dst_unused:UNUSED_PAD src0_sel:DWORD src1_sel:WORD_0
    v_lshlrev_b32_sdwa v94, 3, v123 dst_sel:DWORD dst_unused:UNUSED_PAD src0_sel:DWORD src1_sel:WORD_1
    ds_read_b64 v[92:93], v92
    ds_read_b64 v[94:95], v94
    s_waitcnt lgkmcnt(8)
    v_smfmac_f32_16x16x64_bf16 v[60:63], v[64:67], v[96:103], v68
    v_exp_f32 v147, v147
    v_pk_fma_f32 v[144:145], v[50:51], v[142:143], v[144:145]
    v_exp_f32 v148, v148
    v_add_f32 v144, v144, v145
    v_pk_fma_f32 v[146:147], v[146:147], v[134:135], v[134:135]
    v_exp_f32 v149, v149
    buffer_store_dword v144, v70, s[12:15], s35 offen offset:3072 sc1
    v_rcp_f32 v146, v146
    s_waitcnt lgkmcnt(4)
    v_smfmac_f32_16x16x64_bf16 v[56:59], v[64:67], v[104:111], v68
    s_setprio 3
    v_rcp_f32 v147, v147
    v_pk_fma_f32 v[148:149], v[148:149], v[136:137], v[136:137]
    s_waitcnt lgkmcnt(0)
    v_smfmac_f32_16x16x64_bf16 v[60:63], v[64:67], v[88:95], v68
    v_rcp_f32 v148, v148
    v_pk_mul_f32 v[150:151], v[52:53], v[146:147]
    v_rcp_f32 v149, v149
    s_nop 0
    s_nop 0
    v_pk_fma_f32 v[150:151], v[54:55], v[148:149], v[150:151]
    s_nop 0
    v_add_f32 v150, v150, v151
    v_pk_mul_f32 v[152:153], v[56:57], v[56:57]
    buffer_store_dword v150, v70, s[12:15], s35 offen offset:3200 sc1
    v_pk_fma_f32 v[152:153], v[152:153], v[128:129], v[130:131]
    v_pk_mul_f32 v[154:155], v[58:59], v[58:59]
    v_pk_mul_f32 v[152:153], v[152:153], v[56:57]
    v_pk_fma_f32 v[154:155], v[154:155], v[128:129], v[130:131]
    v_exp_f32 v152, v152
    v_pk_mul_f32 v[154:155], v[154:155], v[58:59]
    v_pk_mul_f32 v[158:159], v[60:61], v[60:61]
    v_exp_f32 v153, v153
    v_pk_fma_f32 v[158:159], v[158:159], v[128:129], v[130:131]
    v_pk_mul_f32 v[160:161], v[62:63], v[62:63]
    v_exp_f32 v154, v154
    v_pk_fma_f32 v[152:153], v[152:153], v[134:135], v[134:135]
    v_pk_mul_f32 v[158:159], v[158:159], v[60:61]
    v_rcp_f32 v152, v152
    v_pk_fma_f32 v[160:161], v[160:161], v[128:129], v[130:131]
    v_rcp_f32 v153, v153
    v_pk_mul_f32 v[160:161], v[160:161], v[62:63]
    v_exp_f32 v155, v155
    v_pk_mul_f32 v[156:157], v[56:57], v[152:153]
    v_exp_f32 v158, v158
    v_pk_fma_f32 v[154:155], v[154:155], v[136:137], v[136:137]
    v_exp_f32 v159, v159
    v_rcp_f32 v154, v154
    v_rcp_f32 v155, v155
    v_pk_fma_f32 v[158:159], v[158:159], v[134:135], v[134:135]
    v_exp_f32 v160, v160
    v_pk_fma_f32 v[156:157], v[58:59], v[154:155], v[156:157]
    v_rcp_f32 v158, v158
    v_add_f32 v156, v156, v157
    v_rcp_f32 v159, v159
    buffer_store_dword v156, v70, s[12:15], s35 offen offset:3584 sc1
    v_exp_f32 v161, v161
    v_pk_mul_f32 v[162:163], v[60:61], v[158:159]
    s_nop 0
    v_pk_fma_f32 v[160:161], v[160:161], v[136:137], v[136:137]
    s_nop 0
    v_rcp_f32 v160, v160
    v_rcp_f32 v161, v161
    s_nop 0
    s_nop 0
    v_pk_fma_f32 v[162:163], v[62:63], v[160:161], v[162:163]
    s_nop 0
    v_add_f32 v162, v162, v163
    s_nop 0
    buffer_store_dword v162, v70, s[12:15], s35 offen offset:3712 sc1
standalone__deep_cross_pnn__recsys_kernel_red:

    v_and_b32 v193, 0xf0, v69
    v_lshrrev_b32 v197, 8, v69
    v_lshl_or_b32 v192, v197, 16, v193
    v_lshrrev_b32 v198, 1, v197
    v_and_b32 v197, 1, v197
    v_lshl_or_b32 v193, v198, 2, v193
    v_lshl_or_b32 v193, v197, 3, v193
    v_mov_b32 v196, 0
    s_mov_b32 s65, 0

    s_lshl_b32 s68, s2, 8
    s_add_u32 s66, s68, 29360128
    s_add_u32 s67, s66, 65536
    s_add_u32 s60, s68, 20971520
    s_lshr_b32 s68, s68, 1

    s_lshl_b32 s61, s3, 20
    s_add_u32 s60, s60, s61

    s_add_u32 s61, s60, 262144
    s_add_u32 s62, s60, 524288
    s_add_u32 s63, s60, 786432

    s_mov_b32 s76, s56
    s_and_b32 s77, s57, 0xffff
    s_mov_b32 s78, 2
    s_mov_b32 s79, 0x00020000
    s_mov_b32 s72, s58
    s_and_b32 s73, s59, 0xffff
    s_mov_b32 s74, 32768
    s_mov_b32 s75, 0x00020000
    s_mov_b64 s[20:21], -1
    s_mov_b64 s[22:23], -1
    s_mov_b64 s[24:25], -1
    s_mov_b64 s[26:27], -1
    s_mov_b64 s[28:29], -1

    v_mov_b32 v216, -1
    buffer_load_short_d16_hi v196, v196, s[76:79], 0 offen
    s_bitcmp1_b32 s64, 30
    s_cbranch_scc0 standalone__deep_cross_pnn__recsys_kernel_rd

standalone__deep_cross_pnn__recsys_kernel_rp:
    s_mov_b64 exec, s[20:21]
    buffer_load_dwordx4 v[176:179], v192, s[12:15], s60 offen sc1
    s_mov_b64 exec, s[22:23]
    buffer_load_dwordx4 v[180:183], v192, s[12:15], s61 offen sc1
    s_mov_b64 exec, s[24:25]
    buffer_load_dwordx4 v[184:187], v192, s[12:15], s62 offen sc1
    s_mov_b64 exec, s[26:27]
    buffer_load_dwordx4 v[188:191], v192, s[12:15], s63 offen sc1
    s_mov_b64 exec, s[28:29]
    buffer_load_dword v194, v193, s[12:15], s66 offen sc1
    buffer_load_dword v195, v193, s[12:15], s67 offen sc1
    s_mov_b64 exec, -1
    s_waitcnt vmcnt(4)
    v_add_f32 v216, v176, v180
    v_add_f32 v217, v177, v181
    v_add_f32 v218, v178, v182
    v_add_f32 v219, v179, v183
    s_waitcnt vmcnt(2)
    v_add_f32 v220, v184, v188
    v_add_f32 v221, v185, v189
    v_add_f32 v222, v186, v190
    v_add_f32 v223, v187, v191
    v_add_f32 v216, v216, v220
    v_add_f32 v217, v217, v221
    v_add_f32 v218, v218, v222
    v_add_f32 v219, v219, v223

    s_nop 0
    v_permlane32_swap_b32 v216, v217
    v_permlane32_swap_b32 v218, v219
    v_add_f32 v216, v216, v217
    v_add_f32 v218, v218, v219
    s_nop 1
    v_permlane16_swap_b32 v216, v218
    s_nop 0
    v_add_f32 v216, v216, v218

    s_waitcnt vmcnt(0)
    v_add_f32 v201, v194, v195
    s_add_u32 s65, s65, 1
    v_add_f32 v197, v201, v216
    v_cmp_u_f32 vcc, v197, v197
    s_cbranch_vccz standalone__deep_cross_pnn__recsys_kernel_rd

    v_cmp_u_f32 s[20:21], v176, v177
    v_cmp_u_f32 vcc, v178, v179
    s_or_b64 s[20:21], s[20:21], vcc

    v_cmp_u_f32 s[22:23], v180, v181
    v_cmp_u_f32 vcc, v182, v183
    s_or_b64 s[22:23], s[22:23], vcc

    v_cmp_u_f32 s[24:25], v184, v185
    v_cmp_u_f32 vcc, v186, v187
    s_or_b64 s[24:25], s[24:25], vcc

    v_cmp_u_f32 s[26:27], v188, v189
    v_cmp_u_f32 vcc, v190, v191
    s_or_b64 s[26:27], s[26:27], vcc

    v_cmp_u_f32 s[28:29], v194, v195

    s_cmp_lt_u32 s65, 300
    s_cbranch_scc1 standalone__deep_cross_pnn__recsys_kernel_rp
    v_mov_b32 v216, -1

standalone__deep_cross_pnn__recsys_kernel_rd:

    v_lshrrev_b32 v197, 2, v69
    s_lshl_b32 s69, s3, 8
    v_add_u32 v198, s69, v197
    ds_write_b32 v198, v216
    v_mov_b32 v199, 0
    s_waitcnt vmcnt(0) lgkmcnt(0)

    s_barrier
    s_cmp_eq_u32 s3, 1
    s_cbranch_scc1 standalone__deep_cross_pnn__recsys_kernel_rc
    s_cmp_lg_u32 s3, 0
    s_cbranch_scc1 standalone__deep_cross_pnn__recsys_kernel_end

    ds_read_b32 v208, v197 offset:0
    ds_read_b32 v209, v197 offset:256
    ds_read_b32 v210, v197 offset:512
    ds_read_b32 v211, v197 offset:768
    ds_read_b32 v212, v197 offset:1024
    ds_read_b32 v213, v197 offset:1280
    ds_read_b32 v214, v197 offset:1536
    ds_read_b32 v215, v197 offset:1792
    s_waitcnt lgkmcnt(6)
    v_add_f32 v200, v208, v209
    s_waitcnt lgkmcnt(5)
    v_add_f32 v200, v200, v210
    s_waitcnt lgkmcnt(4)
    v_add_f32 v200, v200, v211
    s_waitcnt lgkmcnt(3)
    v_add_f32 v200, v200, v212
    s_waitcnt lgkmcnt(2)
    v_add_f32 v200, v200, v213
    s_waitcnt lgkmcnt(1)
    v_add_f32 v200, v200, v214
    s_waitcnt lgkmcnt(0)
    v_add_f32 v200, v200, v215

    v_cmp_u_f32 vcc, v200, v200
    s_cbranch_vccnz standalone__deep_cross_pnn__recsys_kernel_rf

    v_cvt_pk_bf16_f32 v197, v200, v201
    v_lshlrev_b32 v198, 16, v197
    v_and_b32 v197, 0xffff0000, v197
    v_add_f32 v198, v198, v196
    v_cvt_pk_bf16_f32 v198, v198, v198
    v_lshlrev_b32 v198, 16, v198
    v_add_f32 v198, v198, v197
    v_cvt_pk_bf16_f32 v198, v198, v198
    v_lshrrev_b32 v197, 1, v193
    buffer_store_short v198, v197, s[72:75], s68 offen

    s_endpgm
standalone__deep_cross_pnn__recsys_kernel_rf:

    s_lshr_b32 s69, s2, 5
    s_lshl_b32 s69, s69, 4
    s_lshl_b32 s70, 1, s2
    v_mov_b32 v198, s70
    s_mov_b64 exec, 1
    buffer_atomic_or v198, v199, s[52:55], s69 offen offset:136 sc0
    s_waitcnt vmcnt(0)

standalone__deep_cross_pnn__recsys_kernel_rc:

    s_mov_b64 exec, 0xff
    buffer_load_dwordx4 v[176:179], v69, s[52:55], 0 offen offset:128 sc1
    s_waitcnt vmcnt(0)
    v_cmp_ne_u32 vcc, 0, v178
    s_cbranch_vccz standalone__deep_cross_pnn__recsys_kernel_end
    v_cmp_ne_u32 vcc, -1, v176
    s_cbranch_vccnz standalone__deep_cross_pnn__recsys_kernel_end
    v_mov_b32 v199, v178
    s_mov_b64 exec, -1
    v_lshlrev_b32 v198, 3, v69
    s_mov_b32 s69, 14680064
    buffer_load_dwordx4 v[176:179], v198, s[12:15], s69 offen sc1
    s_waitcnt vmcnt(0)
    v_min3_u32 v198, v176, v177, v178
    v_min_u32 v198, v198, v179
    v_cmp_eq_u32 vcc, 0, v198
    s_cbranch_vccnz standalone__deep_cross_pnn__recsys_kernel_end

standalone__deep_cross_pnn__recsys_kernel_rn:

    v_cmp_ne_u32 vcc, 0, v199
    s_cbranch_vccz standalone__deep_cross_pnn__recsys_kernel_end
    s_ff1_i32_b64 s69, vcc
    s_mov_b32 m0, s69
    s_nop 3
    v_readlane_b32 s70, v199, s69
    s_ff1_i32_b32 s71, s70
    s_bitset0_b32 s70, s71
    s_nop 3
    v_writelane_b32 v199, s70, m0
    s_lshl_b32 s69, s69, 5
    s_add_u32 s69, s69, s71

    s_lshl_b32 s68, s69, 8
    s_add_u32 s66, s68, 29360128
    s_add_u32 s67, s66, 65536
    s_add_u32 s60, s68, 20971520
    s_lshr_b32 s68, s68, 1

    s_add_u32 s61, s60, 262144
    s_add_u32 s62, s60, 524288
    s_add_u32 s63, s60, 786432

    buffer_load_dword v194, v193, s[12:15], s66 offen sc1
    buffer_load_dword v195, v193, s[12:15], s67 offen sc1
    s_mov_b32 s65, 0
standalone__deep_cross_pnn__recsys_kernel_rw:
    buffer_load_dwordx4 v[176:179], v192, s[12:15], s60 offen sc1
    buffer_load_dwordx4 v[180:183], v192, s[12:15], s61 offen sc1
    buffer_load_dwordx4 v[184:187], v192, s[12:15], s62 offen sc1
    buffer_load_dwordx4 v[188:191], v192, s[12:15], s63 offen sc1
    s_waitcnt vmcnt(2)
    v_add_f32 v216, v176, v180
    v_add_f32 v217, v177, v181
    v_add_f32 v218, v178, v182
    v_add_f32 v219, v179, v183
    s_waitcnt vmcnt(0)
    v_add_f32 v220, v184, v188
    v_add_f32 v221, v185, v189
    v_add_f32 v222, v186, v190
    v_add_f32 v223, v187, v191
    v_add_f32 v216, v216, v220
    v_add_f32 v217, v217, v221
    v_add_f32 v218, v218, v222
    v_add_f32 v219, v219, v223

    s_nop 0
    v_permlane32_swap_b32 v216, v217
    v_permlane32_swap_b32 v218, v219
    v_add_f32 v216, v216, v217
    v_add_f32 v218, v218, v219
    s_nop 1
    v_permlane16_swap_b32 v216, v218
    s_nop 0
    v_add_f32 v216, v216, v218

    s_mov_b32 s70, 0xff800001
    s_mov_b64 s[20:21], 0
    v_cmp_eq_u32 vcc, s70, v194
    s_or_b64 s[20:21], s[20:21], vcc
    v_cmp_eq_u32 vcc, s70, v195
    s_or_b64 s[20:21], s[20:21], vcc
    v_cmp_eq_u32 vcc, s70, v176
    s_or_b64 s[20:21], s[20:21], vcc
    v_cmp_eq_u32 vcc, s70, v177
    s_or_b64 s[20:21], s[20:21], vcc
    v_cmp_eq_u32 vcc, s70, v178
    s_or_b64 s[20:21], s[20:21], vcc
    v_cmp_eq_u32 vcc, s70, v179
    s_or_b64 s[20:21], s[20:21], vcc
    v_cmp_eq_u32 vcc, s70, v180
    s_or_b64 s[20:21], s[20:21], vcc
    v_cmp_eq_u32 vcc, s70, v181
    s_or_b64 s[20:21], s[20:21], vcc
    v_cmp_eq_u32 vcc, s70, v182
    s_or_b64 s[20:21], s[20:21], vcc
    v_cmp_eq_u32 vcc, s70, v183
    s_or_b64 s[20:21], s[20:21], vcc
    v_cmp_eq_u32 vcc, s70, v184
    s_or_b64 s[20:21], s[20:21], vcc
    v_cmp_eq_u32 vcc, s70, v185
    s_or_b64 s[20:21], s[20:21], vcc
    v_cmp_eq_u32 vcc, s70, v186
    s_or_b64 s[20:21], s[20:21], vcc
    v_cmp_eq_u32 vcc, s70, v187
    s_or_b64 s[20:21], s[20:21], vcc
    v_cmp_eq_u32 vcc, s70, v188
    s_or_b64 s[20:21], s[20:21], vcc
    v_cmp_eq_u32 vcc, s70, v189
    s_or_b64 s[20:21], s[20:21], vcc
    v_cmp_eq_u32 vcc, s70, v190
    s_or_b64 s[20:21], s[20:21], vcc
    v_cmp_eq_u32 vcc, s70, v191
    s_or_b64 s[20:21], s[20:21], vcc

    s_cbranch_scc1 standalone__deep_cross_pnn__recsys_kernel_end
    s_cmp_eq_u32 s65, 0
    s_cselect_b64 vcc, -1, 0
    v_add_f32 v200, v200, v216
    v_cndmask_b32 v200, v200, v216, vcc
    s_add_u32 s60, s60, 1048576
    s_add_u32 s61, s61, 1048576
    s_add_u32 s62, s62, 1048576
    s_add_u32 s63, s63, 1048576
    s_add_u32 s65, s65, 1
    s_cmp_lt_u32 s65, 8
    s_cbranch_scc1 standalone__deep_cross_pnn__recsys_kernel_rw
    v_add_f32 v201, v194, v195

    v_cvt_pk_bf16_f32 v197, v200, v201
    v_lshlrev_b32 v198, 16, v197
    v_and_b32 v197, 0xffff0000, v197
    v_add_f32 v198, v198, v196
    v_cvt_pk_bf16_f32 v198, v198, v198
    v_lshlrev_b32 v198, 16, v198
    v_add_f32 v198, v198, v197
    v_cvt_pk_bf16_f32 v198, v198, v198
    v_lshrrev_b32 v197, 1, v193
    buffer_store_short v198, v197, s[72:75], s68 offen

    s_nop 1
    s_branch standalone__deep_cross_pnn__recsys_kernel_rn
standalone__deep_cross_pnn__recsys_kernel_k2x:
    s_waitcnt lgkmcnt(0)
standalone__deep_cross_pnn__recsys_kernelx_gloop:
    s_waitcnt vmcnt(6)
    v_lshlrev_b32_sdwa v104, 3, v120 dst_sel:DWORD dst_unused:UNUSED_PAD src0_sel:DWORD src1_sel:WORD_0
    v_lshlrev_b32_sdwa v106, 3, v120 dst_sel:DWORD dst_unused:UNUSED_PAD src0_sel:DWORD src1_sel:WORD_1
    ds_read_b64 v[104:105], v104
    ds_read_b64 v[106:107], v106
    v_lshlrev_b32_sdwa v108, 3, v121 dst_sel:DWORD dst_unused:UNUSED_PAD src0_sel:DWORD src1_sel:WORD_0
    v_lshlrev_b32_sdwa v110, 3, v121 dst_sel:DWORD dst_unused:UNUSED_PAD src0_sel:DWORD src1_sel:WORD_1
    ds_read_b64 v[108:109], v108
    ds_read_b64 v[110:111], v110
    s_waitcnt lgkmcnt(10)
    v_smfmac_f32_16x16x64_bf16 v[0:3], v[64:67], v[88:95], v68
    v_lshlrev_b32_sdwa v88, 3, v122 dst_sel:DWORD dst_unused:UNUSED_PAD src0_sel:DWORD src1_sel:WORD_0
    v_lshlrev_b32_sdwa v90, 3, v122 dst_sel:DWORD dst_unused:UNUSED_PAD src0_sel:DWORD src1_sel:WORD_1
    ds_read_b64 v[88:89], v88
    ds_read_b64 v[90:91], v90
    v_lshlrev_b32_sdwa v92, 3, v123 dst_sel:DWORD dst_unused:UNUSED_PAD src0_sel:DWORD src1_sel:WORD_0
    v_lshlrev_b32_sdwa v94, 3, v123 dst_sel:DWORD dst_unused:UNUSED_PAD src0_sel:DWORD src1_sel:WORD_1
    ds_read_b64 v[92:93], v92
    ds_read_addtid_b32 v71 offset:8080
    ds_read_b64 v[94:95], v94
    s_waitcnt lgkmcnt(9)
    v_smfmac_f32_16x16x64_bf16 v[4:7], v[64:67], v[96:103], v68
    buffer_load_dwordx4 v[120:123], off, s[48:51], s20 offset:0 sc1
    s_waitcnt vmcnt(6)
    v_mfma_f32_16x16x32_bf16 v[112:115], v[72:75], v[128:131], 0
    s_waitcnt vmcnt(5)
    v_lshlrev_b32_sdwa v96, 3, v124 dst_sel:DWORD dst_unused:UNUSED_PAD src0_sel:DWORD src1_sel:WORD_0
    v_lshlrev_b32_sdwa v98, 3, v124 dst_sel:DWORD dst_unused:UNUSED_PAD src0_sel:DWORD src1_sel:WORD_1
    ds_read_b64 v[96:97], v96
    ds_read_b64 v[98:99], v98
    s_waitcnt vmcnt(4)
    v_mfma_f32_16x16x32_bf16 v[112:115], v[76:79], v[132:135], v[112:115]
    v_lshlrev_b32_sdwa v100, 3, v125 dst_sel:DWORD dst_unused:UNUSED_PAD src0_sel:DWORD src1_sel:WORD_0
    v_lshlrev_b32_sdwa v102, 3, v125 dst_sel:DWORD dst_unused:UNUSED_PAD src0_sel:DWORD src1_sel:WORD_1
    ds_read_b64 v[100:101], v100
    ds_read_b64 v[102:103], v102
    s_waitcnt lgkmcnt(9)
    v_smfmac_f32_16x16x64_bf16 v[8:11], v[64:67], v[104:111], v68
    s_waitcnt vmcnt(3)
    v_mfma_f32_16x16x32_bf16 v[112:115], v[80:83], v[136:139], v[112:115]
    v_lshlrev_b32_sdwa v104, 3, v126 dst_sel:DWORD dst_unused:UNUSED_PAD src0_sel:DWORD src1_sel:WORD_0
    v_lshlrev_b32_sdwa v106, 3, v126 dst_sel:DWORD dst_unused:UNUSED_PAD src0_sel:DWORD src1_sel:WORD_1
    ds_read_b64 v[104:105], v104
    ds_read_b64 v[106:107], v106
    s_waitcnt vmcnt(2)
    v_mfma_f32_16x16x32_bf16 v[112:115], v[84:87], v[140:143], v[112:115]
    v_lshlrev_b32_sdwa v108, 3, v127 dst_sel:DWORD dst_unused:UNUSED_PAD src0_sel:DWORD src1_sel:WORD_0
    v_lshlrev_b32_sdwa v110, 3, v127 dst_sel:DWORD dst_unused:UNUSED_PAD src0_sel:DWORD src1_sel:WORD_1
    ds_read_b64 v[108:109], v108
    ds_read_b64 v[110:111], v110
    s_waitcnt lgkmcnt(8)
    v_smfmac_f32_16x16x64_bf16 v[12:15], v[64:67], v[88:95], v68
    buffer_load_dwordx4 v[124:127], off, s[48:51], s20 offset:1024 sc1
    v_readfirstlane_b32 s36, v71
    v_cvt_pk_bf16_f32 v112, v112, v113
    v_cvt_pk_bf16_f32 v113, v114, v115
    s_cmp_lt_u32 s36, s37
    s_cbranch_scc1 standalone__deep_cross_pnn__recsys_kernelx_sp0
standalone__deep_cross_pnn__recsys_kernelx_sr0:
    s_add_u32 s37, s37, 512
    ds_write_b64 v70, v[112:113] offset:0
    v_mfma_f32_16x16x32_bf16 v[112:115], v[72:75], v[144:147], 0
    v_mfma_f32_16x16x32_bf16 v[112:115], v[76:79], v[148:151], v[112:115]
    s_waitcnt vmcnt(2)
    v_lshlrev_b32_sdwa v88, 3, v116 dst_sel:DWORD dst_unused:UNUSED_PAD src0_sel:DWORD src1_sel:WORD_0
    v_lshlrev_b32_sdwa v90, 3, v116 dst_sel:DWORD dst_unused:UNUSED_PAD src0_sel:DWORD src1_sel:WORD_1
    ds_read_b64 v[88:89], v88
    ds_read_b64 v[90:91], v90
    v_mfma_f32_16x16x32_bf16 v[112:115], v[80:83], v[152:155], v[112:115]
    v_mfma_f32_16x16x32_bf16 v[112:115], v[84:87], v[156:159], v[112:115]
    v_lshlrev_b32_sdwa v92, 3, v117 dst_sel:DWORD dst_unused:UNUSED_PAD src0_sel:DWORD src1_sel:WORD_0
    v_lshlrev_b32_sdwa v94, 3, v117 dst_sel:DWORD dst_unused:UNUSED_PAD src0_sel:DWORD src1_sel:WORD_1
    ds_read_b64 v[92:93], v92
    ds_read_b64 v[94:95], v94
    s_waitcnt lgkmcnt(9)
    v_smfmac_f32_16x16x64_bf16 v[16:19], v[64:67], v[96:103], v68
    s_nop 1
    v_cvt_pk_bf16_f32 v112, v112, v113
    v_cvt_pk_bf16_f32 v113, v114, v115
    ds_write_b64 v70, v[112:113] offset:128
    v_mfma_f32_16x16x32_bf16 v[112:115], v[72:75], v[160:163], 0
    v_lshlrev_b32_sdwa v96, 3, v118 dst_sel:DWORD dst_unused:UNUSED_PAD src0_sel:DWORD src1_sel:WORD_0
    v_lshlrev_b32_sdwa v98, 3, v118 dst_sel:DWORD dst_unused:UNUSED_PAD src0_sel:DWORD src1_sel:WORD_1
    ds_read_b64 v[96:97], v96
    ds_read_b64 v[98:99], v98
    v_mfma_f32_16x16x32_bf16 v[112:115], v[76:79], v[164:167], v[112:115]
    v_lshlrev_b32_sdwa v100, 3, v119 dst_sel:DWORD dst_unused:UNUSED_PAD src0_sel:DWORD src1_sel:WORD_0
    v_lshlrev_b32_sdwa v102, 3, v119 dst_sel:DWORD dst_unused:UNUSED_PAD src0_sel:DWORD src1_sel:WORD_1
    ds_read_b64 v[100:101], v100
    ds_read_b64 v[102:103], v102
    s_waitcnt lgkmcnt(10)
    v_smfmac_f32_16x16x64_bf16 v[20:23], v[64:67], v[104:111], v68
    buffer_load_dwordx4 v[116:119], off, s[48:51], s20 offset:2048 sc1
    s_setprio 2
    v_mfma_f32_16x16x32_bf16 v[112:115], v[80:83], v[168:171], v[112:115]
    s_waitcnt vmcnt(2)
    v_lshlrev_b32_sdwa v104, 3, v120 dst_sel:DWORD dst_unused:UNUSED_PAD src0_sel:DWORD src1_sel:WORD_0
    v_lshlrev_b32_sdwa v106, 3, v120 dst_sel:DWORD dst_unused:UNUSED_PAD src0_sel:DWORD src1_sel:WORD_1
    ds_read_b64 v[104:105], v104
    ds_read_b64 v[106:107], v106
    v_mfma_f32_16x16x32_bf16 v[112:115], v[84:87], v[172:175], v[112:115]
    v_lshlrev_b32_sdwa v108, 3, v121 dst_sel:DWORD dst_unused:UNUSED_PAD src0_sel:DWORD src1_sel:WORD_0
    v_lshlrev_b32_sdwa v110, 3, v121 dst_sel:DWORD dst_unused:UNUSED_PAD src0_sel:DWORD src1_sel:WORD_1
    ds_read_b64 v[108:109], v108
    ds_read_b64 v[110:111], v110
    s_waitcnt lgkmcnt(9)
    v_smfmac_f32_16x16x64_bf16 v[24:27], v[64:67], v[88:95], v68
    s_nop 1
    v_cvt_pk_bf16_f32 v112, v112, v113
    v_cvt_pk_bf16_f32 v113, v114, v115
    ds_write_b64 v70, v[112:113] offset:256
    v_mfma_f32_16x16x32_bf16 v[112:115], v[72:75], v[176:179], 0
    v_mfma_f32_16x16x32_bf16 v[112:115], v[76:79], v[180:183], v[112:115]
    v_lshlrev_b32_sdwa v88, 3, v122 dst_sel:DWORD dst_unused:UNUSED_PAD src0_sel:DWORD src1_sel:WORD_0
    v_lshlrev_b32_sdwa v90, 3, v122 dst_sel:DWORD dst_unused:UNUSED_PAD src0_sel:DWORD src1_sel:WORD_1
    ds_read_b64 v[88:89], v88
    ds_read_b64 v[90:91], v90
    v_mfma_f32_16x16x32_bf16 v[112:115], v[80:83], v[184:187], v[112:115]
    v_mfma_f32_16x16x32_bf16 v[112:115], v[84:87], v[188:191], v[112:115]
    v_lshlrev_b32_sdwa v92, 3, v123 dst_sel:DWORD dst_unused:UNUSED_PAD src0_sel:DWORD src1_sel:WORD_0
    v_lshlrev_b32_sdwa v94, 3, v123 dst_sel:DWORD dst_unused:UNUSED_PAD src0_sel:DWORD src1_sel:WORD_1
    ds_read_b64 v[92:93], v92
    ds_read_b64 v[94:95], v94
    s_waitcnt lgkmcnt(9) vmcnt(1)
    v_smfmac_f32_16x16x64_bf16 v[28:31], v[64:67], v[96:103], v68
    buffer_load_dwordx4 v[120:123], off, s[48:51], s20 offset:3072 sc1
    s_add_u32 s20, s20, 61440
    v_cvt_pk_bf16_f32 v112, v112, v113
    v_cvt_pk_bf16_f32 v113, v114, v115
    ds_write_b64 v70, v[112:113] offset:384
    v_mfma_f32_16x16x32_bf16 v[112:115], v[72:75], v[192:195], 0
    v_lshlrev_b32_sdwa v96, 3, v124 dst_sel:DWORD dst_unused:UNUSED_PAD src0_sel:DWORD src1_sel:WORD_0
    v_lshlrev_b32_sdwa v98, 3, v124 dst_sel:DWORD dst_unused:UNUSED_PAD src0_sel:DWORD src1_sel:WORD_1
    ds_read_b64 v[96:97], v96
    ds_read_b64 v[98:99], v98
    v_mfma_f32_16x16x32_bf16 v[112:115], v[76:79], v[196:199], v[112:115]
    v_lshlrev_b32_sdwa v100, 3, v125 dst_sel:DWORD dst_unused:UNUSED_PAD src0_sel:DWORD src1_sel:WORD_0
    v_lshlrev_b32_sdwa v102, 3, v125 dst_sel:DWORD dst_unused:UNUSED_PAD src0_sel:DWORD src1_sel:WORD_1
    ds_read_b64 v[100:101], v100
    ds_read_b64 v[102:103], v102
    s_waitcnt lgkmcnt(10)
    v_smfmac_f32_16x16x64_bf16 v[32:35], v[64:67], v[104:111], v68
    v_lshlrev_b32_sdwa v104, 3, v126 dst_sel:DWORD dst_unused:UNUSED_PAD src0_sel:DWORD src1_sel:WORD_0
    v_lshlrev_b32_sdwa v106, 3, v126 dst_sel:DWORD dst_unused:UNUSED_PAD src0_sel:DWORD src1_sel:WORD_1
    v_mfma_f32_16x16x32_bf16 v[112:115], v[80:83], v[200:203], v[112:115]
    ds_read_b64 v[104:105], v104
    ds_read_b64 v[106:107], v106
    v_mfma_f32_16x16x32_bf16 v[112:115], v[84:87], v[204:207], v[112:115]
    v_lshlrev_b32_sdwa v108, 3, v127 dst_sel:DWORD dst_unused:UNUSED_PAD src0_sel:DWORD src1_sel:WORD_0
    v_lshlrev_b32_sdwa v110, 3, v127 dst_sel:DWORD dst_unused:UNUSED_PAD src0_sel:DWORD src1_sel:WORD_1
    buffer_load_dwordx4 v[124:127], off, s[48:51], s20 offset:0 sc1
    ds_read_b64 v[108:109], v108
    ds_read_b64 v[110:111], v110
    s_waitcnt lgkmcnt(9) vmcnt(2)
    v_smfmac_f32_16x16x64_bf16 v[36:39], v[64:67], v[88:95], v68
    s_setprio 1
    v_cvt_pk_bf16_f32 v112, v112, v113
    v_cvt_pk_bf16_f32 v113, v114, v115
    ds_write_b64 v70, v[112:113] offset:512
    v_mfma_f32_16x16x32_bf16 v[112:115], v[72:75], v[208:211], 0
    v_mfma_f32_16x16x32_bf16 v[112:115], v[76:79], v[212:215], v[112:115]
    v_lshlrev_b32_sdwa v88, 3, v116 dst_sel:DWORD dst_unused:UNUSED_PAD src0_sel:DWORD src1_sel:WORD_0
    v_lshlrev_b32_sdwa v90, 3, v116 dst_sel:DWORD dst_unused:UNUSED_PAD src0_sel:DWORD src1_sel:WORD_1
    ds_read_b64 v[88:89], v88
    ds_read_b64 v[90:91], v90
    v_mfma_f32_16x16x32_bf16 v[112:115], v[80:83], v[216:219], v[112:115]
    v_mfma_f32_16x16x32_bf16 v[112:115], v[84:87], v[220:223], v[112:115]
    v_lshlrev_b32_sdwa v92, 3, v117 dst_sel:DWORD dst_unused:UNUSED_PAD src0_sel:DWORD src1_sel:WORD_0
    v_lshlrev_b32_sdwa v94, 3, v117 dst_sel:DWORD dst_unused:UNUSED_PAD src0_sel:DWORD src1_sel:WORD_1
    ds_read_b64 v[92:93], v92
    ds_read_b64 v[94:95], v94
    s_waitcnt lgkmcnt(9)
    v_smfmac_f32_16x16x64_bf16 v[40:43], v[64:67], v[96:103], v68
    v_lshlrev_b32_sdwa v96, 3, v118 dst_sel:DWORD dst_unused:UNUSED_PAD src0_sel:DWORD src1_sel:WORD_0
    v_lshlrev_b32_sdwa v98, 3, v118 dst_sel:DWORD dst_unused:UNUSED_PAD src0_sel:DWORD src1_sel:WORD_1
    v_cvt_pk_bf16_f32 v112, v112, v113
    v_cvt_pk_bf16_f32 v113, v114, v115
    ds_write_b64 v70, v[112:113] offset:640
    v_mfma_f32_16x16x32_bf16 v[112:115], v[72:75], v[224:227], 0
    ds_read_b64 v[96:97], v96
    ds_read_b64 v[98:99], v98
    v_lshlrev_b32_sdwa v100, 3, v119 dst_sel:DWORD dst_unused:UNUSED_PAD src0_sel:DWORD src1_sel:WORD_0
    v_lshlrev_b32_sdwa v102, 3, v119 dst_sel:DWORD dst_unused:UNUSED_PAD src0_sel:DWORD src1_sel:WORD_1
    v_mfma_f32_16x16x32_bf16 v[112:115], v[76:79], v[228:231], v[112:115]
    ds_read_b64 v[100:101], v100
    ds_read_b64 v[102:103], v102
    s_waitcnt lgkmcnt(10)
    v_smfmac_f32_16x16x64_bf16 v[44:47], v[64:67], v[104:111], v68
    buffer_load_dwordx4 v[116:119], off, s[48:51], s20 offset:1024 sc1
    s_waitcnt vmcnt(2)
    v_lshlrev_b32_sdwa v104, 3, v120 dst_sel:DWORD dst_unused:UNUSED_PAD src0_sel:DWORD src1_sel:WORD_0
    v_lshlrev_b32_sdwa v106, 3, v120 dst_sel:DWORD dst_unused:UNUSED_PAD src0_sel:DWORD src1_sel:WORD_1
    v_mfma_f32_16x16x32_bf16 v[112:115], v[80:83], v[232:235], v[112:115]
    ds_read_b64 v[104:105], v104
    ds_read_b64 v[106:107], v106
    v_lshlrev_b32_sdwa v108, 3, v121 dst_sel:DWORD dst_unused:UNUSED_PAD src0_sel:DWORD src1_sel:WORD_0
    v_lshlrev_b32_sdwa v110, 3, v121 dst_sel:DWORD dst_unused:UNUSED_PAD src0_sel:DWORD src1_sel:WORD_1
    v_mfma_f32_16x16x32_bf16 v[112:115], v[84:87], v[236:239], v[112:115]
    ds_read_b64 v[108:109], v108
    ds_read_b64 v[110:111], v110
    s_waitcnt lgkmcnt(9)
    v_smfmac_f32_16x16x64_bf16 v[48:51], v[64:67], v[88:95], v68
    v_lshlrev_b32_sdwa v88, 3, v122 dst_sel:DWORD dst_unused:UNUSED_PAD src0_sel:DWORD src1_sel:WORD_0
    v_lshlrev_b32_sdwa v90, 3, v122 dst_sel:DWORD dst_unused:UNUSED_PAD src0_sel:DWORD src1_sel:WORD_1
    s_nop 1
    v_cvt_pk_bf16_f32 v112, v112, v113
    v_cvt_pk_bf16_f32 v113, v114, v115
    ds_write_b64 v70, v[112:113] offset:768
    v_mfma_f32_16x16x32_bf16 v[112:115], v[72:75], v[240:243], 0
    buffer_load_dwordx4 v[72:75], off, s[48:51], s21 offset:0
    ds_read_b64 v[88:89], v88
    ds_read_b64 v[90:91], v90
    v_lshlrev_b32_sdwa v92, 3, v123 dst_sel:DWORD dst_unused:UNUSED_PAD src0_sel:DWORD src1_sel:WORD_0
    v_lshlrev_b32_sdwa v94, 3, v123 dst_sel:DWORD dst_unused:UNUSED_PAD src0_sel:DWORD src1_sel:WORD_1
    buffer_load_dwordx4 v[120:123], off, s[48:51], s20 offset:2048 sc1
    ds_read_b64 v[92:93], v92
    ds_read_b64 v[94:95], v94
    v_mfma_f32_16x16x32_bf16 v[112:115], v[76:79], v[244:247], v[112:115]
    buffer_load_dwordx4 v[76:79], off, s[48:51], s21 offset:1024
    s_waitcnt lgkmcnt(9)
    v_smfmac_f32_16x16x64_bf16 v[52:55], v[64:67], v[96:103], v68
    s_waitcnt vmcnt(4)
    v_lshlrev_b32_sdwa v96, 3, v124 dst_sel:DWORD dst_unused:UNUSED_PAD src0_sel:DWORD src1_sel:WORD_0
    v_lshlrev_b32_sdwa v98, 3, v124 dst_sel:DWORD dst_unused:UNUSED_PAD src0_sel:DWORD src1_sel:WORD_1
    ds_read_b64 v[96:97], v96
    ds_read_b64 v[98:99], v98
    v_mfma_f32_16x16x32_bf16 v[112:115], v[80:83], v[248:251], v[112:115]
    buffer_load_dwordx4 v[80:83], off, s[48:51], s19 offset:0
    v_lshlrev_b32_sdwa v100, 3, v125 dst_sel:DWORD dst_unused:UNUSED_PAD src0_sel:DWORD src1_sel:WORD_0
    v_lshlrev_b32_sdwa v102, 3, v125 dst_sel:DWORD dst_unused:UNUSED_PAD src0_sel:DWORD src1_sel:WORD_1
    v_mfma_f32_16x16x32_bf16 v[112:115], v[84:87], v[252:255], v[112:115]
    buffer_load_dwordx4 v[84:87], off, s[48:51], s19 offset:1024
    s_add_u32 s21, s21, 4096
    s_add_u32 s19, s19, 4096
    ds_read_b64 v[100:101], v100
    ds_read_b64 v[102:103], v102
    s_nop 2
    v_cvt_pk_bf16_f32 v112, v112, v113
    v_cvt_pk_bf16_f32 v113, v114, v115
    ds_write_b64 v70, v[112:113] offset:896
    ds_append v71 offset:8080
    s_add_u32 s23, s23, s23
    s_cselect_b32 s35, 4294836224, s32
    v_add_u32 v70, s35, v70
    s_waitcnt lgkmcnt(11)
    v_smfmac_f32_16x16x64_bf16 v[56:59], v[64:67], v[104:111], v68
    s_setprio 0
    v_lshlrev_b32_sdwa v104, 3, v126 dst_sel:DWORD dst_unused:UNUSED_PAD src0_sel:DWORD src1_sel:WORD_0
    v_lshlrev_b32_sdwa v106, 3, v126 dst_sel:DWORD dst_unused:UNUSED_PAD src0_sel:DWORD src1_sel:WORD_1
    ds_read_b64 v[104:105], v104
    ds_read_b64 v[106:107], v106
    v_lshlrev_b32_sdwa v108, 3, v127 dst_sel:DWORD dst_unused:UNUSED_PAD src0_sel:DWORD src1_sel:WORD_0
    v_lshlrev_b32_sdwa v110, 3, v127 dst_sel:DWORD dst_unused:UNUSED_PAD src0_sel:DWORD src1_sel:WORD_1
    buffer_load_dwordx4 v[124:127], off, s[48:51], s20 offset:3072 sc1
    s_add_u32 s20, s20, 4096
    ds_read_b64 v[108:109], v108
    ds_read_b64 v[110:111], v110
    s_waitcnt lgkmcnt(10)
    v_smfmac_f32_16x16x64_bf16 v[60:63], v[64:67], v[88:95], v68

    s_cmpk_eq_u32 s37, 11264
    s_cbranch_scc1 standalone__deep_cross_pnn__recsys_kernelx_fin

    s_waitcnt vmcnt(6)
    v_lshlrev_b32_sdwa v88, 3, v116 dst_sel:DWORD dst_unused:UNUSED_PAD src0_sel:DWORD src1_sel:WORD_0
    v_lshlrev_b32_sdwa v90, 3, v116 dst_sel:DWORD dst_unused:UNUSED_PAD src0_sel:DWORD src1_sel:WORD_1
    ds_read_b64 v[88:89], v88
    ds_read_b64 v[90:91], v90
    v_lshlrev_b32_sdwa v92, 3, v117 dst_sel:DWORD dst_unused:UNUSED_PAD src0_sel:DWORD src1_sel:WORD_0
    v_lshlrev_b32_sdwa v94, 3, v117 dst_sel:DWORD dst_unused:UNUSED_PAD src0_sel:DWORD src1_sel:WORD_1
    ds_read_b64 v[92:93], v92
    ds_read_b64 v[94:95], v94
    s_waitcnt lgkmcnt(10)
    v_smfmac_f32_16x16x64_bf16 v[0:3], v[64:67], v[96:103], v68
    v_lshlrev_b32_sdwa v96, 3, v118 dst_sel:DWORD dst_unused:UNUSED_PAD src0_sel:DWORD src1_sel:WORD_0
    v_lshlrev_b32_sdwa v98, 3, v118 dst_sel:DWORD dst_unused:UNUSED_PAD src0_sel:DWORD src1_sel:WORD_1
    ds_read_b64 v[96:97], v96
    ds_read_b64 v[98:99], v98
    v_lshlrev_b32_sdwa v100, 3, v119 dst_sel:DWORD dst_unused:UNUSED_PAD src0_sel:DWORD src1_sel:WORD_0
    v_lshlrev_b32_sdwa v102, 3, v119 dst_sel:DWORD dst_unused:UNUSED_PAD src0_sel:DWORD src1_sel:WORD_1
    ds_read_b64 v[100:101], v100
    ds_read_addtid_b32 v71 offset:8080
    ds_read_b64 v[102:103], v102
    s_waitcnt lgkmcnt(9)
    v_smfmac_f32_16x16x64_bf16 v[4:7], v[64:67], v[104:111], v68
    buffer_load_dwordx4 v[116:119], off, s[48:51], s20 offset:0 sc1
    s_waitcnt vmcnt(6)
    v_mfma_f32_16x16x32_bf16 v[112:115], v[72:75], v[128:131], 0
    s_waitcnt vmcnt(5)
    v_lshlrev_b32_sdwa v104, 3, v120 dst_sel:DWORD dst_unused:UNUSED_PAD src0_sel:DWORD src1_sel:WORD_0
    v_lshlrev_b32_sdwa v106, 3, v120 dst_sel:DWORD dst_unused:UNUSED_PAD src0_sel:DWORD src1_sel:WORD_1
    ds_read_b64 v[104:105], v104
    ds_read_b64 v[106:107], v106
    s_waitcnt vmcnt(4)
    v_mfma_f32_16x16x32_bf16 v[112:115], v[76:79], v[132:135], v[112:115]
    v_lshlrev_b32_sdwa v108, 3, v121 dst_sel:DWORD dst_unused:UNUSED_PAD src0_sel:DWORD src1_sel:WORD_0
    v_lshlrev_b32_sdwa v110, 3, v121 dst_sel:DWORD dst_unused:UNUSED_PAD src0_sel:DWORD src1_sel:WORD_1
    ds_read_b64 v[108:109], v108
    ds_read_b64 v[110:111], v110
    s_waitcnt lgkmcnt(9)
    v_smfmac_f32_16x16x64_bf16 v[8:11], v[64:67], v[88:95], v68
    s_waitcnt vmcnt(3)
    v_mfma_f32_16x16x32_bf16 v[112:115], v[80:83], v[136:139], v[112:115]
    v_lshlrev_b32_sdwa v88, 3, v122 dst_sel:DWORD dst_unused:UNUSED_PAD src0_sel:DWORD src1_sel:WORD_0
    v_lshlrev_b32_sdwa v90, 3, v122 dst_sel:DWORD dst_unused:UNUSED_PAD src0_sel:DWORD src1_sel:WORD_1
    ds_read_b64 v[88:89], v88
    ds_read_b64 v[90:91], v90
    s_waitcnt vmcnt(2)
    v_mfma_f32_16x16x32_bf16 v[112:115], v[84:87], v[140:143], v[112:115]
    v_lshlrev_b32_sdwa v92, 3, v123 dst_sel:DWORD dst_unused:UNUSED_PAD src0_sel:DWORD src1_sel:WORD_0
    v_lshlrev_b32_sdwa v94, 3, v123 dst_sel:DWORD dst_unused:UNUSED_PAD src0_sel:DWORD src1_sel:WORD_1
    ds_read_b64 v[92:93], v92
    ds_read_b64 v[94:95], v94
    s_waitcnt lgkmcnt(8)
    v_smfmac_f32_16x16x64_bf16 v[12:15], v[64:67], v[96:103], v68
    buffer_load_dwordx4 v[120:123], off, s[48:51], s20 offset:1024 sc1
    v_readfirstlane_b32 s36, v71
    v_cvt_pk_bf16_f32 v112, v112, v113
    v_cvt_pk_bf16_f32 v113, v114, v115
    s_cmp_lt_u32 s36, s37
    s_cbranch_scc1 standalone__deep_cross_pnn__recsys_kernelx_sp1
standalone__deep_cross_pnn__recsys_kernelx_sr1:
    s_add_u32 s37, s37, 512
    ds_write_b64 v70, v[112:113] offset:0
    v_mfma_f32_16x16x32_bf16 v[112:115], v[72:75], v[144:147], 0
    v_mfma_f32_16x16x32_bf16 v[112:115], v[76:79], v[148:151], v[112:115]
    s_waitcnt vmcnt(2)
    v_lshlrev_b32_sdwa v96, 3, v124 dst_sel:DWORD dst_unused:UNUSED_PAD src0_sel:DWORD src1_sel:WORD_0
    v_lshlrev_b32_sdwa v98, 3, v124 dst_sel:DWORD dst_unused:UNUSED_PAD src0_sel:DWORD src1_sel:WORD_1
    ds_read_b64 v[96:97], v96
    ds_read_b64 v[98:99], v98
    v_mfma_f32_16x16x32_bf16 v[112:115], v[80:83], v[152:155], v[112:115]
    v_mfma_f32_16x16x32_bf16 v[112:115], v[84:87], v[156:159], v[112:115]
    v_lshlrev_b32_sdwa v100, 3, v125 dst_sel:DWORD dst_unused:UNUSED_PAD src0_sel:DWORD src1_sel:WORD_0
    v_lshlrev_b32_sdwa v102, 3, v125 dst_sel:DWORD dst_unused:UNUSED_PAD src0_sel:DWORD src1_sel:WORD_1
    ds_read_b64 v[100:101], v100
    ds_read_b64 v[102:103], v102
    s_waitcnt lgkmcnt(9)
    v_smfmac_f32_16x16x64_bf16 v[16:19], v[64:67], v[104:111], v68
    s_nop 1
    v_cvt_pk_bf16_f32 v112, v112, v113
    v_cvt_pk_bf16_f32 v113, v114, v115
    ds_write_b64 v70, v[112:113] offset:128
    v_mfma_f32_16x16x32_bf16 v[112:115], v[72:75], v[160:163], 0
    v_lshlrev_b32_sdwa v104, 3, v126 dst_sel:DWORD dst_unused:UNUSED_PAD src0_sel:DWORD src1_sel:WORD_0
    v_lshlrev_b32_sdwa v106, 3, v126 dst_sel:DWORD dst_unused:UNUSED_PAD src0_sel:DWORD src1_sel:WORD_1
    ds_read_b64 v[104:105], v104
    ds_read_b64 v[106:107], v106
    v_mfma_f32_16x16x32_bf16 v[112:115], v[76:79], v[164:167], v[112:115]
    v_lshlrev_b32_sdwa v108, 3, v127 dst_sel:DWORD dst_unused:UNUSED_PAD src0_sel:DWORD src1_sel:WORD_0
    v_lshlrev_b32_sdwa v110, 3, v127 dst_sel:DWORD dst_unused:UNUSED_PAD src0_sel:DWORD src1_sel:WORD_1
    ds_read_b64 v[108:109], v108
    ds_read_b64 v[110:111], v110
    s_waitcnt lgkmcnt(10)
    v_smfmac_f32_16x16x64_bf16 v[20:23], v[64:67], v[88:95], v68
    buffer_load_dwordx4 v[124:127], off, s[48:51], s20 offset:2048 sc1
    s_setprio 2
    v_mfma_f32_16x16x32_bf16 v[112:115], v[80:83], v[168:171], v[112:115]
    s_waitcnt vmcnt(2)
    v_lshlrev_b32_sdwa v88, 3, v116 dst_sel:DWORD dst_unused:UNUSED_PAD src0_sel:DWORD src1_sel:WORD_0
    v_lshlrev_b32_sdwa v90, 3, v116 dst_sel:DWORD dst_unused:UNUSED_PAD src0_sel:DWORD src1_sel:WORD_1
    ds_read_b64 v[88:89], v88
    ds_read_b64 v[90:91], v90
    v_mfma_f32_16x16x32_bf16 v[112:115], v[84:87], v[172:175], v[112:115]
    v_lshlrev_b32_sdwa v92, 3, v117 dst_sel:DWORD dst_unused:UNUSED_PAD src0_sel:DWORD src1_sel:WORD_0
    v_lshlrev_b32_sdwa v94, 3, v117 dst_sel:DWORD dst_unused:UNUSED_PAD src0_sel:DWORD src1_sel:WORD_1
    ds_read_b64 v[92:93], v92
    ds_read_b64 v[94:95], v94
    s_waitcnt lgkmcnt(9)
    v_smfmac_f32_16x16x64_bf16 v[24:27], v[64:67], v[96:103], v68
    s_nop 1
    v_cvt_pk_bf16_f32 v112, v112, v113
    v_cvt_pk_bf16_f32 v113, v114, v115
    ds_write_b64 v70, v[112:113] offset:256
    v_mfma_f32_16x16x32_bf16 v[112:115], v[72:75], v[176:179], 0
    v_mfma_f32_16x16x32_bf16 v[112:115], v[76:79], v[180:183], v[112:115]
    v_lshlrev_b32_sdwa v96, 3, v118 dst_sel:DWORD dst_unused:UNUSED_PAD src0_sel:DWORD src1_sel:WORD_0
    v_lshlrev_b32_sdwa v98, 3, v118 dst_sel:DWORD dst_unused:UNUSED_PAD src0_sel:DWORD src1_sel:WORD_1
    ds_read_b64 v[96:97], v96
    ds_read_b64 v[98:99], v98
    v_mfma_f32_16x16x32_bf16 v[112:115], v[80:83], v[184:187], v[112:115]
    v_mfma_f32_16x16x32_bf16 v[112:115], v[84:87], v[188:191], v[112:115]
    v_lshlrev_b32_sdwa v100, 3, v119 dst_sel:DWORD dst_unused:UNUSED_PAD src0_sel:DWORD src1_sel:WORD_0
    v_lshlrev_b32_sdwa v102, 3, v119 dst_sel:DWORD dst_unused:UNUSED_PAD src0_sel:DWORD src1_sel:WORD_1
    ds_read_b64 v[100:101], v100
    ds_read_b64 v[102:103], v102
    s_waitcnt lgkmcnt(9) vmcnt(1)
    v_smfmac_f32_16x16x64_bf16 v[28:31], v[64:67], v[104:111], v68
    buffer_load_dwordx4 v[116:119], off, s[48:51], s20 offset:3072 sc1
    s_add_u32 s20, s20, 61440
    v_cvt_pk_bf16_f32 v112, v112, v113
    v_cvt_pk_bf16_f32 v113, v114, v115
    ds_write_b64 v70, v[112:113] offset:384
    v_mfma_f32_16x16x32_bf16 v[112:115], v[72:75], v[192:195], 0
    v_lshlrev_b32_sdwa v104, 3, v120 dst_sel:DWORD dst_unused:UNUSED_PAD src0_sel:DWORD src1_sel:WORD_0
    v_lshlrev_b32_sdwa v106, 3, v120 dst_sel:DWORD dst_unused:UNUSED_PAD src0_sel:DWORD src1_sel:WORD_1
    ds_read_b64 v[104:105], v104
    ds_read_b64 v[106:107], v106
    v_mfma_f32_16x16x32_bf16 v[112:115], v[76:79], v[196:199], v[112:115]
    v_lshlrev_b32_sdwa v108, 3, v121 dst_sel:DWORD dst_unused:UNUSED_PAD src0_sel:DWORD src1_sel:WORD_0
    v_lshlrev_b32_sdwa v110, 3, v121 dst_sel:DWORD dst_unused:UNUSED_PAD src0_sel:DWORD src1_sel:WORD_1
    ds_read_b64 v[108:109], v108
    ds_read_b64 v[110:111], v110
    s_waitcnt lgkmcnt(10)
    v_smfmac_f32_16x16x64_bf16 v[32:35], v[64:67], v[88:95], v68
    v_lshlrev_b32_sdwa v88, 3, v122 dst_sel:DWORD dst_unused:UNUSED_PAD src0_sel:DWORD src1_sel:WORD_0
    v_lshlrev_b32_sdwa v90, 3, v122 dst_sel:DWORD dst_unused:UNUSED_PAD src0_sel:DWORD src1_sel:WORD_1
    v_mfma_f32_16x16x32_bf16 v[112:115], v[80:83], v[200:203], v[112:115]
    ds_read_b64 v[88:89], v88
    ds_read_b64 v[90:91], v90
    v_mfma_f32_16x16x32_bf16 v[112:115], v[84:87], v[204:207], v[112:115]
    v_lshlrev_b32_sdwa v92, 3, v123 dst_sel:DWORD dst_unused:UNUSED_PAD src0_sel:DWORD src1_sel:WORD_0
    v_lshlrev_b32_sdwa v94, 3, v123 dst_sel:DWORD dst_unused:UNUSED_PAD src0_sel:DWORD src1_sel:WORD_1
    buffer_load_dwordx4 v[120:123], off, s[48:51], s20 offset:0 sc1
    ds_read_b64 v[92:93], v92
    ds_read_b64 v[94:95], v94
    s_waitcnt lgkmcnt(9) vmcnt(2)
    v_smfmac_f32_16x16x64_bf16 v[36:39], v[64:67], v[96:103], v68
    s_setprio 1
    v_cvt_pk_bf16_f32 v112, v112, v113
    v_cvt_pk_bf16_f32 v113, v114, v115
    ds_write_b64 v70, v[112:113] offset:512
    v_mfma_f32_16x16x32_bf16 v[112:115], v[72:75], v[208:211], 0
    v_mfma_f32_16x16x32_bf16 v[112:115], v[76:79], v[212:215], v[112:115]
    v_lshlrev_b32_sdwa v96, 3, v124 dst_sel:DWORD dst_unused:UNUSED_PAD src0_sel:DWORD src1_sel:WORD_0
    v_lshlrev_b32_sdwa v98, 3, v124 dst_sel:DWORD dst_unused:UNUSED_PAD src0_sel:DWORD src1_sel:WORD_1
    ds_read_b64 v[96:97], v96
    ds_read_b64 v[98:99], v98
    v_mfma_f32_16x16x32_bf16 v[112:115], v[80:83], v[216:219], v[112:115]
    v_mfma_f32_16x16x32_bf16 v[112:115], v[84:87], v[220:223], v[112:115]
    v_lshlrev_b32_sdwa v100, 3, v125 dst_sel:DWORD dst_unused:UNUSED_PAD src0_sel:DWORD src1_sel:WORD_0
    v_lshlrev_b32_sdwa v102, 3, v125 dst_sel:DWORD dst_unused:UNUSED_PAD src0_sel:DWORD src1_sel:WORD_1
    ds_read_b64 v[100:101], v100
    ds_read_b64 v[102:103], v102
    s_waitcnt lgkmcnt(9)
    v_smfmac_f32_16x16x64_bf16 v[40:43], v[64:67], v[104:111], v68
    v_lshlrev_b32_sdwa v104, 3, v126 dst_sel:DWORD dst_unused:UNUSED_PAD src0_sel:DWORD src1_sel:WORD_0
    v_lshlrev_b32_sdwa v106, 3, v126 dst_sel:DWORD dst_unused:UNUSED_PAD src0_sel:DWORD src1_sel:WORD_1
    v_cvt_pk_bf16_f32 v112, v112, v113
    v_cvt_pk_bf16_f32 v113, v114, v115
    ds_write_b64 v70, v[112:113] offset:640
    v_mfma_f32_16x16x32_bf16 v[112:115], v[72:75], v[224:227], 0
    ds_read_b64 v[104:105], v104
    ds_read_b64 v[106:107], v106
    v_lshlrev_b32_sdwa v108, 3, v127 dst_sel:DWORD dst_unused:UNUSED_PAD src0_sel:DWORD src1_sel:WORD_0
    v_lshlrev_b32_sdwa v110, 3, v127 dst_sel:DWORD dst_unused:UNUSED_PAD src0_sel:DWORD src1_sel:WORD_1
    v_mfma_f32_16x16x32_bf16 v[112:115], v[76:79], v[228:231], v[112:115]
    ds_read_b64 v[108:109], v108
    ds_read_b64 v[110:111], v110
    s_waitcnt lgkmcnt(10)
    v_smfmac_f32_16x16x64_bf16 v[44:47], v[64:67], v[88:95], v68
    buffer_load_dwordx4 v[124:127], off, s[48:51], s20 offset:1024 sc1
    s_waitcnt vmcnt(2)
    v_lshlrev_b32_sdwa v88, 3, v116 dst_sel:DWORD dst_unused:UNUSED_PAD src0_sel:DWORD src1_sel:WORD_0
    v_lshlrev_b32_sdwa v90, 3, v116 dst_sel:DWORD dst_unused:UNUSED_PAD src0_sel:DWORD src1_sel:WORD_1
    v_mfma_f32_16x16x32_bf16 v[112:115], v[80:83], v[232:235], v[112:115]
    ds_read_b64 v[88:89], v88
    ds_read_b64 v[90:91], v90
    v_lshlrev_b32_sdwa v92, 3, v117 dst_sel:DWORD dst_unused:UNUSED_PAD src0_sel:DWORD src1_sel:WORD_0
    v_lshlrev_b32_sdwa v94, 3, v117 dst_sel:DWORD dst_unused:UNUSED_PAD src0_sel:DWORD src1_sel:WORD_1
    v_mfma_f32_16x16x32_bf16 v[112:115], v[84:87], v[236:239], v[112:115]
    ds_read_b64 v[92:93], v92
    ds_read_b64 v[94:95], v94
    s_waitcnt lgkmcnt(9)
    v_smfmac_f32_16x16x64_bf16 v[48:51], v[64:67], v[96:103], v68
    v_lshlrev_b32_sdwa v96, 3, v118 dst_sel:DWORD dst_unused:UNUSED_PAD src0_sel:DWORD src1_sel:WORD_0
    v_lshlrev_b32_sdwa v98, 3, v118 dst_sel:DWORD dst_unused:UNUSED_PAD src0_sel:DWORD src1_sel:WORD_1
    s_nop 1
    v_cvt_pk_bf16_f32 v112, v112, v113
    v_cvt_pk_bf16_f32 v113, v114, v115
    ds_write_b64 v70, v[112:113] offset:768
    v_mfma_f32_16x16x32_bf16 v[112:115], v[72:75], v[240:243], 0
    buffer_load_dwordx4 v[72:75], off, s[48:51], s21 offset:0
    ds_read_b64 v[96:97], v96
    ds_read_b64 v[98:99], v98
    v_lshlrev_b32_sdwa v100, 3, v119 dst_sel:DWORD dst_unused:UNUSED_PAD src0_sel:DWORD src1_sel:WORD_0
    v_lshlrev_b32_sdwa v102, 3, v119 dst_sel:DWORD dst_unused:UNUSED_PAD src0_sel:DWORD src1_sel:WORD_1
    buffer_load_dwordx4 v[116:119], off, s[48:51], s20 offset:2048 sc1
    ds_read_b64 v[100:101], v100
    ds_read_b64 v[102:103], v102
    v_mfma_f32_16x16x32_bf16 v[112:115], v[76:79], v[244:247], v[112:115]
    buffer_load_dwordx4 v[76:79], off, s[48:51], s21 offset:1024
    s_waitcnt lgkmcnt(9)
    v_smfmac_f32_16x16x64_bf16 v[52:55], v[64:67], v[104:111], v68
    s_waitcnt vmcnt(4)
    v_lshlrev_b32_sdwa v104, 3, v120 dst_sel:DWORD dst_unused:UNUSED_PAD src0_sel:DWORD src1_sel:WORD_0
    v_lshlrev_b32_sdwa v106, 3, v120 dst_sel:DWORD dst_unused:UNUSED_PAD src0_sel:DWORD src1_sel:WORD_1
    ds_read_b64 v[104:105], v104
    ds_read_b64 v[106:107], v106
    v_mfma_f32_16x16x32_bf16 v[112:115], v[80:83], v[248:251], v[112:115]
    buffer_load_dwordx4 v[80:83], off, s[48:51], s19 offset:0
    v_lshlrev_b32_sdwa v108, 3, v121 dst_sel:DWORD dst_unused:UNUSED_PAD src0_sel:DWORD src1_sel:WORD_0
    v_lshlrev_b32_sdwa v110, 3, v121 dst_sel:DWORD dst_unused:UNUSED_PAD src0_sel:DWORD src1_sel:WORD_1
    v_mfma_f32_16x16x32_bf16 v[112:115], v[84:87], v[252:255], v[112:115]
    buffer_load_dwordx4 v[84:87], off, s[48:51], s19 offset:1024
    s_add_u32 s21, s21, 4096
    s_add_u32 s19, s19, 4096
    ds_read_b64 v[108:109], v108
    ds_read_b64 v[110:111], v110
    s_nop 2
    v_cvt_pk_bf16_f32 v112, v112, v113
    v_cvt_pk_bf16_f32 v113, v114, v115
    ds_write_b64 v70, v[112:113] offset:896
    ds_append v71 offset:8080
    s_add_u32 s23, s23, s23
    s_cselect_b32 s35, 4294836224, s32
    v_add_u32 v70, s35, v70
    s_waitcnt lgkmcnt(11)
    v_smfmac_f32_16x16x64_bf16 v[56:59], v[64:67], v[88:95], v68
    s_setprio 0
    v_lshlrev_b32_sdwa v88, 3, v122 dst_sel:DWORD dst_unused:UNUSED_PAD src0_sel:DWORD src1_sel:WORD_0
    v_lshlrev_b32_sdwa v90, 3, v122 dst_sel:DWORD dst_unused:UNUSED_PAD src0_sel:DWORD src1_sel:WORD_1
    ds_read_b64 v[88:89], v88
    ds_read_b64 v[90:91], v90
    v_lshlrev_b32_sdwa v92, 3, v123 dst_sel:DWORD dst_unused:UNUSED_PAD src0_sel:DWORD src1_sel:WORD_0
    v_lshlrev_b32_sdwa v94, 3, v123 dst_sel:DWORD dst_unused:UNUSED_PAD src0_sel:DWORD src1_sel:WORD_1
    buffer_load_dwordx4 v[120:123], off, s[48:51], s20 offset:3072 sc1
    s_add_u32 s20, s20, 4096
    ds_read_b64 v[92:93], v92
    ds_read_b64 v[94:95], v94
    s_waitcnt lgkmcnt(10)
    v_smfmac_f32_16x16x64_bf16 v[60:63], v[64:67], v[96:103], v68
    s_waitcnt vmcnt(6)
    v_lshlrev_b32_sdwa v96, 3, v124 dst_sel:DWORD dst_unused:UNUSED_PAD src0_sel:DWORD src1_sel:WORD_0
    v_lshlrev_b32_sdwa v98, 3, v124 dst_sel:DWORD dst_unused:UNUSED_PAD src0_sel:DWORD src1_sel:WORD_1
    ds_read_b64 v[96:97], v96
    ds_read_b64 v[98:99], v98
    v_lshlrev_b32_sdwa v100, 3, v125 dst_sel:DWORD dst_unused:UNUSED_PAD src0_sel:DWORD src1_sel:WORD_0
    v_lshlrev_b32_sdwa v102, 3, v125 dst_sel:DWORD dst_unused:UNUSED_PAD src0_sel:DWORD src1_sel:WORD_1
    ds_read_b64 v[100:101], v100
    ds_read_b64 v[102:103], v102
    s_waitcnt lgkmcnt(10)
    v_smfmac_f32_16x16x64_bf16 v[0:3], v[64:67], v[104:111], v68
    v_lshlrev_b32_sdwa v104, 3, v126 dst_sel:DWORD dst_unused:UNUSED_PAD src0_sel:DWORD src1_sel:WORD_0
    v_lshlrev_b32_sdwa v106, 3, v126 dst_sel:DWORD dst_unused:UNUSED_PAD src0_sel:DWORD src1_sel:WORD_1
    ds_read_b64 v[104:105], v104
    ds_read_b64 v[106:107], v106
    v_lshlrev_b32_sdwa v108, 3, v127 dst_sel:DWORD dst_unused:UNUSED_PAD src0_sel:DWORD src1_sel:WORD_0
    v_lshlrev_b32_sdwa v110, 3, v127 dst_sel:DWORD dst_unused:UNUSED_PAD src0_sel:DWORD src1_sel:WORD_1
    ds_read_b64 v[108:109], v108
    ds_read_addtid_b32 v71 offset:8080
    ds_read_b64 v[110:111], v110
    s_waitcnt lgkmcnt(9)
    v_smfmac_f32_16x16x64_bf16 v[4:7], v[64:67], v[88:95], v68
    buffer_load_dwordx4 v[124:127], off, s[48:51], s20 offset:0 sc1
    s_waitcnt vmcnt(6)
    v_mfma_f32_16x16x32_bf16 v[112:115], v[72:75], v[128:131], 0
    s_waitcnt vmcnt(5)
    v_lshlrev_b32_sdwa v88, 3, v116 dst_sel:DWORD dst_unused:UNUSED_PAD src0_sel:DWORD src1_sel:WORD_0
    v_lshlrev_b32_sdwa v90, 3, v116 dst_sel:DWORD dst_unused:UNUSED_PAD src0_sel:DWORD src1_sel:WORD_1
    ds_read_b64 v[88:89], v88
    ds_read_b64 v[90:91], v90
    s_waitcnt vmcnt(4)
    v_mfma_f32_16x16x32_bf16 v[112:115], v[76:79], v[132:135], v[112:115]
    v_lshlrev_b32_sdwa v92, 3, v117 dst_sel:DWORD dst_unused:UNUSED_PAD src0_sel:DWORD src1_sel:WORD_0
    v_lshlrev_b32_sdwa v94, 3, v117 dst_sel:DWORD dst_unused:UNUSED_PAD src0_sel:DWORD src1_sel:WORD_1
    ds_read_b64 v[92:93], v92
    ds_read_b64 v[94:95], v94
    s_waitcnt lgkmcnt(9)
    v_smfmac_f32_16x16x64_bf16 v[8:11], v[64:67], v[96:103], v68
    s_waitcnt vmcnt(3)
    v_mfma_f32_16x16x32_bf16 v[112:115], v[80:83], v[136:139], v[112:115]
    v_lshlrev_b32_sdwa v96, 3, v118 dst_sel:DWORD dst_unused:UNUSED_PAD src0_sel:DWORD src1_sel:WORD_0
    v_lshlrev_b32_sdwa v98, 3, v118 dst_sel:DWORD dst_unused:UNUSED_PAD src0_sel:DWORD src1_sel:WORD_1
    ds_read_b64 v[96:97], v96
    ds_read_b64 v[98:99], v98
    s_waitcnt vmcnt(2)
    v_mfma_f32_16x16x32_bf16 v[112:115], v[84:87], v[140:143], v[112:115]
    v_lshlrev_b32_sdwa v100, 3, v119 dst_sel:DWORD dst_unused:UNUSED_PAD src0_sel:DWORD src1_sel:WORD_0
    v_lshlrev_b32_sdwa v102, 3, v119 dst_sel:DWORD dst_unused:UNUSED_PAD src0_sel:DWORD src1_sel:WORD_1
    ds_read_b64 v[100:101], v100
    ds_read_b64 v[102:103], v102
    s_waitcnt lgkmcnt(8)
    v_smfmac_f32_16x16x64_bf16 v[12:15], v[64:67], v[104:111], v68
    buffer_load_dwordx4 v[116:119], off, s[48:51], s20 offset:1024 sc1
    v_readfirstlane_b32 s36, v71
    v_cvt_pk_bf16_f32 v112, v112, v113
    v_cvt_pk_bf16_f32 v113, v114, v115
    s_cmp_lt_u32 s36, s37
    s_cbranch_scc1 standalone__deep_cross_pnn__recsys_kernelx_sp2
standalone__deep_cross_pnn__recsys_kernelx_sr2:
    s_add_u32 s37, s37, 512
    ds_write_b64 v70, v[112:113] offset:0
    v_mfma_f32_16x16x32_bf16 v[112:115], v[72:75], v[144:147], 0
    v_mfma_f32_16x16x32_bf16 v[112:115], v[76:79], v[148:151], v[112:115]
    s_waitcnt vmcnt(2)
    v_lshlrev_b32_sdwa v104, 3, v120 dst_sel:DWORD dst_unused:UNUSED_PAD src0_sel:DWORD src1_sel:WORD_0
    v_lshlrev_b32_sdwa v106, 3, v120 dst_sel:DWORD dst_unused:UNUSED_PAD src0_sel:DWORD src1_sel:WORD_1
    ds_read_b64 v[104:105], v104
    ds_read_b64 v[106:107], v106
    v_mfma_f32_16x16x32_bf16 v[112:115], v[80:83], v[152:155], v[112:115]
    v_mfma_f32_16x16x32_bf16 v[112:115], v[84:87], v[156:159], v[112:115]
    v_lshlrev_b32_sdwa v108, 3, v121 dst_sel:DWORD dst_unused:UNUSED_PAD src0_sel:DWORD src1_sel:WORD_0
    v_lshlrev_b32_sdwa v110, 3, v121 dst_sel:DWORD dst_unused:UNUSED_PAD src0_sel:DWORD src1_sel:WORD_1
    ds_read_b64 v[108:109], v108
    ds_read_b64 v[110:111], v110
    s_waitcnt lgkmcnt(9)
    v_smfmac_f32_16x16x64_bf16 v[16:19], v[64:67], v[88:95], v68
    s_nop 1
    v_cvt_pk_bf16_f32 v112, v112, v113
    v_cvt_pk_bf16_f32 v113, v114, v115
    ds_write_b64 v70, v[112:113] offset:128
    v_mfma_f32_16x16x32_bf16 v[112:115], v[72:75], v[160:163], 0
    v_lshlrev_b32_sdwa v88, 3, v122 dst_sel:DWORD dst_unused:UNUSED_PAD src0_sel:DWORD src1_sel:WORD_0
    v_lshlrev_b32_sdwa v90, 3, v122 dst_sel:DWORD dst_unused:UNUSED_PAD src0_sel:DWORD src1_sel:WORD_1
    ds_read_b64 v[88:89], v88
    ds_read_b64 v[90:91], v90
    v_mfma_f32_16x16x32_bf16 v[112:115], v[76:79], v[164:167], v[112:115]
    v_lshlrev_b32_sdwa v92, 3, v123 dst_sel:DWORD dst_unused:UNUSED_PAD src0_sel:DWORD src1_sel:WORD_0
    v_lshlrev_b32_sdwa v94, 3, v123 dst_sel:DWORD dst_unused:UNUSED_PAD src0_sel:DWORD src1_sel:WORD_1
    ds_read_b64 v[92:93], v92
    ds_read_b64 v[94:95], v94
    s_waitcnt lgkmcnt(10)
    v_smfmac_f32_16x16x64_bf16 v[20:23], v[64:67], v[96:103], v68
    buffer_load_dwordx4 v[120:123], off, s[48:51], s20 offset:2048 sc1
    s_setprio 2
    v_mfma_f32_16x16x32_bf16 v[112:115], v[80:83], v[168:171], v[112:115]
    s_waitcnt vmcnt(2)
    v_lshlrev_b32_sdwa v96, 3, v124 dst_sel:DWORD dst_unused:UNUSED_PAD src0_sel:DWORD src1_sel:WORD_0
    v_lshlrev_b32_sdwa v98, 3, v124 dst_sel:DWORD dst_unused:UNUSED_PAD src0_sel:DWORD src1_sel:WORD_1
    ds_read_b64 v[96:97], v96
    ds_read_b64 v[98:99], v98
    v_mfma_f32_16x16x32_bf16 v[112:115], v[84:87], v[172:175], v[112:115]
    v_lshlrev_b32_sdwa v100, 3, v125 dst_sel:DWORD dst_unused:UNUSED_PAD src0_sel:DWORD src1_sel:WORD_0
    v_lshlrev_b32_sdwa v102, 3, v125 dst_sel:DWORD dst_unused:UNUSED_PAD src0_sel:DWORD src1_sel:WORD_1
    ds_read_b64 v[100:101], v100
    ds_read_b64 v[102:103], v102
    s_waitcnt lgkmcnt(9)
    v_smfmac_f32_16x16x64_bf16 v[24:27], v[64:67], v[104:111], v68
    s_nop 1
    v_cvt_pk_bf16_f32 v112, v112, v113
    v_cvt_pk_bf16_f32 v113, v114, v115
    ds_write_b64 v70, v[112:113] offset:256
    v_mfma_f32_16x16x32_bf16 v[112:115], v[72:75], v[176:179], 0
    v_mfma_f32_16x16x32_bf16 v[112:115], v[76:79], v[180:183], v[112:115]
    v_lshlrev_b32_sdwa v104, 3, v126 dst_sel:DWORD dst_unused:UNUSED_PAD src0_sel:DWORD src1_sel:WORD_0
    v_lshlrev_b32_sdwa v106, 3, v126 dst_sel:DWORD dst_unused:UNUSED_PAD src0_sel:DWORD src1_sel:WORD_1
    ds_read_b64 v[104:105], v104
    ds_read_b64 v[106:107], v106
    v_mfma_f32_16x16x32_bf16 v[112:115], v[80:83], v[184:187], v[112:115]
    v_mfma_f32_16x16x32_bf16 v[112:115], v[84:87], v[188:191], v[112:115]
    v_lshlrev_b32_sdwa v108, 3, v127 dst_sel:DWORD dst_unused:UNUSED_PAD src0_sel:DWORD src1_sel:WORD_0
    v_lshlrev_b32_sdwa v110, 3, v127 dst_sel:DWORD dst_unused:UNUSED_PAD src0_sel:DWORD src1_sel:WORD_1
    ds_read_b64 v[108:109], v108
    ds_read_b64 v[110:111], v110
    s_waitcnt lgkmcnt(9) vmcnt(1)
    v_smfmac_f32_16x16x64_bf16 v[28:31], v[64:67], v[88:95], v68
    buffer_load_dwordx4 v[124:127], off, s[48:51], s20 offset:3072 sc1
    s_add_u32 s20, s20, 61440
    v_cvt_pk_bf16_f32 v112, v112, v113
    v_cvt_pk_bf16_f32 v113, v114, v115
    ds_write_b64 v70, v[112:113] offset:384
    v_mfma_f32_16x16x32_bf16 v[112:115], v[72:75], v[192:195], 0
    v_lshlrev_b32_sdwa v88, 3, v116 dst_sel:DWORD dst_unused:UNUSED_PAD src0_sel:DWORD src1_sel:WORD_0
    v_lshlrev_b32_sdwa v90, 3, v116 dst_sel:DWORD dst_unused:UNUSED_PAD src0_sel:DWORD src1_sel:WORD_1
    ds_read_b64 v[88:89], v88
    ds_read_b64 v[90:91], v90
    v_mfma_f32_16x16x32_bf16 v[112:115], v[76:79], v[196:199], v[112:115]
    v_lshlrev_b32_sdwa v92, 3, v117 dst_sel:DWORD dst_unused:UNUSED_PAD src0_sel:DWORD src1_sel:WORD_0
    v_lshlrev_b32_sdwa v94, 3, v117 dst_sel:DWORD dst_unused:UNUSED_PAD src0_sel:DWORD src1_sel:WORD_1
    ds_read_b64 v[92:93], v92
    ds_read_b64 v[94:95], v94
    s_waitcnt lgkmcnt(10)
    v_smfmac_f32_16x16x64_bf16 v[32:35], v[64:67], v[96:103], v68
    v_lshlrev_b32_sdwa v96, 3, v118 dst_sel:DWORD dst_unused:UNUSED_PAD src0_sel:DWORD src1_sel:WORD_0
    v_lshlrev_b32_sdwa v98, 3, v118 dst_sel:DWORD dst_unused:UNUSED_PAD src0_sel:DWORD src1_sel:WORD_1
    v_mfma_f32_16x16x32_bf16 v[112:115], v[80:83], v[200:203], v[112:115]
    ds_read_b64 v[96:97], v96
    ds_read_b64 v[98:99], v98
    v_mfma_f32_16x16x32_bf16 v[112:115], v[84:87], v[204:207], v[112:115]
    v_lshlrev_b32_sdwa v100, 3, v119 dst_sel:DWORD dst_unused:UNUSED_PAD src0_sel:DWORD src1_sel:WORD_0
    v_lshlrev_b32_sdwa v102, 3, v119 dst_sel:DWORD dst_unused:UNUSED_PAD src0_sel:DWORD src1_sel:WORD_1
    buffer_load_dwordx4 v[116:119], off, s[48:51], s20 offset:0 sc1
    ds_read_b64 v[100:101], v100
    ds_read_b64 v[102:103], v102
    s_waitcnt lgkmcnt(9) vmcnt(2)
    v_smfmac_f32_16x16x64_bf16 v[36:39], v[64:67], v[104:111], v68
    s_setprio 1
    v_cvt_pk_bf16_f32 v112, v112, v113
    v_cvt_pk_bf16_f32 v113, v114, v115
    ds_write_b64 v70, v[112:113] offset:512
    v_mfma_f32_16x16x32_bf16 v[112:115], v[72:75], v[208:211], 0
    v_mfma_f32_16x16x32_bf16 v[112:115], v[76:79], v[212:215], v[112:115]
    v_lshlrev_b32_sdwa v104, 3, v120 dst_sel:DWORD dst_unused:UNUSED_PAD src0_sel:DWORD src1_sel:WORD_0
    v_lshlrev_b32_sdwa v106, 3, v120 dst_sel:DWORD dst_unused:UNUSED_PAD src0_sel:DWORD src1_sel:WORD_1
    ds_read_b64 v[104:105], v104
    ds_read_b64 v[106:107], v106
    v_mfma_f32_16x16x32_bf16 v[112:115], v[80:83], v[216:219], v[112:115]
    v_mfma_f32_16x16x32_bf16 v[112:115], v[84:87], v[220:223], v[112:115]
    v_lshlrev_b32_sdwa v108, 3, v121 dst_sel:DWORD dst_unused:UNUSED_PAD src0_sel:DWORD src1_sel:WORD_0
    v_lshlrev_b32_sdwa v110, 3, v121 dst_sel:DWORD dst_unused:UNUSED_PAD src0_sel:DWORD src1_sel:WORD_1
    ds_read_b64 v[108:109], v108
    ds_read_b64 v[110:111], v110
    s_waitcnt lgkmcnt(9)
    v_smfmac_f32_16x16x64_bf16 v[40:43], v[64:67], v[88:95], v68
    v_lshlrev_b32_sdwa v88, 3, v122 dst_sel:DWORD dst_unused:UNUSED_PAD src0_sel:DWORD src1_sel:WORD_0
    v_lshlrev_b32_sdwa v90, 3, v122 dst_sel:DWORD dst_unused:UNUSED_PAD src0_sel:DWORD src1_sel:WORD_1
    v_cvt_pk_bf16_f32 v112, v112, v113
    v_cvt_pk_bf16_f32 v113, v114, v115
    ds_write_b64 v70, v[112:113] offset:640
    v_mfma_f32_16x16x32_bf16 v[112:115], v[72:75], v[224:227], 0
    ds_read_b64 v[88:89], v88
    ds_read_b64 v[90:91], v90
    v_lshlrev_b32_sdwa v92, 3, v123 dst_sel:DWORD dst_unused:UNUSED_PAD src0_sel:DWORD src1_sel:WORD_0
    v_lshlrev_b32_sdwa v94, 3, v123 dst_sel:DWORD dst_unused:UNUSED_PAD src0_sel:DWORD src1_sel:WORD_1
    v_mfma_f32_16x16x32_bf16 v[112:115], v[76:79], v[228:231], v[112:115]
    ds_read_b64 v[92:93], v92
    ds_read_b64 v[94:95], v94
    s_waitcnt lgkmcnt(10)
    v_smfmac_f32_16x16x64_bf16 v[44:47], v[64:67], v[96:103], v68
    buffer_load_dwordx4 v[120:123], off, s[48:51], s20 offset:1024 sc1
    s_waitcnt vmcnt(2)
    v_lshlrev_b32_sdwa v96, 3, v124 dst_sel:DWORD dst_unused:UNUSED_PAD src0_sel:DWORD src1_sel:WORD_0
    v_lshlrev_b32_sdwa v98, 3, v124 dst_sel:DWORD dst_unused:UNUSED_PAD src0_sel:DWORD src1_sel:WORD_1
    v_mfma_f32_16x16x32_bf16 v[112:115], v[80:83], v[232:235], v[112:115]
    ds_read_b64 v[96:97], v96
    ds_read_b64 v[98:99], v98
    v_lshlrev_b32_sdwa v100, 3, v125 dst_sel:DWORD dst_unused:UNUSED_PAD src0_sel:DWORD src1_sel:WORD_0
    v_lshlrev_b32_sdwa v102, 3, v125 dst_sel:DWORD dst_unused:UNUSED_PAD src0_sel:DWORD src1_sel:WORD_1
    v_mfma_f32_16x16x32_bf16 v[112:115], v[84:87], v[236:239], v[112:115]
    ds_read_b64 v[100:101], v100
    ds_read_b64 v[102:103], v102
    s_waitcnt lgkmcnt(9)
    v_smfmac_f32_16x16x64_bf16 v[48:51], v[64:67], v[104:111], v68
    v_lshlrev_b32_sdwa v104, 3, v126 dst_sel:DWORD dst_unused:UNUSED_PAD src0_sel:DWORD src1_sel:WORD_0
    v_lshlrev_b32_sdwa v106, 3, v126 dst_sel:DWORD dst_unused:UNUSED_PAD src0_sel:DWORD src1_sel:WORD_1
    s_nop 1
    v_cvt_pk_bf16_f32 v112, v112, v113
    v_cvt_pk_bf16_f32 v113, v114, v115
    ds_write_b64 v70, v[112:113] offset:768
    v_mfma_f32_16x16x32_bf16 v[112:115], v[72:75], v[240:243], 0
    buffer_load_dwordx4 v[72:75], off, s[48:51], s21 offset:0
    ds_read_b64 v[104:105], v104
    ds_read_b64 v[106:107], v106
    v_lshlrev_b32_sdwa v108, 3, v127 dst_sel:DWORD dst_unused:UNUSED_PAD src0_sel:DWORD src1_sel:WORD_0
    v_lshlrev_b32_sdwa v110, 3, v127 dst_sel:DWORD dst_unused:UNUSED_PAD src0_sel:DWORD src1_sel:WORD_1
    buffer_load_dwordx4 v[124:127], off, s[48:51], s20 offset:2048 sc1
    ds_read_b64 v[108:109], v108
    ds_read_b64 v[110:111], v110
    v_mfma_f32_16x16x32_bf16 v[112:115], v[76:79], v[244:247], v[112:115]
    buffer_load_dwordx4 v[76:79], off, s[48:51], s21 offset:1024
    s_waitcnt lgkmcnt(9)
    v_smfmac_f32_16x16x64_bf16 v[52:55], v[64:67], v[88:95], v68
    s_waitcnt vmcnt(4)
    v_lshlrev_b32_sdwa v88, 3, v116 dst_sel:DWORD dst_unused:UNUSED_PAD src0_sel:DWORD src1_sel:WORD_0
    v_lshlrev_b32_sdwa v90, 3, v116 dst_sel:DWORD dst_unused:UNUSED_PAD src0_sel:DWORD src1_sel:WORD_1
    ds_read_b64 v[88:89], v88
    ds_read_b64 v[90:91], v90
    v_mfma_f32_16x16x32_bf16 v[112:115], v[80:83], v[248:251], v[112:115]
    buffer_load_dwordx4 v[80:83], off, s[48:51], s19 offset:0
    v_lshlrev_b32_sdwa v92, 3, v117 dst_sel:DWORD dst_unused:UNUSED_PAD src0_sel:DWORD src1_sel:WORD_0
    v_lshlrev_b32_sdwa v94, 3, v117 dst_sel:DWORD dst_unused:UNUSED_PAD src0_sel:DWORD src1_sel:WORD_1
    v_mfma_f32_16x16x32_bf16 v[112:115], v[84:87], v[252:255], v[112:115]
    buffer_load_dwordx4 v[84:87], off, s[48:51], s19 offset:1024
    s_add_u32 s21, s21, 4096
    s_add_u32 s19, s19, 4096
    ds_read_b64 v[92:93], v92
    ds_read_b64 v[94:95], v94
    s_nop 2
    v_cvt_pk_bf16_f32 v112, v112, v113
    v_cvt_pk_bf16_f32 v113, v114, v115
    ds_write_b64 v70, v[112:113] offset:896
    ds_append v71 offset:8080
    s_add_u32 s23, s23, s23
    s_cselect_b32 s35, 4294836224, s32
    v_add_u32 v70, s35, v70
    s_waitcnt lgkmcnt(11)
    v_smfmac_f32_16x16x64_bf16 v[56:59], v[64:67], v[96:103], v68
    s_setprio 0
    v_lshlrev_b32_sdwa v96, 3, v118 dst_sel:DWORD dst_unused:UNUSED_PAD src0_sel:DWORD src1_sel:WORD_0
    v_lshlrev_b32_sdwa v98, 3, v118 dst_sel:DWORD dst_unused:UNUSED_PAD src0_sel:DWORD src1_sel:WORD_1
    ds_read_b64 v[96:97], v96
    ds_read_b64 v[98:99], v98
    v_lshlrev_b32_sdwa v100, 3, v119 dst_sel:DWORD dst_unused:UNUSED_PAD src0_sel:DWORD src1_sel:WORD_0
    v_lshlrev_b32_sdwa v102, 3, v119 dst_sel:DWORD dst_unused:UNUSED_PAD src0_sel:DWORD src1_sel:WORD_1
    buffer_load_dwordx4 v[116:119], off, s[48:51], s20 offset:3072 sc1
    s_add_u32 s20, s20, 4096
    ds_read_b64 v[100:101], v100
    ds_read_b64 v[102:103], v102
    s_waitcnt lgkmcnt(10)
    v_smfmac_f32_16x16x64_bf16 v[60:63], v[64:67], v[104:111], v68

    s_branch standalone__deep_cross_pnn__recsys_kernelx_gloop

standalone__deep_cross_pnn__recsys_kernelx_sp0:
    s_sleep 1
    ds_read_addtid_b32 v71 offset:8080
    s_waitcnt lgkmcnt(0)
    v_readfirstlane_b32 s36, v71

    s_cmp_lt_u32 s36, s37
    s_cbranch_scc1 standalone__deep_cross_pnn__recsys_kernelx_sp0
    s_branch standalone__deep_cross_pnn__recsys_kernelx_sr0
standalone__deep_cross_pnn__recsys_kernelx_sp1:
    s_sleep 1
    ds_read_addtid_b32 v71 offset:8080
    s_waitcnt lgkmcnt(0)
    v_readfirstlane_b32 s36, v71

    s_cmp_lt_u32 s36, s37
    s_cbranch_scc1 standalone__deep_cross_pnn__recsys_kernelx_sp1
    s_branch standalone__deep_cross_pnn__recsys_kernelx_sr1
standalone__deep_cross_pnn__recsys_kernelx_sp2:
    s_sleep 1
    ds_read_addtid_b32 v71 offset:8080
    s_waitcnt lgkmcnt(0)
    v_readfirstlane_b32 s36, v71

    s_cmp_lt_u32 s36, s37
    s_cbranch_scc1 standalone__deep_cross_pnn__recsys_kernelx_sp2
    s_branch standalone__deep_cross_pnn__recsys_kernelx_sr2
standalone__deep_cross_pnn__recsys_kernelx_sp3:
    s_sleep 1
    ds_read_addtid_b32 v71 offset:8080
    s_waitcnt lgkmcnt(0)
    v_readfirstlane_b32 s36, v71

    s_cmp_lt_u32 s36, s37
    s_cbranch_scc1 standalone__deep_cross_pnn__recsys_kernelx_sp3
    s_branch standalone__deep_cross_pnn__recsys_kernelx_sr3
standalone__deep_cross_pnn__recsys_kernelx_fin:

    s_add_u32 s40, s20, 61440
    s_add_u32 s41, s20, 65536
    s_add_u32 s44, s20, 126976
    s_add_u32 s45, s20, 131072

    s_lshl_b32 s35, s33, 16
    s_lshl_b32 s42, s34, 15
    s_add_u32 s35, s35, s42
    s_lshl_b32 s42, s3, 12
    s_add_u32 s35, s35, s42
    s_add_u32 s35, s35, 20971520

    v_mov_b32 v128, 0xbdd2d3e8
    v_mov_b32 v129, 0xbdd2d3e8
    v_mov_b32 v130, 0xc0135761
    v_mov_b32 v131, 0xc0135761
    v_mov_b32 v132, 1.0
    v_mov_b32 v133, 1.0
    v_mov_b32 v134, s28
    v_mov_b32 v135, s29
    s_waitcnt vmcnt(6)
    v_lshlrev_b32_sdwa v88, 3, v116 dst_sel:DWORD dst_unused:UNUSED_PAD src0_sel:DWORD src1_sel:WORD_0
    v_lshlrev_b32_sdwa v90, 3, v116 dst_sel:DWORD dst_unused:UNUSED_PAD src0_sel:DWORD src1_sel:WORD_1
    ds_read_b64 v[88:89], v88
    ds_read_b64 v[90:91], v90
    v_lshlrev_b32_sdwa v92, 3, v117 dst_sel:DWORD dst_unused:UNUSED_PAD src0_sel:DWORD src1_sel:WORD_0
    v_lshlrev_b32_sdwa v94, 3, v117 dst_sel:DWORD dst_unused:UNUSED_PAD src0_sel:DWORD src1_sel:WORD_1
    ds_read_b64 v[92:93], v92
    ds_read_b64 v[94:95], v94
    s_waitcnt lgkmcnt(10)
    v_smfmac_f32_16x16x64_bf16 v[0:3], v[64:67], v[96:103], v68
    s_setprio 3
    v_mov_b32 v136, s30
    v_mov_b32 v137, s31
    v_lshrrev_b32 v70, 2, v69
    v_and_b32 v138, 128, v70
    v_add_u32 v70, v70, v138
    v_rcp_f32 v134, v134
    v_rcp_f32 v135, v135
    v_rcp_f32 v136, v136
    v_lshlrev_b32_sdwa v96, 3, v118 dst_sel:DWORD dst_unused:UNUSED_PAD src0_sel:DWORD src1_sel:WORD_0
    v_lshlrev_b32_sdwa v98, 3, v118 dst_sel:DWORD dst_unused:UNUSED_PAD src0_sel:DWORD src1_sel:WORD_1
    ds_read_b64 v[96:97], v96
    ds_read_b64 v[98:99], v98
    v_lshlrev_b32_sdwa v100, 3, v119 dst_sel:DWORD dst_unused:UNUSED_PAD src0_sel:DWORD src1_sel:WORD_0
    v_lshlrev_b32_sdwa v102, 3, v119 dst_sel:DWORD dst_unused:UNUSED_PAD src0_sel:DWORD src1_sel:WORD_1
    ds_read_b64 v[100:101], v100
    ds_read_b64 v[102:103], v102
    buffer_load_dwordx4 v[116:119], off, s[48:51], s40 offset:0 sc1
    s_waitcnt lgkmcnt(8)
    v_smfmac_f32_16x16x64_bf16 v[4:7], v[64:67], v[104:111], v68
    v_rcp_f32 v137, v137
    v_mov_b32 v132, 0x7f7fffff
    v_mov_b32 v133, 0xff7fffff
    v_med3_f32 v134, v134, v132, v133
    v_med3_f32 v135, v135, v132, v133
    v_med3_f32 v136, v136, v132, v133
    v_med3_f32 v137, v137, v132, v133
    s_waitcnt vmcnt(5)
    v_lshlrev_b32_sdwa v104, 3, v120 dst_sel:DWORD dst_unused:UNUSED_PAD src0_sel:DWORD src1_sel:WORD_0
    v_lshlrev_b32_sdwa v106, 3, v120 dst_sel:DWORD dst_unused:UNUSED_PAD src0_sel:DWORD src1_sel:WORD_1
    ds_read_b64 v[104:105], v104
    ds_read_b64 v[106:107], v106
    v_lshlrev_b32_sdwa v108, 3, v121 dst_sel:DWORD dst_unused:UNUSED_PAD src0_sel:DWORD src1_sel:WORD_0
    v_lshlrev_b32_sdwa v110, 3, v121 dst_sel:DWORD dst_unused:UNUSED_PAD src0_sel:DWORD src1_sel:WORD_1
    ds_read_b64 v[108:109], v108
    ds_read_b64 v[110:111], v110
    s_waitcnt lgkmcnt(8)
    v_smfmac_f32_16x16x64_bf16 v[8:11], v[64:67], v[88:95], v68
    v_lshlrev_b32_sdwa v88, 3, v122 dst_sel:DWORD dst_unused:UNUSED_PAD src0_sel:DWORD src1_sel:WORD_0
    v_lshlrev_b32_sdwa v90, 3, v122 dst_sel:DWORD dst_unused:UNUSED_PAD src0_sel:DWORD src1_sel:WORD_1
    ds_read_b64 v[88:89], v88
    ds_read_b64 v[90:91], v90
    ds_read_addtid_b32 v71 offset:8080
    v_lshlrev_b32_sdwa v92, 3, v123 dst_sel:DWORD dst_unused:UNUSED_PAD src0_sel:DWORD src1_sel:WORD_0
    v_lshlrev_b32_sdwa v94, 3, v123 dst_sel:DWORD dst_unused:UNUSED_PAD src0_sel:DWORD src1_sel:WORD_1
    ds_read_b64 v[92:93], v92
    ds_read_b64 v[94:95], v94
    buffer_load_dwordx4 v[120:123], off, s[48:51], s44 offset:0 sc1
    s_waitcnt lgkmcnt(9)
    v_smfmac_f32_16x16x64_bf16 v[12:15], v[64:67], v[96:103], v68
    s_waitcnt vmcnt(2)
    v_lshlrev_b32_sdwa v96, 3, v124 dst_sel:DWORD dst_unused:UNUSED_PAD src0_sel:DWORD src1_sel:WORD_0
    v_lshlrev_b32_sdwa v98, 3, v124 dst_sel:DWORD dst_unused:UNUSED_PAD src0_sel:DWORD src1_sel:WORD_1
    ds_read_b64 v[96:97], v96
    ds_read_b64 v[98:99], v98
    v_lshlrev_b32_sdwa v100, 3, v125 dst_sel:DWORD dst_unused:UNUSED_PAD src0_sel:DWORD src1_sel:WORD_0
    v_lshlrev_b32_sdwa v102, 3, v125 dst_sel:DWORD dst_unused:UNUSED_PAD src0_sel:DWORD src1_sel:WORD_1
    ds_read_b64 v[100:101], v100
    ds_read_b64 v[102:103], v102
    s_waitcnt lgkmcnt(9)
    v_smfmac_f32_16x16x64_bf16 v[16:19], v[64:67], v[104:111], v68
    v_lshlrev_b32_sdwa v104, 3, v126 dst_sel:DWORD dst_unused:UNUSED_PAD src0_sel:DWORD src1_sel:WORD_0
    v_lshlrev_b32_sdwa v106, 3, v126 dst_sel:DWORD dst_unused:UNUSED_PAD src0_sel:DWORD src1_sel:WORD_1
    ds_read_b64 v[104:105], v104
    ds_read_b64 v[106:107], v106
    v_lshlrev_b32_sdwa v108, 3, v127 dst_sel:DWORD dst_unused:UNUSED_PAD src0_sel:DWORD src1_sel:WORD_0
    v_lshlrev_b32_sdwa v110, 3, v127 dst_sel:DWORD dst_unused:UNUSED_PAD src0_sel:DWORD src1_sel:WORD_1
    ds_read_b64 v[108:109], v108
    ds_read_b64 v[110:111], v110
    buffer_load_dwordx4 v[124:127], off, s[48:51], s40 offset:1024 sc1
    s_waitcnt lgkmcnt(8)
    v_smfmac_f32_16x16x64_bf16 v[20:23], v[64:67], v[88:95], v68
    v_readfirstlane_b32 s36, v71
    s_waitcnt vmcnt(2)
    s_cmp_lt_u32 s36, s37
    s_cbranch_scc1 standalone__deep_cross_pnn__recsys_kernelx_sp3
standalone__deep_cross_pnn__recsys_kernelx_sr3:
    v_lshlrev_b32_sdwa v88, 3, v116 dst_sel:DWORD dst_unused:UNUSED_PAD src0_sel:DWORD src1_sel:WORD_0
    v_lshlrev_b32_sdwa v90, 3, v116 dst_sel:DWORD dst_unused:UNUSED_PAD src0_sel:DWORD src1_sel:WORD_1
    ds_read_b64 v[88:89], v88
    ds_read_b64 v[90:91], v90
    v_lshlrev_b32_sdwa v92, 3, v117 dst_sel:DWORD dst_unused:UNUSED_PAD src0_sel:DWORD src1_sel:WORD_0
    v_lshlrev_b32_sdwa v94, 3, v117 dst_sel:DWORD dst_unused:UNUSED_PAD src0_sel:DWORD src1_sel:WORD_1
    ds_read_b64 v[92:93], v92
    ds_read_b64 v[94:95], v94
    s_waitcnt lgkmcnt(8)
    v_smfmac_f32_16x16x64_bf16 v[24:27], v[64:67], v[96:103], v68
    v_lshlrev_b32_sdwa v96, 3, v118 dst_sel:DWORD dst_unused:UNUSED_PAD src0_sel:DWORD src1_sel:WORD_0
    v_lshlrev_b32_sdwa v98, 3, v118 dst_sel:DWORD dst_unused:UNUSED_PAD src0_sel:DWORD src1_sel:WORD_1
    ds_read_b64 v[96:97], v96
    ds_read_b64 v[98:99], v98
    v_lshlrev_b32_sdwa v100, 3, v119 dst_sel:DWORD dst_unused:UNUSED_PAD src0_sel:DWORD src1_sel:WORD_0
    v_lshlrev_b32_sdwa v102, 3, v119 dst_sel:DWORD dst_unused:UNUSED_PAD src0_sel:DWORD src1_sel:WORD_1
    ds_read_b64 v[100:101], v100
    ds_read_b64 v[102:103], v102
    buffer_load_dwordx4 v[116:119], off, s[48:51], s44 offset:1024 sc1
    s_waitcnt lgkmcnt(8)
    v_smfmac_f32_16x16x64_bf16 v[28:31], v[64:67], v[104:111], v68
    s_waitcnt vmcnt(2)
    v_lshlrev_b32_sdwa v104, 3, v120 dst_sel:DWORD dst_unused:UNUSED_PAD src0_sel:DWORD src1_sel:WORD_0
    v_lshlrev_b32_sdwa v106, 3, v120 dst_sel:DWORD dst_unused:UNUSED_PAD src0_sel:DWORD src1_sel:WORD_1
    ds_read_b64 v[104:105], v104
    ds_read_b64 v[106:107], v106
    v_lshlrev_b32_sdwa v108, 3, v121 dst_sel:DWORD dst_unused:UNUSED_PAD src0_sel:DWORD src1_sel:WORD_0
    v_lshlrev_b32_sdwa v110, 3, v121 dst_sel:DWORD dst_unused:UNUSED_PAD src0_sel:DWORD src1_sel:WORD_1
    ds_read_b64 v[108:109], v108
    ds_read_b64 v[110:111], v110
    s_waitcnt lgkmcnt(8)
    v_smfmac_f32_16x16x64_bf16 v[0:3], v[64:67], v[88:95], v68
    v_lshlrev_b32_sdwa v88, 3, v122 dst_sel:DWORD dst_unused:UNUSED_PAD src0_sel:DWORD src1_sel:WORD_0
    v_lshlrev_b32_sdwa v90, 3, v122 dst_sel:DWORD dst_unused:UNUSED_PAD src0_sel:DWORD src1_sel:WORD_1
    ds_read_b64 v[88:89], v88
    ds_read_b64 v[90:91], v90
    v_lshlrev_b32_sdwa v92, 3, v123 dst_sel:DWORD dst_unused:UNUSED_PAD src0_sel:DWORD src1_sel:WORD_0
    v_lshlrev_b32_sdwa v94, 3, v123 dst_sel:DWORD dst_unused:UNUSED_PAD src0_sel:DWORD src1_sel:WORD_1
    ds_read_b64 v[92:93], v92
    ds_read_b64 v[94:95], v94
    buffer_load_dwordx4 v[120:123], off, s[48:51], s40 offset:2048 sc1
    s_waitcnt lgkmcnt(8)
    v_smfmac_f32_16x16x64_bf16 v[4:7], v[64:67], v[96:103], v68
    s_waitcnt vmcnt(2)
    v_lshlrev_b32_sdwa v96, 3, v124 dst_sel:DWORD dst_unused:UNUSED_PAD src0_sel:DWORD src1_sel:WORD_0
    v_lshlrev_b32_sdwa v98, 3, v124 dst_sel:DWORD dst_unused:UNUSED_PAD src0_sel:DWORD src1_sel:WORD_1
    ds_read_b64 v[96:97], v96
    ds_read_b64 v[98:99], v98
    v_lshlrev_b32_sdwa v100, 3, v125 dst_sel:DWORD dst_unused:UNUSED_PAD src0_sel:DWORD src1_sel:WORD_0
    v_lshlrev_b32_sdwa v102, 3, v125 dst_sel:DWORD dst_unused:UNUSED_PAD src0_sel:DWORD src1_sel:WORD_1
    ds_read_b64 v[100:101], v100
    ds_read_b64 v[102:103], v102
    s_waitcnt lgkmcnt(8)
    v_smfmac_f32_16x16x64_bf16 v[0:3], v[64:67], v[104:111], v68
    v_lshlrev_b32_sdwa v104, 3, v126 dst_sel:DWORD dst_unused:UNUSED_PAD src0_sel:DWORD src1_sel:WORD_0
    v_lshlrev_b32_sdwa v106, 3, v126 dst_sel:DWORD dst_unused:UNUSED_PAD src0_sel:DWORD src1_sel:WORD_1
    ds_read_b64 v[104:105], v104
    ds_read_b64 v[106:107], v106
    v_lshlrev_b32_sdwa v108, 3, v127 dst_sel:DWORD dst_unused:UNUSED_PAD src0_sel:DWORD src1_sel:WORD_0
    v_lshlrev_b32_sdwa v110, 3, v127 dst_sel:DWORD dst_unused:UNUSED_PAD src0_sel:DWORD src1_sel:WORD_1
    ds_read_b64 v[108:109], v108
    ds_read_b64 v[110:111], v110
    buffer_load_dwordx4 v[124:127], off, s[48:51], s44 offset:2048 sc1
    s_waitcnt lgkmcnt(8)
    v_smfmac_f32_16x16x64_bf16 v[4:7], v[64:67], v[88:95], v68
    s_waitcnt vmcnt(2)
    v_lshlrev_b32_sdwa v88, 3, v116 dst_sel:DWORD dst_unused:UNUSED_PAD src0_sel:DWORD src1_sel:WORD_0
    v_lshlrev_b32_sdwa v90, 3, v116 dst_sel:DWORD dst_unused:UNUSED_PAD src0_sel:DWORD src1_sel:WORD_1
    ds_read_b64 v[88:89], v88
    ds_read_b64 v[90:91], v90
    v_lshlrev_b32_sdwa v92, 3, v117 dst_sel:DWORD dst_unused:UNUSED_PAD src0_sel:DWORD src1_sel:WORD_0
    v_lshlrev_b32_sdwa v94, 3, v117 dst_sel:DWORD dst_unused:UNUSED_PAD src0_sel:DWORD src1_sel:WORD_1
    ds_read_b64 v[92:93], v92
    ds_read_b64 v[94:95], v94
    s_waitcnt lgkmcnt(8)
    v_smfmac_f32_16x16x64_bf16 v[8:11], v[64:67], v[96:103], v68
    v_pk_mul_f32 v[140:141], v[0:1], v[0:1]
    v_pk_mul_f32 v[142:143], v[2:3], v[2:3]
    v_pk_fma_f32 v[140:141], v[140:141], v[128:129], v[130:131]
    v_pk_fma_f32 v[142:143], v[142:143], v[128:129], v[130:131]
    v_pk_mul_f32 v[140:141], v[140:141], v[0:1]
    v_pk_mul_f32 v[142:143], v[142:143], v[2:3]
    v_exp_f32 v140, v140
    v_pk_mul_f32 v[146:147], v[4:5], v[4:5]
    v_lshlrev_b32_sdwa v96, 3, v118 dst_sel:DWORD dst_unused:UNUSED_PAD src0_sel:DWORD src1_sel:WORD_0
    v_lshlrev_b32_sdwa v98, 3, v118 dst_sel:DWORD dst_unused:UNUSED_PAD src0_sel:DWORD src1_sel:WORD_1
    ds_read_b64 v[96:97], v96
    ds_read_b64 v[98:99], v98
    v_lshlrev_b32_sdwa v100, 3, v119 dst_sel:DWORD dst_unused:UNUSED_PAD src0_sel:DWORD src1_sel:WORD_0
    v_lshlrev_b32_sdwa v102, 3, v119 dst_sel:DWORD dst_unused:UNUSED_PAD src0_sel:DWORD src1_sel:WORD_1
    ds_read_b64 v[100:101], v100
    ds_read_b64 v[102:103], v102
    buffer_load_dwordx4 v[116:119], off, s[48:51], s40 offset:3072 sc1
    s_waitcnt lgkmcnt(8)
    v_smfmac_f32_16x16x64_bf16 v[12:15], v[64:67], v[104:111], v68
    v_exp_f32 v141, v141
    v_pk_fma_f32 v[146:147], v[146:147], v[128:129], v[130:131]
    v_pk_mul_f32 v[148:149], v[6:7], v[6:7]
    v_exp_f32 v142, v142
    v_pk_fma_f32 v[140:141], v[140:141], v[134:135], v[134:135]
    v_pk_mul_f32 v[146:147], v[146:147], v[4:5]
    v_rcp_f32 v140, v140
    v_pk_fma_f32 v[148:149], v[148:149], v[128:129], v[130:131]
    s_waitcnt vmcnt(2)
    v_lshlrev_b32_sdwa v104, 3, v120 dst_sel:DWORD dst_unused:UNUSED_PAD src0_sel:DWORD src1_sel:WORD_0
    v_lshlrev_b32_sdwa v106, 3, v120 dst_sel:DWORD dst_unused:UNUSED_PAD src0_sel:DWORD src1_sel:WORD_1
    ds_read_b64 v[104:105], v104
    ds_read_b64 v[106:107], v106
    v_lshlrev_b32_sdwa v108, 3, v121 dst_sel:DWORD dst_unused:UNUSED_PAD src0_sel:DWORD src1_sel:WORD_0
    v_lshlrev_b32_sdwa v110, 3, v121 dst_sel:DWORD dst_unused:UNUSED_PAD src0_sel:DWORD src1_sel:WORD_1
    ds_read_b64 v[108:109], v108
    ds_read_b64 v[110:111], v110
    s_waitcnt lgkmcnt(8)
    v_smfmac_f32_16x16x64_bf16 v[8:11], v[64:67], v[88:95], v68
    v_rcp_f32 v141, v141
    v_pk_mul_f32 v[148:149], v[148:149], v[6:7]
    v_exp_f32 v143, v143
    v_pk_mul_f32 v[144:145], v[0:1], v[140:141]
    v_exp_f32 v146, v146
    v_pk_fma_f32 v[142:143], v[142:143], v[136:137], v[136:137]
    v_exp_f32 v147, v147
    v_rcp_f32 v142, v142
    v_lshlrev_b32_sdwa v88, 3, v122 dst_sel:DWORD dst_unused:UNUSED_PAD src0_sel:DWORD src1_sel:WORD_0
    v_lshlrev_b32_sdwa v90, 3, v122 dst_sel:DWORD dst_unused:UNUSED_PAD src0_sel:DWORD src1_sel:WORD_1
    ds_read_b64 v[88:89], v88
    ds_read_b64 v[90:91], v90
    v_lshlrev_b32_sdwa v92, 3, v123 dst_sel:DWORD dst_unused:UNUSED_PAD src0_sel:DWORD src1_sel:WORD_0
    v_lshlrev_b32_sdwa v94, 3, v123 dst_sel:DWORD dst_unused:UNUSED_PAD src0_sel:DWORD src1_sel:WORD_1
    ds_read_b64 v[92:93], v92
    ds_read_b64 v[94:95], v94
    buffer_load_dwordx4 v[120:123], off, s[48:51], s44 offset:3072 sc1
    s_waitcnt lgkmcnt(8)
    v_smfmac_f32_16x16x64_bf16 v[12:15], v[64:67], v[96:103], v68
    v_rcp_f32 v143, v143
    v_pk_fma_f32 v[146:147], v[146:147], v[134:135], v[134:135]
    v_pk_mul_f32 v[152:153], v[8:9], v[8:9]
    v_rcp_f32 v146, v146
    v_pk_fma_f32 v[144:145], v[2:3], v[142:143], v[144:145]
    v_pk_fma_f32 v[152:153], v[152:153], v[128:129], v[130:131]
    v_rcp_f32 v147, v147
    v_add_f32 v144, v144, v145
    s_waitcnt vmcnt(2)
    v_lshlrev_b32_sdwa v96, 3, v124 dst_sel:DWORD dst_unused:UNUSED_PAD src0_sel:DWORD src1_sel:WORD_0
    v_lshlrev_b32_sdwa v98, 3, v124 dst_sel:DWORD dst_unused:UNUSED_PAD src0_sel:DWORD src1_sel:WORD_1
    ds_read_b64 v[96:97], v96
    ds_read_b64 v[98:99], v98
    v_lshlrev_b32_sdwa v100, 3, v125 dst_sel:DWORD dst_unused:UNUSED_PAD src0_sel:DWORD src1_sel:WORD_0
    v_lshlrev_b32_sdwa v102, 3, v125 dst_sel:DWORD dst_unused:UNUSED_PAD src0_sel:DWORD src1_sel:WORD_1
    ds_read_b64 v[100:101], v100
    ds_read_b64 v[102:103], v102
    s_waitcnt lgkmcnt(8)
    v_smfmac_f32_16x16x64_bf16 v[16:19], v[64:67], v[104:111], v68
    v_exp_f32 v148, v148
    buffer_store_dword v144, v70, s[12:15], s35 offen offset:0 sc1
    v_pk_mul_f32 v[150:151], v[4:5], v[146:147]
    v_exp_f32 v149, v149
    v_pk_mul_f32 v[152:153], v[152:153], v[8:9]
    v_pk_mul_f32 v[154:155], v[10:11], v[10:11]
    v_exp_f32 v152, v152
    v_pk_fma_f32 v[148:149], v[148:149], v[136:137], v[136:137]
    v_lshlrev_b32_sdwa v104, 3, v126 dst_sel:DWORD dst_unused:UNUSED_PAD src0_sel:DWORD src1_sel:WORD_0
    v_lshlrev_b32_sdwa v106, 3, v126 dst_sel:DWORD dst_unused:UNUSED_PAD src0_sel:DWORD src1_sel:WORD_1
    ds_read_b64 v[104:105], v104
    ds_read_b64 v[106:107], v106
    v_lshlrev_b32_sdwa v108, 3, v127 dst_sel:DWORD dst_unused:UNUSED_PAD src0_sel:DWORD src1_sel:WORD_0
    v_lshlrev_b32_sdwa v110, 3, v127 dst_sel:DWORD dst_unused:UNUSED_PAD src0_sel:DWORD src1_sel:WORD_1
    ds_read_b64 v[108:109], v108
    ds_read_b64 v[110:111], v110
    buffer_load_dwordx4 v[124:127], off, s[48:51], s20 offset:0 sc1
    s_waitcnt lgkmcnt(8)
    v_smfmac_f32_16x16x64_bf16 v[20:23], v[64:67], v[88:95], v68
    v_rcp_f32 v148, v148
    v_pk_fma_f32 v[154:155], v[154:155], v[128:129], v[130:131]
    v_pk_mul_f32 v[158:159], v[12:13], v[12:13]
    v_rcp_f32 v149, v149
    v_pk_mul_f32 v[154:155], v[154:155], v[10:11]
    v_pk_fma_f32 v[158:159], v[158:159], v[128:129], v[130:131]
    v_exp_f32 v153, v153
    v_pk_fma_f32 v[150:151], v[6:7], v[148:149], v[150:151]
    s_waitcnt vmcnt(3)
    v_lshlrev_b32_sdwa v88, 3, v116 dst_sel:DWORD dst_unused:UNUSED_PAD src0_sel:DWORD src1_sel:WORD_0
    v_lshlrev_b32_sdwa v90, 3, v116 dst_sel:DWORD dst_unused:UNUSED_PAD src0_sel:DWORD src1_sel:WORD_1
    ds_read_b64 v[88:89], v88
    ds_read_b64 v[90:91], v90
    v_lshlrev_b32_sdwa v92, 3, v117 dst_sel:DWORD dst_unused:UNUSED_PAD src0_sel:DWORD src1_sel:WORD_0
    v_lshlrev_b32_sdwa v94, 3, v117 dst_sel:DWORD dst_unused:UNUSED_PAD src0_sel:DWORD src1_sel:WORD_1
    ds_read_b64 v[92:93], v92
    ds_read_b64 v[94:95], v94
    s_waitcnt lgkmcnt(8)
    v_smfmac_f32_16x16x64_bf16 v[16:19], v[64:67], v[96:103], v68
    v_exp_f32 v154, v154
    v_add_f32 v150, v150, v151
    v_pk_fma_f32 v[152:153], v[152:153], v[134:135], v[134:135]
    v_exp_f32 v155, v155
    buffer_store_dword v150, v70, s[12:15], s35 offen offset:128 sc1
    v_pk_mul_f32 v[158:159], v[158:159], v[12:13]
    v_rcp_f32 v152, v152
    v_pk_fma_f32 v[154:155], v[154:155], v[136:137], v[136:137]
    v_lshlrev_b32_sdwa v96, 3, v118 dst_sel:DWORD dst_unused:UNUSED_PAD src0_sel:DWORD src1_sel:WORD_0
    v_lshlrev_b32_sdwa v98, 3, v118 dst_sel:DWORD dst_unused:UNUSED_PAD src0_sel:DWORD src1_sel:WORD_1
    ds_read_b64 v[96:97], v96
    ds_read_b64 v[98:99], v98
    v_lshlrev_b32_sdwa v100, 3, v119 dst_sel:DWORD dst_unused:UNUSED_PAD src0_sel:DWORD src1_sel:WORD_0
    v_lshlrev_b32_sdwa v102, 3, v119 dst_sel:DWORD dst_unused:UNUSED_PAD src0_sel:DWORD src1_sel:WORD_1
    ds_read_b64 v[100:101], v100
    ds_read_b64 v[102:103], v102
    buffer_load_dwordx4 v[116:119], off, s[48:51], s41 offset:0 sc1
    s_waitcnt lgkmcnt(8)
    v_smfmac_f32_16x16x64_bf16 v[20:23], v[64:67], v[104:111], v68
    v_rcp_f32 v153, v153
    v_pk_mul_f32 v[160:161], v[14:15], v[14:15]
    v_pk_mul_f32 v[164:165], v[16:17], v[16:17]
    v_rcp_f32 v154, v154
    v_pk_mul_f32 v[156:157], v[8:9], v[152:153]
    v_pk_fma_f32 v[160:161], v[160:161], v[128:129], v[130:131]
    v_rcp_f32 v155, v155
    v_pk_mul_f32 v[160:161], v[160:161], v[14:15]
    s_waitcnt vmcnt(4)
    v_lshlrev_b32_sdwa v104, 3, v120 dst_sel:DWORD dst_unused:UNUSED_PAD src0_sel:DWORD src1_sel:WORD_0
    v_lshlrev_b32_sdwa v106, 3, v120 dst_sel:DWORD dst_unused:UNUSED_PAD src0_sel:DWORD src1_sel:WORD_1
    ds_read_b64 v[104:105], v104
    ds_read_b64 v[106:107], v106
    v_lshlrev_b32_sdwa v108, 3, v121 dst_sel:DWORD dst_unused:UNUSED_PAD src0_sel:DWORD src1_sel:WORD_0
    v_lshlrev_b32_sdwa v110, 3, v121 dst_sel:DWORD dst_unused:UNUSED_PAD src0_sel:DWORD src1_sel:WORD_1
    ds_read_b64 v[108:109], v108
    ds_read_b64 v[110:111], v110
    s_waitcnt lgkmcnt(8)
    v_smfmac_f32_16x16x64_bf16 v[24:27], v[64:67], v[88:95], v68
    v_exp_f32 v158, v158
    v_pk_fma_f32 v[156:157], v[10:11], v[154:155], v[156:157]
    v_pk_fma_f32 v[164:165], v[164:165], v[128:129], v[130:131]
    v_exp_f32 v159, v159
    v_add_f32 v156, v156, v157
    v_pk_mul_f32 v[164:165], v[164:165], v[16:17]
    v_exp_f32 v160, v160
    buffer_store_dword v156, v70, s[12:15], s35 offen offset:512 sc1
    v_lshlrev_b32_sdwa v88, 3, v122 dst_sel:DWORD dst_unused:UNUSED_PAD src0_sel:DWORD src1_sel:WORD_0
    v_lshlrev_b32_sdwa v90, 3, v122 dst_sel:DWORD dst_unused:UNUSED_PAD src0_sel:DWORD src1_sel:WORD_1
    ds_read_b64 v[88:89], v88
    ds_read_b64 v[90:91], v90
    v_lshlrev_b32_sdwa v92, 3, v123 dst_sel:DWORD dst_unused:UNUSED_PAD src0_sel:DWORD src1_sel:WORD_0
    v_lshlrev_b32_sdwa v94, 3, v123 dst_sel:DWORD dst_unused:UNUSED_PAD src0_sel:DWORD src1_sel:WORD_1
    ds_read_b64 v[92:93], v92
    ds_read_b64 v[94:95], v94
    buffer_load_dwordx4 v[120:123], off, s[48:51], s45 offset:0 sc1
    s_waitcnt lgkmcnt(8)
    v_smfmac_f32_16x16x64_bf16 v[28:31], v[64:67], v[96:103], v68
    v_exp_f32 v161, v161
    v_pk_fma_f32 v[158:159], v[158:159], v[134:135], v[134:135]
    v_pk_mul_f32 v[166:167], v[18:19], v[18:19]
    v_rcp_f32 v158, v158
    v_pk_fma_f32 v[160:161], v[160:161], v[136:137], v[136:137]
    v_pk_fma_f32 v[166:167], v[166:167], v[128:129], v[130:131]
    v_rcp_f32 v159, v159
    v_pk_mul_f32 v[166:167], v[166:167], v[18:19]
    s_waitcnt vmcnt(4)
    v_lshlrev_b32_sdwa v96, 3, v124 dst_sel:DWORD dst_unused:UNUSED_PAD src0_sel:DWORD src1_sel:WORD_0
    v_lshlrev_b32_sdwa v98, 3, v124 dst_sel:DWORD dst_unused:UNUSED_PAD src0_sel:DWORD src1_sel:WORD_1
    ds_read_b64 v[96:97], v96
    ds_read_b64 v[98:99], v98
    v_lshlrev_b32_sdwa v100, 3, v125 dst_sel:DWORD dst_unused:UNUSED_PAD src0_sel:DWORD src1_sel:WORD_0
    v_lshlrev_b32_sdwa v102, 3, v125 dst_sel:DWORD dst_unused:UNUSED_PAD src0_sel:DWORD src1_sel:WORD_1
    ds_read_b64 v[100:101], v100
    ds_read_b64 v[102:103], v102
    s_waitcnt lgkmcnt(8)
    v_smfmac_f32_16x16x64_bf16 v[24:27], v[64:67], v[104:111], v68
    v_rcp_f32 v160, v160
    v_pk_mul_f32 v[162:163], v[12:13], v[158:159]
    v_pk_mul_f32 v[170:171], v[20:21], v[20:21]
    v_rcp_f32 v161, v161
    v_pk_fma_f32 v[170:171], v[170:171], v[128:129], v[130:131]
    v_pk_mul_f32 v[172:173], v[22:23], v[22:23]
    v_exp_f32 v164, v164
    v_pk_fma_f32 v[162:163], v[14:15], v[160:161], v[162:163]
    v_lshlrev_b32_sdwa v104, 3, v126 dst_sel:DWORD dst_unused:UNUSED_PAD src0_sel:DWORD src1_sel:WORD_0
    v_lshlrev_b32_sdwa v106, 3, v126 dst_sel:DWORD dst_unused:UNUSED_PAD src0_sel:DWORD src1_sel:WORD_1
    ds_read_b64 v[104:105], v104
    ds_read_b64 v[106:107], v106
    v_lshlrev_b32_sdwa v108, 3, v127 dst_sel:DWORD dst_unused:UNUSED_PAD src0_sel:DWORD src1_sel:WORD_0
    v_lshlrev_b32_sdwa v110, 3, v127 dst_sel:DWORD dst_unused:UNUSED_PAD src0_sel:DWORD src1_sel:WORD_1
    ds_read_b64 v[108:109], v108
    ds_read_b64 v[110:111], v110
    buffer_load_dwordx4 v[124:127], off, s[48:51], s20 offset:1024 sc1
    s_waitcnt lgkmcnt(8)
    v_smfmac_f32_16x16x64_bf16 v[28:31], v[64:67], v[88:95], v68
    s_setprio 2
    v_exp_f32 v165, v165
    v_add_f32 v162, v162, v163
    v_pk_mul_f32 v[170:171], v[170:171], v[20:21]
    v_exp_f32 v166, v166
    buffer_store_dword v162, v70, s[12:15], s35 offen offset:640 sc1
    v_pk_fma_f32 v[164:165], v[164:165], v[134:135], v[134:135]
    v_exp_f32 v167, v167
    v_pk_fma_f32 v[172:173], v[172:173], v[128:129], v[130:131]
    s_waitcnt vmcnt(4)
    v_lshlrev_b32_sdwa v88, 3, v116 dst_sel:DWORD dst_unused:UNUSED_PAD src0_sel:DWORD src1_sel:WORD_0
    v_lshlrev_b32_sdwa v90, 3, v116 dst_sel:DWORD dst_unused:UNUSED_PAD src0_sel:DWORD src1_sel:WORD_1
    ds_read_b64 v[88:89], v88
    ds_read_b64 v[90:91], v90
    v_lshlrev_b32_sdwa v92, 3, v117 dst_sel:DWORD dst_unused:UNUSED_PAD src0_sel:DWORD src1_sel:WORD_0
    v_lshlrev_b32_sdwa v94, 3, v117 dst_sel:DWORD dst_unused:UNUSED_PAD src0_sel:DWORD src1_sel:WORD_1
    ds_read_b64 v[92:93], v92
    ds_read_b64 v[94:95], v94
    s_waitcnt lgkmcnt(8)
    v_smfmac_f32_16x16x64_bf16 v[32:35], v[64:67], v[96:103], v68
    v_rcp_f32 v164, v164
    v_pk_fma_f32 v[166:167], v[166:167], v[136:137], v[136:137]
    v_pk_mul_f32 v[172:173], v[172:173], v[22:23]
    v_rcp_f32 v165, v165
    v_pk_mul_f32 v[140:141], v[24:25], v[24:25]
    v_pk_mul_f32 v[142:143], v[26:27], v[26:27]
    v_rcp_f32 v166, v166
    v_pk_mul_f32 v[168:169], v[16:17], v[164:165]
    v_lshlrev_b32_sdwa v96, 3, v118 dst_sel:DWORD dst_unused:UNUSED_PAD src0_sel:DWORD src1_sel:WORD_0
    v_lshlrev_b32_sdwa v98, 3, v118 dst_sel:DWORD dst_unused:UNUSED_PAD src0_sel:DWORD src1_sel:WORD_1
    ds_read_b64 v[96:97], v96
    ds_read_b64 v[98:99], v98
    v_lshlrev_b32_sdwa v100, 3, v119 dst_sel:DWORD dst_unused:UNUSED_PAD src0_sel:DWORD src1_sel:WORD_0
    v_lshlrev_b32_sdwa v102, 3, v119 dst_sel:DWORD dst_unused:UNUSED_PAD src0_sel:DWORD src1_sel:WORD_1
    ds_read_b64 v[100:101], v100
    ds_read_b64 v[102:103], v102
    buffer_load_dwordx4 v[116:119], off, s[48:51], s41 offset:1024 sc1
    s_waitcnt lgkmcnt(8)
    v_smfmac_f32_16x16x64_bf16 v[36:39], v[64:67], v[104:111], v68
    v_rcp_f32 v167, v167
    v_pk_fma_f32 v[140:141], v[140:141], v[128:129], v[130:131]
    v_pk_fma_f32 v[142:143], v[142:143], v[128:129], v[130:131]
    v_exp_f32 v170, v170
    v_pk_fma_f32 v[168:169], v[18:19], v[166:167], v[168:169]
    v_pk_mul_f32 v[140:141], v[140:141], v[24:25]
    v_exp_f32 v171, v171
    v_add_f32 v168, v168, v169
    s_waitcnt vmcnt(3)
    v_lshlrev_b32_sdwa v104, 3, v120 dst_sel:DWORD dst_unused:UNUSED_PAD src0_sel:DWORD src1_sel:WORD_0
    v_lshlrev_b32_sdwa v106, 3, v120 dst_sel:DWORD dst_unused:UNUSED_PAD src0_sel:DWORD src1_sel:WORD_1
    ds_read_b64 v[104:105], v104
    ds_read_b64 v[106:107], v106
    v_lshlrev_b32_sdwa v108, 3, v121 dst_sel:DWORD dst_unused:UNUSED_PAD src0_sel:DWORD src1_sel:WORD_0
    v_lshlrev_b32_sdwa v110, 3, v121 dst_sel:DWORD dst_unused:UNUSED_PAD src0_sel:DWORD src1_sel:WORD_1
    ds_read_b64 v[108:109], v108
    ds_read_b64 v[110:111], v110
    s_waitcnt lgkmcnt(8)
    v_smfmac_f32_16x16x64_bf16 v[32:35], v[64:67], v[88:95], v68
    v_exp_f32 v172, v172
    buffer_store_dword v168, v70, s[12:15], s35 offen offset:1024 sc1
    v_pk_fma_f32 v[170:171], v[170:171], v[134:135], v[134:135]
    v_exp_f32 v173, v173
    v_pk_mul_f32 v[142:143], v[142:143], v[26:27]
    v_pk_mul_f32 v[146:147], v[28:29], v[28:29]
    v_rcp_f32 v170, v170
    v_pk_fma_f32 v[172:173], v[172:173], v[136:137], v[136:137]
    v_lshlrev_b32_sdwa v88, 3, v122 dst_sel:DWORD dst_unused:UNUSED_PAD src0_sel:DWORD src1_sel:WORD_0
    v_lshlrev_b32_sdwa v90, 3, v122 dst_sel:DWORD dst_unused:UNUSED_PAD src0_sel:DWORD src1_sel:WORD_1
    ds_read_b64 v[88:89], v88
    ds_read_b64 v[90:91], v90
    v_lshlrev_b32_sdwa v92, 3, v123 dst_sel:DWORD dst_unused:UNUSED_PAD src0_sel:DWORD src1_sel:WORD_0
    v_lshlrev_b32_sdwa v94, 3, v123 dst_sel:DWORD dst_unused:UNUSED_PAD src0_sel:DWORD src1_sel:WORD_1
    ds_read_b64 v[92:93], v92
    ds_read_b64 v[94:95], v94
    buffer_load_dwordx4 v[120:123], off, s[48:51], s45 offset:1024 sc1
    s_waitcnt lgkmcnt(8)
    v_smfmac_f32_16x16x64_bf16 v[36:39], v[64:67], v[96:103], v68
    v_rcp_f32 v171, v171
    v_pk_fma_f32 v[146:147], v[146:147], v[128:129], v[130:131]
    v_pk_mul_f32 v[148:149], v[30:31], v[30:31]
    v_rcp_f32 v172, v172
    v_pk_mul_f32 v[174:175], v[20:21], v[170:171]
    v_pk_mul_f32 v[146:147], v[146:147], v[28:29]
    v_rcp_f32 v173, v173
    v_pk_fma_f32 v[148:149], v[148:149], v[128:129], v[130:131]
    s_waitcnt vmcnt(4)
    v_lshlrev_b32_sdwa v96, 3, v124 dst_sel:DWORD dst_unused:UNUSED_PAD src0_sel:DWORD src1_sel:WORD_0
    v_lshlrev_b32_sdwa v98, 3, v124 dst_sel:DWORD dst_unused:UNUSED_PAD src0_sel:DWORD src1_sel:WORD_1
    ds_read_b64 v[96:97], v96
    ds_read_b64 v[98:99], v98
    v_lshlrev_b32_sdwa v100, 3, v125 dst_sel:DWORD dst_unused:UNUSED_PAD src0_sel:DWORD src1_sel:WORD_0
    v_lshlrev_b32_sdwa v102, 3, v125 dst_sel:DWORD dst_unused:UNUSED_PAD src0_sel:DWORD src1_sel:WORD_1
    ds_read_b64 v[100:101], v100
    ds_read_b64 v[102:103], v102
    s_waitcnt lgkmcnt(8)
    v_smfmac_f32_16x16x64_bf16 v[32:35], v[64:67], v[104:111], v68
    v_exp_f32 v140, v140
    v_pk_fma_f32 v[174:175], v[22:23], v[172:173], v[174:175]
    v_pk_mul_f32 v[148:149], v[148:149], v[30:31]
    v_exp_f32 v141, v141
    v_add_f32 v174, v174, v175
    v_exp_f32 v142, v142
    buffer_store_dword v174, v70, s[12:15], s35 offen offset:1152 sc1
    v_pk_fma_f32 v[140:141], v[140:141], v[134:135], v[134:135]
    v_lshlrev_b32_sdwa v104, 3, v126 dst_sel:DWORD dst_unused:UNUSED_PAD src0_sel:DWORD src1_sel:WORD_0
    v_lshlrev_b32_sdwa v106, 3, v126 dst_sel:DWORD dst_unused:UNUSED_PAD src0_sel:DWORD src1_sel:WORD_1
    ds_read_b64 v[104:105], v104
    ds_read_b64 v[106:107], v106
    v_lshlrev_b32_sdwa v108, 3, v127 dst_sel:DWORD dst_unused:UNUSED_PAD src0_sel:DWORD src1_sel:WORD_0
    v_lshlrev_b32_sdwa v110, 3, v127 dst_sel:DWORD dst_unused:UNUSED_PAD src0_sel:DWORD src1_sel:WORD_1
    ds_read_b64 v[108:109], v108
    ds_read_b64 v[110:111], v110
    buffer_load_dwordx4 v[124:127], off, s[48:51], s20 offset:2048 sc1
    s_waitcnt lgkmcnt(8)
    v_smfmac_f32_16x16x64_bf16 v[36:39], v[64:67], v[88:95], v68
    v_rcp_f32 v140, v140
    v_pk_mul_f32 v[152:153], v[32:33], v[32:33]
    v_pk_mul_f32 v[154:155], v[34:35], v[34:35]
    v_rcp_f32 v141, v141
    v_pk_fma_f32 v[152:153], v[152:153], v[128:129], v[130:131]
    v_pk_fma_f32 v[154:155], v[154:155], v[128:129], v[130:131]
    v_exp_f32 v143, v143
    v_pk_mul_f32 v[144:145], v[24:25], v[140:141]
    s_waitcnt vmcnt(4)
    v_lshlrev_b32_sdwa v88, 3, v116 dst_sel:DWORD dst_unused:UNUSED_PAD src0_sel:DWORD src1_sel:WORD_0
    v_lshlrev_b32_sdwa v90, 3, v116 dst_sel:DWORD dst_unused:UNUSED_PAD src0_sel:DWORD src1_sel:WORD_1
    ds_read_b64 v[88:89], v88
    ds_read_b64 v[90:91], v90
    v_lshlrev_b32_sdwa v92, 3, v117 dst_sel:DWORD dst_unused:UNUSED_PAD src0_sel:DWORD src1_sel:WORD_0
    v_lshlrev_b32_sdwa v94, 3, v117 dst_sel:DWORD dst_unused:UNUSED_PAD src0_sel:DWORD src1_sel:WORD_1
    ds_read_b64 v[92:93], v92
    ds_read_b64 v[94:95], v94
    s_waitcnt lgkmcnt(8)
    v_smfmac_f32_16x16x64_bf16 v[40:43], v[64:67], v[96:103], v68
    v_exp_f32 v146, v146
    v_pk_fma_f32 v[142:143], v[142:143], v[136:137], v[136:137]
    v_pk_mul_f32 v[152:153], v[152:153], v[32:33]
    v_rcp_f32 v142, v142
    v_pk_mul_f32 v[154:155], v[154:155], v[34:35]
    v_pk_mul_f32 v[158:159], v[36:37], v[36:37]
    v_rcp_f32 v143, v143
    v_pk_fma_f32 v[158:159], v[158:159], v[128:129], v[130:131]
    v_lshlrev_b32_sdwa v96, 3, v118 dst_sel:DWORD dst_unused:UNUSED_PAD src0_sel:DWORD src1_sel:WORD_0
    v_lshlrev_b32_sdwa v98, 3, v118 dst_sel:DWORD dst_unused:UNUSED_PAD src0_sel:DWORD src1_sel:WORD_1
    ds_read_b64 v[96:97], v96
    ds_read_b64 v[98:99], v98
    v_lshlrev_b32_sdwa v100, 3, v119 dst_sel:DWORD dst_unused:UNUSED_PAD src0_sel:DWORD src1_sel:WORD_0
    v_lshlrev_b32_sdwa v102, 3, v119 dst_sel:DWORD dst_unused:UNUSED_PAD src0_sel:DWORD src1_sel:WORD_1
    ds_read_b64 v[100:101], v100
    ds_read_b64 v[102:103], v102
    buffer_load_dwordx4 v[116:119], off, s[48:51], s41 offset:2048 sc1
    s_waitcnt lgkmcnt(8)
    v_smfmac_f32_16x16x64_bf16 v[44:47], v[64:67], v[104:111], v68
    v_exp_f32 v147, v147
    v_pk_fma_f32 v[144:145], v[26:27], v[142:143], v[144:145]
    v_pk_mul_f32 v[158:159], v[158:159], v[36:37]
    v_exp_f32 v148, v148
    v_add_f32 v144, v144, v145
    v_pk_fma_f32 v[146:147], v[146:147], v[134:135], v[134:135]
    v_exp_f32 v149, v149
    buffer_store_dword v144, v70, s[12:15], s35 offen offset:1536 sc1
    s_waitcnt vmcnt(4)
    v_lshlrev_b32_sdwa v104, 3, v120 dst_sel:DWORD dst_unused:UNUSED_PAD src0_sel:DWORD src1_sel:WORD_0
    v_lshlrev_b32_sdwa v106, 3, v120 dst_sel:DWORD dst_unused:UNUSED_PAD src0_sel:DWORD src1_sel:WORD_1
    ds_read_b64 v[104:105], v104
    ds_read_b64 v[106:107], v106
    v_lshlrev_b32_sdwa v108, 3, v121 dst_sel:DWORD dst_unused:UNUSED_PAD src0_sel:DWORD src1_sel:WORD_0
    v_lshlrev_b32_sdwa v110, 3, v121 dst_sel:DWORD dst_unused:UNUSED_PAD src0_sel:DWORD src1_sel:WORD_1
    ds_read_b64 v[108:109], v108
    ds_read_b64 v[110:111], v110
    s_waitcnt lgkmcnt(8)
    v_smfmac_f32_16x16x64_bf16 v[40:43], v[64:67], v[88:95], v68
    v_rcp_f32 v146, v146
    v_pk_fma_f32 v[148:149], v[148:149], v[136:137], v[136:137]
    v_pk_mul_f32 v[160:161], v[38:39], v[38:39]
    v_rcp_f32 v147, v147
    v_pk_fma_f32 v[160:161], v[160:161], v[128:129], v[130:131]
    v_rcp_f32 v148, v148
    v_pk_mul_f32 v[150:151], v[28:29], v[146:147]
    v_pk_mul_f32 v[160:161], v[160:161], v[38:39]
    v_lshlrev_b32_sdwa v88, 3, v122 dst_sel:DWORD dst_unused:UNUSED_PAD src0_sel:DWORD src1_sel:WORD_0
    v_lshlrev_b32_sdwa v90, 3, v122 dst_sel:DWORD dst_unused:UNUSED_PAD src0_sel:DWORD src1_sel:WORD_1
    ds_read_b64 v[88:89], v88
    ds_read_b64 v[90:91], v90
    v_lshlrev_b32_sdwa v92, 3, v123 dst_sel:DWORD dst_unused:UNUSED_PAD src0_sel:DWORD src1_sel:WORD_0
    v_lshlrev_b32_sdwa v94, 3, v123 dst_sel:DWORD dst_unused:UNUSED_PAD src0_sel:DWORD src1_sel:WORD_1
    ds_read_b64 v[92:93], v92
    ds_read_b64 v[94:95], v94
    buffer_load_dwordx4 v[120:123], off, s[48:51], s45 offset:2048 sc1
    s_waitcnt lgkmcnt(8)
    v_smfmac_f32_16x16x64_bf16 v[44:47], v[64:67], v[96:103], v68
    v_rcp_f32 v149, v149
    v_exp_f32 v152, v152
    v_exp_f32 v153, v153
    v_pk_fma_f32 v[150:151], v[30:31], v[148:149], v[150:151]
    v_exp_f32 v154, v154
    v_add_f32 v150, v150, v151
    v_pk_fma_f32 v[152:153], v[152:153], v[134:135], v[134:135]
    v_exp_f32 v155, v155
    s_waitcnt vmcnt(3)
    v_lshlrev_b32_sdwa v96, 3, v124 dst_sel:DWORD dst_unused:UNUSED_PAD src0_sel:DWORD src1_sel:WORD_0
    v_lshlrev_b32_sdwa v98, 3, v124 dst_sel:DWORD dst_unused:UNUSED_PAD src0_sel:DWORD src1_sel:WORD_1
    ds_read_b64 v[96:97], v96
    ds_read_b64 v[98:99], v98
    v_lshlrev_b32_sdwa v100, 3, v125 dst_sel:DWORD dst_unused:UNUSED_PAD src0_sel:DWORD src1_sel:WORD_0
    v_lshlrev_b32_sdwa v102, 3, v125 dst_sel:DWORD dst_unused:UNUSED_PAD src0_sel:DWORD src1_sel:WORD_1
    ds_read_b64 v[100:101], v100
    ds_read_b64 v[102:103], v102
    s_waitcnt lgkmcnt(8)
    v_smfmac_f32_16x16x64_bf16 v[40:43], v[64:67], v[104:111], v68
    v_rcp_f32 v152, v152
    buffer_store_dword v150, v70, s[12:15], s35 offen offset:1664 sc1
    v_pk_fma_f32 v[154:155], v[154:155], v[136:137], v[136:137]
    v_rcp_f32 v153, v153
    v_rcp_f32 v154, v154
    v_rcp_f32 v155, v155
    v_pk_mul_f32 v[156:157], v[32:33], v[152:153]
    v_exp_f32 v158, v158
    v_lshlrev_b32_sdwa v104, 3, v126 dst_sel:DWORD dst_unused:UNUSED_PAD src0_sel:DWORD src1_sel:WORD_0
    v_lshlrev_b32_sdwa v106, 3, v126 dst_sel:DWORD dst_unused:UNUSED_PAD src0_sel:DWORD src1_sel:WORD_1
    ds_read_b64 v[104:105], v104
    ds_read_b64 v[106:107], v106
    v_lshlrev_b32_sdwa v108, 3, v127 dst_sel:DWORD dst_unused:UNUSED_PAD src0_sel:DWORD src1_sel:WORD_0
    v_lshlrev_b32_sdwa v110, 3, v127 dst_sel:DWORD dst_unused:UNUSED_PAD src0_sel:DWORD src1_sel:WORD_1
    ds_read_b64 v[108:109], v108
    ds_read_b64 v[110:111], v110
    buffer_load_dwordx4 v[124:127], off, s[48:51], s20 offset:3072 sc1
    s_waitcnt lgkmcnt(8)
    v_smfmac_f32_16x16x64_bf16 v[44:47], v[64:67], v[88:95], v68
    v_exp_f32 v159, v159
    v_pk_fma_f32 v[156:157], v[34:35], v[154:155], v[156:157]
    v_pk_mul_f32 v[164:165], v[40:41], v[40:41]
    v_exp_f32 v160, v160
    v_add_f32 v156, v156, v157
    v_pk_fma_f32 v[158:159], v[158:159], v[134:135], v[134:135]
    v_exp_f32 v161, v161
    buffer_store_dword v156, v70, s[12:15], s35 offen offset:2048 sc1
    s_waitcnt vmcnt(5)
    v_lshlrev_b32_sdwa v88, 3, v116 dst_sel:DWORD dst_unused:UNUSED_PAD src0_sel:DWORD src1_sel:WORD_0
    v_lshlrev_b32_sdwa v90, 3, v116 dst_sel:DWORD dst_unused:UNUSED_PAD src0_sel:DWORD src1_sel:WORD_1
    ds_read_b64 v[88:89], v88
    ds_read_b64 v[90:91], v90
    v_lshlrev_b32_sdwa v92, 3, v117 dst_sel:DWORD dst_unused:UNUSED_PAD src0_sel:DWORD src1_sel:WORD_0
    v_lshlrev_b32_sdwa v94, 3, v117 dst_sel:DWORD dst_unused:UNUSED_PAD src0_sel:DWORD src1_sel:WORD_1
    ds_read_b64 v[92:93], v92
    ds_read_b64 v[94:95], v94
    s_waitcnt lgkmcnt(8)
    v_smfmac_f32_16x16x64_bf16 v[48:51], v[64:67], v[96:103], v68
    v_rcp_f32 v158, v158
    v_pk_fma_f32 v[160:161], v[160:161], v[136:137], v[136:137]
    v_pk_fma_f32 v[164:165], v[164:165], v[128:129], v[130:131]
    v_rcp_f32 v159, v159
    v_pk_mul_f32 v[164:165], v[164:165], v[40:41]
    v_pk_mul_f32 v[166:167], v[42:43], v[42:43]
    v_rcp_f32 v160, v160
    v_pk_mul_f32 v[162:163], v[36:37], v[158:159]
    v_lshlrev_b32_sdwa v96, 3, v118 dst_sel:DWORD dst_unused:UNUSED_PAD src0_sel:DWORD src1_sel:WORD_0
    v_lshlrev_b32_sdwa v98, 3, v118 dst_sel:DWORD dst_unused:UNUSED_PAD src0_sel:DWORD src1_sel:WORD_1
    ds_read_b64 v[96:97], v96
    ds_read_b64 v[98:99], v98
    v_lshlrev_b32_sdwa v100, 3, v119 dst_sel:DWORD dst_unused:UNUSED_PAD src0_sel:DWORD src1_sel:WORD_0
    v_lshlrev_b32_sdwa v102, 3, v119 dst_sel:DWORD dst_unused:UNUSED_PAD src0_sel:DWORD src1_sel:WORD_1
    ds_read_b64 v[100:101], v100
    ds_read_b64 v[102:103], v102
    buffer_load_dwordx4 v[116:119], off, s[48:51], s41 offset:3072 sc1
    s_waitcnt lgkmcnt(8)
    v_smfmac_f32_16x16x64_bf16 v[52:55], v[64:67], v[104:111], v68
    s_setprio 1
    v_rcp_f32 v161, v161
    v_pk_fma_f32 v[166:167], v[166:167], v[128:129], v[130:131]
    v_pk_mul_f32 v[170:171], v[44:45], v[44:45]
    v_exp_f32 v164, v164
    v_pk_fma_f32 v[162:163], v[38:39], v[160:161], v[162:163]
    v_pk_mul_f32 v[166:167], v[166:167], v[42:43]
    v_exp_f32 v165, v165
    v_add_f32 v162, v162, v163
    s_waitcnt vmcnt(4)
    v_lshlrev_b32_sdwa v104, 3, v120 dst_sel:DWORD dst_unused:UNUSED_PAD src0_sel:DWORD src1_sel:WORD_0
    v_lshlrev_b32_sdwa v106, 3, v120 dst_sel:DWORD dst_unused:UNUSED_PAD src0_sel:DWORD src1_sel:WORD_1
    ds_read_b64 v[104:105], v104
    ds_read_b64 v[106:107], v106
    v_lshlrev_b32_sdwa v108, 3, v121 dst_sel:DWORD dst_unused:UNUSED_PAD src0_sel:DWORD src1_sel:WORD_0
    v_lshlrev_b32_sdwa v110, 3, v121 dst_sel:DWORD dst_unused:UNUSED_PAD src0_sel:DWORD src1_sel:WORD_1
    ds_read_b64 v[108:109], v108
    ds_read_b64 v[110:111], v110
    s_waitcnt lgkmcnt(8)
    v_smfmac_f32_16x16x64_bf16 v[48:51], v[64:67], v[88:95], v68
    v_exp_f32 v166, v166
    buffer_store_dword v162, v70, s[12:15], s35 offen offset:2176 sc1
    v_pk_fma_f32 v[164:165], v[164:165], v[134:135], v[134:135]
    v_exp_f32 v167, v167
    v_pk_fma_f32 v[170:171], v[170:171], v[128:129], v[130:131]
    v_pk_mul_f32 v[172:173], v[46:47], v[46:47]
    v_rcp_f32 v164, v164
    v_pk_fma_f32 v[166:167], v[166:167], v[136:137], v[136:137]
    v_lshlrev_b32_sdwa v88, 3, v122 dst_sel:DWORD dst_unused:UNUSED_PAD src0_sel:DWORD src1_sel:WORD_0
    v_lshlrev_b32_sdwa v90, 3, v122 dst_sel:DWORD dst_unused:UNUSED_PAD src0_sel:DWORD src1_sel:WORD_1
    ds_read_b64 v[88:89], v88
    ds_read_b64 v[90:91], v90
    v_lshlrev_b32_sdwa v92, 3, v123 dst_sel:DWORD dst_unused:UNUSED_PAD src0_sel:DWORD src1_sel:WORD_0
    v_lshlrev_b32_sdwa v94, 3, v123 dst_sel:DWORD dst_unused:UNUSED_PAD src0_sel:DWORD src1_sel:WORD_1
    ds_read_b64 v[92:93], v92
    ds_read_b64 v[94:95], v94
    buffer_load_dwordx4 v[120:123], off, s[48:51], s45 offset:3072 sc1
    s_waitcnt lgkmcnt(8)
    v_smfmac_f32_16x16x64_bf16 v[52:55], v[64:67], v[96:103], v68
    v_rcp_f32 v165, v165
    v_pk_mul_f32 v[170:171], v[170:171], v[44:45]
    v_pk_fma_f32 v[172:173], v[172:173], v[128:129], v[130:131]
    v_rcp_f32 v166, v166
    v_pk_mul_f32 v[168:169], v[40:41], v[164:165]
    v_pk_mul_f32 v[172:173], v[172:173], v[46:47]
    v_rcp_f32 v167, v167
    v_exp_f32 v170, v170
    s_waitcnt vmcnt(4)
    v_lshlrev_b32_sdwa v96, 3, v124 dst_sel:DWORD dst_unused:UNUSED_PAD src0_sel:DWORD src1_sel:WORD_0
    v_lshlrev_b32_sdwa v98, 3, v124 dst_sel:DWORD dst_unused:UNUSED_PAD src0_sel:DWORD src1_sel:WORD_1
    ds_read_b64 v[96:97], v96
    ds_read_b64 v[98:99], v98
    v_lshlrev_b32_sdwa v100, 3, v125 dst_sel:DWORD dst_unused:UNUSED_PAD src0_sel:DWORD src1_sel:WORD_0
    v_lshlrev_b32_sdwa v102, 3, v125 dst_sel:DWORD dst_unused:UNUSED_PAD src0_sel:DWORD src1_sel:WORD_1
    ds_read_b64 v[100:101], v100
    ds_read_b64 v[102:103], v102
    s_waitcnt lgkmcnt(8)
    v_smfmac_f32_16x16x64_bf16 v[48:51], v[64:67], v[104:111], v68
    v_exp_f32 v171, v171
    v_pk_fma_f32 v[168:169], v[42:43], v[166:167], v[168:169]
    v_exp_f32 v172, v172
    v_add_f32 v168, v168, v169
    v_pk_fma_f32 v[170:171], v[170:171], v[134:135], v[134:135]
    v_exp_f32 v173, v173
    buffer_store_dword v168, v70, s[12:15], s35 offen offset:2560 sc1
    v_rcp_f32 v170, v170
    v_lshlrev_b32_sdwa v104, 3, v126 dst_sel:DWORD dst_unused:UNUSED_PAD src0_sel:DWORD src1_sel:WORD_0
    v_lshlrev_b32_sdwa v106, 3, v126 dst_sel:DWORD dst_unused:UNUSED_PAD src0_sel:DWORD src1_sel:WORD_1
    ds_read_b64 v[104:105], v104
    ds_read_b64 v[106:107], v106
    v_lshlrev_b32_sdwa v108, 3, v127 dst_sel:DWORD dst_unused:UNUSED_PAD src0_sel:DWORD src1_sel:WORD_0
    v_lshlrev_b32_sdwa v110, 3, v127 dst_sel:DWORD dst_unused:UNUSED_PAD src0_sel:DWORD src1_sel:WORD_1
    ds_read_b64 v[108:109], v108
    ds_read_b64 v[110:111], v110
    s_waitcnt lgkmcnt(8)
    v_smfmac_f32_16x16x64_bf16 v[52:55], v[64:67], v[88:95], v68
    v_rcp_f32 v171, v171
    v_pk_fma_f32 v[172:173], v[172:173], v[136:137], v[136:137]
    v_pk_mul_f32 v[140:141], v[48:49], v[48:49]
    v_rcp_f32 v172, v172
    v_pk_mul_f32 v[174:175], v[44:45], v[170:171]
    v_pk_fma_f32 v[140:141], v[140:141], v[128:129], v[130:131]
    v_rcp_f32 v173, v173
    v_pk_mul_f32 v[140:141], v[140:141], v[48:49]
    s_waitcnt vmcnt(3)
    v_lshlrev_b32_sdwa v88, 3, v116 dst_sel:DWORD dst_unused:UNUSED_PAD src0_sel:DWORD src1_sel:WORD_0
    v_lshlrev_b32_sdwa v90, 3, v116 dst_sel:DWORD dst_unused:UNUSED_PAD src0_sel:DWORD src1_sel:WORD_1
    ds_read_b64 v[88:89], v88
    ds_read_b64 v[90:91], v90
    v_lshlrev_b32_sdwa v92, 3, v117 dst_sel:DWORD dst_unused:UNUSED_PAD src0_sel:DWORD src1_sel:WORD_0
    v_lshlrev_b32_sdwa v94, 3, v117 dst_sel:DWORD dst_unused:UNUSED_PAD src0_sel:DWORD src1_sel:WORD_1
    ds_read_b64 v[92:93], v92
    ds_read_b64 v[94:95], v94
    s_waitcnt lgkmcnt(8)
    v_smfmac_f32_16x16x64_bf16 v[56:59], v[64:67], v[96:103], v68
    v_exp_f32 v140, v140
    v_pk_fma_f32 v[174:175], v[46:47], v[172:173], v[174:175]
    v_pk_mul_f32 v[142:143], v[50:51], v[50:51]
    v_exp_f32 v141, v141
    v_add_f32 v174, v174, v175
    v_pk_fma_f32 v[142:143], v[142:143], v[128:129], v[130:131]
    buffer_store_dword v174, v70, s[12:15], s35 offen offset:2688 sc1
    v_pk_fma_f32 v[140:141], v[140:141], v[134:135], v[134:135]
    v_lshlrev_b32_sdwa v96, 3, v118 dst_sel:DWORD dst_unused:UNUSED_PAD src0_sel:DWORD src1_sel:WORD_0
    v_lshlrev_b32_sdwa v98, 3, v118 dst_sel:DWORD dst_unused:UNUSED_PAD src0_sel:DWORD src1_sel:WORD_1
    ds_read_b64 v[96:97], v96
    ds_read_b64 v[98:99], v98
    v_lshlrev_b32_sdwa v100, 3, v119 dst_sel:DWORD dst_unused:UNUSED_PAD src0_sel:DWORD src1_sel:WORD_0
    v_lshlrev_b32_sdwa v102, 3, v119 dst_sel:DWORD dst_unused:UNUSED_PAD src0_sel:DWORD src1_sel:WORD_1
    ds_read_b64 v[100:101], v100
    ds_read_b64 v[102:103], v102
    s_waitcnt lgkmcnt(8)
    v_smfmac_f32_16x16x64_bf16 v[60:63], v[64:67], v[104:111], v68
    v_rcp_f32 v140, v140
    v_pk_mul_f32 v[142:143], v[142:143], v[50:51]
    v_pk_mul_f32 v[146:147], v[52:53], v[52:53]
    v_rcp_f32 v141, v141
    v_pk_fma_f32 v[146:147], v[146:147], v[128:129], v[130:131]
    v_pk_mul_f32 v[148:149], v[54:55], v[54:55]
    v_exp_f32 v142, v142
    v_pk_mul_f32 v[144:145], v[48:49], v[140:141]
    s_waitcnt vmcnt(2)
    v_lshlrev_b32_sdwa v104, 3, v120 dst_sel:DWORD dst_unused:UNUSED_PAD src0_sel:DWORD src1_sel:WORD_0
    v_lshlrev_b32_sdwa v106, 3, v120 dst_sel:DWORD dst_unused:UNUSED_PAD src0_sel:DWORD src1_sel:WORD_1
    ds_read_b64 v[104:105], v104
    ds_read_b64 v[106:107], v106
    v_lshlrev_b32_sdwa v108, 3, v121 dst_sel:DWORD dst_unused:UNUSED_PAD src0_sel:DWORD src1_sel:WORD_0
    v_lshlrev_b32_sdwa v110, 3, v121 dst_sel:DWORD dst_unused:UNUSED_PAD src0_sel:DWORD src1_sel:WORD_1
    ds_read_b64 v[108:109], v108
    ds_read_b64 v[110:111], v110
    s_waitcnt lgkmcnt(8)
    v_smfmac_f32_16x16x64_bf16 v[56:59], v[64:67], v[88:95], v68
    v_exp_f32 v143, v143
    v_pk_mul_f32 v[146:147], v[146:147], v[52:53]
    v_pk_fma_f32 v[148:149], v[148:149], v[128:129], v[130:131]
    v_exp_f32 v146, v146
    v_pk_fma_f32 v[142:143], v[142:143], v[136:137], v[136:137]
    v_pk_mul_f32 v[148:149], v[148:149], v[54:55]
    v_rcp_f32 v142, v142
    v_rcp_f32 v143, v143
    v_lshlrev_b32_sdwa v88, 3, v122 dst_sel:DWORD dst_unused:UNUSED_PAD src0_sel:DWORD src1_sel:WORD_0
    v_lshlrev_b32_sdwa v90, 3, v122 dst_sel:DWORD dst_unused:UNUSED_PAD src0_sel:DWORD src1_sel:WORD_1
    ds_read_b64 v[88:89], v88
    ds_read_b64 v[90:91], v90
    v_lshlrev_b32_sdwa v92, 3, v123 dst_sel:DWORD dst_unused:UNUSED_PAD src0_sel:DWORD src1_sel:WORD_0
    v_lshlrev_b32_sdwa v94, 3, v123 dst_sel:DWORD dst_unused:UNUSED_PAD src0_sel:DWORD src1_sel:WORD_1
    ds_read_b64 v[92:93], v92
    ds_read_b64 v[94:95], v94
    s_waitcnt lgkmcnt(8)
    v_smfmac_f32_16x16x64_bf16 v[60:63], v[64:67], v[96:103], v68
    s_setprio 0
    v_exp_f32 v147, v147
    v_pk_fma_f32 v[144:145], v[50:51], v[142:143], v[144:145]
    v_exp_f32 v148, v148
    v_add_f32 v144, v144, v145
    v_pk_fma_f32 v[146:147], v[146:147], v[134:135], v[134:135]
    v_exp_f32 v149, v149
    buffer_store_dword v144, v70, s[12:15], s35 offen offset:3072 sc1
    v_rcp_f32 v146, v146
    s_waitcnt lgkmcnt(4)
    v_smfmac_f32_16x16x64_bf16 v[56:59], v[64:67], v[104:111], v68
    v_rcp_f32 v147, v147
    v_pk_fma_f32 v[148:149], v[148:149], v[136:137], v[136:137]
    s_waitcnt lgkmcnt(0)
    v_smfmac_f32_16x16x64_bf16 v[60:63], v[64:67], v[88:95], v68
    v_rcp_f32 v148, v148
    v_pk_mul_f32 v[150:151], v[52:53], v[146:147]
    v_rcp_f32 v149, v149
    s_nop 0
    s_nop 0
    v_pk_fma_f32 v[150:151], v[54:55], v[148:149], v[150:151]
    s_nop 0
    v_add_f32 v150, v150, v151
    v_pk_mul_f32 v[152:153], v[56:57], v[56:57]
    buffer_store_dword v150, v70, s[12:15], s35 offen offset:3200 sc1
    v_pk_fma_f32 v[152:153], v[152:153], v[128:129], v[130:131]
    v_pk_mul_f32 v[154:155], v[58:59], v[58:59]
    v_pk_mul_f32 v[152:153], v[152:153], v[56:57]
    v_pk_fma_f32 v[154:155], v[154:155], v[128:129], v[130:131]
    v_exp_f32 v152, v152
    v_pk_mul_f32 v[154:155], v[154:155], v[58:59]
    v_pk_mul_f32 v[158:159], v[60:61], v[60:61]
    v_exp_f32 v153, v153
    v_pk_fma_f32 v[158:159], v[158:159], v[128:129], v[130:131]
    v_pk_mul_f32 v[160:161], v[62:63], v[62:63]
    v_exp_f32 v154, v154
    v_pk_fma_f32 v[152:153], v[152:153], v[134:135], v[134:135]
    v_pk_mul_f32 v[158:159], v[158:159], v[60:61]
    v_rcp_f32 v152, v152
    v_pk_fma_f32 v[160:161], v[160:161], v[128:129], v[130:131]
    v_rcp_f32 v153, v153
    v_pk_mul_f32 v[160:161], v[160:161], v[62:63]
    v_exp_f32 v155, v155
    v_pk_mul_f32 v[156:157], v[56:57], v[152:153]
    v_exp_f32 v158, v158
    v_pk_fma_f32 v[154:155], v[154:155], v[136:137], v[136:137]
    v_exp_f32 v159, v159
    v_rcp_f32 v154, v154
    v_rcp_f32 v155, v155
    v_pk_fma_f32 v[158:159], v[158:159], v[134:135], v[134:135]
    v_exp_f32 v160, v160
    v_pk_fma_f32 v[156:157], v[58:59], v[154:155], v[156:157]
    v_rcp_f32 v158, v158
    v_add_f32 v156, v156, v157
    v_rcp_f32 v159, v159
    buffer_store_dword v156, v70, s[12:15], s35 offen offset:3584 sc1
    v_exp_f32 v161, v161
    v_pk_mul_f32 v[162:163], v[60:61], v[158:159]
    s_nop 0
    v_pk_fma_f32 v[160:161], v[160:161], v[136:137], v[136:137]
    s_nop 0
    v_rcp_f32 v160, v160
    v_rcp_f32 v161, v161
    s_nop 0
    s_nop 0
    v_pk_fma_f32 v[162:163], v[62:63], v[160:161], v[162:163]
    s_nop 0
    v_add_f32 v162, v162, v163
    s_nop 0
    buffer_store_dword v162, v70, s[12:15], s35 offen offset:3712 sc1
    s_branch standalone__deep_cross_pnn__recsys_kernel_red
standalone__deep_cross_pnn__recsys_kernel_end:
    s_endpgm
.section .rodata,"a"
.p2align 6
.amdhsa_kernel standalone__deep_cross_pnn__recsys_kernel
  .amdhsa_next_free_vgpr 256
  .amdhsa_next_free_sgpr 102
  .amdhsa_accum_offset 256
  .amdhsa_group_segment_fixed_size 0
  .amdhsa_kernarg_size 80
  .amdhsa_user_sgpr_count 2
  .amdhsa_user_sgpr_kernarg_segment_ptr 1
  .amdhsa_system_sgpr_workgroup_id_x 1
.end_amdhsa_kernel
```
